```python
import torch

def _softmax(x, axis=-1):
    return torch.softmax(x, dim=axis)

def _gelu(x):
    return torch.nn.functional.gelu(x, approximate='tanh')

def _silu(x):
    return torch.nn.functional.silu(x)

def _sigmoid(x):
    return torch.sigmoid(x)

def _layernorm(x, axis=-1, eps=1e-05):
    m = x.mean(dim=axis, keepdim=True)
    v = x.var(dim=axis, keepdim=True, unbiased=False)
    return (x - m) / torch.sqrt(v + eps)

def _scatter_add(tgt, idx, src, axis=0):
    return tgt.clone().index_add_(axis, idx, src)

def _segment_sum(src, seg, n):
    out = torch.zeros((n,) + src.shape[1:], dtype=src.dtype)
    return out.index_add_(0, seg, src)

def _pad(x, pw):
    flat = tuple((v for pair in reversed(pw) for v in pair))
    return torch.nn.functional.pad(x, flat)
kernel_name = 'parallel_sum__sliding_local_dilated__mixer_gmlp__prompt'

def setup_inputs():

    _w = lambda a: (lambda t: t.to(torch.bfloat16) if t.is_floating_point() else t)(torch.as_tensor(a))

    def _A_setup():
        B, S, D = (1, 2048, 1024)
        return {'x': _w((lambda *s: torch.randn(*s, dtype=torch.bfloat16) * 0.05)(B, S, D)), 'wqkv': _w((lambda *s: torch.randn(*s, dtype=torch.bfloat16) * 0.2)(D, 3 * D)), 'wo': _w((lambda *s: torch.randn(*s, dtype=torch.bfloat16) * 0.1)(D, D))}
    _A_in = _A_setup()

    def _B_setup():
        B, S, D, F = (1, 2048, 1024, 3584)
        Fh = F // 2
        return {'x': _w((lambda *s: torch.randn(*s, dtype=torch.bfloat16) * 0.05)(B, S, D)), 'w_in': _w((lambda *s: torch.randn(*s, dtype=torch.bfloat16) * 1.6)(D, 2 * Fh)), 'w_sp': _w(0.01 * (lambda *s: torch.randn(*s, dtype=torch.bfloat16) * 1.6)(S, S)), 'b_sp': _w(1.0 + 0.01 * (lambda *s: torch.randn(*s, dtype=torch.bfloat16) * 0.05)(S)), 'w_out': _w((lambda *s: torch.randn(*s, dtype=torch.bfloat16) * 0.05)(Fh, D))}
    _B_in = _B_setup()
    return {'A_x': _A_in['x'], 'A_wqkv': _A_in['wqkv'], 'A_wo': _A_in['wo'], 'B_x': _B_in['x'], 'B_w_in': _B_in['w_in'], 'B_w_sp': _B_in['w_sp'], 'B_b_sp': _B_in['b_sp'], 'B_w_out': _B_in['w_out']}

def reference(A_x, A_wqkv, A_wo, B_x, B_w_in, B_w_sp, B_b_sp, B_w_out):

    def _A_ref(x, wqkv, wo):
        B, S, D = x.shape
        H = 32
        Dh = D // H
        W, dil = (8, 2)
        qkv = (lambda x, *d: x.permute(*d))((x @ wqkv).reshape(B, S, 3, H, Dh), 2, 0, 3, 1, 4)
        q, k, v = (qkv[0], qkv[1], qkv[2])
        scale = Dh ** (-0.5)
        pos = torch.arange(S)
        off = torch.arange(W) * dil
        idx = pos[:, None] - off[None, :]
        mask = idx >= 0
        idx_c = torch.where(mask, idx, 0).reshape(-1)
        kg = k[:, :, idx_c, :].reshape(B, H, S, W, Dh)
        vg = v[:, :, idx_c, :].reshape(B, H, S, W, Dh)
        logits = torch.einsum('bhsd,bhswd->bhsw', q, kg) * scale
        logits = torch.where(mask[None, None, :, :], logits, -1000000000.0)
        attn = _softmax(logits, axis=-1)
        o = torch.einsum('bhsw,bhswd->bhsd', attn, vg)
        return (lambda x, *d: x.permute(*d))(o, 0, 2, 1, 3).reshape(B, S, D) @ wo

    def _B_ref(x, w_in, w_sp, b_sp, w_out):
        B, S, D = x.shape
        F = w_in.shape[-1]
        Fh = F // 2
        z = _gelu(torch.einsum('bsd,df->bsf', x, w_in))
        z1 = z[..., :Fh].clone()
        z2 = _layernorm(z[..., Fh:], axis=-1)
        g = torch.einsum('ts,bsf->btf', w_sp, z2) + b_sp[None, :, None]
        return torch.einsum('bsf,fd->bsd', z1 * g, w_out)
    x = A_x
    xn = _layernorm(x, axis=-1)
    return x + _A_ref(xn, A_wqkv, A_wo) + _B_ref(xn, B_w_in, B_w_sp, B_b_sp, B_w_out)
```

```asm
; @launch grid=(256,1,1) block=(256,1,1) lds=163840
.amdgcn_target "amdgcn-amd-amdhsa--gfx950"
.text
.globl parallel_sum__sliding_local_dilated__mixer_gmlp__prompt_kernel
.p2align 8
.type parallel_sum__sliding_local_dilated__mixer_gmlp__prompt_kernel,@function
parallel_sum__sliding_local_dilated__mixer_gmlp__prompt_kernel:
L_code:
    s_cmp_ge_u32 s2, 256
    s_cbranch_scc1 L_exit
    s_load_dwordx16 s[4:19], s[0:1], 0
    s_load_dwordx2 s[20:21], s[0:1], 64
    s_load_dwordx2 s[24:25], s[0:1], 80
    v_lshrrev_b32 v1, 6, v0
    v_and_b32 v0, 63, v0
    v_readfirstlane_b32 s3, v1
    s_lshr_b32 s64, s2, 3
    v_lshl_add_u32 v1, s64, 2, v1
    v_and_b32 v2, 7, v0
    v_lshl_add_u32 v2, v1, 3, v2
    v_lshlrev_b32 v4, 7, v2
    s_getpc_b64 s[64:65]
L_pc_1:
    s_sub_u32 s64, s64, L_pc_1-L_code
    s_subb_u32 s65, s65, 0
    v_min_u32 v4, L_exit-L_code, v4
    v_mov_b32 v5, s65
    v_add_co_u32 v4, vcc, s64, v4
    s_nop 1
    v_addc_co_u32 v5, vcc, 0, v5, vcc
    global_load_dword a240, v[4:5], off
    s_lshr_b32 s64, s2, 1
    s_and_b32 s65, s64, 3
    s_and_b32 s92, s2, 1
    s_lshr_b32 s66, s2, 2
    s_lshl1_add_u32 s66, s66, s92
    s_lshl2_add_u32 s66, s66, s3
    s_and_b32 s67, s64, 1
    s_lshl2_add_u32 s66, s66, s67
    s_mov_b32 s38, 0x400000
    s_lshl_b32 s66, s66, 11
    s_add_u32 s67, s66, 4096
    v_lshrrev_b32 v1, 2, v0
    v_and_b32 v2, 3, v0
    v_lshlrev_b32 v3, 4, v0
    s_mov_b32 s39, 0x20000
    s_waitcnt lgkmcnt(0)
    s_mov_b64 s[36:37], s[4:5]
    buffer_load_dwordx4 v[24:27], v3, s[36:39], s66 offen offset:0
    buffer_load_dwordx4 v[28:31], v3, s[36:39], s66 offen offset:1024
    buffer_load_dwordx4 v[32:35], v3, s[36:39], s67 offen offset:0
    buffer_load_dwordx4 v[36:39], v3, s[36:39], s67 offen offset:1024
    s_add_u32 s44, s24, 0x2000000
    s_addc_u32 s45, s25, 0
    s_mov_b32 s46, 0x64000
    s_mov_b32 s47, 0x20000
    s_mov_b32 s28, s24
    s_mov_b32 s29, s25
    s_mov_b32 s30, 0x400000
    s_mov_b32 s31, 0x20000
    s_mov_b32 s67, 0x5c000
    buffer_load_dword v250, off, s[44:47], s67 sc1
    s_lshr_b32 s84, s64, 2
    s_lshl_b32 s84, s84, 17
    s_lshl_b32 s65, s65, 10
    s_add_u32 s84, s84, s65
    s_lshl_b32 s65, s3, 15
    s_add_u32 s90, s84, s65
    s_lshl_b32 s92, s92, 7
    s_add_u32 s90, s90, s92
    s_bitcmp1_b32 s3, 0
    s_cselect_b32 s40, s12, s6
    s_cselect_b32 s41, s13, s7
    s_cselect_b32 s70, 28, 24
    s_lshl_b32 s70, s70, 2
    s_lshr_b32 s71, s3, 1
    s_mul_i32 s72, s71, s70
    s_lshl_b32 s42, s72, 16
    s_mov_b32 s43, 0x20000
    s_lshl_b32 s71, s71, 8
    s_sub_u32 s71, s2, s71
    s_add_u32 s71, s71, 256
    v_mul_lo_u32 v4, v0, s70
    s_mul_i32 s71, s70, s71
    s_lshl_b32 s71, s71, 6
    buffer_load_dword a240, v4, s[40:43], s71 offen
    s_add_u32 s71, s71, s70
    s_lshl2_add_u32 s91, s2, s3
    s_lshl_b32 s91, s91, 8
    s_lshl_b32 s63, s2, 7
    s_add_u32 s63, s63, 262144
    s_and_b32 s70, s2, 7
    s_lshr_b32 s71, s2, 3
    s_and_b32 s72, s70, 1
    s_lshl_b32 s73, s72, 2
    s_and_b32 s74, s71, 3
    s_add_u32 s73, s73, s74
    s_lshr_b32 s75, s70, 1
    s_lshr_b32 s76, s71, 2
    s_lshl_b32 s48, s73, 2
    s_add_u32 s48, s48, s3
    s_lshl_b32 s96, s75, 2
    s_add_u32 s96, s96, s74
    s_mul_i32 s97, s72, 7
    s_add_u32 s97, s97, s76
    s_lshr_b32 s77, s76, 2
    s_sub_u32 s97, s97, s77
    s_lshl_b32 s97, s97, 2
    s_add_u32 s97, s97, s3
    s_cmp_lg_u32 s76, 3
    s_cselect_b32 s62, 1, 0
    s_mov_b32 s36, s16
    s_mov_b32 s37, s17
    s_mov_b32 s38, 0x1000
    s_mov_b32 s39, 0x20000
    v_and_b32 v4, 15, v0
    v_lshlrev_b32 v4, 2, v4
    s_lshl_b32 s77, s96, 8
    buffer_load_dword a244, v4, s[36:39], s77 offen offset:0
    buffer_load_dword a245, v4, s[36:39], s77 offen offset:64
    buffer_load_dword a246, v4, s[36:39], s77 offen offset:128
    buffer_load_dword a247, v4, s[36:39], s77 offen offset:192
    s_lshl_b32 s52, s73, 19
    s_mov_b32 s51, 0x40000000
    s_cmp_lt_u32 s76, 4
    s_cselect_b32 s83, 7, 6
    s_lshl_b32 s83, s83, 10
    s_mul_i32 s55, s3, s83
    s_lshl_b32 s83, s83, 3
    s_lshl_b32 s50, s73, 2
    s_add_u32 s50, s50, s75
    s_lshl_b32 s50, s50, 3
    s_add_u32 s50, s50, s76
    s_lshl_b32 s50, s50, 7
    s_add_u32 s50, s50, 311296
    v_lshlrev_b32 v224, 4, v0
    v_bfe_u32 v4, v0, 3, 2
    v_lshlrev_b32 v5, 3, v2
    v_lshl_add_u32 v6, v1, 7, v5
    v_xor_b32 v7, 0, v4
    v_lshl_add_u32 v229, v7, 5, v6
    v_xor_b32 v7, 1, v4
    v_lshl_add_u32 v230, v7, 5, v6
    v_xor_b32 v7, 2, v4
    v_lshl_add_u32 v231, v7, 5, v6
    v_xor_b32 v7, 3, v4
    v_lshl_add_u32 v232, v7, 5, v6
    v_xor_b32 v7, s3, v4
    v_lshl_add_u32 v247, v7, 5, v6
    v_add_u32 v248, s83, v247
    v_add_u32 v249, s83, v248
    v_lshl_add_u32 v6, v1, 6, v5
    v_bfe_u32 v4, v0, 4, 1
    v_xor_b32 v7, 0, v4
    v_lshl_add_u32 v233, v7, 5, v6
    v_xor_b32 v7, 1, v4
    v_lshl_add_u32 v234, v7, 5, v6
    v_add_u32 v235, s83, v229
    v_add_u32 v236, s83, v230
    v_add_u32 v237, s83, v231
    v_add_u32 v238, s83, v232
    v_add_u32 v239, s83, v233
    v_add_u32 v240, s83, v234
    v_add_u32 v241, s83, v235
    v_add_u32 v242, s83, v236
    v_add_u32 v243, s83, v237
    v_add_u32 v244, s83, v238
    v_add_u32 v245, s83, v239
    v_add_u32 v246, s83, v240
    s_and_b32 s77, s76, 3
    s_lshl_b32 s49, s75, 2
    s_add_u32 s49, s49, s77
    s_sub_u32 s32, s12, 4096
    s_subb_u32 s33, s13, 0
    s_mov_b32 s34, 0x701000
    s_mov_b32 s81, 7168
    s_mov_b32 s82, 0
    s_mov_b32 s80, s51
    s_cmp_ge_u32 s76, 4
    s_cbranch_scc1 L_zsetup_2
    s_lshl_b32 s77, s49, 7
    s_add_u32 s77, s77, 4096
    s_add_u32 s78, s77, 2048
    s_add_u32 s79, s77, 4096
    s_add_u32 s60, s49, 40
    s_lshl_b32 s80, s60, 6
    s_add_u32 s80, s80, 2048
    s_sub_u32 s32, s6, 4096
    s_subb_u32 s33, s7, 0
    s_mov_b32 s34, 0x601000
    s_mov_b32 s81, 6144
    s_cmp_eq_u32 s73, 0
    s_cselect_b32 s82, 0, 0x20000
    s_branch L_setup_done_4
L_zsetup_2:
    s_cmp_ge_u32 s49, 14
    s_cbranch_scc1 L_csetup_3
    s_lshl_b32 s77, s49, 8
    s_add_u32 s77, s77, 7680
    s_add_u32 s78, s77, 128
    s_lshl_b32 s60, s49, 1
    s_lshl_b32 s79, s49, 7
    s_add_u32 s79, s79, 4096
    s_branch L_setup_done_4
L_csetup_3:
    s_mul_i32 s60, s49, 6
    s_sub_u32 s60, s60, 56
    s_lshl_b32 s77, s60, 6
    s_add_u32 s77, s77, 4096
    s_add_u32 s78, s77, 128
    s_add_u32 s79, s77, 256
L_setup_done_4:
    s_mov_b32 s35, 0x20000
    s_lshl_b32 s59, s81, 6
    v_lshrrev_b32 v4, 3, v0
    v_lshrrev_b32 v5, 4, v0
    v_and_b32 v6, 7, v0
    v_lshlrev_b32 v7, 1, v5
    v_xor_b32 v6, v6, v7
    s_mul_i32 s84, s3, s81
    s_lshl_b32 s84, s84, 4
    v_mul_lo_u32 v4, v4, s81
    v_lshl_add_u32 v4, v6, 4, v4
    v_add_u32 v227, s84, v4
    v_and_b32 v7, 2, v7
    v_xor_b32 v6, v2, v7
    v_mul_u32_u24 v4, 7168, v1
    v_lshl_add_u32 v4, v6, 4, v4
    s_mul_i32 s84, s3, 114688
    v_add_u32 v228, s84, v4
    s_mov_b32 s56, 2
    v_bfe_u32 v4, v0, 3, 1
    v_or_b32 v5, 8, v0
    v_lshlrev_b32 v5, 4, v5
    v_lshl_add_u32 v4, v4, 10, v5
    s_lshl_b32 s84, s3, 17
    s_add_u32 s84, s84, s82
    v_add_u32 v225, 2048, v4
    v_add_u32 v224, s84, v224
    s_sub_u32 s52, s52, s82
    s_add_u32 s53, s52, 4096
    s_lshl_b32 s86, s73, 5
    s_lshr_b32 s87, s82, 14
    s_sub_u32 s86, s86, s87
    s_add_u32 s87, s87, 31
    v_min_u32 v252, s87, v0
    v_add_u32 v252, s86, v252
    v_lshlrev_b32 v252, 7, v252
    v_add_u32 v252, 262144, v252
    s_sub_u32 s40, s12, 4096
    s_subb_u32 s41, s13, 0
    s_mov_b32 s42, 0x701000
    s_mov_b32 s43, 0x20000
    s_lshl_b32 s86, s81, 3
    s_sub_u32 s64, s77, 0
    s_sub_u32 s65, s77, 1024
    s_add_u32 s65, s65, s86
    s_sub_u32 s66, s78, 2048
    s_sub_u32 s67, s78, 3072
    s_add_u32 s67, s67, s86
    s_sub_u32 s68, s79, 0
    s_sub_u32 s69, s79, 1024
    s_add_u32 s69, s69, s86
    s_mov_b32 s70, s80
    s_mov_b32 s58, 8192
    s_mov_b32 s61, 458752
    v_and_b32 v4, 1, v0
    v_lshl_add_u32 v5, v1, 1, v4
    v_lshlrev_b32 v6, 8, v5
    v_and_b32 v5, 7, v5
    s_lshl_b32 s84, s3, 1
    v_xor_b32 v5, s84, v5
    v_bfe_u32 v4, v0, 1, 1
    v_lshl_add_u32 v6, v4, 3, v6
    v_add_u32 v6, 57344, v6
    v_lshl_add_u32 v6, v5, 4, v6
    v_lshrrev_b32 v4, 4, v0
    v_xor_b32 v4, v4, v0
    s_lshl_b32 s84, s3, 12
    s_add_u32 s84, s84, 57344
    v_lshl_add_u32 v7, v4, 4, s84
    v_lshrrev_b32 v4, 5, v0
    v_bfe_u32 v5, v0, 3, 2
    v_lshl_add_u32 v4, v4, 4, v5
    v_and_b32 v5, 7, v0
    v_lshl_add_u32 v4, v4, 4, v5
    v_lshlrev_b32 v61, 4, v4
    s_waitcnt vmcnt(8)
    v_lshlrev_b32 v64, 16, v24
    v_and_b32 v65, 0xffff0000, v24
    v_lshlrev_b32 v66, 16, v25
    v_and_b32 v67, 0xffff0000, v25
    v_lshlrev_b32 v68, 16, v26
    v_and_b32 v69, 0xffff0000, v26
    v_lshlrev_b32 v70, 16, v27
    v_and_b32 v71, 0xffff0000, v27
    v_lshlrev_b32 v72, 16, v28
    v_and_b32 v73, 0xffff0000, v28
    v_lshlrev_b32 v74, 16, v29
    v_and_b32 v75, 0xffff0000, v29
    v_lshlrev_b32 v76, 16, v30
    v_and_b32 v77, 0xffff0000, v30
    v_lshlrev_b32 v78, 16, v31
    v_and_b32 v79, 0xffff0000, v31
    v_pk_add_f32 v[40:41], v[64:65], v[66:67]
    v_pk_mul_f32 v[48:49], v[64:65], v[64:65]
    v_pk_fma_f32 v[48:49], v[66:67], v[66:67], v[48:49]
    v_pk_add_f32 v[40:41], v[40:41], v[68:69]
    v_pk_fma_f32 v[48:49], v[68:69], v[68:69], v[48:49]
    v_pk_add_f32 v[40:41], v[40:41], v[70:71]
    v_pk_fma_f32 v[48:49], v[70:71], v[70:71], v[48:49]
    v_pk_add_f32 v[40:41], v[40:41], v[72:73]
    v_pk_fma_f32 v[48:49], v[72:73], v[72:73], v[48:49]
    v_pk_add_f32 v[40:41], v[40:41], v[74:75]
    v_pk_fma_f32 v[48:49], v[74:75], v[74:75], v[48:49]
    v_pk_add_f32 v[40:41], v[40:41], v[76:77]
    v_pk_fma_f32 v[48:49], v[76:77], v[76:77], v[48:49]
    v_pk_add_f32 v[40:41], v[40:41], v[78:79]
    v_pk_fma_f32 v[48:49], v[78:79], v[78:79], v[48:49]
    s_waitcnt vmcnt(6)
    v_lshlrev_b32 v80, 16, v32
    v_and_b32 v81, 0xffff0000, v32
    v_lshlrev_b32 v82, 16, v33
    v_and_b32 v83, 0xffff0000, v33
    v_lshlrev_b32 v84, 16, v34
    v_and_b32 v85, 0xffff0000, v34
    v_lshlrev_b32 v86, 16, v35
    v_and_b32 v87, 0xffff0000, v35
    v_lshlrev_b32 v88, 16, v36
    v_and_b32 v89, 0xffff0000, v36
    v_lshlrev_b32 v90, 16, v37
    v_and_b32 v91, 0xffff0000, v37
    v_lshlrev_b32 v92, 16, v38
    v_and_b32 v93, 0xffff0000, v38
    v_lshlrev_b32 v94, 16, v39
    v_and_b32 v95, 0xffff0000, v39
    v_pk_add_f32 v[42:43], v[80:81], v[82:83]
    v_pk_mul_f32 v[50:51], v[80:81], v[80:81]
    v_pk_fma_f32 v[50:51], v[82:83], v[82:83], v[50:51]
    v_pk_add_f32 v[42:43], v[42:43], v[84:85]
    v_pk_fma_f32 v[50:51], v[84:85], v[84:85], v[50:51]
    v_pk_add_f32 v[42:43], v[42:43], v[86:87]
    v_pk_fma_f32 v[50:51], v[86:87], v[86:87], v[50:51]
    v_pk_add_f32 v[42:43], v[42:43], v[88:89]
    v_pk_fma_f32 v[50:51], v[88:89], v[88:89], v[50:51]
    v_pk_add_f32 v[42:43], v[42:43], v[90:91]
    v_pk_fma_f32 v[50:51], v[90:91], v[90:91], v[50:51]
    v_pk_add_f32 v[42:43], v[42:43], v[92:93]
    v_pk_fma_f32 v[50:51], v[92:93], v[92:93], v[50:51]
    v_pk_add_f32 v[42:43], v[42:43], v[94:95]
    v_pk_fma_f32 v[50:51], v[94:95], v[94:95], v[50:51]
    v_add_f32 v40, v40, v41
    v_add_f32 v42, v42, v43
    v_add_f32 v48, v48, v49
    v_add_f32 v50, v50, v51
    s_nop 0
    v_permlane32_swap_b32 v40, v42
    v_permlane32_swap_b32 v48, v50
    v_add_f32 v40, v40, v42
    v_add_f32 v48, v48, v50
    v_mov_b32 v42, v40
    v_mov_b32 v50, v48
    s_nop 0
    v_permlane16_swap_b32 v40, v42
    v_permlane16_swap_b32 v48, v50
    v_add_f32 v40, v40, v42
    v_add_f32 v48, v48, v50
    s_nop 0
    v_add_f32_dpp v40, v40, v40 row_ror:8 row_mask:0xf bank_mask:0xf
    v_add_f32_dpp v48, v48, v48 row_ror:8 row_mask:0xf bank_mask:0xf
    s_nop 0
    v_add_f32_dpp v40, v40, v40 row_ror:4 row_mask:0xf bank_mask:0xf
    v_add_f32_dpp v48, v48, v48 row_ror:4 row_mask:0xf bank_mask:0xf
    s_nop 0
    v_add_f32_dpp v40, v40, v40 row_ror:2 row_mask:0xf bank_mask:0xf
    v_add_f32_dpp v48, v48, v48 row_ror:2 row_mask:0xf bank_mask:0xf
    s_nop 0
    v_add_f32_dpp v40, v40, v40 row_ror:1 row_mask:0xf bank_mask:0xf
    v_add_f32_dpp v48, v48, v48 row_ror:1 row_mask:0xf bank_mask:0xf
    v_mul_f32 v40, 0x3a800000, v40
    v_mul_f32 v48, 0x3a800000, v48
    v_fma_f32 v48, -v40, v40, v48
    v_max_f32 v48, 0, v48
    v_cvt_pk_bf16_f32 v40, 0, v40
    v_cvt_pk_bf16_f32 v48, 0, v48
    v_add_f32 v48, 0x3727c5ac, v48
    v_cvt_pk_bf16_f32 v48, 0, v48
    v_sqrt_f32 v48, v48
    s_nop 0
    v_cvt_pk_bf16_f32 v48, 0, v48
    v_rcp_f32 v41, v48
    s_nop 0
    v_readlane_b32 s84, v40, 0
    v_readlane_b32 s85, v41, 0
    v_readlane_b32 s86, v40, 32
    v_readlane_b32 s87, v41, 32
    v_pk_add_f32 v[64:65], v[64:65], s[84:85] op_sel:[0,0] op_sel_hi:[1,0] neg_lo:[0,1] neg_hi:[0,1]
    v_pk_add_f32 v[66:67], v[66:67], s[84:85] op_sel:[0,0] op_sel_hi:[1,0] neg_lo:[0,1] neg_hi:[0,1]
    v_pk_add_f32 v[68:69], v[68:69], s[84:85] op_sel:[0,0] op_sel_hi:[1,0] neg_lo:[0,1] neg_hi:[0,1]
    v_pk_add_f32 v[70:71], v[70:71], s[84:85] op_sel:[0,0] op_sel_hi:[1,0] neg_lo:[0,1] neg_hi:[0,1]
    v_pk_add_f32 v[72:73], v[72:73], s[84:85] op_sel:[0,0] op_sel_hi:[1,0] neg_lo:[0,1] neg_hi:[0,1]
    v_pk_add_f32 v[74:75], v[74:75], s[84:85] op_sel:[0,0] op_sel_hi:[1,0] neg_lo:[0,1] neg_hi:[0,1]
    v_pk_add_f32 v[76:77], v[76:77], s[84:85] op_sel:[0,0] op_sel_hi:[1,0] neg_lo:[0,1] neg_hi:[0,1]
    v_pk_add_f32 v[78:79], v[78:79], s[84:85] op_sel:[0,0] op_sel_hi:[1,0] neg_lo:[0,1] neg_hi:[0,1]
    v_cvt_pk_bf16_f32 v64, 0, v64
    v_cvt_pk_bf16_f32 v65, 0, v65
    v_cvt_pk_bf16_f32 v66, 0, v66
    v_cvt_pk_bf16_f32 v67, 0, v67
    v_cvt_pk_bf16_f32 v68, 0, v68
    v_cvt_pk_bf16_f32 v69, 0, v69
    v_cvt_pk_bf16_f32 v70, 0, v70
    v_cvt_pk_bf16_f32 v71, 0, v71
    v_cvt_pk_bf16_f32 v72, 0, v72
    v_cvt_pk_bf16_f32 v73, 0, v73
    v_cvt_pk_bf16_f32 v74, 0, v74
    v_cvt_pk_bf16_f32 v75, 0, v75
    v_cvt_pk_bf16_f32 v76, 0, v76
    v_cvt_pk_bf16_f32 v77, 0, v77
    v_cvt_pk_bf16_f32 v78, 0, v78
    v_cvt_pk_bf16_f32 v79, 0, v79
    v_pk_mul_f32 v[64:65], v[64:65], s[84:85] op_sel:[0,1] op_sel_hi:[1,1]
    v_pk_mul_f32 v[66:67], v[66:67], s[84:85] op_sel:[0,1] op_sel_hi:[1,1]
    v_pk_mul_f32 v[68:69], v[68:69], s[84:85] op_sel:[0,1] op_sel_hi:[1,1]
    v_pk_mul_f32 v[70:71], v[70:71], s[84:85] op_sel:[0,1] op_sel_hi:[1,1]
    v_pk_mul_f32 v[72:73], v[72:73], s[84:85] op_sel:[0,1] op_sel_hi:[1,1]
    v_pk_mul_f32 v[74:75], v[74:75], s[84:85] op_sel:[0,1] op_sel_hi:[1,1]
    v_pk_mul_f32 v[76:77], v[76:77], s[84:85] op_sel:[0,1] op_sel_hi:[1,1]
    v_pk_mul_f32 v[78:79], v[78:79], s[84:85] op_sel:[0,1] op_sel_hi:[1,1]
    v_xor_b32 v4, 0, v6
    v_add_u32 v5, 8192, v4
    v_cvt_pk_bf16_f32 v8, v64, v65
    v_cvt_pk_bf16_f32 v9, v66, v67
    v_cvt_pk_bf16_f32 v10, v68, v69
    v_cvt_pk_bf16_f32 v11, v70, v71
    v_cvt_pk_bf16_f32 v12, v72, v73
    v_cvt_pk_bf16_f32 v13, v74, v75
    v_cvt_pk_bf16_f32 v14, v76, v77
    v_cvt_pk_bf16_f32 v15, v78, v79
    ds_write2_b64 v4, v[8:9], v[10:11] offset1:16
    ds_write2_b64 v5, v[12:13], v[14:15] offset1:16
    v_pk_add_f32 v[80:81], v[80:81], s[86:87] op_sel:[0,0] op_sel_hi:[1,0] neg_lo:[0,1] neg_hi:[0,1]
    v_pk_add_f32 v[82:83], v[82:83], s[86:87] op_sel:[0,0] op_sel_hi:[1,0] neg_lo:[0,1] neg_hi:[0,1]
    v_pk_add_f32 v[84:85], v[84:85], s[86:87] op_sel:[0,0] op_sel_hi:[1,0] neg_lo:[0,1] neg_hi:[0,1]
    v_pk_add_f32 v[86:87], v[86:87], s[86:87] op_sel:[0,0] op_sel_hi:[1,0] neg_lo:[0,1] neg_hi:[0,1]
    v_pk_add_f32 v[88:89], v[88:89], s[86:87] op_sel:[0,0] op_sel_hi:[1,0] neg_lo:[0,1] neg_hi:[0,1]
    v_pk_add_f32 v[90:91], v[90:91], s[86:87] op_sel:[0,0] op_sel_hi:[1,0] neg_lo:[0,1] neg_hi:[0,1]
    v_pk_add_f32 v[92:93], v[92:93], s[86:87] op_sel:[0,0] op_sel_hi:[1,0] neg_lo:[0,1] neg_hi:[0,1]
    v_pk_add_f32 v[94:95], v[94:95], s[86:87] op_sel:[0,0] op_sel_hi:[1,0] neg_lo:[0,1] neg_hi:[0,1]
    v_cvt_pk_bf16_f32 v80, 0, v80
    v_cvt_pk_bf16_f32 v81, 0, v81
    v_cvt_pk_bf16_f32 v82, 0, v82
    v_cvt_pk_bf16_f32 v83, 0, v83
    v_cvt_pk_bf16_f32 v84, 0, v84
    v_cvt_pk_bf16_f32 v85, 0, v85
    v_cvt_pk_bf16_f32 v86, 0, v86
    v_cvt_pk_bf16_f32 v87, 0, v87
    v_cvt_pk_bf16_f32 v88, 0, v88
    v_cvt_pk_bf16_f32 v89, 0, v89
    v_cvt_pk_bf16_f32 v90, 0, v90
    v_cvt_pk_bf16_f32 v91, 0, v91
    v_cvt_pk_bf16_f32 v92, 0, v92
    v_cvt_pk_bf16_f32 v93, 0, v93
    v_cvt_pk_bf16_f32 v94, 0, v94
    v_cvt_pk_bf16_f32 v95, 0, v95
    v_pk_mul_f32 v[80:81], v[80:81], s[86:87] op_sel:[0,1] op_sel_hi:[1,1]
    v_pk_mul_f32 v[82:83], v[82:83], s[86:87] op_sel:[0,1] op_sel_hi:[1,1]
    v_pk_mul_f32 v[84:85], v[84:85], s[86:87] op_sel:[0,1] op_sel_hi:[1,1]
    v_pk_mul_f32 v[86:87], v[86:87], s[86:87] op_sel:[0,1] op_sel_hi:[1,1]
    v_pk_mul_f32 v[88:89], v[88:89], s[86:87] op_sel:[0,1] op_sel_hi:[1,1]
    v_pk_mul_f32 v[90:91], v[90:91], s[86:87] op_sel:[0,1] op_sel_hi:[1,1]
    v_pk_mul_f32 v[92:93], v[92:93], s[86:87] op_sel:[0,1] op_sel_hi:[1,1]
    v_pk_mul_f32 v[94:95], v[94:95], s[86:87] op_sel:[0,1] op_sel_hi:[1,1]
    v_xor_b32 v4, 16, v6
    v_add_u32 v5, 8192, v4
    v_cvt_pk_bf16_f32 v16, v80, v81
    v_cvt_pk_bf16_f32 v17, v82, v83
    v_cvt_pk_bf16_f32 v18, v84, v85
    v_cvt_pk_bf16_f32 v19, v86, v87
    v_cvt_pk_bf16_f32 v20, v88, v89
    v_cvt_pk_bf16_f32 v21, v90, v91
    v_cvt_pk_bf16_f32 v22, v92, v93
    v_cvt_pk_bf16_f32 v23, v94, v95
    ds_write2_b64 v4, v[16:17], v[18:19] offset1:16
    ds_write2_b64 v5, v[20:21], v[22:23] offset1:16
    v_xor_b32 v41, 64, v7
    v_lshlrev_b32 v6, 2, v0
    v_mov_b64 v[4:5], -1
    s_waitcnt lgkmcnt(0)
    s_barrier
    ds_read_b128 v[192:195], v7 offset:0
    ds_read_b128 v[196:199], v41 offset:1024
    ds_read_b128 v[200:203], v7 offset:2048
    ds_read_b128 v[204:207], v41 offset:3072
    buffer_store_dword v4, v6, s[44:47], s91 offen sc1
    s_waitcnt lgkmcnt(3)
    buffer_store_dwordx4 v[192:195], v61, s[28:31], s90 offen sc1
    s_add_u32 s90, s90, 8192
    s_waitcnt lgkmcnt(2)
    buffer_store_dwordx4 v[196:199], v61, s[28:31], s90 offen sc1
    s_add_u32 s90, s90, 8192
    s_waitcnt lgkmcnt(1)
    buffer_store_dwordx4 v[200:203], v61, s[28:31], s90 offen sc1
    s_add_u32 s90, s90, 8192
    s_waitcnt lgkmcnt(0)
    buffer_store_dwordx4 v[204:207], v61, s[28:31], s90 offen sc1
L_noln_5:
    v_lshlrev_b32 v253, 5, v1
    v_add_u32 v253, v253, v2
    v_lshlrev_b32 v253, 7, v253
    s_mov_b32 s38, 0
    s_mov_b32 s17, 0
    s_cmp_lg_u32 s76, 3
    s_cbranch_scc1 L_touch_c_8
    s_cmp_lt_u32 s3, 2
    s_cselect_b64 s[36:37], s[6:7], s[12:13]
    s_cselect_b32 s87, 6, 7
    s_lshl_b32 s38, s87, 20
    s_mul_i32 s86, s87, 262144
    s_and_b32 s87, s2, 31
    s_lshl_b32 s88, s87, 1
    s_and_b32 s89, s3, 1
    s_add_u32 s88, s88, s89
    s_lshr_b32 s17, s88, 3
    s_lshl_b32 s17, s17, 7
    s_and_b32 s89, s88, 7
    s_add_u32 s17, s17, s89
    s_lshl_b32 s17, s17, 9
    s_add_u32 s17, s17, s86
    s_branch L_touch_done_9
L_touch_c_8:
    s_cmp_lt_u32 s76, 6
    s_cbranch_scc1 L_touch_done_9
    s_cmp_lg_u32 s75, 3
    s_cbranch_scc1 L_touch_done_9
    s_mov_b64 s[36:37], s[8:9]
    s_mov_b32 s38, 0x200000
    s_bfe_u32 s88, s2, 0x30003
    s_lshl_b32 s88, s88, 1
    s_and_b32 s87, s2, 1
    s_add_u32 s88, s88, s87
    s_lshl_b32 s88, s88, 2
    s_add_u32 s88, s88, s3
    s_lshr_b32 s17, s88, 3
    s_lshl_b32 s17, s17, 7
    s_and_b32 s89, s88, 7
    s_add_u32 s17, s17, s89
    s_lshl_b32 s17, s17, 9
L_touch_done_9:
    v_and_b32 v8, 15, v0
    v_lshrrev_b32 v4, 3, v0
    v_lshrrev_b32 v5, 4, v0
    v_and_b32 v6, 7, v0
    v_xor_b32 v7, v6, v5
    s_lshl_b32 s86, s96, 19
    s_lshl_b32 s87, s3, 17
    s_add_u32 s86, s86, s87
    v_lshl_add_u32 v9, v4, 13, s86
    v_xor_b32 v10, 0, v7
    v_lshl_add_u32 v10, v10, 4, v9
    v_add_u32 v10, 0, v10
    v_accvgpr_write_b32 a248, v10
    v_xor_b32 v10, 4, v7
    v_lshl_add_u32 v10, v10, 4, v9
    v_add_u32 v10, 64512, v10
    v_accvgpr_write_b32 a249, v10
    v_xor_b32 v10, 0, v7
    v_lshl_add_u32 v10, v10, 4, v9
    v_add_u32 v10, 2048, v10
    v_accvgpr_write_b32 a250, v10
    v_xor_b32 v10, 4, v7
    v_lshl_add_u32 v10, v10, 4, v9
    v_add_u32 v10, 66560, v10
    v_accvgpr_write_b32 a251, v10
    s_and_b32 s86, s2, 1
    s_lshl_b32 s86, s86, 3
    s_bfe_u32 s87, s2, 0x30003
    s_add_u32 s86, s86, s87
    s_lshl_b32 s86, s86, 7
    v_lshlrev_b32 v10, 1, v5
    v_xor_b32 v10, v6, v10
    v_lshl_add_u32 v11, v4, 11, s86
    v_lshl_add_u32 v226, v10, 4, v11
    v_bfe_u32 v10, v0, 1, 3
    v_xor_b32 v10, v5, v10
    v_lshlrev_b32 v11, 7, v8
    v_add_u32 v11, 65536, v11
    v_xor_b32 v12, 0, v10
    v_lshl_add_u32 v12, v12, 4, v11
    v_accvgpr_write_b32 a252, v12
    v_xor_b32 v12, 4, v10
    v_lshl_add_u32 v12, v12, 4, v11
    v_accvgpr_write_b32 a253, v12
    s_lshr_b32 s86, s97, 2
    s_lshl_b32 s86, s86, 10
    s_add_u32 s86, s86, 294912
    v_lshl_add_u32 v10, v6, 7, s86
    v_accvgpr_write_b32 a254, v10
    s_and_b32 s86, s2, 0
    s_xor_b32 s86, s86, 3
    s_lshl_b32 s98, s86, 7
    s_lshl_b32 s86, s86, 12
    s_lshl_b32 s99, s3, 12
    s_add_u32 s99, s99, 65536
    s_lshl_b32 s16, s97, 17
    s_add_u32 s16, s16, 0x1800000
    s_add_u32 s16, s16, s86
    s_cmp_eq_u32 s3, 0
    s_cselect_b32 s50, s50, s51
    s_mul_i32 s6, s48, 229376
    s_lshl_b32 s86, s60, 11
    s_add_u32 s6, s6, s86
    s_add_u32 s6, s6, 0x1000000
    s_and_b32 s10, s3, 1
    s_lshl_b32 s10, s10, 13
    s_cmp_ge_u32 s2, 128
    s_cbranch_scc1 L_prep_z_10
    s_add_u32 s7, s6, 114688
    s_mul_i32 s12, s48, 360448
    s_lshl_b32 s86, s49, 12
    s_add_u32 s12, s12, s86
    s_add_u32 s12, s12, 0x400800
    s_add_u32 s13, s12, 180224
    s_and_b32 s88, s2, 31
    s_lshl_b32 s88, s88, 2
    s_add_u32 s88, s88, s3
    s_lshl_b32 s54, s88, 16
    s_add_u32 s54, s54, 0
    s_mov_b32 s71, 524288
    s_bfe_u32 s86, s88, 0x10003
    s_bfe_u32 s87, s88, 0x10006
    s_xor_b32 s86, s86, s87
    s_mul_i32 s86, s86, 72
    s_xor_b32 s88, s88, s86
    s_xor_b32 s88, s88, 64
    s_lshr_b32 s60, s88, 3
    s_lshl_b32 s60, s60, 7
    s_and_b32 s89, s88, 7
    s_add_u32 s60, s60, s89
    s_lshl_b32 s60, s60, 9
    s_cmp_eq_u32 s62, 0
    s_cselect_b32 s23, 0x380000, 0
    s_cselect_b32 s22, 0x800000, 0
    s_mov_b32 s72, 0xff000ff
    s_mov_b32 s73, 0xf00fff00
    s_mov_b32 s74, 0x1fe001fe
    s_mov_b32 s75, 0xe01ffe01
    s_mov_b32 s76, 0x3fc003fc
    s_mov_b32 s77, 0xc03ffc03
    s_mov_b32 s78, 0x7f8007f8
    s_mov_b32 s79, 0x807ff807
    s_cmp_eq_u32 s3, 0
    s_cselect_b32 s80, 0xfff00ff, s72
    s_cselect_b32 s81, 0xf000ff00, s73
    s_cselect_b32 s82, 0x1fff01ff, s74
    s_cselect_b32 s83, 0xe000fe00, s75
    s_cselect_b32 s84, 0x3fff03ff, s76
    s_cselect_b32 s85, 0xc000fc00, s77
    s_cselect_b32 s86, 0x7fff07ff, s78
    s_cselect_b32 s87, 0x8000f800, s79
    s_cmp_eq_u32 s48, 0
    s_cselect_b32 s80, 0xff000ff, s80
    s_cselect_b32 s88, 0xff000ff, s72
    s_cselect_b32 s81, 0xf000ff00, s81
    s_cselect_b32 s89, 0xf000ff00, s73
    s_cselect_b32 s82, 0x1fe001fe, s82
    s_cselect_b32 s90, 0x1fe001fe, s74
    s_cselect_b32 s83, 0xe000fe00, s83
    s_cselect_b32 s91, 0xe000fe00, s75
    s_cselect_b32 s84, 0x3fc003fc, s84
    s_cselect_b32 s92, 0x3fc003fc, s76
    s_cselect_b32 s85, 0xc000fc00, s85
    s_cselect_b32 s93, 0xc000fc00, s77
    s_cselect_b32 s86, 0x7f8007f8, s86
    s_cselect_b32 s94, 0x7f8007f8, s78
    s_cselect_b32 s87, 0x8000f800, s87
    s_cselect_b32 s95, 0x8000f800, s79
    s_add_u32 s11, s10, L_epi_q-L_code
    s_branch L_prep_done_11
L_prep_z_10:
    s_add_u32 s11, s10, L_epi_B-L_code
    s_add_u32 s86, s10, L_epi_C-L_code
    s_add_u32 s87, s6, 8192
    s_cmp_ge_u32 s49, 14
    s_cselect_b32 s11, s86, s11
    s_cselect_b32 s6, s87, s6
    s_add_u32 s7, s6, 114688
    s_add_u32 s12, s6, 2048
    s_add_u32 s13, s7, 2048
    s_lshl_b32 s80, s48, 13
    s_add_u32 s81, s80, 4096
    s_lshl_b32 s82, s49, 9
    s_add_u32 s82, s82, s80
    s_lshl_b32 s86, s48, 12
    s_lshl_b32 s83, s49, 19
    s_add_u32 s83, s83, s86
    s_add_u32 s83, s83, 0x1800000
    s_lshl_b32 s84, s49, 10
    s_lshl_b32 s86, s73, 7
    s_add_u32 s84, s84, s86
    s_add_u32 s84, s84, 294912
L_prep_done_11:
    s_add_u32 s10, s10, L_k23-L_code
    s_cmp_lt_u32 s3, 2
    s_cselect_b32 s10, s11, s10
    v_lshl_add_u32 v10, v0, 7, s10
    s_getpc_b64 s[0:1]
L_pc_12:
    s_sub_u32 s0, s0, L_pc_12-L_code
    s_subb_u32 s1, s1, 0
    v_min_u32 v10, L_exit-L_code, v10
    v_mov_b32 v11, s1
    v_add_co_u32 v10, vcc, s0, v10
    s_nop 1
    v_addc_co_u32 v11, vcc, 0, v11, vcc
    v_accvgpr_write_b32 a242, v10
    v_accvgpr_write_b32 a243, v11
    s_xor_b32 s11, s2, 128
    s_lshr_b32 s11, s11, 5
    s_add_u32 s11, s11, 1
    s_sub_u32 s10, s11, 5
    s_cmp_lt_u32 s10, 2
    s_cselect_b32 s10, 3, 0
    s_xor_b32 s11, s11, s10
    s_cmp_lt_u32 s11, 8
    s_cselect_b32 s11, s11, 0x4000
    s_lshl_b32 s11, s11, 9
    s_and_b32 s10, s2, 31
    s_lshl_b32 s10, s10, 2
    s_add_u32 s10, s10, s3
    s_lshl_b32 s10, s10, 16
    s_add_u32 s11, s11, s10
    s_lshl2_add_u32 s0, s2, s3
    s_lshr_b32 s1, s0, 3
    s_lshl_b32 s1, s1, 7
    s_and_b32 s0, s0, 7
    s_add_u32 s0, s0, s1
    s_lshl_b32 s0, s0, 9
    s_cmp_lt_u32 s2, 32
    s_cselect_b32 s1, 20, 17
    s_lshl_b32 s1, s1, 18
    s_add_u32 s0, s0, s1
    s_add_u32 s10, s0, 4096
    s_bfe_u32 s0, s2, 0x20001
    s_lshl_b32 s0, s0, 5
    s_add_u32 s48, s48, s0
    s_sub_u32 s0, s97, 43
    s_lshl_b32 s0, s0, 3
    s_lshl1_add_u32 s0, s96, s0
    s_and_b32 s1, s2, 0xfe
    s_sub_u32 s1, s1, 1024
    s_cmp_ge_u32 s97, 43
    s_cselect_b32 s0, s0, s1
    s_cmp_eq_u32 s3, 3
    s_cselect_b32 s0, s0, s1
    s_cmp_eq_u32 s62, 0
    s_cselect_b32 s0, s48, s0
    s_lshl_b32 s0, s0, 7
    s_add_u32 s48, s0, 393216
    v_accvgpr_write_b32 a232, 0
    v_accvgpr_write_b32 a233, 0
    v_accvgpr_write_b32 a234, 0
    v_accvgpr_write_b32 a235, 0
    v_accvgpr_write_b32 a236, 0
    v_accvgpr_write_b32 a237, 0
    v_accvgpr_write_b32 a238, 0
    v_accvgpr_write_b32 a239, 0
    v_mov_b64 v[0:1], 0
    v_mov_b64 v[2:3], 0
    v_mov_b64 v[4:5], 0
    v_mov_b64 v[6:7], 0
    v_mov_b64 v[8:9], 0
    v_mov_b64 v[10:11], 0
    v_mov_b64 v[12:13], 0
    v_mov_b64 v[14:15], 0
    v_mov_b64 v[16:17], 0
    v_mov_b64 v[18:19], 0
    v_mov_b64 v[20:21], 0
    v_mov_b64 v[22:23], 0
    v_mov_b64 v[24:25], 0
    v_mov_b64 v[26:27], 0
    v_mov_b64 v[28:29], 0
    v_mov_b64 v[30:31], 0
    v_mov_b64 v[32:33], 0
    v_mov_b64 v[34:35], 0
    v_mov_b64 v[36:37], 0
    v_mov_b64 v[38:39], 0
    v_mov_b64 v[40:41], 0
    v_mov_b64 v[42:43], 0
    v_mov_b64 v[44:45], 0
    v_mov_b64 v[46:47], 0
    v_mov_b64 v[48:49], 0
    v_mov_b64 v[50:51], 0
    v_mov_b64 v[52:53], 0
    v_mov_b64 v[54:55], 0
    v_mov_b64 v[56:57], 0
    v_mov_b64 v[58:59], 0
    v_mov_b64 v[60:61], 0
    v_mov_b64 v[62:63], 0
    v_mov_b64 v[64:65], 0
    v_mov_b64 v[66:67], 0
    v_mov_b64 v[68:69], 0
    v_mov_b64 v[70:71], 0
    v_mov_b64 v[72:73], 0
    v_mov_b64 v[74:75], 0
    v_mov_b64 v[76:77], 0
    v_mov_b64 v[78:79], 0
    v_mov_b64 v[80:81], 0
    v_mov_b64 v[82:83], 0
    v_mov_b64 v[84:85], 0
    v_mov_b64 v[86:87], 0
    v_mov_b64 v[88:89], 0
    v_mov_b64 v[90:91], 0
    v_mov_b64 v[92:93], 0
    v_mov_b64 v[94:95], 0
    v_mov_b64 v[96:97], 0
    v_mov_b64 v[98:99], 0
    v_mov_b64 v[100:101], 0
    v_mov_b64 v[102:103], 0
    v_mov_b64 v[104:105], 0
    v_mov_b64 v[106:107], 0
    v_mov_b64 v[108:109], 0
    v_mov_b64 v[110:111], 0
    v_mov_b64 v[112:113], 0
    v_mov_b64 v[114:115], 0
    v_mov_b64 v[116:117], 0
    v_mov_b64 v[118:119], 0
    v_mov_b64 v[120:121], 0
    v_mov_b64 v[122:123], 0
    v_mov_b64 v[124:125], 0
    v_mov_b64 v[126:127], 0
    v_mov_b64 v[128:129], 0
    v_mov_b64 v[130:131], 0
    v_mov_b64 v[132:133], 0
    v_mov_b64 v[134:135], 0
    v_mov_b64 v[136:137], 0
    v_mov_b64 v[138:139], 0
    v_mov_b64 v[140:141], 0
    v_mov_b64 v[142:143], 0
    v_mov_b64 v[144:145], 0
    v_mov_b64 v[146:147], 0
    v_mov_b64 v[148:149], 0
    v_mov_b64 v[150:151], 0
    v_mov_b64 v[152:153], 0
    v_mov_b64 v[154:155], 0
    v_mov_b64 v[156:157], 0
    v_mov_b64 v[158:159], 0
    v_mov_b64 v[160:161], 0
    v_mov_b64 v[162:163], 0
    v_mov_b64 v[164:165], 0
    v_mov_b64 v[166:167], 0
    v_mov_b64 v[168:169], 0
    v_mov_b64 v[170:171], 0
    v_mov_b64 v[172:173], 0
    v_mov_b64 v[174:175], 0
    v_mov_b64 v[176:177], 0
    v_mov_b64 v[178:179], 0
    v_mov_b64 v[180:181], 0
    v_mov_b64 v[182:183], 0
    v_mov_b64 v[184:185], 0
    v_mov_b64 v[186:187], 0
    v_mov_b64 v[188:189], 0
    v_mov_b64 v[190:191], 0
    s_waitcnt vmcnt(0)
    s_barrier
    v_readfirstlane_b32 s27, v250
    s_mul_i32 s26, s27, 0x9e3779b1
    s_add_u32 s26, s26, 0x7f4a7c15
    s_cmp_lg_u32 s3, 0
    s_cbranch_scc1 L_noflag_13
    v_mbcnt_lo_u32_b32 v192, -1, 0
    v_mov_b32 v251, s26
    v_lshlrev_b32 v192, 2, v192
    s_mov_b32 exec_hi, 0
    buffer_store_dword v251, v192, s[44:47], s63 offen sc1
    s_mov_b64 exec, -1
L_noflag_13:
L_noln_7:
    s_cmp_ge_u32 s2, 128
    s_cbranch_scc1 L_prez_14
    s_add_u32 m0, s55, 114688
    s_nop 0
    buffer_load_dwordx4 v227, s[32:35], s64 offen offset:0 lds
    s_add_u32 s64, s64, s59
    buffer_load_dwordx4 v227, s[32:35], s65 offen offset:1024 lds
    s_add_u32 s65, s65, s59
    buffer_load_dwordx4 v227, s[32:35], s66 offen offset:2048 lds
    s_add_u32 s66, s66, s59
    buffer_load_dwordx4 v227, s[32:35], s67 offen offset:3072 lds
    s_add_u32 s67, s67, s59
    s_add_u32 m0, s55, 118784
    s_nop 0
    buffer_load_dwordx4 v227, s[32:35], s68 offen offset:0 lds
    s_add_u32 s68, s68, s59
    buffer_load_dwordx4 v227, s[32:35], s69 offen offset:1024 lds
    s_add_u32 s69, s69, s59
    buffer_load_dwordx4 v228, s[40:43], s70 offen offset:2048 lds
    s_add_u32 s70, s70, s61
    s_add_u32 m0, s55, 0
    s_nop 0
    buffer_load_dwordx4 v227, s[32:35], s64 offen offset:0 lds
    s_add_u32 s64, s64, s59
    buffer_load_dwordx4 v227, s[32:35], s65 offen offset:1024 lds
    s_add_u32 s65, s65, s59
    buffer_load_dwordx4 v227, s[32:35], s66 offen offset:2048 lds
    s_add_u32 s66, s66, s59
    buffer_load_dwordx4 v227, s[32:35], s67 offen offset:3072 lds
    s_add_u32 s67, s67, s59
    s_add_u32 m0, s55, 4096
    s_nop 0
    buffer_load_dwordx4 v227, s[32:35], s68 offen offset:0 lds
    s_add_u32 s68, s68, s59
    buffer_load_dwordx4 v227, s[32:35], s69 offen offset:1024 lds
    s_add_u32 s69, s69, s59
    buffer_load_dwordx4 v228, s[40:43], s70 offen offset:2048 lds
    s_add_u32 s70, s70, s61
    s_branch L_prej_15
L_prez_14:
    s_add_u32 m0, s55, 98304
    s_nop 0
    buffer_load_dwordx4 v227, s[32:35], s64 offen offset:0 lds
    s_add_u32 s64, s64, s59
    buffer_load_dwordx4 v227, s[32:35], s65 offen offset:1024 lds
    s_add_u32 s65, s65, s59
    buffer_load_dwordx4 v227, s[32:35], s66 offen offset:2048 lds
    s_add_u32 s66, s66, s59
    buffer_load_dwordx4 v227, s[32:35], s67 offen offset:3072 lds
    s_add_u32 s67, s67, s59
    s_add_u32 m0, s55, 102400
    s_nop 0
    buffer_load_dwordx4 v227, s[32:35], s68 offen offset:0 lds
    s_add_u32 s68, s68, s59
    buffer_load_dwordx4 v227, s[32:35], s69 offen offset:1024 lds
    s_add_u32 s69, s69, s59
    s_add_u32 m0, s55, 0
    s_nop 0
    buffer_load_dwordx4 v227, s[32:35], s64 offen offset:0 lds
    s_add_u32 s64, s64, s59
    buffer_load_dwordx4 v227, s[32:35], s65 offen offset:1024 lds
    s_add_u32 s65, s65, s59
    buffer_load_dwordx4 v227, s[32:35], s66 offen offset:2048 lds
    s_add_u32 s66, s66, s59
    buffer_load_dwordx4 v227, s[32:35], s67 offen offset:3072 lds
    s_add_u32 s67, s67, s59
    s_add_u32 m0, s55, 4096
    s_nop 0
    buffer_load_dwordx4 v227, s[32:35], s68 offen offset:0 lds
    s_add_u32 s68, s68, s59
    buffer_load_dwordx4 v227, s[32:35], s69 offen offset:1024 lds
    s_add_u32 s69, s69, s59
L_prej_15:
    buffer_load_dword a240, v253, s[36:39], s17 offen
    s_add_u32 s17, s17, 524288
    buffer_load_dword a240, v253, s[36:39], s17 offen
    s_add_u32 s17, s17, 524288
    s_cmp_lg_u32 s62, 0
    s_cbranch_scc1 L_touch_done_16
    buffer_load_dword a240, v253, s[36:39], s17 offen
    s_add_u32 s17, s17, 524288
    buffer_load_dword a240, v253, s[36:39], s17 offen
    s_add_u32 s17, s17, 524288
L_touch_done_16:
    v_mov_b64 v[192:193], 0
    v_mov_b64 v[194:195], 0
    v_mov_b64 v[196:197], 0
    v_mov_b64 v[198:199], 0
    v_mov_b64 v[200:201], 0
    v_mov_b64 v[202:203], 0
    v_mov_b64 v[204:205], 0
    v_mov_b64 v[206:207], 0
    v_mov_b64 v[208:209], 0
    v_mov_b64 v[210:211], 0
    v_mov_b64 v[212:213], 0
    v_mov_b64 v[214:215], 0
    v_mov_b64 v[216:217], 0
    v_mov_b64 v[218:219], 0
    v_mov_b64 v[220:221], 0
    v_mov_b64 v[222:223], 0
    s_cmp_eq_u32 s3, 0
    s_cbranch_scc1 L_vret
    s_cmp_ge_u32 s2, 128
    s_cbranch_scc1 L_vz
    s_cmp_eq_u32 s3, 1
    s_cbranch_scc1 L_pg_q_0
    s_cmp_eq_u32 s3, 2
    s_cbranch_scc1 L_pg_q_1
    s_branch L_pg_q_2
L_vz:
    s_cmp_ge_u32 s49, 14
    s_cbranch_scc1 L_vc
    s_cmp_eq_u32 s3, 1
    s_cbranch_scc1 L_pg_B_0
    s_cmp_eq_u32 s3, 2
    s_cbranch_scc1 L_pg_B_1
    s_branch L_pg_B_2
L_vc:
    s_cmp_eq_u32 s3, 1
    s_cbranch_scc1 L_pg_C_0
    s_cmp_eq_u32 s3, 2
    s_cbranch_scc1 L_pg_C_1
    s_branch L_pg_C_2
L_vret:
    s_waitcnt vmcnt(12)
    v_readfirstlane_b32 s27, v250
    s_mul_i32 s26, s27, 0x9e3779b1
    s_add_u32 s26, s26, 0x7f4a7c15
    s_cmp_lg_u32 s3, 0
    s_cbranch_scc1 L_nopoll_17
    s_mov_b32 s63, 0
L_poll_18:
    buffer_load_dword v251, v252, s[44:47], 0 offen sc1
    s_waitcnt vmcnt(0)
    v_cmp_ne_u32 vcc, s26, v251
    s_add_u32 s63, s63, 1
    s_cmp_eq_u64 vcc, 0
    s_cbranch_scc1 L_polled_19
    s_sleep 2
    s_cmp_lt_u32 s63, 200000
    s_cbranch_scc1 L_poll_18
    s_endpgm
L_polled_19:
L_nopoll_17:
    v_mov_b32 v250, v224
    v_mov_b32 v251, v224
    v_mov_b32 v252, v224
    s_barrier
    s_cmp_ge_u32 s2, 128
    s_cbranch_scc1 L_zB_20
    s_branch L_po_q_0
.p2align 12
L_pg_q_0:
    s_branch L_pg_q_3
L_po_q_0:
    buffer_load_dwordx4 a[192:195], v224, s[28:31], s52 offen offset:0 sc1
    buffer_load_dwordx4 a[196:199], v250, s[28:31], s52 offen offset:1024 sc1
    buffer_load_dwordx4 a[200:203], v251, s[28:31], s52 offen offset:2048 sc1
    buffer_load_dwordx4 a[204:207], v252, s[28:31], s52 offen offset:3072 sc1
    buffer_load_dwordx4 a[208:211], v225, s[28:31], s52 offen sc1
    buffer_load_dwordx4 a[212:215], v224, s[28:31], s53 offen offset:0 sc1
    buffer_load_dwordx4 a[216:219], v250, s[28:31], s53 offen offset:1024 sc1
    buffer_load_dwordx4 a[220:223], v251, s[28:31], s53 offen offset:2048 sc1
    buffer_load_dwordx4 a[224:227], v252, s[28:31], s53 offen offset:3072 sc1
    buffer_load_dwordx4 a[228:231], v225, s[28:31], s53 offen sc1
    s_waitcnt vmcnt(5)
    s_barrier
    ds_read_b64_tr_b16 a[0:1], v241 offset:0
    ds_read_b64_tr_b16 a[2:3], v241 offset:7168
    ds_read_b64_tr_b16 a[4:5], v242 offset:0
    ds_read_b64_tr_b16 a[6:7], v242 offset:7168
    ds_read_b64_tr_b16 a[8:9], v243 offset:0
    ds_read_b64_tr_b16 a[10:11], v243 offset:7168
    ds_read_b64_tr_b16 a[12:13], v244 offset:0
    ds_read_b64_tr_b16 a[14:15], v244 offset:7168
    ds_read_b64_tr_b16 a[16:17], v241 offset:2048
    ds_read_b64_tr_b16 a[18:19], v241 offset:9216
    s_mov_b32 s57, 4
    s_waitcnt lgkmcnt(6)
    v_mfma_f32_16x16x32_bf16 v[0:3], a[0:3], a[192:195], v[0:3]
    ds_read_b64_tr_b16 a[20:21], v249 offset:2048
    s_add_u32 s52, s52, s58
    s_add_u32 s53, s53, s58
    v_mfma_f32_16x16x32_bf16 v[4:7], a[0:3], a[196:199], v[4:7]
    buffer_load_dwordx4 a[32:35], v224, s[28:31], s52 offen offset:0 sc1
    v_mfma_f32_16x16x32_bf16 v[8:11], a[0:3], a[200:203], v[8:11]
    ds_read_b64_tr_b16 a[22:23], v249 offset:9216
    v_mfma_f32_16x16x32_bf16 v[12:15], a[0:3], a[204:207], v[12:15]
    v_mfma_f32_16x16x32_bf16 v[28:31], a[4:7], a[204:207], v[28:31]
    ds_read_b64_tr_b16 a[24:25], v242 offset:2048
    v_mfma_f32_16x16x32_bf16 v[24:27], a[4:7], a[200:203], v[24:27]
    buffer_load_dwordx4 a[36:39], v250, s[28:31], s52 offen offset:1024 sc1
    v_mfma_f32_16x16x32_bf16 v[20:23], a[4:7], a[196:199], v[20:23]
    ds_read_b64_tr_b16 a[26:27], v242 offset:9216
    v_mfma_f32_16x16x32_bf16 v[16:19], a[4:7], a[192:195], v[16:19]
    s_waitcnt lgkmcnt(6)
    v_mfma_f32_16x16x32_bf16 v[32:35], a[8:11], a[192:195], v[32:35]
    ds_read_b64_tr_b16 a[28:29], v243 offset:2048
    v_mfma_f32_16x16x32_bf16 v[36:39], a[8:11], a[196:199], v[36:39]
    buffer_load_dwordx4 a[40:43], v251, s[28:31], s52 offen offset:2048 sc1
    v_mfma_f32_16x16x32_bf16 v[40:43], a[8:11], a[200:203], v[40:43]
    ds_read_b64_tr_b16 a[30:31], v243 offset:9216
    v_mfma_f32_16x16x32_bf16 v[44:47], a[8:11], a[204:207], v[44:47]
    v_mfma_f32_16x16x32_bf16 v[60:63], a[12:15], a[204:207], v[60:63]
    ds_read_b64_tr_b16 a[0:1], v244 offset:2048
    v_mfma_f32_16x16x32_bf16 v[56:59], a[12:15], a[200:203], v[56:59]
    buffer_load_dwordx4 a[44:47], v252, s[28:31], s52 offen offset:3072 sc1
    v_mfma_f32_16x16x32_bf16 v[52:55], a[12:15], a[196:199], v[52:55]
    ds_read_b64_tr_b16 a[2:3], v244 offset:9216
    v_mfma_f32_16x16x32_bf16 v[48:51], a[12:15], a[192:195], v[48:51]
    s_waitcnt lgkmcnt(6)
    v_mfma_f32_16x16x32_bf16 v[64:67], a[16:19], a[192:195], v[64:67]
    ds_read_b64_tr_b16 a[4:5], v241 offset:4096
    v_mfma_f32_16x16x32_bf16 v[68:71], a[16:19], a[196:199], v[68:71]
    buffer_load_dwordx4 a[48:51], v225, s[28:31], s52 offen sc1
    v_mfma_f32_16x16x32_bf16 v[72:75], a[16:19], a[200:203], v[72:75]
    ds_read_b64_tr_b16 a[6:7], v241 offset:11264
    v_mfma_f32_16x16x32_bf16 v[76:79], a[16:19], a[204:207], v[76:79]
    v_mfma_f32_16x16x32_bf16 a[232:235], a[20:23], a[208:211], a[232:235]
    ds_read_b64_tr_b16 a[8:9], v242 offset:4096
    s_waitcnt lgkmcnt(5)
    v_mfma_f32_16x16x32_bf16 v[80:83], a[24:27], a[192:195], v[80:83]
    ds_read_b64_tr_b16 a[10:11], v242 offset:11264
    v_mfma_f32_16x16x32_bf16 v[84:87], a[24:27], a[196:199], v[84:87]
    ds_read_b64_tr_b16 a[12:13], v243 offset:4096
    v_mfma_f32_16x16x32_bf16 v[88:91], a[24:27], a[200:203], v[88:91]
    ds_read_b64_tr_b16 a[14:15], v243 offset:11264
    v_mfma_f32_16x16x32_bf16 v[92:95], a[24:27], a[204:207], v[92:95]
    buffer_load_dwordx4 a[52:55], v224, s[28:31], s53 offen offset:0 sc1
    v_mfma_f32_16x16x32_bf16 v[108:111], a[28:31], a[204:207], v[108:111]
    ds_read_b64_tr_b16 a[16:17], v244 offset:4096
    v_mfma_f32_16x16x32_bf16 v[104:107], a[28:31], a[200:203], v[104:107]
    buffer_load_dwordx4 a[56:59], v250, s[28:31], s53 offen offset:1024 sc1
    v_mfma_f32_16x16x32_bf16 v[100:103], a[28:31], a[196:199], v[100:103]
    ds_read_b64_tr_b16 a[18:19], v244 offset:11264
    v_mfma_f32_16x16x32_bf16 v[96:99], a[28:31], a[192:195], v[96:99]
    s_waitcnt lgkmcnt(6)
    v_mfma_f32_16x16x32_bf16 v[112:115], a[0:3], a[192:195], v[112:115]
    ds_read_b64_tr_b16 a[20:21], v249 offset:4096
    v_mfma_f32_16x16x32_bf16 v[116:119], a[0:3], a[196:199], v[116:119]
    buffer_load_dwordx4 a[60:63], v251, s[28:31], s53 offen offset:2048 sc1
    v_mfma_f32_16x16x32_bf16 v[120:123], a[0:3], a[200:203], v[120:123]
    ds_read_b64_tr_b16 a[22:23], v249 offset:11264
    v_mfma_f32_16x16x32_bf16 v[124:127], a[0:3], a[204:207], v[124:127]
    v_mfma_f32_16x16x32_bf16 v[140:143], a[204:207], a[4:7], v[140:143]
    ds_read_b64_tr_b16 a[24:25], v245 offset:6144
    v_mfma_f32_16x16x32_bf16 v[136:139], a[200:203], a[4:7], v[136:139]
    buffer_load_dwordx4 a[64:67], v252, s[28:31], s53 offen offset:3072 sc1
    v_mfma_f32_16x16x32_bf16 v[132:135], a[196:199], a[4:7], v[132:135]
    ds_read_b64_tr_b16 a[26:27], v245 offset:13312
    v_mfma_f32_16x16x32_bf16 v[128:131], a[192:195], a[4:7], v[128:131]
    s_waitcnt lgkmcnt(6)
    v_mfma_f32_16x16x32_bf16 v[144:147], a[192:195], a[8:11], v[144:147]
    ds_read_b64_tr_b16 a[28:29], v246 offset:6144
    v_mfma_f32_16x16x32_bf16 v[148:151], a[196:199], a[8:11], v[148:151]
    ds_read_b64_tr_b16 a[30:31], v246 offset:13312
    v_mfma_f32_16x16x32_bf16 v[152:155], a[200:203], a[8:11], v[152:155]
    v_mfma_f32_16x16x32_bf16 v[156:159], a[204:207], a[8:11], v[156:159]
    v_mfma_f32_16x16x32_bf16 v[172:175], a[204:207], a[12:15], v[172:175]
    ds_read_b64_tr_b16 a[0:1], v241 offset:14336
    v_mfma_f32_16x16x32_bf16 v[168:171], a[200:203], a[12:15], v[168:171]
    buffer_load_dwordx4 a[68:71], v225, s[28:31], s53 offen sc1
    v_mfma_f32_16x16x32_bf16 v[164:167], a[196:199], a[12:15], v[164:167]
    ds_read_b64_tr_b16 a[2:3], v241 offset:21504
    v_mfma_f32_16x16x32_bf16 v[160:163], a[192:195], a[12:15], v[160:163]
    s_waitcnt lgkmcnt(6)
    v_mfma_f32_16x16x32_bf16 v[176:179], a[192:195], a[16:19], v[176:179]
    ds_read_b64_tr_b16 a[4:5], v242 offset:14336
    s_add_u32 m0, s55, 28672
    v_mfma_f32_16x16x32_bf16 v[180:183], a[196:199], a[16:19], v[180:183]
    buffer_load_dwordx4 v227, s[32:35], s64 offen offset:0 lds
    s_add_u32 s64, s64, s59
    v_mfma_f32_16x16x32_bf16 v[184:187], a[200:203], a[16:19], v[184:187]
    ds_read_b64_tr_b16 a[6:7], v242 offset:21504
    v_mfma_f32_16x16x32_bf16 v[188:191], a[204:207], a[16:19], v[188:191]
    v_mfma_f32_16x16x32_bf16 a[236:239], a[208:211], a[20:23], a[236:239]
    ds_read_b64_tr_b16 a[8:9], v243 offset:14336
    s_waitcnt lgkmcnt(5)
    v_mfma_f32_16x16x32_bf16 v[192:195], a[24:27], a[192:195], v[192:195]
    ds_read_b64_tr_b16 a[10:11], v243 offset:21504
    v_mfma_f32_16x16x32_bf16 v[196:199], a[24:27], a[196:199], v[196:199]
    ds_read_b64_tr_b16 a[12:13], v244 offset:14336
    v_mfma_f32_16x16x32_bf16 v[200:203], a[24:27], a[200:203], v[200:203]
    ds_read_b64_tr_b16 a[14:15], v244 offset:21504
    v_mfma_f32_16x16x32_bf16 v[204:207], a[24:27], a[204:207], v[204:207]
    buffer_load_dwordx4 v227, s[32:35], s65 offen offset:1024 lds
    s_add_u32 s65, s65, s59
    v_mfma_f32_16x16x32_bf16 v[220:223], a[28:31], a[204:207], v[220:223]
    ds_read_b64_tr_b16 a[16:17], v241 offset:16384
    v_mfma_f32_16x16x32_bf16 v[216:219], a[28:31], a[200:203], v[216:219]
    buffer_load_dwordx4 v227, s[32:35], s66 offen offset:2048 lds
    s_add_u32 s66, s66, s59
    v_mfma_f32_16x16x32_bf16 v[212:215], a[28:31], a[196:199], v[212:215]
    ds_read_b64_tr_b16 a[18:19], v241 offset:23552
    v_mfma_f32_16x16x32_bf16 v[208:211], a[28:31], a[192:195], v[208:211]
    buffer_load_dwordx4 v227, s[32:35], s67 offen offset:3072 lds
    s_add_u32 s67, s67, s59
    s_waitcnt vmcnt(14) lgkmcnt(6)
    v_mfma_f32_16x16x32_bf16 v[0:3], a[0:3], a[212:215], v[0:3]
    ds_read_b64_tr_b16 a[20:21], v249 offset:16384
    v_mfma_f32_16x16x32_bf16 v[4:7], a[0:3], a[216:219], v[4:7]
    ds_read_b64_tr_b16 a[22:23], v249 offset:23552
    v_mfma_f32_16x16x32_bf16 v[8:11], a[0:3], a[220:223], v[8:11]
    v_mfma_f32_16x16x32_bf16 v[12:15], a[0:3], a[224:227], v[12:15]
    v_mfma_f32_16x16x32_bf16 v[28:31], a[4:7], a[224:227], v[28:31]
    ds_read_b64_tr_b16 a[24:25], v242 offset:16384
    s_add_u32 m0, s55, 32768
    v_mfma_f32_16x16x32_bf16 v[24:27], a[4:7], a[220:223], v[24:27]
    buffer_load_dwordx4 v227, s[32:35], s68 offen offset:0 lds
    s_add_u32 s68, s68, s59
    v_mfma_f32_16x16x32_bf16 v[20:23], a[4:7], a[216:219], v[20:23]
    ds_read_b64_tr_b16 a[26:27], v242 offset:23552
    v_mfma_f32_16x16x32_bf16 v[16:19], a[4:7], a[212:215], v[16:19]
    s_waitcnt lgkmcnt(6)
    v_mfma_f32_16x16x32_bf16 v[32:35], a[8:11], a[212:215], v[32:35]
    ds_read_b64_tr_b16 a[28:29], v243 offset:16384
    v_mfma_f32_16x16x32_bf16 v[36:39], a[8:11], a[216:219], v[36:39]
    buffer_load_dwordx4 v227, s[32:35], s69 offen offset:1024 lds
    s_add_u32 s69, s69, s59
    v_mfma_f32_16x16x32_bf16 v[40:43], a[8:11], a[220:223], v[40:43]
    ds_read_b64_tr_b16 a[30:31], v243 offset:23552
    v_mfma_f32_16x16x32_bf16 v[44:47], a[8:11], a[224:227], v[44:47]
    v_mfma_f32_16x16x32_bf16 v[60:63], a[12:15], a[224:227], v[60:63]
    ds_read_b64_tr_b16 a[0:1], v244 offset:16384
    v_mfma_f32_16x16x32_bf16 v[56:59], a[12:15], a[220:223], v[56:59]
    buffer_load_dwordx4 v228, s[40:43], s70 offen offset:2048 lds
    s_add_u32 s70, s70, s61
    v_mfma_f32_16x16x32_bf16 v[52:55], a[12:15], a[216:219], v[52:55]
    ds_read_b64_tr_b16 a[2:3], v244 offset:23552
    v_mfma_f32_16x16x32_bf16 v[48:51], a[12:15], a[212:215], v[48:51]
    s_waitcnt lgkmcnt(6)
    v_mfma_f32_16x16x32_bf16 v[64:67], a[16:19], a[212:215], v[64:67]
    ds_read_b64_tr_b16 a[4:5], v241 offset:18432
    s_add_u32 s52, s52, s58
    s_add_u32 s53, s53, s58
    v_mfma_f32_16x16x32_bf16 v[68:71], a[16:19], a[216:219], v[68:71]
    buffer_load_dwordx4 a[72:75], v224, s[28:31], s52 offen offset:0 sc1
    v_mfma_f32_16x16x32_bf16 v[72:75], a[16:19], a[220:223], v[72:75]
    ds_read_b64_tr_b16 a[6:7], v241 offset:25600
    v_mfma_f32_16x16x32_bf16 v[76:79], a[16:19], a[224:227], v[76:79]
    v_mfma_f32_16x16x32_bf16 a[232:235], a[20:23], a[228:231], a[232:235]
    ds_read_b64_tr_b16 a[8:9], v242 offset:18432
    s_waitcnt lgkmcnt(5)
    v_mfma_f32_16x16x32_bf16 v[80:83], a[24:27], a[212:215], v[80:83]
    ds_read_b64_tr_b16 a[10:11], v242 offset:25600
    v_mfma_f32_16x16x32_bf16 v[84:87], a[24:27], a[216:219], v[84:87]
    ds_read_b64_tr_b16 a[12:13], v243 offset:18432
    v_mfma_f32_16x16x32_bf16 v[88:91], a[24:27], a[220:223], v[88:91]
    ds_read_b64_tr_b16 a[14:15], v243 offset:25600
    v_mfma_f32_16x16x32_bf16 v[92:95], a[24:27], a[224:227], v[92:95]
    buffer_load_dwordx4 a[76:79], v250, s[28:31], s52 offen offset:1024 sc1
    v_mfma_f32_16x16x32_bf16 v[108:111], a[28:31], a[224:227], v[108:111]
    ds_read_b64_tr_b16 a[16:17], v244 offset:18432
    v_mfma_f32_16x16x32_bf16 v[104:107], a[28:31], a[220:223], v[104:107]
    buffer_load_dwordx4 a[80:83], v251, s[28:31], s52 offen offset:2048 sc1
    v_mfma_f32_16x16x32_bf16 v[100:103], a[28:31], a[216:219], v[100:103]
    ds_read_b64_tr_b16 a[18:19], v244 offset:25600
    v_mfma_f32_16x16x32_bf16 v[96:99], a[28:31], a[212:215], v[96:99]
    s_waitcnt lgkmcnt(6)
    v_mfma_f32_16x16x32_bf16 v[112:115], a[0:3], a[212:215], v[112:115]
    ds_read_b64_tr_b16 a[20:21], v249 offset:18432
    v_mfma_f32_16x16x32_bf16 v[116:119], a[0:3], a[216:219], v[116:119]
    buffer_load_dwordx4 a[84:87], v252, s[28:31], s52 offen offset:3072 sc1
    v_mfma_f32_16x16x32_bf16 v[120:123], a[0:3], a[220:223], v[120:123]
    ds_read_b64_tr_b16 a[22:23], v249 offset:25600
    v_mfma_f32_16x16x32_bf16 v[124:127], a[0:3], a[224:227], v[124:127]
    v_mfma_f32_16x16x32_bf16 v[140:143], a[224:227], a[4:7], v[140:143]
    ds_read_b64_tr_b16 a[24:25], v245 offset:20480
    v_mfma_f32_16x16x32_bf16 v[136:139], a[220:223], a[4:7], v[136:139]
    buffer_load_dwordx4 a[88:91], v225, s[28:31], s52 offen sc1
    v_mfma_f32_16x16x32_bf16 v[132:135], a[216:219], a[4:7], v[132:135]
    ds_read_b64_tr_b16 a[26:27], v245 offset:27648
    v_mfma_f32_16x16x32_bf16 v[128:131], a[212:215], a[4:7], v[128:131]
    s_waitcnt lgkmcnt(6)
    v_mfma_f32_16x16x32_bf16 v[144:147], a[212:215], a[8:11], v[144:147]
    ds_read_b64_tr_b16 a[28:29], v246 offset:20480
    v_mfma_f32_16x16x32_bf16 v[148:151], a[216:219], a[8:11], v[148:151]
    ds_read_b64_tr_b16 a[30:31], v246 offset:27648
    v_mfma_f32_16x16x32_bf16 v[152:155], a[220:223], a[8:11], v[152:155]
    v_mfma_f32_16x16x32_bf16 v[156:159], a[224:227], a[8:11], v[156:159]
    s_waitcnt vmcnt(12)
    s_barrier
    v_mfma_f32_16x16x32_bf16 v[172:175], a[224:227], a[12:15], v[172:175]
    ds_read_b64_tr_b16 a[0:1], v229 offset:0
    v_mfma_f32_16x16x32_bf16 v[168:171], a[220:223], a[12:15], v[168:171]
    buffer_load_dwordx4 a[92:95], v224, s[28:31], s53 offen offset:0 sc1
    v_mfma_f32_16x16x32_bf16 v[164:167], a[216:219], a[12:15], v[164:167]
    ds_read_b64_tr_b16 a[2:3], v229 offset:7168
    v_mfma_f32_16x16x32_bf16 v[160:163], a[212:215], a[12:15], v[160:163]
    s_waitcnt lgkmcnt(6)
    v_mfma_f32_16x16x32_bf16 v[176:179], a[212:215], a[16:19], v[176:179]
    ds_read_b64_tr_b16 a[4:5], v230 offset:0
    v_mfma_f32_16x16x32_bf16 v[180:183], a[216:219], a[16:19], v[180:183]
    buffer_load_dwordx4 a[96:99], v250, s[28:31], s53 offen offset:1024 sc1
    v_mfma_f32_16x16x32_bf16 v[184:187], a[220:223], a[16:19], v[184:187]
    ds_read_b64_tr_b16 a[6:7], v230 offset:7168
    v_mfma_f32_16x16x32_bf16 v[188:191], a[224:227], a[16:19], v[188:191]
    v_mfma_f32_16x16x32_bf16 a[236:239], a[228:231], a[20:23], a[236:239]
    ds_read_b64_tr_b16 a[8:9], v231 offset:0
    s_waitcnt lgkmcnt(5)
    v_mfma_f32_16x16x32_bf16 v[192:195], a[24:27], a[212:215], v[192:195]
    ds_read_b64_tr_b16 a[10:11], v231 offset:7168
    v_mfma_f32_16x16x32_bf16 v[196:199], a[24:27], a[216:219], v[196:199]
    ds_read_b64_tr_b16 a[12:13], v232 offset:0
    v_mfma_f32_16x16x32_bf16 v[200:203], a[24:27], a[220:223], v[200:203]
    ds_read_b64_tr_b16 a[14:15], v232 offset:7168
    v_mfma_f32_16x16x32_bf16 v[204:207], a[24:27], a[224:227], v[204:207]
    buffer_load_dwordx4 a[100:103], v251, s[28:31], s53 offen offset:2048 sc1
    v_mfma_f32_16x16x32_bf16 v[220:223], a[28:31], a[224:227], v[220:223]
    ds_read_b64_tr_b16 a[16:17], v229 offset:2048
    v_mfma_f32_16x16x32_bf16 v[216:219], a[28:31], a[220:223], v[216:219]
    buffer_load_dwordx4 a[104:107], v252, s[28:31], s53 offen offset:3072 sc1
    v_mfma_f32_16x16x32_bf16 v[212:215], a[28:31], a[216:219], v[212:215]
    ds_read_b64_tr_b16 a[18:19], v229 offset:9216
    v_mfma_f32_16x16x32_bf16 v[208:211], a[28:31], a[212:215], v[208:211]
    buffer_load_dwordx4 a[108:111], v225, s[28:31], s53 offen sc1
    s_waitcnt lgkmcnt(6)
    v_mfma_f32_16x16x32_bf16 v[0:3], a[0:3], a[32:35], v[0:3]
    ds_read_b64_tr_b16 a[20:21], v247 offset:2048
    v_mfma_f32_16x16x32_bf16 v[4:7], a[0:3], a[36:39], v[4:7]
    ds_read_b64_tr_b16 a[22:23], v247 offset:9216
    v_mfma_f32_16x16x32_bf16 v[8:11], a[0:3], a[40:43], v[8:11]
    v_mfma_f32_16x16x32_bf16 v[12:15], a[0:3], a[44:47], v[12:15]
    v_mfma_f32_16x16x32_bf16 v[28:31], a[4:7], a[44:47], v[28:31]
    ds_read_b64_tr_b16 a[24:25], v230 offset:2048
    s_add_u32 s52, s52, s58
    s_add_u32 s53, s53, s58
    v_mfma_f32_16x16x32_bf16 v[24:27], a[4:7], a[40:43], v[24:27]
    s_add_u32 s56, s56, 1
    s_add_u32 m0, s55, 57344
    buffer_load_dword a240, v253, s[36:39], s17 offen
    v_mfma_f32_16x16x32_bf16 v[20:23], a[4:7], a[36:39], v[20:23]
    ds_read_b64_tr_b16 a[26:27], v230 offset:9216
    s_add_u32 s17, s17, s71
    v_mfma_f32_16x16x32_bf16 v[16:19], a[4:7], a[32:35], v[16:19]
    s_waitcnt lgkmcnt(6)
    v_mfma_f32_16x16x32_bf16 v[32:35], a[8:11], a[32:35], v[32:35]
    ds_read_b64_tr_b16 a[28:29], v231 offset:2048
    v_mfma_f32_16x16x32_bf16 v[36:39], a[8:11], a[36:39], v[36:39]
    buffer_load_dwordx4 v227, s[32:35], s64 offen offset:0 lds
    s_add_u32 s64, s64, s59
    v_mfma_f32_16x16x32_bf16 v[40:43], a[8:11], a[40:43], v[40:43]
    ds_read_b64_tr_b16 a[30:31], v231 offset:9216
    v_mfma_f32_16x16x32_bf16 v[44:47], a[8:11], a[44:47], v[44:47]
    v_mfma_f32_16x16x32_bf16 v[60:63], a[12:15], a[44:47], v[60:63]
    ds_read_b64_tr_b16 a[0:1], v232 offset:2048
    v_mfma_f32_16x16x32_bf16 v[56:59], a[12:15], a[40:43], v[56:59]
    buffer_load_dwordx4 a[112:115], v224, s[28:31], s52 offen offset:0 sc1
    v_mfma_f32_16x16x32_bf16 v[52:55], a[12:15], a[36:39], v[52:55]
    ds_read_b64_tr_b16 a[2:3], v232 offset:9216
    v_mfma_f32_16x16x32_bf16 v[48:51], a[12:15], a[32:35], v[48:51]
    s_waitcnt lgkmcnt(6)
    v_mfma_f32_16x16x32_bf16 v[64:67], a[16:19], a[32:35], v[64:67]
    ds_read_b64_tr_b16 a[4:5], v229 offset:4096
    v_mfma_f32_16x16x32_bf16 v[68:71], a[16:19], a[36:39], v[68:71]
    buffer_load_dwordx4 v227, s[32:35], s65 offen offset:1024 lds
    s_add_u32 s65, s65, s59
    v_mfma_f32_16x16x32_bf16 v[72:75], a[16:19], a[40:43], v[72:75]
    ds_read_b64_tr_b16 a[6:7], v229 offset:11264
    v_mfma_f32_16x16x32_bf16 v[76:79], a[16:19], a[44:47], v[76:79]
    v_mfma_f32_16x16x32_bf16 a[232:235], a[20:23], a[48:51], a[232:235]
    ds_read_b64_tr_b16 a[8:9], v230 offset:4096
    s_waitcnt lgkmcnt(5)
    v_mfma_f32_16x16x32_bf16 v[80:83], a[24:27], a[32:35], v[80:83]
    ds_read_b64_tr_b16 a[10:11], v230 offset:11264
    v_mfma_f32_16x16x32_bf16 v[84:87], a[24:27], a[36:39], v[84:87]
    ds_read_b64_tr_b16 a[12:13], v231 offset:4096
    v_mfma_f32_16x16x32_bf16 v[88:91], a[24:27], a[40:43], v[88:91]
    ds_read_b64_tr_b16 a[14:15], v231 offset:11264
    v_mfma_f32_16x16x32_bf16 v[92:95], a[24:27], a[44:47], v[92:95]
    buffer_load_dwordx4 a[116:119], v250, s[28:31], s52 offen offset:1024 sc1
    v_mfma_f32_16x16x32_bf16 v[108:111], a[28:31], a[44:47], v[108:111]
    ds_read_b64_tr_b16 a[16:17], v232 offset:4096
    v_mfma_f32_16x16x32_bf16 v[104:107], a[28:31], a[40:43], v[104:107]
    buffer_load_dwordx4 v227, s[32:35], s66 offen offset:2048 lds
    s_add_u32 s66, s66, s59
    v_mfma_f32_16x16x32_bf16 v[100:103], a[28:31], a[36:39], v[100:103]
    ds_read_b64_tr_b16 a[18:19], v232 offset:11264
    v_mfma_f32_16x16x32_bf16 v[96:99], a[28:31], a[32:35], v[96:99]
    s_waitcnt lgkmcnt(6)
    v_mfma_f32_16x16x32_bf16 v[112:115], a[0:3], a[32:35], v[112:115]
    ds_read_b64_tr_b16 a[20:21], v247 offset:4096
    v_mfma_f32_16x16x32_bf16 v[116:119], a[0:3], a[36:39], v[116:119]
    buffer_load_dwordx4 a[120:123], v251, s[28:31], s52 offen offset:2048 sc1
    v_mfma_f32_16x16x32_bf16 v[120:123], a[0:3], a[40:43], v[120:123]
    ds_read_b64_tr_b16 a[22:23], v247 offset:11264
    v_mfma_f32_16x16x32_bf16 v[124:127], a[0:3], a[44:47], v[124:127]
    v_mfma_f32_16x16x32_bf16 v[140:143], a[44:47], a[4:7], v[140:143]
    ds_read_b64_tr_b16 a[24:25], v233 offset:6144
    v_mfma_f32_16x16x32_bf16 v[136:139], a[40:43], a[4:7], v[136:139]
    buffer_load_dwordx4 v227, s[32:35], s67 offen offset:3072 lds
    s_add_u32 s67, s67, s59
    v_mfma_f32_16x16x32_bf16 v[132:135], a[36:39], a[4:7], v[132:135]
    ds_read_b64_tr_b16 a[26:27], v233 offset:13312
    v_mfma_f32_16x16x32_bf16 v[128:131], a[32:35], a[4:7], v[128:131]
    s_waitcnt lgkmcnt(6)
    v_mfma_f32_16x16x32_bf16 v[144:147], a[32:35], a[8:11], v[144:147]
    ds_read_b64_tr_b16 a[28:29], v234 offset:6144
    v_mfma_f32_16x16x32_bf16 v[148:151], a[36:39], a[8:11], v[148:151]
    ds_read_b64_tr_b16 a[30:31], v234 offset:13312
    v_mfma_f32_16x16x32_bf16 v[152:155], a[40:43], a[8:11], v[152:155]
    v_mfma_f32_16x16x32_bf16 v[156:159], a[44:47], a[8:11], v[156:159]
    v_mfma_f32_16x16x32_bf16 v[172:175], a[44:47], a[12:15], v[172:175]
    ds_read_b64_tr_b16 a[0:1], v229 offset:14336
    v_mfma_f32_16x16x32_bf16 v[168:171], a[40:43], a[12:15], v[168:171]
    buffer_load_dwordx4 a[124:127], v252, s[28:31], s52 offen offset:3072 sc1
    v_mfma_f32_16x16x32_bf16 v[164:167], a[36:39], a[12:15], v[164:167]
    ds_read_b64_tr_b16 a[2:3], v229 offset:21504
    v_mfma_f32_16x16x32_bf16 v[160:163], a[32:35], a[12:15], v[160:163]
    s_waitcnt lgkmcnt(6)
    v_mfma_f32_16x16x32_bf16 v[176:179], a[32:35], a[16:19], v[176:179]
    ds_read_b64_tr_b16 a[4:5], v230 offset:14336
    s_add_u32 m0, s55, 61440
    v_mfma_f32_16x16x32_bf16 v[180:183], a[36:39], a[16:19], v[180:183]
    buffer_load_dwordx4 v227, s[32:35], s68 offen offset:0 lds
    s_add_u32 s68, s68, s59
    v_mfma_f32_16x16x32_bf16 v[184:187], a[40:43], a[16:19], v[184:187]
    ds_read_b64_tr_b16 a[6:7], v230 offset:21504
    v_mfma_f32_16x16x32_bf16 v[188:191], a[44:47], a[16:19], v[188:191]
    v_mfma_f32_16x16x32_bf16 a[236:239], a[48:51], a[20:23], a[236:239]
    ds_read_b64_tr_b16 a[8:9], v231 offset:14336
    s_waitcnt lgkmcnt(5)
    v_mfma_f32_16x16x32_bf16 v[192:195], a[24:27], a[32:35], v[192:195]
    ds_read_b64_tr_b16 a[10:11], v231 offset:21504
    v_mfma_f32_16x16x32_bf16 v[196:199], a[24:27], a[36:39], v[196:199]
    ds_read_b64_tr_b16 a[12:13], v232 offset:14336
    v_mfma_f32_16x16x32_bf16 v[200:203], a[24:27], a[40:43], v[200:203]
    ds_read_b64_tr_b16 a[14:15], v232 offset:21504
    v_mfma_f32_16x16x32_bf16 v[204:207], a[24:27], a[44:47], v[204:207]
    buffer_load_dwordx4 a[128:131], v225, s[28:31], s52 offen sc1
    v_mfma_f32_16x16x32_bf16 v[220:223], a[28:31], a[44:47], v[220:223]
    ds_read_b64_tr_b16 a[16:17], v229 offset:16384
    v_mfma_f32_16x16x32_bf16 v[216:219], a[28:31], a[40:43], v[216:219]
    buffer_load_dwordx4 v227, s[32:35], s69 offen offset:1024 lds
    s_add_u32 s69, s69, s59
    v_mfma_f32_16x16x32_bf16 v[212:215], a[28:31], a[36:39], v[212:215]
    ds_read_b64_tr_b16 a[18:19], v229 offset:23552
    v_mfma_f32_16x16x32_bf16 v[208:211], a[28:31], a[32:35], v[208:211]
    buffer_load_dwordx4 a[132:135], v224, s[28:31], s53 offen offset:0 sc1
    s_waitcnt lgkmcnt(6)
    v_mfma_f32_16x16x32_bf16 v[0:3], a[0:3], a[52:55], v[0:3]
    ds_read_b64_tr_b16 a[20:21], v247 offset:16384
    v_mfma_f32_16x16x32_bf16 v[4:7], a[0:3], a[56:59], v[4:7]
    ds_read_b64_tr_b16 a[22:23], v247 offset:23552
    v_mfma_f32_16x16x32_bf16 v[8:11], a[0:3], a[60:63], v[8:11]
    v_mfma_f32_16x16x32_bf16 v[12:15], a[0:3], a[64:67], v[12:15]
    v_mfma_f32_16x16x32_bf16 v[28:31], a[4:7], a[64:67], v[28:31]
    ds_read_b64_tr_b16 a[24:25], v230 offset:16384
    v_mfma_f32_16x16x32_bf16 v[24:27], a[4:7], a[60:63], v[24:27]
    buffer_load_dwordx4 v228, s[40:43], s70 offen offset:2048 lds
    s_add_u32 s70, s70, s61
    v_mfma_f32_16x16x32_bf16 v[20:23], a[4:7], a[56:59], v[20:23]
    ds_read_b64_tr_b16 a[26:27], v230 offset:23552
    v_mfma_f32_16x16x32_bf16 v[16:19], a[4:7], a[52:55], v[16:19]
    s_waitcnt lgkmcnt(6)
    v_mfma_f32_16x16x32_bf16 v[32:35], a[8:11], a[52:55], v[32:35]
    ds_read_b64_tr_b16 a[28:29], v231 offset:16384
    v_mfma_f32_16x16x32_bf16 v[36:39], a[8:11], a[56:59], v[36:39]
    buffer_load_dwordx4 a[136:139], v250, s[28:31], s53 offen offset:1024 sc1
    v_mfma_f32_16x16x32_bf16 v[40:43], a[8:11], a[60:63], v[40:43]
    ds_read_b64_tr_b16 a[30:31], v231 offset:23552
    v_mfma_f32_16x16x32_bf16 v[44:47], a[8:11], a[64:67], v[44:47]
    v_mfma_f32_16x16x32_bf16 v[60:63], a[12:15], a[64:67], v[60:63]
    ds_read_b64_tr_b16 a[0:1], v232 offset:16384
    v_mfma_f32_16x16x32_bf16 v[56:59], a[12:15], a[60:63], v[56:59]
    buffer_load_dwordx4 a[140:143], v251, s[28:31], s53 offen offset:2048 sc1
    v_mfma_f32_16x16x32_bf16 v[52:55], a[12:15], a[56:59], v[52:55]
    ds_read_b64_tr_b16 a[2:3], v232 offset:23552
    v_mfma_f32_16x16x32_bf16 v[48:51], a[12:15], a[52:55], v[48:51]
    s_waitcnt lgkmcnt(6)
    v_mfma_f32_16x16x32_bf16 v[64:67], a[16:19], a[52:55], v[64:67]
    ds_read_b64_tr_b16 a[4:5], v229 offset:18432
    v_mfma_f32_16x16x32_bf16 v[68:71], a[16:19], a[56:59], v[68:71]
    buffer_load_dwordx4 a[144:147], v252, s[28:31], s53 offen offset:3072 sc1
    v_mfma_f32_16x16x32_bf16 v[72:75], a[16:19], a[60:63], v[72:75]
    ds_read_b64_tr_b16 a[6:7], v229 offset:25600
    v_mfma_f32_16x16x32_bf16 v[76:79], a[16:19], a[64:67], v[76:79]
    v_mfma_f32_16x16x32_bf16 a[232:235], a[20:23], a[68:71], a[232:235]
    ds_read_b64_tr_b16 a[8:9], v230 offset:18432
    s_waitcnt lgkmcnt(5)
    v_mfma_f32_16x16x32_bf16 v[80:83], a[24:27], a[52:55], v[80:83]
    ds_read_b64_tr_b16 a[10:11], v230 offset:25600
    v_mfma_f32_16x16x32_bf16 v[84:87], a[24:27], a[56:59], v[84:87]
    ds_read_b64_tr_b16 a[12:13], v231 offset:18432
    v_mfma_f32_16x16x32_bf16 v[88:91], a[24:27], a[60:63], v[88:91]
    ds_read_b64_tr_b16 a[14:15], v231 offset:25600
    v_mfma_f32_16x16x32_bf16 v[92:95], a[24:27], a[64:67], v[92:95]
    buffer_load_dwordx4 a[148:151], v225, s[28:31], s53 offen sc1
    v_mfma_f32_16x16x32_bf16 v[108:111], a[28:31], a[64:67], v[108:111]
    ds_read_b64_tr_b16 a[16:17], v232 offset:18432
    s_add_u32 s52, s52, s58
    s_add_u32 s53, s53, s58
    v_mfma_f32_16x16x32_bf16 v[104:107], a[28:31], a[60:63], v[104:107]
    s_add_u32 s56, s56, 1
    s_add_u32 m0, s55, 86016
    buffer_load_dword a240, v253, s[36:39], s17 offen
    v_mfma_f32_16x16x32_bf16 v[100:103], a[28:31], a[56:59], v[100:103]
    ds_read_b64_tr_b16 a[18:19], v232 offset:25600
    s_add_u32 s17, s17, s71
    v_mfma_f32_16x16x32_bf16 v[96:99], a[28:31], a[52:55], v[96:99]
    s_waitcnt lgkmcnt(6)
    v_mfma_f32_16x16x32_bf16 v[112:115], a[0:3], a[52:55], v[112:115]
    ds_read_b64_tr_b16 a[20:21], v247 offset:18432
    v_mfma_f32_16x16x32_bf16 v[116:119], a[0:3], a[56:59], v[116:119]
    buffer_load_dwordx4 v227, s[32:35], s64 offen offset:0 lds
    s_add_u32 s64, s64, s59
    v_mfma_f32_16x16x32_bf16 v[120:123], a[0:3], a[60:63], v[120:123]
    ds_read_b64_tr_b16 a[22:23], v247 offset:25600
    v_mfma_f32_16x16x32_bf16 v[124:127], a[0:3], a[64:67], v[124:127]
    v_mfma_f32_16x16x32_bf16 v[140:143], a[64:67], a[4:7], v[140:143]
    ds_read_b64_tr_b16 a[24:25], v233 offset:20480
    v_mfma_f32_16x16x32_bf16 v[136:139], a[60:63], a[4:7], v[136:139]
    buffer_load_dwordx4 a[152:155], v224, s[28:31], s52 offen offset:0 sc1
    v_mfma_f32_16x16x32_bf16 v[132:135], a[56:59], a[4:7], v[132:135]
    ds_read_b64_tr_b16 a[26:27], v233 offset:27648
    v_mfma_f32_16x16x32_bf16 v[128:131], a[52:55], a[4:7], v[128:131]
    s_waitcnt lgkmcnt(6)
    v_mfma_f32_16x16x32_bf16 v[144:147], a[52:55], a[8:11], v[144:147]
    ds_read_b64_tr_b16 a[28:29], v234 offset:20480
    v_mfma_f32_16x16x32_bf16 v[148:151], a[56:59], a[8:11], v[148:151]
    ds_read_b64_tr_b16 a[30:31], v234 offset:27648
    v_mfma_f32_16x16x32_bf16 v[152:155], a[60:63], a[8:11], v[152:155]
    v_mfma_f32_16x16x32_bf16 v[156:159], a[64:67], a[8:11], v[156:159]
    s_waitcnt vmcnt(21)
    s_barrier
    v_mfma_f32_16x16x32_bf16 v[172:175], a[64:67], a[12:15], v[172:175]
    ds_read_b64_tr_b16 a[0:1], v229 offset:28672
    v_mfma_f32_16x16x32_bf16 v[168:171], a[60:63], a[12:15], v[168:171]
    buffer_load_dwordx4 v227, s[32:35], s65 offen offset:1024 lds
    s_add_u32 s65, s65, s59
    v_mfma_f32_16x16x32_bf16 v[164:167], a[56:59], a[12:15], v[164:167]
    ds_read_b64_tr_b16 a[2:3], v229 offset:35840
    v_mfma_f32_16x16x32_bf16 v[160:163], a[52:55], a[12:15], v[160:163]
    s_waitcnt lgkmcnt(6)
    v_mfma_f32_16x16x32_bf16 v[176:179], a[52:55], a[16:19], v[176:179]
    ds_read_b64_tr_b16 a[4:5], v230 offset:28672
    v_mfma_f32_16x16x32_bf16 v[180:183], a[56:59], a[16:19], v[180:183]
    buffer_load_dwordx4 a[156:159], v250, s[28:31], s52 offen offset:1024 sc1
    v_mfma_f32_16x16x32_bf16 v[184:187], a[60:63], a[16:19], v[184:187]
    ds_read_b64_tr_b16 a[6:7], v230 offset:35840
    v_mfma_f32_16x16x32_bf16 v[188:191], a[64:67], a[16:19], v[188:191]
    v_mfma_f32_16x16x32_bf16 a[236:239], a[68:71], a[20:23], a[236:239]
    ds_read_b64_tr_b16 a[8:9], v231 offset:28672
    s_waitcnt lgkmcnt(5)
    v_mfma_f32_16x16x32_bf16 v[192:195], a[24:27], a[52:55], v[192:195]
    ds_read_b64_tr_b16 a[10:11], v231 offset:35840
    v_mfma_f32_16x16x32_bf16 v[196:199], a[24:27], a[56:59], v[196:199]
    ds_read_b64_tr_b16 a[12:13], v232 offset:28672
    v_mfma_f32_16x16x32_bf16 v[200:203], a[24:27], a[60:63], v[200:203]
    ds_read_b64_tr_b16 a[14:15], v232 offset:35840
    v_mfma_f32_16x16x32_bf16 v[204:207], a[24:27], a[64:67], v[204:207]
    buffer_load_dwordx4 v227, s[32:35], s66 offen offset:2048 lds
    s_add_u32 s66, s66, s59
    v_mfma_f32_16x16x32_bf16 v[220:223], a[28:31], a[64:67], v[220:223]
    ds_read_b64_tr_b16 a[16:17], v229 offset:30720
    v_mfma_f32_16x16x32_bf16 v[216:219], a[28:31], a[60:63], v[216:219]
    buffer_load_dwordx4 a[160:163], v251, s[28:31], s52 offen offset:2048 sc1
    v_mfma_f32_16x16x32_bf16 v[212:215], a[28:31], a[56:59], v[212:215]
    ds_read_b64_tr_b16 a[18:19], v229 offset:37888
    v_mfma_f32_16x16x32_bf16 v[208:211], a[28:31], a[52:55], v[208:211]
    buffer_load_dwordx4 v227, s[32:35], s67 offen offset:3072 lds
    s_add_u32 s67, s67, s59
    s_waitcnt lgkmcnt(6)
    v_mfma_f32_16x16x32_bf16 v[0:3], a[0:3], a[72:75], v[0:3]
    ds_read_b64_tr_b16 a[20:21], v247 offset:30720
    v_mfma_f32_16x16x32_bf16 v[4:7], a[0:3], a[76:79], v[4:7]
    ds_read_b64_tr_b16 a[22:23], v247 offset:37888
    v_mfma_f32_16x16x32_bf16 v[8:11], a[0:3], a[80:83], v[8:11]
    v_mfma_f32_16x16x32_bf16 v[12:15], a[0:3], a[84:87], v[12:15]
    v_mfma_f32_16x16x32_bf16 v[28:31], a[4:7], a[84:87], v[28:31]
    ds_read_b64_tr_b16 a[24:25], v230 offset:30720
    v_mfma_f32_16x16x32_bf16 v[24:27], a[4:7], a[80:83], v[24:27]
    buffer_load_dwordx4 a[164:167], v252, s[28:31], s52 offen offset:3072 sc1
    v_mfma_f32_16x16x32_bf16 v[20:23], a[4:7], a[76:79], v[20:23]
    ds_read_b64_tr_b16 a[26:27], v230 offset:37888
    v_mfma_f32_16x16x32_bf16 v[16:19], a[4:7], a[72:75], v[16:19]
    s_waitcnt lgkmcnt(6)
    v_mfma_f32_16x16x32_bf16 v[32:35], a[8:11], a[72:75], v[32:35]
    ds_read_b64_tr_b16 a[28:29], v231 offset:30720
    s_add_u32 m0, s55, 90112
    v_mfma_f32_16x16x32_bf16 v[36:39], a[8:11], a[76:79], v[36:39]
    buffer_load_dwordx4 v227, s[32:35], s68 offen offset:0 lds
    s_add_u32 s68, s68, s59
    v_mfma_f32_16x16x32_bf16 v[40:43], a[8:11], a[80:83], v[40:43]
    ds_read_b64_tr_b16 a[30:31], v231 offset:37888
    v_mfma_f32_16x16x32_bf16 v[44:47], a[8:11], a[84:87], v[44:47]
    v_mfma_f32_16x16x32_bf16 v[60:63], a[12:15], a[84:87], v[60:63]
    ds_read_b64_tr_b16 a[0:1], v232 offset:30720
    v_mfma_f32_16x16x32_bf16 v[56:59], a[12:15], a[80:83], v[56:59]
    buffer_load_dwordx4 a[168:171], v225, s[28:31], s52 offen sc1
    v_mfma_f32_16x16x32_bf16 v[52:55], a[12:15], a[76:79], v[52:55]
    ds_read_b64_tr_b16 a[2:3], v232 offset:37888
    v_mfma_f32_16x16x32_bf16 v[48:51], a[12:15], a[72:75], v[48:51]
    s_waitcnt lgkmcnt(6)
    v_mfma_f32_16x16x32_bf16 v[64:67], a[16:19], a[72:75], v[64:67]
    ds_read_b64_tr_b16 a[4:5], v229 offset:32768
    v_mfma_f32_16x16x32_bf16 v[68:71], a[16:19], a[76:79], v[68:71]
    buffer_load_dwordx4 v227, s[32:35], s69 offen offset:1024 lds
    s_add_u32 s69, s69, s59
    v_mfma_f32_16x16x32_bf16 v[72:75], a[16:19], a[80:83], v[72:75]
    ds_read_b64_tr_b16 a[6:7], v229 offset:39936
    v_mfma_f32_16x16x32_bf16 v[76:79], a[16:19], a[84:87], v[76:79]
    s_branch L_po_q_1
.p2align 12
L_pg_q_1:
    s_branch L_pg_q_4
L_po_q_1:
    v_mfma_f32_16x16x32_bf16 a[232:235], a[20:23], a[88:91], a[232:235]
    ds_read_b64_tr_b16 a[8:9], v230 offset:32768
    s_waitcnt lgkmcnt(5)
    v_mfma_f32_16x16x32_bf16 v[80:83], a[24:27], a[72:75], v[80:83]
    ds_read_b64_tr_b16 a[10:11], v230 offset:39936
    v_mfma_f32_16x16x32_bf16 v[84:87], a[24:27], a[76:79], v[84:87]
    ds_read_b64_tr_b16 a[12:13], v231 offset:32768
    v_mfma_f32_16x16x32_bf16 v[88:91], a[24:27], a[80:83], v[88:91]
    ds_read_b64_tr_b16 a[14:15], v231 offset:39936
    v_mfma_f32_16x16x32_bf16 v[92:95], a[24:27], a[84:87], v[92:95]
    buffer_load_dwordx4 a[172:175], v224, s[28:31], s53 offen offset:0 sc1
    v_mfma_f32_16x16x32_bf16 v[108:111], a[28:31], a[84:87], v[108:111]
    ds_read_b64_tr_b16 a[16:17], v232 offset:32768
    v_mfma_f32_16x16x32_bf16 v[104:107], a[28:31], a[80:83], v[104:107]
    buffer_load_dwordx4 v228, s[40:43], s70 offen offset:2048 lds
    s_add_u32 s70, s70, s61
    v_mfma_f32_16x16x32_bf16 v[100:103], a[28:31], a[76:79], v[100:103]
    ds_read_b64_tr_b16 a[18:19], v232 offset:39936
    v_mfma_f32_16x16x32_bf16 v[96:99], a[28:31], a[72:75], v[96:99]
    s_waitcnt lgkmcnt(6)
    v_mfma_f32_16x16x32_bf16 v[112:115], a[0:3], a[72:75], v[112:115]
    ds_read_b64_tr_b16 a[20:21], v247 offset:32768
    v_mfma_f32_16x16x32_bf16 v[116:119], a[0:3], a[76:79], v[116:119]
    buffer_load_dwordx4 a[176:179], v250, s[28:31], s53 offen offset:1024 sc1
    v_mfma_f32_16x16x32_bf16 v[120:123], a[0:3], a[80:83], v[120:123]
    ds_read_b64_tr_b16 a[22:23], v247 offset:39936
    v_mfma_f32_16x16x32_bf16 v[124:127], a[0:3], a[84:87], v[124:127]
    v_mfma_f32_16x16x32_bf16 v[140:143], a[84:87], a[4:7], v[140:143]
    ds_read_b64_tr_b16 a[24:25], v233 offset:34816
    v_mfma_f32_16x16x32_bf16 v[136:139], a[80:83], a[4:7], v[136:139]
    buffer_load_dwordx4 a[180:183], v251, s[28:31], s53 offen offset:2048 sc1
    v_mfma_f32_16x16x32_bf16 v[132:135], a[76:79], a[4:7], v[132:135]
    ds_read_b64_tr_b16 a[26:27], v233 offset:41984
    v_mfma_f32_16x16x32_bf16 v[128:131], a[72:75], a[4:7], v[128:131]
    s_waitcnt lgkmcnt(6)
    v_mfma_f32_16x16x32_bf16 v[144:147], a[72:75], a[8:11], v[144:147]
    ds_read_b64_tr_b16 a[28:29], v234 offset:34816
    v_mfma_f32_16x16x32_bf16 v[148:151], a[76:79], a[8:11], v[148:151]
    ds_read_b64_tr_b16 a[30:31], v234 offset:41984
    v_mfma_f32_16x16x32_bf16 v[152:155], a[80:83], a[8:11], v[152:155]
    v_mfma_f32_16x16x32_bf16 v[156:159], a[84:87], a[8:11], v[156:159]
    v_mfma_f32_16x16x32_bf16 v[172:175], a[84:87], a[12:15], v[172:175]
    ds_read_b64_tr_b16 a[0:1], v229 offset:43008
    v_mfma_f32_16x16x32_bf16 v[168:171], a[80:83], a[12:15], v[168:171]
    buffer_load_dwordx4 a[184:187], v252, s[28:31], s53 offen offset:3072 sc1
    v_mfma_f32_16x16x32_bf16 v[164:167], a[76:79], a[12:15], v[164:167]
    ds_read_b64_tr_b16 a[2:3], v229 offset:50176
    v_mfma_f32_16x16x32_bf16 v[160:163], a[72:75], a[12:15], v[160:163]
    s_waitcnt lgkmcnt(6)
    v_mfma_f32_16x16x32_bf16 v[176:179], a[72:75], a[16:19], v[176:179]
    ds_read_b64_tr_b16 a[4:5], v230 offset:43008
    v_mfma_f32_16x16x32_bf16 v[180:183], a[76:79], a[16:19], v[180:183]
    buffer_load_dwordx4 a[188:191], v225, s[28:31], s53 offen sc1
    v_mfma_f32_16x16x32_bf16 v[184:187], a[80:83], a[16:19], v[184:187]
    ds_read_b64_tr_b16 a[6:7], v230 offset:50176
    v_mfma_f32_16x16x32_bf16 v[188:191], a[84:87], a[16:19], v[188:191]
    v_mfma_f32_16x16x32_bf16 a[236:239], a[88:91], a[20:23], a[236:239]
    ds_read_b64_tr_b16 a[8:9], v231 offset:43008
    s_add_u32 s52, s52, s58
    s_add_u32 s53, s53, s58
    s_waitcnt lgkmcnt(5)
    v_mfma_f32_16x16x32_bf16 v[192:195], a[24:27], a[72:75], v[192:195]
    ds_read_b64_tr_b16 a[10:11], v231 offset:50176
    s_add_u32 s56, s56, 1
    s_add_u32 m0, s55, 114688
    v_mfma_f32_16x16x32_bf16 v[196:199], a[24:27], a[76:79], v[196:199]
    ds_read_b64_tr_b16 a[12:13], v232 offset:43008
    v_mfma_f32_16x16x32_bf16 v[200:203], a[24:27], a[80:83], v[200:203]
    ds_read_b64_tr_b16 a[14:15], v232 offset:50176
    v_mfma_f32_16x16x32_bf16 v[204:207], a[24:27], a[84:87], v[204:207]
    buffer_load_dword a240, v253, s[36:39], s17 offen
    s_add_u32 s17, s17, s71
    v_mfma_f32_16x16x32_bf16 v[220:223], a[28:31], a[84:87], v[220:223]
    ds_read_b64_tr_b16 a[16:17], v229 offset:45056
    v_mfma_f32_16x16x32_bf16 v[216:219], a[28:31], a[80:83], v[216:219]
    buffer_load_dwordx4 v227, s[32:35], s64 offen offset:0 lds
    s_add_u32 s64, s64, s59
    v_mfma_f32_16x16x32_bf16 v[212:215], a[28:31], a[76:79], v[212:215]
    ds_read_b64_tr_b16 a[18:19], v229 offset:52224
    v_mfma_f32_16x16x32_bf16 v[208:211], a[28:31], a[72:75], v[208:211]
    buffer_load_dwordx4 a[192:195], v224, s[28:31], s52 offen offset:0 sc1
    s_waitcnt lgkmcnt(6)
    v_mfma_f32_16x16x32_bf16 v[0:3], a[0:3], a[92:95], v[0:3]
    ds_read_b64_tr_b16 a[20:21], v247 offset:45056
    v_mfma_f32_16x16x32_bf16 v[4:7], a[0:3], a[96:99], v[4:7]
    ds_read_b64_tr_b16 a[22:23], v247 offset:52224
    v_mfma_f32_16x16x32_bf16 v[8:11], a[0:3], a[100:103], v[8:11]
    v_mfma_f32_16x16x32_bf16 v[12:15], a[0:3], a[104:107], v[12:15]
    v_mfma_f32_16x16x32_bf16 v[28:31], a[4:7], a[104:107], v[28:31]
    ds_read_b64_tr_b16 a[24:25], v230 offset:45056
    v_mfma_f32_16x16x32_bf16 v[24:27], a[4:7], a[100:103], v[24:27]
    buffer_load_dwordx4 v227, s[32:35], s65 offen offset:1024 lds
    s_add_u32 s65, s65, s59
    v_mfma_f32_16x16x32_bf16 v[20:23], a[4:7], a[96:99], v[20:23]
    ds_read_b64_tr_b16 a[26:27], v230 offset:52224
    v_mfma_f32_16x16x32_bf16 v[16:19], a[4:7], a[92:95], v[16:19]
    s_waitcnt lgkmcnt(6)
    v_mfma_f32_16x16x32_bf16 v[32:35], a[8:11], a[92:95], v[32:35]
    ds_read_b64_tr_b16 a[28:29], v231 offset:45056
    v_mfma_f32_16x16x32_bf16 v[36:39], a[8:11], a[96:99], v[36:39]
    buffer_load_dwordx4 a[196:199], v250, s[28:31], s52 offen offset:1024 sc1
    v_mfma_f32_16x16x32_bf16 v[40:43], a[8:11], a[100:103], v[40:43]
    ds_read_b64_tr_b16 a[30:31], v231 offset:52224
    v_mfma_f32_16x16x32_bf16 v[44:47], a[8:11], a[104:107], v[44:47]
    v_mfma_f32_16x16x32_bf16 v[60:63], a[12:15], a[104:107], v[60:63]
    ds_read_b64_tr_b16 a[0:1], v232 offset:45056
    v_mfma_f32_16x16x32_bf16 v[56:59], a[12:15], a[100:103], v[56:59]
    buffer_load_dwordx4 v227, s[32:35], s66 offen offset:2048 lds
    s_add_u32 s66, s66, s59
    v_mfma_f32_16x16x32_bf16 v[52:55], a[12:15], a[96:99], v[52:55]
    ds_read_b64_tr_b16 a[2:3], v232 offset:52224
    v_mfma_f32_16x16x32_bf16 v[48:51], a[12:15], a[92:95], v[48:51]
    s_waitcnt lgkmcnt(6)
    v_mfma_f32_16x16x32_bf16 v[64:67], a[16:19], a[92:95], v[64:67]
    ds_read_b64_tr_b16 a[4:5], v229 offset:47104
    v_mfma_f32_16x16x32_bf16 v[68:71], a[16:19], a[96:99], v[68:71]
    buffer_load_dwordx4 a[200:203], v251, s[28:31], s52 offen offset:2048 sc1
    v_mfma_f32_16x16x32_bf16 v[72:75], a[16:19], a[100:103], v[72:75]
    ds_read_b64_tr_b16 a[6:7], v229 offset:54272
    v_mfma_f32_16x16x32_bf16 v[76:79], a[16:19], a[104:107], v[76:79]
    v_mfma_f32_16x16x32_bf16 a[232:235], a[20:23], a[108:111], a[232:235]
    ds_read_b64_tr_b16 a[8:9], v230 offset:47104
    s_waitcnt lgkmcnt(5)
    v_mfma_f32_16x16x32_bf16 v[80:83], a[24:27], a[92:95], v[80:83]
    ds_read_b64_tr_b16 a[10:11], v230 offset:54272
    v_mfma_f32_16x16x32_bf16 v[84:87], a[24:27], a[96:99], v[84:87]
    ds_read_b64_tr_b16 a[12:13], v231 offset:47104
    v_mfma_f32_16x16x32_bf16 v[88:91], a[24:27], a[100:103], v[88:91]
    ds_read_b64_tr_b16 a[14:15], v231 offset:54272
    v_mfma_f32_16x16x32_bf16 v[92:95], a[24:27], a[104:107], v[92:95]
    buffer_load_dwordx4 v227, s[32:35], s67 offen offset:3072 lds
    s_add_u32 s67, s67, s59
    v_mfma_f32_16x16x32_bf16 v[108:111], a[28:31], a[104:107], v[108:111]
    ds_read_b64_tr_b16 a[16:17], v232 offset:47104
    v_mfma_f32_16x16x32_bf16 v[104:107], a[28:31], a[100:103], v[104:107]
    buffer_load_dwordx4 a[204:207], v252, s[28:31], s52 offen offset:3072 sc1
    v_mfma_f32_16x16x32_bf16 v[100:103], a[28:31], a[96:99], v[100:103]
    ds_read_b64_tr_b16 a[18:19], v232 offset:54272
    v_mfma_f32_16x16x32_bf16 v[96:99], a[28:31], a[92:95], v[96:99]
    s_waitcnt lgkmcnt(6)
    v_mfma_f32_16x16x32_bf16 v[112:115], a[0:3], a[92:95], v[112:115]
    ds_read_b64_tr_b16 a[20:21], v247 offset:47104
    s_add_u32 m0, s55, 118784
    v_mfma_f32_16x16x32_bf16 v[116:119], a[0:3], a[96:99], v[116:119]
    buffer_load_dwordx4 v227, s[32:35], s68 offen offset:0 lds
    s_add_u32 s68, s68, s59
    v_mfma_f32_16x16x32_bf16 v[120:123], a[0:3], a[100:103], v[120:123]
    ds_read_b64_tr_b16 a[22:23], v247 offset:54272
    v_mfma_f32_16x16x32_bf16 v[124:127], a[0:3], a[104:107], v[124:127]
    v_mfma_f32_16x16x32_bf16 v[140:143], a[104:107], a[4:7], v[140:143]
    ds_read_b64_tr_b16 a[24:25], v233 offset:49152
    v_mfma_f32_16x16x32_bf16 v[136:139], a[100:103], a[4:7], v[136:139]
    buffer_load_dwordx4 a[208:211], v225, s[28:31], s52 offen sc1
    v_mfma_f32_16x16x32_bf16 v[132:135], a[96:99], a[4:7], v[132:135]
    ds_read_b64_tr_b16 a[26:27], v233 offset:56320
    v_mfma_f32_16x16x32_bf16 v[128:131], a[92:95], a[4:7], v[128:131]
    s_waitcnt lgkmcnt(6)
    v_mfma_f32_16x16x32_bf16 v[144:147], a[92:95], a[8:11], v[144:147]
    ds_read_b64_tr_b16 a[28:29], v234 offset:49152
    v_mfma_f32_16x16x32_bf16 v[148:151], a[96:99], a[8:11], v[148:151]
    ds_read_b64_tr_b16 a[30:31], v234 offset:56320
    v_mfma_f32_16x16x32_bf16 v[152:155], a[100:103], a[8:11], v[152:155]
    v_mfma_f32_16x16x32_bf16 v[156:159], a[104:107], a[8:11], v[156:159]
    s_waitcnt vmcnt(29)
    s_barrier
    v_mfma_f32_16x16x32_bf16 v[172:175], a[104:107], a[12:15], v[172:175]
    ds_read_b64_tr_b16 a[0:1], v235 offset:0
    v_mfma_f32_16x16x32_bf16 v[168:171], a[100:103], a[12:15], v[168:171]
    buffer_load_dwordx4 v227, s[32:35], s69 offen offset:1024 lds
    s_add_u32 s69, s69, s59
    v_mfma_f32_16x16x32_bf16 v[164:167], a[96:99], a[12:15], v[164:167]
    ds_read_b64_tr_b16 a[2:3], v235 offset:7168
    v_mfma_f32_16x16x32_bf16 v[160:163], a[92:95], a[12:15], v[160:163]
    s_waitcnt lgkmcnt(6)
    v_mfma_f32_16x16x32_bf16 v[176:179], a[92:95], a[16:19], v[176:179]
    ds_read_b64_tr_b16 a[4:5], v236 offset:0
    v_mfma_f32_16x16x32_bf16 v[180:183], a[96:99], a[16:19], v[180:183]
    buffer_load_dwordx4 a[212:215], v224, s[28:31], s53 offen offset:0 sc1
    v_mfma_f32_16x16x32_bf16 v[184:187], a[100:103], a[16:19], v[184:187]
    ds_read_b64_tr_b16 a[6:7], v236 offset:7168
    v_mfma_f32_16x16x32_bf16 v[188:191], a[104:107], a[16:19], v[188:191]
    v_mfma_f32_16x16x32_bf16 a[236:239], a[108:111], a[20:23], a[236:239]
    ds_read_b64_tr_b16 a[8:9], v237 offset:0
    s_waitcnt lgkmcnt(5)
    v_mfma_f32_16x16x32_bf16 v[192:195], a[24:27], a[92:95], v[192:195]
    ds_read_b64_tr_b16 a[10:11], v237 offset:7168
    v_mfma_f32_16x16x32_bf16 v[196:199], a[24:27], a[96:99], v[196:199]
    ds_read_b64_tr_b16 a[12:13], v238 offset:0
    v_mfma_f32_16x16x32_bf16 v[200:203], a[24:27], a[100:103], v[200:203]
    ds_read_b64_tr_b16 a[14:15], v238 offset:7168
    v_mfma_f32_16x16x32_bf16 v[204:207], a[24:27], a[104:107], v[204:207]
    buffer_load_dwordx4 v228, s[40:43], s70 offen offset:2048 lds
    s_add_u32 s70, s70, s61
    v_mfma_f32_16x16x32_bf16 v[220:223], a[28:31], a[104:107], v[220:223]
    ds_read_b64_tr_b16 a[16:17], v235 offset:2048
    v_mfma_f32_16x16x32_bf16 v[216:219], a[28:31], a[100:103], v[216:219]
    buffer_load_dwordx4 a[216:219], v250, s[28:31], s53 offen offset:1024 sc1
    v_mfma_f32_16x16x32_bf16 v[212:215], a[28:31], a[96:99], v[212:215]
    ds_read_b64_tr_b16 a[18:19], v235 offset:9216
    v_mfma_f32_16x16x32_bf16 v[208:211], a[28:31], a[92:95], v[208:211]
    buffer_load_dwordx4 a[220:223], v251, s[28:31], s53 offen offset:2048 sc1
    s_waitcnt lgkmcnt(6)
    v_mfma_f32_16x16x32_bf16 v[0:3], a[0:3], a[112:115], v[0:3]
    ds_read_b64_tr_b16 a[20:21], v248 offset:2048
    v_mfma_f32_16x16x32_bf16 v[4:7], a[0:3], a[116:119], v[4:7]
    ds_read_b64_tr_b16 a[22:23], v248 offset:9216
    v_mfma_f32_16x16x32_bf16 v[8:11], a[0:3], a[120:123], v[8:11]
    v_mfma_f32_16x16x32_bf16 v[12:15], a[0:3], a[124:127], v[12:15]
    v_mfma_f32_16x16x32_bf16 v[28:31], a[4:7], a[124:127], v[28:31]
    ds_read_b64_tr_b16 a[24:25], v236 offset:2048
    v_mfma_f32_16x16x32_bf16 v[24:27], a[4:7], a[120:123], v[24:27]
    buffer_load_dwordx4 a[224:227], v252, s[28:31], s53 offen offset:3072 sc1
    v_mfma_f32_16x16x32_bf16 v[20:23], a[4:7], a[116:119], v[20:23]
    ds_read_b64_tr_b16 a[26:27], v236 offset:9216
    v_mfma_f32_16x16x32_bf16 v[16:19], a[4:7], a[112:115], v[16:19]
    s_waitcnt lgkmcnt(6)
    v_mfma_f32_16x16x32_bf16 v[32:35], a[8:11], a[112:115], v[32:35]
    ds_read_b64_tr_b16 a[28:29], v237 offset:2048
    v_mfma_f32_16x16x32_bf16 v[36:39], a[8:11], a[116:119], v[36:39]
    buffer_load_dwordx4 a[228:231], v225, s[28:31], s53 offen sc1
    v_mfma_f32_16x16x32_bf16 v[40:43], a[8:11], a[120:123], v[40:43]
    ds_read_b64_tr_b16 a[30:31], v237 offset:9216
    v_mfma_f32_16x16x32_bf16 v[44:47], a[8:11], a[124:127], v[44:47]
    v_mfma_f32_16x16x32_bf16 v[60:63], a[12:15], a[124:127], v[60:63]
    ds_read_b64_tr_b16 a[0:1], v238 offset:2048
    s_add_u32 s52, s52, s58
    s_add_u32 s53, s53, s58
    v_mfma_f32_16x16x32_bf16 v[56:59], a[12:15], a[120:123], v[56:59]
    ds_read_b64_tr_b16 a[2:3], v238 offset:9216
    s_add_u32 s56, s56, 1
    s_cmp_eq_u32 s56, 6
    v_mfma_f32_16x16x32_bf16 v[52:55], a[12:15], a[116:119], v[52:55]
    s_cselect_b64 s[36:37], s[18:19], s[36:37]
    s_cselect_b32 s38, s23, s38
    v_mfma_f32_16x16x32_bf16 v[48:51], a[12:15], a[112:115], v[48:51]
    s_cselect_b32 s17, s60, s17
    s_cselect_b32 s71, 1048576, s71
    s_waitcnt lgkmcnt(6)
    v_mfma_f32_16x16x32_bf16 v[64:67], a[16:19], a[112:115], v[64:67]
    ds_read_b64_tr_b16 a[4:5], v235 offset:4096
    s_add_u32 m0, s55, 0
    v_mfma_f32_16x16x32_bf16 v[68:71], a[16:19], a[116:119], v[68:71]
    buffer_load_dword a240, v253, s[36:39], s17 offen
    s_add_u32 s17, s17, s71
    s_lshr_b32 s0, s2, 5
    v_mfma_f32_16x16x32_bf16 v[72:75], a[16:19], a[120:123], v[72:75]
    ds_read_b64_tr_b16 a[6:7], v235 offset:11264
    s_cmp_eq_u32 s0, 1
    s_cselect_b32 s0, s10, s51
    v_mfma_f32_16x16x32_bf16 v[76:79], a[16:19], a[124:127], v[76:79]
    buffer_load_dword a240, v253, s[40:43], s0 offen
    s_cbranch_scc0 L_nosp_27
    s_add_u32 s0, s14, s11
    s_addc_u32 s1, s15, 0
    global_load_dword a240, v253, s[0:1]
L_nosp_27:
    v_mfma_f32_16x16x32_bf16 a[232:235], a[20:23], a[128:131], a[232:235]
    ds_read_b64_tr_b16 a[8:9], v236 offset:4096
    s_waitcnt lgkmcnt(5)
    v_mfma_f32_16x16x32_bf16 v[80:83], a[24:27], a[112:115], v[80:83]
    ds_read_b64_tr_b16 a[10:11], v236 offset:11264
    v_mfma_f32_16x16x32_bf16 v[84:87], a[24:27], a[116:119], v[84:87]
    ds_read_b64_tr_b16 a[12:13], v237 offset:4096
    v_mfma_f32_16x16x32_bf16 v[88:91], a[24:27], a[120:123], v[88:91]
    ds_read_b64_tr_b16 a[14:15], v237 offset:11264
    v_mfma_f32_16x16x32_bf16 v[92:95], a[24:27], a[124:127], v[92:95]
    buffer_load_dwordx4 v227, s[32:35], s64 offen offset:0 lds
    s_add_u32 s64, s64, s59
    v_mfma_f32_16x16x32_bf16 v[108:111], a[28:31], a[124:127], v[108:111]
    ds_read_b64_tr_b16 a[16:17], v238 offset:4096
    v_mfma_f32_16x16x32_bf16 v[104:107], a[28:31], a[120:123], v[104:107]
    buffer_load_dwordx4 a[32:35], v224, s[28:31], s52 offen offset:0 sc1
    v_mfma_f32_16x16x32_bf16 v[100:103], a[28:31], a[116:119], v[100:103]
    ds_read_b64_tr_b16 a[18:19], v238 offset:11264
    v_mfma_f32_16x16x32_bf16 v[96:99], a[28:31], a[112:115], v[96:99]
    s_waitcnt lgkmcnt(6)
    v_mfma_f32_16x16x32_bf16 v[112:115], a[0:3], a[112:115], v[112:115]
    ds_read_b64_tr_b16 a[20:21], v248 offset:4096
    v_mfma_f32_16x16x32_bf16 v[116:119], a[0:3], a[116:119], v[116:119]
    buffer_load_dwordx4 v227, s[32:35], s65 offen offset:1024 lds
    s_add_u32 s65, s65, s59
    v_mfma_f32_16x16x32_bf16 v[120:123], a[0:3], a[120:123], v[120:123]
    ds_read_b64_tr_b16 a[22:23], v248 offset:11264
    v_mfma_f32_16x16x32_bf16 v[124:127], a[0:3], a[124:127], v[124:127]
    v_mfma_f32_16x16x32_bf16 v[140:143], a[124:127], a[4:7], v[140:143]
    ds_read_b64_tr_b16 a[24:25], v239 offset:6144
    v_mfma_f32_16x16x32_bf16 v[136:139], a[120:123], a[4:7], v[136:139]
    buffer_load_dwordx4 a[36:39], v250, s[28:31], s52 offen offset:1024 sc1
    v_mfma_f32_16x16x32_bf16 v[132:135], a[116:119], a[4:7], v[132:135]
    ds_read_b64_tr_b16 a[26:27], v239 offset:13312
    v_mfma_f32_16x16x32_bf16 v[128:131], a[112:115], a[4:7], v[128:131]
    s_waitcnt lgkmcnt(6)
    v_mfma_f32_16x16x32_bf16 v[144:147], a[112:115], a[8:11], v[144:147]
    ds_read_b64_tr_b16 a[28:29], v240 offset:6144
    v_mfma_f32_16x16x32_bf16 v[148:151], a[116:119], a[8:11], v[148:151]
    ds_read_b64_tr_b16 a[30:31], v240 offset:13312
    v_mfma_f32_16x16x32_bf16 v[152:155], a[120:123], a[8:11], v[152:155]
    v_mfma_f32_16x16x32_bf16 v[156:159], a[124:127], a[8:11], v[156:159]
    v_mfma_f32_16x16x32_bf16 v[172:175], a[124:127], a[12:15], v[172:175]
    ds_read_b64_tr_b16 a[0:1], v235 offset:14336
    v_mfma_f32_16x16x32_bf16 v[168:171], a[120:123], a[12:15], v[168:171]
    buffer_load_dwordx4 v227, s[32:35], s66 offen offset:2048 lds
    s_add_u32 s66, s66, s59
    v_mfma_f32_16x16x32_bf16 v[164:167], a[116:119], a[12:15], v[164:167]
    ds_read_b64_tr_b16 a[2:3], v235 offset:21504
    v_mfma_f32_16x16x32_bf16 v[160:163], a[112:115], a[12:15], v[160:163]
    s_waitcnt lgkmcnt(6)
    v_mfma_f32_16x16x32_bf16 v[176:179], a[112:115], a[16:19], v[176:179]
    ds_read_b64_tr_b16 a[4:5], v236 offset:14336
    v_mfma_f32_16x16x32_bf16 v[180:183], a[116:119], a[16:19], v[180:183]
    buffer_load_dwordx4 a[40:43], v251, s[28:31], s52 offen offset:2048 sc1
    v_mfma_f32_16x16x32_bf16 v[184:187], a[120:123], a[16:19], v[184:187]
    ds_read_b64_tr_b16 a[6:7], v236 offset:21504
    v_mfma_f32_16x16x32_bf16 v[188:191], a[124:127], a[16:19], v[188:191]
    v_mfma_f32_16x16x32_bf16 a[236:239], a[128:131], a[20:23], a[236:239]
    ds_read_b64_tr_b16 a[8:9], v237 offset:14336
    s_waitcnt lgkmcnt(5)
    v_mfma_f32_16x16x32_bf16 v[192:195], a[24:27], a[112:115], v[192:195]
    ds_read_b64_tr_b16 a[10:11], v237 offset:21504
    v_mfma_f32_16x16x32_bf16 v[196:199], a[24:27], a[116:119], v[196:199]
    ds_read_b64_tr_b16 a[12:13], v238 offset:14336
    v_mfma_f32_16x16x32_bf16 v[200:203], a[24:27], a[120:123], v[200:203]
    ds_read_b64_tr_b16 a[14:15], v238 offset:21504
    v_mfma_f32_16x16x32_bf16 v[204:207], a[24:27], a[124:127], v[204:207]
    buffer_load_dwordx4 v227, s[32:35], s67 offen offset:3072 lds
    s_add_u32 s67, s67, s59
    v_mfma_f32_16x16x32_bf16 v[220:223], a[28:31], a[124:127], v[220:223]
    ds_read_b64_tr_b16 a[16:17], v235 offset:16384
    v_mfma_f32_16x16x32_bf16 v[216:219], a[28:31], a[120:123], v[216:219]
    buffer_load_dwordx4 a[44:47], v252, s[28:31], s52 offen offset:3072 sc1
    s_add_u32 m0, s55, 4096
    v_mfma_f32_16x16x32_bf16 v[212:215], a[28:31], a[116:119], v[212:215]
    ds_read_b64_tr_b16 a[18:19], v235 offset:23552
    v_mfma_f32_16x16x32_bf16 v[208:211], a[28:31], a[112:115], v[208:211]
    buffer_load_dwordx4 v227, s[32:35], s68 offen offset:0 lds
    s_add_u32 s68, s68, s59
    s_waitcnt lgkmcnt(6)
    v_mfma_f32_16x16x32_bf16 v[0:3], a[0:3], a[132:135], v[0:3]
    ds_read_b64_tr_b16 a[20:21], v248 offset:16384
    v_mfma_f32_16x16x32_bf16 v[4:7], a[0:3], a[136:139], v[4:7]
    ds_read_b64_tr_b16 a[22:23], v248 offset:23552
    v_mfma_f32_16x16x32_bf16 v[8:11], a[0:3], a[140:143], v[8:11]
    v_mfma_f32_16x16x32_bf16 v[12:15], a[0:3], a[144:147], v[12:15]
    v_mfma_f32_16x16x32_bf16 v[28:31], a[4:7], a[144:147], v[28:31]
    ds_read_b64_tr_b16 a[24:25], v236 offset:16384
    v_mfma_f32_16x16x32_bf16 v[24:27], a[4:7], a[140:143], v[24:27]
    buffer_load_dwordx4 a[48:51], v225, s[28:31], s52 offen sc1
    v_mfma_f32_16x16x32_bf16 v[20:23], a[4:7], a[136:139], v[20:23]
    ds_read_b64_tr_b16 a[26:27], v236 offset:23552
    v_mfma_f32_16x16x32_bf16 v[16:19], a[4:7], a[132:135], v[16:19]
    s_waitcnt lgkmcnt(6)
    v_mfma_f32_16x16x32_bf16 v[32:35], a[8:11], a[132:135], v[32:35]
    ds_read_b64_tr_b16 a[28:29], v237 offset:16384
    v_mfma_f32_16x16x32_bf16 v[36:39], a[8:11], a[136:139], v[36:39]
    buffer_load_dwordx4 v227, s[32:35], s69 offen offset:1024 lds
    s_add_u32 s69, s69, s59
    v_mfma_f32_16x16x32_bf16 v[40:43], a[8:11], a[140:143], v[40:43]
    ds_read_b64_tr_b16 a[30:31], v237 offset:23552
    v_mfma_f32_16x16x32_bf16 v[44:47], a[8:11], a[144:147], v[44:47]
    v_mfma_f32_16x16x32_bf16 v[60:63], a[12:15], a[144:147], v[60:63]
    ds_read_b64_tr_b16 a[0:1], v238 offset:16384
    v_mfma_f32_16x16x32_bf16 v[56:59], a[12:15], a[140:143], v[56:59]
    buffer_load_dwordx4 a[52:55], v224, s[28:31], s53 offen offset:0 sc1
    v_mfma_f32_16x16x32_bf16 v[52:55], a[12:15], a[136:139], v[52:55]
    ds_read_b64_tr_b16 a[2:3], v238 offset:23552
    v_mfma_f32_16x16x32_bf16 v[48:51], a[12:15], a[132:135], v[48:51]
    s_waitcnt lgkmcnt(6)
    v_mfma_f32_16x16x32_bf16 v[64:67], a[16:19], a[132:135], v[64:67]
    ds_read_b64_tr_b16 a[4:5], v235 offset:18432
    v_mfma_f32_16x16x32_bf16 v[68:71], a[16:19], a[136:139], v[68:71]
    buffer_load_dwordx4 v228, s[40:43], s70 offen offset:2048 lds
    s_add_u32 s70, s70, s61
    v_mfma_f32_16x16x32_bf16 v[72:75], a[16:19], a[140:143], v[72:75]
    ds_read_b64_tr_b16 a[6:7], v235 offset:25600
    v_mfma_f32_16x16x32_bf16 v[76:79], a[16:19], a[144:147], v[76:79]
    v_mfma_f32_16x16x32_bf16 a[232:235], a[20:23], a[148:151], a[232:235]
    ds_read_b64_tr_b16 a[8:9], v236 offset:18432
    s_waitcnt lgkmcnt(5)
    v_mfma_f32_16x16x32_bf16 v[80:83], a[24:27], a[132:135], v[80:83]
    ds_read_b64_tr_b16 a[10:11], v236 offset:25600
    v_mfma_f32_16x16x32_bf16 v[84:87], a[24:27], a[136:139], v[84:87]
    ds_read_b64_tr_b16 a[12:13], v237 offset:18432
    v_mfma_f32_16x16x32_bf16 v[88:91], a[24:27], a[140:143], v[88:91]
    ds_read_b64_tr_b16 a[14:15], v237 offset:25600
    v_mfma_f32_16x16x32_bf16 v[92:95], a[24:27], a[144:147], v[92:95]
    buffer_load_dwordx4 a[56:59], v250, s[28:31], s53 offen offset:1024 sc1
    v_mfma_f32_16x16x32_bf16 v[108:111], a[28:31], a[144:147], v[108:111]
    ds_read_b64_tr_b16 a[16:17], v238 offset:18432
    v_mfma_f32_16x16x32_bf16 v[104:107], a[28:31], a[140:143], v[104:107]
    buffer_load_dwordx4 a[60:63], v251, s[28:31], s53 offen offset:2048 sc1
    v_mfma_f32_16x16x32_bf16 v[100:103], a[28:31], a[136:139], v[100:103]
    ds_read_b64_tr_b16 a[18:19], v238 offset:25600
    v_mfma_f32_16x16x32_bf16 v[96:99], a[28:31], a[132:135], v[96:99]
    s_waitcnt lgkmcnt(6)
    v_mfma_f32_16x16x32_bf16 v[112:115], a[0:3], a[132:135], v[112:115]
    ds_read_b64_tr_b16 a[20:21], v248 offset:18432
    v_mfma_f32_16x16x32_bf16 v[116:119], a[0:3], a[136:139], v[116:119]
    buffer_load_dwordx4 a[64:67], v252, s[28:31], s53 offen offset:3072 sc1
    v_mfma_f32_16x16x32_bf16 v[120:123], a[0:3], a[140:143], v[120:123]
    ds_read_b64_tr_b16 a[22:23], v248 offset:25600
    v_mfma_f32_16x16x32_bf16 v[124:127], a[0:3], a[144:147], v[124:127]
    v_mfma_f32_16x16x32_bf16 v[140:143], a[144:147], a[4:7], v[140:143]
    ds_read_b64_tr_b16 a[24:25], v239 offset:20480
    v_mfma_f32_16x16x32_bf16 v[136:139], a[140:143], a[4:7], v[136:139]
    buffer_load_dwordx4 a[68:71], v225, s[28:31], s53 offen sc1
    v_mfma_f32_16x16x32_bf16 v[132:135], a[136:139], a[4:7], v[132:135]
    ds_read_b64_tr_b16 a[26:27], v239 offset:27648
    v_mfma_f32_16x16x32_bf16 v[128:131], a[132:135], a[4:7], v[128:131]
    s_waitcnt lgkmcnt(6)
    v_mfma_f32_16x16x32_bf16 v[144:147], a[132:135], a[8:11], v[144:147]
    ds_read_b64_tr_b16 a[28:29], v240 offset:20480
    v_mfma_f32_16x16x32_bf16 v[148:151], a[136:139], a[8:11], v[148:151]
    ds_read_b64_tr_b16 a[30:31], v240 offset:27648
    v_mfma_f32_16x16x32_bf16 v[152:155], a[140:143], a[8:11], v[152:155]
    v_mfma_f32_16x16x32_bf16 v[156:159], a[144:147], a[8:11], v[156:159]
    s_waitcnt vmcnt(37)
    s_barrier
    v_mfma_f32_16x16x32_bf16 v[172:175], a[144:147], a[12:15], v[172:175]
    ds_read_b64_tr_b16 a[0:1], v235 offset:28672
    s_add_u32 s52, s52, s58
    s_add_u32 s53, s53, s58
    v_mfma_f32_16x16x32_bf16 v[168:171], a[140:143], a[12:15], v[168:171]
    s_add_u32 s56, s56, 1
    s_add_u32 m0, s55, 28672
    buffer_load_dword a240, v253, s[36:39], s17 offen
    v_mfma_f32_16x16x32_bf16 v[164:167], a[136:139], a[12:15], v[164:167]
    ds_read_b64_tr_b16 a[2:3], v235 offset:35840
    s_add_u32 s17, s17, s71
    v_mfma_f32_16x16x32_bf16 v[160:163], a[132:135], a[12:15], v[160:163]
    s_waitcnt lgkmcnt(6)
    v_mfma_f32_16x16x32_bf16 v[176:179], a[132:135], a[16:19], v[176:179]
    ds_read_b64_tr_b16 a[4:5], v236 offset:28672
    s_lshr_b32 s0, s2, 5
    s_cmp_eq_u32 s0, 2
    v_mfma_f32_16x16x32_bf16 v[180:183], a[136:139], a[16:19], v[180:183]
    s_cselect_b32 s0, s10, s51
    buffer_load_dword a240, v253, s[40:43], s0 offen
    s_cbranch_scc0 L_nosp_28
    s_add_u32 s0, s14, s11
    s_addc_u32 s1, s15, 0
    global_load_dword a240, v253, s[0:1]
L_nosp_28:
    v_mfma_f32_16x16x32_bf16 v[184:187], a[140:143], a[16:19], v[184:187]
    ds_read_b64_tr_b16 a[6:7], v236 offset:35840
    v_mfma_f32_16x16x32_bf16 v[188:191], a[144:147], a[16:19], v[188:191]
    v_mfma_f32_16x16x32_bf16 a[236:239], a[148:151], a[20:23], a[236:239]
    ds_read_b64_tr_b16 a[8:9], v237 offset:28672
    s_waitcnt lgkmcnt(5)
    v_mfma_f32_16x16x32_bf16 v[192:195], a[24:27], a[132:135], v[192:195]
    ds_read_b64_tr_b16 a[10:11], v237 offset:35840
    v_mfma_f32_16x16x32_bf16 v[196:199], a[24:27], a[136:139], v[196:199]
    ds_read_b64_tr_b16 a[12:13], v238 offset:28672
    v_mfma_f32_16x16x32_bf16 v[200:203], a[24:27], a[140:143], v[200:203]
    ds_read_b64_tr_b16 a[14:15], v238 offset:35840
    v_mfma_f32_16x16x32_bf16 v[204:207], a[24:27], a[144:147], v[204:207]
    buffer_load_dwordx4 v227, s[32:35], s64 offen offset:0 lds
    s_add_u32 s64, s64, s59
    v_mfma_f32_16x16x32_bf16 v[220:223], a[28:31], a[144:147], v[220:223]
    ds_read_b64_tr_b16 a[16:17], v235 offset:30720
    v_mfma_f32_16x16x32_bf16 v[216:219], a[28:31], a[140:143], v[216:219]
    ds_read_b64_tr_b16 a[18:19], v235 offset:37888
    v_mfma_f32_16x16x32_bf16 v[212:215], a[28:31], a[136:139], v[212:215]
    v_mfma_f32_16x16x32_bf16 v[208:211], a[28:31], a[132:135], v[208:211]
    s_waitcnt lgkmcnt(6)
    v_mfma_f32_16x16x32_bf16 v[0:3], a[0:3], a[152:155], v[0:3]
    ds_read_b64_tr_b16 a[20:21], v248 offset:30720
    v_mfma_f32_16x16x32_bf16 v[4:7], a[0:3], a[156:159], v[4:7]
    buffer_load_dwordx4 a[72:75], v224, s[28:31], s52 offen offset:0 sc1
    v_mfma_f32_16x16x32_bf16 v[8:11], a[0:3], a[160:163], v[8:11]
    ds_read_b64_tr_b16 a[22:23], v248 offset:37888
    v_mfma_f32_16x16x32_bf16 v[12:15], a[0:3], a[164:167], v[12:15]
    v_mfma_f32_16x16x32_bf16 v[28:31], a[4:7], a[164:167], v[28:31]
    ds_read_b64_tr_b16 a[24:25], v236 offset:30720
    v_mfma_f32_16x16x32_bf16 v[24:27], a[4:7], a[160:163], v[24:27]
    buffer_load_dwordx4 v227, s[32:35], s65 offen offset:1024 lds
    s_add_u32 s65, s65, s59
    v_mfma_f32_16x16x32_bf16 v[20:23], a[4:7], a[156:159], v[20:23]
    ds_read_b64_tr_b16 a[26:27], v236 offset:37888
    v_mfma_f32_16x16x32_bf16 v[16:19], a[4:7], a[152:155], v[16:19]
    s_waitcnt lgkmcnt(6)
    v_mfma_f32_16x16x32_bf16 v[32:35], a[8:11], a[152:155], v[32:35]
    ds_read_b64_tr_b16 a[28:29], v237 offset:30720
    v_mfma_f32_16x16x32_bf16 v[36:39], a[8:11], a[156:159], v[36:39]
    ds_read_b64_tr_b16 a[30:31], v237 offset:37888
    v_mfma_f32_16x16x32_bf16 v[40:43], a[8:11], a[160:163], v[40:43]
    v_mfma_f32_16x16x32_bf16 v[44:47], a[8:11], a[164:167], v[44:47]
    v_mfma_f32_16x16x32_bf16 v[60:63], a[12:15], a[164:167], v[60:63]
    ds_read_b64_tr_b16 a[0:1], v238 offset:30720
    v_mfma_f32_16x16x32_bf16 v[56:59], a[12:15], a[160:163], v[56:59]
    buffer_load_dwordx4 a[76:79], v250, s[28:31], s52 offen offset:1024 sc1
    v_mfma_f32_16x16x32_bf16 v[52:55], a[12:15], a[156:159], v[52:55]
    ds_read_b64_tr_b16 a[2:3], v238 offset:37888
    v_mfma_f32_16x16x32_bf16 v[48:51], a[12:15], a[152:155], v[48:51]
    s_waitcnt lgkmcnt(6)
    v_mfma_f32_16x16x32_bf16 v[64:67], a[16:19], a[152:155], v[64:67]
    ds_read_b64_tr_b16 a[4:5], v235 offset:32768
    v_mfma_f32_16x16x32_bf16 v[68:71], a[16:19], a[156:159], v[68:71]
    ds_read_b64_tr_b16 a[6:7], v235 offset:39936
    v_mfma_f32_16x16x32_bf16 v[72:75], a[16:19], a[160:163], v[72:75]
    v_mfma_f32_16x16x32_bf16 v[76:79], a[16:19], a[164:167], v[76:79]
    v_mfma_f32_16x16x32_bf16 a[232:235], a[20:23], a[168:171], a[232:235]
    ds_read_b64_tr_b16 a[8:9], v236 offset:32768
    s_waitcnt lgkmcnt(5)
    v_mfma_f32_16x16x32_bf16 v[80:83], a[24:27], a[152:155], v[80:83]
    ds_read_b64_tr_b16 a[10:11], v236 offset:39936
    v_mfma_f32_16x16x32_bf16 v[84:87], a[24:27], a[156:159], v[84:87]
    ds_read_b64_tr_b16 a[12:13], v237 offset:32768
    v_mfma_f32_16x16x32_bf16 v[88:91], a[24:27], a[160:163], v[88:91]
    ds_read_b64_tr_b16 a[14:15], v237 offset:39936
    v_mfma_f32_16x16x32_bf16 v[92:95], a[24:27], a[164:167], v[92:95]
    buffer_load_dwordx4 v227, s[32:35], s66 offen offset:2048 lds
    s_add_u32 s66, s66, s59
    v_mfma_f32_16x16x32_bf16 v[108:111], a[28:31], a[164:167], v[108:111]
    ds_read_b64_tr_b16 a[16:17], v238 offset:32768
    v_mfma_f32_16x16x32_bf16 v[104:107], a[28:31], a[160:163], v[104:107]
    buffer_load_dwordx4 a[80:83], v251, s[28:31], s52 offen offset:2048 sc1
    v_mfma_f32_16x16x32_bf16 v[100:103], a[28:31], a[156:159], v[100:103]
    ds_read_b64_tr_b16 a[18:19], v238 offset:39936
    v_mfma_f32_16x16x32_bf16 v[96:99], a[28:31], a[152:155], v[96:99]
    s_waitcnt lgkmcnt(6)
    v_mfma_f32_16x16x32_bf16 v[112:115], a[0:3], a[152:155], v[112:115]
    ds_read_b64_tr_b16 a[20:21], v248 offset:32768
    v_mfma_f32_16x16x32_bf16 v[116:119], a[0:3], a[156:159], v[116:119]
    buffer_load_dwordx4 v227, s[32:35], s67 offen offset:3072 lds
    s_add_u32 s67, s67, s59
    v_mfma_f32_16x16x32_bf16 v[120:123], a[0:3], a[160:163], v[120:123]
    ds_read_b64_tr_b16 a[22:23], v248 offset:39936
    v_mfma_f32_16x16x32_bf16 v[124:127], a[0:3], a[164:167], v[124:127]
    v_mfma_f32_16x16x32_bf16 v[140:143], a[164:167], a[4:7], v[140:143]
    ds_read_b64_tr_b16 a[24:25], v239 offset:34816
    v_mfma_f32_16x16x32_bf16 v[136:139], a[160:163], a[4:7], v[136:139]
    ds_read_b64_tr_b16 a[26:27], v239 offset:41984
    v_mfma_f32_16x16x32_bf16 v[132:135], a[156:159], a[4:7], v[132:135]
    v_mfma_f32_16x16x32_bf16 v[128:131], a[152:155], a[4:7], v[128:131]
    s_waitcnt lgkmcnt(6)
    v_mfma_f32_16x16x32_bf16 v[144:147], a[152:155], a[8:11], v[144:147]
    ds_read_b64_tr_b16 a[28:29], v240 offset:34816
    v_mfma_f32_16x16x32_bf16 v[148:151], a[156:159], a[8:11], v[148:151]
    buffer_load_dwordx4 a[84:87], v252, s[28:31], s52 offen offset:3072 sc1
    v_mfma_f32_16x16x32_bf16 v[152:155], a[160:163], a[8:11], v[152:155]
    ds_read_b64_tr_b16 a[30:31], v240 offset:41984
    v_mfma_f32_16x16x32_bf16 v[156:159], a[164:167], a[8:11], v[156:159]
    v_mfma_f32_16x16x32_bf16 v[172:175], a[164:167], a[12:15], v[172:175]
    ds_read_b64_tr_b16 a[0:1], v235 offset:43008
    s_add_u32 m0, s55, 32768
    v_mfma_f32_16x16x32_bf16 v[168:171], a[160:163], a[12:15], v[168:171]
    buffer_load_dwordx4 v227, s[32:35], s68 offen offset:0 lds
    s_add_u32 s68, s68, s59
    v_mfma_f32_16x16x32_bf16 v[164:167], a[156:159], a[12:15], v[164:167]
    ds_read_b64_tr_b16 a[2:3], v235 offset:50176
    v_mfma_f32_16x16x32_bf16 v[160:163], a[152:155], a[12:15], v[160:163]
    s_waitcnt lgkmcnt(6)
    v_mfma_f32_16x16x32_bf16 v[176:179], a[152:155], a[16:19], v[176:179]
    ds_read_b64_tr_b16 a[4:5], v236 offset:43008
    v_mfma_f32_16x16x32_bf16 v[180:183], a[156:159], a[16:19], v[180:183]
    s_branch L_po_q_2
.p2align 12
L_pg_q_2:
    s_branch L_pg_q_5
L_po_q_2:
    ds_read_b64_tr_b16 a[6:7], v236 offset:50176
    v_mfma_f32_16x16x32_bf16 v[184:187], a[160:163], a[16:19], v[184:187]
    v_mfma_f32_16x16x32_bf16 v[188:191], a[164:167], a[16:19], v[188:191]
    v_mfma_f32_16x16x32_bf16 a[236:239], a[168:171], a[20:23], a[236:239]
    ds_read_b64_tr_b16 a[8:9], v237 offset:43008
    s_waitcnt lgkmcnt(5)
    v_mfma_f32_16x16x32_bf16 v[192:195], a[24:27], a[152:155], v[192:195]
    ds_read_b64_tr_b16 a[10:11], v237 offset:50176
    v_mfma_f32_16x16x32_bf16 v[196:199], a[24:27], a[156:159], v[196:199]
    ds_read_b64_tr_b16 a[12:13], v238 offset:43008
    v_mfma_f32_16x16x32_bf16 v[200:203], a[24:27], a[160:163], v[200:203]
    ds_read_b64_tr_b16 a[14:15], v238 offset:50176
    v_mfma_f32_16x16x32_bf16 v[204:207], a[24:27], a[164:167], v[204:207]
    buffer_load_dwordx4 a[88:91], v225, s[28:31], s52 offen sc1
    v_mfma_f32_16x16x32_bf16 v[220:223], a[28:31], a[164:167], v[220:223]
    ds_read_b64_tr_b16 a[16:17], v235 offset:45056
    v_mfma_f32_16x16x32_bf16 v[216:219], a[28:31], a[160:163], v[216:219]
    buffer_load_dwordx4 v227, s[32:35], s69 offen offset:1024 lds
    s_add_u32 s69, s69, s59
    v_mfma_f32_16x16x32_bf16 v[212:215], a[28:31], a[156:159], v[212:215]
    ds_read_b64_tr_b16 a[18:19], v235 offset:52224
    v_mfma_f32_16x16x32_bf16 v[208:211], a[28:31], a[152:155], v[208:211]
    s_waitcnt lgkmcnt(6)
    v_mfma_f32_16x16x32_bf16 v[0:3], a[0:3], a[172:175], v[0:3]
    ds_read_b64_tr_b16 a[20:21], v248 offset:45056
    v_mfma_f32_16x16x32_bf16 v[4:7], a[0:3], a[176:179], v[4:7]
    buffer_load_dwordx4 a[92:95], v224, s[28:31], s53 offen offset:0 sc1
    v_mfma_f32_16x16x32_bf16 v[8:11], a[0:3], a[180:183], v[8:11]
    ds_read_b64_tr_b16 a[22:23], v248 offset:52224
    v_mfma_f32_16x16x32_bf16 v[12:15], a[0:3], a[184:187], v[12:15]
    v_mfma_f32_16x16x32_bf16 v[28:31], a[4:7], a[184:187], v[28:31]
    ds_read_b64_tr_b16 a[24:25], v236 offset:45056
    v_mfma_f32_16x16x32_bf16 v[24:27], a[4:7], a[180:183], v[24:27]
    ds_read_b64_tr_b16 a[26:27], v236 offset:52224
    v_mfma_f32_16x16x32_bf16 v[20:23], a[4:7], a[176:179], v[20:23]
    v_mfma_f32_16x16x32_bf16 v[16:19], a[4:7], a[172:175], v[16:19]
    s_waitcnt lgkmcnt(6)
    v_mfma_f32_16x16x32_bf16 v[32:35], a[8:11], a[172:175], v[32:35]
    ds_read_b64_tr_b16 a[28:29], v237 offset:45056
    v_mfma_f32_16x16x32_bf16 v[36:39], a[8:11], a[176:179], v[36:39]
    buffer_load_dwordx4 v228, s[40:43], s70 offen offset:2048 lds
    s_add_u32 s70, s70, s61
    v_mfma_f32_16x16x32_bf16 v[40:43], a[8:11], a[180:183], v[40:43]
    ds_read_b64_tr_b16 a[30:31], v237 offset:52224
    v_mfma_f32_16x16x32_bf16 v[44:47], a[8:11], a[184:187], v[44:47]
    v_mfma_f32_16x16x32_bf16 v[60:63], a[12:15], a[184:187], v[60:63]
    ds_read_b64_tr_b16 a[0:1], v238 offset:45056
    v_mfma_f32_16x16x32_bf16 v[56:59], a[12:15], a[180:183], v[56:59]
    ds_read_b64_tr_b16 a[2:3], v238 offset:52224
    v_mfma_f32_16x16x32_bf16 v[52:55], a[12:15], a[176:179], v[52:55]
    v_mfma_f32_16x16x32_bf16 v[48:51], a[12:15], a[172:175], v[48:51]
    s_waitcnt lgkmcnt(6)
    v_mfma_f32_16x16x32_bf16 v[64:67], a[16:19], a[172:175], v[64:67]
    ds_read_b64_tr_b16 a[4:5], v235 offset:47104
    v_mfma_f32_16x16x32_bf16 v[68:71], a[16:19], a[176:179], v[68:71]
    buffer_load_dwordx4 a[96:99], v250, s[28:31], s53 offen offset:1024 sc1
    v_mfma_f32_16x16x32_bf16 v[72:75], a[16:19], a[180:183], v[72:75]
    ds_read_b64_tr_b16 a[6:7], v235 offset:54272
    v_mfma_f32_16x16x32_bf16 v[76:79], a[16:19], a[184:187], v[76:79]
    v_mfma_f32_16x16x32_bf16 a[232:235], a[20:23], a[188:191], a[232:235]
    ds_read_b64_tr_b16 a[8:9], v236 offset:47104
    s_waitcnt lgkmcnt(5)
    v_mfma_f32_16x16x32_bf16 v[80:83], a[24:27], a[172:175], v[80:83]
    ds_read_b64_tr_b16 a[10:11], v236 offset:54272
    v_mfma_f32_16x16x32_bf16 v[84:87], a[24:27], a[176:179], v[84:87]
    ds_read_b64_tr_b16 a[12:13], v237 offset:47104
    v_mfma_f32_16x16x32_bf16 v[88:91], a[24:27], a[180:183], v[88:91]
    ds_read_b64_tr_b16 a[14:15], v237 offset:54272
    v_mfma_f32_16x16x32_bf16 v[92:95], a[24:27], a[184:187], v[92:95]
    buffer_load_dwordx4 a[100:103], v251, s[28:31], s53 offen offset:2048 sc1
    v_mfma_f32_16x16x32_bf16 v[108:111], a[28:31], a[184:187], v[108:111]
    ds_read_b64_tr_b16 a[16:17], v238 offset:47104
    v_mfma_f32_16x16x32_bf16 v[104:107], a[28:31], a[180:183], v[104:107]
    buffer_load_dwordx4 a[104:107], v252, s[28:31], s53 offen offset:3072 sc1
    v_mfma_f32_16x16x32_bf16 v[100:103], a[28:31], a[176:179], v[100:103]
    ds_read_b64_tr_b16 a[18:19], v238 offset:54272
    v_mfma_f32_16x16x32_bf16 v[96:99], a[28:31], a[172:175], v[96:99]
    s_waitcnt lgkmcnt(6)
    v_mfma_f32_16x16x32_bf16 v[112:115], a[0:3], a[172:175], v[112:115]
    ds_read_b64_tr_b16 a[20:21], v248 offset:47104
    v_mfma_f32_16x16x32_bf16 v[116:119], a[0:3], a[176:179], v[116:119]
    ds_read_b64_tr_b16 a[22:23], v248 offset:54272
    v_mfma_f32_16x16x32_bf16 v[120:123], a[0:3], a[180:183], v[120:123]
    v_mfma_f32_16x16x32_bf16 v[124:127], a[0:3], a[184:187], v[124:127]
    v_mfma_f32_16x16x32_bf16 v[140:143], a[184:187], a[4:7], v[140:143]
    ds_read_b64_tr_b16 a[24:25], v239 offset:49152
    v_mfma_f32_16x16x32_bf16 v[136:139], a[180:183], a[4:7], v[136:139]
    buffer_load_dwordx4 a[108:111], v225, s[28:31], s53 offen sc1
    v_mfma_f32_16x16x32_bf16 v[132:135], a[176:179], a[4:7], v[132:135]
    ds_read_b64_tr_b16 a[26:27], v239 offset:56320
    v_mfma_f32_16x16x32_bf16 v[128:131], a[172:175], a[4:7], v[128:131]
    s_waitcnt lgkmcnt(6)
    v_mfma_f32_16x16x32_bf16 v[144:147], a[172:175], a[8:11], v[144:147]
    ds_read_b64_tr_b16 a[28:29], v240 offset:49152
    v_mfma_f32_16x16x32_bf16 v[148:151], a[176:179], a[8:11], v[148:151]
    ds_read_b64_tr_b16 a[30:31], v240 offset:56320
    v_mfma_f32_16x16x32_bf16 v[152:155], a[180:183], a[8:11], v[152:155]
    v_mfma_f32_16x16x32_bf16 v[156:159], a[184:187], a[8:11], v[156:159]
    s_waitcnt vmcnt(38)
    s_barrier
    v_mfma_f32_16x16x32_bf16 v[172:175], a[184:187], a[12:15], v[172:175]
    ds_read_b64_tr_b16 a[0:1], v241 offset:0
    s_add_u32 s52, s52, s58
    s_add_u32 s53, s53, s58
    v_mfma_f32_16x16x32_bf16 v[168:171], a[180:183], a[12:15], v[168:171]
    s_add_u32 s56, s56, 1
    s_add_u32 m0, s55, 57344
    buffer_load_dword a240, v253, s[36:39], s17 offen
    v_mfma_f32_16x16x32_bf16 v[164:167], a[176:179], a[12:15], v[164:167]
    ds_read_b64_tr_b16 a[2:3], v241 offset:7168
    s_add_u32 s17, s17, s71
    v_mfma_f32_16x16x32_bf16 v[160:163], a[172:175], a[12:15], v[160:163]
    s_waitcnt lgkmcnt(6)
    v_mfma_f32_16x16x32_bf16 v[176:179], a[172:175], a[16:19], v[176:179]
    ds_read_b64_tr_b16 a[4:5], v242 offset:0
    s_lshr_b32 s0, s2, 5
    s_cmp_eq_u32 s0, 0
    v_mfma_f32_16x16x32_bf16 v[180:183], a[176:179], a[16:19], v[180:183]
    s_cselect_b32 s0, s10, s51
    buffer_load_dword a240, v253, s[32:35], s0 offen
    s_cbranch_scc0 L_nosp_26
    s_add_u32 s0, s14, s11
    s_addc_u32 s1, s15, 0
    global_load_dword a240, v253, s[0:1]
L_nosp_26:
    v_mfma_f32_16x16x32_bf16 v[184:187], a[180:183], a[16:19], v[184:187]
    ds_read_b64_tr_b16 a[6:7], v242 offset:7168
    v_mfma_f32_16x16x32_bf16 v[188:191], a[184:187], a[16:19], v[188:191]
    v_mfma_f32_16x16x32_bf16 a[236:239], a[188:191], a[20:23], a[236:239]
    ds_read_b64_tr_b16 a[8:9], v243 offset:0
    s_waitcnt lgkmcnt(5)
    v_mfma_f32_16x16x32_bf16 v[192:195], a[24:27], a[172:175], v[192:195]
    ds_read_b64_tr_b16 a[10:11], v243 offset:7168
    v_mfma_f32_16x16x32_bf16 v[196:199], a[24:27], a[176:179], v[196:199]
    ds_read_b64_tr_b16 a[12:13], v244 offset:0
    v_mfma_f32_16x16x32_bf16 v[200:203], a[24:27], a[180:183], v[200:203]
    ds_read_b64_tr_b16 a[14:15], v244 offset:7168
    v_mfma_f32_16x16x32_bf16 v[204:207], a[24:27], a[184:187], v[204:207]
    buffer_load_dwordx4 v227, s[32:35], s64 offen offset:0 lds
    s_add_u32 s64, s64, s59
    v_mfma_f32_16x16x32_bf16 v[220:223], a[28:31], a[184:187], v[220:223]
    ds_read_b64_tr_b16 a[16:17], v241 offset:2048
    v_mfma_f32_16x16x32_bf16 v[216:219], a[28:31], a[180:183], v[216:219]
    ds_read_b64_tr_b16 a[18:19], v241 offset:9216
    v_mfma_f32_16x16x32_bf16 v[212:215], a[28:31], a[176:179], v[212:215]
    v_mfma_f32_16x16x32_bf16 v[208:211], a[28:31], a[172:175], v[208:211]
    s_waitcnt lgkmcnt(6)
    v_mfma_f32_16x16x32_bf16 v[0:3], a[0:3], a[192:195], v[0:3]
    ds_read_b64_tr_b16 a[20:21], v249 offset:2048
    v_mfma_f32_16x16x32_bf16 v[4:7], a[0:3], a[196:199], v[4:7]
    buffer_load_dwordx4 a[112:115], v224, s[28:31], s52 offen offset:0 sc1
    v_mfma_f32_16x16x32_bf16 v[8:11], a[0:3], a[200:203], v[8:11]
    ds_read_b64_tr_b16 a[22:23], v249 offset:9216
    v_mfma_f32_16x16x32_bf16 v[12:15], a[0:3], a[204:207], v[12:15]
    v_mfma_f32_16x16x32_bf16 v[28:31], a[4:7], a[204:207], v[28:31]
    ds_read_b64_tr_b16 a[24:25], v242 offset:2048
    v_mfma_f32_16x16x32_bf16 v[24:27], a[4:7], a[200:203], v[24:27]
    buffer_load_dwordx4 v227, s[32:35], s65 offen offset:1024 lds
    s_add_u32 s65, s65, s59
    v_mfma_f32_16x16x32_bf16 v[20:23], a[4:7], a[196:199], v[20:23]
    ds_read_b64_tr_b16 a[26:27], v242 offset:9216
    v_mfma_f32_16x16x32_bf16 v[16:19], a[4:7], a[192:195], v[16:19]
    s_waitcnt lgkmcnt(6)
    v_mfma_f32_16x16x32_bf16 v[32:35], a[8:11], a[192:195], v[32:35]
    ds_read_b64_tr_b16 a[28:29], v243 offset:2048
    v_mfma_f32_16x16x32_bf16 v[36:39], a[8:11], a[196:199], v[36:39]
    ds_read_b64_tr_b16 a[30:31], v243 offset:9216
    v_mfma_f32_16x16x32_bf16 v[40:43], a[8:11], a[200:203], v[40:43]
    v_mfma_f32_16x16x32_bf16 v[44:47], a[8:11], a[204:207], v[44:47]
    v_mfma_f32_16x16x32_bf16 v[60:63], a[12:15], a[204:207], v[60:63]
    ds_read_b64_tr_b16 a[0:1], v244 offset:2048
    v_mfma_f32_16x16x32_bf16 v[56:59], a[12:15], a[200:203], v[56:59]
    buffer_load_dwordx4 a[116:119], v250, s[28:31], s52 offen offset:1024 sc1
    v_mfma_f32_16x16x32_bf16 v[52:55], a[12:15], a[196:199], v[52:55]
    ds_read_b64_tr_b16 a[2:3], v244 offset:9216
    v_mfma_f32_16x16x32_bf16 v[48:51], a[12:15], a[192:195], v[48:51]
    s_waitcnt lgkmcnt(6)
    v_mfma_f32_16x16x32_bf16 v[64:67], a[16:19], a[192:195], v[64:67]
    ds_read_b64_tr_b16 a[4:5], v241 offset:4096
    v_mfma_f32_16x16x32_bf16 v[68:71], a[16:19], a[196:199], v[68:71]
    ds_read_b64_tr_b16 a[6:7], v241 offset:11264
    v_mfma_f32_16x16x32_bf16 v[72:75], a[16:19], a[200:203], v[72:75]
    v_mfma_f32_16x16x32_bf16 v[76:79], a[16:19], a[204:207], v[76:79]
    v_mfma_f32_16x16x32_bf16 a[232:235], a[20:23], a[208:211], a[232:235]
    ds_read_b64_tr_b16 a[8:9], v242 offset:4096
    s_waitcnt lgkmcnt(5)
    v_mfma_f32_16x16x32_bf16 v[80:83], a[24:27], a[192:195], v[80:83]
    ds_read_b64_tr_b16 a[10:11], v242 offset:11264
    v_mfma_f32_16x16x32_bf16 v[84:87], a[24:27], a[196:199], v[84:87]
    ds_read_b64_tr_b16 a[12:13], v243 offset:4096
    v_mfma_f32_16x16x32_bf16 v[88:91], a[24:27], a[200:203], v[88:91]
    ds_read_b64_tr_b16 a[14:15], v243 offset:11264
    v_mfma_f32_16x16x32_bf16 v[92:95], a[24:27], a[204:207], v[92:95]
    buffer_load_dwordx4 v227, s[32:35], s66 offen offset:2048 lds
    s_add_u32 s66, s66, s59
    v_mfma_f32_16x16x32_bf16 v[108:111], a[28:31], a[204:207], v[108:111]
    ds_read_b64_tr_b16 a[16:17], v244 offset:4096
    v_mfma_f32_16x16x32_bf16 v[104:107], a[28:31], a[200:203], v[104:107]
    buffer_load_dwordx4 a[120:123], v251, s[28:31], s52 offen offset:2048 sc1
    v_mfma_f32_16x16x32_bf16 v[100:103], a[28:31], a[196:199], v[100:103]
    ds_read_b64_tr_b16 a[18:19], v244 offset:11264
    v_mfma_f32_16x16x32_bf16 v[96:99], a[28:31], a[192:195], v[96:99]
    s_waitcnt lgkmcnt(6)
    v_mfma_f32_16x16x32_bf16 v[112:115], a[0:3], a[192:195], v[112:115]
    ds_read_b64_tr_b16 a[20:21], v249 offset:4096
    v_mfma_f32_16x16x32_bf16 v[116:119], a[0:3], a[196:199], v[116:119]
    buffer_load_dwordx4 v227, s[32:35], s67 offen offset:3072 lds
    s_add_u32 s67, s67, s59
    v_mfma_f32_16x16x32_bf16 v[120:123], a[0:3], a[200:203], v[120:123]
    ds_read_b64_tr_b16 a[22:23], v249 offset:11264
    v_mfma_f32_16x16x32_bf16 v[124:127], a[0:3], a[204:207], v[124:127]
    v_mfma_f32_16x16x32_bf16 v[140:143], a[204:207], a[4:7], v[140:143]
    ds_read_b64_tr_b16 a[24:25], v245 offset:6144
    v_mfma_f32_16x16x32_bf16 v[136:139], a[200:203], a[4:7], v[136:139]
    ds_read_b64_tr_b16 a[26:27], v245 offset:13312
    v_mfma_f32_16x16x32_bf16 v[132:135], a[196:199], a[4:7], v[132:135]
    v_mfma_f32_16x16x32_bf16 v[128:131], a[192:195], a[4:7], v[128:131]
    s_waitcnt lgkmcnt(6)
    v_mfma_f32_16x16x32_bf16 v[144:147], a[192:195], a[8:11], v[144:147]
    ds_read_b64_tr_b16 a[28:29], v246 offset:6144
    v_mfma_f32_16x16x32_bf16 v[148:151], a[196:199], a[8:11], v[148:151]
    buffer_load_dwordx4 a[124:127], v252, s[28:31], s52 offen offset:3072 sc1
    v_mfma_f32_16x16x32_bf16 v[152:155], a[200:203], a[8:11], v[152:155]
    ds_read_b64_tr_b16 a[30:31], v246 offset:13312
    v_mfma_f32_16x16x32_bf16 v[156:159], a[204:207], a[8:11], v[156:159]
    v_mfma_f32_16x16x32_bf16 v[172:175], a[204:207], a[12:15], v[172:175]
    ds_read_b64_tr_b16 a[0:1], v241 offset:14336
    s_add_u32 m0, s55, 61440
    v_mfma_f32_16x16x32_bf16 v[168:171], a[200:203], a[12:15], v[168:171]
    buffer_load_dwordx4 v227, s[32:35], s68 offen offset:0 lds
    s_add_u32 s68, s68, s59
    v_mfma_f32_16x16x32_bf16 v[164:167], a[196:199], a[12:15], v[164:167]
    ds_read_b64_tr_b16 a[2:3], v241 offset:21504
    v_mfma_f32_16x16x32_bf16 v[160:163], a[192:195], a[12:15], v[160:163]
    s_waitcnt lgkmcnt(6)
    v_mfma_f32_16x16x32_bf16 v[176:179], a[192:195], a[16:19], v[176:179]
    ds_read_b64_tr_b16 a[4:5], v242 offset:14336
    v_mfma_f32_16x16x32_bf16 v[180:183], a[196:199], a[16:19], v[180:183]
    ds_read_b64_tr_b16 a[6:7], v242 offset:21504
    v_mfma_f32_16x16x32_bf16 v[184:187], a[200:203], a[16:19], v[184:187]
    v_mfma_f32_16x16x32_bf16 v[188:191], a[204:207], a[16:19], v[188:191]
    v_mfma_f32_16x16x32_bf16 a[236:239], a[208:211], a[20:23], a[236:239]
    ds_read_b64_tr_b16 a[8:9], v243 offset:14336
    s_waitcnt lgkmcnt(5)
    v_mfma_f32_16x16x32_bf16 v[192:195], a[24:27], a[192:195], v[192:195]
    ds_read_b64_tr_b16 a[10:11], v243 offset:21504
    v_mfma_f32_16x16x32_bf16 v[196:199], a[24:27], a[196:199], v[196:199]
    ds_read_b64_tr_b16 a[12:13], v244 offset:14336
    v_mfma_f32_16x16x32_bf16 v[200:203], a[24:27], a[200:203], v[200:203]
    ds_read_b64_tr_b16 a[14:15], v244 offset:21504
    v_mfma_f32_16x16x32_bf16 v[204:207], a[24:27], a[204:207], v[204:207]
    buffer_load_dwordx4 a[128:131], v225, s[28:31], s52 offen sc1
    v_mfma_f32_16x16x32_bf16 v[220:223], a[28:31], a[204:207], v[220:223]
    ds_read_b64_tr_b16 a[16:17], v241 offset:16384
    v_mfma_f32_16x16x32_bf16 v[216:219], a[28:31], a[200:203], v[216:219]
    buffer_load_dwordx4 v227, s[32:35], s69 offen offset:1024 lds
    s_add_u32 s69, s69, s59
    v_mfma_f32_16x16x32_bf16 v[212:215], a[28:31], a[196:199], v[212:215]
    ds_read_b64_tr_b16 a[18:19], v241 offset:23552
    v_mfma_f32_16x16x32_bf16 v[208:211], a[28:31], a[192:195], v[208:211]
    s_waitcnt lgkmcnt(6)
    v_mfma_f32_16x16x32_bf16 v[0:3], a[0:3], a[212:215], v[0:3]
    ds_read_b64_tr_b16 a[20:21], v249 offset:16384
    v_mfma_f32_16x16x32_bf16 v[4:7], a[0:3], a[216:219], v[4:7]
    buffer_load_dwordx4 a[132:135], v224, s[28:31], s53 offen offset:0 sc1
    v_mfma_f32_16x16x32_bf16 v[8:11], a[0:3], a[220:223], v[8:11]
    ds_read_b64_tr_b16 a[22:23], v249 offset:23552
    v_mfma_f32_16x16x32_bf16 v[12:15], a[0:3], a[224:227], v[12:15]
    v_mfma_f32_16x16x32_bf16 v[28:31], a[4:7], a[224:227], v[28:31]
    ds_read_b64_tr_b16 a[24:25], v242 offset:16384
    v_mfma_f32_16x16x32_bf16 v[24:27], a[4:7], a[220:223], v[24:27]
    ds_read_b64_tr_b16 a[26:27], v242 offset:23552
    v_mfma_f32_16x16x32_bf16 v[20:23], a[4:7], a[216:219], v[20:23]
    v_mfma_f32_16x16x32_bf16 v[16:19], a[4:7], a[212:215], v[16:19]
    s_waitcnt lgkmcnt(6)
    v_mfma_f32_16x16x32_bf16 v[32:35], a[8:11], a[212:215], v[32:35]
    ds_read_b64_tr_b16 a[28:29], v243 offset:16384
    v_mfma_f32_16x16x32_bf16 v[36:39], a[8:11], a[216:219], v[36:39]
    buffer_load_dwordx4 v228, s[40:43], s70 offen offset:2048 lds
    s_add_u32 s70, s70, s61
    v_mfma_f32_16x16x32_bf16 v[40:43], a[8:11], a[220:223], v[40:43]
    ds_read_b64_tr_b16 a[30:31], v243 offset:23552
    v_mfma_f32_16x16x32_bf16 v[44:47], a[8:11], a[224:227], v[44:47]
    v_mfma_f32_16x16x32_bf16 v[60:63], a[12:15], a[224:227], v[60:63]
    ds_read_b64_tr_b16 a[0:1], v244 offset:16384
    v_mfma_f32_16x16x32_bf16 v[56:59], a[12:15], a[220:223], v[56:59]
    ds_read_b64_tr_b16 a[2:3], v244 offset:23552
    v_mfma_f32_16x16x32_bf16 v[52:55], a[12:15], a[216:219], v[52:55]
    v_mfma_f32_16x16x32_bf16 v[48:51], a[12:15], a[212:215], v[48:51]
    s_waitcnt lgkmcnt(6)
    v_mfma_f32_16x16x32_bf16 v[64:67], a[16:19], a[212:215], v[64:67]
    ds_read_b64_tr_b16 a[4:5], v241 offset:18432
    v_mfma_f32_16x16x32_bf16 v[68:71], a[16:19], a[216:219], v[68:71]
    buffer_load_dwordx4 a[136:139], v250, s[28:31], s53 offen offset:1024 sc1
    v_mfma_f32_16x16x32_bf16 v[72:75], a[16:19], a[220:223], v[72:75]
    ds_read_b64_tr_b16 a[6:7], v241 offset:25600
    v_mfma_f32_16x16x32_bf16 v[76:79], a[16:19], a[224:227], v[76:79]
    v_mfma_f32_16x16x32_bf16 a[232:235], a[20:23], a[228:231], a[232:235]
    ds_read_b64_tr_b16 a[8:9], v242 offset:18432
    s_waitcnt lgkmcnt(5)
    v_mfma_f32_16x16x32_bf16 v[80:83], a[24:27], a[212:215], v[80:83]
    ds_read_b64_tr_b16 a[10:11], v242 offset:25600
    v_mfma_f32_16x16x32_bf16 v[84:87], a[24:27], a[216:219], v[84:87]
    ds_read_b64_tr_b16 a[12:13], v243 offset:18432
    v_mfma_f32_16x16x32_bf16 v[88:91], a[24:27], a[220:223], v[88:91]
    ds_read_b64_tr_b16 a[14:15], v243 offset:25600
    v_mfma_f32_16x16x32_bf16 v[92:95], a[24:27], a[224:227], v[92:95]
    buffer_load_dwordx4 a[140:143], v251, s[28:31], s53 offen offset:2048 sc1
    v_mfma_f32_16x16x32_bf16 v[108:111], a[28:31], a[224:227], v[108:111]
    ds_read_b64_tr_b16 a[16:17], v244 offset:18432
    v_mfma_f32_16x16x32_bf16 v[104:107], a[28:31], a[220:223], v[104:107]
    buffer_load_dwordx4 a[144:147], v252, s[28:31], s53 offen offset:3072 sc1
    v_mfma_f32_16x16x32_bf16 v[100:103], a[28:31], a[216:219], v[100:103]
    ds_read_b64_tr_b16 a[18:19], v244 offset:25600
    v_mfma_f32_16x16x32_bf16 v[96:99], a[28:31], a[212:215], v[96:99]
    s_waitcnt lgkmcnt(6)
    v_mfma_f32_16x16x32_bf16 v[112:115], a[0:3], a[212:215], v[112:115]
    ds_read_b64_tr_b16 a[20:21], v249 offset:18432
    v_mfma_f32_16x16x32_bf16 v[116:119], a[0:3], a[216:219], v[116:119]
    ds_read_b64_tr_b16 a[22:23], v249 offset:25600
    v_mfma_f32_16x16x32_bf16 v[120:123], a[0:3], a[220:223], v[120:123]
    v_mfma_f32_16x16x32_bf16 v[124:127], a[0:3], a[224:227], v[124:127]
    v_mfma_f32_16x16x32_bf16 v[140:143], a[224:227], a[4:7], v[140:143]
    ds_read_b64_tr_b16 a[24:25], v245 offset:20480
    v_mfma_f32_16x16x32_bf16 v[136:139], a[220:223], a[4:7], v[136:139]
    buffer_load_dwordx4 a[148:151], v225, s[28:31], s53 offen sc1
    v_mfma_f32_16x16x32_bf16 v[132:135], a[216:219], a[4:7], v[132:135]
    ds_read_b64_tr_b16 a[26:27], v245 offset:27648
    v_mfma_f32_16x16x32_bf16 v[128:131], a[212:215], a[4:7], v[128:131]
    s_waitcnt lgkmcnt(6)
    v_mfma_f32_16x16x32_bf16 v[144:147], a[212:215], a[8:11], v[144:147]
    ds_read_b64_tr_b16 a[28:29], v246 offset:20480
    v_mfma_f32_16x16x32_bf16 v[148:151], a[216:219], a[8:11], v[148:151]
    ds_read_b64_tr_b16 a[30:31], v246 offset:27648
    v_mfma_f32_16x16x32_bf16 v[152:155], a[220:223], a[8:11], v[152:155]
    v_mfma_f32_16x16x32_bf16 v[156:159], a[224:227], a[8:11], v[156:159]
    s_waitcnt vmcnt(38)
    s_barrier
    v_mfma_f32_16x16x32_bf16 v[172:175], a[224:227], a[12:15], v[172:175]
    ds_read_b64_tr_b16 a[0:1], v229 offset:0
    s_add_u32 s52, s52, s58
    s_add_u32 s53, s53, s58
    v_mfma_f32_16x16x32_bf16 v[168:171], a[220:223], a[12:15], v[168:171]
    s_add_u32 s56, s56, 1
    s_add_u32 m0, s55, 86016
    buffer_load_dword a240, v253, s[36:39], s17 offen
    v_mfma_f32_16x16x32_bf16 v[164:167], a[216:219], a[12:15], v[164:167]
    ds_read_b64_tr_b16 a[2:3], v229 offset:7168
    s_add_u32 s17, s17, s71
    v_mfma_f32_16x16x32_bf16 v[160:163], a[212:215], a[12:15], v[160:163]
    s_waitcnt lgkmcnt(6)
    v_mfma_f32_16x16x32_bf16 v[176:179], a[212:215], a[16:19], v[176:179]
    ds_read_b64_tr_b16 a[4:5], v230 offset:0
    v_mfma_f32_16x16x32_bf16 v[180:183], a[216:219], a[16:19], v[180:183]
    buffer_load_dwordx4 v227, s[32:35], s64 offen offset:0 lds
    s_add_u32 s64, s64, s59
    v_mfma_f32_16x16x32_bf16 v[184:187], a[220:223], a[16:19], v[184:187]
    ds_read_b64_tr_b16 a[6:7], v230 offset:7168
    v_mfma_f32_16x16x32_bf16 v[188:191], a[224:227], a[16:19], v[188:191]
    v_mfma_f32_16x16x32_bf16 a[236:239], a[228:231], a[20:23], a[236:239]
    ds_read_b64_tr_b16 a[8:9], v231 offset:0
    s_waitcnt lgkmcnt(5)
    v_mfma_f32_16x16x32_bf16 v[192:195], a[24:27], a[212:215], v[192:195]
    ds_read_b64_tr_b16 a[10:11], v231 offset:7168
    v_mfma_f32_16x16x32_bf16 v[196:199], a[24:27], a[216:219], v[196:199]
    ds_read_b64_tr_b16 a[12:13], v232 offset:0
    v_mfma_f32_16x16x32_bf16 v[200:203], a[24:27], a[220:223], v[200:203]
    ds_read_b64_tr_b16 a[14:15], v232 offset:7168
    v_mfma_f32_16x16x32_bf16 v[204:207], a[24:27], a[224:227], v[204:207]
    buffer_load_dwordx4 a[152:155], v224, s[28:31], s52 offen offset:0 sc1
    v_mfma_f32_16x16x32_bf16 v[220:223], a[28:31], a[224:227], v[220:223]
    ds_read_b64_tr_b16 a[16:17], v229 offset:2048
    v_mfma_f32_16x16x32_bf16 v[216:219], a[28:31], a[220:223], v[216:219]
    ds_read_b64_tr_b16 a[18:19], v229 offset:9216
    v_mfma_f32_16x16x32_bf16 v[212:215], a[28:31], a[216:219], v[212:215]
    v_mfma_f32_16x16x32_bf16 v[208:211], a[28:31], a[212:215], v[208:211]
    s_sub_u32 s57, s57, 2
.p2align 3
L_loop_24:
    s_waitcnt lgkmcnt(6)
    v_mfma_f32_16x16x32_bf16 v[0:3], a[0:3], a[32:35], v[0:3]
    ds_read_b64_tr_b16 a[20:21], v247 offset:2048
    v_mfma_f32_16x16x32_bf16 v[4:7], a[0:3], a[36:39], v[4:7]
    buffer_load_dwordx4 v227, s[32:35], s65 offen offset:1024 lds
    s_add_u32 s65, s65, s59
    v_mfma_f32_16x16x32_bf16 v[8:11], a[0:3], a[40:43], v[8:11]
    ds_read_b64_tr_b16 a[22:23], v247 offset:9216
    v_mfma_f32_16x16x32_bf16 v[12:15], a[0:3], a[44:47], v[12:15]
    v_mfma_f32_16x16x32_bf16 v[28:31], a[4:7], a[44:47], v[28:31]
    ds_read_b64_tr_b16 a[24:25], v230 offset:2048
    v_mfma_f32_16x16x32_bf16 v[24:27], a[4:7], a[40:43], v[24:27]
    ds_read_b64_tr_b16 a[26:27], v230 offset:9216
    v_mfma_f32_16x16x32_bf16 v[20:23], a[4:7], a[36:39], v[20:23]
    v_mfma_f32_16x16x32_bf16 v[16:19], a[4:7], a[32:35], v[16:19]
    s_waitcnt lgkmcnt(6)
    v_mfma_f32_16x16x32_bf16 v[32:35], a[8:11], a[32:35], v[32:35]
    ds_read_b64_tr_b16 a[28:29], v231 offset:2048
    v_mfma_f32_16x16x32_bf16 v[36:39], a[8:11], a[36:39], v[36:39]
    buffer_load_dwordx4 a[156:159], v250, s[28:31], s52 offen offset:1024 sc1
    v_mfma_f32_16x16x32_bf16 v[40:43], a[8:11], a[40:43], v[40:43]
    ds_read_b64_tr_b16 a[30:31], v231 offset:9216
    v_mfma_f32_16x16x32_bf16 v[44:47], a[8:11], a[44:47], v[44:47]
    v_mfma_f32_16x16x32_bf16 v[60:63], a[12:15], a[44:47], v[60:63]
    ds_read_b64_tr_b16 a[0:1], v232 offset:2048
    v_mfma_f32_16x16x32_bf16 v[56:59], a[12:15], a[40:43], v[56:59]
    buffer_load_dwordx4 v227, s[32:35], s66 offen offset:2048 lds
    s_add_u32 s66, s66, s59
    v_mfma_f32_16x16x32_bf16 v[52:55], a[12:15], a[36:39], v[52:55]
    ds_read_b64_tr_b16 a[2:3], v232 offset:9216
    v_mfma_f32_16x16x32_bf16 v[48:51], a[12:15], a[32:35], v[48:51]
    s_waitcnt lgkmcnt(6)
    v_mfma_f32_16x16x32_bf16 v[64:67], a[16:19], a[32:35], v[64:67]
    ds_read_b64_tr_b16 a[4:5], v229 offset:4096
    v_mfma_f32_16x16x32_bf16 v[68:71], a[16:19], a[36:39], v[68:71]
    ds_read_b64_tr_b16 a[6:7], v229 offset:11264
    v_mfma_f32_16x16x32_bf16 v[72:75], a[16:19], a[40:43], v[72:75]
    v_mfma_f32_16x16x32_bf16 v[76:79], a[16:19], a[44:47], v[76:79]
    v_mfma_f32_16x16x32_bf16 a[232:235], a[20:23], a[48:51], a[232:235]
    ds_read_b64_tr_b16 a[8:9], v230 offset:4096
    s_waitcnt lgkmcnt(5)
    v_mfma_f32_16x16x32_bf16 v[80:83], a[24:27], a[32:35], v[80:83]
    ds_read_b64_tr_b16 a[10:11], v230 offset:11264
    v_mfma_f32_16x16x32_bf16 v[84:87], a[24:27], a[36:39], v[84:87]
    ds_read_b64_tr_b16 a[12:13], v231 offset:4096
    v_mfma_f32_16x16x32_bf16 v[88:91], a[24:27], a[40:43], v[88:91]
    ds_read_b64_tr_b16 a[14:15], v231 offset:11264
    v_mfma_f32_16x16x32_bf16 v[92:95], a[24:27], a[44:47], v[92:95]
    buffer_load_dwordx4 a[160:163], v251, s[28:31], s52 offen offset:2048 sc1
    v_mfma_f32_16x16x32_bf16 v[108:111], a[28:31], a[44:47], v[108:111]
    ds_read_b64_tr_b16 a[16:17], v232 offset:4096
    v_mfma_f32_16x16x32_bf16 v[104:107], a[28:31], a[40:43], v[104:107]
    buffer_load_dwordx4 v227, s[32:35], s67 offen offset:3072 lds
    s_add_u32 s67, s67, s59
    v_mfma_f32_16x16x32_bf16 v[100:103], a[28:31], a[36:39], v[100:103]
    ds_read_b64_tr_b16 a[18:19], v232 offset:11264
    v_mfma_f32_16x16x32_bf16 v[96:99], a[28:31], a[32:35], v[96:99]
    s_waitcnt lgkmcnt(6)
    v_mfma_f32_16x16x32_bf16 v[112:115], a[0:3], a[32:35], v[112:115]
    ds_read_b64_tr_b16 a[20:21], v247 offset:4096
    v_mfma_f32_16x16x32_bf16 v[116:119], a[0:3], a[36:39], v[116:119]
    ds_read_b64_tr_b16 a[22:23], v247 offset:11264
    v_mfma_f32_16x16x32_bf16 v[120:123], a[0:3], a[40:43], v[120:123]
    v_mfma_f32_16x16x32_bf16 v[124:127], a[0:3], a[44:47], v[124:127]
    v_mfma_f32_16x16x32_bf16 v[140:143], a[44:47], a[4:7], v[140:143]
    ds_read_b64_tr_b16 a[24:25], v233 offset:6144
    v_mfma_f32_16x16x32_bf16 v[136:139], a[40:43], a[4:7], v[136:139]
    buffer_load_dwordx4 a[164:167], v252, s[28:31], s52 offen offset:3072 sc1
    v_mfma_f32_16x16x32_bf16 v[132:135], a[36:39], a[4:7], v[132:135]
    ds_read_b64_tr_b16 a[26:27], v233 offset:13312
    v_mfma_f32_16x16x32_bf16 v[128:131], a[32:35], a[4:7], v[128:131]
    s_waitcnt lgkmcnt(6)
    v_mfma_f32_16x16x32_bf16 v[144:147], a[32:35], a[8:11], v[144:147]
    ds_read_b64_tr_b16 a[28:29], v234 offset:6144
    v_mfma_f32_16x16x32_bf16 v[148:151], a[36:39], a[8:11], v[148:151]
    ds_read_b64_tr_b16 a[30:31], v234 offset:13312
    v_mfma_f32_16x16x32_bf16 v[152:155], a[40:43], a[8:11], v[152:155]
    v_mfma_f32_16x16x32_bf16 v[156:159], a[44:47], a[8:11], v[156:159]
    v_mfma_f32_16x16x32_bf16 v[172:175], a[44:47], a[12:15], v[172:175]
    ds_read_b64_tr_b16 a[0:1], v229 offset:14336
    s_add_u32 m0, s55, 90112
    v_mfma_f32_16x16x32_bf16 v[168:171], a[40:43], a[12:15], v[168:171]
    buffer_load_dwordx4 v227, s[32:35], s68 offen offset:0 lds
    s_add_u32 s68, s68, s59
    v_mfma_f32_16x16x32_bf16 v[164:167], a[36:39], a[12:15], v[164:167]
    ds_read_b64_tr_b16 a[2:3], v229 offset:21504
    v_mfma_f32_16x16x32_bf16 v[160:163], a[32:35], a[12:15], v[160:163]
    s_waitcnt lgkmcnt(6)
    v_mfma_f32_16x16x32_bf16 v[176:179], a[32:35], a[16:19], v[176:179]
    ds_read_b64_tr_b16 a[4:5], v230 offset:14336
    v_mfma_f32_16x16x32_bf16 v[180:183], a[36:39], a[16:19], v[180:183]
    buffer_load_dwordx4 a[168:171], v225, s[28:31], s52 offen sc1
    v_mfma_f32_16x16x32_bf16 v[184:187], a[40:43], a[16:19], v[184:187]
    ds_read_b64_tr_b16 a[6:7], v230 offset:21504
    v_mfma_f32_16x16x32_bf16 v[188:191], a[44:47], a[16:19], v[188:191]
    v_mfma_f32_16x16x32_bf16 a[236:239], a[48:51], a[20:23], a[236:239]
    ds_read_b64_tr_b16 a[8:9], v231 offset:14336
    s_waitcnt lgkmcnt(5)
    v_mfma_f32_16x16x32_bf16 v[192:195], a[24:27], a[32:35], v[192:195]
    ds_read_b64_tr_b16 a[10:11], v231 offset:21504
    v_mfma_f32_16x16x32_bf16 v[196:199], a[24:27], a[36:39], v[196:199]
    ds_read_b64_tr_b16 a[12:13], v232 offset:14336
    v_mfma_f32_16x16x32_bf16 v[200:203], a[24:27], a[40:43], v[200:203]
    ds_read_b64_tr_b16 a[14:15], v232 offset:21504
    v_mfma_f32_16x16x32_bf16 v[204:207], a[24:27], a[44:47], v[204:207]
    buffer_load_dwordx4 v227, s[32:35], s69 offen offset:1024 lds
    s_add_u32 s69, s69, s59
    v_mfma_f32_16x16x32_bf16 v[220:223], a[28:31], a[44:47], v[220:223]
    ds_read_b64_tr_b16 a[16:17], v229 offset:16384
    v_mfma_f32_16x16x32_bf16 v[216:219], a[28:31], a[40:43], v[216:219]
    ds_read_b64_tr_b16 a[18:19], v229 offset:23552
    v_mfma_f32_16x16x32_bf16 v[212:215], a[28:31], a[36:39], v[212:215]
    v_mfma_f32_16x16x32_bf16 v[208:211], a[28:31], a[32:35], v[208:211]
    s_waitcnt lgkmcnt(6)
    v_mfma_f32_16x16x32_bf16 v[0:3], a[0:3], a[52:55], v[0:3]
    ds_read_b64_tr_b16 a[20:21], v247 offset:16384
    v_mfma_f32_16x16x32_bf16 v[4:7], a[0:3], a[56:59], v[4:7]
    buffer_load_dwordx4 a[172:175], v224, s[28:31], s53 offen offset:0 sc1
    v_mfma_f32_16x16x32_bf16 v[8:11], a[0:3], a[60:63], v[8:11]
    ds_read_b64_tr_b16 a[22:23], v247 offset:23552
    v_mfma_f32_16x16x32_bf16 v[12:15], a[0:3], a[64:67], v[12:15]
    v_mfma_f32_16x16x32_bf16 v[28:31], a[4:7], a[64:67], v[28:31]
    ds_read_b64_tr_b16 a[24:25], v230 offset:16384
    v_mfma_f32_16x16x32_bf16 v[24:27], a[4:7], a[60:63], v[24:27]
    ds_read_b64_tr_b16 a[26:27], v230 offset:23552
    v_mfma_f32_16x16x32_bf16 v[20:23], a[4:7], a[56:59], v[20:23]
    v_mfma_f32_16x16x32_bf16 v[16:19], a[4:7], a[52:55], v[16:19]
    s_waitcnt lgkmcnt(6)
    v_mfma_f32_16x16x32_bf16 v[32:35], a[8:11], a[52:55], v[32:35]
    ds_read_b64_tr_b16 a[28:29], v231 offset:16384
    v_mfma_f32_16x16x32_bf16 v[36:39], a[8:11], a[56:59], v[36:39]
    buffer_load_dwordx4 v228, s[40:43], s70 offen offset:2048 lds
    s_add_u32 s70, s70, s61
    v_mfma_f32_16x16x32_bf16 v[40:43], a[8:11], a[60:63], v[40:43]
    ds_read_b64_tr_b16 a[30:31], v231 offset:23552
    v_mfma_f32_16x16x32_bf16 v[44:47], a[8:11], a[64:67], v[44:47]
    v_mfma_f32_16x16x32_bf16 v[60:63], a[12:15], a[64:67], v[60:63]
    ds_read_b64_tr_b16 a[0:1], v232 offset:16384
    v_mfma_f32_16x16x32_bf16 v[56:59], a[12:15], a[60:63], v[56:59]
    buffer_load_dwordx4 a[176:179], v250, s[28:31], s53 offen offset:1024 sc1
    v_mfma_f32_16x16x32_bf16 v[52:55], a[12:15], a[56:59], v[52:55]
    ds_read_b64_tr_b16 a[2:3], v232 offset:23552
    v_mfma_f32_16x16x32_bf16 v[48:51], a[12:15], a[52:55], v[48:51]
    s_waitcnt lgkmcnt(6)
    v_mfma_f32_16x16x32_bf16 v[64:67], a[16:19], a[52:55], v[64:67]
    ds_read_b64_tr_b16 a[4:5], v229 offset:18432
    v_mfma_f32_16x16x32_bf16 v[68:71], a[16:19], a[56:59], v[68:71]
    ds_read_b64_tr_b16 a[6:7], v229 offset:25600
    v_mfma_f32_16x16x32_bf16 v[72:75], a[16:19], a[60:63], v[72:75]
    v_mfma_f32_16x16x32_bf16 v[76:79], a[16:19], a[64:67], v[76:79]
    v_mfma_f32_16x16x32_bf16 a[232:235], a[20:23], a[68:71], a[232:235]
    ds_read_b64_tr_b16 a[8:9], v230 offset:18432
    s_waitcnt lgkmcnt(5)
    v_mfma_f32_16x16x32_bf16 v[80:83], a[24:27], a[52:55], v[80:83]
    ds_read_b64_tr_b16 a[10:11], v230 offset:25600
    v_mfma_f32_16x16x32_bf16 v[84:87], a[24:27], a[56:59], v[84:87]
    ds_read_b64_tr_b16 a[12:13], v231 offset:18432
    v_mfma_f32_16x16x32_bf16 v[88:91], a[24:27], a[60:63], v[88:91]
    ds_read_b64_tr_b16 a[14:15], v231 offset:25600
    v_mfma_f32_16x16x32_bf16 v[92:95], a[24:27], a[64:67], v[92:95]
    buffer_load_dwordx4 a[180:183], v251, s[28:31], s53 offen offset:2048 sc1
    v_mfma_f32_16x16x32_bf16 v[108:111], a[28:31], a[64:67], v[108:111]
    ds_read_b64_tr_b16 a[16:17], v232 offset:18432
    v_mfma_f32_16x16x32_bf16 v[104:107], a[28:31], a[60:63], v[104:107]
    buffer_load_dwordx4 a[184:187], v252, s[28:31], s53 offen offset:3072 sc1
    v_mfma_f32_16x16x32_bf16 v[100:103], a[28:31], a[56:59], v[100:103]
    ds_read_b64_tr_b16 a[18:19], v232 offset:25600
    v_mfma_f32_16x16x32_bf16 v[96:99], a[28:31], a[52:55], v[96:99]
    s_waitcnt lgkmcnt(6)
    v_mfma_f32_16x16x32_bf16 v[112:115], a[0:3], a[52:55], v[112:115]
    s_branch L_po_q_3
.p2align 12
L_pg_q_3:
    s_branch L_pg_q_6
L_po_q_3:
    ds_read_b64_tr_b16 a[20:21], v247 offset:18432
    v_mfma_f32_16x16x32_bf16 v[116:119], a[0:3], a[56:59], v[116:119]
    ds_read_b64_tr_b16 a[22:23], v247 offset:25600
    v_mfma_f32_16x16x32_bf16 v[120:123], a[0:3], a[60:63], v[120:123]
    v_mfma_f32_16x16x32_bf16 v[124:127], a[0:3], a[64:67], v[124:127]
    v_mfma_f32_16x16x32_bf16 v[140:143], a[64:67], a[4:7], v[140:143]
    ds_read_b64_tr_b16 a[24:25], v233 offset:20480
    v_mfma_f32_16x16x32_bf16 v[136:139], a[60:63], a[4:7], v[136:139]
    buffer_load_dwordx4 a[188:191], v225, s[28:31], s53 offen sc1
    v_mfma_f32_16x16x32_bf16 v[132:135], a[56:59], a[4:7], v[132:135]
    ds_read_b64_tr_b16 a[26:27], v233 offset:27648
    v_mfma_f32_16x16x32_bf16 v[128:131], a[52:55], a[4:7], v[128:131]
    s_waitcnt lgkmcnt(6)
    v_mfma_f32_16x16x32_bf16 v[144:147], a[52:55], a[8:11], v[144:147]
    ds_read_b64_tr_b16 a[28:29], v234 offset:20480
    v_mfma_f32_16x16x32_bf16 v[148:151], a[56:59], a[8:11], v[148:151]
    ds_read_b64_tr_b16 a[30:31], v234 offset:27648
    v_mfma_f32_16x16x32_bf16 v[152:155], a[60:63], a[8:11], v[152:155]
    v_mfma_f32_16x16x32_bf16 v[156:159], a[64:67], a[8:11], v[156:159]
    s_waitcnt vmcnt(36)
    s_barrier
    v_mfma_f32_16x16x32_bf16 v[172:175], a[64:67], a[12:15], v[172:175]
    ds_read_b64_tr_b16 a[0:1], v229 offset:28672
    s_add_u32 s52, s52, s58
    s_add_u32 s53, s53, s58
    v_mfma_f32_16x16x32_bf16 v[168:171], a[60:63], a[12:15], v[168:171]
    ds_read_b64_tr_b16 a[2:3], v229 offset:35840
    s_add_u32 s56, s56, 1
    s_cmp_eq_u32 s56, 10
    v_mfma_f32_16x16x32_bf16 v[164:167], a[56:59], a[12:15], v[164:167]
    s_cselect_b64 s[36:37], s[14:15], s[36:37]
    s_cselect_b32 s38, s22, s38
    v_mfma_f32_16x16x32_bf16 v[160:163], a[52:55], a[12:15], v[160:163]
    s_cselect_b32 s17, s54, s17
    s_cselect_b32 s71, 512, s71
    s_waitcnt lgkmcnt(6)
    v_mfma_f32_16x16x32_bf16 v[176:179], a[52:55], a[16:19], v[176:179]
    ds_read_b64_tr_b16 a[4:5], v230 offset:28672
    s_add_u32 m0, s55, 114688
    v_mfma_f32_16x16x32_bf16 v[180:183], a[56:59], a[16:19], v[180:183]
    buffer_load_dword a240, v253, s[36:39], s17 offen
    s_add_u32 s17, s17, s71
    v_mfma_f32_16x16x32_bf16 v[184:187], a[60:63], a[16:19], v[184:187]
    ds_read_b64_tr_b16 a[6:7], v230 offset:35840
    v_mfma_f32_16x16x32_bf16 v[188:191], a[64:67], a[16:19], v[188:191]
    buffer_load_dwordx4 v227, s[32:35], s64 offen offset:0 lds
    s_add_u32 s64, s64, s59
    v_mfma_f32_16x16x32_bf16 a[236:239], a[68:71], a[20:23], a[236:239]
    ds_read_b64_tr_b16 a[8:9], v231 offset:28672
    s_waitcnt lgkmcnt(5)
    v_mfma_f32_16x16x32_bf16 v[192:195], a[24:27], a[52:55], v[192:195]
    ds_read_b64_tr_b16 a[10:11], v231 offset:35840
    v_mfma_f32_16x16x32_bf16 v[196:199], a[24:27], a[56:59], v[196:199]
    ds_read_b64_tr_b16 a[12:13], v232 offset:28672
    v_mfma_f32_16x16x32_bf16 v[200:203], a[24:27], a[60:63], v[200:203]
    ds_read_b64_tr_b16 a[14:15], v232 offset:35840
    v_mfma_f32_16x16x32_bf16 v[204:207], a[24:27], a[64:67], v[204:207]
    buffer_load_dwordx4 a[192:195], v224, s[28:31], s52 offen offset:0 sc1
    v_mfma_f32_16x16x32_bf16 v[220:223], a[28:31], a[64:67], v[220:223]
    ds_read_b64_tr_b16 a[16:17], v229 offset:30720
    v_mfma_f32_16x16x32_bf16 v[216:219], a[28:31], a[60:63], v[216:219]
    ds_read_b64_tr_b16 a[18:19], v229 offset:37888
    v_mfma_f32_16x16x32_bf16 v[212:215], a[28:31], a[56:59], v[212:215]
    v_mfma_f32_16x16x32_bf16 v[208:211], a[28:31], a[52:55], v[208:211]
    s_waitcnt lgkmcnt(6)
    v_mfma_f32_16x16x32_bf16 v[0:3], a[0:3], a[72:75], v[0:3]
    ds_read_b64_tr_b16 a[20:21], v247 offset:30720
    v_mfma_f32_16x16x32_bf16 v[4:7], a[0:3], a[76:79], v[4:7]
    buffer_load_dwordx4 v227, s[32:35], s65 offen offset:1024 lds
    s_add_u32 s65, s65, s59
    v_mfma_f32_16x16x32_bf16 v[8:11], a[0:3], a[80:83], v[8:11]
    ds_read_b64_tr_b16 a[22:23], v247 offset:37888
    v_mfma_f32_16x16x32_bf16 v[12:15], a[0:3], a[84:87], v[12:15]
    v_mfma_f32_16x16x32_bf16 v[28:31], a[4:7], a[84:87], v[28:31]
    ds_read_b64_tr_b16 a[24:25], v230 offset:30720
    v_mfma_f32_16x16x32_bf16 v[24:27], a[4:7], a[80:83], v[24:27]
    ds_read_b64_tr_b16 a[26:27], v230 offset:37888
    v_mfma_f32_16x16x32_bf16 v[20:23], a[4:7], a[76:79], v[20:23]
    v_mfma_f32_16x16x32_bf16 v[16:19], a[4:7], a[72:75], v[16:19]
    s_waitcnt lgkmcnt(6)
    v_mfma_f32_16x16x32_bf16 v[32:35], a[8:11], a[72:75], v[32:35]
    ds_read_b64_tr_b16 a[28:29], v231 offset:30720
    v_mfma_f32_16x16x32_bf16 v[36:39], a[8:11], a[76:79], v[36:39]
    buffer_load_dwordx4 a[196:199], v250, s[28:31], s52 offen offset:1024 sc1
    v_mfma_f32_16x16x32_bf16 v[40:43], a[8:11], a[80:83], v[40:43]
    ds_read_b64_tr_b16 a[30:31], v231 offset:37888
    v_mfma_f32_16x16x32_bf16 v[44:47], a[8:11], a[84:87], v[44:47]
    v_mfma_f32_16x16x32_bf16 v[60:63], a[12:15], a[84:87], v[60:63]
    ds_read_b64_tr_b16 a[0:1], v232 offset:30720
    v_mfma_f32_16x16x32_bf16 v[56:59], a[12:15], a[80:83], v[56:59]
    buffer_load_dwordx4 v227, s[32:35], s66 offen offset:2048 lds
    s_add_u32 s66, s66, s59
    v_mfma_f32_16x16x32_bf16 v[52:55], a[12:15], a[76:79], v[52:55]
    ds_read_b64_tr_b16 a[2:3], v232 offset:37888
    v_mfma_f32_16x16x32_bf16 v[48:51], a[12:15], a[72:75], v[48:51]
    s_waitcnt lgkmcnt(6)
    v_mfma_f32_16x16x32_bf16 v[64:67], a[16:19], a[72:75], v[64:67]
    ds_read_b64_tr_b16 a[4:5], v229 offset:32768
    v_mfma_f32_16x16x32_bf16 v[68:71], a[16:19], a[76:79], v[68:71]
    ds_read_b64_tr_b16 a[6:7], v229 offset:39936
    v_mfma_f32_16x16x32_bf16 v[72:75], a[16:19], a[80:83], v[72:75]
    v_mfma_f32_16x16x32_bf16 v[76:79], a[16:19], a[84:87], v[76:79]
    v_mfma_f32_16x16x32_bf16 a[232:235], a[20:23], a[88:91], a[232:235]
    ds_read_b64_tr_b16 a[8:9], v230 offset:32768
    s_waitcnt lgkmcnt(5)
    v_mfma_f32_16x16x32_bf16 v[80:83], a[24:27], a[72:75], v[80:83]
    ds_read_b64_tr_b16 a[10:11], v230 offset:39936
    v_mfma_f32_16x16x32_bf16 v[84:87], a[24:27], a[76:79], v[84:87]
    ds_read_b64_tr_b16 a[12:13], v231 offset:32768
    v_mfma_f32_16x16x32_bf16 v[88:91], a[24:27], a[80:83], v[88:91]
    ds_read_b64_tr_b16 a[14:15], v231 offset:39936
    v_mfma_f32_16x16x32_bf16 v[92:95], a[24:27], a[84:87], v[92:95]
    buffer_load_dwordx4 a[200:203], v251, s[28:31], s52 offen offset:2048 sc1
    v_mfma_f32_16x16x32_bf16 v[108:111], a[28:31], a[84:87], v[108:111]
    ds_read_b64_tr_b16 a[16:17], v232 offset:32768
    v_mfma_f32_16x16x32_bf16 v[104:107], a[28:31], a[80:83], v[104:107]
    buffer_load_dwordx4 v227, s[32:35], s67 offen offset:3072 lds
    s_add_u32 s67, s67, s59
    v_mfma_f32_16x16x32_bf16 v[100:103], a[28:31], a[76:79], v[100:103]
    ds_read_b64_tr_b16 a[18:19], v232 offset:39936
    v_mfma_f32_16x16x32_bf16 v[96:99], a[28:31], a[72:75], v[96:99]
    s_waitcnt lgkmcnt(6)
    v_mfma_f32_16x16x32_bf16 v[112:115], a[0:3], a[72:75], v[112:115]
    ds_read_b64_tr_b16 a[20:21], v247 offset:32768
    v_mfma_f32_16x16x32_bf16 v[116:119], a[0:3], a[76:79], v[116:119]
    ds_read_b64_tr_b16 a[22:23], v247 offset:39936
    v_mfma_f32_16x16x32_bf16 v[120:123], a[0:3], a[80:83], v[120:123]
    v_mfma_f32_16x16x32_bf16 v[124:127], a[0:3], a[84:87], v[124:127]
    v_mfma_f32_16x16x32_bf16 v[140:143], a[84:87], a[4:7], v[140:143]
    ds_read_b64_tr_b16 a[24:25], v233 offset:34816
    v_mfma_f32_16x16x32_bf16 v[136:139], a[80:83], a[4:7], v[136:139]
    buffer_load_dwordx4 a[204:207], v252, s[28:31], s52 offen offset:3072 sc1
    v_mfma_f32_16x16x32_bf16 v[132:135], a[76:79], a[4:7], v[132:135]
    ds_read_b64_tr_b16 a[26:27], v233 offset:41984
    v_mfma_f32_16x16x32_bf16 v[128:131], a[72:75], a[4:7], v[128:131]
    s_waitcnt lgkmcnt(6)
    v_mfma_f32_16x16x32_bf16 v[144:147], a[72:75], a[8:11], v[144:147]
    ds_read_b64_tr_b16 a[28:29], v234 offset:34816
    v_mfma_f32_16x16x32_bf16 v[148:151], a[76:79], a[8:11], v[148:151]
    ds_read_b64_tr_b16 a[30:31], v234 offset:41984
    v_mfma_f32_16x16x32_bf16 v[152:155], a[80:83], a[8:11], v[152:155]
    v_mfma_f32_16x16x32_bf16 v[156:159], a[84:87], a[8:11], v[156:159]
    v_mfma_f32_16x16x32_bf16 v[172:175], a[84:87], a[12:15], v[172:175]
    ds_read_b64_tr_b16 a[0:1], v229 offset:43008
    s_add_u32 m0, s55, 118784
    v_mfma_f32_16x16x32_bf16 v[168:171], a[80:83], a[12:15], v[168:171]
    buffer_load_dwordx4 v227, s[32:35], s68 offen offset:0 lds
    s_add_u32 s68, s68, s59
    v_mfma_f32_16x16x32_bf16 v[164:167], a[76:79], a[12:15], v[164:167]
    ds_read_b64_tr_b16 a[2:3], v229 offset:50176
    v_mfma_f32_16x16x32_bf16 v[160:163], a[72:75], a[12:15], v[160:163]
    s_waitcnt lgkmcnt(6)
    v_mfma_f32_16x16x32_bf16 v[176:179], a[72:75], a[16:19], v[176:179]
    ds_read_b64_tr_b16 a[4:5], v230 offset:43008
    v_mfma_f32_16x16x32_bf16 v[180:183], a[76:79], a[16:19], v[180:183]
    buffer_load_dwordx4 a[208:211], v225, s[28:31], s52 offen sc1
    v_mfma_f32_16x16x32_bf16 v[184:187], a[80:83], a[16:19], v[184:187]
    ds_read_b64_tr_b16 a[6:7], v230 offset:50176
    v_mfma_f32_16x16x32_bf16 v[188:191], a[84:87], a[16:19], v[188:191]
    v_mfma_f32_16x16x32_bf16 a[236:239], a[88:91], a[20:23], a[236:239]
    ds_read_b64_tr_b16 a[8:9], v231 offset:43008
    s_waitcnt lgkmcnt(5)
    v_mfma_f32_16x16x32_bf16 v[192:195], a[24:27], a[72:75], v[192:195]
    ds_read_b64_tr_b16 a[10:11], v231 offset:50176
    v_mfma_f32_16x16x32_bf16 v[196:199], a[24:27], a[76:79], v[196:199]
    ds_read_b64_tr_b16 a[12:13], v232 offset:43008
    v_mfma_f32_16x16x32_bf16 v[200:203], a[24:27], a[80:83], v[200:203]
    ds_read_b64_tr_b16 a[14:15], v232 offset:50176
    v_mfma_f32_16x16x32_bf16 v[204:207], a[24:27], a[84:87], v[204:207]
    buffer_load_dwordx4 v227, s[32:35], s69 offen offset:1024 lds
    s_add_u32 s69, s69, s59
    v_mfma_f32_16x16x32_bf16 v[220:223], a[28:31], a[84:87], v[220:223]
    ds_read_b64_tr_b16 a[16:17], v229 offset:45056
    v_mfma_f32_16x16x32_bf16 v[216:219], a[28:31], a[80:83], v[216:219]
    ds_read_b64_tr_b16 a[18:19], v229 offset:52224
    v_mfma_f32_16x16x32_bf16 v[212:215], a[28:31], a[76:79], v[212:215]
    v_mfma_f32_16x16x32_bf16 v[208:211], a[28:31], a[72:75], v[208:211]
    s_waitcnt lgkmcnt(6)
    v_mfma_f32_16x16x32_bf16 v[0:3], a[0:3], a[92:95], v[0:3]
    ds_read_b64_tr_b16 a[20:21], v247 offset:45056
    v_mfma_f32_16x16x32_bf16 v[4:7], a[0:3], a[96:99], v[4:7]
    buffer_load_dwordx4 a[212:215], v224, s[28:31], s53 offen offset:0 sc1
    v_mfma_f32_16x16x32_bf16 v[8:11], a[0:3], a[100:103], v[8:11]
    ds_read_b64_tr_b16 a[22:23], v247 offset:52224
    v_mfma_f32_16x16x32_bf16 v[12:15], a[0:3], a[104:107], v[12:15]
    v_mfma_f32_16x16x32_bf16 v[28:31], a[4:7], a[104:107], v[28:31]
    ds_read_b64_tr_b16 a[24:25], v230 offset:45056
    v_mfma_f32_16x16x32_bf16 v[24:27], a[4:7], a[100:103], v[24:27]
    ds_read_b64_tr_b16 a[26:27], v230 offset:52224
    v_mfma_f32_16x16x32_bf16 v[20:23], a[4:7], a[96:99], v[20:23]
    v_mfma_f32_16x16x32_bf16 v[16:19], a[4:7], a[92:95], v[16:19]
    s_waitcnt lgkmcnt(6)
    v_mfma_f32_16x16x32_bf16 v[32:35], a[8:11], a[92:95], v[32:35]
    ds_read_b64_tr_b16 a[28:29], v231 offset:45056
    v_mfma_f32_16x16x32_bf16 v[36:39], a[8:11], a[96:99], v[36:39]
    buffer_load_dwordx4 v228, s[40:43], s70 offen offset:2048 lds
    s_add_u32 s70, s70, s61
    v_mfma_f32_16x16x32_bf16 v[40:43], a[8:11], a[100:103], v[40:43]
    ds_read_b64_tr_b16 a[30:31], v231 offset:52224
    v_mfma_f32_16x16x32_bf16 v[44:47], a[8:11], a[104:107], v[44:47]
    v_mfma_f32_16x16x32_bf16 v[60:63], a[12:15], a[104:107], v[60:63]
    ds_read_b64_tr_b16 a[0:1], v232 offset:45056
    v_mfma_f32_16x16x32_bf16 v[56:59], a[12:15], a[100:103], v[56:59]
    buffer_load_dwordx4 a[216:219], v250, s[28:31], s53 offen offset:1024 sc1
    v_mfma_f32_16x16x32_bf16 v[52:55], a[12:15], a[96:99], v[52:55]
    ds_read_b64_tr_b16 a[2:3], v232 offset:52224
    v_mfma_f32_16x16x32_bf16 v[48:51], a[12:15], a[92:95], v[48:51]
    s_waitcnt lgkmcnt(6)
    v_mfma_f32_16x16x32_bf16 v[64:67], a[16:19], a[92:95], v[64:67]
    ds_read_b64_tr_b16 a[4:5], v229 offset:47104
    v_mfma_f32_16x16x32_bf16 v[68:71], a[16:19], a[96:99], v[68:71]
    ds_read_b64_tr_b16 a[6:7], v229 offset:54272
    v_mfma_f32_16x16x32_bf16 v[72:75], a[16:19], a[100:103], v[72:75]
    v_mfma_f32_16x16x32_bf16 v[76:79], a[16:19], a[104:107], v[76:79]
    v_mfma_f32_16x16x32_bf16 a[232:235], a[20:23], a[108:111], a[232:235]
    ds_read_b64_tr_b16 a[8:9], v230 offset:47104
    s_waitcnt lgkmcnt(5)
    v_mfma_f32_16x16x32_bf16 v[80:83], a[24:27], a[92:95], v[80:83]
    ds_read_b64_tr_b16 a[10:11], v230 offset:54272
    v_mfma_f32_16x16x32_bf16 v[84:87], a[24:27], a[96:99], v[84:87]
    ds_read_b64_tr_b16 a[12:13], v231 offset:47104
    v_mfma_f32_16x16x32_bf16 v[88:91], a[24:27], a[100:103], v[88:91]
    ds_read_b64_tr_b16 a[14:15], v231 offset:54272
    v_mfma_f32_16x16x32_bf16 v[92:95], a[24:27], a[104:107], v[92:95]
    buffer_load_dwordx4 a[220:223], v251, s[28:31], s53 offen offset:2048 sc1
    v_mfma_f32_16x16x32_bf16 v[108:111], a[28:31], a[104:107], v[108:111]
    ds_read_b64_tr_b16 a[16:17], v232 offset:47104
    v_mfma_f32_16x16x32_bf16 v[104:107], a[28:31], a[100:103], v[104:107]
    buffer_load_dwordx4 a[224:227], v252, s[28:31], s53 offen offset:3072 sc1
    v_mfma_f32_16x16x32_bf16 v[100:103], a[28:31], a[96:99], v[100:103]
    ds_read_b64_tr_b16 a[18:19], v232 offset:54272
    v_mfma_f32_16x16x32_bf16 v[96:99], a[28:31], a[92:95], v[96:99]
    s_waitcnt lgkmcnt(6)
    v_mfma_f32_16x16x32_bf16 v[112:115], a[0:3], a[92:95], v[112:115]
    ds_read_b64_tr_b16 a[20:21], v247 offset:47104
    v_mfma_f32_16x16x32_bf16 v[116:119], a[0:3], a[96:99], v[116:119]
    ds_read_b64_tr_b16 a[22:23], v247 offset:54272
    v_mfma_f32_16x16x32_bf16 v[120:123], a[0:3], a[100:103], v[120:123]
    v_mfma_f32_16x16x32_bf16 v[124:127], a[0:3], a[104:107], v[124:127]
    v_mfma_f32_16x16x32_bf16 v[140:143], a[104:107], a[4:7], v[140:143]
    ds_read_b64_tr_b16 a[24:25], v233 offset:49152
    v_mfma_f32_16x16x32_bf16 v[136:139], a[100:103], a[4:7], v[136:139]
    buffer_load_dwordx4 a[228:231], v225, s[28:31], s53 offen sc1
    v_mfma_f32_16x16x32_bf16 v[132:135], a[96:99], a[4:7], v[132:135]
    ds_read_b64_tr_b16 a[26:27], v233 offset:56320
    v_mfma_f32_16x16x32_bf16 v[128:131], a[92:95], a[4:7], v[128:131]
    s_waitcnt lgkmcnt(6)
    v_mfma_f32_16x16x32_bf16 v[144:147], a[92:95], a[8:11], v[144:147]
    ds_read_b64_tr_b16 a[28:29], v234 offset:49152
    v_mfma_f32_16x16x32_bf16 v[148:151], a[96:99], a[8:11], v[148:151]
    ds_read_b64_tr_b16 a[30:31], v234 offset:56320
    v_mfma_f32_16x16x32_bf16 v[152:155], a[100:103], a[8:11], v[152:155]
    v_mfma_f32_16x16x32_bf16 v[156:159], a[104:107], a[8:11], v[156:159]
    s_waitcnt vmcnt(36)
    s_barrier
    v_mfma_f32_16x16x32_bf16 v[172:175], a[104:107], a[12:15], v[172:175]
    ds_read_b64_tr_b16 a[0:1], v235 offset:0
    s_add_u32 s52, s52, s58
    s_add_u32 s53, s53, s58
    v_mfma_f32_16x16x32_bf16 v[168:171], a[100:103], a[12:15], v[168:171]
    ds_read_b64_tr_b16 a[2:3], v235 offset:7168
    s_add_u32 s56, s56, 1
    s_cmp_eq_u32 s56, 16
    v_mfma_f32_16x16x32_bf16 v[164:167], a[96:99], a[12:15], v[164:167]
    s_cbranch_scc0 L_tailsw_29
    v_accvgpr_read_b32 v250, a242
    v_accvgpr_read_b32 v251, a243
    v_mov_b32 v227, v226
    v_mov_b32 v228, v226
    global_load_dword a240, v[250:251], off
    s_lshl_b32 s1, s3, 14
    v_add_u32 v224, s1, v226
    v_add_u32 v250, 64512, v224
    v_add_u32 v251, 129024, v224
    v_add_u32 v252, 193536, v224
    v_add_u32 v225, 262144, v224
    s_mov_b64 s[28:29], s[18:19]
    s_mov_b32 s30, 0x380000
    s_mov_b64 s[32:33], s[8:9]
    s_mov_b32 s34, 0x200000
    s_mov_b64 s[40:41], s[8:9]
    s_mov_b32 s42, 0x200000
    s_mov_b32 s52, 524288
    s_mov_b32 s53, 851968
    s_mov_b32 s58, 655360
    s_mul_i32 s64, s3, 114688
    s_mov_b32 s59, 458752
    s_mov_b32 s61, 458752
    s_add_u32 s65, s64, 15360
    s_add_u32 s66, s64, 30720
    s_add_u32 s67, s64, 46080
    s_add_u32 s68, s64, 65536
    s_add_u32 s69, s64, 80896
    s_add_u32 s70, s64, 96256
L_tailsw_29:
    s_cmp_eq_u32 s56, 11
    v_mfma_f32_16x16x32_bf16 v[160:163], a[92:95], a[12:15], v[160:163]
    s_cselect_b32 s38, 0, s38
    s_add_u32 m0, s55, 0
    buffer_load_dword a240, v253, s[36:39], s17 offen
    s_waitcnt lgkmcnt(6)
    v_mfma_f32_16x16x32_bf16 v[176:179], a[92:95], a[16:19], v[176:179]
    ds_read_b64_tr_b16 a[4:5], v236 offset:0
    s_add_u32 s17, s17, s71
    v_mfma_f32_16x16x32_bf16 v[180:183], a[96:99], a[16:19], v[180:183]
    buffer_load_dwordx4 v227, s[32:35], s64 offen offset:0 lds
    s_add_u32 s64, s64, s59
    v_mfma_f32_16x16x32_bf16 v[184:187], a[100:103], a[16:19], v[184:187]
    ds_read_b64_tr_b16 a[6:7], v236 offset:7168
    v_mfma_f32_16x16x32_bf16 v[188:191], a[104:107], a[16:19], v[188:191]
    v_mfma_f32_16x16x32_bf16 a[236:239], a[108:111], a[20:23], a[236:239]
    ds_read_b64_tr_b16 a[8:9], v237 offset:0
    s_waitcnt lgkmcnt(5)
    v_mfma_f32_16x16x32_bf16 v[192:195], a[24:27], a[92:95], v[192:195]
    ds_read_b64_tr_b16 a[10:11], v237 offset:7168
    v_mfma_f32_16x16x32_bf16 v[196:199], a[24:27], a[96:99], v[196:199]
    ds_read_b64_tr_b16 a[12:13], v238 offset:0
    v_mfma_f32_16x16x32_bf16 v[200:203], a[24:27], a[100:103], v[200:203]
    ds_read_b64_tr_b16 a[14:15], v238 offset:7168
    v_mfma_f32_16x16x32_bf16 v[204:207], a[24:27], a[104:107], v[204:207]
    buffer_load_dwordx4 a[32:35], v224, s[28:31], s52 offen offset:0 sc1
    v_mfma_f32_16x16x32_bf16 v[220:223], a[28:31], a[104:107], v[220:223]
    ds_read_b64_tr_b16 a[16:17], v235 offset:2048
    v_mfma_f32_16x16x32_bf16 v[216:219], a[28:31], a[100:103], v[216:219]
    ds_read_b64_tr_b16 a[18:19], v235 offset:9216
    v_mfma_f32_16x16x32_bf16 v[212:215], a[28:31], a[96:99], v[212:215]
    v_mfma_f32_16x16x32_bf16 v[208:211], a[28:31], a[92:95], v[208:211]
    s_waitcnt lgkmcnt(6)
    v_mfma_f32_16x16x32_bf16 v[0:3], a[0:3], a[112:115], v[0:3]
    ds_read_b64_tr_b16 a[20:21], v248 offset:2048
    v_mfma_f32_16x16x32_bf16 v[4:7], a[0:3], a[116:119], v[4:7]
    buffer_load_dwordx4 v227, s[32:35], s65 offen offset:1024 lds
    s_add_u32 s65, s65, s59
    v_mfma_f32_16x16x32_bf16 v[8:11], a[0:3], a[120:123], v[8:11]
    ds_read_b64_tr_b16 a[22:23], v248 offset:9216
    v_mfma_f32_16x16x32_bf16 v[12:15], a[0:3], a[124:127], v[12:15]
    v_mfma_f32_16x16x32_bf16 v[28:31], a[4:7], a[124:127], v[28:31]
    ds_read_b64_tr_b16 a[24:25], v236 offset:2048
    v_mfma_f32_16x16x32_bf16 v[24:27], a[4:7], a[120:123], v[24:27]
    ds_read_b64_tr_b16 a[26:27], v236 offset:9216
    v_mfma_f32_16x16x32_bf16 v[20:23], a[4:7], a[116:119], v[20:23]
    v_mfma_f32_16x16x32_bf16 v[16:19], a[4:7], a[112:115], v[16:19]
    s_waitcnt lgkmcnt(6)
    v_mfma_f32_16x16x32_bf16 v[32:35], a[8:11], a[112:115], v[32:35]
    ds_read_b64_tr_b16 a[28:29], v237 offset:2048
    v_mfma_f32_16x16x32_bf16 v[36:39], a[8:11], a[116:119], v[36:39]
    buffer_load_dwordx4 a[36:39], v250, s[28:31], s52 offen offset:1024 sc1
    v_mfma_f32_16x16x32_bf16 v[40:43], a[8:11], a[120:123], v[40:43]
    ds_read_b64_tr_b16 a[30:31], v237 offset:9216
    v_mfma_f32_16x16x32_bf16 v[44:47], a[8:11], a[124:127], v[44:47]
    v_mfma_f32_16x16x32_bf16 v[60:63], a[12:15], a[124:127], v[60:63]
    ds_read_b64_tr_b16 a[0:1], v238 offset:2048
    v_mfma_f32_16x16x32_bf16 v[56:59], a[12:15], a[120:123], v[56:59]
    buffer_load_dwordx4 v227, s[32:35], s66 offen offset:2048 lds
    s_add_u32 s66, s66, s59
    v_mfma_f32_16x16x32_bf16 v[52:55], a[12:15], a[116:119], v[52:55]
    ds_read_b64_tr_b16 a[2:3], v238 offset:9216
    v_mfma_f32_16x16x32_bf16 v[48:51], a[12:15], a[112:115], v[48:51]
    s_waitcnt lgkmcnt(6)
    v_mfma_f32_16x16x32_bf16 v[64:67], a[16:19], a[112:115], v[64:67]
    ds_read_b64_tr_b16 a[4:5], v235 offset:4096
    v_mfma_f32_16x16x32_bf16 v[68:71], a[16:19], a[116:119], v[68:71]
    ds_read_b64_tr_b16 a[6:7], v235 offset:11264
    v_mfma_f32_16x16x32_bf16 v[72:75], a[16:19], a[120:123], v[72:75]
    v_mfma_f32_16x16x32_bf16 v[76:79], a[16:19], a[124:127], v[76:79]
    v_mfma_f32_16x16x32_bf16 a[232:235], a[20:23], a[128:131], a[232:235]
    ds_read_b64_tr_b16 a[8:9], v236 offset:4096
    s_waitcnt lgkmcnt(5)
    v_mfma_f32_16x16x32_bf16 v[80:83], a[24:27], a[112:115], v[80:83]
    ds_read_b64_tr_b16 a[10:11], v236 offset:11264
    v_mfma_f32_16x16x32_bf16 v[84:87], a[24:27], a[116:119], v[84:87]
    ds_read_b64_tr_b16 a[12:13], v237 offset:4096
    v_mfma_f32_16x16x32_bf16 v[88:91], a[24:27], a[120:123], v[88:91]
    ds_read_b64_tr_b16 a[14:15], v237 offset:11264
    v_mfma_f32_16x16x32_bf16 v[92:95], a[24:27], a[124:127], v[92:95]
    buffer_load_dwordx4 a[40:43], v251, s[28:31], s52 offen offset:2048 sc1
    v_mfma_f32_16x16x32_bf16 v[108:111], a[28:31], a[124:127], v[108:111]
    ds_read_b64_tr_b16 a[16:17], v238 offset:4096
    v_mfma_f32_16x16x32_bf16 v[104:107], a[28:31], a[120:123], v[104:107]
    buffer_load_dwordx4 v227, s[32:35], s67 offen offset:3072 lds
    s_add_u32 s67, s67, s59
    v_mfma_f32_16x16x32_bf16 v[100:103], a[28:31], a[116:119], v[100:103]
    ds_read_b64_tr_b16 a[18:19], v238 offset:11264
    v_mfma_f32_16x16x32_bf16 v[96:99], a[28:31], a[112:115], v[96:99]
    s_waitcnt lgkmcnt(6)
    v_mfma_f32_16x16x32_bf16 v[112:115], a[0:3], a[112:115], v[112:115]
    ds_read_b64_tr_b16 a[20:21], v248 offset:4096
    v_mfma_f32_16x16x32_bf16 v[116:119], a[0:3], a[116:119], v[116:119]
    ds_read_b64_tr_b16 a[22:23], v248 offset:11264
    v_mfma_f32_16x16x32_bf16 v[120:123], a[0:3], a[120:123], v[120:123]
    v_mfma_f32_16x16x32_bf16 v[124:127], a[0:3], a[124:127], v[124:127]
    v_mfma_f32_16x16x32_bf16 v[140:143], a[124:127], a[4:7], v[140:143]
    ds_read_b64_tr_b16 a[24:25], v239 offset:6144
    v_mfma_f32_16x16x32_bf16 v[136:139], a[120:123], a[4:7], v[136:139]
    buffer_load_dwordx4 a[44:47], v252, s[28:31], s52 offen offset:3072 sc1
    v_mfma_f32_16x16x32_bf16 v[132:135], a[116:119], a[4:7], v[132:135]
    ds_read_b64_tr_b16 a[26:27], v239 offset:13312
    v_mfma_f32_16x16x32_bf16 v[128:131], a[112:115], a[4:7], v[128:131]
    s_waitcnt lgkmcnt(6)
    v_mfma_f32_16x16x32_bf16 v[144:147], a[112:115], a[8:11], v[144:147]
    ds_read_b64_tr_b16 a[28:29], v240 offset:6144
    v_mfma_f32_16x16x32_bf16 v[148:151], a[116:119], a[8:11], v[148:151]
    ds_read_b64_tr_b16 a[30:31], v240 offset:13312
    v_mfma_f32_16x16x32_bf16 v[152:155], a[120:123], a[8:11], v[152:155]
    v_mfma_f32_16x16x32_bf16 v[156:159], a[124:127], a[8:11], v[156:159]
    v_mfma_f32_16x16x32_bf16 v[172:175], a[124:127], a[12:15], v[172:175]
    ds_read_b64_tr_b16 a[0:1], v235 offset:14336
    s_add_u32 m0, s55, 4096
    v_mfma_f32_16x16x32_bf16 v[168:171], a[120:123], a[12:15], v[168:171]
    buffer_load_dwordx4 v227, s[32:35], s68 offen offset:0 lds
    s_add_u32 s68, s68, s59
    v_mfma_f32_16x16x32_bf16 v[164:167], a[116:119], a[12:15], v[164:167]
    ds_read_b64_tr_b16 a[2:3], v235 offset:21504
    v_mfma_f32_16x16x32_bf16 v[160:163], a[112:115], a[12:15], v[160:163]
    s_waitcnt lgkmcnt(6)
    v_mfma_f32_16x16x32_bf16 v[176:179], a[112:115], a[16:19], v[176:179]
    ds_read_b64_tr_b16 a[4:5], v236 offset:14336
    v_mfma_f32_16x16x32_bf16 v[180:183], a[116:119], a[16:19], v[180:183]
    buffer_load_dwordx4 a[48:51], v225, s[28:31], s52 offen sc1
    v_mfma_f32_16x16x32_bf16 v[184:187], a[120:123], a[16:19], v[184:187]
    ds_read_b64_tr_b16 a[6:7], v236 offset:21504
    v_mfma_f32_16x16x32_bf16 v[188:191], a[124:127], a[16:19], v[188:191]
    v_mfma_f32_16x16x32_bf16 a[236:239], a[128:131], a[20:23], a[236:239]
    ds_read_b64_tr_b16 a[8:9], v237 offset:14336
    s_waitcnt lgkmcnt(5)
    v_mfma_f32_16x16x32_bf16 v[192:195], a[24:27], a[112:115], v[192:195]
    ds_read_b64_tr_b16 a[10:11], v237 offset:21504
    v_mfma_f32_16x16x32_bf16 v[196:199], a[24:27], a[116:119], v[196:199]
    ds_read_b64_tr_b16 a[12:13], v238 offset:14336
    v_mfma_f32_16x16x32_bf16 v[200:203], a[24:27], a[120:123], v[200:203]
    ds_read_b64_tr_b16 a[14:15], v238 offset:21504
    v_mfma_f32_16x16x32_bf16 v[204:207], a[24:27], a[124:127], v[204:207]
    buffer_load_dwordx4 v227, s[32:35], s69 offen offset:1024 lds
    s_add_u32 s69, s69, s59
    v_mfma_f32_16x16x32_bf16 v[220:223], a[28:31], a[124:127], v[220:223]
    ds_read_b64_tr_b16 a[16:17], v235 offset:16384
    v_mfma_f32_16x16x32_bf16 v[216:219], a[28:31], a[120:123], v[216:219]
    ds_read_b64_tr_b16 a[18:19], v235 offset:23552
    v_mfma_f32_16x16x32_bf16 v[212:215], a[28:31], a[116:119], v[212:215]
    v_mfma_f32_16x16x32_bf16 v[208:211], a[28:31], a[112:115], v[208:211]
    s_waitcnt lgkmcnt(6)
    v_mfma_f32_16x16x32_bf16 v[0:3], a[0:3], a[132:135], v[0:3]
    ds_read_b64_tr_b16 a[20:21], v248 offset:16384
    v_mfma_f32_16x16x32_bf16 v[4:7], a[0:3], a[136:139], v[4:7]
    buffer_load_dwordx4 a[52:55], v224, s[28:31], s53 offen offset:0 sc1
    v_mfma_f32_16x16x32_bf16 v[8:11], a[0:3], a[140:143], v[8:11]
    ds_read_b64_tr_b16 a[22:23], v248 offset:23552
    v_mfma_f32_16x16x32_bf16 v[12:15], a[0:3], a[144:147], v[12:15]
    v_mfma_f32_16x16x32_bf16 v[28:31], a[4:7], a[144:147], v[28:31]
    ds_read_b64_tr_b16 a[24:25], v236 offset:16384
    v_mfma_f32_16x16x32_bf16 v[24:27], a[4:7], a[140:143], v[24:27]
    ds_read_b64_tr_b16 a[26:27], v236 offset:23552
    v_mfma_f32_16x16x32_bf16 v[20:23], a[4:7], a[136:139], v[20:23]
    v_mfma_f32_16x16x32_bf16 v[16:19], a[4:7], a[132:135], v[16:19]
    s_waitcnt lgkmcnt(6)
    v_mfma_f32_16x16x32_bf16 v[32:35], a[8:11], a[132:135], v[32:35]
    ds_read_b64_tr_b16 a[28:29], v237 offset:16384
    v_mfma_f32_16x16x32_bf16 v[36:39], a[8:11], a[136:139], v[36:39]
    buffer_load_dwordx4 v228, s[40:43], s70 offen offset:2048 lds
    s_add_u32 s70, s70, s61
    v_mfma_f32_16x16x32_bf16 v[40:43], a[8:11], a[140:143], v[40:43]
    ds_read_b64_tr_b16 a[30:31], v237 offset:23552
    v_mfma_f32_16x16x32_bf16 v[44:47], a[8:11], a[144:147], v[44:47]
    v_mfma_f32_16x16x32_bf16 v[60:63], a[12:15], a[144:147], v[60:63]
    ds_read_b64_tr_b16 a[0:1], v238 offset:16384
    v_mfma_f32_16x16x32_bf16 v[56:59], a[12:15], a[140:143], v[56:59]
    buffer_load_dwordx4 a[56:59], v250, s[28:31], s53 offen offset:1024 sc1
    v_mfma_f32_16x16x32_bf16 v[52:55], a[12:15], a[136:139], v[52:55]
    ds_read_b64_tr_b16 a[2:3], v238 offset:23552
    v_mfma_f32_16x16x32_bf16 v[48:51], a[12:15], a[132:135], v[48:51]
    s_waitcnt lgkmcnt(6)
    v_mfma_f32_16x16x32_bf16 v[64:67], a[16:19], a[132:135], v[64:67]
    ds_read_b64_tr_b16 a[4:5], v235 offset:18432
    v_mfma_f32_16x16x32_bf16 v[68:71], a[16:19], a[136:139], v[68:71]
    ds_read_b64_tr_b16 a[6:7], v235 offset:25600
    v_mfma_f32_16x16x32_bf16 v[72:75], a[16:19], a[140:143], v[72:75]
    v_mfma_f32_16x16x32_bf16 v[76:79], a[16:19], a[144:147], v[76:79]
    v_mfma_f32_16x16x32_bf16 a[232:235], a[20:23], a[148:151], a[232:235]
    ds_read_b64_tr_b16 a[8:9], v236 offset:18432
    s_waitcnt lgkmcnt(5)
    v_mfma_f32_16x16x32_bf16 v[80:83], a[24:27], a[132:135], v[80:83]
    ds_read_b64_tr_b16 a[10:11], v236 offset:25600
    v_mfma_f32_16x16x32_bf16 v[84:87], a[24:27], a[136:139], v[84:87]
    ds_read_b64_tr_b16 a[12:13], v237 offset:18432
    v_mfma_f32_16x16x32_bf16 v[88:91], a[24:27], a[140:143], v[88:91]
    ds_read_b64_tr_b16 a[14:15], v237 offset:25600
    v_mfma_f32_16x16x32_bf16 v[92:95], a[24:27], a[144:147], v[92:95]
    buffer_load_dwordx4 a[60:63], v251, s[28:31], s53 offen offset:2048 sc1
    v_mfma_f32_16x16x32_bf16 v[108:111], a[28:31], a[144:147], v[108:111]
    ds_read_b64_tr_b16 a[16:17], v238 offset:18432
    v_mfma_f32_16x16x32_bf16 v[104:107], a[28:31], a[140:143], v[104:107]
    buffer_load_dwordx4 a[64:67], v252, s[28:31], s53 offen offset:3072 sc1
    v_mfma_f32_16x16x32_bf16 v[100:103], a[28:31], a[136:139], v[100:103]
    ds_read_b64_tr_b16 a[18:19], v238 offset:25600
    v_mfma_f32_16x16x32_bf16 v[96:99], a[28:31], a[132:135], v[96:99]
    s_waitcnt lgkmcnt(6)
    v_mfma_f32_16x16x32_bf16 v[112:115], a[0:3], a[132:135], v[112:115]
    ds_read_b64_tr_b16 a[20:21], v248 offset:18432
    v_mfma_f32_16x16x32_bf16 v[116:119], a[0:3], a[136:139], v[116:119]
    ds_read_b64_tr_b16 a[22:23], v248 offset:25600
    v_mfma_f32_16x16x32_bf16 v[120:123], a[0:3], a[140:143], v[120:123]
    v_mfma_f32_16x16x32_bf16 v[124:127], a[0:3], a[144:147], v[124:127]
    v_mfma_f32_16x16x32_bf16 v[140:143], a[144:147], a[4:7], v[140:143]
    ds_read_b64_tr_b16 a[24:25], v239 offset:20480
    v_mfma_f32_16x16x32_bf16 v[136:139], a[140:143], a[4:7], v[136:139]
    buffer_load_dwordx4 a[68:71], v225, s[28:31], s53 offen sc1
    v_mfma_f32_16x16x32_bf16 v[132:135], a[136:139], a[4:7], v[132:135]
    ds_read_b64_tr_b16 a[26:27], v239 offset:27648
    v_mfma_f32_16x16x32_bf16 v[128:131], a[132:135], a[4:7], v[128:131]
    s_waitcnt lgkmcnt(6)
    v_mfma_f32_16x16x32_bf16 v[144:147], a[132:135], a[8:11], v[144:147]
    ds_read_b64_tr_b16 a[28:29], v240 offset:20480
    v_mfma_f32_16x16x32_bf16 v[148:151], a[136:139], a[8:11], v[148:151]
    ds_read_b64_tr_b16 a[30:31], v240 offset:27648
    v_mfma_f32_16x16x32_bf16 v[152:155], a[140:143], a[8:11], v[152:155]
    v_mfma_f32_16x16x32_bf16 v[156:159], a[144:147], a[8:11], v[156:159]
    s_waitcnt vmcnt(36)
    s_barrier
    v_mfma_f32_16x16x32_bf16 v[172:175], a[144:147], a[12:15], v[172:175]
    ds_read_b64_tr_b16 a[0:1], v235 offset:28672
    s_add_u32 s52, s52, s58
    s_add_u32 s53, s53, s58
    v_mfma_f32_16x16x32_bf16 v[168:171], a[140:143], a[12:15], v[168:171]
    s_add_u32 s56, s56, 1
    s_add_u32 m0, s55, 28672
    buffer_load_dword a240, v253, s[36:39], s17 offen
    v_mfma_f32_16x16x32_bf16 v[164:167], a[136:139], a[12:15], v[164:167]
    ds_read_b64_tr_b16 a[2:3], v235 offset:35840
    s_add_u32 s17, s17, s71
    v_mfma_f32_16x16x32_bf16 v[160:163], a[132:135], a[12:15], v[160:163]
    s_waitcnt lgkmcnt(6)
    v_mfma_f32_16x16x32_bf16 v[176:179], a[132:135], a[16:19], v[176:179]
    ds_read_b64_tr_b16 a[4:5], v236 offset:28672
    v_mfma_f32_16x16x32_bf16 v[180:183], a[136:139], a[16:19], v[180:183]
    buffer_load_dwordx4 v227, s[32:35], s64 offen offset:0 lds
    s_add_u32 s64, s64, s59
    v_mfma_f32_16x16x32_bf16 v[184:187], a[140:143], a[16:19], v[184:187]
    ds_read_b64_tr_b16 a[6:7], v236 offset:35840
    v_mfma_f32_16x16x32_bf16 v[188:191], a[144:147], a[16:19], v[188:191]
    v_mfma_f32_16x16x32_bf16 a[236:239], a[148:151], a[20:23], a[236:239]
    ds_read_b64_tr_b16 a[8:9], v237 offset:28672
    s_waitcnt lgkmcnt(5)
    v_mfma_f32_16x16x32_bf16 v[192:195], a[24:27], a[132:135], v[192:195]
    ds_read_b64_tr_b16 a[10:11], v237 offset:35840
    v_mfma_f32_16x16x32_bf16 v[196:199], a[24:27], a[136:139], v[196:199]
    ds_read_b64_tr_b16 a[12:13], v238 offset:28672
    v_mfma_f32_16x16x32_bf16 v[200:203], a[24:27], a[140:143], v[200:203]
    ds_read_b64_tr_b16 a[14:15], v238 offset:35840
    v_mfma_f32_16x16x32_bf16 v[204:207], a[24:27], a[144:147], v[204:207]
    buffer_load_dwordx4 a[72:75], v224, s[28:31], s52 offen offset:0 sc1
    v_mfma_f32_16x16x32_bf16 v[220:223], a[28:31], a[144:147], v[220:223]
    ds_read_b64_tr_b16 a[16:17], v235 offset:30720
    v_mfma_f32_16x16x32_bf16 v[216:219], a[28:31], a[140:143], v[216:219]
    s_branch L_po_q_4
.p2align 12
L_pg_q_4:
    s_branch L_pg_K_0
L_po_q_4:
    ds_read_b64_tr_b16 a[18:19], v235 offset:37888
    v_mfma_f32_16x16x32_bf16 v[212:215], a[28:31], a[136:139], v[212:215]
    v_mfma_f32_16x16x32_bf16 v[208:211], a[28:31], a[132:135], v[208:211]
    s_waitcnt lgkmcnt(6)
    v_mfma_f32_16x16x32_bf16 v[0:3], a[0:3], a[152:155], v[0:3]
    ds_read_b64_tr_b16 a[20:21], v248 offset:30720
    v_mfma_f32_16x16x32_bf16 v[4:7], a[0:3], a[156:159], v[4:7]
    buffer_load_dwordx4 v227, s[32:35], s65 offen offset:1024 lds
    s_add_u32 s65, s65, s59
    v_mfma_f32_16x16x32_bf16 v[8:11], a[0:3], a[160:163], v[8:11]
    ds_read_b64_tr_b16 a[22:23], v248 offset:37888
    v_mfma_f32_16x16x32_bf16 v[12:15], a[0:3], a[164:167], v[12:15]
    v_mfma_f32_16x16x32_bf16 v[28:31], a[4:7], a[164:167], v[28:31]
    ds_read_b64_tr_b16 a[24:25], v236 offset:30720
    v_mfma_f32_16x16x32_bf16 v[24:27], a[4:7], a[160:163], v[24:27]
    ds_read_b64_tr_b16 a[26:27], v236 offset:37888
    v_mfma_f32_16x16x32_bf16 v[20:23], a[4:7], a[156:159], v[20:23]
    v_mfma_f32_16x16x32_bf16 v[16:19], a[4:7], a[152:155], v[16:19]
    s_waitcnt lgkmcnt(6)
    v_mfma_f32_16x16x32_bf16 v[32:35], a[8:11], a[152:155], v[32:35]
    ds_read_b64_tr_b16 a[28:29], v237 offset:30720
    v_mfma_f32_16x16x32_bf16 v[36:39], a[8:11], a[156:159], v[36:39]
    buffer_load_dwordx4 a[76:79], v250, s[28:31], s52 offen offset:1024 sc1
    v_mfma_f32_16x16x32_bf16 v[40:43], a[8:11], a[160:163], v[40:43]
    ds_read_b64_tr_b16 a[30:31], v237 offset:37888
    v_mfma_f32_16x16x32_bf16 v[44:47], a[8:11], a[164:167], v[44:47]
    v_mfma_f32_16x16x32_bf16 v[60:63], a[12:15], a[164:167], v[60:63]
    ds_read_b64_tr_b16 a[0:1], v238 offset:30720
    v_mfma_f32_16x16x32_bf16 v[56:59], a[12:15], a[160:163], v[56:59]
    buffer_load_dwordx4 v227, s[32:35], s66 offen offset:2048 lds
    s_add_u32 s66, s66, s59
    v_mfma_f32_16x16x32_bf16 v[52:55], a[12:15], a[156:159], v[52:55]
    ds_read_b64_tr_b16 a[2:3], v238 offset:37888
    v_mfma_f32_16x16x32_bf16 v[48:51], a[12:15], a[152:155], v[48:51]
    s_waitcnt lgkmcnt(6)
    v_mfma_f32_16x16x32_bf16 v[64:67], a[16:19], a[152:155], v[64:67]
    ds_read_b64_tr_b16 a[4:5], v235 offset:32768
    v_mfma_f32_16x16x32_bf16 v[68:71], a[16:19], a[156:159], v[68:71]
    ds_read_b64_tr_b16 a[6:7], v235 offset:39936
    v_mfma_f32_16x16x32_bf16 v[72:75], a[16:19], a[160:163], v[72:75]
    v_mfma_f32_16x16x32_bf16 v[76:79], a[16:19], a[164:167], v[76:79]
    v_mfma_f32_16x16x32_bf16 a[232:235], a[20:23], a[168:171], a[232:235]
    ds_read_b64_tr_b16 a[8:9], v236 offset:32768
    s_waitcnt lgkmcnt(5)
    v_mfma_f32_16x16x32_bf16 v[80:83], a[24:27], a[152:155], v[80:83]
    ds_read_b64_tr_b16 a[10:11], v236 offset:39936
    v_mfma_f32_16x16x32_bf16 v[84:87], a[24:27], a[156:159], v[84:87]
    ds_read_b64_tr_b16 a[12:13], v237 offset:32768
    v_mfma_f32_16x16x32_bf16 v[88:91], a[24:27], a[160:163], v[88:91]
    ds_read_b64_tr_b16 a[14:15], v237 offset:39936
    v_mfma_f32_16x16x32_bf16 v[92:95], a[24:27], a[164:167], v[92:95]
    buffer_load_dwordx4 a[80:83], v251, s[28:31], s52 offen offset:2048 sc1
    v_mfma_f32_16x16x32_bf16 v[108:111], a[28:31], a[164:167], v[108:111]
    ds_read_b64_tr_b16 a[16:17], v238 offset:32768
    v_mfma_f32_16x16x32_bf16 v[104:107], a[28:31], a[160:163], v[104:107]
    buffer_load_dwordx4 v227, s[32:35], s67 offen offset:3072 lds
    s_add_u32 s67, s67, s59
    v_mfma_f32_16x16x32_bf16 v[100:103], a[28:31], a[156:159], v[100:103]
    ds_read_b64_tr_b16 a[18:19], v238 offset:39936
    v_mfma_f32_16x16x32_bf16 v[96:99], a[28:31], a[152:155], v[96:99]
    s_waitcnt lgkmcnt(6)
    v_mfma_f32_16x16x32_bf16 v[112:115], a[0:3], a[152:155], v[112:115]
    ds_read_b64_tr_b16 a[20:21], v248 offset:32768
    v_mfma_f32_16x16x32_bf16 v[116:119], a[0:3], a[156:159], v[116:119]
    ds_read_b64_tr_b16 a[22:23], v248 offset:39936
    v_mfma_f32_16x16x32_bf16 v[120:123], a[0:3], a[160:163], v[120:123]
    v_mfma_f32_16x16x32_bf16 v[124:127], a[0:3], a[164:167], v[124:127]
    v_mfma_f32_16x16x32_bf16 v[140:143], a[164:167], a[4:7], v[140:143]
    ds_read_b64_tr_b16 a[24:25], v239 offset:34816
    v_mfma_f32_16x16x32_bf16 v[136:139], a[160:163], a[4:7], v[136:139]
    buffer_load_dwordx4 a[84:87], v252, s[28:31], s52 offen offset:3072 sc1
    v_mfma_f32_16x16x32_bf16 v[132:135], a[156:159], a[4:7], v[132:135]
    ds_read_b64_tr_b16 a[26:27], v239 offset:41984
    v_mfma_f32_16x16x32_bf16 v[128:131], a[152:155], a[4:7], v[128:131]
    s_waitcnt lgkmcnt(6)
    v_mfma_f32_16x16x32_bf16 v[144:147], a[152:155], a[8:11], v[144:147]
    ds_read_b64_tr_b16 a[28:29], v240 offset:34816
    v_mfma_f32_16x16x32_bf16 v[148:151], a[156:159], a[8:11], v[148:151]
    ds_read_b64_tr_b16 a[30:31], v240 offset:41984
    v_mfma_f32_16x16x32_bf16 v[152:155], a[160:163], a[8:11], v[152:155]
    v_mfma_f32_16x16x32_bf16 v[156:159], a[164:167], a[8:11], v[156:159]
    v_mfma_f32_16x16x32_bf16 v[172:175], a[164:167], a[12:15], v[172:175]
    ds_read_b64_tr_b16 a[0:1], v235 offset:43008
    s_add_u32 m0, s55, 32768
    v_mfma_f32_16x16x32_bf16 v[168:171], a[160:163], a[12:15], v[168:171]
    buffer_load_dwordx4 v227, s[32:35], s68 offen offset:0 lds
    s_add_u32 s68, s68, s59
    v_mfma_f32_16x16x32_bf16 v[164:167], a[156:159], a[12:15], v[164:167]
    ds_read_b64_tr_b16 a[2:3], v235 offset:50176
    v_mfma_f32_16x16x32_bf16 v[160:163], a[152:155], a[12:15], v[160:163]
    s_waitcnt lgkmcnt(6)
    v_mfma_f32_16x16x32_bf16 v[176:179], a[152:155], a[16:19], v[176:179]
    ds_read_b64_tr_b16 a[4:5], v236 offset:43008
    v_mfma_f32_16x16x32_bf16 v[180:183], a[156:159], a[16:19], v[180:183]
    buffer_load_dwordx4 a[88:91], v225, s[28:31], s52 offen sc1
    v_mfma_f32_16x16x32_bf16 v[184:187], a[160:163], a[16:19], v[184:187]
    ds_read_b64_tr_b16 a[6:7], v236 offset:50176
    v_mfma_f32_16x16x32_bf16 v[188:191], a[164:167], a[16:19], v[188:191]
    v_mfma_f32_16x16x32_bf16 a[236:239], a[168:171], a[20:23], a[236:239]
    ds_read_b64_tr_b16 a[8:9], v237 offset:43008
    s_waitcnt lgkmcnt(5)
    v_mfma_f32_16x16x32_bf16 v[192:195], a[24:27], a[152:155], v[192:195]
    ds_read_b64_tr_b16 a[10:11], v237 offset:50176
    v_mfma_f32_16x16x32_bf16 v[196:199], a[24:27], a[156:159], v[196:199]
    ds_read_b64_tr_b16 a[12:13], v238 offset:43008
    v_mfma_f32_16x16x32_bf16 v[200:203], a[24:27], a[160:163], v[200:203]
    ds_read_b64_tr_b16 a[14:15], v238 offset:50176
    v_mfma_f32_16x16x32_bf16 v[204:207], a[24:27], a[164:167], v[204:207]
    buffer_load_dwordx4 v227, s[32:35], s69 offen offset:1024 lds
    s_add_u32 s69, s69, s59
    v_mfma_f32_16x16x32_bf16 v[220:223], a[28:31], a[164:167], v[220:223]
    ds_read_b64_tr_b16 a[16:17], v235 offset:45056
    v_mfma_f32_16x16x32_bf16 v[216:219], a[28:31], a[160:163], v[216:219]
    ds_read_b64_tr_b16 a[18:19], v235 offset:52224
    v_mfma_f32_16x16x32_bf16 v[212:215], a[28:31], a[156:159], v[212:215]
    v_mfma_f32_16x16x32_bf16 v[208:211], a[28:31], a[152:155], v[208:211]
    s_waitcnt lgkmcnt(6)
    v_mfma_f32_16x16x32_bf16 v[0:3], a[0:3], a[172:175], v[0:3]
    ds_read_b64_tr_b16 a[20:21], v248 offset:45056
    v_mfma_f32_16x16x32_bf16 v[4:7], a[0:3], a[176:179], v[4:7]
    buffer_load_dwordx4 a[92:95], v224, s[28:31], s53 offen offset:0 sc1
    v_mfma_f32_16x16x32_bf16 v[8:11], a[0:3], a[180:183], v[8:11]
    ds_read_b64_tr_b16 a[22:23], v248 offset:52224
    v_mfma_f32_16x16x32_bf16 v[12:15], a[0:3], a[184:187], v[12:15]
    v_mfma_f32_16x16x32_bf16 v[28:31], a[4:7], a[184:187], v[28:31]
    ds_read_b64_tr_b16 a[24:25], v236 offset:45056
    v_mfma_f32_16x16x32_bf16 v[24:27], a[4:7], a[180:183], v[24:27]
    ds_read_b64_tr_b16 a[26:27], v236 offset:52224
    v_mfma_f32_16x16x32_bf16 v[20:23], a[4:7], a[176:179], v[20:23]
    v_mfma_f32_16x16x32_bf16 v[16:19], a[4:7], a[172:175], v[16:19]
    s_waitcnt lgkmcnt(6)
    v_mfma_f32_16x16x32_bf16 v[32:35], a[8:11], a[172:175], v[32:35]
    ds_read_b64_tr_b16 a[28:29], v237 offset:45056
    v_mfma_f32_16x16x32_bf16 v[36:39], a[8:11], a[176:179], v[36:39]
    buffer_load_dwordx4 v228, s[40:43], s70 offen offset:2048 lds
    s_add_u32 s70, s70, s61
    v_mfma_f32_16x16x32_bf16 v[40:43], a[8:11], a[180:183], v[40:43]
    ds_read_b64_tr_b16 a[30:31], v237 offset:52224
    v_mfma_f32_16x16x32_bf16 v[44:47], a[8:11], a[184:187], v[44:47]
    v_mfma_f32_16x16x32_bf16 v[60:63], a[12:15], a[184:187], v[60:63]
    ds_read_b64_tr_b16 a[0:1], v238 offset:45056
    v_mfma_f32_16x16x32_bf16 v[56:59], a[12:15], a[180:183], v[56:59]
    buffer_load_dwordx4 a[96:99], v250, s[28:31], s53 offen offset:1024 sc1
    v_mfma_f32_16x16x32_bf16 v[52:55], a[12:15], a[176:179], v[52:55]
    ds_read_b64_tr_b16 a[2:3], v238 offset:52224
    v_mfma_f32_16x16x32_bf16 v[48:51], a[12:15], a[172:175], v[48:51]
    s_waitcnt lgkmcnt(6)
    v_mfma_f32_16x16x32_bf16 v[64:67], a[16:19], a[172:175], v[64:67]
    ds_read_b64_tr_b16 a[4:5], v235 offset:47104
    v_mfma_f32_16x16x32_bf16 v[68:71], a[16:19], a[176:179], v[68:71]
    ds_read_b64_tr_b16 a[6:7], v235 offset:54272
    v_mfma_f32_16x16x32_bf16 v[72:75], a[16:19], a[180:183], v[72:75]
    v_mfma_f32_16x16x32_bf16 v[76:79], a[16:19], a[184:187], v[76:79]
    v_mfma_f32_16x16x32_bf16 a[232:235], a[20:23], a[188:191], a[232:235]
    ds_read_b64_tr_b16 a[8:9], v236 offset:47104
    s_waitcnt lgkmcnt(5)
    v_mfma_f32_16x16x32_bf16 v[80:83], a[24:27], a[172:175], v[80:83]
    ds_read_b64_tr_b16 a[10:11], v236 offset:54272
    v_mfma_f32_16x16x32_bf16 v[84:87], a[24:27], a[176:179], v[84:87]
    ds_read_b64_tr_b16 a[12:13], v237 offset:47104
    v_mfma_f32_16x16x32_bf16 v[88:91], a[24:27], a[180:183], v[88:91]
    ds_read_b64_tr_b16 a[14:15], v237 offset:54272
    v_mfma_f32_16x16x32_bf16 v[92:95], a[24:27], a[184:187], v[92:95]
    buffer_load_dwordx4 a[100:103], v251, s[28:31], s53 offen offset:2048 sc1
    v_mfma_f32_16x16x32_bf16 v[108:111], a[28:31], a[184:187], v[108:111]
    ds_read_b64_tr_b16 a[16:17], v238 offset:47104
    v_mfma_f32_16x16x32_bf16 v[104:107], a[28:31], a[180:183], v[104:107]
    buffer_load_dwordx4 a[104:107], v252, s[28:31], s53 offen offset:3072 sc1
    v_mfma_f32_16x16x32_bf16 v[100:103], a[28:31], a[176:179], v[100:103]
    ds_read_b64_tr_b16 a[18:19], v238 offset:54272
    v_mfma_f32_16x16x32_bf16 v[96:99], a[28:31], a[172:175], v[96:99]
    s_waitcnt lgkmcnt(6)
    v_mfma_f32_16x16x32_bf16 v[112:115], a[0:3], a[172:175], v[112:115]
    ds_read_b64_tr_b16 a[20:21], v248 offset:47104
    v_mfma_f32_16x16x32_bf16 v[116:119], a[0:3], a[176:179], v[116:119]
    ds_read_b64_tr_b16 a[22:23], v248 offset:54272
    v_mfma_f32_16x16x32_bf16 v[120:123], a[0:3], a[180:183], v[120:123]
    v_mfma_f32_16x16x32_bf16 v[124:127], a[0:3], a[184:187], v[124:127]
    v_mfma_f32_16x16x32_bf16 v[140:143], a[184:187], a[4:7], v[140:143]
    ds_read_b64_tr_b16 a[24:25], v239 offset:49152
    v_mfma_f32_16x16x32_bf16 v[136:139], a[180:183], a[4:7], v[136:139]
    buffer_load_dwordx4 a[108:111], v225, s[28:31], s53 offen sc1
    v_mfma_f32_16x16x32_bf16 v[132:135], a[176:179], a[4:7], v[132:135]
    ds_read_b64_tr_b16 a[26:27], v239 offset:56320
    v_mfma_f32_16x16x32_bf16 v[128:131], a[172:175], a[4:7], v[128:131]
    s_waitcnt lgkmcnt(6)
    v_mfma_f32_16x16x32_bf16 v[144:147], a[172:175], a[8:11], v[144:147]
    ds_read_b64_tr_b16 a[28:29], v240 offset:49152
    v_mfma_f32_16x16x32_bf16 v[148:151], a[176:179], a[8:11], v[148:151]
    ds_read_b64_tr_b16 a[30:31], v240 offset:56320
    v_mfma_f32_16x16x32_bf16 v[152:155], a[180:183], a[8:11], v[152:155]
    v_mfma_f32_16x16x32_bf16 v[156:159], a[184:187], a[8:11], v[156:159]
    s_waitcnt vmcnt(36)
    s_barrier
    v_mfma_f32_16x16x32_bf16 v[172:175], a[184:187], a[12:15], v[172:175]
    ds_read_b64_tr_b16 a[0:1], v241 offset:0
    s_add_u32 s52, s52, s58
    s_add_u32 s53, s53, s58
    v_mfma_f32_16x16x32_bf16 v[168:171], a[180:183], a[12:15], v[168:171]
    ds_read_b64_tr_b16 a[2:3], v241 offset:7168
    s_add_u32 s56, s56, 1
    s_cmp_eq_u32 s56, 18
    v_mfma_f32_16x16x32_bf16 v[164:167], a[176:179], a[12:15], v[164:167]
    s_cselect_b32 s55, 163840, s55
    s_cselect_b32 s34, 0, s34
    v_mfma_f32_16x16x32_bf16 v[160:163], a[172:175], a[12:15], v[160:163]
    s_cselect_b32 s42, 0, s42
    s_add_u32 m0, s55, 57344
    buffer_load_dword a240, v253, s[36:39], s17 offen
    s_waitcnt lgkmcnt(6)
    v_mfma_f32_16x16x32_bf16 v[176:179], a[172:175], a[16:19], v[176:179]
    ds_read_b64_tr_b16 a[4:5], v242 offset:0
    s_add_u32 s17, s17, s71
    v_mfma_f32_16x16x32_bf16 v[180:183], a[176:179], a[16:19], v[180:183]
    buffer_load_dwordx4 v227, s[32:35], s64 offen offset:0 lds
    s_add_u32 s64, s64, s59
    v_mfma_f32_16x16x32_bf16 v[184:187], a[180:183], a[16:19], v[184:187]
    ds_read_b64_tr_b16 a[6:7], v242 offset:7168
    v_mfma_f32_16x16x32_bf16 v[188:191], a[184:187], a[16:19], v[188:191]
    v_mfma_f32_16x16x32_bf16 a[236:239], a[188:191], a[20:23], a[236:239]
    ds_read_b64_tr_b16 a[8:9], v243 offset:0
    s_waitcnt lgkmcnt(5)
    v_mfma_f32_16x16x32_bf16 v[192:195], a[24:27], a[172:175], v[192:195]
    ds_read_b64_tr_b16 a[10:11], v243 offset:7168
    v_mfma_f32_16x16x32_bf16 v[196:199], a[24:27], a[176:179], v[196:199]
    ds_read_b64_tr_b16 a[12:13], v244 offset:0
    v_mfma_f32_16x16x32_bf16 v[200:203], a[24:27], a[180:183], v[200:203]
    ds_read_b64_tr_b16 a[14:15], v244 offset:7168
    v_mfma_f32_16x16x32_bf16 v[204:207], a[24:27], a[184:187], v[204:207]
    buffer_load_dwordx4 a[112:115], v224, s[28:31], s52 offen offset:0 sc1
    v_mfma_f32_16x16x32_bf16 v[220:223], a[28:31], a[184:187], v[220:223]
    ds_read_b64_tr_b16 a[16:17], v241 offset:2048
    v_mfma_f32_16x16x32_bf16 v[216:219], a[28:31], a[180:183], v[216:219]
    ds_read_b64_tr_b16 a[18:19], v241 offset:9216
    v_mfma_f32_16x16x32_bf16 v[212:215], a[28:31], a[176:179], v[212:215]
    v_mfma_f32_16x16x32_bf16 v[208:211], a[28:31], a[172:175], v[208:211]
L_entry_25:
    s_waitcnt lgkmcnt(6)
    v_mfma_f32_16x16x32_bf16 v[0:3], a[0:3], a[192:195], v[0:3]
    ds_read_b64_tr_b16 a[20:21], v249 offset:2048
    v_mfma_f32_16x16x32_bf16 v[4:7], a[0:3], a[196:199], v[4:7]
    buffer_load_dwordx4 v227, s[32:35], s65 offen offset:1024 lds
    s_add_u32 s65, s65, s59
    v_mfma_f32_16x16x32_bf16 v[8:11], a[0:3], a[200:203], v[8:11]
    ds_read_b64_tr_b16 a[22:23], v249 offset:9216
    v_mfma_f32_16x16x32_bf16 v[12:15], a[0:3], a[204:207], v[12:15]
    v_mfma_f32_16x16x32_bf16 v[28:31], a[4:7], a[204:207], v[28:31]
    ds_read_b64_tr_b16 a[24:25], v242 offset:2048
    v_mfma_f32_16x16x32_bf16 v[24:27], a[4:7], a[200:203], v[24:27]
    ds_read_b64_tr_b16 a[26:27], v242 offset:9216
    v_mfma_f32_16x16x32_bf16 v[20:23], a[4:7], a[196:199], v[20:23]
    v_mfma_f32_16x16x32_bf16 v[16:19], a[4:7], a[192:195], v[16:19]
    s_waitcnt lgkmcnt(6)
    v_mfma_f32_16x16x32_bf16 v[32:35], a[8:11], a[192:195], v[32:35]
    ds_read_b64_tr_b16 a[28:29], v243 offset:2048
    v_mfma_f32_16x16x32_bf16 v[36:39], a[8:11], a[196:199], v[36:39]
    buffer_load_dwordx4 a[116:119], v250, s[28:31], s52 offen offset:1024 sc1
    v_mfma_f32_16x16x32_bf16 v[40:43], a[8:11], a[200:203], v[40:43]
    ds_read_b64_tr_b16 a[30:31], v243 offset:9216
    v_mfma_f32_16x16x32_bf16 v[44:47], a[8:11], a[204:207], v[44:47]
    v_mfma_f32_16x16x32_bf16 v[60:63], a[12:15], a[204:207], v[60:63]
    ds_read_b64_tr_b16 a[0:1], v244 offset:2048
    v_mfma_f32_16x16x32_bf16 v[56:59], a[12:15], a[200:203], v[56:59]
    buffer_load_dwordx4 v227, s[32:35], s66 offen offset:2048 lds
    s_add_u32 s66, s66, s59
    v_mfma_f32_16x16x32_bf16 v[52:55], a[12:15], a[196:199], v[52:55]
    ds_read_b64_tr_b16 a[2:3], v244 offset:9216
    v_mfma_f32_16x16x32_bf16 v[48:51], a[12:15], a[192:195], v[48:51]
    s_waitcnt lgkmcnt(6)
    v_mfma_f32_16x16x32_bf16 v[64:67], a[16:19], a[192:195], v[64:67]
    ds_read_b64_tr_b16 a[4:5], v241 offset:4096
    v_mfma_f32_16x16x32_bf16 v[68:71], a[16:19], a[196:199], v[68:71]
    ds_read_b64_tr_b16 a[6:7], v241 offset:11264
    v_mfma_f32_16x16x32_bf16 v[72:75], a[16:19], a[200:203], v[72:75]
    v_mfma_f32_16x16x32_bf16 v[76:79], a[16:19], a[204:207], v[76:79]
    v_mfma_f32_16x16x32_bf16 a[232:235], a[20:23], a[208:211], a[232:235]
    ds_read_b64_tr_b16 a[8:9], v242 offset:4096
    s_waitcnt lgkmcnt(5)
    v_mfma_f32_16x16x32_bf16 v[80:83], a[24:27], a[192:195], v[80:83]
    ds_read_b64_tr_b16 a[10:11], v242 offset:11264
    v_mfma_f32_16x16x32_bf16 v[84:87], a[24:27], a[196:199], v[84:87]
    ds_read_b64_tr_b16 a[12:13], v243 offset:4096
    v_mfma_f32_16x16x32_bf16 v[88:91], a[24:27], a[200:203], v[88:91]
    ds_read_b64_tr_b16 a[14:15], v243 offset:11264
    v_mfma_f32_16x16x32_bf16 v[92:95], a[24:27], a[204:207], v[92:95]
    buffer_load_dwordx4 a[120:123], v251, s[28:31], s52 offen offset:2048 sc1
    v_mfma_f32_16x16x32_bf16 v[108:111], a[28:31], a[204:207], v[108:111]
    ds_read_b64_tr_b16 a[16:17], v244 offset:4096
    v_mfma_f32_16x16x32_bf16 v[104:107], a[28:31], a[200:203], v[104:107]
    buffer_load_dwordx4 v227, s[32:35], s67 offen offset:3072 lds
    s_add_u32 s67, s67, s59
    v_mfma_f32_16x16x32_bf16 v[100:103], a[28:31], a[196:199], v[100:103]
    ds_read_b64_tr_b16 a[18:19], v244 offset:11264
    v_mfma_f32_16x16x32_bf16 v[96:99], a[28:31], a[192:195], v[96:99]
    s_waitcnt lgkmcnt(6)
    v_mfma_f32_16x16x32_bf16 v[112:115], a[0:3], a[192:195], v[112:115]
    ds_read_b64_tr_b16 a[20:21], v249 offset:4096
    v_mfma_f32_16x16x32_bf16 v[116:119], a[0:3], a[196:199], v[116:119]
    ds_read_b64_tr_b16 a[22:23], v249 offset:11264
    v_mfma_f32_16x16x32_bf16 v[120:123], a[0:3], a[200:203], v[120:123]
    v_mfma_f32_16x16x32_bf16 v[124:127], a[0:3], a[204:207], v[124:127]
    v_mfma_f32_16x16x32_bf16 v[140:143], a[204:207], a[4:7], v[140:143]
    ds_read_b64_tr_b16 a[24:25], v245 offset:6144
    v_mfma_f32_16x16x32_bf16 v[136:139], a[200:203], a[4:7], v[136:139]
    buffer_load_dwordx4 a[124:127], v252, s[28:31], s52 offen offset:3072 sc1
    v_mfma_f32_16x16x32_bf16 v[132:135], a[196:199], a[4:7], v[132:135]
    ds_read_b64_tr_b16 a[26:27], v245 offset:13312
    v_mfma_f32_16x16x32_bf16 v[128:131], a[192:195], a[4:7], v[128:131]
    s_waitcnt lgkmcnt(6)
    v_mfma_f32_16x16x32_bf16 v[144:147], a[192:195], a[8:11], v[144:147]
    ds_read_b64_tr_b16 a[28:29], v246 offset:6144
    v_mfma_f32_16x16x32_bf16 v[148:151], a[196:199], a[8:11], v[148:151]
    ds_read_b64_tr_b16 a[30:31], v246 offset:13312
    v_mfma_f32_16x16x32_bf16 v[152:155], a[200:203], a[8:11], v[152:155]
    v_mfma_f32_16x16x32_bf16 v[156:159], a[204:207], a[8:11], v[156:159]
    v_mfma_f32_16x16x32_bf16 v[172:175], a[204:207], a[12:15], v[172:175]
    ds_read_b64_tr_b16 a[0:1], v241 offset:14336
    s_add_u32 m0, s55, 61440
    v_mfma_f32_16x16x32_bf16 v[168:171], a[200:203], a[12:15], v[168:171]
    buffer_load_dwordx4 v227, s[32:35], s68 offen offset:0 lds
    s_add_u32 s68, s68, s59
    v_mfma_f32_16x16x32_bf16 v[164:167], a[196:199], a[12:15], v[164:167]
    ds_read_b64_tr_b16 a[2:3], v241 offset:21504
    v_mfma_f32_16x16x32_bf16 v[160:163], a[192:195], a[12:15], v[160:163]
    s_waitcnt lgkmcnt(6)
    v_mfma_f32_16x16x32_bf16 v[176:179], a[192:195], a[16:19], v[176:179]
    ds_read_b64_tr_b16 a[4:5], v242 offset:14336
    v_mfma_f32_16x16x32_bf16 v[180:183], a[196:199], a[16:19], v[180:183]
    buffer_load_dwordx4 a[128:131], v225, s[28:31], s52 offen sc1
    v_mfma_f32_16x16x32_bf16 v[184:187], a[200:203], a[16:19], v[184:187]
    ds_read_b64_tr_b16 a[6:7], v242 offset:21504
    v_mfma_f32_16x16x32_bf16 v[188:191], a[204:207], a[16:19], v[188:191]
    v_mfma_f32_16x16x32_bf16 a[236:239], a[208:211], a[20:23], a[236:239]
    ds_read_b64_tr_b16 a[8:9], v243 offset:14336
    s_waitcnt lgkmcnt(5)
    v_mfma_f32_16x16x32_bf16 v[192:195], a[24:27], a[192:195], v[192:195]
    ds_read_b64_tr_b16 a[10:11], v243 offset:21504
    v_mfma_f32_16x16x32_bf16 v[196:199], a[24:27], a[196:199], v[196:199]
    ds_read_b64_tr_b16 a[12:13], v244 offset:14336
    v_mfma_f32_16x16x32_bf16 v[200:203], a[24:27], a[200:203], v[200:203]
    ds_read_b64_tr_b16 a[14:15], v244 offset:21504
    v_mfma_f32_16x16x32_bf16 v[204:207], a[24:27], a[204:207], v[204:207]
    buffer_load_dwordx4 v227, s[32:35], s69 offen offset:1024 lds
    s_add_u32 s69, s69, s59
    v_mfma_f32_16x16x32_bf16 v[220:223], a[28:31], a[204:207], v[220:223]
    ds_read_b64_tr_b16 a[16:17], v241 offset:16384
    v_mfma_f32_16x16x32_bf16 v[216:219], a[28:31], a[200:203], v[216:219]
    ds_read_b64_tr_b16 a[18:19], v241 offset:23552
    v_mfma_f32_16x16x32_bf16 v[212:215], a[28:31], a[196:199], v[212:215]
    v_mfma_f32_16x16x32_bf16 v[208:211], a[28:31], a[192:195], v[208:211]
    s_waitcnt lgkmcnt(6)
    v_mfma_f32_16x16x32_bf16 v[0:3], a[0:3], a[212:215], v[0:3]
    ds_read_b64_tr_b16 a[20:21], v249 offset:16384
    v_mfma_f32_16x16x32_bf16 v[4:7], a[0:3], a[216:219], v[4:7]
    buffer_load_dwordx4 a[132:135], v224, s[28:31], s53 offen offset:0 sc1
    v_mfma_f32_16x16x32_bf16 v[8:11], a[0:3], a[220:223], v[8:11]
    ds_read_b64_tr_b16 a[22:23], v249 offset:23552
    v_mfma_f32_16x16x32_bf16 v[12:15], a[0:3], a[224:227], v[12:15]
    v_mfma_f32_16x16x32_bf16 v[28:31], a[4:7], a[224:227], v[28:31]
    ds_read_b64_tr_b16 a[24:25], v242 offset:16384
    v_mfma_f32_16x16x32_bf16 v[24:27], a[4:7], a[220:223], v[24:27]
    ds_read_b64_tr_b16 a[26:27], v242 offset:23552
    v_mfma_f32_16x16x32_bf16 v[20:23], a[4:7], a[216:219], v[20:23]
    v_mfma_f32_16x16x32_bf16 v[16:19], a[4:7], a[212:215], v[16:19]
    s_waitcnt lgkmcnt(6)
    v_mfma_f32_16x16x32_bf16 v[32:35], a[8:11], a[212:215], v[32:35]
    ds_read_b64_tr_b16 a[28:29], v243 offset:16384
    v_mfma_f32_16x16x32_bf16 v[36:39], a[8:11], a[216:219], v[36:39]
    buffer_load_dwordx4 v228, s[40:43], s70 offen offset:2048 lds
    s_add_u32 s70, s70, s61
    v_mfma_f32_16x16x32_bf16 v[40:43], a[8:11], a[220:223], v[40:43]
    ds_read_b64_tr_b16 a[30:31], v243 offset:23552
    v_mfma_f32_16x16x32_bf16 v[44:47], a[8:11], a[224:227], v[44:47]
    v_mfma_f32_16x16x32_bf16 v[60:63], a[12:15], a[224:227], v[60:63]
    ds_read_b64_tr_b16 a[0:1], v244 offset:16384
    v_mfma_f32_16x16x32_bf16 v[56:59], a[12:15], a[220:223], v[56:59]
    buffer_load_dwordx4 a[136:139], v250, s[28:31], s53 offen offset:1024 sc1
    v_mfma_f32_16x16x32_bf16 v[52:55], a[12:15], a[216:219], v[52:55]
    ds_read_b64_tr_b16 a[2:3], v244 offset:23552
    v_mfma_f32_16x16x32_bf16 v[48:51], a[12:15], a[212:215], v[48:51]
    s_waitcnt lgkmcnt(6)
    v_mfma_f32_16x16x32_bf16 v[64:67], a[16:19], a[212:215], v[64:67]
    ds_read_b64_tr_b16 a[4:5], v241 offset:18432
    v_mfma_f32_16x16x32_bf16 v[68:71], a[16:19], a[216:219], v[68:71]
    ds_read_b64_tr_b16 a[6:7], v241 offset:25600
    v_mfma_f32_16x16x32_bf16 v[72:75], a[16:19], a[220:223], v[72:75]
    v_mfma_f32_16x16x32_bf16 v[76:79], a[16:19], a[224:227], v[76:79]
    v_mfma_f32_16x16x32_bf16 a[232:235], a[20:23], a[228:231], a[232:235]
    ds_read_b64_tr_b16 a[8:9], v242 offset:18432
    s_waitcnt lgkmcnt(5)
    v_mfma_f32_16x16x32_bf16 v[80:83], a[24:27], a[212:215], v[80:83]
    ds_read_b64_tr_b16 a[10:11], v242 offset:25600
    v_mfma_f32_16x16x32_bf16 v[84:87], a[24:27], a[216:219], v[84:87]
    ds_read_b64_tr_b16 a[12:13], v243 offset:18432
    v_mfma_f32_16x16x32_bf16 v[88:91], a[24:27], a[220:223], v[88:91]
    ds_read_b64_tr_b16 a[14:15], v243 offset:25600
    v_mfma_f32_16x16x32_bf16 v[92:95], a[24:27], a[224:227], v[92:95]
    buffer_load_dwordx4 a[140:143], v251, s[28:31], s53 offen offset:2048 sc1
    v_mfma_f32_16x16x32_bf16 v[108:111], a[28:31], a[224:227], v[108:111]
    ds_read_b64_tr_b16 a[16:17], v244 offset:18432
    v_mfma_f32_16x16x32_bf16 v[104:107], a[28:31], a[220:223], v[104:107]
    buffer_load_dwordx4 a[144:147], v252, s[28:31], s53 offen offset:3072 sc1
    v_mfma_f32_16x16x32_bf16 v[100:103], a[28:31], a[216:219], v[100:103]
    ds_read_b64_tr_b16 a[18:19], v244 offset:25600
    v_mfma_f32_16x16x32_bf16 v[96:99], a[28:31], a[212:215], v[96:99]
    s_waitcnt lgkmcnt(6)
    v_mfma_f32_16x16x32_bf16 v[112:115], a[0:3], a[212:215], v[112:115]
    ds_read_b64_tr_b16 a[20:21], v249 offset:18432
    v_mfma_f32_16x16x32_bf16 v[116:119], a[0:3], a[216:219], v[116:119]
    ds_read_b64_tr_b16 a[22:23], v249 offset:25600
    v_mfma_f32_16x16x32_bf16 v[120:123], a[0:3], a[220:223], v[120:123]
    v_mfma_f32_16x16x32_bf16 v[124:127], a[0:3], a[224:227], v[124:127]
    v_mfma_f32_16x16x32_bf16 v[140:143], a[224:227], a[4:7], v[140:143]
    ds_read_b64_tr_b16 a[24:25], v245 offset:20480
    v_mfma_f32_16x16x32_bf16 v[136:139], a[220:223], a[4:7], v[136:139]
    buffer_load_dwordx4 a[148:151], v225, s[28:31], s53 offen sc1
    v_mfma_f32_16x16x32_bf16 v[132:135], a[216:219], a[4:7], v[132:135]
    ds_read_b64_tr_b16 a[26:27], v245 offset:27648
    v_mfma_f32_16x16x32_bf16 v[128:131], a[212:215], a[4:7], v[128:131]
    s_waitcnt lgkmcnt(6)
    v_mfma_f32_16x16x32_bf16 v[144:147], a[212:215], a[8:11], v[144:147]
    ds_read_b64_tr_b16 a[28:29], v246 offset:20480
    v_mfma_f32_16x16x32_bf16 v[148:151], a[216:219], a[8:11], v[148:151]
    ds_read_b64_tr_b16 a[30:31], v246 offset:27648
    v_mfma_f32_16x16x32_bf16 v[152:155], a[220:223], a[8:11], v[152:155]
    v_mfma_f32_16x16x32_bf16 v[156:159], a[224:227], a[8:11], v[156:159]
    s_waitcnt vmcnt(36)
    s_barrier
    v_mfma_f32_16x16x32_bf16 v[172:175], a[224:227], a[12:15], v[172:175]
    ds_read_b64_tr_b16 a[0:1], v229 offset:0
    s_add_u32 s52, s52, s58
    s_add_u32 s53, s53, s58
    v_mfma_f32_16x16x32_bf16 v[168:171], a[220:223], a[12:15], v[168:171]
    s_add_u32 s56, s56, 1
    s_add_u32 m0, s55, 86016
    buffer_load_dword a240, v253, s[36:39], s17 offen
    v_mfma_f32_16x16x32_bf16 v[164:167], a[216:219], a[12:15], v[164:167]
    ds_read_b64_tr_b16 a[2:3], v229 offset:7168
    s_add_u32 s17, s17, s71
    v_mfma_f32_16x16x32_bf16 v[160:163], a[212:215], a[12:15], v[160:163]
    s_waitcnt lgkmcnt(6)
    v_mfma_f32_16x16x32_bf16 v[176:179], a[212:215], a[16:19], v[176:179]
    ds_read_b64_tr_b16 a[4:5], v230 offset:0
    v_mfma_f32_16x16x32_bf16 v[180:183], a[216:219], a[16:19], v[180:183]
    buffer_load_dwordx4 v227, s[32:35], s64 offen offset:0 lds
    s_add_u32 s64, s64, s59
    v_mfma_f32_16x16x32_bf16 v[184:187], a[220:223], a[16:19], v[184:187]
    ds_read_b64_tr_b16 a[6:7], v230 offset:7168
    v_mfma_f32_16x16x32_bf16 v[188:191], a[224:227], a[16:19], v[188:191]
    v_mfma_f32_16x16x32_bf16 a[236:239], a[228:231], a[20:23], a[236:239]
    ds_read_b64_tr_b16 a[8:9], v231 offset:0
    s_waitcnt lgkmcnt(5)
    v_mfma_f32_16x16x32_bf16 v[192:195], a[24:27], a[212:215], v[192:195]
    ds_read_b64_tr_b16 a[10:11], v231 offset:7168
    v_mfma_f32_16x16x32_bf16 v[196:199], a[24:27], a[216:219], v[196:199]
    ds_read_b64_tr_b16 a[12:13], v232 offset:0
    v_mfma_f32_16x16x32_bf16 v[200:203], a[24:27], a[220:223], v[200:203]
    ds_read_b64_tr_b16 a[14:15], v232 offset:7168
    v_mfma_f32_16x16x32_bf16 v[204:207], a[24:27], a[224:227], v[204:207]
    buffer_load_dwordx4 a[152:155], v224, s[28:31], s52 offen offset:0 sc1
    v_mfma_f32_16x16x32_bf16 v[220:223], a[28:31], a[224:227], v[220:223]
    ds_read_b64_tr_b16 a[16:17], v229 offset:2048
    v_mfma_f32_16x16x32_bf16 v[216:219], a[28:31], a[220:223], v[216:219]
    ds_read_b64_tr_b16 a[18:19], v229 offset:9216
    v_mfma_f32_16x16x32_bf16 v[212:215], a[28:31], a[216:219], v[212:215]
    v_mfma_f32_16x16x32_bf16 v[208:211], a[28:31], a[212:215], v[208:211]
    s_sub_u32 s57, s57, 1
    s_cmp_lg_u32 s57, 0
    s_cbranch_scc1 L_loop_24
L_epi_q:
    s_mov_b64 s[32:33], s[14:15]
    s_lshl_b32 s34, s62, 23
    s_mov_b32 s42, 0x200000
    v_mov_b32 v247, v224
    v_accvgpr_read_b32 v250, a248
    v_accvgpr_read_b32 v251, a249
    v_accvgpr_read_b32 v252, a250
    v_accvgpr_read_b32 v253, a251
    s_lshl_b32 s55, s3, 10
    s_mov_b32 s54, 917504
    s_mov_b32 s36, s24
    s_mov_b32 s37, s25
    s_mov_b32 s38, 0x2000000
    s_mov_b32 s39, 0x20000
    v_mbcnt_lo_u32_b32 v248, -1, 0
    v_mbcnt_hi_u32_b32 v248, -1, v248
    s_waitcnt lgkmcnt(0)
    s_barrier
    s_lshl_b32 s0, s3, 13
    s_add_u32 s0, s0, 98304
    v_lshl_add_u32 v229, v248, 4, s0
    v_lshl_add_u32 v242, v248, 3, s0
    s_lshr_b32 s0, s3, 1
    s_lshl_b32 s0, s0, 11
    s_add_u32 s0, s0, 98304
    s_and_b32 s1, s3, 1
    s_lshl_b32 s10, s1, 3
    s_add_u32 s10, s10, s0
    s_lshl_b32 s1, s1, 9
    s_add_u32 s1, s1, s0
    v_lshl_add_u32 v245, v248, 4, s10
    v_lshl_add_u32 v246, v248, 3, s1
    s_add_u32 m0, s99, 65536
    s_nop 0
    buffer_load_dwordx4 v250, s[32:35], s98 offen offset:0 lds
    v_accvgpr_read_b32 v230, a232
    v_accvgpr_read_b32 v231, a233
    v_accvgpr_read_b32 v232, a234
    v_accvgpr_read_b32 v233, a235
    v_accvgpr_read_b32 v234, a236
    v_accvgpr_read_b32 v235, a237
    v_accvgpr_read_b32 v236, a238
    v_accvgpr_read_b32 v237, a239
    v_cvt_pk_bf16_f32 v230, v230, v231
    v_cvt_pk_bf16_f32 v231, v232, v233
    buffer_load_dwordx4 v251, s[32:35], s98 offen offset:1024 lds
    v_cvt_pk_bf16_f32 v232, v234, v235
    v_cvt_pk_bf16_f32 v233, v236, v237
    ds_write_b64 v245, v[230:231] offset:0
    ds_write_b64 v246, v[232:233] offset:4096
    ds_write_b64 v245, v[230:231] offset:1024
    ds_write_b64 v246, v[232:233] offset:5120
    v_cvt_pk_bf16_f32 v72, v72, v73
    v_cvt_pk_bf16_f32 v73, v74, v75
    v_cvt_pk_bf16_f32 v74, v88, v89
    v_cvt_pk_bf16_f32 v75, v90, v91
    v_cvt_pk_bf16_f32 v76, v76, v77
    v_cvt_pk_bf16_f32 v77, v78, v79
    v_cvt_pk_bf16_f32 v78, v92, v93
    v_cvt_pk_bf16_f32 v79, v94, v95
    buffer_load_dwordx4 v252, s[32:35], s98 offen offset:2048 lds
    v_cvt_pk_bf16_f32 v104, v104, v105
    v_cvt_pk_bf16_f32 v105, v106, v107
    v_cvt_pk_bf16_f32 v106, v120, v121
    v_cvt_pk_bf16_f32 v107, v122, v123
    v_cvt_pk_bf16_f32 v108, v108, v109
    v_cvt_pk_bf16_f32 v109, v110, v111
    v_cvt_pk_bf16_f32 v110, v124, v125
    v_cvt_pk_bf16_f32 v111, v126, v127
    v_cvt_pk_bf16_f32 v131, v130, v131
    v_cvt_pk_bf16_f32 v130, v128, v129
    buffer_load_dwordx4 v253, s[32:35], s98 offen offset:3072 lds
    v_cvt_pk_bf16_f32 v143, v142, v143
    v_cvt_pk_bf16_f32 v142, v140, v141
    v_cvt_pk_bf16_f32 v140, v132, v133
    v_cvt_pk_bf16_f32 v141, v134, v135
    v_cvt_pk_bf16_f32 v132, v136, v137
    v_cvt_pk_bf16_f32 v133, v138, v139
    v_cvt_pk_bf16_f32 v147, v146, v147
    v_cvt_pk_bf16_f32 v146, v144, v145
    v_cvt_pk_bf16_f32 v159, v158, v159
    v_cvt_pk_bf16_f32 v158, v156, v157
    s_branch L_po_q_5
.p2align 12
L_pg_q_5:
    s_branch L_pg_K_1
L_po_q_5:
    s_xor_b32 s98, s98, 1024
    s_add_u32 m0, s99, 81920
    s_nop 0
    buffer_load_dwordx4 v250, s[32:35], s98 offen offset:0 lds
    v_cvt_pk_bf16_f32 v156, v148, v149
    v_cvt_pk_bf16_f32 v157, v150, v151
    v_cvt_pk_bf16_f32 v148, v152, v153
    v_cvt_pk_bf16_f32 v149, v154, v155
    v_cvt_pk_bf16_f32 v163, v162, v163
    v_cvt_pk_bf16_f32 v162, v160, v161
    v_cvt_pk_bf16_f32 v175, v174, v175
    v_cvt_pk_bf16_f32 v174, v172, v173
    v_cvt_pk_bf16_f32 v172, v164, v165
    v_cvt_pk_bf16_f32 v173, v166, v167
    buffer_load_dwordx4 v251, s[32:35], s98 offen offset:1024 lds
    v_cvt_pk_bf16_f32 v164, v168, v169
    v_cvt_pk_bf16_f32 v165, v170, v171
    v_cvt_pk_bf16_f32 v179, v178, v179
    v_cvt_pk_bf16_f32 v178, v176, v177
    v_cvt_pk_bf16_f32 v191, v190, v191
    v_cvt_pk_bf16_f32 v190, v188, v189
    v_cvt_pk_bf16_f32 v188, v180, v181
    v_cvt_pk_bf16_f32 v189, v182, v183
    v_cvt_pk_bf16_f32 v180, v184, v185
    v_cvt_pk_bf16_f32 v181, v186, v187
    s_cmp_eq_u32 s3, 3
    s_cbranch_scc1 L_noxw_30
    ds_write_b128 v229, v[72:75] offset:8192
    ds_write_b64 v242, v[132:133] offset:12288
    ds_write_b64 v242, v[148:149] offset:12800
    ds_write_b128 v229, v[76:79] offset:9216
    ds_write_b64 v242, v[142:143] offset:13312
    ds_write_b64 v242, v[158:159] offset:13824
    ds_write_b128 v229, v[104:107] offset:10240
    ds_write_b64 v242, v[164:165] offset:14336
    ds_write_b64 v242, v[180:181] offset:14848
    ds_write_b128 v229, v[108:111] offset:11264
    ds_write_b64 v242, v[174:175] offset:15360
    ds_write_b64 v242, v[190:191] offset:15872
L_noxw_30:
    buffer_load_dwordx4 v252, s[32:35], s98 offen offset:2048 lds
    v_cvt_pk_bf16_f32 v64, v64, v65
    v_cvt_pk_bf16_f32 v65, v66, v67
    v_cvt_pk_bf16_f32 v66, v80, v81
    v_cvt_pk_bf16_f32 v67, v82, v83
    v_cvt_pk_bf16_f32 v68, v68, v69
    v_cvt_pk_bf16_f32 v69, v70, v71
    v_cvt_pk_bf16_f32 v70, v84, v85
    v_cvt_pk_bf16_f32 v71, v86, v87
    v_cvt_pk_bf16_f32 v96, v96, v97
    v_cvt_pk_bf16_f32 v97, v98, v99
    buffer_load_dwordx4 v253, s[32:35], s98 offen offset:3072 lds
    v_cvt_pk_bf16_f32 v98, v112, v113
    v_cvt_pk_bf16_f32 v99, v114, v115
    v_cvt_pk_bf16_f32 v100, v100, v101
    v_cvt_pk_bf16_f32 v101, v102, v103
    v_cvt_pk_bf16_f32 v102, v116, v117
    v_cvt_pk_bf16_f32 v103, v118, v119
    v_lshlrev_b32 v224, 4, v248
    v_mov_b32 v244, s26
    s_mov_b32 s52, s16
    v_accvgpr_read_b32 v225, a252
    v_accvgpr_read_b32 v226, a253
    s_xor_b32 s98, s98, 3072
    s_add_u32 m0, s99, 0
    s_nop 0
    buffer_load_dwordx4 v250, s[32:35], s98 offen offset:0 lds
    v_accvgpr_read_b32 v240, a254
    v_add_u32 v227, 0x10000, v225
    v_add_u32 v228, 0x10000, v226
    s_waitcnt lgkmcnt(0)
    s_barrier
    ds_read_b128 v[134:137], v229 offset:0
    ds_read_b64 v[128:129], v242 offset:4096
    ds_read_b64 v[144:145], v242 offset:4608
    ds_read_b128 v[150:153], v229 offset:1024
    ds_read_b64 v[138:139], v242 offset:5120
    ds_read_b64 v[154:155], v242 offset:5632
    ds_read_b128 v[166:169], v229 offset:2048
    ds_read_b64 v[160:161], v242 offset:6144
    ds_read_b64 v[176:177], v242 offset:6656
    ds_read_b128 v[182:185], v229 offset:3072
    ds_read_b64 v[170:171], v242 offset:7168
    ds_read_b64 v[186:187], v242 offset:7680
    v_cvt_pk_bf16_f32 v0, v0, v1
    v_cvt_pk_bf16_f32 v1, v2, v3
    v_cvt_pk_bf16_f32 v2, v16, v17
    v_cvt_pk_bf16_f32 v3, v18, v19
    v_cvt_pk_bf16_f32 v4, v4, v5
    v_cvt_pk_bf16_f32 v5, v6, v7
    v_cvt_pk_bf16_f32 v6, v20, v21
    buffer_load_dwordx4 v251, s[32:35], s98 offen offset:1024 lds
    v_cvt_pk_bf16_f32 v7, v22, v23
    v_cvt_pk_bf16_f32 v8, v8, v9
    v_cvt_pk_bf16_f32 v9, v10, v11
    v_cvt_pk_bf16_f32 v10, v24, v25
    v_cvt_pk_bf16_f32 v11, v26, v27
    v_cvt_pk_bf16_f32 v12, v12, v13
    v_cvt_pk_bf16_f32 v13, v14, v15
    v_cvt_pk_bf16_f32 v14, v28, v29
    v_cvt_pk_bf16_f32 v15, v30, v31
    v_cvt_pk_bf16_f32 v32, v32, v33
    buffer_load_dwordx4 v252, s[32:35], s98 offen offset:2048 lds
    v_cvt_pk_bf16_f32 v33, v34, v35
    v_cvt_pk_bf16_f32 v34, v48, v49
    v_cvt_pk_bf16_f32 v35, v50, v51
    v_cvt_pk_bf16_f32 v36, v36, v37
    v_cvt_pk_bf16_f32 v37, v38, v39
    v_cvt_pk_bf16_f32 v38, v52, v53
    v_cvt_pk_bf16_f32 v39, v54, v55
    v_cvt_pk_bf16_f32 v40, v40, v41
    v_cvt_pk_bf16_f32 v41, v42, v43
    v_cvt_pk_bf16_f32 v42, v56, v57
    buffer_load_dwordx4 v253, s[32:35], s98 offen offset:3072 lds
    v_cvt_pk_bf16_f32 v43, v58, v59
    v_cvt_pk_bf16_f32 v44, v44, v45
    v_cvt_pk_bf16_f32 v45, v46, v47
    v_cvt_pk_bf16_f32 v46, v60, v61
    v_cvt_pk_bf16_f32 v47, v62, v63
    v_mov_b32 v238, 0xbdd2d3e8
    v_mov_b32 v239, 0xc0135761
    s_mov_b32 s64, 0xfff0ffff
    s_mov_b32 s65, 0xf000ff00
    s_mov_b32 s66, 0xffe0fffe
    s_mov_b32 s67, 0xe000fe00
    s_mov_b32 s68, 0xffc0fffc
    s_mov_b32 s69, 0xc000fc00
    s_mov_b32 s70, 0xff80fff8
    s_mov_b32 s71, 0x8000f800
    s_waitcnt lgkmcnt(0)
    v_pk_mul_f32 v[230:231], v[192:193], v[192:193]
    v_pk_mul_f32 v[232:233], v[194:195], v[194:195]
    v_pk_mul_f32 v[234:235], v[208:209], v[208:209]
    s_xor_b32 s98, s98, 1024
    s_add_u32 m0, s99, 16384
    s_nop 0
    buffer_load_dwordx4 v250, s[32:35], s98 offen offset:0 lds
    v_pk_mul_f32 v[236:237], v[210:211], v[210:211]
    v_pk_fma_f32 v[230:231], v[230:231], v[238:239], v[238:239] op_sel:[0,0,1] op_sel_hi:[1,0,1]
    v_pk_fma_f32 v[232:233], v[232:233], v[238:239], v[238:239] op_sel:[0,0,1] op_sel_hi:[1,0,1]
    v_pk_fma_f32 v[234:235], v[234:235], v[238:239], v[238:239] op_sel:[0,0,1] op_sel_hi:[1,0,1]
    v_pk_fma_f32 v[236:237], v[236:237], v[238:239], v[238:239] op_sel:[0,0,1] op_sel_hi:[1,0,1]
    v_pk_mul_f32 v[230:231], v[230:231], v[192:193]
    v_pk_mul_f32 v[232:233], v[232:233], v[194:195]
    v_pk_mul_f32 v[234:235], v[234:235], v[208:209]
    v_pk_mul_f32 v[236:237], v[236:237], v[210:211]
    v_mfma_f32_16x16x32_bf16 v[16:19], v[64:67], v[0:3], 0
    v_exp_f32 v230, v230
    buffer_load_dwordx4 v251, s[32:35], s98 offen offset:1024 lds
    v_exp_f32 v231, v231
    v_mfma_f32_16x16x32_bf16 v[80:83], v[134:137], v[0:3], 0
    v_exp_f32 v232, v232
    v_exp_f32 v233, v233
    v_exp_f32 v234, v234
    v_exp_f32 v235, v235
    v_exp_f32 v236, v236
    v_exp_f32 v237, v237
    v_pk_add_f32 v[230:231], v[230:231], 1.0 op_sel_hi:[1,0]
    v_pk_add_f32 v[232:233], v[232:233], 1.0 op_sel_hi:[1,0]
    v_pk_add_f32 v[234:235], v[234:235], 1.0 op_sel_hi:[1,0]
    buffer_load_dwordx4 v252, s[32:35], s98 offen offset:2048 lds
    v_pk_add_f32 v[236:237], v[236:237], 1.0 op_sel_hi:[1,0]
    v_mfma_f32_16x16x32_bf16 v[20:23], v[68:71], v[4:7], 0
    v_rcp_f32 v230, v230
    v_rcp_f32 v231, v231
    v_mfma_f32_16x16x32_bf16 v[84:87], v[150:153], v[4:7], 0
    v_rcp_f32 v232, v232
    v_rcp_f32 v233, v233
    v_rcp_f32 v234, v234
    v_rcp_f32 v235, v235
    v_rcp_f32 v236, v236
    v_rcp_f32 v237, v237
    v_pk_mul_f32 v[192:193], v[192:193], v[230:231]
    buffer_load_dwordx4 v253, s[32:35], s98 offen offset:3072 lds
    v_pk_mul_f32 v[194:195], v[194:195], v[232:233]
    v_pk_mul_f32 v[208:209], v[208:209], v[234:235]
    v_pk_mul_f32 v[210:211], v[210:211], v[236:237]
    v_pk_mul_f32 v[230:231], v[196:197], v[196:197]
    v_pk_mul_f32 v[232:233], v[198:199], v[198:199]
    v_pk_mul_f32 v[234:235], v[212:213], v[212:213]
    v_pk_mul_f32 v[236:237], v[214:215], v[214:215]
    v_pk_fma_f32 v[230:231], v[230:231], v[238:239], v[238:239] op_sel:[0,0,1] op_sel_hi:[1,0,1]
    v_pk_fma_f32 v[232:233], v[232:233], v[238:239], v[238:239] op_sel:[0,0,1] op_sel_hi:[1,0,1]
    v_pk_fma_f32 v[234:235], v[234:235], v[238:239], v[238:239] op_sel:[0,0,1] op_sel_hi:[1,0,1]
    s_mov_b32 s58, 0
    buffer_load_dwordx4 a[0:3], v247, s[28:31], s58 offen
    v_pk_fma_f32 v[236:237], v[236:237], v[238:239], v[238:239] op_sel:[0,0,1] op_sel_hi:[1,0,1]
    v_pk_mul_f32 v[230:231], v[230:231], v[196:197]
    v_pk_mul_f32 v[232:233], v[232:233], v[198:199]
    v_pk_mul_f32 v[234:235], v[234:235], v[212:213]
    v_pk_mul_f32 v[236:237], v[236:237], v[214:215]
    v_mfma_f32_16x16x32_bf16 v[24:27], v[72:75], v[8:11], 0
    v_exp_f32 v230, v230
    v_exp_f32 v231, v231
    v_mfma_f32_16x16x32_bf16 v[88:91], v[64:67], v[8:11], 0
    v_exp_f32 v232, v232
    v_exp_f32 v233, v233
    v_exp_f32 v234, v234
    s_mov_b32 s58, 65536
    buffer_load_dwordx4 a[4:7], v247, s[28:31], s58 offen
    v_exp_f32 v235, v235
    v_exp_f32 v236, v236
    v_exp_f32 v237, v237
    v_pk_add_f32 v[230:231], v[230:231], 1.0 op_sel_hi:[1,0]
    v_pk_add_f32 v[232:233], v[232:233], 1.0 op_sel_hi:[1,0]
    v_pk_add_f32 v[234:235], v[234:235], 1.0 op_sel_hi:[1,0]
    v_pk_add_f32 v[236:237], v[236:237], 1.0 op_sel_hi:[1,0]
    v_mfma_f32_16x16x32_bf16 v[28:31], v[76:79], v[12:15], 0
    v_rcp_f32 v230, v230
    v_rcp_f32 v231, v231
    v_mfma_f32_16x16x32_bf16 v[92:95], v[68:71], v[12:15], 0
    v_rcp_f32 v232, v232
    s_mov_b32 s58, 131072
    buffer_load_dwordx4 a[8:11], v247, s[28:31], s58 offen
    v_rcp_f32 v233, v233
    v_rcp_f32 v234, v234
    v_rcp_f32 v235, v235
    v_rcp_f32 v236, v236
    v_rcp_f32 v237, v237
    v_pk_mul_f32 v[196:197], v[196:197], v[230:231]
    v_pk_mul_f32 v[198:199], v[198:199], v[232:233]
    v_pk_mul_f32 v[212:213], v[212:213], v[234:235]
    v_pk_mul_f32 v[214:215], v[214:215], v[236:237]
    v_pk_mul_f32 v[230:231], v[200:201], v[200:201]
    s_mov_b32 s58, 196608
    buffer_load_dwordx4 a[12:15], v247, s[28:31], s58 offen
    v_pk_mul_f32 v[232:233], v[202:203], v[202:203]
    v_pk_mul_f32 v[234:235], v[216:217], v[216:217]
    v_pk_mul_f32 v[236:237], v[218:219], v[218:219]
    v_pk_fma_f32 v[230:231], v[230:231], v[238:239], v[238:239] op_sel:[0,0,1] op_sel_hi:[1,0,1]
    v_pk_fma_f32 v[232:233], v[232:233], v[238:239], v[238:239] op_sel:[0,0,1] op_sel_hi:[1,0,1]
    v_pk_fma_f32 v[234:235], v[234:235], v[238:239], v[238:239] op_sel:[0,0,1] op_sel_hi:[1,0,1]
    v_pk_fma_f32 v[236:237], v[236:237], v[238:239], v[238:239] op_sel:[0,0,1] op_sel_hi:[1,0,1]
    v_pk_mul_f32 v[230:231], v[230:231], v[200:201]
    v_pk_mul_f32 v[232:233], v[232:233], v[202:203]
    v_pk_mul_f32 v[234:235], v[234:235], v[216:217]
    s_mov_b32 s58, 262144
    buffer_load_dwordx4 a[16:19], v247, s[28:31], s58 offen
    v_pk_mul_f32 v[236:237], v[236:237], v[218:219]
    v_mfma_f32_16x16x32_bf16 v[48:51], v[96:99], v[32:35], 0
    v_exp_f32 v230, v230
    v_exp_f32 v231, v231
    v_mfma_f32_16x16x32_bf16 v[112:115], v[166:169], v[32:35], 0
    v_exp_f32 v232, v232
    v_exp_f32 v233, v233
    v_exp_f32 v234, v234
    v_exp_f32 v235, v235
    v_exp_f32 v236, v236
    v_exp_f32 v237, v237
    v_pk_add_f32 v[230:231], v[230:231], 1.0 op_sel_hi:[1,0]
    s_mov_b32 s58, 327680
    buffer_load_dwordx4 a[20:23], v247, s[28:31], s58 offen
    v_pk_add_f32 v[232:233], v[232:233], 1.0 op_sel_hi:[1,0]
    v_pk_add_f32 v[234:235], v[234:235], 1.0 op_sel_hi:[1,0]
    v_pk_add_f32 v[236:237], v[236:237], 1.0 op_sel_hi:[1,0]
    v_mfma_f32_16x16x32_bf16 v[52:55], v[100:103], v[36:39], 0
    v_rcp_f32 v230, v230
    v_rcp_f32 v231, v231
    v_mfma_f32_16x16x32_bf16 v[116:119], v[182:185], v[36:39], 0
    v_rcp_f32 v232, v232
    v_rcp_f32 v233, v233
    v_rcp_f32 v234, v234
    v_rcp_f32 v235, v235
    v_rcp_f32 v236, v236
    s_mov_b32 s58, 393216
    buffer_load_dwordx4 a[24:27], v247, s[28:31], s58 offen
    v_rcp_f32 v237, v237
    v_pk_mul_f32 v[200:201], v[200:201], v[230:231]
    v_pk_mul_f32 v[202:203], v[202:203], v[232:233]
    v_pk_mul_f32 v[216:217], v[216:217], v[234:235]
    v_pk_mul_f32 v[218:219], v[218:219], v[236:237]
    v_pk_mul_f32 v[230:231], v[204:205], v[204:205]
    v_pk_mul_f32 v[232:233], v[206:207], v[206:207]
    v_pk_mul_f32 v[234:235], v[220:221], v[220:221]
    v_pk_mul_f32 v[236:237], v[222:223], v[222:223]
    v_pk_fma_f32 v[230:231], v[230:231], v[238:239], v[238:239] op_sel:[0,0,1] op_sel_hi:[1,0,1]
    s_mov_b32 s58, 458752
    buffer_load_dwordx4 a[28:31], v247, s[28:31], s58 offen
    v_pk_fma_f32 v[232:233], v[232:233], v[238:239], v[238:239] op_sel:[0,0,1] op_sel_hi:[1,0,1]
    v_pk_fma_f32 v[234:235], v[234:235], v[238:239], v[238:239] op_sel:[0,0,1] op_sel_hi:[1,0,1]
    v_pk_fma_f32 v[236:237], v[236:237], v[238:239], v[238:239] op_sel:[0,0,1] op_sel_hi:[1,0,1]
    v_pk_mul_f32 v[230:231], v[230:231], v[204:205]
    v_pk_mul_f32 v[232:233], v[232:233], v[206:207]
    v_pk_mul_f32 v[234:235], v[234:235], v[220:221]
    v_pk_mul_f32 v[236:237], v[236:237], v[222:223]
    v_mfma_f32_16x16x32_bf16 v[56:59], v[104:107], v[40:43], 0
    v_exp_f32 v230, v230
    v_exp_f32 v231, v231
    v_mfma_f32_16x16x32_bf16 v[120:123], v[96:99], v[40:43], 0
    v_exp_f32 v232, v232
    s_mov_b32 s58, 2555904
    buffer_load_dwordx4 a[156:159], v247, s[28:31], s58 offen
    v_exp_f32 v233, v233
    v_exp_f32 v234, v234
    v_exp_f32 v235, v235
    v_exp_f32 v236, v236
    v_exp_f32 v237, v237
    v_pk_add_f32 v[230:231], v[230:231], 1.0 op_sel_hi:[1,0]
    v_pk_add_f32 v[232:233], v[232:233], 1.0 op_sel_hi:[1,0]
    v_pk_add_f32 v[234:235], v[234:235], 1.0 op_sel_hi:[1,0]
    v_pk_add_f32 v[236:237], v[236:237], 1.0 op_sel_hi:[1,0]
    v_mfma_f32_16x16x32_bf16 v[60:63], v[108:111], v[44:47], 0
    v_rcp_f32 v230, v230
    s_mov_b32 s58, 2621440
    buffer_load_dwordx4 a[160:163], v247, s[28:31], s58 offen
    v_rcp_f32 v231, v231
    v_mfma_f32_16x16x32_bf16 v[124:127], v[100:103], v[44:47], 0
    v_rcp_f32 v232, v232
    v_rcp_f32 v233, v233
    v_rcp_f32 v234, v234
    v_rcp_f32 v235, v235
    v_rcp_f32 v236, v236
    v_rcp_f32 v237, v237
    v_pk_mul_f32 v[204:205], v[204:205], v[230:231]
    v_pk_mul_f32 v[206:207], v[206:207], v[232:233]
    v_pk_mul_f32 v[220:221], v[220:221], v[234:235]
    s_mov_b32 s58, 2686976
    buffer_load_dwordx4 a[164:167], v247, s[28:31], s58 offen
    v_pk_mul_f32 v[222:223], v[222:223], v[236:237]
    v_cvt_pk_bf16_f32 v64, v192, v193
    v_cvt_pk_bf16_f32 v65, v194, v195
    v_cvt_pk_bf16_f32 v66, v208, v209
    v_cvt_pk_bf16_f32 v67, v210, v211
    v_cvt_pk_bf16_f32 v68, v196, v197
    v_cvt_pk_bf16_f32 v69, v198, v199
    v_cvt_pk_bf16_f32 v70, v212, v213
    v_cvt_pk_bf16_f32 v71, v214, v215
    v_cvt_pk_bf16_f32 v72, v200, v201
    s_mov_b32 s58, 2752512
    buffer_load_dwordx4 a[168:171], v247, s[28:31], s58 offen
    v_cvt_pk_bf16_f32 v73, v202, v203
    v_cvt_pk_bf16_f32 v74, v216, v217
    v_cvt_pk_bf16_f32 v75, v218, v219
    v_cvt_pk_bf16_f32 v76, v204, v205
    v_cvt_pk_bf16_f32 v77, v206, v207
    v_cvt_pk_bf16_f32 v78, v220, v221
    v_cvt_pk_bf16_f32 v79, v222, v223
    buffer_store_dwordx4 v[64:67], v224, s[36:39], s6 offen offset:0 sc1
    buffer_store_dwordx4 v[68:71], v224, s[36:39], s6 offen offset:1024 sc1
    buffer_store_dwordx4 v[72:75], v224, s[36:39], s7 offen offset:0 sc1
    buffer_store_dwordx4 v[76:79], v224, s[36:39], s7 offen offset:1024 sc1
L_lz_31:
    v_mov_b32 v249, 0xcfa8965f
    v_mov_b32 v0, 0xffff
    v_mov_b32 v1, 0xffff0000
    s_mov_b32 s10, 0x3e3504f3
    s_mov_b32 s11, s10
    s_mov_b32 s22, 0x3e8293ee
    s_mov_b32 s23, s22
    s_mov_b32 s58, 2818048
    buffer_load_dwordx4 a[172:175], v247, s[28:31], s58 offen
    v_cndmask_b32 v245, 0, v0, s[64:65]
    v_cndmask_b32 v2, 0, v1, s[66:67]
    v_or_b32 v245, v245, v2
    v_cndmask_b32 v246, 0, v0, s[68:69]
    v_cndmask_b32 v2, 0, v1, s[70:71]
    v_or_b32 v246, v246, v2
    v_cndmask_b32 v16, v80, v16, s[64:65]
    v_cndmask_b32 v17, v81, v17, s[66:67]
    v_cndmask_b32 v18, v82, v18, s[68:69]
    v_cndmask_b32 v19, v83, v19, s[70:71]
    s_mov_b32 s58, 2883584
    buffer_load_dwordx4 a[176:179], v247, s[28:31], s58 offen
    v_cndmask_b32 v20, v84, v20, s[64:65]
    v_cndmask_b32 v21, v85, v21, s[66:67]
    v_cndmask_b32 v22, v86, v22, s[68:69]
    v_cndmask_b32 v23, v87, v23, s[70:71]
    v_cndmask_b32 v24, v88, v24, s[64:65]
    v_cndmask_b32 v25, v89, v25, s[66:67]
    v_cndmask_b32 v26, v90, v26, s[68:69]
    v_cndmask_b32 v27, v91, v27, s[70:71]
    v_cndmask_b32 v28, v92, v28, s[64:65]
    v_cndmask_b32 v29, v93, v29, s[66:67]
    s_mov_b32 s58, 2949120
    buffer_load_dwordx4 a[180:183], v247, s[28:31], s58 offen
    v_cndmask_b32 v30, v94, v30, s[68:69]
    v_cndmask_b32 v31, v95, v31, s[70:71]
    v_cndmask_b32 v16, v249, v16, s[80:81]
    v_cndmask_b32 v17, v249, v17, s[82:83]
    v_cndmask_b32 v18, v249, v18, s[84:85]
    v_cndmask_b32 v19, v249, v19, s[86:87]
    v_cndmask_b32 v20, v249, v20, s[88:89]
    v_cndmask_b32 v21, v249, v21, s[90:91]
    v_cndmask_b32 v22, v249, v22, s[92:93]
    v_cndmask_b32 v23, v249, v23, s[94:95]
    s_mov_b32 s58, 3014656
    buffer_load_dwordx4 a[184:187], v247, s[28:31], s58 offen
    v_cndmask_b32 v24, v249, v24, s[72:73]
    v_cndmask_b32 v25, v249, v25, s[74:75]
    v_cndmask_b32 v26, v249, v26, s[76:77]
    v_cndmask_b32 v27, v249, v27, s[78:79]
    v_cndmask_b32 v28, v249, v28, s[72:73]
    v_cndmask_b32 v29, v249, v29, s[74:75]
    v_cndmask_b32 v30, v249, v30, s[76:77]
    v_cndmask_b32 v31, v249, v31, s[78:79]
    v_max3_f32 v0, v16, v17, v18
    v_max3_f32 v1, v20, v21, v22
    s_mov_b32 s58, 3080192
    buffer_load_dwordx4 a[188:191], v247, s[28:31], s58 offen
    v_max3_f32 v2, v24, v25, v26
    v_max3_f32 v3, v28, v29, v30
    v_max_f32 v0, v0, v19
    v_max_f32 v1, v1, v23
    v_max_f32 v2, v2, v27
    v_max_f32 v3, v3, v31
    v_cndmask_b32 v48, v112, v48, s[64:65]
    v_cndmask_b32 v49, v113, v49, s[66:67]
    v_cndmask_b32 v50, v114, v50, s[68:69]
    v_cndmask_b32 v51, v115, v51, s[70:71]
    s_mov_b32 s58, 3145728
    buffer_load_dwordx4 a[192:195], v247, s[28:31], s58 offen
    v_cndmask_b32 v52, v116, v52, s[64:65]
    v_cndmask_b32 v53, v117, v53, s[66:67]
    v_cndmask_b32 v54, v118, v54, s[68:69]
    v_cndmask_b32 v55, v119, v55, s[70:71]
    v_cndmask_b32 v56, v120, v56, s[64:65]
    v_cndmask_b32 v57, v121, v57, s[66:67]
    v_cndmask_b32 v58, v122, v58, s[68:69]
    v_cndmask_b32 v59, v123, v59, s[70:71]
    v_cndmask_b32 v60, v124, v60, s[64:65]
    v_cndmask_b32 v61, v125, v61, s[66:67]
    s_mov_b32 s58, 3211264
    buffer_load_dwordx4 a[196:199], v247, s[28:31], s58 offen
    v_cndmask_b32 v62, v126, v62, s[68:69]
    v_cndmask_b32 v63, v127, v63, s[70:71]
    v_cndmask_b32 v48, v249, v48, s[80:81]
    v_cndmask_b32 v49, v249, v49, s[82:83]
    v_cndmask_b32 v50, v249, v50, s[84:85]
    v_cndmask_b32 v51, v249, v51, s[86:87]
    v_cndmask_b32 v52, v249, v52, s[88:89]
    v_cndmask_b32 v53, v249, v53, s[90:91]
    v_cndmask_b32 v54, v249, v54, s[92:93]
    v_cndmask_b32 v55, v249, v55, s[94:95]
    s_mov_b32 s58, 3276800
    buffer_load_dwordx4 a[200:203], v247, s[28:31], s58 offen
    v_cndmask_b32 v56, v249, v56, s[72:73]
    v_cndmask_b32 v57, v249, v57, s[74:75]
    v_cndmask_b32 v58, v249, v58, s[76:77]
    v_cndmask_b32 v59, v249, v59, s[78:79]
    v_cndmask_b32 v60, v249, v60, s[72:73]
    v_cndmask_b32 v61, v249, v61, s[74:75]
    v_cndmask_b32 v62, v249, v62, s[76:77]
    v_cndmask_b32 v63, v249, v63, s[78:79]
    v_max3_f32 v32, v48, v49, v50
    v_max3_f32 v33, v52, v53, v54
    s_mov_b32 s58, 3342336
    buffer_load_dwordx4 a[204:207], v247, s[28:31], s58 offen
    v_max3_f32 v34, v56, v57, v58
    v_max3_f32 v35, v60, v61, v62
    v_max_f32 v32, v32, v51
    v_max_f32 v33, v33, v55
    v_max_f32 v34, v34, v59
    v_max_f32 v35, v35, v63
    v_permlane16_swap_b32 v0, v1
    v_permlane16_swap_b32 v2, v3
    v_permlane16_swap_b32 v32, v33
    v_permlane16_swap_b32 v34, v35
    v_max_f32 v0, v0, v1
    v_max_f32 v2, v2, v3
    v_max_f32 v32, v32, v33
    v_max_f32 v34, v34, v35
    v_permlane32_swap_b32 v0, v2
    s_nop 0
    v_permlane32_swap_b32 v32, v34
    s_mov_b32 s58, 3407872
    buffer_load_dwordx4 a[208:211], v247, s[28:31], s58 offen
    v_max_f32 v0, v0, v2
    v_max_f32 v32, v32, v34
    v_mul_f32 v0, s22, v0
    v_mul_f32 v32, s22, v32
    v_mov_b32 v2, v0
    v_mov_b32 v34, v32
    s_nop 0
    v_permlane32_swap_b32 v0, v2
    v_permlane32_swap_b32 v32, v34
    v_mov_b32 v1, v0
    v_mov_b32 v3, v2
    v_mov_b32 v33, v32
    v_mov_b32 v35, v34
    v_permlane16_swap_b32 v0, v1
    v_permlane16_swap_b32 v2, v3
    v_permlane16_swap_b32 v32, v33
    v_permlane16_swap_b32 v34, v35
    s_mov_b32 s58, 3473408
    buffer_load_dwordx4 a[212:215], v247, s[28:31], s58 offen
    v_pk_fma_f32 v[16:17], v[16:17], s[22:23], v[0:1] op_sel:[0,0,0] op_sel_hi:[1,1,0] neg_lo:[0,0,1] neg_hi:[0,0,1]
    v_pk_fma_f32 v[18:19], v[18:19], s[22:23], v[0:1] op_sel:[0,0,0] op_sel_hi:[1,1,0] neg_lo:[0,0,1] neg_hi:[0,0,1]
    v_pk_fma_f32 v[20:21], v[20:21], s[22:23], v[0:1] op_sel:[0,0,1] op_sel_hi:[1,1,1] neg_lo:[0,0,1] neg_hi:[0,0,1]
    v_pk_fma_f32 v[22:23], v[22:23], s[22:23], v[0:1] op_sel:[0,0,1] op_sel_hi:[1,1,1] neg_lo:[0,0,1] neg_hi:[0,0,1]
    v_pk_fma_f32 v[24:25], v[24:25], s[22:23], v[2:3] op_sel:[0,0,0] op_sel_hi:[1,1,0] neg_lo:[0,0,1] neg_hi:[0,0,1]
    v_pk_fma_f32 v[26:27], v[26:27], s[22:23], v[2:3] op_sel:[0,0,0] op_sel_hi:[1,1,0] neg_lo:[0,0,1] neg_hi:[0,0,1]
    v_pk_fma_f32 v[28:29], v[28:29], s[22:23], v[2:3] op_sel:[0,0,1] op_sel_hi:[1,1,1] neg_lo:[0,0,1] neg_hi:[0,0,1]
    v_pk_fma_f32 v[30:31], v[30:31], s[22:23], v[2:3] op_sel:[0,0,1] op_sel_hi:[1,1,1] neg_lo:[0,0,1] neg_hi:[0,0,1]
    v_exp_f32 v16, v16
    v_exp_f32 v17, v17
    s_mov_b32 s58, 3538944
    buffer_load_dwordx4 a[216:219], v247, s[28:31], s58 offen
    v_exp_f32 v18, v18
    v_exp_f32 v19, v19
    v_exp_f32 v20, v20
    v_exp_f32 v21, v21
    v_exp_f32 v22, v22
    v_exp_f32 v23, v23
    v_exp_f32 v24, v24
    v_exp_f32 v25, v25
    v_exp_f32 v26, v26
    v_exp_f32 v27, v27
    s_mov_b32 s58, 3604480
    buffer_load_dwordx4 a[220:223], v247, s[28:31], s58 offen
    v_exp_f32 v28, v28
    v_exp_f32 v29, v29
    v_exp_f32 v30, v30
    v_exp_f32 v31, v31
    v_pk_add_f32 v[4:5], v[16:17], v[18:19]
    v_pk_add_f32 v[6:7], v[20:21], v[22:23]
    v_pk_add_f32 v[8:9], v[24:25], v[26:27]
    v_pk_add_f32 v[10:11], v[28:29], v[30:31]
    v_add_f32 v0, v4, v5
    v_add_f32 v1, v6, v7
    s_add_u32 m0, s55, 57344
    s_nop 0
    buffer_load_dwordx4 v247, s[40:43], s54 offen lds
    s_add_u32 s54, s54, 65536
    v_add_f32 v2, v8, v9
    v_add_f32 v3, v10, v11
    v_pk_fma_f32 v[48:49], v[48:49], s[22:23], v[32:33] op_sel:[0,0,0] op_sel_hi:[1,1,0] neg_lo:[0,0,1] neg_hi:[0,0,1]
    v_pk_fma_f32 v[50:51], v[50:51], s[22:23], v[32:33] op_sel:[0,0,0] op_sel_hi:[1,1,0] neg_lo:[0,0,1] neg_hi:[0,0,1]
    v_pk_fma_f32 v[52:53], v[52:53], s[22:23], v[32:33] op_sel:[0,0,1] op_sel_hi:[1,1,1] neg_lo:[0,0,1] neg_hi:[0,0,1]
    v_pk_fma_f32 v[54:55], v[54:55], s[22:23], v[32:33] op_sel:[0,0,1] op_sel_hi:[1,1,1] neg_lo:[0,0,1] neg_hi:[0,0,1]
    v_pk_fma_f32 v[56:57], v[56:57], s[22:23], v[34:35] op_sel:[0,0,0] op_sel_hi:[1,1,0] neg_lo:[0,0,1] neg_hi:[0,0,1]
    v_pk_fma_f32 v[58:59], v[58:59], s[22:23], v[34:35] op_sel:[0,0,0] op_sel_hi:[1,1,0] neg_lo:[0,0,1] neg_hi:[0,0,1]
    v_pk_fma_f32 v[60:61], v[60:61], s[22:23], v[34:35] op_sel:[0,0,1] op_sel_hi:[1,1,1] neg_lo:[0,0,1] neg_hi:[0,0,1]
    v_pk_fma_f32 v[62:63], v[62:63], s[22:23], v[34:35] op_sel:[0,0,1] op_sel_hi:[1,1,1] neg_lo:[0,0,1] neg_hi:[0,0,1]
    s_add_u32 m0, s55, 61440
    s_nop 0
    buffer_load_dwordx4 v247, s[40:43], s54 offen lds
    s_add_u32 s54, s54, 65536
    v_exp_f32 v48, v48
    v_exp_f32 v49, v49
    v_exp_f32 v50, v50
    v_exp_f32 v51, v51
    v_exp_f32 v52, v52
    v_exp_f32 v53, v53
    v_exp_f32 v54, v54
    v_exp_f32 v55, v55
    v_exp_f32 v56, v56
    v_exp_f32 v57, v57
    v_exp_f32 v58, v58
    v_exp_f32 v59, v59
    v_exp_f32 v60, v60
    v_exp_f32 v61, v61
    v_exp_f32 v62, v62
    v_exp_f32 v63, v63
    v_pk_add_f32 v[36:37], v[48:49], v[50:51]
    v_pk_add_f32 v[38:39], v[52:53], v[54:55]
    v_pk_add_f32 v[40:41], v[56:57], v[58:59]
    v_pk_add_f32 v[42:43], v[60:61], v[62:63]
    v_add_f32 v32, v36, v37
    v_add_f32 v33, v38, v39
    v_add_f32 v34, v40, v41
    v_add_f32 v35, v42, v43
    v_permlane16_swap_b32 v0, v1
    v_permlane16_swap_b32 v2, v3
    v_permlane16_swap_b32 v32, v33
    v_permlane16_swap_b32 v34, v35
    v_add_f32 v0, v0, v1
    v_add_f32 v2, v2, v3
    v_add_f32 v32, v32, v33
    v_add_f32 v34, v34, v35
    v_permlane32_swap_b32 v0, v2
    s_nop 0
    v_permlane32_swap_b32 v32, v34
    v_add_f32 v0, v0, v2
    v_add_f32 v32, v32, v34
    v_rcp_f32 v0, v0
    v_rcp_f32 v32, v32
    v_mov_b32 v2, v0
    v_mov_b32 v34, v32
    s_nop 0
    v_permlane32_swap_b32 v0, v2
    v_permlane32_swap_b32 v32, v34
    v_mov_b32 v1, v0
    v_mov_b32 v3, v2
    v_mov_b32 v33, v32
    v_mov_b32 v35, v34
    v_permlane16_swap_b32 v0, v1
    v_permlane16_swap_b32 v2, v3
    v_permlane16_swap_b32 v32, v33
    v_permlane16_swap_b32 v34, v35
    v_pk_mul_f32 v[16:17], v[16:17], v[0:1] op_sel:[0,0] op_sel_hi:[1,0]
    v_pk_mul_f32 v[18:19], v[18:19], v[0:1] op_sel:[0,0] op_sel_hi:[1,0]
    v_pk_mul_f32 v[20:21], v[20:21], v[0:1] op_sel:[0,1] op_sel_hi:[1,1]
    v_pk_mul_f32 v[22:23], v[22:23], v[0:1] op_sel:[0,1] op_sel_hi:[1,1]
    v_pk_mul_f32 v[24:25], v[24:25], v[2:3] op_sel:[0,0] op_sel_hi:[1,0]
    v_pk_mul_f32 v[26:27], v[26:27], v[2:3] op_sel:[0,0] op_sel_hi:[1,0]
    v_pk_mul_f32 v[28:29], v[28:29], v[2:3] op_sel:[0,1] op_sel_hi:[1,1]
    v_pk_mul_f32 v[30:31], v[30:31], v[2:3] op_sel:[0,1] op_sel_hi:[1,1]
    v_cvt_pk_bf16_f32 v82, v16, v17
    v_cvt_pk_bf16_f32 v83, v18, v19
    v_cvt_pk_bf16_f32 v86, v20, v21
    v_cvt_pk_bf16_f32 v87, v22, v23
    v_cvt_pk_bf16_f32 v90, v24, v25
    v_cvt_pk_bf16_f32 v91, v26, v27
    v_cvt_pk_bf16_f32 v94, v28, v29
    v_cvt_pk_bf16_f32 v95, v30, v31
    s_branch L_po_q_6
.p2align 12
L_pg_q_6:
    s_branch L_pg_K_2
L_po_q_6:
    v_bfi_b32 v80, v245, 0, v82
    v_and_b32 v82, v245, v82
    v_bfi_b32 v81, v246, 0, v83
    v_and_b32 v83, v246, v83
    v_bfi_b32 v84, v245, 0, v86
    v_and_b32 v86, v245, v86
    v_bfi_b32 v85, v246, 0, v87
    v_and_b32 v87, v246, v87
    v_bfi_b32 v88, v245, 0, v90
    v_and_b32 v90, v245, v90
    v_bfi_b32 v89, v246, 0, v91
    v_and_b32 v91, v246, v91
    v_bfi_b32 v92, v245, 0, v94
    v_and_b32 v94, v245, v94
    v_bfi_b32 v93, v246, 0, v95
    v_and_b32 v95, v246, v95
    s_cmp_eq_u32 s62, 0
    s_cbranch_scc1 L_lzf_32
L_lzf_ret_33:
    buffer_load_dword v243, v240, s[44:47], 0 offen sc1
    s_sub_u32 s0, s12, 2048
    s_sub_u32 s1, s13, 2048
    v_pk_mul_f32 v[48:49], v[48:49], v[32:33] op_sel:[0,0] op_sel_hi:[1,0]
    v_pk_mul_f32 v[50:51], v[50:51], v[32:33] op_sel:[0,0] op_sel_hi:[1,0]
    v_pk_mul_f32 v[52:53], v[52:53], v[32:33] op_sel:[0,1] op_sel_hi:[1,1]
    v_pk_mul_f32 v[54:55], v[54:55], v[32:33] op_sel:[0,1] op_sel_hi:[1,1]
    v_pk_mul_f32 v[56:57], v[56:57], v[34:35] op_sel:[0,0] op_sel_hi:[1,0]
    v_pk_mul_f32 v[58:59], v[58:59], v[34:35] op_sel:[0,0] op_sel_hi:[1,0]
    v_pk_mul_f32 v[60:61], v[60:61], v[34:35] op_sel:[0,1] op_sel_hi:[1,1]
    v_pk_mul_f32 v[62:63], v[62:63], v[34:35] op_sel:[0,1] op_sel_hi:[1,1]
    v_mfma_f32_16x16x32_bf16 v[192:195], v[128:131], v[80:83], 0
    v_cvt_pk_bf16_f32 v114, v48, v49
    v_cvt_pk_bf16_f32 v115, v50, v51
    v_mfma_f32_16x16x32_bf16 v[196:199], v[144:147], v[80:83], 0
    v_cvt_pk_bf16_f32 v118, v52, v53
    v_cvt_pk_bf16_f32 v119, v54, v55
    v_mfma_f32_16x16x32_bf16 v[200:203], v[138:141], v[84:87], 0
    v_cvt_pk_bf16_f32 v122, v56, v57
    v_cvt_pk_bf16_f32 v123, v58, v59
    v_mfma_f32_16x16x32_bf16 v[204:207], v[154:157], v[84:87], 0
    v_cvt_pk_bf16_f32 v126, v60, v61
    v_cvt_pk_bf16_f32 v127, v62, v63
    v_mfma_f32_16x16x32_bf16 v[208:211], v[130:133], v[88:91], 0
    v_bfi_b32 v112, v245, 0, v114
    v_and_b32 v114, v245, v114
    v_mfma_f32_16x16x32_bf16 v[212:215], v[146:149], v[88:91], 0
    v_bfi_b32 v113, v246, 0, v115
    v_and_b32 v115, v246, v115
    v_mfma_f32_16x16x32_bf16 v[216:219], v[140:143], v[92:95], 0
    v_bfi_b32 v116, v245, 0, v118
    v_and_b32 v118, v245, v118
    v_mfma_f32_16x16x32_bf16 v[220:223], v[156:159], v[92:95], 0
    v_bfi_b32 v117, v246, 0, v119
    v_and_b32 v119, v246, v119
    v_bfi_b32 v120, v245, 0, v122
    v_and_b32 v122, v245, v122
    v_bfi_b32 v121, v246, 0, v123
    v_and_b32 v123, v246, v123
    v_bfi_b32 v124, v245, 0, v126
    v_and_b32 v126, v245, v126
    v_bfi_b32 v125, v246, 0, v127
    v_and_b32 v127, v246, v127
    v_cvt_pk_bf16_f32 v96, v192, v193
    v_cvt_pk_bf16_f32 v97, v194, v195
    v_cvt_pk_bf16_f32 v98, v196, v197
    v_cvt_pk_bf16_f32 v99, v198, v199
    buffer_store_dwordx4 v[96:99], v224, s[36:39], s0 offen offset:0 sc1
    v_cvt_pk_bf16_f32 v100, v200, v201
    v_cvt_pk_bf16_f32 v101, v202, v203
    v_cvt_pk_bf16_f32 v102, v204, v205
    v_cvt_pk_bf16_f32 v103, v206, v207
    buffer_store_dwordx4 v[100:103], v224, s[36:39], s0 offen offset:1024 sc1
    v_cvt_pk_bf16_f32 v104, v208, v209
    v_cvt_pk_bf16_f32 v105, v210, v211
    v_cvt_pk_bf16_f32 v106, v212, v213
    v_cvt_pk_bf16_f32 v107, v214, v215
    buffer_store_dwordx4 v[104:107], v224, s[36:39], s1 offen offset:0 sc1
    v_cvt_pk_bf16_f32 v108, v216, v217
    v_cvt_pk_bf16_f32 v109, v218, v219
    v_cvt_pk_bf16_f32 v110, v220, v221
    v_cvt_pk_bf16_f32 v111, v222, v223
    buffer_store_dwordx4 v[108:111], v224, s[36:39], s1 offen offset:1024 sc1
    v_mfma_f32_16x16x32_bf16 v[192:195], v[160:163], v[112:115], 0
    v_accvgpr_read_b32 v8, a244
    v_accvgpr_read_b32 v24, a245
    v_accvgpr_read_b32 v40, a246
    v_mfma_f32_16x16x32_bf16 v[196:199], v[176:179], v[112:115], 0
    v_accvgpr_read_b32 v56, a247
    v_lshlrev_b32 v0, 16, v8
    v_and_b32 v8, 0xffff0000, v8
    v_mfma_f32_16x16x32_bf16 v[200:203], v[170:173], v[116:119], 0
    v_mov_b32 v1, v0
    v_mov_b64 v[2:3], v[0:1]
    v_mov_b64 v[4:5], v[0:1]
    v_mfma_f32_16x16x32_bf16 v[204:207], v[186:189], v[116:119], 0
    v_mov_b64 v[6:7], v[0:1]
    v_mov_b32 v9, v8
    v_mov_b64 v[10:11], v[8:9]
    v_mfma_f32_16x16x32_bf16 v[208:211], v[162:165], v[120:123], 0
    v_mov_b64 v[12:13], v[8:9]
    v_mov_b64 v[14:15], v[8:9]
    v_lshlrev_b32 v16, 16, v24
    v_mfma_f32_16x16x32_bf16 v[212:215], v[178:181], v[120:123], 0
    v_and_b32 v24, 0xffff0000, v24
    v_mov_b32 v17, v16
    v_mov_b64 v[18:19], v[16:17]
    v_mfma_f32_16x16x32_bf16 v[216:219], v[172:175], v[124:127], 0
    v_mov_b64 v[20:21], v[16:17]
    v_mov_b64 v[22:23], v[16:17]
    v_mov_b32 v25, v24
    v_mfma_f32_16x16x32_bf16 v[220:223], v[188:191], v[124:127], 0
    v_mov_b64 v[26:27], v[24:25]
    v_mov_b64 v[28:29], v[24:25]
    v_mov_b64 v[30:31], v[24:25]
    v_lshlrev_b32 v32, 16, v40
    v_and_b32 v40, 0xffff0000, v40
    v_mov_b32 v33, v32
    v_mov_b64 v[34:35], v[32:33]
    v_mov_b64 v[36:37], v[32:33]
    v_mov_b64 v[38:39], v[32:33]
    v_mov_b32 v41, v40
    v_mov_b64 v[42:43], v[40:41]
    v_mov_b64 v[44:45], v[40:41]
    v_mov_b64 v[46:47], v[40:41]
    v_lshlrev_b32 v48, 16, v56
    v_and_b32 v56, 0xffff0000, v56
    v_mov_b32 v49, v48
    v_mov_b64 v[50:51], v[48:49]
    v_mov_b64 v[52:53], v[48:49]
    v_mov_b64 v[54:55], v[48:49]
    v_mov_b32 v57, v56
    v_mov_b64 v[58:59], v[56:57]
    v_mov_b64 v[60:61], v[56:57]
    v_mov_b64 v[62:63], v[56:57]
    v_cvt_pk_bf16_f32 v80, v192, v193
    v_cvt_pk_bf16_f32 v81, v194, v195
    v_cvt_pk_bf16_f32 v82, v196, v197
    v_cvt_pk_bf16_f32 v83, v198, v199
    v_cvt_pk_bf16_f32 v84, v200, v201
    v_cvt_pk_bf16_f32 v85, v202, v203
    v_cvt_pk_bf16_f32 v86, v204, v205
    v_cvt_pk_bf16_f32 v87, v206, v207
    v_cvt_pk_bf16_f32 v88, v208, v209
    v_cvt_pk_bf16_f32 v89, v210, v211
    v_cvt_pk_bf16_f32 v90, v212, v213
    v_cvt_pk_bf16_f32 v91, v214, v215
    v_cvt_pk_bf16_f32 v92, v216, v217
    v_cvt_pk_bf16_f32 v93, v218, v219
    v_cvt_pk_bf16_f32 v94, v220, v221
    v_cvt_pk_bf16_f32 v95, v222, v223
    s_waitcnt vmcnt(4)
    v_cmp_ne_u32 vcc, s26, v243
    s_cmp_eq_u32 s62, 0
    s_cselect_b64 vcc, -1, vcc
    s_cmp_eq_u64 vcc, 0
    s_cbranch_scc1 L_z2ok_23
    s_branch L_k1tail_22
    s_branch L_po_C_0
.p2align 12
L_pg_C_0:
    s_branch L_pg_C_3
L_po_C_0:
L_zC_21:
    buffer_load_dwordx4 a[160:163], v224, s[28:31], s52 offen offset:0 sc1
    buffer_load_dwordx4 a[164:167], v250, s[28:31], s52 offen offset:1024 sc1
    buffer_load_dwordx4 a[168:171], v251, s[28:31], s52 offen offset:2048 sc1
    buffer_load_dwordx4 a[172:175], v252, s[28:31], s52 offen offset:3072 sc1
    buffer_load_dwordx4 a[176:179], v224, s[28:31], s53 offen offset:0 sc1
    buffer_load_dwordx4 a[180:183], v250, s[28:31], s53 offen offset:1024 sc1
    buffer_load_dwordx4 a[184:187], v251, s[28:31], s53 offen offset:2048 sc1
    buffer_load_dwordx4 a[188:191], v252, s[28:31], s53 offen offset:3072 sc1
    s_waitcnt vmcnt(4)
    s_barrier
    ds_read_b64_tr_b16 a[0:1], v241 offset:0
    ds_read_b64_tr_b16 a[2:3], v241 offset:6144
    ds_read_b64_tr_b16 a[4:5], v242 offset:0
    ds_read_b64_tr_b16 a[6:7], v242 offset:6144
    ds_read_b64_tr_b16 a[8:9], v243 offset:0
    ds_read_b64_tr_b16 a[10:11], v243 offset:6144
    ds_read_b64_tr_b16 a[12:13], v244 offset:0
    ds_read_b64_tr_b16 a[14:15], v244 offset:6144
    ds_read_b64_tr_b16 a[16:17], v241 offset:2048
    ds_read_b64_tr_b16 a[18:19], v241 offset:8192
    s_mov_b32 s57, 4
    s_waitcnt lgkmcnt(6)
    v_mfma_f32_16x16x32_bf16 v[0:3], a[0:3], a[160:163], v[0:3]
    ds_read_b64_tr_b16 a[20:21], v242 offset:2048
    s_add_u32 s52, s52, s58
    s_add_u32 s53, s53, s58
    v_mfma_f32_16x16x32_bf16 v[4:7], a[0:3], a[164:167], v[4:7]
    buffer_load_dwordx4 a[32:35], v224, s[28:31], s52 offen offset:0 sc1
    v_mfma_f32_16x16x32_bf16 v[8:11], a[0:3], a[168:171], v[8:11]
    ds_read_b64_tr_b16 a[22:23], v242 offset:8192
    v_mfma_f32_16x16x32_bf16 v[12:15], a[0:3], a[172:175], v[12:15]
    v_mfma_f32_16x16x32_bf16 v[28:31], a[4:7], a[172:175], v[28:31]
    ds_read_b64_tr_b16 a[24:25], v243 offset:2048
    v_mfma_f32_16x16x32_bf16 v[24:27], a[4:7], a[168:171], v[24:27]
    buffer_load_dwordx4 a[36:39], v250, s[28:31], s52 offen offset:1024 sc1
    v_mfma_f32_16x16x32_bf16 v[20:23], a[4:7], a[164:167], v[20:23]
    ds_read_b64_tr_b16 a[26:27], v243 offset:8192
    v_mfma_f32_16x16x32_bf16 v[16:19], a[4:7], a[160:163], v[16:19]
    s_waitcnt lgkmcnt(6)
    v_mfma_f32_16x16x32_bf16 v[32:35], a[8:11], a[160:163], v[32:35]
    ds_read_b64_tr_b16 a[28:29], v244 offset:2048
    v_mfma_f32_16x16x32_bf16 v[36:39], a[8:11], a[164:167], v[36:39]
    buffer_load_dwordx4 a[40:43], v251, s[28:31], s52 offen offset:2048 sc1
    v_mfma_f32_16x16x32_bf16 v[40:43], a[8:11], a[168:171], v[40:43]
    ds_read_b64_tr_b16 a[30:31], v244 offset:8192
    v_mfma_f32_16x16x32_bf16 v[44:47], a[8:11], a[172:175], v[44:47]
    v_mfma_f32_16x16x32_bf16 v[60:63], a[12:15], a[172:175], v[60:63]
    ds_read_b64_tr_b16 a[0:1], v241 offset:4096
    v_mfma_f32_16x16x32_bf16 v[56:59], a[12:15], a[168:171], v[56:59]
    buffer_load_dwordx4 a[44:47], v252, s[28:31], s52 offen offset:3072 sc1
    v_mfma_f32_16x16x32_bf16 v[52:55], a[12:15], a[164:167], v[52:55]
    ds_read_b64_tr_b16 a[2:3], v241 offset:10240
    v_mfma_f32_16x16x32_bf16 v[48:51], a[12:15], a[160:163], v[48:51]
    s_waitcnt lgkmcnt(6)
    v_mfma_f32_16x16x32_bf16 v[64:67], a[16:19], a[160:163], v[64:67]
    ds_read_b64_tr_b16 a[4:5], v242 offset:4096
    v_mfma_f32_16x16x32_bf16 v[68:71], a[16:19], a[164:167], v[68:71]
    buffer_load_dwordx4 a[48:51], v224, s[28:31], s53 offen offset:0 sc1
    v_mfma_f32_16x16x32_bf16 v[72:75], a[16:19], a[168:171], v[72:75]
    ds_read_b64_tr_b16 a[6:7], v242 offset:10240
    v_mfma_f32_16x16x32_bf16 v[76:79], a[16:19], a[172:175], v[76:79]
    v_mfma_f32_16x16x32_bf16 v[92:95], a[20:23], a[172:175], v[92:95]
    ds_read_b64_tr_b16 a[8:9], v243 offset:4096
    v_mfma_f32_16x16x32_bf16 v[88:91], a[20:23], a[168:171], v[88:91]
    buffer_load_dwordx4 a[52:55], v250, s[28:31], s53 offen offset:1024 sc1
    v_mfma_f32_16x16x32_bf16 v[84:87], a[20:23], a[164:167], v[84:87]
    ds_read_b64_tr_b16 a[10:11], v243 offset:10240
    v_mfma_f32_16x16x32_bf16 v[80:83], a[20:23], a[160:163], v[80:83]
    s_waitcnt lgkmcnt(6)
    v_mfma_f32_16x16x32_bf16 v[96:99], a[24:27], a[160:163], v[96:99]
    ds_read_b64_tr_b16 a[12:13], v244 offset:4096
    v_mfma_f32_16x16x32_bf16 v[100:103], a[24:27], a[164:167], v[100:103]
    buffer_load_dwordx4 a[56:59], v251, s[28:31], s53 offen offset:2048 sc1
    v_mfma_f32_16x16x32_bf16 v[104:107], a[24:27], a[168:171], v[104:107]
    ds_read_b64_tr_b16 a[14:15], v244 offset:10240
    v_mfma_f32_16x16x32_bf16 v[108:111], a[24:27], a[172:175], v[108:111]
    v_mfma_f32_16x16x32_bf16 v[124:127], a[28:31], a[172:175], v[124:127]
    ds_read_b64_tr_b16 a[16:17], v241 offset:12288
    v_mfma_f32_16x16x32_bf16 v[120:123], a[28:31], a[168:171], v[120:123]
    buffer_load_dwordx4 a[60:63], v252, s[28:31], s53 offen offset:3072 sc1
    v_mfma_f32_16x16x32_bf16 v[116:119], a[28:31], a[164:167], v[116:119]
    ds_read_b64_tr_b16 a[18:19], v241 offset:18432
    v_mfma_f32_16x16x32_bf16 v[112:115], a[28:31], a[160:163], v[112:115]
    s_waitcnt lgkmcnt(6)
    v_mfma_f32_16x16x32_bf16 v[128:131], a[0:3], a[160:163], v[128:131]
    ds_read_b64_tr_b16 a[20:21], v242 offset:12288
    s_add_u32 m0, s55, 24576
    v_mfma_f32_16x16x32_bf16 v[132:135], a[0:3], a[164:167], v[132:135]
    buffer_load_dwordx4 v227, s[32:35], s64 offen offset:0 lds
    s_add_u32 s64, s64, s59
    v_mfma_f32_16x16x32_bf16 v[136:139], a[0:3], a[168:171], v[136:139]
    ds_read_b64_tr_b16 a[22:23], v242 offset:18432
    v_mfma_f32_16x16x32_bf16 v[140:143], a[0:3], a[172:175], v[140:143]
    v_mfma_f32_16x16x32_bf16 v[156:159], a[4:7], a[172:175], v[156:159]
    ds_read_b64_tr_b16 a[24:25], v243 offset:12288
    v_mfma_f32_16x16x32_bf16 v[152:155], a[4:7], a[168:171], v[152:155]
    ds_read_b64_tr_b16 a[26:27], v243 offset:18432
    v_mfma_f32_16x16x32_bf16 v[148:151], a[4:7], a[164:167], v[148:151]
    v_mfma_f32_16x16x32_bf16 v[144:147], a[4:7], a[160:163], v[144:147]
    s_waitcnt lgkmcnt(6)
    v_mfma_f32_16x16x32_bf16 v[160:163], a[8:11], a[160:163], v[160:163]
    ds_read_b64_tr_b16 a[28:29], v244 offset:12288
    v_mfma_f32_16x16x32_bf16 v[164:167], a[8:11], a[164:167], v[164:167]
    buffer_load_dwordx4 v227, s[32:35], s65 offen offset:1024 lds
    s_add_u32 s65, s65, s59
    v_mfma_f32_16x16x32_bf16 v[168:171], a[8:11], a[168:171], v[168:171]
    ds_read_b64_tr_b16 a[30:31], v244 offset:18432
    v_mfma_f32_16x16x32_bf16 v[172:175], a[8:11], a[172:175], v[172:175]
    v_mfma_f32_16x16x32_bf16 v[188:191], a[12:15], a[172:175], v[188:191]
    ds_read_b64_tr_b16 a[0:1], v241 offset:14336
    v_mfma_f32_16x16x32_bf16 v[184:187], a[12:15], a[168:171], v[184:187]
    buffer_load_dwordx4 v227, s[32:35], s66 offen offset:2048 lds
    s_add_u32 s66, s66, s59
    v_mfma_f32_16x16x32_bf16 v[180:183], a[12:15], a[164:167], v[180:183]
    ds_read_b64_tr_b16 a[2:3], v241 offset:20480
    v_mfma_f32_16x16x32_bf16 v[176:179], a[12:15], a[160:163], v[176:179]
    s_waitcnt vmcnt(11) lgkmcnt(6)
    v_mfma_f32_16x16x32_bf16 v[0:3], a[16:19], a[176:179], v[0:3]
    ds_read_b64_tr_b16 a[4:5], v242 offset:14336
    v_mfma_f32_16x16x32_bf16 v[4:7], a[16:19], a[180:183], v[4:7]
    buffer_load_dwordx4 v227, s[32:35], s67 offen offset:3072 lds
    s_add_u32 s67, s67, s59
    v_mfma_f32_16x16x32_bf16 v[8:11], a[16:19], a[184:187], v[8:11]
    ds_read_b64_tr_b16 a[6:7], v242 offset:20480
    v_mfma_f32_16x16x32_bf16 v[12:15], a[16:19], a[188:191], v[12:15]
    v_mfma_f32_16x16x32_bf16 v[28:31], a[20:23], a[188:191], v[28:31]
    ds_read_b64_tr_b16 a[8:9], v243 offset:14336
    s_add_u32 m0, s55, 28672
    v_mfma_f32_16x16x32_bf16 v[24:27], a[20:23], a[184:187], v[24:27]
    buffer_load_dwordx4 v227, s[32:35], s68 offen offset:0 lds
    s_add_u32 s68, s68, s59
    v_mfma_f32_16x16x32_bf16 v[20:23], a[20:23], a[180:183], v[20:23]
    ds_read_b64_tr_b16 a[10:11], v243 offset:20480
    v_mfma_f32_16x16x32_bf16 v[16:19], a[20:23], a[176:179], v[16:19]
    s_waitcnt lgkmcnt(6)
    v_mfma_f32_16x16x32_bf16 v[32:35], a[24:27], a[176:179], v[32:35]
    ds_read_b64_tr_b16 a[12:13], v244 offset:14336
    v_mfma_f32_16x16x32_bf16 v[36:39], a[24:27], a[180:183], v[36:39]
    buffer_load_dwordx4 v227, s[32:35], s69 offen offset:1024 lds
    s_add_u32 s69, s69, s59
    v_mfma_f32_16x16x32_bf16 v[40:43], a[24:27], a[184:187], v[40:43]
    ds_read_b64_tr_b16 a[14:15], v244 offset:20480
    v_mfma_f32_16x16x32_bf16 v[44:47], a[24:27], a[188:191], v[44:47]
    v_mfma_f32_16x16x32_bf16 v[60:63], a[28:31], a[188:191], v[60:63]
    ds_read_b64_tr_b16 a[16:17], v241 offset:16384
    s_add_u32 s52, s52, s58
    s_add_u32 s53, s53, s58
    v_mfma_f32_16x16x32_bf16 v[56:59], a[28:31], a[184:187], v[56:59]
    buffer_load_dwordx4 a[64:67], v224, s[28:31], s52 offen offset:0 sc1
    v_mfma_f32_16x16x32_bf16 v[52:55], a[28:31], a[180:183], v[52:55]
    ds_read_b64_tr_b16 a[18:19], v241 offset:22528
    v_mfma_f32_16x16x32_bf16 v[48:51], a[28:31], a[176:179], v[48:51]
    s_waitcnt lgkmcnt(6)
    v_mfma_f32_16x16x32_bf16 v[64:67], a[0:3], a[176:179], v[64:67]
    ds_read_b64_tr_b16 a[20:21], v242 offset:16384
    v_mfma_f32_16x16x32_bf16 v[68:71], a[0:3], a[180:183], v[68:71]
    buffer_load_dwordx4 a[68:71], v250, s[28:31], s52 offen offset:1024 sc1
    v_mfma_f32_16x16x32_bf16 v[72:75], a[0:3], a[184:187], v[72:75]
    ds_read_b64_tr_b16 a[22:23], v242 offset:22528
    v_mfma_f32_16x16x32_bf16 v[76:79], a[0:3], a[188:191], v[76:79]
    v_mfma_f32_16x16x32_bf16 v[92:95], a[4:7], a[188:191], v[92:95]
    ds_read_b64_tr_b16 a[24:25], v243 offset:16384
    v_mfma_f32_16x16x32_bf16 v[88:91], a[4:7], a[184:187], v[88:91]
    buffer_load_dwordx4 a[72:75], v251, s[28:31], s52 offen offset:2048 sc1
    v_mfma_f32_16x16x32_bf16 v[84:87], a[4:7], a[180:183], v[84:87]
    ds_read_b64_tr_b16 a[26:27], v243 offset:22528
    v_mfma_f32_16x16x32_bf16 v[80:83], a[4:7], a[176:179], v[80:83]
    s_waitcnt lgkmcnt(6)
    v_mfma_f32_16x16x32_bf16 v[96:99], a[8:11], a[176:179], v[96:99]
    ds_read_b64_tr_b16 a[28:29], v244 offset:16384
    v_mfma_f32_16x16x32_bf16 v[100:103], a[8:11], a[180:183], v[100:103]
    ds_read_b64_tr_b16 a[30:31], v244 offset:22528
    v_mfma_f32_16x16x32_bf16 v[104:107], a[8:11], a[184:187], v[104:107]
    v_mfma_f32_16x16x32_bf16 v[108:111], a[8:11], a[188:191], v[108:111]
    s_waitcnt vmcnt(9)
    s_barrier
    v_mfma_f32_16x16x32_bf16 v[124:127], a[12:15], a[188:191], v[124:127]
    ds_read_b64_tr_b16 a[0:1], v229 offset:0
    v_mfma_f32_16x16x32_bf16 v[120:123], a[12:15], a[184:187], v[120:123]
    buffer_load_dwordx4 a[76:79], v252, s[28:31], s52 offen offset:3072 sc1
    v_mfma_f32_16x16x32_bf16 v[116:119], a[12:15], a[180:183], v[116:119]
    ds_read_b64_tr_b16 a[2:3], v229 offset:6144
    v_mfma_f32_16x16x32_bf16 v[112:115], a[12:15], a[176:179], v[112:115]
    s_waitcnt lgkmcnt(6)
    v_mfma_f32_16x16x32_bf16 v[128:131], a[16:19], a[176:179], v[128:131]
    ds_read_b64_tr_b16 a[4:5], v230 offset:0
    v_mfma_f32_16x16x32_bf16 v[132:135], a[16:19], a[180:183], v[132:135]
    buffer_load_dwordx4 a[80:83], v224, s[28:31], s53 offen offset:0 sc1
    v_mfma_f32_16x16x32_bf16 v[136:139], a[16:19], a[184:187], v[136:139]
    ds_read_b64_tr_b16 a[6:7], v230 offset:6144
    v_mfma_f32_16x16x32_bf16 v[140:143], a[16:19], a[188:191], v[140:143]
    v_mfma_f32_16x16x32_bf16 v[156:159], a[20:23], a[188:191], v[156:159]
    ds_read_b64_tr_b16 a[8:9], v231 offset:0
    v_mfma_f32_16x16x32_bf16 v[152:155], a[20:23], a[184:187], v[152:155]
    buffer_load_dwordx4 a[84:87], v250, s[28:31], s53 offen offset:1024 sc1
    v_mfma_f32_16x16x32_bf16 v[148:151], a[20:23], a[180:183], v[148:151]
    ds_read_b64_tr_b16 a[10:11], v231 offset:6144
    v_mfma_f32_16x16x32_bf16 v[144:147], a[20:23], a[176:179], v[144:147]
    s_waitcnt lgkmcnt(6)
    v_mfma_f32_16x16x32_bf16 v[160:163], a[24:27], a[176:179], v[160:163]
    ds_read_b64_tr_b16 a[12:13], v232 offset:0
    v_mfma_f32_16x16x32_bf16 v[164:167], a[24:27], a[180:183], v[164:167]
    buffer_load_dwordx4 a[88:91], v251, s[28:31], s53 offen offset:2048 sc1
    v_mfma_f32_16x16x32_bf16 v[168:171], a[24:27], a[184:187], v[168:171]
    ds_read_b64_tr_b16 a[14:15], v232 offset:6144
    v_mfma_f32_16x16x32_bf16 v[172:175], a[24:27], a[188:191], v[172:175]
    v_mfma_f32_16x16x32_bf16 v[188:191], a[28:31], a[188:191], v[188:191]
    ds_read_b64_tr_b16 a[16:17], v229 offset:2048
    v_mfma_f32_16x16x32_bf16 v[184:187], a[28:31], a[184:187], v[184:187]
    buffer_load_dwordx4 a[92:95], v252, s[28:31], s53 offen offset:3072 sc1
    v_mfma_f32_16x16x32_bf16 v[180:183], a[28:31], a[180:183], v[180:183]
    ds_read_b64_tr_b16 a[18:19], v229 offset:8192
    v_mfma_f32_16x16x32_bf16 v[176:179], a[28:31], a[176:179], v[176:179]
    s_waitcnt lgkmcnt(6)
    v_mfma_f32_16x16x32_bf16 v[0:3], a[0:3], a[32:35], v[0:3]
    ds_read_b64_tr_b16 a[20:21], v230 offset:2048
    v_mfma_f32_16x16x32_bf16 v[4:7], a[0:3], a[36:39], v[4:7]
    buffer_load_dword a240, v253, s[36:39], s17 offen
    s_add_u32 s17, s17, 524288
    v_mfma_f32_16x16x32_bf16 v[8:11], a[0:3], a[40:43], v[8:11]
    ds_read_b64_tr_b16 a[22:23], v230 offset:8192
    v_mfma_f32_16x16x32_bf16 v[12:15], a[0:3], a[44:47], v[12:15]
    v_mfma_f32_16x16x32_bf16 v[28:31], a[4:7], a[44:47], v[28:31]
    ds_read_b64_tr_b16 a[24:25], v231 offset:2048
    v_mfma_f32_16x16x32_bf16 v[24:27], a[4:7], a[40:43], v[24:27]
    buffer_load_dword a240, v253, s[36:39], s17 offen
    s_add_u32 s17, s17, 524288
    v_mfma_f32_16x16x32_bf16 v[20:23], a[4:7], a[36:39], v[20:23]
    ds_read_b64_tr_b16 a[26:27], v231 offset:8192
    v_mfma_f32_16x16x32_bf16 v[16:19], a[4:7], a[32:35], v[16:19]
    s_waitcnt lgkmcnt(6)
    v_mfma_f32_16x16x32_bf16 v[32:35], a[8:11], a[32:35], v[32:35]
    ds_read_b64_tr_b16 a[28:29], v232 offset:2048
    v_mfma_f32_16x16x32_bf16 v[36:39], a[8:11], a[36:39], v[36:39]
    ds_read_b64_tr_b16 a[30:31], v232 offset:8192
    v_mfma_f32_16x16x32_bf16 v[40:43], a[8:11], a[40:43], v[40:43]
    v_mfma_f32_16x16x32_bf16 v[44:47], a[8:11], a[44:47], v[44:47]
    v_mfma_f32_16x16x32_bf16 v[60:63], a[12:15], a[44:47], v[60:63]
    ds_read_b64_tr_b16 a[0:1], v229 offset:4096
    s_add_u32 s52, s52, s58
    s_add_u32 s53, s53, s58
    v_mfma_f32_16x16x32_bf16 v[56:59], a[12:15], a[40:43], v[56:59]
    s_add_u32 s56, s56, 1
    s_add_u32 m0, s55, 49152
    s_nop 0
    buffer_load_dwordx4 v227, s[32:35], s64 offen offset:0 lds
    v_mfma_f32_16x16x32_bf16 v[52:55], a[12:15], a[36:39], v[52:55]
    ds_read_b64_tr_b16 a[2:3], v229 offset:10240
    s_add_u32 s64, s64, s59
    v_mfma_f32_16x16x32_bf16 v[48:51], a[12:15], a[32:35], v[48:51]
    s_waitcnt lgkmcnt(6)
    v_mfma_f32_16x16x32_bf16 v[64:67], a[16:19], a[32:35], v[64:67]
    ds_read_b64_tr_b16 a[4:5], v230 offset:4096
    v_mfma_f32_16x16x32_bf16 v[68:71], a[16:19], a[36:39], v[68:71]
    buffer_load_dwordx4 a[96:99], v224, s[28:31], s52 offen offset:0 sc1
    v_mfma_f32_16x16x32_bf16 v[72:75], a[16:19], a[40:43], v[72:75]
    ds_read_b64_tr_b16 a[6:7], v230 offset:10240
    v_mfma_f32_16x16x32_bf16 v[76:79], a[16:19], a[44:47], v[76:79]
    v_mfma_f32_16x16x32_bf16 v[92:95], a[20:23], a[44:47], v[92:95]
    ds_read_b64_tr_b16 a[8:9], v231 offset:4096
    v_mfma_f32_16x16x32_bf16 v[88:91], a[20:23], a[40:43], v[88:91]
    buffer_load_dwordx4 v227, s[32:35], s65 offen offset:1024 lds
    s_add_u32 s65, s65, s59
    v_mfma_f32_16x16x32_bf16 v[84:87], a[20:23], a[36:39], v[84:87]
    ds_read_b64_tr_b16 a[10:11], v231 offset:10240
    v_mfma_f32_16x16x32_bf16 v[80:83], a[20:23], a[32:35], v[80:83]
    s_waitcnt lgkmcnt(6)
    v_mfma_f32_16x16x32_bf16 v[96:99], a[24:27], a[32:35], v[96:99]
    ds_read_b64_tr_b16 a[12:13], v232 offset:4096
    v_mfma_f32_16x16x32_bf16 v[100:103], a[24:27], a[36:39], v[100:103]
    buffer_load_dwordx4 a[100:103], v250, s[28:31], s52 offen offset:1024 sc1
    v_mfma_f32_16x16x32_bf16 v[104:107], a[24:27], a[40:43], v[104:107]
    ds_read_b64_tr_b16 a[14:15], v232 offset:10240
    v_mfma_f32_16x16x32_bf16 v[108:111], a[24:27], a[44:47], v[108:111]
    v_mfma_f32_16x16x32_bf16 v[124:127], a[28:31], a[44:47], v[124:127]
    ds_read_b64_tr_b16 a[16:17], v229 offset:12288
    v_mfma_f32_16x16x32_bf16 v[120:123], a[28:31], a[40:43], v[120:123]
    buffer_load_dwordx4 v227, s[32:35], s66 offen offset:2048 lds
    s_add_u32 s66, s66, s59
    v_mfma_f32_16x16x32_bf16 v[116:119], a[28:31], a[36:39], v[116:119]
    ds_read_b64_tr_b16 a[18:19], v229 offset:18432
    v_mfma_f32_16x16x32_bf16 v[112:115], a[28:31], a[32:35], v[112:115]
    s_waitcnt lgkmcnt(6)
    v_mfma_f32_16x16x32_bf16 v[128:131], a[0:3], a[32:35], v[128:131]
    ds_read_b64_tr_b16 a[20:21], v230 offset:12288
    v_mfma_f32_16x16x32_bf16 v[132:135], a[0:3], a[36:39], v[132:135]
    buffer_load_dwordx4 a[104:107], v251, s[28:31], s52 offen offset:2048 sc1
    v_mfma_f32_16x16x32_bf16 v[136:139], a[0:3], a[40:43], v[136:139]
    ds_read_b64_tr_b16 a[22:23], v230 offset:18432
    v_mfma_f32_16x16x32_bf16 v[140:143], a[0:3], a[44:47], v[140:143]
    v_mfma_f32_16x16x32_bf16 v[156:159], a[4:7], a[44:47], v[156:159]
    ds_read_b64_tr_b16 a[24:25], v231 offset:12288
    v_mfma_f32_16x16x32_bf16 v[152:155], a[4:7], a[40:43], v[152:155]
    buffer_load_dwordx4 v227, s[32:35], s67 offen offset:3072 lds
    s_add_u32 s67, s67, s59
    v_mfma_f32_16x16x32_bf16 v[148:151], a[4:7], a[36:39], v[148:151]
    ds_read_b64_tr_b16 a[26:27], v231 offset:18432
    v_mfma_f32_16x16x32_bf16 v[144:147], a[4:7], a[32:35], v[144:147]
    s_waitcnt lgkmcnt(6)
    v_mfma_f32_16x16x32_bf16 v[160:163], a[8:11], a[32:35], v[160:163]
    ds_read_b64_tr_b16 a[28:29], v232 offset:12288
    v_mfma_f32_16x16x32_bf16 v[164:167], a[8:11], a[36:39], v[164:167]
    ds_read_b64_tr_b16 a[30:31], v232 offset:18432
    v_mfma_f32_16x16x32_bf16 v[168:171], a[8:11], a[40:43], v[168:171]
    v_mfma_f32_16x16x32_bf16 v[172:175], a[8:11], a[44:47], v[172:175]
    v_mfma_f32_16x16x32_bf16 v[188:191], a[12:15], a[44:47], v[188:191]
    ds_read_b64_tr_b16 a[0:1], v229 offset:14336
    v_mfma_f32_16x16x32_bf16 v[184:187], a[12:15], a[40:43], v[184:187]
    buffer_load_dwordx4 a[108:111], v252, s[28:31], s52 offen offset:3072 sc1
    v_mfma_f32_16x16x32_bf16 v[180:183], a[12:15], a[36:39], v[180:183]
    ds_read_b64_tr_b16 a[2:3], v229 offset:20480
    v_mfma_f32_16x16x32_bf16 v[176:179], a[12:15], a[32:35], v[176:179]
    s_waitcnt lgkmcnt(6)
    v_mfma_f32_16x16x32_bf16 v[0:3], a[16:19], a[48:51], v[0:3]
    ds_read_b64_tr_b16 a[4:5], v230 offset:14336
    s_add_u32 m0, s55, 53248
    v_mfma_f32_16x16x32_bf16 v[4:7], a[16:19], a[52:55], v[4:7]
    buffer_load_dwordx4 v227, s[32:35], s68 offen offset:0 lds
    s_add_u32 s68, s68, s59
    v_mfma_f32_16x16x32_bf16 v[8:11], a[16:19], a[56:59], v[8:11]
    ds_read_b64_tr_b16 a[6:7], v230 offset:20480
    v_mfma_f32_16x16x32_bf16 v[12:15], a[16:19], a[60:63], v[12:15]
    v_mfma_f32_16x16x32_bf16 v[28:31], a[20:23], a[60:63], v[28:31]
    ds_read_b64_tr_b16 a[8:9], v231 offset:14336
    v_mfma_f32_16x16x32_bf16 v[24:27], a[20:23], a[56:59], v[24:27]
    buffer_load_dwordx4 a[112:115], v224, s[28:31], s53 offen offset:0 sc1
    v_mfma_f32_16x16x32_bf16 v[20:23], a[20:23], a[52:55], v[20:23]
    ds_read_b64_tr_b16 a[10:11], v231 offset:20480
    v_mfma_f32_16x16x32_bf16 v[16:19], a[20:23], a[48:51], v[16:19]
    s_waitcnt lgkmcnt(6)
    v_mfma_f32_16x16x32_bf16 v[32:35], a[24:27], a[48:51], v[32:35]
    ds_read_b64_tr_b16 a[12:13], v232 offset:14336
    v_mfma_f32_16x16x32_bf16 v[36:39], a[24:27], a[52:55], v[36:39]
    buffer_load_dwordx4 v227, s[32:35], s69 offen offset:1024 lds
    s_add_u32 s69, s69, s59
    v_mfma_f32_16x16x32_bf16 v[40:43], a[24:27], a[56:59], v[40:43]
    ds_read_b64_tr_b16 a[14:15], v232 offset:20480
    v_mfma_f32_16x16x32_bf16 v[44:47], a[24:27], a[60:63], v[44:47]
    v_mfma_f32_16x16x32_bf16 v[60:63], a[28:31], a[60:63], v[60:63]
    ds_read_b64_tr_b16 a[16:17], v229 offset:16384
    v_mfma_f32_16x16x32_bf16 v[56:59], a[28:31], a[56:59], v[56:59]
    buffer_load_dwordx4 a[116:119], v250, s[28:31], s53 offen offset:1024 sc1
    v_mfma_f32_16x16x32_bf16 v[52:55], a[28:31], a[52:55], v[52:55]
    ds_read_b64_tr_b16 a[18:19], v229 offset:22528
    v_mfma_f32_16x16x32_bf16 v[48:51], a[28:31], a[48:51], v[48:51]
    s_waitcnt lgkmcnt(6)
    v_mfma_f32_16x16x32_bf16 v[64:67], a[0:3], a[48:51], v[64:67]
    ds_read_b64_tr_b16 a[20:21], v230 offset:16384
    v_mfma_f32_16x16x32_bf16 v[68:71], a[0:3], a[52:55], v[68:71]
    buffer_load_dwordx4 a[120:123], v251, s[28:31], s53 offen offset:2048 sc1
    v_mfma_f32_16x16x32_bf16 v[72:75], a[0:3], a[56:59], v[72:75]
    ds_read_b64_tr_b16 a[22:23], v230 offset:22528
    v_mfma_f32_16x16x32_bf16 v[76:79], a[0:3], a[60:63], v[76:79]
    v_mfma_f32_16x16x32_bf16 v[92:95], a[4:7], a[60:63], v[92:95]
    ds_read_b64_tr_b16 a[24:25], v231 offset:16384
    v_mfma_f32_16x16x32_bf16 v[88:91], a[4:7], a[56:59], v[88:91]
    buffer_load_dwordx4 a[124:127], v252, s[28:31], s53 offen offset:3072 sc1
    v_mfma_f32_16x16x32_bf16 v[84:87], a[4:7], a[52:55], v[84:87]
    ds_read_b64_tr_b16 a[26:27], v231 offset:22528
    v_mfma_f32_16x16x32_bf16 v[80:83], a[4:7], a[48:51], v[80:83]
    s_waitcnt lgkmcnt(6)
    v_mfma_f32_16x16x32_bf16 v[96:99], a[8:11], a[48:51], v[96:99]
    ds_read_b64_tr_b16 a[28:29], v232 offset:16384
    v_mfma_f32_16x16x32_bf16 v[100:103], a[8:11], a[52:55], v[100:103]
    ds_read_b64_tr_b16 a[30:31], v232 offset:22528
    v_mfma_f32_16x16x32_bf16 v[104:107], a[8:11], a[56:59], v[104:107]
    v_mfma_f32_16x16x32_bf16 v[108:111], a[8:11], a[60:63], v[108:111]
    s_waitcnt vmcnt(16)
    s_barrier
    v_mfma_f32_16x16x32_bf16 v[124:127], a[12:15], a[60:63], v[124:127]
    ds_read_b64_tr_b16 a[0:1], v229 offset:24576
    s_add_u32 s52, s52, s58
    s_add_u32 s53, s53, s58
    v_mfma_f32_16x16x32_bf16 v[120:123], a[12:15], a[56:59], v[120:123]
    s_add_u32 s56, s56, 1
    s_add_u32 m0, s55, 73728
    s_nop 0
    buffer_load_dwordx4 v227, s[32:35], s64 offen offset:0 lds
    v_mfma_f32_16x16x32_bf16 v[116:119], a[12:15], a[52:55], v[116:119]
    ds_read_b64_tr_b16 a[2:3], v229 offset:30720
    s_add_u32 s64, s64, s59
    v_mfma_f32_16x16x32_bf16 v[112:115], a[12:15], a[48:51], v[112:115]
    s_waitcnt lgkmcnt(6)
    v_mfma_f32_16x16x32_bf16 v[128:131], a[16:19], a[48:51], v[128:131]
    ds_read_b64_tr_b16 a[4:5], v230 offset:24576
    v_mfma_f32_16x16x32_bf16 v[132:135], a[16:19], a[52:55], v[132:135]
    buffer_load_dwordx4 a[128:131], v224, s[28:31], s52 offen offset:0 sc1
    v_mfma_f32_16x16x32_bf16 v[136:139], a[16:19], a[56:59], v[136:139]
    ds_read_b64_tr_b16 a[6:7], v230 offset:30720
    v_mfma_f32_16x16x32_bf16 v[140:143], a[16:19], a[60:63], v[140:143]
    v_mfma_f32_16x16x32_bf16 v[156:159], a[20:23], a[60:63], v[156:159]
    ds_read_b64_tr_b16 a[8:9], v231 offset:24576
    v_mfma_f32_16x16x32_bf16 v[152:155], a[20:23], a[56:59], v[152:155]
    buffer_load_dwordx4 v227, s[32:35], s65 offen offset:1024 lds
    s_add_u32 s65, s65, s59
    v_mfma_f32_16x16x32_bf16 v[148:151], a[20:23], a[52:55], v[148:151]
    ds_read_b64_tr_b16 a[10:11], v231 offset:30720
    v_mfma_f32_16x16x32_bf16 v[144:147], a[20:23], a[48:51], v[144:147]
    s_waitcnt lgkmcnt(6)
    v_mfma_f32_16x16x32_bf16 v[160:163], a[24:27], a[48:51], v[160:163]
    ds_read_b64_tr_b16 a[12:13], v232 offset:24576
    v_mfma_f32_16x16x32_bf16 v[164:167], a[24:27], a[52:55], v[164:167]
    buffer_load_dwordx4 a[132:135], v250, s[28:31], s52 offen offset:1024 sc1
    v_mfma_f32_16x16x32_bf16 v[168:171], a[24:27], a[56:59], v[168:171]
    ds_read_b64_tr_b16 a[14:15], v232 offset:30720
    v_mfma_f32_16x16x32_bf16 v[172:175], a[24:27], a[60:63], v[172:175]
    v_mfma_f32_16x16x32_bf16 v[188:191], a[28:31], a[60:63], v[188:191]
    ds_read_b64_tr_b16 a[16:17], v229 offset:26624
    v_mfma_f32_16x16x32_bf16 v[184:187], a[28:31], a[56:59], v[184:187]
    buffer_load_dwordx4 v227, s[32:35], s66 offen offset:2048 lds
    s_add_u32 s66, s66, s59
    v_mfma_f32_16x16x32_bf16 v[180:183], a[28:31], a[52:55], v[180:183]
    ds_read_b64_tr_b16 a[18:19], v229 offset:32768
    v_mfma_f32_16x16x32_bf16 v[176:179], a[28:31], a[48:51], v[176:179]
    s_waitcnt lgkmcnt(6)
    v_mfma_f32_16x16x32_bf16 v[0:3], a[0:3], a[64:67], v[0:3]
    ds_read_b64_tr_b16 a[20:21], v230 offset:26624
    v_mfma_f32_16x16x32_bf16 v[4:7], a[0:3], a[68:71], v[4:7]
    buffer_load_dwordx4 a[136:139], v251, s[28:31], s52 offen offset:2048 sc1
    v_mfma_f32_16x16x32_bf16 v[8:11], a[0:3], a[72:75], v[8:11]
    ds_read_b64_tr_b16 a[22:23], v230 offset:32768
    v_mfma_f32_16x16x32_bf16 v[12:15], a[0:3], a[76:79], v[12:15]
    v_mfma_f32_16x16x32_bf16 v[28:31], a[4:7], a[76:79], v[28:31]
    ds_read_b64_tr_b16 a[24:25], v231 offset:26624
    v_mfma_f32_16x16x32_bf16 v[24:27], a[4:7], a[72:75], v[24:27]
    buffer_load_dwordx4 v227, s[32:35], s67 offen offset:3072 lds
    s_add_u32 s67, s67, s59
    v_mfma_f32_16x16x32_bf16 v[20:23], a[4:7], a[68:71], v[20:23]
    ds_read_b64_tr_b16 a[26:27], v231 offset:32768
    v_mfma_f32_16x16x32_bf16 v[16:19], a[4:7], a[64:67], v[16:19]
    s_waitcnt lgkmcnt(6)
    v_mfma_f32_16x16x32_bf16 v[32:35], a[8:11], a[64:67], v[32:35]
    ds_read_b64_tr_b16 a[28:29], v232 offset:26624
    v_mfma_f32_16x16x32_bf16 v[36:39], a[8:11], a[68:71], v[36:39]
    ds_read_b64_tr_b16 a[30:31], v232 offset:32768
    v_mfma_f32_16x16x32_bf16 v[40:43], a[8:11], a[72:75], v[40:43]
    v_mfma_f32_16x16x32_bf16 v[44:47], a[8:11], a[76:79], v[44:47]
    v_mfma_f32_16x16x32_bf16 v[60:63], a[12:15], a[76:79], v[60:63]
    ds_read_b64_tr_b16 a[0:1], v229 offset:28672
    v_mfma_f32_16x16x32_bf16 v[56:59], a[12:15], a[72:75], v[56:59]
    buffer_load_dwordx4 a[140:143], v252, s[28:31], s52 offen offset:3072 sc1
    v_mfma_f32_16x16x32_bf16 v[52:55], a[12:15], a[68:71], v[52:55]
    ds_read_b64_tr_b16 a[2:3], v229 offset:34816
    v_mfma_f32_16x16x32_bf16 v[48:51], a[12:15], a[64:67], v[48:51]
    s_waitcnt lgkmcnt(6)
    v_mfma_f32_16x16x32_bf16 v[64:67], a[16:19], a[64:67], v[64:67]
    ds_read_b64_tr_b16 a[4:5], v230 offset:28672
    s_add_u32 m0, s55, 77824
    v_mfma_f32_16x16x32_bf16 v[68:71], a[16:19], a[68:71], v[68:71]
    buffer_load_dwordx4 v227, s[32:35], s68 offen offset:0 lds
    s_add_u32 s68, s68, s59
    v_mfma_f32_16x16x32_bf16 v[72:75], a[16:19], a[72:75], v[72:75]
    ds_read_b64_tr_b16 a[6:7], v230 offset:34816
    v_mfma_f32_16x16x32_bf16 v[76:79], a[16:19], a[76:79], v[76:79]
    v_mfma_f32_16x16x32_bf16 v[92:95], a[20:23], a[76:79], v[92:95]
    ds_read_b64_tr_b16 a[8:9], v231 offset:28672
    v_mfma_f32_16x16x32_bf16 v[88:91], a[20:23], a[72:75], v[88:91]
    buffer_load_dwordx4 a[144:147], v224, s[28:31], s53 offen offset:0 sc1
    v_mfma_f32_16x16x32_bf16 v[84:87], a[20:23], a[68:71], v[84:87]
    ds_read_b64_tr_b16 a[10:11], v231 offset:34816
    v_mfma_f32_16x16x32_bf16 v[80:83], a[20:23], a[64:67], v[80:83]
    s_waitcnt lgkmcnt(6)
    v_mfma_f32_16x16x32_bf16 v[96:99], a[24:27], a[64:67], v[96:99]
    ds_read_b64_tr_b16 a[12:13], v232 offset:28672
    v_mfma_f32_16x16x32_bf16 v[100:103], a[24:27], a[68:71], v[100:103]
    buffer_load_dwordx4 v227, s[32:35], s69 offen offset:1024 lds
    s_add_u32 s69, s69, s59
    v_mfma_f32_16x16x32_bf16 v[104:107], a[24:27], a[72:75], v[104:107]
    ds_read_b64_tr_b16 a[14:15], v232 offset:34816
    v_mfma_f32_16x16x32_bf16 v[108:111], a[24:27], a[76:79], v[108:111]
    v_mfma_f32_16x16x32_bf16 v[124:127], a[28:31], a[76:79], v[124:127]
    ds_read_b64_tr_b16 a[16:17], v229 offset:36864
    v_mfma_f32_16x16x32_bf16 v[120:123], a[28:31], a[72:75], v[120:123]
    buffer_load_dwordx4 a[148:151], v250, s[28:31], s53 offen offset:1024 sc1
    v_mfma_f32_16x16x32_bf16 v[116:119], a[28:31], a[68:71], v[116:119]
    ds_read_b64_tr_b16 a[18:19], v229 offset:43008
    v_mfma_f32_16x16x32_bf16 v[112:115], a[28:31], a[64:67], v[112:115]
    s_waitcnt lgkmcnt(6)
    v_mfma_f32_16x16x32_bf16 v[128:131], a[0:3], a[64:67], v[128:131]
    ds_read_b64_tr_b16 a[20:21], v230 offset:36864
    v_mfma_f32_16x16x32_bf16 v[132:135], a[0:3], a[68:71], v[132:135]
    buffer_load_dwordx4 a[152:155], v251, s[28:31], s53 offen offset:2048 sc1
    v_mfma_f32_16x16x32_bf16 v[136:139], a[0:3], a[72:75], v[136:139]
    ds_read_b64_tr_b16 a[22:23], v230 offset:43008
    v_mfma_f32_16x16x32_bf16 v[140:143], a[0:3], a[76:79], v[140:143]
    v_mfma_f32_16x16x32_bf16 v[156:159], a[4:7], a[76:79], v[156:159]
    ds_read_b64_tr_b16 a[24:25], v231 offset:36864
    v_mfma_f32_16x16x32_bf16 v[152:155], a[4:7], a[72:75], v[152:155]
    buffer_load_dwordx4 a[156:159], v252, s[28:31], s53 offen offset:3072 sc1
    v_mfma_f32_16x16x32_bf16 v[148:151], a[4:7], a[68:71], v[148:151]
    ds_read_b64_tr_b16 a[26:27], v231 offset:43008
    v_mfma_f32_16x16x32_bf16 v[144:147], a[4:7], a[64:67], v[144:147]
    s_waitcnt lgkmcnt(6)
    v_mfma_f32_16x16x32_bf16 v[160:163], a[8:11], a[64:67], v[160:163]
    ds_read_b64_tr_b16 a[28:29], v232 offset:36864
    v_mfma_f32_16x16x32_bf16 v[164:167], a[8:11], a[68:71], v[164:167]
    ds_read_b64_tr_b16 a[30:31], v232 offset:43008
    v_mfma_f32_16x16x32_bf16 v[168:171], a[8:11], a[72:75], v[168:171]
    v_mfma_f32_16x16x32_bf16 v[172:175], a[8:11], a[76:79], v[172:175]
    v_mfma_f32_16x16x32_bf16 v[188:191], a[12:15], a[76:79], v[188:191]
    ds_read_b64_tr_b16 a[0:1], v229 offset:38912
    s_add_u32 s52, s52, s58
    s_add_u32 s53, s53, s58
    v_mfma_f32_16x16x32_bf16 v[184:187], a[12:15], a[72:75], v[184:187]
    s_add_u32 s56, s56, 1
    s_add_u32 m0, s55, 98304
    s_nop 0
    buffer_load_dwordx4 v227, s[32:35], s64 offen offset:0 lds
    v_mfma_f32_16x16x32_bf16 v[180:183], a[12:15], a[68:71], v[180:183]
    ds_read_b64_tr_b16 a[2:3], v229 offset:45056
    s_add_u32 s64, s64, s59
    v_mfma_f32_16x16x32_bf16 v[176:179], a[12:15], a[64:67], v[176:179]
    s_waitcnt lgkmcnt(6)
    v_mfma_f32_16x16x32_bf16 v[0:3], a[16:19], a[80:83], v[0:3]
    ds_read_b64_tr_b16 a[4:5], v230 offset:38912
    v_mfma_f32_16x16x32_bf16 v[4:7], a[16:19], a[84:87], v[4:7]
    buffer_load_dwordx4 a[160:163], v224, s[28:31], s52 offen offset:0 sc1
    v_mfma_f32_16x16x32_bf16 v[8:11], a[16:19], a[88:91], v[8:11]
    ds_read_b64_tr_b16 a[6:7], v230 offset:45056
    v_mfma_f32_16x16x32_bf16 v[12:15], a[16:19], a[92:95], v[12:15]
    v_mfma_f32_16x16x32_bf16 v[28:31], a[20:23], a[92:95], v[28:31]
    ds_read_b64_tr_b16 a[8:9], v231 offset:38912
    v_mfma_f32_16x16x32_bf16 v[24:27], a[20:23], a[88:91], v[24:27]
    buffer_load_dwordx4 v227, s[32:35], s65 offen offset:1024 lds
    s_add_u32 s65, s65, s59
    v_mfma_f32_16x16x32_bf16 v[20:23], a[20:23], a[84:87], v[20:23]
    ds_read_b64_tr_b16 a[10:11], v231 offset:45056
    v_mfma_f32_16x16x32_bf16 v[16:19], a[20:23], a[80:83], v[16:19]
    s_waitcnt lgkmcnt(6)
    v_mfma_f32_16x16x32_bf16 v[32:35], a[24:27], a[80:83], v[32:35]
    ds_read_b64_tr_b16 a[12:13], v232 offset:38912
    v_mfma_f32_16x16x32_bf16 v[36:39], a[24:27], a[84:87], v[36:39]
    buffer_load_dwordx4 a[164:167], v250, s[28:31], s52 offen offset:1024 sc1
    v_mfma_f32_16x16x32_bf16 v[40:43], a[24:27], a[88:91], v[40:43]
    ds_read_b64_tr_b16 a[14:15], v232 offset:45056
    v_mfma_f32_16x16x32_bf16 v[44:47], a[24:27], a[92:95], v[44:47]
    v_mfma_f32_16x16x32_bf16 v[60:63], a[28:31], a[92:95], v[60:63]
    ds_read_b64_tr_b16 a[16:17], v229 offset:40960
    v_mfma_f32_16x16x32_bf16 v[56:59], a[28:31], a[88:91], v[56:59]
    buffer_load_dwordx4 v227, s[32:35], s66 offen offset:2048 lds
    s_add_u32 s66, s66, s59
    v_mfma_f32_16x16x32_bf16 v[52:55], a[28:31], a[84:87], v[52:55]
    ds_read_b64_tr_b16 a[18:19], v229 offset:47104
    v_mfma_f32_16x16x32_bf16 v[48:51], a[28:31], a[80:83], v[48:51]
    s_waitcnt lgkmcnt(6)
    v_mfma_f32_16x16x32_bf16 v[64:67], a[0:3], a[80:83], v[64:67]
    ds_read_b64_tr_b16 a[20:21], v230 offset:40960
    v_mfma_f32_16x16x32_bf16 v[68:71], a[0:3], a[84:87], v[68:71]
    s_branch L_po_C_1
.p2align 12
L_pg_C_1:
    s_branch L_pg_C_4
L_po_C_1:
    buffer_load_dwordx4 a[168:171], v251, s[28:31], s52 offen offset:2048 sc1
    v_mfma_f32_16x16x32_bf16 v[72:75], a[0:3], a[88:91], v[72:75]
    ds_read_b64_tr_b16 a[22:23], v230 offset:47104
    v_mfma_f32_16x16x32_bf16 v[76:79], a[0:3], a[92:95], v[76:79]
    v_mfma_f32_16x16x32_bf16 v[92:95], a[4:7], a[92:95], v[92:95]
    ds_read_b64_tr_b16 a[24:25], v231 offset:40960
    v_mfma_f32_16x16x32_bf16 v[88:91], a[4:7], a[88:91], v[88:91]
    buffer_load_dwordx4 v227, s[32:35], s67 offen offset:3072 lds
    s_add_u32 s67, s67, s59
    v_mfma_f32_16x16x32_bf16 v[84:87], a[4:7], a[84:87], v[84:87]
    ds_read_b64_tr_b16 a[26:27], v231 offset:47104
    v_mfma_f32_16x16x32_bf16 v[80:83], a[4:7], a[80:83], v[80:83]
    s_waitcnt lgkmcnt(6)
    v_mfma_f32_16x16x32_bf16 v[96:99], a[8:11], a[80:83], v[96:99]
    ds_read_b64_tr_b16 a[28:29], v232 offset:40960
    v_mfma_f32_16x16x32_bf16 v[100:103], a[8:11], a[84:87], v[100:103]
    ds_read_b64_tr_b16 a[30:31], v232 offset:47104
    v_mfma_f32_16x16x32_bf16 v[104:107], a[8:11], a[88:91], v[104:107]
    v_mfma_f32_16x16x32_bf16 v[108:111], a[8:11], a[92:95], v[108:111]
    s_waitcnt vmcnt(21)
    s_barrier
    v_mfma_f32_16x16x32_bf16 v[124:127], a[12:15], a[92:95], v[124:127]
    ds_read_b64_tr_b16 a[0:1], v235 offset:0
    v_mfma_f32_16x16x32_bf16 v[120:123], a[12:15], a[88:91], v[120:123]
    buffer_load_dwordx4 a[172:175], v252, s[28:31], s52 offen offset:3072 sc1
    v_mfma_f32_16x16x32_bf16 v[116:119], a[12:15], a[84:87], v[116:119]
    ds_read_b64_tr_b16 a[2:3], v235 offset:6144
    v_mfma_f32_16x16x32_bf16 v[112:115], a[12:15], a[80:83], v[112:115]
    s_waitcnt lgkmcnt(6)
    v_mfma_f32_16x16x32_bf16 v[128:131], a[16:19], a[80:83], v[128:131]
    ds_read_b64_tr_b16 a[4:5], v236 offset:0
    s_add_u32 m0, s55, 102400
    v_mfma_f32_16x16x32_bf16 v[132:135], a[16:19], a[84:87], v[132:135]
    buffer_load_dwordx4 v227, s[32:35], s68 offen offset:0 lds
    s_add_u32 s68, s68, s59
    v_mfma_f32_16x16x32_bf16 v[136:139], a[16:19], a[88:91], v[136:139]
    ds_read_b64_tr_b16 a[6:7], v236 offset:6144
    v_mfma_f32_16x16x32_bf16 v[140:143], a[16:19], a[92:95], v[140:143]
    v_mfma_f32_16x16x32_bf16 v[156:159], a[20:23], a[92:95], v[156:159]
    ds_read_b64_tr_b16 a[8:9], v237 offset:0
    v_mfma_f32_16x16x32_bf16 v[152:155], a[20:23], a[88:91], v[152:155]
    buffer_load_dwordx4 a[176:179], v224, s[28:31], s53 offen offset:0 sc1
    v_mfma_f32_16x16x32_bf16 v[148:151], a[20:23], a[84:87], v[148:151]
    ds_read_b64_tr_b16 a[10:11], v237 offset:6144
    v_mfma_f32_16x16x32_bf16 v[144:147], a[20:23], a[80:83], v[144:147]
    s_waitcnt lgkmcnt(6)
    v_mfma_f32_16x16x32_bf16 v[160:163], a[24:27], a[80:83], v[160:163]
    ds_read_b64_tr_b16 a[12:13], v238 offset:0
    v_mfma_f32_16x16x32_bf16 v[164:167], a[24:27], a[84:87], v[164:167]
    buffer_load_dwordx4 v227, s[32:35], s69 offen offset:1024 lds
    s_add_u32 s69, s69, s59
    v_mfma_f32_16x16x32_bf16 v[168:171], a[24:27], a[88:91], v[168:171]
    ds_read_b64_tr_b16 a[14:15], v238 offset:6144
    v_mfma_f32_16x16x32_bf16 v[172:175], a[24:27], a[92:95], v[172:175]
    v_mfma_f32_16x16x32_bf16 v[188:191], a[28:31], a[92:95], v[188:191]
    ds_read_b64_tr_b16 a[16:17], v235 offset:2048
    v_mfma_f32_16x16x32_bf16 v[184:187], a[28:31], a[88:91], v[184:187]
    buffer_load_dwordx4 a[180:183], v250, s[28:31], s53 offen offset:1024 sc1
    v_mfma_f32_16x16x32_bf16 v[180:183], a[28:31], a[84:87], v[180:183]
    ds_read_b64_tr_b16 a[18:19], v235 offset:8192
    v_mfma_f32_16x16x32_bf16 v[176:179], a[28:31], a[80:83], v[176:179]
    s_waitcnt lgkmcnt(6)
    v_mfma_f32_16x16x32_bf16 v[0:3], a[0:3], a[96:99], v[0:3]
    ds_read_b64_tr_b16 a[20:21], v236 offset:2048
    v_mfma_f32_16x16x32_bf16 v[4:7], a[0:3], a[100:103], v[4:7]
    buffer_load_dwordx4 a[184:187], v251, s[28:31], s53 offen offset:2048 sc1
    v_mfma_f32_16x16x32_bf16 v[8:11], a[0:3], a[104:107], v[8:11]
    ds_read_b64_tr_b16 a[22:23], v236 offset:8192
    v_mfma_f32_16x16x32_bf16 v[12:15], a[0:3], a[108:111], v[12:15]
    v_mfma_f32_16x16x32_bf16 v[28:31], a[4:7], a[108:111], v[28:31]
    ds_read_b64_tr_b16 a[24:25], v237 offset:2048
    v_mfma_f32_16x16x32_bf16 v[24:27], a[4:7], a[104:107], v[24:27]
    buffer_load_dwordx4 a[188:191], v252, s[28:31], s53 offen offset:3072 sc1
    v_mfma_f32_16x16x32_bf16 v[20:23], a[4:7], a[100:103], v[20:23]
    ds_read_b64_tr_b16 a[26:27], v237 offset:8192
    v_mfma_f32_16x16x32_bf16 v[16:19], a[4:7], a[96:99], v[16:19]
    s_waitcnt lgkmcnt(6)
    v_mfma_f32_16x16x32_bf16 v[32:35], a[8:11], a[96:99], v[32:35]
    ds_read_b64_tr_b16 a[28:29], v238 offset:2048
    v_mfma_f32_16x16x32_bf16 v[36:39], a[8:11], a[100:103], v[36:39]
    ds_read_b64_tr_b16 a[30:31], v238 offset:8192
    v_mfma_f32_16x16x32_bf16 v[40:43], a[8:11], a[104:107], v[40:43]
    v_mfma_f32_16x16x32_bf16 v[44:47], a[8:11], a[108:111], v[44:47]
    v_mfma_f32_16x16x32_bf16 v[60:63], a[12:15], a[108:111], v[60:63]
    ds_read_b64_tr_b16 a[0:1], v235 offset:4096
    s_add_u32 s52, s52, s58
    s_add_u32 s53, s53, s58
    v_mfma_f32_16x16x32_bf16 v[56:59], a[12:15], a[104:107], v[56:59]
    s_add_u32 s56, s56, 1
    s_add_u32 m0, s55, 0
    s_nop 0
    buffer_load_dwordx4 v227, s[32:35], s64 offen offset:0 lds
    v_mfma_f32_16x16x32_bf16 v[52:55], a[12:15], a[100:103], v[52:55]
    ds_read_b64_tr_b16 a[2:3], v235 offset:10240
    s_add_u32 s64, s64, s59
    v_mfma_f32_16x16x32_bf16 v[48:51], a[12:15], a[96:99], v[48:51]
    s_waitcnt lgkmcnt(6)
    v_mfma_f32_16x16x32_bf16 v[64:67], a[16:19], a[96:99], v[64:67]
    ds_read_b64_tr_b16 a[4:5], v236 offset:4096
    v_mfma_f32_16x16x32_bf16 v[68:71], a[16:19], a[100:103], v[68:71]
    buffer_load_dwordx4 a[32:35], v224, s[28:31], s52 offen offset:0 sc1
    v_mfma_f32_16x16x32_bf16 v[72:75], a[16:19], a[104:107], v[72:75]
    ds_read_b64_tr_b16 a[6:7], v236 offset:10240
    v_mfma_f32_16x16x32_bf16 v[76:79], a[16:19], a[108:111], v[76:79]
    v_mfma_f32_16x16x32_bf16 v[92:95], a[20:23], a[108:111], v[92:95]
    ds_read_b64_tr_b16 a[8:9], v237 offset:4096
    v_mfma_f32_16x16x32_bf16 v[88:91], a[20:23], a[104:107], v[88:91]
    buffer_load_dwordx4 v227, s[32:35], s65 offen offset:1024 lds
    s_add_u32 s65, s65, s59
    v_mfma_f32_16x16x32_bf16 v[84:87], a[20:23], a[100:103], v[84:87]
    ds_read_b64_tr_b16 a[10:11], v237 offset:10240
    v_mfma_f32_16x16x32_bf16 v[80:83], a[20:23], a[96:99], v[80:83]
    s_waitcnt lgkmcnt(6)
    v_mfma_f32_16x16x32_bf16 v[96:99], a[24:27], a[96:99], v[96:99]
    ds_read_b64_tr_b16 a[12:13], v238 offset:4096
    v_mfma_f32_16x16x32_bf16 v[100:103], a[24:27], a[100:103], v[100:103]
    buffer_load_dwordx4 a[36:39], v250, s[28:31], s52 offen offset:1024 sc1
    v_mfma_f32_16x16x32_bf16 v[104:107], a[24:27], a[104:107], v[104:107]
    ds_read_b64_tr_b16 a[14:15], v238 offset:10240
    v_mfma_f32_16x16x32_bf16 v[108:111], a[24:27], a[108:111], v[108:111]
    v_mfma_f32_16x16x32_bf16 v[124:127], a[28:31], a[108:111], v[124:127]
    ds_read_b64_tr_b16 a[16:17], v235 offset:12288
    v_mfma_f32_16x16x32_bf16 v[120:123], a[28:31], a[104:107], v[120:123]
    buffer_load_dwordx4 v227, s[32:35], s66 offen offset:2048 lds
    s_add_u32 s66, s66, s59
    v_mfma_f32_16x16x32_bf16 v[116:119], a[28:31], a[100:103], v[116:119]
    ds_read_b64_tr_b16 a[18:19], v235 offset:18432
    v_mfma_f32_16x16x32_bf16 v[112:115], a[28:31], a[96:99], v[112:115]
    s_waitcnt lgkmcnt(6)
    v_mfma_f32_16x16x32_bf16 v[128:131], a[0:3], a[96:99], v[128:131]
    ds_read_b64_tr_b16 a[20:21], v236 offset:12288
    v_mfma_f32_16x16x32_bf16 v[132:135], a[0:3], a[100:103], v[132:135]
    buffer_load_dwordx4 a[40:43], v251, s[28:31], s52 offen offset:2048 sc1
    v_mfma_f32_16x16x32_bf16 v[136:139], a[0:3], a[104:107], v[136:139]
    ds_read_b64_tr_b16 a[22:23], v236 offset:18432
    v_mfma_f32_16x16x32_bf16 v[140:143], a[0:3], a[108:111], v[140:143]
    v_mfma_f32_16x16x32_bf16 v[156:159], a[4:7], a[108:111], v[156:159]
    ds_read_b64_tr_b16 a[24:25], v237 offset:12288
    v_mfma_f32_16x16x32_bf16 v[152:155], a[4:7], a[104:107], v[152:155]
    buffer_load_dwordx4 v227, s[32:35], s67 offen offset:3072 lds
    s_add_u32 s67, s67, s59
    v_mfma_f32_16x16x32_bf16 v[148:151], a[4:7], a[100:103], v[148:151]
    ds_read_b64_tr_b16 a[26:27], v237 offset:18432
    v_mfma_f32_16x16x32_bf16 v[144:147], a[4:7], a[96:99], v[144:147]
    s_waitcnt lgkmcnt(6)
    v_mfma_f32_16x16x32_bf16 v[160:163], a[8:11], a[96:99], v[160:163]
    ds_read_b64_tr_b16 a[28:29], v238 offset:12288
    v_mfma_f32_16x16x32_bf16 v[164:167], a[8:11], a[100:103], v[164:167]
    ds_read_b64_tr_b16 a[30:31], v238 offset:18432
    v_mfma_f32_16x16x32_bf16 v[168:171], a[8:11], a[104:107], v[168:171]
    v_mfma_f32_16x16x32_bf16 v[172:175], a[8:11], a[108:111], v[172:175]
    v_mfma_f32_16x16x32_bf16 v[188:191], a[12:15], a[108:111], v[188:191]
    ds_read_b64_tr_b16 a[0:1], v235 offset:14336
    v_mfma_f32_16x16x32_bf16 v[184:187], a[12:15], a[104:107], v[184:187]
    buffer_load_dwordx4 a[44:47], v252, s[28:31], s52 offen offset:3072 sc1
    v_mfma_f32_16x16x32_bf16 v[180:183], a[12:15], a[100:103], v[180:183]
    ds_read_b64_tr_b16 a[2:3], v235 offset:20480
    v_mfma_f32_16x16x32_bf16 v[176:179], a[12:15], a[96:99], v[176:179]
    s_waitcnt lgkmcnt(6)
    v_mfma_f32_16x16x32_bf16 v[0:3], a[16:19], a[112:115], v[0:3]
    ds_read_b64_tr_b16 a[4:5], v236 offset:14336
    s_add_u32 m0, s55, 4096
    v_mfma_f32_16x16x32_bf16 v[4:7], a[16:19], a[116:119], v[4:7]
    buffer_load_dwordx4 v227, s[32:35], s68 offen offset:0 lds
    s_add_u32 s68, s68, s59
    v_mfma_f32_16x16x32_bf16 v[8:11], a[16:19], a[120:123], v[8:11]
    ds_read_b64_tr_b16 a[6:7], v236 offset:20480
    v_mfma_f32_16x16x32_bf16 v[12:15], a[16:19], a[124:127], v[12:15]
    v_mfma_f32_16x16x32_bf16 v[28:31], a[20:23], a[124:127], v[28:31]
    ds_read_b64_tr_b16 a[8:9], v237 offset:14336
    v_mfma_f32_16x16x32_bf16 v[24:27], a[20:23], a[120:123], v[24:27]
    buffer_load_dwordx4 a[48:51], v224, s[28:31], s53 offen offset:0 sc1
    v_mfma_f32_16x16x32_bf16 v[20:23], a[20:23], a[116:119], v[20:23]
    ds_read_b64_tr_b16 a[10:11], v237 offset:20480
    v_mfma_f32_16x16x32_bf16 v[16:19], a[20:23], a[112:115], v[16:19]
    s_waitcnt lgkmcnt(6)
    v_mfma_f32_16x16x32_bf16 v[32:35], a[24:27], a[112:115], v[32:35]
    ds_read_b64_tr_b16 a[12:13], v238 offset:14336
    v_mfma_f32_16x16x32_bf16 v[36:39], a[24:27], a[116:119], v[36:39]
    buffer_load_dwordx4 v227, s[32:35], s69 offen offset:1024 lds
    s_add_u32 s69, s69, s59
    v_mfma_f32_16x16x32_bf16 v[40:43], a[24:27], a[120:123], v[40:43]
    ds_read_b64_tr_b16 a[14:15], v238 offset:20480
    v_mfma_f32_16x16x32_bf16 v[44:47], a[24:27], a[124:127], v[44:47]
    v_mfma_f32_16x16x32_bf16 v[60:63], a[28:31], a[124:127], v[60:63]
    ds_read_b64_tr_b16 a[16:17], v235 offset:16384
    v_mfma_f32_16x16x32_bf16 v[56:59], a[28:31], a[120:123], v[56:59]
    buffer_load_dwordx4 a[52:55], v250, s[28:31], s53 offen offset:1024 sc1
    v_mfma_f32_16x16x32_bf16 v[52:55], a[28:31], a[116:119], v[52:55]
    ds_read_b64_tr_b16 a[18:19], v235 offset:22528
    v_mfma_f32_16x16x32_bf16 v[48:51], a[28:31], a[112:115], v[48:51]
    s_waitcnt lgkmcnt(6)
    v_mfma_f32_16x16x32_bf16 v[64:67], a[0:3], a[112:115], v[64:67]
    ds_read_b64_tr_b16 a[20:21], v236 offset:16384
    v_mfma_f32_16x16x32_bf16 v[68:71], a[0:3], a[116:119], v[68:71]
    buffer_load_dwordx4 a[56:59], v251, s[28:31], s53 offen offset:2048 sc1
    v_mfma_f32_16x16x32_bf16 v[72:75], a[0:3], a[120:123], v[72:75]
    ds_read_b64_tr_b16 a[22:23], v236 offset:22528
    v_mfma_f32_16x16x32_bf16 v[76:79], a[0:3], a[124:127], v[76:79]
    v_mfma_f32_16x16x32_bf16 v[92:95], a[4:7], a[124:127], v[92:95]
    ds_read_b64_tr_b16 a[24:25], v237 offset:16384
    v_mfma_f32_16x16x32_bf16 v[88:91], a[4:7], a[120:123], v[88:91]
    buffer_load_dwordx4 a[60:63], v252, s[28:31], s53 offen offset:3072 sc1
    v_mfma_f32_16x16x32_bf16 v[84:87], a[4:7], a[116:119], v[84:87]
    ds_read_b64_tr_b16 a[26:27], v237 offset:22528
    v_mfma_f32_16x16x32_bf16 v[80:83], a[4:7], a[112:115], v[80:83]
    s_waitcnt lgkmcnt(6)
    v_mfma_f32_16x16x32_bf16 v[96:99], a[8:11], a[112:115], v[96:99]
    ds_read_b64_tr_b16 a[28:29], v238 offset:16384
    v_mfma_f32_16x16x32_bf16 v[100:103], a[8:11], a[116:119], v[100:103]
    ds_read_b64_tr_b16 a[30:31], v238 offset:22528
    v_mfma_f32_16x16x32_bf16 v[104:107], a[8:11], a[120:123], v[104:107]
    v_mfma_f32_16x16x32_bf16 v[108:111], a[8:11], a[124:127], v[108:111]
    s_waitcnt vmcnt(28)
    s_barrier
    v_mfma_f32_16x16x32_bf16 v[124:127], a[12:15], a[124:127], v[124:127]
    ds_read_b64_tr_b16 a[0:1], v235 offset:24576
    s_add_u32 s52, s52, s58
    s_add_u32 s53, s53, s58
    v_mfma_f32_16x16x32_bf16 v[120:123], a[12:15], a[120:123], v[120:123]
    s_add_u32 s56, s56, 1
    s_add_u32 m0, s55, 24576
    s_nop 0
    buffer_load_dwordx4 v227, s[32:35], s64 offen offset:0 lds
    v_mfma_f32_16x16x32_bf16 v[116:119], a[12:15], a[116:119], v[116:119]
    ds_read_b64_tr_b16 a[2:3], v235 offset:30720
    s_add_u32 s64, s64, s59
    v_mfma_f32_16x16x32_bf16 v[112:115], a[12:15], a[112:115], v[112:115]
    s_waitcnt lgkmcnt(6)
    v_mfma_f32_16x16x32_bf16 v[128:131], a[16:19], a[112:115], v[128:131]
    ds_read_b64_tr_b16 a[4:5], v236 offset:24576
    v_mfma_f32_16x16x32_bf16 v[132:135], a[16:19], a[116:119], v[132:135]
    buffer_load_dwordx4 a[64:67], v224, s[28:31], s52 offen offset:0 sc1
    v_mfma_f32_16x16x32_bf16 v[136:139], a[16:19], a[120:123], v[136:139]
    ds_read_b64_tr_b16 a[6:7], v236 offset:30720
    v_mfma_f32_16x16x32_bf16 v[140:143], a[16:19], a[124:127], v[140:143]
    v_mfma_f32_16x16x32_bf16 v[156:159], a[20:23], a[124:127], v[156:159]
    ds_read_b64_tr_b16 a[8:9], v237 offset:24576
    v_mfma_f32_16x16x32_bf16 v[152:155], a[20:23], a[120:123], v[152:155]
    ds_read_b64_tr_b16 a[10:11], v237 offset:30720
    v_mfma_f32_16x16x32_bf16 v[148:151], a[20:23], a[116:119], v[148:151]
    v_mfma_f32_16x16x32_bf16 v[144:147], a[20:23], a[112:115], v[144:147]
    s_waitcnt lgkmcnt(6)
    v_mfma_f32_16x16x32_bf16 v[160:163], a[24:27], a[112:115], v[160:163]
    ds_read_b64_tr_b16 a[12:13], v238 offset:24576
    v_mfma_f32_16x16x32_bf16 v[164:167], a[24:27], a[116:119], v[164:167]
    buffer_load_dwordx4 v227, s[32:35], s65 offen offset:1024 lds
    s_add_u32 s65, s65, s59
    v_mfma_f32_16x16x32_bf16 v[168:171], a[24:27], a[120:123], v[168:171]
    ds_read_b64_tr_b16 a[14:15], v238 offset:30720
    v_mfma_f32_16x16x32_bf16 v[172:175], a[24:27], a[124:127], v[172:175]
    v_mfma_f32_16x16x32_bf16 v[188:191], a[28:31], a[124:127], v[188:191]
    ds_read_b64_tr_b16 a[16:17], v235 offset:26624
    v_mfma_f32_16x16x32_bf16 v[184:187], a[28:31], a[120:123], v[184:187]
    ds_read_b64_tr_b16 a[18:19], v235 offset:32768
    v_mfma_f32_16x16x32_bf16 v[180:183], a[28:31], a[116:119], v[180:183]
    v_mfma_f32_16x16x32_bf16 v[176:179], a[28:31], a[112:115], v[176:179]
    s_waitcnt lgkmcnt(6)
    v_mfma_f32_16x16x32_bf16 v[0:3], a[0:3], a[128:131], v[0:3]
    ds_read_b64_tr_b16 a[20:21], v236 offset:26624
    v_mfma_f32_16x16x32_bf16 v[4:7], a[0:3], a[132:135], v[4:7]
    buffer_load_dwordx4 a[68:71], v250, s[28:31], s52 offen offset:1024 sc1
    v_mfma_f32_16x16x32_bf16 v[8:11], a[0:3], a[136:139], v[8:11]
    ds_read_b64_tr_b16 a[22:23], v236 offset:32768
    v_mfma_f32_16x16x32_bf16 v[12:15], a[0:3], a[140:143], v[12:15]
    v_mfma_f32_16x16x32_bf16 v[28:31], a[4:7], a[140:143], v[28:31]
    ds_read_b64_tr_b16 a[24:25], v237 offset:26624
    v_mfma_f32_16x16x32_bf16 v[24:27], a[4:7], a[136:139], v[24:27]
    buffer_load_dwordx4 v227, s[32:35], s66 offen offset:2048 lds
    s_add_u32 s66, s66, s59
    v_mfma_f32_16x16x32_bf16 v[20:23], a[4:7], a[132:135], v[20:23]
    ds_read_b64_tr_b16 a[26:27], v237 offset:32768
    v_mfma_f32_16x16x32_bf16 v[16:19], a[4:7], a[128:131], v[16:19]
    s_waitcnt lgkmcnt(6)
    v_mfma_f32_16x16x32_bf16 v[32:35], a[8:11], a[128:131], v[32:35]
    ds_read_b64_tr_b16 a[28:29], v238 offset:26624
    v_mfma_f32_16x16x32_bf16 v[36:39], a[8:11], a[132:135], v[36:39]
    ds_read_b64_tr_b16 a[30:31], v238 offset:32768
    v_mfma_f32_16x16x32_bf16 v[40:43], a[8:11], a[136:139], v[40:43]
    v_mfma_f32_16x16x32_bf16 v[44:47], a[8:11], a[140:143], v[44:47]
    v_mfma_f32_16x16x32_bf16 v[60:63], a[12:15], a[140:143], v[60:63]
    ds_read_b64_tr_b16 a[0:1], v235 offset:28672
    v_mfma_f32_16x16x32_bf16 v[56:59], a[12:15], a[136:139], v[56:59]
    buffer_load_dwordx4 a[72:75], v251, s[28:31], s52 offen offset:2048 sc1
    v_mfma_f32_16x16x32_bf16 v[52:55], a[12:15], a[132:135], v[52:55]
    ds_read_b64_tr_b16 a[2:3], v235 offset:34816
    v_mfma_f32_16x16x32_bf16 v[48:51], a[12:15], a[128:131], v[48:51]
    s_waitcnt lgkmcnt(6)
    v_mfma_f32_16x16x32_bf16 v[64:67], a[16:19], a[128:131], v[64:67]
    ds_read_b64_tr_b16 a[4:5], v236 offset:28672
    v_mfma_f32_16x16x32_bf16 v[68:71], a[16:19], a[132:135], v[68:71]
    ds_read_b64_tr_b16 a[6:7], v236 offset:34816
    v_mfma_f32_16x16x32_bf16 v[72:75], a[16:19], a[136:139], v[72:75]
    v_mfma_f32_16x16x32_bf16 v[76:79], a[16:19], a[140:143], v[76:79]
    v_mfma_f32_16x16x32_bf16 v[92:95], a[20:23], a[140:143], v[92:95]
    ds_read_b64_tr_b16 a[8:9], v237 offset:28672
    v_mfma_f32_16x16x32_bf16 v[88:91], a[20:23], a[136:139], v[88:91]
    buffer_load_dwordx4 v227, s[32:35], s67 offen offset:3072 lds
    s_add_u32 s67, s67, s59
    v_mfma_f32_16x16x32_bf16 v[84:87], a[20:23], a[132:135], v[84:87]
    ds_read_b64_tr_b16 a[10:11], v237 offset:34816
    v_mfma_f32_16x16x32_bf16 v[80:83], a[20:23], a[128:131], v[80:83]
    s_waitcnt lgkmcnt(6)
    v_mfma_f32_16x16x32_bf16 v[96:99], a[24:27], a[128:131], v[96:99]
    ds_read_b64_tr_b16 a[12:13], v238 offset:28672
    v_mfma_f32_16x16x32_bf16 v[100:103], a[24:27], a[132:135], v[100:103]
    ds_read_b64_tr_b16 a[14:15], v238 offset:34816
    v_mfma_f32_16x16x32_bf16 v[104:107], a[24:27], a[136:139], v[104:107]
    v_mfma_f32_16x16x32_bf16 v[108:111], a[24:27], a[140:143], v[108:111]
    v_mfma_f32_16x16x32_bf16 v[124:127], a[28:31], a[140:143], v[124:127]
    ds_read_b64_tr_b16 a[16:17], v235 offset:36864
    v_mfma_f32_16x16x32_bf16 v[120:123], a[28:31], a[136:139], v[120:123]
    buffer_load_dwordx4 a[76:79], v252, s[28:31], s52 offen offset:3072 sc1
    v_mfma_f32_16x16x32_bf16 v[116:119], a[28:31], a[132:135], v[116:119]
    ds_read_b64_tr_b16 a[18:19], v235 offset:43008
    v_mfma_f32_16x16x32_bf16 v[112:115], a[28:31], a[128:131], v[112:115]
    s_waitcnt lgkmcnt(6)
    v_mfma_f32_16x16x32_bf16 v[128:131], a[0:3], a[128:131], v[128:131]
    ds_read_b64_tr_b16 a[20:21], v236 offset:36864
    s_add_u32 m0, s55, 28672
    v_mfma_f32_16x16x32_bf16 v[132:135], a[0:3], a[132:135], v[132:135]
    buffer_load_dwordx4 v227, s[32:35], s68 offen offset:0 lds
    s_add_u32 s68, s68, s59
    v_mfma_f32_16x16x32_bf16 v[136:139], a[0:3], a[136:139], v[136:139]
    ds_read_b64_tr_b16 a[22:23], v236 offset:43008
    v_mfma_f32_16x16x32_bf16 v[140:143], a[0:3], a[140:143], v[140:143]
    v_mfma_f32_16x16x32_bf16 v[156:159], a[4:7], a[140:143], v[156:159]
    ds_read_b64_tr_b16 a[24:25], v237 offset:36864
    v_mfma_f32_16x16x32_bf16 v[152:155], a[4:7], a[136:139], v[152:155]
    ds_read_b64_tr_b16 a[26:27], v237 offset:43008
    v_mfma_f32_16x16x32_bf16 v[148:151], a[4:7], a[132:135], v[148:151]
    v_mfma_f32_16x16x32_bf16 v[144:147], a[4:7], a[128:131], v[144:147]
    s_waitcnt lgkmcnt(6)
    v_mfma_f32_16x16x32_bf16 v[160:163], a[8:11], a[128:131], v[160:163]
    ds_read_b64_tr_b16 a[28:29], v238 offset:36864
    v_mfma_f32_16x16x32_bf16 v[164:167], a[8:11], a[132:135], v[164:167]
    buffer_load_dwordx4 a[80:83], v224, s[28:31], s53 offen offset:0 sc1
    v_mfma_f32_16x16x32_bf16 v[168:171], a[8:11], a[136:139], v[168:171]
    ds_read_b64_tr_b16 a[30:31], v238 offset:43008
    v_mfma_f32_16x16x32_bf16 v[172:175], a[8:11], a[140:143], v[172:175]
    v_mfma_f32_16x16x32_bf16 v[188:191], a[12:15], a[140:143], v[188:191]
    ds_read_b64_tr_b16 a[0:1], v235 offset:38912
    v_mfma_f32_16x16x32_bf16 v[184:187], a[12:15], a[136:139], v[184:187]
    ds_read_b64_tr_b16 a[2:3], v235 offset:45056
    v_mfma_f32_16x16x32_bf16 v[180:183], a[12:15], a[132:135], v[180:183]
    v_mfma_f32_16x16x32_bf16 v[176:179], a[12:15], a[128:131], v[176:179]
    s_waitcnt lgkmcnt(6)
    v_mfma_f32_16x16x32_bf16 v[0:3], a[16:19], a[144:147], v[0:3]
    ds_read_b64_tr_b16 a[4:5], v236 offset:38912
    v_mfma_f32_16x16x32_bf16 v[4:7], a[16:19], a[148:151], v[4:7]
    buffer_load_dwordx4 v227, s[32:35], s69 offen offset:1024 lds
    s_add_u32 s69, s69, s59
    v_mfma_f32_16x16x32_bf16 v[8:11], a[16:19], a[152:155], v[8:11]
    ds_read_b64_tr_b16 a[6:7], v236 offset:45056
    v_mfma_f32_16x16x32_bf16 v[12:15], a[16:19], a[156:159], v[12:15]
    v_mfma_f32_16x16x32_bf16 v[28:31], a[20:23], a[156:159], v[28:31]
    ds_read_b64_tr_b16 a[8:9], v237 offset:38912
    v_mfma_f32_16x16x32_bf16 v[24:27], a[20:23], a[152:155], v[24:27]
    buffer_load_dwordx4 a[84:87], v250, s[28:31], s53 offen offset:1024 sc1
    v_mfma_f32_16x16x32_bf16 v[20:23], a[20:23], a[148:151], v[20:23]
    ds_read_b64_tr_b16 a[10:11], v237 offset:45056
    v_mfma_f32_16x16x32_bf16 v[16:19], a[20:23], a[144:147], v[16:19]
    s_waitcnt lgkmcnt(6)
    v_mfma_f32_16x16x32_bf16 v[32:35], a[24:27], a[144:147], v[32:35]
    ds_read_b64_tr_b16 a[12:13], v238 offset:38912
    v_mfma_f32_16x16x32_bf16 v[36:39], a[24:27], a[148:151], v[36:39]
    ds_read_b64_tr_b16 a[14:15], v238 offset:45056
    v_mfma_f32_16x16x32_bf16 v[40:43], a[24:27], a[152:155], v[40:43]
    v_mfma_f32_16x16x32_bf16 v[44:47], a[24:27], a[156:159], v[44:47]
    v_mfma_f32_16x16x32_bf16 v[60:63], a[28:31], a[156:159], v[60:63]
    ds_read_b64_tr_b16 a[16:17], v235 offset:40960
    v_mfma_f32_16x16x32_bf16 v[56:59], a[28:31], a[152:155], v[56:59]
    buffer_load_dwordx4 a[88:91], v251, s[28:31], s53 offen offset:2048 sc1
    v_mfma_f32_16x16x32_bf16 v[52:55], a[28:31], a[148:151], v[52:55]
    ds_read_b64_tr_b16 a[18:19], v235 offset:47104
    v_mfma_f32_16x16x32_bf16 v[48:51], a[28:31], a[144:147], v[48:51]
    s_waitcnt lgkmcnt(6)
    v_mfma_f32_16x16x32_bf16 v[64:67], a[0:3], a[144:147], v[64:67]
    ds_read_b64_tr_b16 a[20:21], v236 offset:40960
    v_mfma_f32_16x16x32_bf16 v[68:71], a[0:3], a[148:151], v[68:71]
    ds_read_b64_tr_b16 a[22:23], v236 offset:47104
    v_mfma_f32_16x16x32_bf16 v[72:75], a[0:3], a[152:155], v[72:75]
    v_mfma_f32_16x16x32_bf16 v[76:79], a[0:3], a[156:159], v[76:79]
    v_mfma_f32_16x16x32_bf16 v[92:95], a[4:7], a[156:159], v[92:95]
    ds_read_b64_tr_b16 a[24:25], v237 offset:40960
    v_mfma_f32_16x16x32_bf16 v[88:91], a[4:7], a[152:155], v[88:91]
    buffer_load_dwordx4 a[92:95], v252, s[28:31], s53 offen offset:3072 sc1
    v_mfma_f32_16x16x32_bf16 v[84:87], a[4:7], a[148:151], v[84:87]
    ds_read_b64_tr_b16 a[26:27], v237 offset:47104
    v_mfma_f32_16x16x32_bf16 v[80:83], a[4:7], a[144:147], v[80:83]
    s_waitcnt lgkmcnt(6)
    v_mfma_f32_16x16x32_bf16 v[96:99], a[8:11], a[144:147], v[96:99]
    ds_read_b64_tr_b16 a[28:29], v238 offset:40960
    v_mfma_f32_16x16x32_bf16 v[100:103], a[8:11], a[148:151], v[100:103]
    ds_read_b64_tr_b16 a[30:31], v238 offset:47104
    v_mfma_f32_16x16x32_bf16 v[104:107], a[8:11], a[152:155], v[104:107]
    v_mfma_f32_16x16x32_bf16 v[108:111], a[8:11], a[156:159], v[108:111]
    s_waitcnt vmcnt(28)
    s_barrier
    v_mfma_f32_16x16x32_bf16 v[124:127], a[12:15], a[156:159], v[124:127]
    ds_read_b64_tr_b16 a[0:1], v241 offset:0
    s_add_u32 s52, s52, s58
    s_add_u32 s53, s53, s58
    v_mfma_f32_16x16x32_bf16 v[120:123], a[12:15], a[152:155], v[120:123]
    s_add_u32 s56, s56, 1
    s_add_u32 m0, s55, 49152
    s_nop 0
    buffer_load_dwordx4 v227, s[32:35], s64 offen offset:0 lds
    v_mfma_f32_16x16x32_bf16 v[116:119], a[12:15], a[148:151], v[116:119]
    ds_read_b64_tr_b16 a[2:3], v241 offset:6144
    s_add_u32 s64, s64, s59
    v_mfma_f32_16x16x32_bf16 v[112:115], a[12:15], a[144:147], v[112:115]
    s_waitcnt lgkmcnt(6)
    v_mfma_f32_16x16x32_bf16 v[128:131], a[16:19], a[144:147], v[128:131]
    ds_read_b64_tr_b16 a[4:5], v242 offset:0
    v_mfma_f32_16x16x32_bf16 v[132:135], a[16:19], a[148:151], v[132:135]
    buffer_load_dwordx4 a[96:99], v224, s[28:31], s52 offen offset:0 sc1
    v_mfma_f32_16x16x32_bf16 v[136:139], a[16:19], a[152:155], v[136:139]
    ds_read_b64_tr_b16 a[6:7], v242 offset:6144
    v_mfma_f32_16x16x32_bf16 v[140:143], a[16:19], a[156:159], v[140:143]
    v_mfma_f32_16x16x32_bf16 v[156:159], a[20:23], a[156:159], v[156:159]
    ds_read_b64_tr_b16 a[8:9], v243 offset:0
    v_mfma_f32_16x16x32_bf16 v[152:155], a[20:23], a[152:155], v[152:155]
    ds_read_b64_tr_b16 a[10:11], v243 offset:6144
    v_mfma_f32_16x16x32_bf16 v[148:151], a[20:23], a[148:151], v[148:151]
    v_mfma_f32_16x16x32_bf16 v[144:147], a[20:23], a[144:147], v[144:147]
    s_waitcnt lgkmcnt(6)
    v_mfma_f32_16x16x32_bf16 v[160:163], a[24:27], a[144:147], v[160:163]
    ds_read_b64_tr_b16 a[12:13], v244 offset:0
    v_mfma_f32_16x16x32_bf16 v[164:167], a[24:27], a[148:151], v[164:167]
    buffer_load_dwordx4 v227, s[32:35], s65 offen offset:1024 lds
    s_add_u32 s65, s65, s59
    v_mfma_f32_16x16x32_bf16 v[168:171], a[24:27], a[152:155], v[168:171]
    ds_read_b64_tr_b16 a[14:15], v244 offset:6144
    v_mfma_f32_16x16x32_bf16 v[172:175], a[24:27], a[156:159], v[172:175]
    v_mfma_f32_16x16x32_bf16 v[188:191], a[28:31], a[156:159], v[188:191]
    ds_read_b64_tr_b16 a[16:17], v241 offset:2048
    v_mfma_f32_16x16x32_bf16 v[184:187], a[28:31], a[152:155], v[184:187]
    ds_read_b64_tr_b16 a[18:19], v241 offset:8192
    v_mfma_f32_16x16x32_bf16 v[180:183], a[28:31], a[148:151], v[180:183]
    v_mfma_f32_16x16x32_bf16 v[176:179], a[28:31], a[144:147], v[176:179]
    s_waitcnt lgkmcnt(6)
    v_mfma_f32_16x16x32_bf16 v[0:3], a[0:3], a[160:163], v[0:3]
    ds_read_b64_tr_b16 a[20:21], v242 offset:2048
    v_mfma_f32_16x16x32_bf16 v[4:7], a[0:3], a[164:167], v[4:7]
    buffer_load_dwordx4 a[100:103], v250, s[28:31], s52 offen offset:1024 sc1
    v_mfma_f32_16x16x32_bf16 v[8:11], a[0:3], a[168:171], v[8:11]
    ds_read_b64_tr_b16 a[22:23], v242 offset:8192
    v_mfma_f32_16x16x32_bf16 v[12:15], a[0:3], a[172:175], v[12:15]
    v_mfma_f32_16x16x32_bf16 v[28:31], a[4:7], a[172:175], v[28:31]
    ds_read_b64_tr_b16 a[24:25], v243 offset:2048
    v_mfma_f32_16x16x32_bf16 v[24:27], a[4:7], a[168:171], v[24:27]
    buffer_load_dwordx4 v227, s[32:35], s66 offen offset:2048 lds
    s_add_u32 s66, s66, s59
    v_mfma_f32_16x16x32_bf16 v[20:23], a[4:7], a[164:167], v[20:23]
    ds_read_b64_tr_b16 a[26:27], v243 offset:8192
    v_mfma_f32_16x16x32_bf16 v[16:19], a[4:7], a[160:163], v[16:19]
    s_waitcnt lgkmcnt(6)
    v_mfma_f32_16x16x32_bf16 v[32:35], a[8:11], a[160:163], v[32:35]
    ds_read_b64_tr_b16 a[28:29], v244 offset:2048
    v_mfma_f32_16x16x32_bf16 v[36:39], a[8:11], a[164:167], v[36:39]
    ds_read_b64_tr_b16 a[30:31], v244 offset:8192
    v_mfma_f32_16x16x32_bf16 v[40:43], a[8:11], a[168:171], v[40:43]
    v_mfma_f32_16x16x32_bf16 v[44:47], a[8:11], a[172:175], v[44:47]
    v_mfma_f32_16x16x32_bf16 v[60:63], a[12:15], a[172:175], v[60:63]
    ds_read_b64_tr_b16 a[0:1], v241 offset:4096
    v_mfma_f32_16x16x32_bf16 v[56:59], a[12:15], a[168:171], v[56:59]
    buffer_load_dwordx4 a[104:107], v251, s[28:31], s52 offen offset:2048 sc1
    v_mfma_f32_16x16x32_bf16 v[52:55], a[12:15], a[164:167], v[52:55]
    ds_read_b64_tr_b16 a[2:3], v241 offset:10240
    v_mfma_f32_16x16x32_bf16 v[48:51], a[12:15], a[160:163], v[48:51]
    s_waitcnt lgkmcnt(6)
    v_mfma_f32_16x16x32_bf16 v[64:67], a[16:19], a[160:163], v[64:67]
    ds_read_b64_tr_b16 a[4:5], v242 offset:4096
    v_mfma_f32_16x16x32_bf16 v[68:71], a[16:19], a[164:167], v[68:71]
    ds_read_b64_tr_b16 a[6:7], v242 offset:10240
    v_mfma_f32_16x16x32_bf16 v[72:75], a[16:19], a[168:171], v[72:75]
    v_mfma_f32_16x16x32_bf16 v[76:79], a[16:19], a[172:175], v[76:79]
    v_mfma_f32_16x16x32_bf16 v[92:95], a[20:23], a[172:175], v[92:95]
    ds_read_b64_tr_b16 a[8:9], v243 offset:4096
    v_mfma_f32_16x16x32_bf16 v[88:91], a[20:23], a[168:171], v[88:91]
    buffer_load_dwordx4 v227, s[32:35], s67 offen offset:3072 lds
    s_add_u32 s67, s67, s59
    v_mfma_f32_16x16x32_bf16 v[84:87], a[20:23], a[164:167], v[84:87]
    ds_read_b64_tr_b16 a[10:11], v243 offset:10240
    v_mfma_f32_16x16x32_bf16 v[80:83], a[20:23], a[160:163], v[80:83]
    s_waitcnt lgkmcnt(6)
    v_mfma_f32_16x16x32_bf16 v[96:99], a[24:27], a[160:163], v[96:99]
    ds_read_b64_tr_b16 a[12:13], v244 offset:4096
    v_mfma_f32_16x16x32_bf16 v[100:103], a[24:27], a[164:167], v[100:103]
    ds_read_b64_tr_b16 a[14:15], v244 offset:10240
    v_mfma_f32_16x16x32_bf16 v[104:107], a[24:27], a[168:171], v[104:107]
    v_mfma_f32_16x16x32_bf16 v[108:111], a[24:27], a[172:175], v[108:111]
    v_mfma_f32_16x16x32_bf16 v[124:127], a[28:31], a[172:175], v[124:127]
    ds_read_b64_tr_b16 a[16:17], v241 offset:12288
    v_mfma_f32_16x16x32_bf16 v[120:123], a[28:31], a[168:171], v[120:123]
    buffer_load_dwordx4 a[108:111], v252, s[28:31], s52 offen offset:3072 sc1
    v_mfma_f32_16x16x32_bf16 v[116:119], a[28:31], a[164:167], v[116:119]
    ds_read_b64_tr_b16 a[18:19], v241 offset:18432
    v_mfma_f32_16x16x32_bf16 v[112:115], a[28:31], a[160:163], v[112:115]
    s_waitcnt lgkmcnt(6)
    v_mfma_f32_16x16x32_bf16 v[128:131], a[0:3], a[160:163], v[128:131]
    ds_read_b64_tr_b16 a[20:21], v242 offset:12288
    s_add_u32 m0, s55, 53248
    v_mfma_f32_16x16x32_bf16 v[132:135], a[0:3], a[164:167], v[132:135]
    buffer_load_dwordx4 v227, s[32:35], s68 offen offset:0 lds
    s_add_u32 s68, s68, s59
    v_mfma_f32_16x16x32_bf16 v[136:139], a[0:3], a[168:171], v[136:139]
    ds_read_b64_tr_b16 a[22:23], v242 offset:18432
    v_mfma_f32_16x16x32_bf16 v[140:143], a[0:3], a[172:175], v[140:143]
    v_mfma_f32_16x16x32_bf16 v[156:159], a[4:7], a[172:175], v[156:159]
    ds_read_b64_tr_b16 a[24:25], v243 offset:12288
    v_mfma_f32_16x16x32_bf16 v[152:155], a[4:7], a[168:171], v[152:155]
    ds_read_b64_tr_b16 a[26:27], v243 offset:18432
    v_mfma_f32_16x16x32_bf16 v[148:151], a[4:7], a[164:167], v[148:151]
    v_mfma_f32_16x16x32_bf16 v[144:147], a[4:7], a[160:163], v[144:147]
    s_waitcnt lgkmcnt(6)
    v_mfma_f32_16x16x32_bf16 v[160:163], a[8:11], a[160:163], v[160:163]
    ds_read_b64_tr_b16 a[28:29], v244 offset:12288
    v_mfma_f32_16x16x32_bf16 v[164:167], a[8:11], a[164:167], v[164:167]
    buffer_load_dwordx4 a[112:115], v224, s[28:31], s53 offen offset:0 sc1
    v_mfma_f32_16x16x32_bf16 v[168:171], a[8:11], a[168:171], v[168:171]
    ds_read_b64_tr_b16 a[30:31], v244 offset:18432
    v_mfma_f32_16x16x32_bf16 v[172:175], a[8:11], a[172:175], v[172:175]
    v_mfma_f32_16x16x32_bf16 v[188:191], a[12:15], a[172:175], v[188:191]
    ds_read_b64_tr_b16 a[0:1], v241 offset:14336
    v_mfma_f32_16x16x32_bf16 v[184:187], a[12:15], a[168:171], v[184:187]
    ds_read_b64_tr_b16 a[2:3], v241 offset:20480
    v_mfma_f32_16x16x32_bf16 v[180:183], a[12:15], a[164:167], v[180:183]
    v_mfma_f32_16x16x32_bf16 v[176:179], a[12:15], a[160:163], v[176:179]
    s_waitcnt lgkmcnt(6)
    v_mfma_f32_16x16x32_bf16 v[0:3], a[16:19], a[176:179], v[0:3]
    ds_read_b64_tr_b16 a[4:5], v242 offset:14336
    v_mfma_f32_16x16x32_bf16 v[4:7], a[16:19], a[180:183], v[4:7]
    buffer_load_dwordx4 v227, s[32:35], s69 offen offset:1024 lds
    s_add_u32 s69, s69, s59
    v_mfma_f32_16x16x32_bf16 v[8:11], a[16:19], a[184:187], v[8:11]
    ds_read_b64_tr_b16 a[6:7], v242 offset:20480
    v_mfma_f32_16x16x32_bf16 v[12:15], a[16:19], a[188:191], v[12:15]
    v_mfma_f32_16x16x32_bf16 v[28:31], a[20:23], a[188:191], v[28:31]
    ds_read_b64_tr_b16 a[8:9], v243 offset:14336
    v_mfma_f32_16x16x32_bf16 v[24:27], a[20:23], a[184:187], v[24:27]
    buffer_load_dwordx4 a[116:119], v250, s[28:31], s53 offen offset:1024 sc1
    v_mfma_f32_16x16x32_bf16 v[20:23], a[20:23], a[180:183], v[20:23]
    ds_read_b64_tr_b16 a[10:11], v243 offset:20480
    v_mfma_f32_16x16x32_bf16 v[16:19], a[20:23], a[176:179], v[16:19]
    s_branch L_po_C_2
.p2align 12
L_pg_C_2:
    s_branch L_pg_C_5
L_po_C_2:
    s_waitcnt lgkmcnt(6)
    v_mfma_f32_16x16x32_bf16 v[32:35], a[24:27], a[176:179], v[32:35]
    ds_read_b64_tr_b16 a[12:13], v244 offset:14336
    v_mfma_f32_16x16x32_bf16 v[36:39], a[24:27], a[180:183], v[36:39]
    ds_read_b64_tr_b16 a[14:15], v244 offset:20480
    v_mfma_f32_16x16x32_bf16 v[40:43], a[24:27], a[184:187], v[40:43]
    v_mfma_f32_16x16x32_bf16 v[44:47], a[24:27], a[188:191], v[44:47]
    v_mfma_f32_16x16x32_bf16 v[60:63], a[28:31], a[188:191], v[60:63]
    ds_read_b64_tr_b16 a[16:17], v241 offset:16384
    v_mfma_f32_16x16x32_bf16 v[56:59], a[28:31], a[184:187], v[56:59]
    buffer_load_dwordx4 a[120:123], v251, s[28:31], s53 offen offset:2048 sc1
    v_mfma_f32_16x16x32_bf16 v[52:55], a[28:31], a[180:183], v[52:55]
    ds_read_b64_tr_b16 a[18:19], v241 offset:22528
    v_mfma_f32_16x16x32_bf16 v[48:51], a[28:31], a[176:179], v[48:51]
    s_waitcnt lgkmcnt(6)
    v_mfma_f32_16x16x32_bf16 v[64:67], a[0:3], a[176:179], v[64:67]
    ds_read_b64_tr_b16 a[20:21], v242 offset:16384
    v_mfma_f32_16x16x32_bf16 v[68:71], a[0:3], a[180:183], v[68:71]
    ds_read_b64_tr_b16 a[22:23], v242 offset:22528
    v_mfma_f32_16x16x32_bf16 v[72:75], a[0:3], a[184:187], v[72:75]
    v_mfma_f32_16x16x32_bf16 v[76:79], a[0:3], a[188:191], v[76:79]
    v_mfma_f32_16x16x32_bf16 v[92:95], a[4:7], a[188:191], v[92:95]
    ds_read_b64_tr_b16 a[24:25], v243 offset:16384
    v_mfma_f32_16x16x32_bf16 v[88:91], a[4:7], a[184:187], v[88:91]
    buffer_load_dwordx4 a[124:127], v252, s[28:31], s53 offen offset:3072 sc1
    v_mfma_f32_16x16x32_bf16 v[84:87], a[4:7], a[180:183], v[84:87]
    ds_read_b64_tr_b16 a[26:27], v243 offset:22528
    v_mfma_f32_16x16x32_bf16 v[80:83], a[4:7], a[176:179], v[80:83]
    s_waitcnt lgkmcnt(6)
    v_mfma_f32_16x16x32_bf16 v[96:99], a[8:11], a[176:179], v[96:99]
    ds_read_b64_tr_b16 a[28:29], v244 offset:16384
    v_mfma_f32_16x16x32_bf16 v[100:103], a[8:11], a[180:183], v[100:103]
    ds_read_b64_tr_b16 a[30:31], v244 offset:22528
    v_mfma_f32_16x16x32_bf16 v[104:107], a[8:11], a[184:187], v[104:107]
    v_mfma_f32_16x16x32_bf16 v[108:111], a[8:11], a[188:191], v[108:111]
    s_waitcnt vmcnt(28)
    s_barrier
    v_mfma_f32_16x16x32_bf16 v[124:127], a[12:15], a[188:191], v[124:127]
    ds_read_b64_tr_b16 a[0:1], v229 offset:0
    s_add_u32 s52, s52, s58
    s_add_u32 s53, s53, s58
    v_mfma_f32_16x16x32_bf16 v[120:123], a[12:15], a[184:187], v[120:123]
    s_add_u32 s56, s56, 1
    s_add_u32 m0, s55, 73728
    s_nop 0
    buffer_load_dwordx4 v227, s[32:35], s64 offen offset:0 lds
    v_mfma_f32_16x16x32_bf16 v[116:119], a[12:15], a[180:183], v[116:119]
    ds_read_b64_tr_b16 a[2:3], v229 offset:6144
    s_add_u32 s64, s64, s59
    v_mfma_f32_16x16x32_bf16 v[112:115], a[12:15], a[176:179], v[112:115]
    s_waitcnt lgkmcnt(6)
    v_mfma_f32_16x16x32_bf16 v[128:131], a[16:19], a[176:179], v[128:131]
    ds_read_b64_tr_b16 a[4:5], v230 offset:0
    v_mfma_f32_16x16x32_bf16 v[132:135], a[16:19], a[180:183], v[132:135]
    buffer_load_dwordx4 a[128:131], v224, s[28:31], s52 offen offset:0 sc1
    v_mfma_f32_16x16x32_bf16 v[136:139], a[16:19], a[184:187], v[136:139]
    ds_read_b64_tr_b16 a[6:7], v230 offset:6144
    v_mfma_f32_16x16x32_bf16 v[140:143], a[16:19], a[188:191], v[140:143]
    v_mfma_f32_16x16x32_bf16 v[156:159], a[20:23], a[188:191], v[156:159]
    ds_read_b64_tr_b16 a[8:9], v231 offset:0
    v_mfma_f32_16x16x32_bf16 v[152:155], a[20:23], a[184:187], v[152:155]
    ds_read_b64_tr_b16 a[10:11], v231 offset:6144
    v_mfma_f32_16x16x32_bf16 v[148:151], a[20:23], a[180:183], v[148:151]
    v_mfma_f32_16x16x32_bf16 v[144:147], a[20:23], a[176:179], v[144:147]
    s_waitcnt lgkmcnt(6)
    v_mfma_f32_16x16x32_bf16 v[160:163], a[24:27], a[176:179], v[160:163]
    ds_read_b64_tr_b16 a[12:13], v232 offset:0
    v_mfma_f32_16x16x32_bf16 v[164:167], a[24:27], a[180:183], v[164:167]
    buffer_load_dwordx4 v227, s[32:35], s65 offen offset:1024 lds
    s_add_u32 s65, s65, s59
    v_mfma_f32_16x16x32_bf16 v[168:171], a[24:27], a[184:187], v[168:171]
    ds_read_b64_tr_b16 a[14:15], v232 offset:6144
    v_mfma_f32_16x16x32_bf16 v[172:175], a[24:27], a[188:191], v[172:175]
    v_mfma_f32_16x16x32_bf16 v[188:191], a[28:31], a[188:191], v[188:191]
    ds_read_b64_tr_b16 a[16:17], v229 offset:2048
    v_mfma_f32_16x16x32_bf16 v[184:187], a[28:31], a[184:187], v[184:187]
    ds_read_b64_tr_b16 a[18:19], v229 offset:8192
    v_mfma_f32_16x16x32_bf16 v[180:183], a[28:31], a[180:183], v[180:183]
    v_mfma_f32_16x16x32_bf16 v[176:179], a[28:31], a[176:179], v[176:179]
    s_sub_u32 s57, s57, 2
.p2align 3
L_loop_34:
    s_waitcnt lgkmcnt(6)
    v_mfma_f32_16x16x32_bf16 v[0:3], a[0:3], a[32:35], v[0:3]
    ds_read_b64_tr_b16 a[20:21], v230 offset:2048
    v_mfma_f32_16x16x32_bf16 v[4:7], a[0:3], a[36:39], v[4:7]
    buffer_load_dwordx4 a[132:135], v250, s[28:31], s52 offen offset:1024 sc1
    v_mfma_f32_16x16x32_bf16 v[8:11], a[0:3], a[40:43], v[8:11]
    ds_read_b64_tr_b16 a[22:23], v230 offset:8192
    v_mfma_f32_16x16x32_bf16 v[12:15], a[0:3], a[44:47], v[12:15]
    v_mfma_f32_16x16x32_bf16 v[28:31], a[4:7], a[44:47], v[28:31]
    ds_read_b64_tr_b16 a[24:25], v231 offset:2048
    v_mfma_f32_16x16x32_bf16 v[24:27], a[4:7], a[40:43], v[24:27]
    buffer_load_dwordx4 v227, s[32:35], s66 offen offset:2048 lds
    s_add_u32 s66, s66, s59
    v_mfma_f32_16x16x32_bf16 v[20:23], a[4:7], a[36:39], v[20:23]
    ds_read_b64_tr_b16 a[26:27], v231 offset:8192
    v_mfma_f32_16x16x32_bf16 v[16:19], a[4:7], a[32:35], v[16:19]
    s_waitcnt lgkmcnt(6)
    v_mfma_f32_16x16x32_bf16 v[32:35], a[8:11], a[32:35], v[32:35]
    ds_read_b64_tr_b16 a[28:29], v232 offset:2048
    v_mfma_f32_16x16x32_bf16 v[36:39], a[8:11], a[36:39], v[36:39]
    ds_read_b64_tr_b16 a[30:31], v232 offset:8192
    v_mfma_f32_16x16x32_bf16 v[40:43], a[8:11], a[40:43], v[40:43]
    v_mfma_f32_16x16x32_bf16 v[44:47], a[8:11], a[44:47], v[44:47]
    v_mfma_f32_16x16x32_bf16 v[60:63], a[12:15], a[44:47], v[60:63]
    ds_read_b64_tr_b16 a[0:1], v229 offset:4096
    v_mfma_f32_16x16x32_bf16 v[56:59], a[12:15], a[40:43], v[56:59]
    buffer_load_dwordx4 a[136:139], v251, s[28:31], s52 offen offset:2048 sc1
    v_mfma_f32_16x16x32_bf16 v[52:55], a[12:15], a[36:39], v[52:55]
    ds_read_b64_tr_b16 a[2:3], v229 offset:10240
    v_mfma_f32_16x16x32_bf16 v[48:51], a[12:15], a[32:35], v[48:51]
    s_waitcnt lgkmcnt(6)
    v_mfma_f32_16x16x32_bf16 v[64:67], a[16:19], a[32:35], v[64:67]
    ds_read_b64_tr_b16 a[4:5], v230 offset:4096
    v_mfma_f32_16x16x32_bf16 v[68:71], a[16:19], a[36:39], v[68:71]
    ds_read_b64_tr_b16 a[6:7], v230 offset:10240
    v_mfma_f32_16x16x32_bf16 v[72:75], a[16:19], a[40:43], v[72:75]
    v_mfma_f32_16x16x32_bf16 v[76:79], a[16:19], a[44:47], v[76:79]
    v_mfma_f32_16x16x32_bf16 v[92:95], a[20:23], a[44:47], v[92:95]
    ds_read_b64_tr_b16 a[8:9], v231 offset:4096
    v_mfma_f32_16x16x32_bf16 v[88:91], a[20:23], a[40:43], v[88:91]
    buffer_load_dwordx4 v227, s[32:35], s67 offen offset:3072 lds
    s_add_u32 s67, s67, s59
    v_mfma_f32_16x16x32_bf16 v[84:87], a[20:23], a[36:39], v[84:87]
    ds_read_b64_tr_b16 a[10:11], v231 offset:10240
    v_mfma_f32_16x16x32_bf16 v[80:83], a[20:23], a[32:35], v[80:83]
    s_waitcnt lgkmcnt(6)
    v_mfma_f32_16x16x32_bf16 v[96:99], a[24:27], a[32:35], v[96:99]
    ds_read_b64_tr_b16 a[12:13], v232 offset:4096
    v_mfma_f32_16x16x32_bf16 v[100:103], a[24:27], a[36:39], v[100:103]
    ds_read_b64_tr_b16 a[14:15], v232 offset:10240
    v_mfma_f32_16x16x32_bf16 v[104:107], a[24:27], a[40:43], v[104:107]
    v_mfma_f32_16x16x32_bf16 v[108:111], a[24:27], a[44:47], v[108:111]
    v_mfma_f32_16x16x32_bf16 v[124:127], a[28:31], a[44:47], v[124:127]
    ds_read_b64_tr_b16 a[16:17], v229 offset:12288
    v_mfma_f32_16x16x32_bf16 v[120:123], a[28:31], a[40:43], v[120:123]
    buffer_load_dwordx4 a[140:143], v252, s[28:31], s52 offen offset:3072 sc1
    v_mfma_f32_16x16x32_bf16 v[116:119], a[28:31], a[36:39], v[116:119]
    ds_read_b64_tr_b16 a[18:19], v229 offset:18432
    v_mfma_f32_16x16x32_bf16 v[112:115], a[28:31], a[32:35], v[112:115]
    s_waitcnt lgkmcnt(6)
    v_mfma_f32_16x16x32_bf16 v[128:131], a[0:3], a[32:35], v[128:131]
    ds_read_b64_tr_b16 a[20:21], v230 offset:12288
    s_add_u32 m0, s55, 77824
    v_mfma_f32_16x16x32_bf16 v[132:135], a[0:3], a[36:39], v[132:135]
    buffer_load_dwordx4 v227, s[32:35], s68 offen offset:0 lds
    s_add_u32 s68, s68, s59
    v_mfma_f32_16x16x32_bf16 v[136:139], a[0:3], a[40:43], v[136:139]
    ds_read_b64_tr_b16 a[22:23], v230 offset:18432
    v_mfma_f32_16x16x32_bf16 v[140:143], a[0:3], a[44:47], v[140:143]
    v_mfma_f32_16x16x32_bf16 v[156:159], a[4:7], a[44:47], v[156:159]
    ds_read_b64_tr_b16 a[24:25], v231 offset:12288
    v_mfma_f32_16x16x32_bf16 v[152:155], a[4:7], a[40:43], v[152:155]
    ds_read_b64_tr_b16 a[26:27], v231 offset:18432
    v_mfma_f32_16x16x32_bf16 v[148:151], a[4:7], a[36:39], v[148:151]
    v_mfma_f32_16x16x32_bf16 v[144:147], a[4:7], a[32:35], v[144:147]
    s_waitcnt lgkmcnt(6)
    v_mfma_f32_16x16x32_bf16 v[160:163], a[8:11], a[32:35], v[160:163]
    ds_read_b64_tr_b16 a[28:29], v232 offset:12288
    v_mfma_f32_16x16x32_bf16 v[164:167], a[8:11], a[36:39], v[164:167]
    buffer_load_dwordx4 a[144:147], v224, s[28:31], s53 offen offset:0 sc1
    v_mfma_f32_16x16x32_bf16 v[168:171], a[8:11], a[40:43], v[168:171]
    ds_read_b64_tr_b16 a[30:31], v232 offset:18432
    v_mfma_f32_16x16x32_bf16 v[172:175], a[8:11], a[44:47], v[172:175]
    v_mfma_f32_16x16x32_bf16 v[188:191], a[12:15], a[44:47], v[188:191]
    ds_read_b64_tr_b16 a[0:1], v229 offset:14336
    v_mfma_f32_16x16x32_bf16 v[184:187], a[12:15], a[40:43], v[184:187]
    ds_read_b64_tr_b16 a[2:3], v229 offset:20480
    v_mfma_f32_16x16x32_bf16 v[180:183], a[12:15], a[36:39], v[180:183]
    v_mfma_f32_16x16x32_bf16 v[176:179], a[12:15], a[32:35], v[176:179]
    s_waitcnt lgkmcnt(6)
    v_mfma_f32_16x16x32_bf16 v[0:3], a[16:19], a[48:51], v[0:3]
    ds_read_b64_tr_b16 a[4:5], v230 offset:14336
    v_mfma_f32_16x16x32_bf16 v[4:7], a[16:19], a[52:55], v[4:7]
    buffer_load_dwordx4 v227, s[32:35], s69 offen offset:1024 lds
    s_add_u32 s69, s69, s59
    v_mfma_f32_16x16x32_bf16 v[8:11], a[16:19], a[56:59], v[8:11]
    ds_read_b64_tr_b16 a[6:7], v230 offset:20480
    v_mfma_f32_16x16x32_bf16 v[12:15], a[16:19], a[60:63], v[12:15]
    v_mfma_f32_16x16x32_bf16 v[28:31], a[20:23], a[60:63], v[28:31]
    ds_read_b64_tr_b16 a[8:9], v231 offset:14336
    v_mfma_f32_16x16x32_bf16 v[24:27], a[20:23], a[56:59], v[24:27]
    buffer_load_dwordx4 a[148:151], v250, s[28:31], s53 offen offset:1024 sc1
    v_mfma_f32_16x16x32_bf16 v[20:23], a[20:23], a[52:55], v[20:23]
    ds_read_b64_tr_b16 a[10:11], v231 offset:20480
    v_mfma_f32_16x16x32_bf16 v[16:19], a[20:23], a[48:51], v[16:19]
    s_waitcnt lgkmcnt(6)
    v_mfma_f32_16x16x32_bf16 v[32:35], a[24:27], a[48:51], v[32:35]
    ds_read_b64_tr_b16 a[12:13], v232 offset:14336
    v_mfma_f32_16x16x32_bf16 v[36:39], a[24:27], a[52:55], v[36:39]
    ds_read_b64_tr_b16 a[14:15], v232 offset:20480
    v_mfma_f32_16x16x32_bf16 v[40:43], a[24:27], a[56:59], v[40:43]
    v_mfma_f32_16x16x32_bf16 v[44:47], a[24:27], a[60:63], v[44:47]
    v_mfma_f32_16x16x32_bf16 v[60:63], a[28:31], a[60:63], v[60:63]
    ds_read_b64_tr_b16 a[16:17], v229 offset:16384
    v_mfma_f32_16x16x32_bf16 v[56:59], a[28:31], a[56:59], v[56:59]
    buffer_load_dwordx4 a[152:155], v251, s[28:31], s53 offen offset:2048 sc1
    v_mfma_f32_16x16x32_bf16 v[52:55], a[28:31], a[52:55], v[52:55]
    ds_read_b64_tr_b16 a[18:19], v229 offset:22528
    v_mfma_f32_16x16x32_bf16 v[48:51], a[28:31], a[48:51], v[48:51]
    s_waitcnt lgkmcnt(6)
    v_mfma_f32_16x16x32_bf16 v[64:67], a[0:3], a[48:51], v[64:67]
    ds_read_b64_tr_b16 a[20:21], v230 offset:16384
    v_mfma_f32_16x16x32_bf16 v[68:71], a[0:3], a[52:55], v[68:71]
    ds_read_b64_tr_b16 a[22:23], v230 offset:22528
    v_mfma_f32_16x16x32_bf16 v[72:75], a[0:3], a[56:59], v[72:75]
    v_mfma_f32_16x16x32_bf16 v[76:79], a[0:3], a[60:63], v[76:79]
    v_mfma_f32_16x16x32_bf16 v[92:95], a[4:7], a[60:63], v[92:95]
    ds_read_b64_tr_b16 a[24:25], v231 offset:16384
    v_mfma_f32_16x16x32_bf16 v[88:91], a[4:7], a[56:59], v[88:91]
    buffer_load_dwordx4 a[156:159], v252, s[28:31], s53 offen offset:3072 sc1
    v_mfma_f32_16x16x32_bf16 v[84:87], a[4:7], a[52:55], v[84:87]
    ds_read_b64_tr_b16 a[26:27], v231 offset:22528
    v_mfma_f32_16x16x32_bf16 v[80:83], a[4:7], a[48:51], v[80:83]
    s_waitcnt lgkmcnt(6)
    v_mfma_f32_16x16x32_bf16 v[96:99], a[8:11], a[48:51], v[96:99]
    ds_read_b64_tr_b16 a[28:29], v232 offset:16384
    v_mfma_f32_16x16x32_bf16 v[100:103], a[8:11], a[52:55], v[100:103]
    ds_read_b64_tr_b16 a[30:31], v232 offset:22528
    v_mfma_f32_16x16x32_bf16 v[104:107], a[8:11], a[56:59], v[104:107]
    v_mfma_f32_16x16x32_bf16 v[108:111], a[8:11], a[60:63], v[108:111]
    s_waitcnt vmcnt(28)
    s_barrier
    v_mfma_f32_16x16x32_bf16 v[124:127], a[12:15], a[60:63], v[124:127]
    ds_read_b64_tr_b16 a[0:1], v229 offset:24576
    s_add_u32 s52, s52, s58
    s_add_u32 s53, s53, s58
    v_mfma_f32_16x16x32_bf16 v[120:123], a[12:15], a[56:59], v[120:123]
    s_add_u32 s56, s56, 1
    s_add_u32 m0, s55, 98304
    s_nop 0
    buffer_load_dwordx4 v227, s[32:35], s64 offen offset:0 lds
    v_mfma_f32_16x16x32_bf16 v[116:119], a[12:15], a[52:55], v[116:119]
    ds_read_b64_tr_b16 a[2:3], v229 offset:30720
    s_add_u32 s64, s64, s59
    v_mfma_f32_16x16x32_bf16 v[112:115], a[12:15], a[48:51], v[112:115]
    s_waitcnt lgkmcnt(6)
    v_mfma_f32_16x16x32_bf16 v[128:131], a[16:19], a[48:51], v[128:131]
    ds_read_b64_tr_b16 a[4:5], v230 offset:24576
    v_mfma_f32_16x16x32_bf16 v[132:135], a[16:19], a[52:55], v[132:135]
    buffer_load_dwordx4 a[160:163], v224, s[28:31], s52 offen offset:0 sc1
    v_mfma_f32_16x16x32_bf16 v[136:139], a[16:19], a[56:59], v[136:139]
    ds_read_b64_tr_b16 a[6:7], v230 offset:30720
    v_mfma_f32_16x16x32_bf16 v[140:143], a[16:19], a[60:63], v[140:143]
    v_mfma_f32_16x16x32_bf16 v[156:159], a[20:23], a[60:63], v[156:159]
    ds_read_b64_tr_b16 a[8:9], v231 offset:24576
    v_mfma_f32_16x16x32_bf16 v[152:155], a[20:23], a[56:59], v[152:155]
    ds_read_b64_tr_b16 a[10:11], v231 offset:30720
    v_mfma_f32_16x16x32_bf16 v[148:151], a[20:23], a[52:55], v[148:151]
    v_mfma_f32_16x16x32_bf16 v[144:147], a[20:23], a[48:51], v[144:147]
    s_waitcnt lgkmcnt(6)
    v_mfma_f32_16x16x32_bf16 v[160:163], a[24:27], a[48:51], v[160:163]
    ds_read_b64_tr_b16 a[12:13], v232 offset:24576
    v_mfma_f32_16x16x32_bf16 v[164:167], a[24:27], a[52:55], v[164:167]
    buffer_load_dwordx4 v227, s[32:35], s65 offen offset:1024 lds
    s_add_u32 s65, s65, s59
    v_mfma_f32_16x16x32_bf16 v[168:171], a[24:27], a[56:59], v[168:171]
    ds_read_b64_tr_b16 a[14:15], v232 offset:30720
    v_mfma_f32_16x16x32_bf16 v[172:175], a[24:27], a[60:63], v[172:175]
    v_mfma_f32_16x16x32_bf16 v[188:191], a[28:31], a[60:63], v[188:191]
    ds_read_b64_tr_b16 a[16:17], v229 offset:26624
    v_mfma_f32_16x16x32_bf16 v[184:187], a[28:31], a[56:59], v[184:187]
    ds_read_b64_tr_b16 a[18:19], v229 offset:32768
    v_mfma_f32_16x16x32_bf16 v[180:183], a[28:31], a[52:55], v[180:183]
    v_mfma_f32_16x16x32_bf16 v[176:179], a[28:31], a[48:51], v[176:179]
    s_waitcnt lgkmcnt(6)
    v_mfma_f32_16x16x32_bf16 v[0:3], a[0:3], a[64:67], v[0:3]
    ds_read_b64_tr_b16 a[20:21], v230 offset:26624
    v_mfma_f32_16x16x32_bf16 v[4:7], a[0:3], a[68:71], v[4:7]
    buffer_load_dwordx4 a[164:167], v250, s[28:31], s52 offen offset:1024 sc1
    v_mfma_f32_16x16x32_bf16 v[8:11], a[0:3], a[72:75], v[8:11]
    ds_read_b64_tr_b16 a[22:23], v230 offset:32768
    v_mfma_f32_16x16x32_bf16 v[12:15], a[0:3], a[76:79], v[12:15]
    v_mfma_f32_16x16x32_bf16 v[28:31], a[4:7], a[76:79], v[28:31]
    ds_read_b64_tr_b16 a[24:25], v231 offset:26624
    v_mfma_f32_16x16x32_bf16 v[24:27], a[4:7], a[72:75], v[24:27]
    buffer_load_dwordx4 v227, s[32:35], s66 offen offset:2048 lds
    s_add_u32 s66, s66, s59
    v_mfma_f32_16x16x32_bf16 v[20:23], a[4:7], a[68:71], v[20:23]
    ds_read_b64_tr_b16 a[26:27], v231 offset:32768
    v_mfma_f32_16x16x32_bf16 v[16:19], a[4:7], a[64:67], v[16:19]
    s_waitcnt lgkmcnt(6)
    v_mfma_f32_16x16x32_bf16 v[32:35], a[8:11], a[64:67], v[32:35]
    ds_read_b64_tr_b16 a[28:29], v232 offset:26624
    v_mfma_f32_16x16x32_bf16 v[36:39], a[8:11], a[68:71], v[36:39]
    ds_read_b64_tr_b16 a[30:31], v232 offset:32768
    v_mfma_f32_16x16x32_bf16 v[40:43], a[8:11], a[72:75], v[40:43]
    v_mfma_f32_16x16x32_bf16 v[44:47], a[8:11], a[76:79], v[44:47]
    v_mfma_f32_16x16x32_bf16 v[60:63], a[12:15], a[76:79], v[60:63]
    ds_read_b64_tr_b16 a[0:1], v229 offset:28672
    v_mfma_f32_16x16x32_bf16 v[56:59], a[12:15], a[72:75], v[56:59]
    buffer_load_dwordx4 a[168:171], v251, s[28:31], s52 offen offset:2048 sc1
    v_mfma_f32_16x16x32_bf16 v[52:55], a[12:15], a[68:71], v[52:55]
    ds_read_b64_tr_b16 a[2:3], v229 offset:34816
    v_mfma_f32_16x16x32_bf16 v[48:51], a[12:15], a[64:67], v[48:51]
    s_waitcnt lgkmcnt(6)
    v_mfma_f32_16x16x32_bf16 v[64:67], a[16:19], a[64:67], v[64:67]
    ds_read_b64_tr_b16 a[4:5], v230 offset:28672
    v_mfma_f32_16x16x32_bf16 v[68:71], a[16:19], a[68:71], v[68:71]
    ds_read_b64_tr_b16 a[6:7], v230 offset:34816
    v_mfma_f32_16x16x32_bf16 v[72:75], a[16:19], a[72:75], v[72:75]
    v_mfma_f32_16x16x32_bf16 v[76:79], a[16:19], a[76:79], v[76:79]
    v_mfma_f32_16x16x32_bf16 v[92:95], a[20:23], a[76:79], v[92:95]
    ds_read_b64_tr_b16 a[8:9], v231 offset:28672
    v_mfma_f32_16x16x32_bf16 v[88:91], a[20:23], a[72:75], v[88:91]
    buffer_load_dwordx4 v227, s[32:35], s67 offen offset:3072 lds
    s_add_u32 s67, s67, s59
    v_mfma_f32_16x16x32_bf16 v[84:87], a[20:23], a[68:71], v[84:87]
    ds_read_b64_tr_b16 a[10:11], v231 offset:34816
    v_mfma_f32_16x16x32_bf16 v[80:83], a[20:23], a[64:67], v[80:83]
    s_waitcnt lgkmcnt(6)
    v_mfma_f32_16x16x32_bf16 v[96:99], a[24:27], a[64:67], v[96:99]
    ds_read_b64_tr_b16 a[12:13], v232 offset:28672
    v_mfma_f32_16x16x32_bf16 v[100:103], a[24:27], a[68:71], v[100:103]
    ds_read_b64_tr_b16 a[14:15], v232 offset:34816
    v_mfma_f32_16x16x32_bf16 v[104:107], a[24:27], a[72:75], v[104:107]
    v_mfma_f32_16x16x32_bf16 v[108:111], a[24:27], a[76:79], v[108:111]
    v_mfma_f32_16x16x32_bf16 v[124:127], a[28:31], a[76:79], v[124:127]
    ds_read_b64_tr_b16 a[16:17], v229 offset:36864
    v_mfma_f32_16x16x32_bf16 v[120:123], a[28:31], a[72:75], v[120:123]
    buffer_load_dwordx4 a[172:175], v252, s[28:31], s52 offen offset:3072 sc1
    v_mfma_f32_16x16x32_bf16 v[116:119], a[28:31], a[68:71], v[116:119]
    ds_read_b64_tr_b16 a[18:19], v229 offset:43008
    v_mfma_f32_16x16x32_bf16 v[112:115], a[28:31], a[64:67], v[112:115]
    s_waitcnt lgkmcnt(6)
    v_mfma_f32_16x16x32_bf16 v[128:131], a[0:3], a[64:67], v[128:131]
    ds_read_b64_tr_b16 a[20:21], v230 offset:36864
    s_add_u32 m0, s55, 102400
    v_mfma_f32_16x16x32_bf16 v[132:135], a[0:3], a[68:71], v[132:135]
    buffer_load_dwordx4 v227, s[32:35], s68 offen offset:0 lds
    s_add_u32 s68, s68, s59
    v_mfma_f32_16x16x32_bf16 v[136:139], a[0:3], a[72:75], v[136:139]
    ds_read_b64_tr_b16 a[22:23], v230 offset:43008
    v_mfma_f32_16x16x32_bf16 v[140:143], a[0:3], a[76:79], v[140:143]
    v_mfma_f32_16x16x32_bf16 v[156:159], a[4:7], a[76:79], v[156:159]
    ds_read_b64_tr_b16 a[24:25], v231 offset:36864
    v_mfma_f32_16x16x32_bf16 v[152:155], a[4:7], a[72:75], v[152:155]
    ds_read_b64_tr_b16 a[26:27], v231 offset:43008
    v_mfma_f32_16x16x32_bf16 v[148:151], a[4:7], a[68:71], v[148:151]
    v_mfma_f32_16x16x32_bf16 v[144:147], a[4:7], a[64:67], v[144:147]
    s_waitcnt lgkmcnt(6)
    v_mfma_f32_16x16x32_bf16 v[160:163], a[8:11], a[64:67], v[160:163]
    ds_read_b64_tr_b16 a[28:29], v232 offset:36864
    v_mfma_f32_16x16x32_bf16 v[164:167], a[8:11], a[68:71], v[164:167]
    buffer_load_dwordx4 a[176:179], v224, s[28:31], s53 offen offset:0 sc1
    v_mfma_f32_16x16x32_bf16 v[168:171], a[8:11], a[72:75], v[168:171]
    ds_read_b64_tr_b16 a[30:31], v232 offset:43008
    v_mfma_f32_16x16x32_bf16 v[172:175], a[8:11], a[76:79], v[172:175]
    v_mfma_f32_16x16x32_bf16 v[188:191], a[12:15], a[76:79], v[188:191]
    ds_read_b64_tr_b16 a[0:1], v229 offset:38912
    v_mfma_f32_16x16x32_bf16 v[184:187], a[12:15], a[72:75], v[184:187]
    ds_read_b64_tr_b16 a[2:3], v229 offset:45056
    v_mfma_f32_16x16x32_bf16 v[180:183], a[12:15], a[68:71], v[180:183]
    v_mfma_f32_16x16x32_bf16 v[176:179], a[12:15], a[64:67], v[176:179]
    s_waitcnt lgkmcnt(6)
    v_mfma_f32_16x16x32_bf16 v[0:3], a[16:19], a[80:83], v[0:3]
    ds_read_b64_tr_b16 a[4:5], v230 offset:38912
    v_mfma_f32_16x16x32_bf16 v[4:7], a[16:19], a[84:87], v[4:7]
    buffer_load_dwordx4 v227, s[32:35], s69 offen offset:1024 lds
    s_add_u32 s69, s69, s59
    v_mfma_f32_16x16x32_bf16 v[8:11], a[16:19], a[88:91], v[8:11]
    ds_read_b64_tr_b16 a[6:7], v230 offset:45056
    v_mfma_f32_16x16x32_bf16 v[12:15], a[16:19], a[92:95], v[12:15]
    v_mfma_f32_16x16x32_bf16 v[28:31], a[20:23], a[92:95], v[28:31]
    ds_read_b64_tr_b16 a[8:9], v231 offset:38912
    v_mfma_f32_16x16x32_bf16 v[24:27], a[20:23], a[88:91], v[24:27]
    buffer_load_dwordx4 a[180:183], v250, s[28:31], s53 offen offset:1024 sc1
    v_mfma_f32_16x16x32_bf16 v[20:23], a[20:23], a[84:87], v[20:23]
    ds_read_b64_tr_b16 a[10:11], v231 offset:45056
    v_mfma_f32_16x16x32_bf16 v[16:19], a[20:23], a[80:83], v[16:19]
    s_waitcnt lgkmcnt(6)
    v_mfma_f32_16x16x32_bf16 v[32:35], a[24:27], a[80:83], v[32:35]
    ds_read_b64_tr_b16 a[12:13], v232 offset:38912
    v_mfma_f32_16x16x32_bf16 v[36:39], a[24:27], a[84:87], v[36:39]
    ds_read_b64_tr_b16 a[14:15], v232 offset:45056
    v_mfma_f32_16x16x32_bf16 v[40:43], a[24:27], a[88:91], v[40:43]
    v_mfma_f32_16x16x32_bf16 v[44:47], a[24:27], a[92:95], v[44:47]
    v_mfma_f32_16x16x32_bf16 v[60:63], a[28:31], a[92:95], v[60:63]
    ds_read_b64_tr_b16 a[16:17], v229 offset:40960
    v_mfma_f32_16x16x32_bf16 v[56:59], a[28:31], a[88:91], v[56:59]
    buffer_load_dwordx4 a[184:187], v251, s[28:31], s53 offen offset:2048 sc1
    v_mfma_f32_16x16x32_bf16 v[52:55], a[28:31], a[84:87], v[52:55]
    ds_read_b64_tr_b16 a[18:19], v229 offset:47104
    v_mfma_f32_16x16x32_bf16 v[48:51], a[28:31], a[80:83], v[48:51]
    s_waitcnt lgkmcnt(6)
    v_mfma_f32_16x16x32_bf16 v[64:67], a[0:3], a[80:83], v[64:67]
    ds_read_b64_tr_b16 a[20:21], v230 offset:40960
    v_mfma_f32_16x16x32_bf16 v[68:71], a[0:3], a[84:87], v[68:71]
    ds_read_b64_tr_b16 a[22:23], v230 offset:47104
    v_mfma_f32_16x16x32_bf16 v[72:75], a[0:3], a[88:91], v[72:75]
    v_mfma_f32_16x16x32_bf16 v[76:79], a[0:3], a[92:95], v[76:79]
    v_mfma_f32_16x16x32_bf16 v[92:95], a[4:7], a[92:95], v[92:95]
    ds_read_b64_tr_b16 a[24:25], v231 offset:40960
    v_mfma_f32_16x16x32_bf16 v[88:91], a[4:7], a[88:91], v[88:91]
    buffer_load_dwordx4 a[188:191], v252, s[28:31], s53 offen offset:3072 sc1
    v_mfma_f32_16x16x32_bf16 v[84:87], a[4:7], a[84:87], v[84:87]
    ds_read_b64_tr_b16 a[26:27], v231 offset:47104
    v_mfma_f32_16x16x32_bf16 v[80:83], a[4:7], a[80:83], v[80:83]
    s_waitcnt lgkmcnt(6)
    v_mfma_f32_16x16x32_bf16 v[96:99], a[8:11], a[80:83], v[96:99]
    ds_read_b64_tr_b16 a[28:29], v232 offset:40960
    v_mfma_f32_16x16x32_bf16 v[100:103], a[8:11], a[84:87], v[100:103]
    ds_read_b64_tr_b16 a[30:31], v232 offset:47104
    v_mfma_f32_16x16x32_bf16 v[104:107], a[8:11], a[88:91], v[104:107]
    v_mfma_f32_16x16x32_bf16 v[108:111], a[8:11], a[92:95], v[108:111]
    s_waitcnt vmcnt(28)
    s_barrier
    v_mfma_f32_16x16x32_bf16 v[124:127], a[12:15], a[92:95], v[124:127]
    ds_read_b64_tr_b16 a[0:1], v235 offset:0
    s_add_u32 s52, s52, s58
    s_add_u32 s53, s53, s58
    v_mfma_f32_16x16x32_bf16 v[120:123], a[12:15], a[88:91], v[120:123]
    ds_read_b64_tr_b16 a[2:3], v235 offset:6144
    s_add_u32 s56, s56, 1
    s_cmp_eq_u32 s56, 16
    v_mfma_f32_16x16x32_bf16 v[116:119], a[12:15], a[84:87], v[116:119]
    s_cbranch_scc0 L_tailsw_36
    v_accvgpr_read_b32 v250, a242
    v_accvgpr_read_b32 v251, a243
    v_mov_b32 v227, v226
    v_mov_b32 v228, v226
    global_load_dword a240, v[250:251], off
    s_lshl_b32 s1, s3, 14
    v_add_u32 v224, s1, v226
    v_add_u32 v250, 64512, v224
    v_add_u32 v251, 129024, v224
    v_add_u32 v252, 193536, v224
    v_add_u32 v225, 262144, v224
    s_mov_b64 s[28:29], s[18:19]
    s_mov_b32 s30, 0x380000
    s_mov_b64 s[32:33], s[8:9]
    s_mov_b32 s34, 0x200000
    s_mov_b64 s[40:41], s[8:9]
    s_mov_b32 s42, 0x200000
    s_mov_b32 s52, 524288
    s_mov_b32 s53, 786432
    s_mov_b32 s58, 524288
    s_mul_i32 s64, s3, 98304
    s_mov_b32 s59, 393216
    s_mov_b32 s61, 393216
    s_add_u32 s65, s64, 15360
    s_add_u32 s66, s64, 30720
    s_add_u32 s67, s64, 46080
    s_add_u32 s68, s64, 65536
    s_add_u32 s69, s64, 80896
L_tailsw_36:
    s_add_u32 m0, s55, 0
    s_nop 0
    buffer_load_dwordx4 v227, s[32:35], s64 offen offset:0 lds
    v_mfma_f32_16x16x32_bf16 v[112:115], a[12:15], a[80:83], v[112:115]
    s_add_u32 s64, s64, s59
    s_waitcnt lgkmcnt(6)
    v_mfma_f32_16x16x32_bf16 v[128:131], a[16:19], a[80:83], v[128:131]
    ds_read_b64_tr_b16 a[4:5], v236 offset:0
    v_mfma_f32_16x16x32_bf16 v[132:135], a[16:19], a[84:87], v[132:135]
    buffer_load_dwordx4 a[32:35], v224, s[28:31], s52 offen offset:0 sc1
    v_mfma_f32_16x16x32_bf16 v[136:139], a[16:19], a[88:91], v[136:139]
    ds_read_b64_tr_b16 a[6:7], v236 offset:6144
    v_mfma_f32_16x16x32_bf16 v[140:143], a[16:19], a[92:95], v[140:143]
    v_mfma_f32_16x16x32_bf16 v[156:159], a[20:23], a[92:95], v[156:159]
    ds_read_b64_tr_b16 a[8:9], v237 offset:0
    v_mfma_f32_16x16x32_bf16 v[152:155], a[20:23], a[88:91], v[152:155]
    ds_read_b64_tr_b16 a[10:11], v237 offset:6144
    v_mfma_f32_16x16x32_bf16 v[148:151], a[20:23], a[84:87], v[148:151]
    v_mfma_f32_16x16x32_bf16 v[144:147], a[20:23], a[80:83], v[144:147]
    s_waitcnt lgkmcnt(6)
    v_mfma_f32_16x16x32_bf16 v[160:163], a[24:27], a[80:83], v[160:163]
    ds_read_b64_tr_b16 a[12:13], v238 offset:0
    v_mfma_f32_16x16x32_bf16 v[164:167], a[24:27], a[84:87], v[164:167]
    buffer_load_dwordx4 v227, s[32:35], s65 offen offset:1024 lds
    s_add_u32 s65, s65, s59
    v_mfma_f32_16x16x32_bf16 v[168:171], a[24:27], a[88:91], v[168:171]
    ds_read_b64_tr_b16 a[14:15], v238 offset:6144
    v_mfma_f32_16x16x32_bf16 v[172:175], a[24:27], a[92:95], v[172:175]
    v_mfma_f32_16x16x32_bf16 v[188:191], a[28:31], a[92:95], v[188:191]
    ds_read_b64_tr_b16 a[16:17], v235 offset:2048
    v_mfma_f32_16x16x32_bf16 v[184:187], a[28:31], a[88:91], v[184:187]
    ds_read_b64_tr_b16 a[18:19], v235 offset:8192
    v_mfma_f32_16x16x32_bf16 v[180:183], a[28:31], a[84:87], v[180:183]
    v_mfma_f32_16x16x32_bf16 v[176:179], a[28:31], a[80:83], v[176:179]
    s_waitcnt lgkmcnt(6)
    v_mfma_f32_16x16x32_bf16 v[0:3], a[0:3], a[96:99], v[0:3]
    ds_read_b64_tr_b16 a[20:21], v236 offset:2048
    v_mfma_f32_16x16x32_bf16 v[4:7], a[0:3], a[100:103], v[4:7]
    buffer_load_dwordx4 a[36:39], v250, s[28:31], s52 offen offset:1024 sc1
    v_mfma_f32_16x16x32_bf16 v[8:11], a[0:3], a[104:107], v[8:11]
    ds_read_b64_tr_b16 a[22:23], v236 offset:8192
    v_mfma_f32_16x16x32_bf16 v[12:15], a[0:3], a[108:111], v[12:15]
    v_mfma_f32_16x16x32_bf16 v[28:31], a[4:7], a[108:111], v[28:31]
    ds_read_b64_tr_b16 a[24:25], v237 offset:2048
    v_mfma_f32_16x16x32_bf16 v[24:27], a[4:7], a[104:107], v[24:27]
    buffer_load_dwordx4 v227, s[32:35], s66 offen offset:2048 lds
    s_add_u32 s66, s66, s59
    v_mfma_f32_16x16x32_bf16 v[20:23], a[4:7], a[100:103], v[20:23]
    ds_read_b64_tr_b16 a[26:27], v237 offset:8192
    v_mfma_f32_16x16x32_bf16 v[16:19], a[4:7], a[96:99], v[16:19]
    s_waitcnt lgkmcnt(6)
    v_mfma_f32_16x16x32_bf16 v[32:35], a[8:11], a[96:99], v[32:35]
    ds_read_b64_tr_b16 a[28:29], v238 offset:2048
    v_mfma_f32_16x16x32_bf16 v[36:39], a[8:11], a[100:103], v[36:39]
    ds_read_b64_tr_b16 a[30:31], v238 offset:8192
    v_mfma_f32_16x16x32_bf16 v[40:43], a[8:11], a[104:107], v[40:43]
    v_mfma_f32_16x16x32_bf16 v[44:47], a[8:11], a[108:111], v[44:47]
    v_mfma_f32_16x16x32_bf16 v[60:63], a[12:15], a[108:111], v[60:63]
    ds_read_b64_tr_b16 a[0:1], v235 offset:4096
    v_mfma_f32_16x16x32_bf16 v[56:59], a[12:15], a[104:107], v[56:59]
    buffer_load_dwordx4 a[40:43], v251, s[28:31], s52 offen offset:2048 sc1
    v_mfma_f32_16x16x32_bf16 v[52:55], a[12:15], a[100:103], v[52:55]
    ds_read_b64_tr_b16 a[2:3], v235 offset:10240
    v_mfma_f32_16x16x32_bf16 v[48:51], a[12:15], a[96:99], v[48:51]
    s_waitcnt lgkmcnt(6)
    v_mfma_f32_16x16x32_bf16 v[64:67], a[16:19], a[96:99], v[64:67]
    ds_read_b64_tr_b16 a[4:5], v236 offset:4096
    v_mfma_f32_16x16x32_bf16 v[68:71], a[16:19], a[100:103], v[68:71]
    ds_read_b64_tr_b16 a[6:7], v236 offset:10240
    v_mfma_f32_16x16x32_bf16 v[72:75], a[16:19], a[104:107], v[72:75]
    v_mfma_f32_16x16x32_bf16 v[76:79], a[16:19], a[108:111], v[76:79]
    v_mfma_f32_16x16x32_bf16 v[92:95], a[20:23], a[108:111], v[92:95]
    ds_read_b64_tr_b16 a[8:9], v237 offset:4096
    v_mfma_f32_16x16x32_bf16 v[88:91], a[20:23], a[104:107], v[88:91]
    buffer_load_dwordx4 v227, s[32:35], s67 offen offset:3072 lds
    s_add_u32 s67, s67, s59
    v_mfma_f32_16x16x32_bf16 v[84:87], a[20:23], a[100:103], v[84:87]
    ds_read_b64_tr_b16 a[10:11], v237 offset:10240
    v_mfma_f32_16x16x32_bf16 v[80:83], a[20:23], a[96:99], v[80:83]
    s_waitcnt lgkmcnt(6)
    v_mfma_f32_16x16x32_bf16 v[96:99], a[24:27], a[96:99], v[96:99]
    ds_read_b64_tr_b16 a[12:13], v238 offset:4096
    v_mfma_f32_16x16x32_bf16 v[100:103], a[24:27], a[100:103], v[100:103]
    ds_read_b64_tr_b16 a[14:15], v238 offset:10240
    v_mfma_f32_16x16x32_bf16 v[104:107], a[24:27], a[104:107], v[104:107]
    v_mfma_f32_16x16x32_bf16 v[108:111], a[24:27], a[108:111], v[108:111]
    v_mfma_f32_16x16x32_bf16 v[124:127], a[28:31], a[108:111], v[124:127]
    ds_read_b64_tr_b16 a[16:17], v235 offset:12288
    v_mfma_f32_16x16x32_bf16 v[120:123], a[28:31], a[104:107], v[120:123]
    buffer_load_dwordx4 a[44:47], v252, s[28:31], s52 offen offset:3072 sc1
    v_mfma_f32_16x16x32_bf16 v[116:119], a[28:31], a[100:103], v[116:119]
    ds_read_b64_tr_b16 a[18:19], v235 offset:18432
    v_mfma_f32_16x16x32_bf16 v[112:115], a[28:31], a[96:99], v[112:115]
    s_waitcnt lgkmcnt(6)
    v_mfma_f32_16x16x32_bf16 v[128:131], a[0:3], a[96:99], v[128:131]
    ds_read_b64_tr_b16 a[20:21], v236 offset:12288
    s_add_u32 m0, s55, 4096
    v_mfma_f32_16x16x32_bf16 v[132:135], a[0:3], a[100:103], v[132:135]
    buffer_load_dwordx4 v227, s[32:35], s68 offen offset:0 lds
    s_add_u32 s68, s68, s59
    v_mfma_f32_16x16x32_bf16 v[136:139], a[0:3], a[104:107], v[136:139]
    ds_read_b64_tr_b16 a[22:23], v236 offset:18432
    v_mfma_f32_16x16x32_bf16 v[140:143], a[0:3], a[108:111], v[140:143]
    v_mfma_f32_16x16x32_bf16 v[156:159], a[4:7], a[108:111], v[156:159]
    s_branch L_po_C_3
.p2align 12
L_pg_C_3:
    s_branch L_pg_K_0
L_po_C_3:
    ds_read_b64_tr_b16 a[24:25], v237 offset:12288
    v_mfma_f32_16x16x32_bf16 v[152:155], a[4:7], a[104:107], v[152:155]
    ds_read_b64_tr_b16 a[26:27], v237 offset:18432
    v_mfma_f32_16x16x32_bf16 v[148:151], a[4:7], a[100:103], v[148:151]
    v_mfma_f32_16x16x32_bf16 v[144:147], a[4:7], a[96:99], v[144:147]
    s_waitcnt lgkmcnt(6)
    v_mfma_f32_16x16x32_bf16 v[160:163], a[8:11], a[96:99], v[160:163]
    ds_read_b64_tr_b16 a[28:29], v238 offset:12288
    v_mfma_f32_16x16x32_bf16 v[164:167], a[8:11], a[100:103], v[164:167]
    buffer_load_dwordx4 a[48:51], v224, s[28:31], s53 offen offset:0 sc1
    v_mfma_f32_16x16x32_bf16 v[168:171], a[8:11], a[104:107], v[168:171]
    ds_read_b64_tr_b16 a[30:31], v238 offset:18432
    v_mfma_f32_16x16x32_bf16 v[172:175], a[8:11], a[108:111], v[172:175]
    v_mfma_f32_16x16x32_bf16 v[188:191], a[12:15], a[108:111], v[188:191]
    ds_read_b64_tr_b16 a[0:1], v235 offset:14336
    v_mfma_f32_16x16x32_bf16 v[184:187], a[12:15], a[104:107], v[184:187]
    ds_read_b64_tr_b16 a[2:3], v235 offset:20480
    v_mfma_f32_16x16x32_bf16 v[180:183], a[12:15], a[100:103], v[180:183]
    v_mfma_f32_16x16x32_bf16 v[176:179], a[12:15], a[96:99], v[176:179]
    s_waitcnt lgkmcnt(6)
    v_mfma_f32_16x16x32_bf16 v[0:3], a[16:19], a[112:115], v[0:3]
    ds_read_b64_tr_b16 a[4:5], v236 offset:14336
    v_mfma_f32_16x16x32_bf16 v[4:7], a[16:19], a[116:119], v[4:7]
    buffer_load_dwordx4 v227, s[32:35], s69 offen offset:1024 lds
    s_add_u32 s69, s69, s59
    v_mfma_f32_16x16x32_bf16 v[8:11], a[16:19], a[120:123], v[8:11]
    ds_read_b64_tr_b16 a[6:7], v236 offset:20480
    v_mfma_f32_16x16x32_bf16 v[12:15], a[16:19], a[124:127], v[12:15]
    v_mfma_f32_16x16x32_bf16 v[28:31], a[20:23], a[124:127], v[28:31]
    ds_read_b64_tr_b16 a[8:9], v237 offset:14336
    v_mfma_f32_16x16x32_bf16 v[24:27], a[20:23], a[120:123], v[24:27]
    buffer_load_dwordx4 a[52:55], v250, s[28:31], s53 offen offset:1024 sc1
    v_mfma_f32_16x16x32_bf16 v[20:23], a[20:23], a[116:119], v[20:23]
    ds_read_b64_tr_b16 a[10:11], v237 offset:20480
    v_mfma_f32_16x16x32_bf16 v[16:19], a[20:23], a[112:115], v[16:19]
    s_waitcnt lgkmcnt(6)
    v_mfma_f32_16x16x32_bf16 v[32:35], a[24:27], a[112:115], v[32:35]
    ds_read_b64_tr_b16 a[12:13], v238 offset:14336
    v_mfma_f32_16x16x32_bf16 v[36:39], a[24:27], a[116:119], v[36:39]
    ds_read_b64_tr_b16 a[14:15], v238 offset:20480
    v_mfma_f32_16x16x32_bf16 v[40:43], a[24:27], a[120:123], v[40:43]
    v_mfma_f32_16x16x32_bf16 v[44:47], a[24:27], a[124:127], v[44:47]
    v_mfma_f32_16x16x32_bf16 v[60:63], a[28:31], a[124:127], v[60:63]
    ds_read_b64_tr_b16 a[16:17], v235 offset:16384
    v_mfma_f32_16x16x32_bf16 v[56:59], a[28:31], a[120:123], v[56:59]
    buffer_load_dwordx4 a[56:59], v251, s[28:31], s53 offen offset:2048 sc1
    v_mfma_f32_16x16x32_bf16 v[52:55], a[28:31], a[116:119], v[52:55]
    ds_read_b64_tr_b16 a[18:19], v235 offset:22528
    v_mfma_f32_16x16x32_bf16 v[48:51], a[28:31], a[112:115], v[48:51]
    s_waitcnt lgkmcnt(6)
    v_mfma_f32_16x16x32_bf16 v[64:67], a[0:3], a[112:115], v[64:67]
    ds_read_b64_tr_b16 a[20:21], v236 offset:16384
    v_mfma_f32_16x16x32_bf16 v[68:71], a[0:3], a[116:119], v[68:71]
    ds_read_b64_tr_b16 a[22:23], v236 offset:22528
    v_mfma_f32_16x16x32_bf16 v[72:75], a[0:3], a[120:123], v[72:75]
    v_mfma_f32_16x16x32_bf16 v[76:79], a[0:3], a[124:127], v[76:79]
    v_mfma_f32_16x16x32_bf16 v[92:95], a[4:7], a[124:127], v[92:95]
    ds_read_b64_tr_b16 a[24:25], v237 offset:16384
    v_mfma_f32_16x16x32_bf16 v[88:91], a[4:7], a[120:123], v[88:91]
    buffer_load_dwordx4 a[60:63], v252, s[28:31], s53 offen offset:3072 sc1
    v_mfma_f32_16x16x32_bf16 v[84:87], a[4:7], a[116:119], v[84:87]
    ds_read_b64_tr_b16 a[26:27], v237 offset:22528
    v_mfma_f32_16x16x32_bf16 v[80:83], a[4:7], a[112:115], v[80:83]
    s_waitcnt lgkmcnt(6)
    v_mfma_f32_16x16x32_bf16 v[96:99], a[8:11], a[112:115], v[96:99]
    ds_read_b64_tr_b16 a[28:29], v238 offset:16384
    v_mfma_f32_16x16x32_bf16 v[100:103], a[8:11], a[116:119], v[100:103]
    ds_read_b64_tr_b16 a[30:31], v238 offset:22528
    v_mfma_f32_16x16x32_bf16 v[104:107], a[8:11], a[120:123], v[104:107]
    v_mfma_f32_16x16x32_bf16 v[108:111], a[8:11], a[124:127], v[108:111]
    s_waitcnt vmcnt(28)
    s_barrier
    v_mfma_f32_16x16x32_bf16 v[124:127], a[12:15], a[124:127], v[124:127]
    ds_read_b64_tr_b16 a[0:1], v235 offset:24576
    s_add_u32 s52, s52, s58
    s_add_u32 s53, s53, s58
    v_mfma_f32_16x16x32_bf16 v[120:123], a[12:15], a[120:123], v[120:123]
    s_add_u32 s56, s56, 1
    s_add_u32 m0, s55, 24576
    s_nop 0
    buffer_load_dwordx4 v227, s[32:35], s64 offen offset:0 lds
    v_mfma_f32_16x16x32_bf16 v[116:119], a[12:15], a[116:119], v[116:119]
    ds_read_b64_tr_b16 a[2:3], v235 offset:30720
    s_add_u32 s64, s64, s59
    v_mfma_f32_16x16x32_bf16 v[112:115], a[12:15], a[112:115], v[112:115]
    s_waitcnt lgkmcnt(6)
    v_mfma_f32_16x16x32_bf16 v[128:131], a[16:19], a[112:115], v[128:131]
    ds_read_b64_tr_b16 a[4:5], v236 offset:24576
    v_mfma_f32_16x16x32_bf16 v[132:135], a[16:19], a[116:119], v[132:135]
    buffer_load_dwordx4 a[64:67], v224, s[28:31], s52 offen offset:0 sc1
    v_mfma_f32_16x16x32_bf16 v[136:139], a[16:19], a[120:123], v[136:139]
    ds_read_b64_tr_b16 a[6:7], v236 offset:30720
    v_mfma_f32_16x16x32_bf16 v[140:143], a[16:19], a[124:127], v[140:143]
    v_mfma_f32_16x16x32_bf16 v[156:159], a[20:23], a[124:127], v[156:159]
    ds_read_b64_tr_b16 a[8:9], v237 offset:24576
    v_mfma_f32_16x16x32_bf16 v[152:155], a[20:23], a[120:123], v[152:155]
    ds_read_b64_tr_b16 a[10:11], v237 offset:30720
    v_mfma_f32_16x16x32_bf16 v[148:151], a[20:23], a[116:119], v[148:151]
    v_mfma_f32_16x16x32_bf16 v[144:147], a[20:23], a[112:115], v[144:147]
    s_waitcnt lgkmcnt(6)
    v_mfma_f32_16x16x32_bf16 v[160:163], a[24:27], a[112:115], v[160:163]
    ds_read_b64_tr_b16 a[12:13], v238 offset:24576
    v_mfma_f32_16x16x32_bf16 v[164:167], a[24:27], a[116:119], v[164:167]
    buffer_load_dwordx4 v227, s[32:35], s65 offen offset:1024 lds
    s_add_u32 s65, s65, s59
    v_mfma_f32_16x16x32_bf16 v[168:171], a[24:27], a[120:123], v[168:171]
    ds_read_b64_tr_b16 a[14:15], v238 offset:30720
    v_mfma_f32_16x16x32_bf16 v[172:175], a[24:27], a[124:127], v[172:175]
    v_mfma_f32_16x16x32_bf16 v[188:191], a[28:31], a[124:127], v[188:191]
    ds_read_b64_tr_b16 a[16:17], v235 offset:26624
    v_mfma_f32_16x16x32_bf16 v[184:187], a[28:31], a[120:123], v[184:187]
    ds_read_b64_tr_b16 a[18:19], v235 offset:32768
    v_mfma_f32_16x16x32_bf16 v[180:183], a[28:31], a[116:119], v[180:183]
    v_mfma_f32_16x16x32_bf16 v[176:179], a[28:31], a[112:115], v[176:179]
    s_waitcnt lgkmcnt(6)
    v_mfma_f32_16x16x32_bf16 v[0:3], a[0:3], a[128:131], v[0:3]
    ds_read_b64_tr_b16 a[20:21], v236 offset:26624
    v_mfma_f32_16x16x32_bf16 v[4:7], a[0:3], a[132:135], v[4:7]
    buffer_load_dwordx4 a[68:71], v250, s[28:31], s52 offen offset:1024 sc1
    v_mfma_f32_16x16x32_bf16 v[8:11], a[0:3], a[136:139], v[8:11]
    ds_read_b64_tr_b16 a[22:23], v236 offset:32768
    v_mfma_f32_16x16x32_bf16 v[12:15], a[0:3], a[140:143], v[12:15]
    v_mfma_f32_16x16x32_bf16 v[28:31], a[4:7], a[140:143], v[28:31]
    ds_read_b64_tr_b16 a[24:25], v237 offset:26624
    v_mfma_f32_16x16x32_bf16 v[24:27], a[4:7], a[136:139], v[24:27]
    buffer_load_dwordx4 v227, s[32:35], s66 offen offset:2048 lds
    s_add_u32 s66, s66, s59
    v_mfma_f32_16x16x32_bf16 v[20:23], a[4:7], a[132:135], v[20:23]
    ds_read_b64_tr_b16 a[26:27], v237 offset:32768
    v_mfma_f32_16x16x32_bf16 v[16:19], a[4:7], a[128:131], v[16:19]
    s_waitcnt lgkmcnt(6)
    v_mfma_f32_16x16x32_bf16 v[32:35], a[8:11], a[128:131], v[32:35]
    ds_read_b64_tr_b16 a[28:29], v238 offset:26624
    v_mfma_f32_16x16x32_bf16 v[36:39], a[8:11], a[132:135], v[36:39]
    ds_read_b64_tr_b16 a[30:31], v238 offset:32768
    v_mfma_f32_16x16x32_bf16 v[40:43], a[8:11], a[136:139], v[40:43]
    v_mfma_f32_16x16x32_bf16 v[44:47], a[8:11], a[140:143], v[44:47]
    v_mfma_f32_16x16x32_bf16 v[60:63], a[12:15], a[140:143], v[60:63]
    ds_read_b64_tr_b16 a[0:1], v235 offset:28672
    v_mfma_f32_16x16x32_bf16 v[56:59], a[12:15], a[136:139], v[56:59]
    buffer_load_dwordx4 a[72:75], v251, s[28:31], s52 offen offset:2048 sc1
    v_mfma_f32_16x16x32_bf16 v[52:55], a[12:15], a[132:135], v[52:55]
    ds_read_b64_tr_b16 a[2:3], v235 offset:34816
    v_mfma_f32_16x16x32_bf16 v[48:51], a[12:15], a[128:131], v[48:51]
    s_waitcnt lgkmcnt(6)
    v_mfma_f32_16x16x32_bf16 v[64:67], a[16:19], a[128:131], v[64:67]
    ds_read_b64_tr_b16 a[4:5], v236 offset:28672
    v_mfma_f32_16x16x32_bf16 v[68:71], a[16:19], a[132:135], v[68:71]
    ds_read_b64_tr_b16 a[6:7], v236 offset:34816
    v_mfma_f32_16x16x32_bf16 v[72:75], a[16:19], a[136:139], v[72:75]
    v_mfma_f32_16x16x32_bf16 v[76:79], a[16:19], a[140:143], v[76:79]
    v_mfma_f32_16x16x32_bf16 v[92:95], a[20:23], a[140:143], v[92:95]
    ds_read_b64_tr_b16 a[8:9], v237 offset:28672
    v_mfma_f32_16x16x32_bf16 v[88:91], a[20:23], a[136:139], v[88:91]
    buffer_load_dwordx4 v227, s[32:35], s67 offen offset:3072 lds
    s_add_u32 s67, s67, s59
    v_mfma_f32_16x16x32_bf16 v[84:87], a[20:23], a[132:135], v[84:87]
    ds_read_b64_tr_b16 a[10:11], v237 offset:34816
    v_mfma_f32_16x16x32_bf16 v[80:83], a[20:23], a[128:131], v[80:83]
    s_waitcnt lgkmcnt(6)
    v_mfma_f32_16x16x32_bf16 v[96:99], a[24:27], a[128:131], v[96:99]
    ds_read_b64_tr_b16 a[12:13], v238 offset:28672
    v_mfma_f32_16x16x32_bf16 v[100:103], a[24:27], a[132:135], v[100:103]
    ds_read_b64_tr_b16 a[14:15], v238 offset:34816
    v_mfma_f32_16x16x32_bf16 v[104:107], a[24:27], a[136:139], v[104:107]
    v_mfma_f32_16x16x32_bf16 v[108:111], a[24:27], a[140:143], v[108:111]
    v_mfma_f32_16x16x32_bf16 v[124:127], a[28:31], a[140:143], v[124:127]
    ds_read_b64_tr_b16 a[16:17], v235 offset:36864
    v_mfma_f32_16x16x32_bf16 v[120:123], a[28:31], a[136:139], v[120:123]
    buffer_load_dwordx4 a[76:79], v252, s[28:31], s52 offen offset:3072 sc1
    v_mfma_f32_16x16x32_bf16 v[116:119], a[28:31], a[132:135], v[116:119]
    ds_read_b64_tr_b16 a[18:19], v235 offset:43008
    v_mfma_f32_16x16x32_bf16 v[112:115], a[28:31], a[128:131], v[112:115]
    s_waitcnt lgkmcnt(6)
    v_mfma_f32_16x16x32_bf16 v[128:131], a[0:3], a[128:131], v[128:131]
    ds_read_b64_tr_b16 a[20:21], v236 offset:36864
    s_add_u32 m0, s55, 28672
    v_mfma_f32_16x16x32_bf16 v[132:135], a[0:3], a[132:135], v[132:135]
    buffer_load_dwordx4 v227, s[32:35], s68 offen offset:0 lds
    s_add_u32 s68, s68, s59
    v_mfma_f32_16x16x32_bf16 v[136:139], a[0:3], a[136:139], v[136:139]
    ds_read_b64_tr_b16 a[22:23], v236 offset:43008
    v_mfma_f32_16x16x32_bf16 v[140:143], a[0:3], a[140:143], v[140:143]
    v_mfma_f32_16x16x32_bf16 v[156:159], a[4:7], a[140:143], v[156:159]
    ds_read_b64_tr_b16 a[24:25], v237 offset:36864
    v_mfma_f32_16x16x32_bf16 v[152:155], a[4:7], a[136:139], v[152:155]
    ds_read_b64_tr_b16 a[26:27], v237 offset:43008
    v_mfma_f32_16x16x32_bf16 v[148:151], a[4:7], a[132:135], v[148:151]
    v_mfma_f32_16x16x32_bf16 v[144:147], a[4:7], a[128:131], v[144:147]
    s_waitcnt lgkmcnt(6)
    v_mfma_f32_16x16x32_bf16 v[160:163], a[8:11], a[128:131], v[160:163]
    ds_read_b64_tr_b16 a[28:29], v238 offset:36864
    v_mfma_f32_16x16x32_bf16 v[164:167], a[8:11], a[132:135], v[164:167]
    buffer_load_dwordx4 a[80:83], v224, s[28:31], s53 offen offset:0 sc1
    v_mfma_f32_16x16x32_bf16 v[168:171], a[8:11], a[136:139], v[168:171]
    ds_read_b64_tr_b16 a[30:31], v238 offset:43008
    v_mfma_f32_16x16x32_bf16 v[172:175], a[8:11], a[140:143], v[172:175]
    v_mfma_f32_16x16x32_bf16 v[188:191], a[12:15], a[140:143], v[188:191]
    ds_read_b64_tr_b16 a[0:1], v235 offset:38912
    v_mfma_f32_16x16x32_bf16 v[184:187], a[12:15], a[136:139], v[184:187]
    ds_read_b64_tr_b16 a[2:3], v235 offset:45056
    v_mfma_f32_16x16x32_bf16 v[180:183], a[12:15], a[132:135], v[180:183]
    v_mfma_f32_16x16x32_bf16 v[176:179], a[12:15], a[128:131], v[176:179]
    s_waitcnt lgkmcnt(6)
    v_mfma_f32_16x16x32_bf16 v[0:3], a[16:19], a[144:147], v[0:3]
    ds_read_b64_tr_b16 a[4:5], v236 offset:38912
    v_mfma_f32_16x16x32_bf16 v[4:7], a[16:19], a[148:151], v[4:7]
    buffer_load_dwordx4 v227, s[32:35], s69 offen offset:1024 lds
    s_add_u32 s69, s69, s59
    v_mfma_f32_16x16x32_bf16 v[8:11], a[16:19], a[152:155], v[8:11]
    ds_read_b64_tr_b16 a[6:7], v236 offset:45056
    v_mfma_f32_16x16x32_bf16 v[12:15], a[16:19], a[156:159], v[12:15]
    v_mfma_f32_16x16x32_bf16 v[28:31], a[20:23], a[156:159], v[28:31]
    ds_read_b64_tr_b16 a[8:9], v237 offset:38912
    v_mfma_f32_16x16x32_bf16 v[24:27], a[20:23], a[152:155], v[24:27]
    buffer_load_dwordx4 a[84:87], v250, s[28:31], s53 offen offset:1024 sc1
    v_mfma_f32_16x16x32_bf16 v[20:23], a[20:23], a[148:151], v[20:23]
    ds_read_b64_tr_b16 a[10:11], v237 offset:45056
    v_mfma_f32_16x16x32_bf16 v[16:19], a[20:23], a[144:147], v[16:19]
    s_waitcnt lgkmcnt(6)
    v_mfma_f32_16x16x32_bf16 v[32:35], a[24:27], a[144:147], v[32:35]
    ds_read_b64_tr_b16 a[12:13], v238 offset:38912
    v_mfma_f32_16x16x32_bf16 v[36:39], a[24:27], a[148:151], v[36:39]
    ds_read_b64_tr_b16 a[14:15], v238 offset:45056
    v_mfma_f32_16x16x32_bf16 v[40:43], a[24:27], a[152:155], v[40:43]
    v_mfma_f32_16x16x32_bf16 v[44:47], a[24:27], a[156:159], v[44:47]
    v_mfma_f32_16x16x32_bf16 v[60:63], a[28:31], a[156:159], v[60:63]
    ds_read_b64_tr_b16 a[16:17], v235 offset:40960
    v_mfma_f32_16x16x32_bf16 v[56:59], a[28:31], a[152:155], v[56:59]
    buffer_load_dwordx4 a[88:91], v251, s[28:31], s53 offen offset:2048 sc1
    v_mfma_f32_16x16x32_bf16 v[52:55], a[28:31], a[148:151], v[52:55]
    ds_read_b64_tr_b16 a[18:19], v235 offset:47104
    v_mfma_f32_16x16x32_bf16 v[48:51], a[28:31], a[144:147], v[48:51]
    s_waitcnt lgkmcnt(6)
    v_mfma_f32_16x16x32_bf16 v[64:67], a[0:3], a[144:147], v[64:67]
    ds_read_b64_tr_b16 a[20:21], v236 offset:40960
    v_mfma_f32_16x16x32_bf16 v[68:71], a[0:3], a[148:151], v[68:71]
    ds_read_b64_tr_b16 a[22:23], v236 offset:47104
    v_mfma_f32_16x16x32_bf16 v[72:75], a[0:3], a[152:155], v[72:75]
    v_mfma_f32_16x16x32_bf16 v[76:79], a[0:3], a[156:159], v[76:79]
    v_mfma_f32_16x16x32_bf16 v[92:95], a[4:7], a[156:159], v[92:95]
    ds_read_b64_tr_b16 a[24:25], v237 offset:40960
    v_mfma_f32_16x16x32_bf16 v[88:91], a[4:7], a[152:155], v[88:91]
    buffer_load_dwordx4 a[92:95], v252, s[28:31], s53 offen offset:3072 sc1
    v_mfma_f32_16x16x32_bf16 v[84:87], a[4:7], a[148:151], v[84:87]
    ds_read_b64_tr_b16 a[26:27], v237 offset:47104
    v_mfma_f32_16x16x32_bf16 v[80:83], a[4:7], a[144:147], v[80:83]
    s_waitcnt lgkmcnt(6)
    v_mfma_f32_16x16x32_bf16 v[96:99], a[8:11], a[144:147], v[96:99]
    ds_read_b64_tr_b16 a[28:29], v238 offset:40960
    v_mfma_f32_16x16x32_bf16 v[100:103], a[8:11], a[148:151], v[100:103]
    ds_read_b64_tr_b16 a[30:31], v238 offset:47104
    v_mfma_f32_16x16x32_bf16 v[104:107], a[8:11], a[152:155], v[104:107]
    v_mfma_f32_16x16x32_bf16 v[108:111], a[8:11], a[156:159], v[108:111]
    s_waitcnt vmcnt(28)
    s_barrier
    v_mfma_f32_16x16x32_bf16 v[124:127], a[12:15], a[156:159], v[124:127]
    ds_read_b64_tr_b16 a[0:1], v241 offset:0
    s_add_u32 s52, s52, s58
    s_add_u32 s53, s53, s58
    v_mfma_f32_16x16x32_bf16 v[120:123], a[12:15], a[152:155], v[120:123]
    ds_read_b64_tr_b16 a[2:3], v241 offset:6144
    s_add_u32 s56, s56, 1
    s_cmp_eq_u32 s56, 18
    v_mfma_f32_16x16x32_bf16 v[116:119], a[12:15], a[148:151], v[116:119]
    s_cselect_b32 s55, 163840, s55
    s_cselect_b32 s34, 0, s34
    v_mfma_f32_16x16x32_bf16 v[112:115], a[12:15], a[144:147], v[112:115]
    s_cselect_b32 s42, 0, s42
    s_add_u32 m0, s55, 49152
    s_nop 0
    buffer_load_dwordx4 v227, s[32:35], s64 offen offset:0 lds
    s_waitcnt lgkmcnt(6)
    v_mfma_f32_16x16x32_bf16 v[128:131], a[16:19], a[144:147], v[128:131]
    ds_read_b64_tr_b16 a[4:5], v242 offset:0
    s_add_u32 s64, s64, s59
    v_mfma_f32_16x16x32_bf16 v[132:135], a[16:19], a[148:151], v[132:135]
    buffer_load_dwordx4 a[96:99], v224, s[28:31], s52 offen offset:0 sc1
    v_mfma_f32_16x16x32_bf16 v[136:139], a[16:19], a[152:155], v[136:139]
    ds_read_b64_tr_b16 a[6:7], v242 offset:6144
    v_mfma_f32_16x16x32_bf16 v[140:143], a[16:19], a[156:159], v[140:143]
    v_mfma_f32_16x16x32_bf16 v[156:159], a[20:23], a[156:159], v[156:159]
    ds_read_b64_tr_b16 a[8:9], v243 offset:0
    v_mfma_f32_16x16x32_bf16 v[152:155], a[20:23], a[152:155], v[152:155]
    ds_read_b64_tr_b16 a[10:11], v243 offset:6144
    v_mfma_f32_16x16x32_bf16 v[148:151], a[20:23], a[148:151], v[148:151]
    v_mfma_f32_16x16x32_bf16 v[144:147], a[20:23], a[144:147], v[144:147]
    s_waitcnt lgkmcnt(6)
    v_mfma_f32_16x16x32_bf16 v[160:163], a[24:27], a[144:147], v[160:163]
    ds_read_b64_tr_b16 a[12:13], v244 offset:0
    v_mfma_f32_16x16x32_bf16 v[164:167], a[24:27], a[148:151], v[164:167]
    buffer_load_dwordx4 v227, s[32:35], s65 offen offset:1024 lds
    s_add_u32 s65, s65, s59
    v_mfma_f32_16x16x32_bf16 v[168:171], a[24:27], a[152:155], v[168:171]
    ds_read_b64_tr_b16 a[14:15], v244 offset:6144
    v_mfma_f32_16x16x32_bf16 v[172:175], a[24:27], a[156:159], v[172:175]
    v_mfma_f32_16x16x32_bf16 v[188:191], a[28:31], a[156:159], v[188:191]
    ds_read_b64_tr_b16 a[16:17], v241 offset:2048
    v_mfma_f32_16x16x32_bf16 v[184:187], a[28:31], a[152:155], v[184:187]
    ds_read_b64_tr_b16 a[18:19], v241 offset:8192
    v_mfma_f32_16x16x32_bf16 v[180:183], a[28:31], a[148:151], v[180:183]
    v_mfma_f32_16x16x32_bf16 v[176:179], a[28:31], a[144:147], v[176:179]
L_entry_35:
    s_waitcnt lgkmcnt(6)
    v_mfma_f32_16x16x32_bf16 v[0:3], a[0:3], a[160:163], v[0:3]
    ds_read_b64_tr_b16 a[20:21], v242 offset:2048
    v_mfma_f32_16x16x32_bf16 v[4:7], a[0:3], a[164:167], v[4:7]
    buffer_load_dwordx4 a[100:103], v250, s[28:31], s52 offen offset:1024 sc1
    v_mfma_f32_16x16x32_bf16 v[8:11], a[0:3], a[168:171], v[8:11]
    ds_read_b64_tr_b16 a[22:23], v242 offset:8192
    v_mfma_f32_16x16x32_bf16 v[12:15], a[0:3], a[172:175], v[12:15]
    v_mfma_f32_16x16x32_bf16 v[28:31], a[4:7], a[172:175], v[28:31]
    ds_read_b64_tr_b16 a[24:25], v243 offset:2048
    v_mfma_f32_16x16x32_bf16 v[24:27], a[4:7], a[168:171], v[24:27]
    buffer_load_dwordx4 v227, s[32:35], s66 offen offset:2048 lds
    s_add_u32 s66, s66, s59
    v_mfma_f32_16x16x32_bf16 v[20:23], a[4:7], a[164:167], v[20:23]
    ds_read_b64_tr_b16 a[26:27], v243 offset:8192
    v_mfma_f32_16x16x32_bf16 v[16:19], a[4:7], a[160:163], v[16:19]
    s_waitcnt lgkmcnt(6)
    v_mfma_f32_16x16x32_bf16 v[32:35], a[8:11], a[160:163], v[32:35]
    ds_read_b64_tr_b16 a[28:29], v244 offset:2048
    v_mfma_f32_16x16x32_bf16 v[36:39], a[8:11], a[164:167], v[36:39]
    ds_read_b64_tr_b16 a[30:31], v244 offset:8192
    v_mfma_f32_16x16x32_bf16 v[40:43], a[8:11], a[168:171], v[40:43]
    v_mfma_f32_16x16x32_bf16 v[44:47], a[8:11], a[172:175], v[44:47]
    v_mfma_f32_16x16x32_bf16 v[60:63], a[12:15], a[172:175], v[60:63]
    ds_read_b64_tr_b16 a[0:1], v241 offset:4096
    v_mfma_f32_16x16x32_bf16 v[56:59], a[12:15], a[168:171], v[56:59]
    buffer_load_dwordx4 a[104:107], v251, s[28:31], s52 offen offset:2048 sc1
    v_mfma_f32_16x16x32_bf16 v[52:55], a[12:15], a[164:167], v[52:55]
    ds_read_b64_tr_b16 a[2:3], v241 offset:10240
    v_mfma_f32_16x16x32_bf16 v[48:51], a[12:15], a[160:163], v[48:51]
    s_waitcnt lgkmcnt(6)
    v_mfma_f32_16x16x32_bf16 v[64:67], a[16:19], a[160:163], v[64:67]
    ds_read_b64_tr_b16 a[4:5], v242 offset:4096
    v_mfma_f32_16x16x32_bf16 v[68:71], a[16:19], a[164:167], v[68:71]
    ds_read_b64_tr_b16 a[6:7], v242 offset:10240
    v_mfma_f32_16x16x32_bf16 v[72:75], a[16:19], a[168:171], v[72:75]
    v_mfma_f32_16x16x32_bf16 v[76:79], a[16:19], a[172:175], v[76:79]
    v_mfma_f32_16x16x32_bf16 v[92:95], a[20:23], a[172:175], v[92:95]
    ds_read_b64_tr_b16 a[8:9], v243 offset:4096
    v_mfma_f32_16x16x32_bf16 v[88:91], a[20:23], a[168:171], v[88:91]
    buffer_load_dwordx4 v227, s[32:35], s67 offen offset:3072 lds
    s_add_u32 s67, s67, s59
    v_mfma_f32_16x16x32_bf16 v[84:87], a[20:23], a[164:167], v[84:87]
    ds_read_b64_tr_b16 a[10:11], v243 offset:10240
    v_mfma_f32_16x16x32_bf16 v[80:83], a[20:23], a[160:163], v[80:83]
    s_waitcnt lgkmcnt(6)
    v_mfma_f32_16x16x32_bf16 v[96:99], a[24:27], a[160:163], v[96:99]
    ds_read_b64_tr_b16 a[12:13], v244 offset:4096
    v_mfma_f32_16x16x32_bf16 v[100:103], a[24:27], a[164:167], v[100:103]
    ds_read_b64_tr_b16 a[14:15], v244 offset:10240
    v_mfma_f32_16x16x32_bf16 v[104:107], a[24:27], a[168:171], v[104:107]
    v_mfma_f32_16x16x32_bf16 v[108:111], a[24:27], a[172:175], v[108:111]
    v_mfma_f32_16x16x32_bf16 v[124:127], a[28:31], a[172:175], v[124:127]
    ds_read_b64_tr_b16 a[16:17], v241 offset:12288
    v_mfma_f32_16x16x32_bf16 v[120:123], a[28:31], a[168:171], v[120:123]
    buffer_load_dwordx4 a[108:111], v252, s[28:31], s52 offen offset:3072 sc1
    v_mfma_f32_16x16x32_bf16 v[116:119], a[28:31], a[164:167], v[116:119]
    ds_read_b64_tr_b16 a[18:19], v241 offset:18432
    v_mfma_f32_16x16x32_bf16 v[112:115], a[28:31], a[160:163], v[112:115]
    s_waitcnt lgkmcnt(6)
    v_mfma_f32_16x16x32_bf16 v[128:131], a[0:3], a[160:163], v[128:131]
    ds_read_b64_tr_b16 a[20:21], v242 offset:12288
    s_add_u32 m0, s55, 53248
    v_mfma_f32_16x16x32_bf16 v[132:135], a[0:3], a[164:167], v[132:135]
    buffer_load_dwordx4 v227, s[32:35], s68 offen offset:0 lds
    s_add_u32 s68, s68, s59
    v_mfma_f32_16x16x32_bf16 v[136:139], a[0:3], a[168:171], v[136:139]
    ds_read_b64_tr_b16 a[22:23], v242 offset:18432
    v_mfma_f32_16x16x32_bf16 v[140:143], a[0:3], a[172:175], v[140:143]
    v_mfma_f32_16x16x32_bf16 v[156:159], a[4:7], a[172:175], v[156:159]
    ds_read_b64_tr_b16 a[24:25], v243 offset:12288
    v_mfma_f32_16x16x32_bf16 v[152:155], a[4:7], a[168:171], v[152:155]
    ds_read_b64_tr_b16 a[26:27], v243 offset:18432
    v_mfma_f32_16x16x32_bf16 v[148:151], a[4:7], a[164:167], v[148:151]
    v_mfma_f32_16x16x32_bf16 v[144:147], a[4:7], a[160:163], v[144:147]
    s_waitcnt lgkmcnt(6)
    v_mfma_f32_16x16x32_bf16 v[160:163], a[8:11], a[160:163], v[160:163]
    ds_read_b64_tr_b16 a[28:29], v244 offset:12288
    v_mfma_f32_16x16x32_bf16 v[164:167], a[8:11], a[164:167], v[164:167]
    buffer_load_dwordx4 a[112:115], v224, s[28:31], s53 offen offset:0 sc1
    v_mfma_f32_16x16x32_bf16 v[168:171], a[8:11], a[168:171], v[168:171]
    ds_read_b64_tr_b16 a[30:31], v244 offset:18432
    v_mfma_f32_16x16x32_bf16 v[172:175], a[8:11], a[172:175], v[172:175]
    v_mfma_f32_16x16x32_bf16 v[188:191], a[12:15], a[172:175], v[188:191]
    ds_read_b64_tr_b16 a[0:1], v241 offset:14336
    v_mfma_f32_16x16x32_bf16 v[184:187], a[12:15], a[168:171], v[184:187]
    ds_read_b64_tr_b16 a[2:3], v241 offset:20480
    v_mfma_f32_16x16x32_bf16 v[180:183], a[12:15], a[164:167], v[180:183]
    v_mfma_f32_16x16x32_bf16 v[176:179], a[12:15], a[160:163], v[176:179]
    s_waitcnt lgkmcnt(6)
    v_mfma_f32_16x16x32_bf16 v[0:3], a[16:19], a[176:179], v[0:3]
    ds_read_b64_tr_b16 a[4:5], v242 offset:14336
    v_mfma_f32_16x16x32_bf16 v[4:7], a[16:19], a[180:183], v[4:7]
    buffer_load_dwordx4 v227, s[32:35], s69 offen offset:1024 lds
    s_add_u32 s69, s69, s59
    v_mfma_f32_16x16x32_bf16 v[8:11], a[16:19], a[184:187], v[8:11]
    ds_read_b64_tr_b16 a[6:7], v242 offset:20480
    v_mfma_f32_16x16x32_bf16 v[12:15], a[16:19], a[188:191], v[12:15]
    v_mfma_f32_16x16x32_bf16 v[28:31], a[20:23], a[188:191], v[28:31]
    ds_read_b64_tr_b16 a[8:9], v243 offset:14336
    v_mfma_f32_16x16x32_bf16 v[24:27], a[20:23], a[184:187], v[24:27]
    buffer_load_dwordx4 a[116:119], v250, s[28:31], s53 offen offset:1024 sc1
    v_mfma_f32_16x16x32_bf16 v[20:23], a[20:23], a[180:183], v[20:23]
    ds_read_b64_tr_b16 a[10:11], v243 offset:20480
    v_mfma_f32_16x16x32_bf16 v[16:19], a[20:23], a[176:179], v[16:19]
    s_waitcnt lgkmcnt(6)
    v_mfma_f32_16x16x32_bf16 v[32:35], a[24:27], a[176:179], v[32:35]
    ds_read_b64_tr_b16 a[12:13], v244 offset:14336
    v_mfma_f32_16x16x32_bf16 v[36:39], a[24:27], a[180:183], v[36:39]
    ds_read_b64_tr_b16 a[14:15], v244 offset:20480
    v_mfma_f32_16x16x32_bf16 v[40:43], a[24:27], a[184:187], v[40:43]
    v_mfma_f32_16x16x32_bf16 v[44:47], a[24:27], a[188:191], v[44:47]
    v_mfma_f32_16x16x32_bf16 v[60:63], a[28:31], a[188:191], v[60:63]
    ds_read_b64_tr_b16 a[16:17], v241 offset:16384
    v_mfma_f32_16x16x32_bf16 v[56:59], a[28:31], a[184:187], v[56:59]
    buffer_load_dwordx4 a[120:123], v251, s[28:31], s53 offen offset:2048 sc1
    v_mfma_f32_16x16x32_bf16 v[52:55], a[28:31], a[180:183], v[52:55]
    ds_read_b64_tr_b16 a[18:19], v241 offset:22528
    v_mfma_f32_16x16x32_bf16 v[48:51], a[28:31], a[176:179], v[48:51]
    s_waitcnt lgkmcnt(6)
    v_mfma_f32_16x16x32_bf16 v[64:67], a[0:3], a[176:179], v[64:67]
    ds_read_b64_tr_b16 a[20:21], v242 offset:16384
    v_mfma_f32_16x16x32_bf16 v[68:71], a[0:3], a[180:183], v[68:71]
    ds_read_b64_tr_b16 a[22:23], v242 offset:22528
    v_mfma_f32_16x16x32_bf16 v[72:75], a[0:3], a[184:187], v[72:75]
    v_mfma_f32_16x16x32_bf16 v[76:79], a[0:3], a[188:191], v[76:79]
    v_mfma_f32_16x16x32_bf16 v[92:95], a[4:7], a[188:191], v[92:95]
    ds_read_b64_tr_b16 a[24:25], v243 offset:16384
    v_mfma_f32_16x16x32_bf16 v[88:91], a[4:7], a[184:187], v[88:91]
    buffer_load_dwordx4 a[124:127], v252, s[28:31], s53 offen offset:3072 sc1
    v_mfma_f32_16x16x32_bf16 v[84:87], a[4:7], a[180:183], v[84:87]
    ds_read_b64_tr_b16 a[26:27], v243 offset:22528
    v_mfma_f32_16x16x32_bf16 v[80:83], a[4:7], a[176:179], v[80:83]
    s_waitcnt lgkmcnt(6)
    v_mfma_f32_16x16x32_bf16 v[96:99], a[8:11], a[176:179], v[96:99]
    ds_read_b64_tr_b16 a[28:29], v244 offset:16384
    v_mfma_f32_16x16x32_bf16 v[100:103], a[8:11], a[180:183], v[100:103]
    ds_read_b64_tr_b16 a[30:31], v244 offset:22528
    v_mfma_f32_16x16x32_bf16 v[104:107], a[8:11], a[184:187], v[104:107]
    v_mfma_f32_16x16x32_bf16 v[108:111], a[8:11], a[188:191], v[108:111]
    s_waitcnt vmcnt(28)
    s_barrier
    v_mfma_f32_16x16x32_bf16 v[124:127], a[12:15], a[188:191], v[124:127]
    ds_read_b64_tr_b16 a[0:1], v229 offset:0
    s_add_u32 s52, s52, s58
    s_add_u32 s53, s53, s58
    v_mfma_f32_16x16x32_bf16 v[120:123], a[12:15], a[184:187], v[120:123]
    s_add_u32 s56, s56, 1
    s_add_u32 m0, s55, 73728
    s_nop 0
    buffer_load_dwordx4 v227, s[32:35], s64 offen offset:0 lds
    v_mfma_f32_16x16x32_bf16 v[116:119], a[12:15], a[180:183], v[116:119]
    ds_read_b64_tr_b16 a[2:3], v229 offset:6144
    s_add_u32 s64, s64, s59
    v_mfma_f32_16x16x32_bf16 v[112:115], a[12:15], a[176:179], v[112:115]
    s_waitcnt lgkmcnt(6)
    v_mfma_f32_16x16x32_bf16 v[128:131], a[16:19], a[176:179], v[128:131]
    ds_read_b64_tr_b16 a[4:5], v230 offset:0
    v_mfma_f32_16x16x32_bf16 v[132:135], a[16:19], a[180:183], v[132:135]
    buffer_load_dwordx4 a[128:131], v224, s[28:31], s52 offen offset:0 sc1
    v_mfma_f32_16x16x32_bf16 v[136:139], a[16:19], a[184:187], v[136:139]
    ds_read_b64_tr_b16 a[6:7], v230 offset:6144
    v_mfma_f32_16x16x32_bf16 v[140:143], a[16:19], a[188:191], v[140:143]
    v_mfma_f32_16x16x32_bf16 v[156:159], a[20:23], a[188:191], v[156:159]
    ds_read_b64_tr_b16 a[8:9], v231 offset:0
    v_mfma_f32_16x16x32_bf16 v[152:155], a[20:23], a[184:187], v[152:155]
    ds_read_b64_tr_b16 a[10:11], v231 offset:6144
    v_mfma_f32_16x16x32_bf16 v[148:151], a[20:23], a[180:183], v[148:151]
    v_mfma_f32_16x16x32_bf16 v[144:147], a[20:23], a[176:179], v[144:147]
    s_waitcnt lgkmcnt(6)
    v_mfma_f32_16x16x32_bf16 v[160:163], a[24:27], a[176:179], v[160:163]
    ds_read_b64_tr_b16 a[12:13], v232 offset:0
    v_mfma_f32_16x16x32_bf16 v[164:167], a[24:27], a[180:183], v[164:167]
    buffer_load_dwordx4 v227, s[32:35], s65 offen offset:1024 lds
    s_add_u32 s65, s65, s59
    v_mfma_f32_16x16x32_bf16 v[168:171], a[24:27], a[184:187], v[168:171]
    ds_read_b64_tr_b16 a[14:15], v232 offset:6144
    v_mfma_f32_16x16x32_bf16 v[172:175], a[24:27], a[188:191], v[172:175]
    v_mfma_f32_16x16x32_bf16 v[188:191], a[28:31], a[188:191], v[188:191]
    ds_read_b64_tr_b16 a[16:17], v229 offset:2048
    v_mfma_f32_16x16x32_bf16 v[184:187], a[28:31], a[184:187], v[184:187]
    ds_read_b64_tr_b16 a[18:19], v229 offset:8192
    v_mfma_f32_16x16x32_bf16 v[180:183], a[28:31], a[180:183], v[180:183]
    v_mfma_f32_16x16x32_bf16 v[176:179], a[28:31], a[176:179], v[176:179]
    s_sub_u32 s57, s57, 1
    s_cmp_lg_u32 s57, 0
    s_cbranch_scc1 L_loop_34
L_epi_C:
    s_mov_b64 s[32:33], s[14:15]
    s_lshl_b32 s34, s62, 23
    s_mov_b32 s42, 0x200000
    buffer_load_dword a240, v253, s[32:35], s11 offen
    v_mov_b32 v247, v224
    v_accvgpr_read_b32 v250, a248
    v_accvgpr_read_b32 v251, a249
    v_accvgpr_read_b32 v252, a250
    v_accvgpr_read_b32 v253, a251
    s_lshl_b32 s55, s3, 10
    s_mov_b32 s54, 786432
    s_mov_b32 s36, s24
    s_mov_b32 s37, s25
    s_mov_b32 s38, 0x2000000
    s_mov_b32 s39, 0x20000
    v_mbcnt_lo_u32_b32 v248, -1, 0
    v_mbcnt_hi_u32_b32 v248, -1, v248
    s_waitcnt lgkmcnt(0)
    s_barrier
    v_mov_b32 v238, 0xbdd2d3e8
    v_mov_b32 v239, 0xc0135761
    v_lshlrev_b32 v224, 4, v248
    v_mov_b32 v244, s26
    s_mov_b32 s52, s16
    v_accvgpr_read_b32 v225, a252
    v_accvgpr_read_b32 v226, a253
    v_accvgpr_read_b32 v240, a254
    v_add_u32 v227, 0x10000, v225
    v_add_u32 v228, 0x10000, v226
    s_sub_u32 s10, s6, 8192
    s_sub_u32 s11, s7, 8192
    v_pk_mul_f32 v[230:231], v[0:1], v[0:1]
    v_pk_mul_f32 v[232:233], v[2:3], v[2:3]
    v_pk_mul_f32 v[234:235], v[16:17], v[16:17]
    v_pk_mul_f32 v[236:237], v[18:19], v[18:19]
    v_pk_fma_f32 v[230:231], v[230:231], v[238:239], v[238:239] op_sel:[0,0,1] op_sel_hi:[1,0,1]
    v_pk_fma_f32 v[232:233], v[232:233], v[238:239], v[238:239] op_sel:[0,0,1] op_sel_hi:[1,0,1]
    v_pk_fma_f32 v[234:235], v[234:235], v[238:239], v[238:239] op_sel:[0,0,1] op_sel_hi:[1,0,1]
    v_pk_fma_f32 v[236:237], v[236:237], v[238:239], v[238:239] op_sel:[0,0,1] op_sel_hi:[1,0,1]
    v_pk_mul_f32 v[230:231], v[230:231], v[0:1]
    v_pk_mul_f32 v[232:233], v[232:233], v[2:3]
    v_pk_mul_f32 v[234:235], v[234:235], v[16:17]
    v_pk_mul_f32 v[236:237], v[236:237], v[18:19]
    v_exp_f32 v230, v230
    v_exp_f32 v231, v231
    v_exp_f32 v232, v232
    v_exp_f32 v233, v233
    v_exp_f32 v234, v234
    v_exp_f32 v235, v235
    v_exp_f32 v236, v236
    v_exp_f32 v237, v237
    v_pk_add_f32 v[230:231], v[230:231], 1.0 op_sel_hi:[1,0]
    v_pk_add_f32 v[232:233], v[232:233], 1.0 op_sel_hi:[1,0]
    v_pk_add_f32 v[234:235], v[234:235], 1.0 op_sel_hi:[1,0]
    v_pk_add_f32 v[236:237], v[236:237], 1.0 op_sel_hi:[1,0]
    v_rcp_f32 v230, v230
    v_rcp_f32 v231, v231
    v_rcp_f32 v232, v232
    v_rcp_f32 v233, v233
    v_rcp_f32 v234, v234
    v_rcp_f32 v235, v235
    v_rcp_f32 v236, v236
    v_rcp_f32 v237, v237
    v_pk_mul_f32 v[0:1], v[0:1], v[230:231]
    v_pk_mul_f32 v[2:3], v[2:3], v[232:233]
    v_pk_mul_f32 v[16:17], v[16:17], v[234:235]
    v_pk_mul_f32 v[18:19], v[18:19], v[236:237]
    v_cvt_pk_bf16_f32 v0, v0, v1
    v_cvt_pk_bf16_f32 v1, v2, v3
    s_branch L_po_C_4
.p2align 12
L_pg_C_4:
    s_branch L_pg_K_1
L_po_C_4:
    v_cvt_pk_bf16_f32 v2, v16, v17
    v_cvt_pk_bf16_f32 v3, v18, v19
    buffer_store_dwordx4 v[0:3], v224, s[36:39], s10 offen offset:0 sc1
    v_pk_mul_f32 v[230:231], v[4:5], v[4:5]
    v_pk_mul_f32 v[232:233], v[6:7], v[6:7]
    v_pk_mul_f32 v[234:235], v[20:21], v[20:21]
    v_pk_mul_f32 v[236:237], v[22:23], v[22:23]
    v_pk_fma_f32 v[230:231], v[230:231], v[238:239], v[238:239] op_sel:[0,0,1] op_sel_hi:[1,0,1]
    v_pk_fma_f32 v[232:233], v[232:233], v[238:239], v[238:239] op_sel:[0,0,1] op_sel_hi:[1,0,1]
    v_pk_fma_f32 v[234:235], v[234:235], v[238:239], v[238:239] op_sel:[0,0,1] op_sel_hi:[1,0,1]
    v_pk_fma_f32 v[236:237], v[236:237], v[238:239], v[238:239] op_sel:[0,0,1] op_sel_hi:[1,0,1]
    v_pk_mul_f32 v[230:231], v[230:231], v[4:5]
    v_pk_mul_f32 v[232:233], v[232:233], v[6:7]
    v_pk_mul_f32 v[234:235], v[234:235], v[20:21]
    v_pk_mul_f32 v[236:237], v[236:237], v[22:23]
    v_exp_f32 v230, v230
    v_exp_f32 v231, v231
    v_exp_f32 v232, v232
    v_exp_f32 v233, v233
    v_exp_f32 v234, v234
    v_exp_f32 v235, v235
    v_exp_f32 v236, v236
    v_exp_f32 v237, v237
    v_pk_add_f32 v[230:231], v[230:231], 1.0 op_sel_hi:[1,0]
    v_pk_add_f32 v[232:233], v[232:233], 1.0 op_sel_hi:[1,0]
    v_pk_add_f32 v[234:235], v[234:235], 1.0 op_sel_hi:[1,0]
    v_pk_add_f32 v[236:237], v[236:237], 1.0 op_sel_hi:[1,0]
    v_rcp_f32 v230, v230
    v_rcp_f32 v231, v231
    v_rcp_f32 v232, v232
    v_rcp_f32 v233, v233
    v_rcp_f32 v234, v234
    v_rcp_f32 v235, v235
    v_rcp_f32 v236, v236
    v_rcp_f32 v237, v237
    v_pk_mul_f32 v[4:5], v[4:5], v[230:231]
    v_pk_mul_f32 v[6:7], v[6:7], v[232:233]
    v_pk_mul_f32 v[20:21], v[20:21], v[234:235]
    v_pk_mul_f32 v[22:23], v[22:23], v[236:237]
    v_cvt_pk_bf16_f32 v4, v4, v5
    v_cvt_pk_bf16_f32 v5, v6, v7
    v_cvt_pk_bf16_f32 v6, v20, v21
    v_cvt_pk_bf16_f32 v7, v22, v23
    buffer_store_dwordx4 v[4:7], v224, s[36:39], s10 offen offset:1024 sc1
    v_pk_mul_f32 v[230:231], v[8:9], v[8:9]
    v_pk_mul_f32 v[232:233], v[10:11], v[10:11]
    v_pk_mul_f32 v[234:235], v[24:25], v[24:25]
    v_pk_mul_f32 v[236:237], v[26:27], v[26:27]
    v_pk_fma_f32 v[230:231], v[230:231], v[238:239], v[238:239] op_sel:[0,0,1] op_sel_hi:[1,0,1]
    v_pk_fma_f32 v[232:233], v[232:233], v[238:239], v[238:239] op_sel:[0,0,1] op_sel_hi:[1,0,1]
    v_pk_fma_f32 v[234:235], v[234:235], v[238:239], v[238:239] op_sel:[0,0,1] op_sel_hi:[1,0,1]
    v_pk_fma_f32 v[236:237], v[236:237], v[238:239], v[238:239] op_sel:[0,0,1] op_sel_hi:[1,0,1]
    v_pk_mul_f32 v[230:231], v[230:231], v[8:9]
    v_pk_mul_f32 v[232:233], v[232:233], v[10:11]
    v_pk_mul_f32 v[234:235], v[234:235], v[24:25]
    v_pk_mul_f32 v[236:237], v[236:237], v[26:27]
    v_exp_f32 v230, v230
    v_exp_f32 v231, v231
    v_exp_f32 v232, v232
    v_exp_f32 v233, v233
    v_exp_f32 v234, v234
    v_exp_f32 v235, v235
    v_exp_f32 v236, v236
    v_exp_f32 v237, v237
    v_pk_add_f32 v[230:231], v[230:231], 1.0 op_sel_hi:[1,0]
    v_pk_add_f32 v[232:233], v[232:233], 1.0 op_sel_hi:[1,0]
    v_pk_add_f32 v[234:235], v[234:235], 1.0 op_sel_hi:[1,0]
    v_pk_add_f32 v[236:237], v[236:237], 1.0 op_sel_hi:[1,0]
    v_rcp_f32 v230, v230
    v_rcp_f32 v231, v231
    v_rcp_f32 v232, v232
    v_rcp_f32 v233, v233
    v_rcp_f32 v234, v234
    v_rcp_f32 v235, v235
    v_rcp_f32 v236, v236
    v_rcp_f32 v237, v237
    v_pk_mul_f32 v[8:9], v[8:9], v[230:231]
    v_pk_mul_f32 v[10:11], v[10:11], v[232:233]
    v_pk_mul_f32 v[24:25], v[24:25], v[234:235]
    v_pk_mul_f32 v[26:27], v[26:27], v[236:237]
    v_cvt_pk_bf16_f32 v8, v8, v9
    v_cvt_pk_bf16_f32 v9, v10, v11
    v_cvt_pk_bf16_f32 v10, v24, v25
    v_cvt_pk_bf16_f32 v11, v26, v27
    buffer_store_dwordx4 v[8:11], v224, s[36:39], s11 offen offset:0 sc1
    v_pk_mul_f32 v[230:231], v[12:13], v[12:13]
    v_pk_mul_f32 v[232:233], v[14:15], v[14:15]
    v_pk_mul_f32 v[234:235], v[28:29], v[28:29]
    v_pk_mul_f32 v[236:237], v[30:31], v[30:31]
    v_pk_fma_f32 v[230:231], v[230:231], v[238:239], v[238:239] op_sel:[0,0,1] op_sel_hi:[1,0,1]
    v_pk_fma_f32 v[232:233], v[232:233], v[238:239], v[238:239] op_sel:[0,0,1] op_sel_hi:[1,0,1]
    v_pk_fma_f32 v[234:235], v[234:235], v[238:239], v[238:239] op_sel:[0,0,1] op_sel_hi:[1,0,1]
    v_pk_fma_f32 v[236:237], v[236:237], v[238:239], v[238:239] op_sel:[0,0,1] op_sel_hi:[1,0,1]
    v_pk_mul_f32 v[230:231], v[230:231], v[12:13]
    v_pk_mul_f32 v[232:233], v[232:233], v[14:15]
    v_pk_mul_f32 v[234:235], v[234:235], v[28:29]
    v_pk_mul_f32 v[236:237], v[236:237], v[30:31]
    v_exp_f32 v230, v230
    v_exp_f32 v231, v231
    v_exp_f32 v232, v232
    v_exp_f32 v233, v233
    v_exp_f32 v234, v234
    v_exp_f32 v235, v235
    v_exp_f32 v236, v236
    v_exp_f32 v237, v237
    v_pk_add_f32 v[230:231], v[230:231], 1.0 op_sel_hi:[1,0]
    v_pk_add_f32 v[232:233], v[232:233], 1.0 op_sel_hi:[1,0]
    v_pk_add_f32 v[234:235], v[234:235], 1.0 op_sel_hi:[1,0]
    v_pk_add_f32 v[236:237], v[236:237], 1.0 op_sel_hi:[1,0]
    v_rcp_f32 v230, v230
    v_rcp_f32 v231, v231
    v_rcp_f32 v232, v232
    v_rcp_f32 v233, v233
    v_rcp_f32 v234, v234
    v_rcp_f32 v235, v235
    v_rcp_f32 v236, v236
    v_rcp_f32 v237, v237
    v_pk_mul_f32 v[12:13], v[12:13], v[230:231]
    v_pk_mul_f32 v[14:15], v[14:15], v[232:233]
    v_pk_mul_f32 v[28:29], v[28:29], v[234:235]
    v_pk_mul_f32 v[30:31], v[30:31], v[236:237]
    v_cvt_pk_bf16_f32 v12, v12, v13
    v_cvt_pk_bf16_f32 v13, v14, v15
    v_cvt_pk_bf16_f32 v14, v28, v29
    v_cvt_pk_bf16_f32 v15, v30, v31
    buffer_store_dwordx4 v[12:15], v224, s[36:39], s11 offen offset:1024 sc1
    v_pk_mul_f32 v[230:231], v[32:33], v[32:33]
    v_pk_mul_f32 v[232:233], v[34:35], v[34:35]
    v_pk_mul_f32 v[234:235], v[48:49], v[48:49]
    v_pk_mul_f32 v[236:237], v[50:51], v[50:51]
    v_pk_fma_f32 v[230:231], v[230:231], v[238:239], v[238:239] op_sel:[0,0,1] op_sel_hi:[1,0,1]
    v_pk_fma_f32 v[232:233], v[232:233], v[238:239], v[238:239] op_sel:[0,0,1] op_sel_hi:[1,0,1]
    v_pk_fma_f32 v[234:235], v[234:235], v[238:239], v[238:239] op_sel:[0,0,1] op_sel_hi:[1,0,1]
    v_pk_fma_f32 v[236:237], v[236:237], v[238:239], v[238:239] op_sel:[0,0,1] op_sel_hi:[1,0,1]
    v_pk_mul_f32 v[230:231], v[230:231], v[32:33]
    v_pk_mul_f32 v[232:233], v[232:233], v[34:35]
    v_pk_mul_f32 v[234:235], v[234:235], v[48:49]
    v_pk_mul_f32 v[236:237], v[236:237], v[50:51]
    v_exp_f32 v230, v230
    v_exp_f32 v231, v231
    v_exp_f32 v232, v232
    v_exp_f32 v233, v233
    v_exp_f32 v234, v234
    v_exp_f32 v235, v235
    v_exp_f32 v236, v236
    v_exp_f32 v237, v237
    v_pk_add_f32 v[230:231], v[230:231], 1.0 op_sel_hi:[1,0]
    v_pk_add_f32 v[232:233], v[232:233], 1.0 op_sel_hi:[1,0]
    v_pk_add_f32 v[234:235], v[234:235], 1.0 op_sel_hi:[1,0]
    v_pk_add_f32 v[236:237], v[236:237], 1.0 op_sel_hi:[1,0]
    v_rcp_f32 v230, v230
    v_rcp_f32 v231, v231
    v_rcp_f32 v232, v232
    v_rcp_f32 v233, v233
    v_rcp_f32 v234, v234
    v_rcp_f32 v235, v235
    v_rcp_f32 v236, v236
    v_rcp_f32 v237, v237
    v_pk_mul_f32 v[32:33], v[32:33], v[230:231]
    v_pk_mul_f32 v[34:35], v[34:35], v[232:233]
    v_pk_mul_f32 v[48:49], v[48:49], v[234:235]
    v_pk_mul_f32 v[50:51], v[50:51], v[236:237]
    v_cvt_pk_bf16_f32 v32, v32, v33
    v_cvt_pk_bf16_f32 v33, v34, v35
    v_cvt_pk_bf16_f32 v34, v48, v49
    v_cvt_pk_bf16_f32 v35, v50, v51
    buffer_store_dwordx4 v[32:35], v224, s[36:39], s10 offen offset:2048 sc1
    v_pk_mul_f32 v[230:231], v[36:37], v[36:37]
    v_pk_mul_f32 v[232:233], v[38:39], v[38:39]
    v_pk_mul_f32 v[234:235], v[52:53], v[52:53]
    v_pk_mul_f32 v[236:237], v[54:55], v[54:55]
    v_pk_fma_f32 v[230:231], v[230:231], v[238:239], v[238:239] op_sel:[0,0,1] op_sel_hi:[1,0,1]
    v_pk_fma_f32 v[232:233], v[232:233], v[238:239], v[238:239] op_sel:[0,0,1] op_sel_hi:[1,0,1]
    v_pk_fma_f32 v[234:235], v[234:235], v[238:239], v[238:239] op_sel:[0,0,1] op_sel_hi:[1,0,1]
    v_pk_fma_f32 v[236:237], v[236:237], v[238:239], v[238:239] op_sel:[0,0,1] op_sel_hi:[1,0,1]
    v_pk_mul_f32 v[230:231], v[230:231], v[36:37]
    v_pk_mul_f32 v[232:233], v[232:233], v[38:39]
    v_pk_mul_f32 v[234:235], v[234:235], v[52:53]
    v_pk_mul_f32 v[236:237], v[236:237], v[54:55]
    v_exp_f32 v230, v230
    v_exp_f32 v231, v231
    v_exp_f32 v232, v232
    v_exp_f32 v233, v233
    v_exp_f32 v234, v234
    v_exp_f32 v235, v235
    v_exp_f32 v236, v236
    v_exp_f32 v237, v237
    v_pk_add_f32 v[230:231], v[230:231], 1.0 op_sel_hi:[1,0]
    v_pk_add_f32 v[232:233], v[232:233], 1.0 op_sel_hi:[1,0]
    v_pk_add_f32 v[234:235], v[234:235], 1.0 op_sel_hi:[1,0]
    v_pk_add_f32 v[236:237], v[236:237], 1.0 op_sel_hi:[1,0]
    v_rcp_f32 v230, v230
    v_rcp_f32 v231, v231
    v_rcp_f32 v232, v232
    v_rcp_f32 v233, v233
    v_rcp_f32 v234, v234
    v_rcp_f32 v235, v235
    v_rcp_f32 v236, v236
    v_rcp_f32 v237, v237
    v_pk_mul_f32 v[36:37], v[36:37], v[230:231]
    v_pk_mul_f32 v[38:39], v[38:39], v[232:233]
    v_pk_mul_f32 v[52:53], v[52:53], v[234:235]
    v_pk_mul_f32 v[54:55], v[54:55], v[236:237]
    v_cvt_pk_bf16_f32 v36, v36, v37
    v_cvt_pk_bf16_f32 v37, v38, v39
    v_cvt_pk_bf16_f32 v38, v52, v53
    v_cvt_pk_bf16_f32 v39, v54, v55
    buffer_store_dwordx4 v[36:39], v224, s[36:39], s10 offen offset:3072 sc1
    v_pk_mul_f32 v[230:231], v[40:41], v[40:41]
    v_pk_mul_f32 v[232:233], v[42:43], v[42:43]
    v_pk_mul_f32 v[234:235], v[56:57], v[56:57]
    v_pk_mul_f32 v[236:237], v[58:59], v[58:59]
    v_pk_fma_f32 v[230:231], v[230:231], v[238:239], v[238:239] op_sel:[0,0,1] op_sel_hi:[1,0,1]
    v_pk_fma_f32 v[232:233], v[232:233], v[238:239], v[238:239] op_sel:[0,0,1] op_sel_hi:[1,0,1]
    v_pk_fma_f32 v[234:235], v[234:235], v[238:239], v[238:239] op_sel:[0,0,1] op_sel_hi:[1,0,1]
    v_pk_fma_f32 v[236:237], v[236:237], v[238:239], v[238:239] op_sel:[0,0,1] op_sel_hi:[1,0,1]
    v_pk_mul_f32 v[230:231], v[230:231], v[40:41]
    v_pk_mul_f32 v[232:233], v[232:233], v[42:43]
    v_pk_mul_f32 v[234:235], v[234:235], v[56:57]
    v_pk_mul_f32 v[236:237], v[236:237], v[58:59]
    v_exp_f32 v230, v230
    v_exp_f32 v231, v231
    v_exp_f32 v232, v232
    v_exp_f32 v233, v233
    v_exp_f32 v234, v234
    v_exp_f32 v235, v235
    v_exp_f32 v236, v236
    v_exp_f32 v237, v237
    v_pk_add_f32 v[230:231], v[230:231], 1.0 op_sel_hi:[1,0]
    v_pk_add_f32 v[232:233], v[232:233], 1.0 op_sel_hi:[1,0]
    v_pk_add_f32 v[234:235], v[234:235], 1.0 op_sel_hi:[1,0]
    v_pk_add_f32 v[236:237], v[236:237], 1.0 op_sel_hi:[1,0]
    v_rcp_f32 v230, v230
    v_rcp_f32 v231, v231
    v_rcp_f32 v232, v232
    v_rcp_f32 v233, v233
    v_rcp_f32 v234, v234
    v_rcp_f32 v235, v235
    v_rcp_f32 v236, v236
    v_rcp_f32 v237, v237
    v_pk_mul_f32 v[40:41], v[40:41], v[230:231]
    v_pk_mul_f32 v[42:43], v[42:43], v[232:233]
    v_pk_mul_f32 v[56:57], v[56:57], v[234:235]
    v_pk_mul_f32 v[58:59], v[58:59], v[236:237]
    v_cvt_pk_bf16_f32 v40, v40, v41
    v_cvt_pk_bf16_f32 v41, v42, v43
    v_cvt_pk_bf16_f32 v42, v56, v57
    v_cvt_pk_bf16_f32 v43, v58, v59
    buffer_store_dwordx4 v[40:43], v224, s[36:39], s11 offen offset:2048 sc1
    v_pk_mul_f32 v[230:231], v[44:45], v[44:45]
    v_pk_mul_f32 v[232:233], v[46:47], v[46:47]
    v_pk_mul_f32 v[234:235], v[60:61], v[60:61]
    v_pk_mul_f32 v[236:237], v[62:63], v[62:63]
    v_pk_fma_f32 v[230:231], v[230:231], v[238:239], v[238:239] op_sel:[0,0,1] op_sel_hi:[1,0,1]
    v_pk_fma_f32 v[232:233], v[232:233], v[238:239], v[238:239] op_sel:[0,0,1] op_sel_hi:[1,0,1]
    v_pk_fma_f32 v[234:235], v[234:235], v[238:239], v[238:239] op_sel:[0,0,1] op_sel_hi:[1,0,1]
    v_pk_fma_f32 v[236:237], v[236:237], v[238:239], v[238:239] op_sel:[0,0,1] op_sel_hi:[1,0,1]
    v_pk_mul_f32 v[230:231], v[230:231], v[44:45]
    v_pk_mul_f32 v[232:233], v[232:233], v[46:47]
    v_pk_mul_f32 v[234:235], v[234:235], v[60:61]
    v_pk_mul_f32 v[236:237], v[236:237], v[62:63]
    v_exp_f32 v230, v230
    v_exp_f32 v231, v231
    v_exp_f32 v232, v232
    v_exp_f32 v233, v233
    v_exp_f32 v234, v234
    v_exp_f32 v235, v235
    v_exp_f32 v236, v236
    v_exp_f32 v237, v237
    v_pk_add_f32 v[230:231], v[230:231], 1.0 op_sel_hi:[1,0]
    v_pk_add_f32 v[232:233], v[232:233], 1.0 op_sel_hi:[1,0]
    v_pk_add_f32 v[234:235], v[234:235], 1.0 op_sel_hi:[1,0]
    v_pk_add_f32 v[236:237], v[236:237], 1.0 op_sel_hi:[1,0]
    v_rcp_f32 v230, v230
    v_rcp_f32 v231, v231
    v_rcp_f32 v232, v232
    v_rcp_f32 v233, v233
    v_rcp_f32 v234, v234
    v_rcp_f32 v235, v235
    v_rcp_f32 v236, v236
    v_rcp_f32 v237, v237
    v_pk_mul_f32 v[44:45], v[44:45], v[230:231]
    v_pk_mul_f32 v[46:47], v[46:47], v[232:233]
    v_pk_mul_f32 v[60:61], v[60:61], v[234:235]
    v_pk_mul_f32 v[62:63], v[62:63], v[236:237]
    v_cvt_pk_bf16_f32 v44, v44, v45
    v_cvt_pk_bf16_f32 v45, v46, v47
    v_cvt_pk_bf16_f32 v46, v60, v61
    v_cvt_pk_bf16_f32 v47, v62, v63
    buffer_store_dwordx4 v[44:47], v224, s[36:39], s11 offen offset:3072 sc1
    s_add_u32 s10, s10, 4096
    s_add_u32 s11, s11, 4096
    v_pk_mul_f32 v[230:231], v[64:65], v[64:65]
    v_pk_mul_f32 v[232:233], v[66:67], v[66:67]
    v_pk_mul_f32 v[234:235], v[80:81], v[80:81]
    v_pk_mul_f32 v[236:237], v[82:83], v[82:83]
    v_pk_fma_f32 v[230:231], v[230:231], v[238:239], v[238:239] op_sel:[0,0,1] op_sel_hi:[1,0,1]
    v_pk_fma_f32 v[232:233], v[232:233], v[238:239], v[238:239] op_sel:[0,0,1] op_sel_hi:[1,0,1]
    v_pk_fma_f32 v[234:235], v[234:235], v[238:239], v[238:239] op_sel:[0,0,1] op_sel_hi:[1,0,1]
    v_pk_fma_f32 v[236:237], v[236:237], v[238:239], v[238:239] op_sel:[0,0,1] op_sel_hi:[1,0,1]
    v_pk_mul_f32 v[230:231], v[230:231], v[64:65]
    v_pk_mul_f32 v[232:233], v[232:233], v[66:67]
    v_pk_mul_f32 v[234:235], v[234:235], v[80:81]
    v_pk_mul_f32 v[236:237], v[236:237], v[82:83]
    v_exp_f32 v230, v230
    v_exp_f32 v231, v231
    v_exp_f32 v232, v232
    v_exp_f32 v233, v233
    v_exp_f32 v234, v234
    v_exp_f32 v235, v235
    v_exp_f32 v236, v236
    v_exp_f32 v237, v237
    v_pk_add_f32 v[230:231], v[230:231], 1.0 op_sel_hi:[1,0]
    v_pk_add_f32 v[232:233], v[232:233], 1.0 op_sel_hi:[1,0]
    v_pk_add_f32 v[234:235], v[234:235], 1.0 op_sel_hi:[1,0]
    v_pk_add_f32 v[236:237], v[236:237], 1.0 op_sel_hi:[1,0]
    v_rcp_f32 v230, v230
    v_rcp_f32 v231, v231
    v_rcp_f32 v232, v232
    v_rcp_f32 v233, v233
    v_rcp_f32 v234, v234
    v_rcp_f32 v235, v235
    s_mov_b32 s58, 0
    buffer_load_dwordx4 a[0:3], v247, s[28:31], s58 offen
    v_rcp_f32 v236, v236
    v_rcp_f32 v237, v237
    v_pk_mul_f32 v[64:65], v[64:65], v[230:231]
    v_pk_mul_f32 v[66:67], v[66:67], v[232:233]
    v_pk_mul_f32 v[80:81], v[80:81], v[234:235]
    v_pk_mul_f32 v[82:83], v[82:83], v[236:237]
    v_cvt_pk_bf16_f32 v64, v64, v65
    v_cvt_pk_bf16_f32 v65, v66, v67
    v_cvt_pk_bf16_f32 v66, v80, v81
    v_cvt_pk_bf16_f32 v67, v82, v83
    buffer_store_dwordx4 v[64:67], v224, s[36:39], s10 offen offset:0 sc1
    v_pk_mul_f32 v[230:231], v[68:69], v[68:69]
    v_pk_mul_f32 v[232:233], v[70:71], v[70:71]
    s_mov_b32 s58, 65536
    buffer_load_dwordx4 a[4:7], v247, s[28:31], s58 offen
    v_pk_mul_f32 v[234:235], v[84:85], v[84:85]
    v_pk_mul_f32 v[236:237], v[86:87], v[86:87]
    v_pk_fma_f32 v[230:231], v[230:231], v[238:239], v[238:239] op_sel:[0,0,1] op_sel_hi:[1,0,1]
    v_pk_fma_f32 v[232:233], v[232:233], v[238:239], v[238:239] op_sel:[0,0,1] op_sel_hi:[1,0,1]
    v_pk_fma_f32 v[234:235], v[234:235], v[238:239], v[238:239] op_sel:[0,0,1] op_sel_hi:[1,0,1]
    v_pk_fma_f32 v[236:237], v[236:237], v[238:239], v[238:239] op_sel:[0,0,1] op_sel_hi:[1,0,1]
    v_pk_mul_f32 v[230:231], v[230:231], v[68:69]
    v_pk_mul_f32 v[232:233], v[232:233], v[70:71]
    v_pk_mul_f32 v[234:235], v[234:235], v[84:85]
    v_pk_mul_f32 v[236:237], v[236:237], v[86:87]
    v_exp_f32 v230, v230
    v_exp_f32 v231, v231
    s_mov_b32 s58, 131072
    buffer_load_dwordx4 a[8:11], v247, s[28:31], s58 offen
    v_exp_f32 v232, v232
    v_exp_f32 v233, v233
    v_exp_f32 v234, v234
    v_exp_f32 v235, v235
    v_exp_f32 v236, v236
    v_exp_f32 v237, v237
    v_pk_add_f32 v[230:231], v[230:231], 1.0 op_sel_hi:[1,0]
    v_pk_add_f32 v[232:233], v[232:233], 1.0 op_sel_hi:[1,0]
    v_pk_add_f32 v[234:235], v[234:235], 1.0 op_sel_hi:[1,0]
    v_pk_add_f32 v[236:237], v[236:237], 1.0 op_sel_hi:[1,0]
    v_rcp_f32 v230, v230
    v_rcp_f32 v231, v231
    s_mov_b32 s58, 196608
    buffer_load_dwordx4 a[12:15], v247, s[28:31], s58 offen
    v_rcp_f32 v232, v232
    v_rcp_f32 v233, v233
    v_rcp_f32 v234, v234
    v_rcp_f32 v235, v235
    v_rcp_f32 v236, v236
    v_rcp_f32 v237, v237
    v_pk_mul_f32 v[68:69], v[68:69], v[230:231]
    v_pk_mul_f32 v[70:71], v[70:71], v[232:233]
    v_pk_mul_f32 v[84:85], v[84:85], v[234:235]
    v_pk_mul_f32 v[86:87], v[86:87], v[236:237]
    v_cvt_pk_bf16_f32 v68, v68, v69
    v_cvt_pk_bf16_f32 v69, v70, v71
    s_mov_b32 s58, 262144
    buffer_load_dwordx4 a[16:19], v247, s[28:31], s58 offen
    v_cvt_pk_bf16_f32 v70, v84, v85
    v_cvt_pk_bf16_f32 v71, v86, v87
    buffer_store_dwordx4 v[68:71], v224, s[36:39], s10 offen offset:1024 sc1
    v_pk_mul_f32 v[230:231], v[72:73], v[72:73]
    v_pk_mul_f32 v[232:233], v[74:75], v[74:75]
    v_pk_mul_f32 v[234:235], v[88:89], v[88:89]
    v_pk_mul_f32 v[236:237], v[90:91], v[90:91]
    v_pk_fma_f32 v[230:231], v[230:231], v[238:239], v[238:239] op_sel:[0,0,1] op_sel_hi:[1,0,1]
    v_pk_fma_f32 v[232:233], v[232:233], v[238:239], v[238:239] op_sel:[0,0,1] op_sel_hi:[1,0,1]
    v_pk_fma_f32 v[234:235], v[234:235], v[238:239], v[238:239] op_sel:[0,0,1] op_sel_hi:[1,0,1]
    v_pk_fma_f32 v[236:237], v[236:237], v[238:239], v[238:239] op_sel:[0,0,1] op_sel_hi:[1,0,1]
    v_pk_mul_f32 v[230:231], v[230:231], v[72:73]
    v_pk_mul_f32 v[232:233], v[232:233], v[74:75]
    s_mov_b32 s58, 327680
    buffer_load_dwordx4 a[20:23], v247, s[28:31], s58 offen
    v_pk_mul_f32 v[234:235], v[234:235], v[88:89]
    v_pk_mul_f32 v[236:237], v[236:237], v[90:91]
    v_exp_f32 v230, v230
    v_exp_f32 v231, v231
    v_exp_f32 v232, v232
    v_exp_f32 v233, v233
    v_exp_f32 v234, v234
    v_exp_f32 v235, v235
    v_exp_f32 v236, v236
    v_exp_f32 v237, v237
    v_pk_add_f32 v[230:231], v[230:231], 1.0 op_sel_hi:[1,0]
    v_pk_add_f32 v[232:233], v[232:233], 1.0 op_sel_hi:[1,0]
    s_mov_b32 s58, 393216
    buffer_load_dwordx4 a[24:27], v247, s[28:31], s58 offen
    v_pk_add_f32 v[234:235], v[234:235], 1.0 op_sel_hi:[1,0]
    v_pk_add_f32 v[236:237], v[236:237], 1.0 op_sel_hi:[1,0]
    v_rcp_f32 v230, v230
    v_rcp_f32 v231, v231
    v_rcp_f32 v232, v232
    v_rcp_f32 v233, v233
    v_rcp_f32 v234, v234
    v_rcp_f32 v235, v235
    v_rcp_f32 v236, v236
    v_rcp_f32 v237, v237
    v_pk_mul_f32 v[72:73], v[72:73], v[230:231]
    v_pk_mul_f32 v[74:75], v[74:75], v[232:233]
    s_mov_b32 s58, 458752
    buffer_load_dwordx4 a[28:31], v247, s[28:31], s58 offen
    v_pk_mul_f32 v[88:89], v[88:89], v[234:235]
    v_pk_mul_f32 v[90:91], v[90:91], v[236:237]
    v_cvt_pk_bf16_f32 v72, v72, v73
    v_cvt_pk_bf16_f32 v73, v74, v75
    v_cvt_pk_bf16_f32 v74, v88, v89
    v_cvt_pk_bf16_f32 v75, v90, v91
    buffer_store_dwordx4 v[72:75], v224, s[36:39], s11 offen offset:0 sc1
    v_pk_mul_f32 v[230:231], v[76:77], v[76:77]
    v_pk_mul_f32 v[232:233], v[78:79], v[78:79]
    v_pk_mul_f32 v[234:235], v[92:93], v[92:93]
    v_pk_mul_f32 v[236:237], v[94:95], v[94:95]
    v_pk_fma_f32 v[230:231], v[230:231], v[238:239], v[238:239] op_sel:[0,0,1] op_sel_hi:[1,0,1]
    v_pk_fma_f32 v[232:233], v[232:233], v[238:239], v[238:239] op_sel:[0,0,1] op_sel_hi:[1,0,1]
    s_mov_b32 s58, 2162688
    buffer_load_dwordx4 a[132:135], v247, s[28:31], s58 offen
    v_pk_fma_f32 v[234:235], v[234:235], v[238:239], v[238:239] op_sel:[0,0,1] op_sel_hi:[1,0,1]
    v_pk_fma_f32 v[236:237], v[236:237], v[238:239], v[238:239] op_sel:[0,0,1] op_sel_hi:[1,0,1]
    v_pk_mul_f32 v[230:231], v[230:231], v[76:77]
    v_pk_mul_f32 v[232:233], v[232:233], v[78:79]
    v_pk_mul_f32 v[234:235], v[234:235], v[92:93]
    v_pk_mul_f32 v[236:237], v[236:237], v[94:95]
    v_exp_f32 v230, v230
    v_exp_f32 v231, v231
    v_exp_f32 v232, v232
    v_exp_f32 v233, v233
    v_exp_f32 v234, v234
    v_exp_f32 v235, v235
    s_mov_b32 s58, 2228224
    buffer_load_dwordx4 a[136:139], v247, s[28:31], s58 offen
    v_exp_f32 v236, v236
    v_exp_f32 v237, v237
    v_pk_add_f32 v[230:231], v[230:231], 1.0 op_sel_hi:[1,0]
    v_pk_add_f32 v[232:233], v[232:233], 1.0 op_sel_hi:[1,0]
    v_pk_add_f32 v[234:235], v[234:235], 1.0 op_sel_hi:[1,0]
    v_pk_add_f32 v[236:237], v[236:237], 1.0 op_sel_hi:[1,0]
    v_rcp_f32 v230, v230
    v_rcp_f32 v231, v231
    v_rcp_f32 v232, v232
    v_rcp_f32 v233, v233
    v_rcp_f32 v234, v234
    v_rcp_f32 v235, v235
    s_mov_b32 s58, 2293760
    buffer_load_dwordx4 a[140:143], v247, s[28:31], s58 offen
    v_rcp_f32 v236, v236
    v_rcp_f32 v237, v237
    v_pk_mul_f32 v[76:77], v[76:77], v[230:231]
    v_pk_mul_f32 v[78:79], v[78:79], v[232:233]
    v_pk_mul_f32 v[92:93], v[92:93], v[234:235]
    v_pk_mul_f32 v[94:95], v[94:95], v[236:237]
    v_cvt_pk_bf16_f32 v76, v76, v77
    v_cvt_pk_bf16_f32 v77, v78, v79
    v_cvt_pk_bf16_f32 v78, v92, v93
    v_cvt_pk_bf16_f32 v79, v94, v95
    buffer_store_dwordx4 v[76:79], v224, s[36:39], s11 offen offset:1024 sc1
    v_pk_mul_f32 v[230:231], v[96:97], v[96:97]
    v_pk_mul_f32 v[232:233], v[98:99], v[98:99]
    s_mov_b32 s58, 2359296
    buffer_load_dwordx4 a[144:147], v247, s[28:31], s58 offen
    v_pk_mul_f32 v[234:235], v[112:113], v[112:113]
    v_pk_mul_f32 v[236:237], v[114:115], v[114:115]
    v_pk_fma_f32 v[230:231], v[230:231], v[238:239], v[238:239] op_sel:[0,0,1] op_sel_hi:[1,0,1]
    v_pk_fma_f32 v[232:233], v[232:233], v[238:239], v[238:239] op_sel:[0,0,1] op_sel_hi:[1,0,1]
    v_pk_fma_f32 v[234:235], v[234:235], v[238:239], v[238:239] op_sel:[0,0,1] op_sel_hi:[1,0,1]
    v_pk_fma_f32 v[236:237], v[236:237], v[238:239], v[238:239] op_sel:[0,0,1] op_sel_hi:[1,0,1]
    v_pk_mul_f32 v[230:231], v[230:231], v[96:97]
    v_pk_mul_f32 v[232:233], v[232:233], v[98:99]
    v_pk_mul_f32 v[234:235], v[234:235], v[112:113]
    v_pk_mul_f32 v[236:237], v[236:237], v[114:115]
    v_exp_f32 v230, v230
    v_exp_f32 v231, v231
    s_mov_b32 s58, 2424832
    buffer_load_dwordx4 a[148:151], v247, s[28:31], s58 offen
    v_exp_f32 v232, v232
    v_exp_f32 v233, v233
    v_exp_f32 v234, v234
    v_exp_f32 v235, v235
    v_exp_f32 v236, v236
    v_exp_f32 v237, v237
    v_pk_add_f32 v[230:231], v[230:231], 1.0 op_sel_hi:[1,0]
    v_pk_add_f32 v[232:233], v[232:233], 1.0 op_sel_hi:[1,0]
    v_pk_add_f32 v[234:235], v[234:235], 1.0 op_sel_hi:[1,0]
    v_pk_add_f32 v[236:237], v[236:237], 1.0 op_sel_hi:[1,0]
    v_rcp_f32 v230, v230
    v_rcp_f32 v231, v231
    s_mov_b32 s58, 2490368
    buffer_load_dwordx4 a[152:155], v247, s[28:31], s58 offen
    v_rcp_f32 v232, v232
    v_rcp_f32 v233, v233
    v_rcp_f32 v234, v234
    v_rcp_f32 v235, v235
    v_rcp_f32 v236, v236
    v_rcp_f32 v237, v237
    v_pk_mul_f32 v[96:97], v[96:97], v[230:231]
    v_pk_mul_f32 v[98:99], v[98:99], v[232:233]
    v_pk_mul_f32 v[112:113], v[112:113], v[234:235]
    v_pk_mul_f32 v[114:115], v[114:115], v[236:237]
    v_cvt_pk_bf16_f32 v96, v96, v97
    v_cvt_pk_bf16_f32 v97, v98, v99
    s_mov_b32 s58, 2555904
    buffer_load_dwordx4 a[156:159], v247, s[28:31], s58 offen
    v_cvt_pk_bf16_f32 v98, v112, v113
    v_cvt_pk_bf16_f32 v99, v114, v115
    buffer_store_dwordx4 v[96:99], v224, s[36:39], s10 offen offset:2048 sc1
    v_pk_mul_f32 v[230:231], v[100:101], v[100:101]
    v_pk_mul_f32 v[232:233], v[102:103], v[102:103]
    v_pk_mul_f32 v[234:235], v[116:117], v[116:117]
    v_pk_mul_f32 v[236:237], v[118:119], v[118:119]
    v_pk_fma_f32 v[230:231], v[230:231], v[238:239], v[238:239] op_sel:[0,0,1] op_sel_hi:[1,0,1]
    v_pk_fma_f32 v[232:233], v[232:233], v[238:239], v[238:239] op_sel:[0,0,1] op_sel_hi:[1,0,1]
    v_pk_fma_f32 v[234:235], v[234:235], v[238:239], v[238:239] op_sel:[0,0,1] op_sel_hi:[1,0,1]
    v_pk_fma_f32 v[236:237], v[236:237], v[238:239], v[238:239] op_sel:[0,0,1] op_sel_hi:[1,0,1]
    v_pk_mul_f32 v[230:231], v[230:231], v[100:101]
    v_pk_mul_f32 v[232:233], v[232:233], v[102:103]
    s_mov_b32 s58, 2621440
    buffer_load_dwordx4 a[160:163], v247, s[28:31], s58 offen
    v_pk_mul_f32 v[234:235], v[234:235], v[116:117]
    v_pk_mul_f32 v[236:237], v[236:237], v[118:119]
    v_exp_f32 v230, v230
    v_exp_f32 v231, v231
    v_exp_f32 v232, v232
    v_exp_f32 v233, v233
    v_exp_f32 v234, v234
    v_exp_f32 v235, v235
    v_exp_f32 v236, v236
    v_exp_f32 v237, v237
    v_pk_add_f32 v[230:231], v[230:231], 1.0 op_sel_hi:[1,0]
    v_pk_add_f32 v[232:233], v[232:233], 1.0 op_sel_hi:[1,0]
    s_mov_b32 s58, 2686976
    buffer_load_dwordx4 a[164:167], v247, s[28:31], s58 offen
    v_pk_add_f32 v[234:235], v[234:235], 1.0 op_sel_hi:[1,0]
    v_pk_add_f32 v[236:237], v[236:237], 1.0 op_sel_hi:[1,0]
    v_rcp_f32 v230, v230
    v_rcp_f32 v231, v231
    v_rcp_f32 v232, v232
    v_rcp_f32 v233, v233
    v_rcp_f32 v234, v234
    v_rcp_f32 v235, v235
    v_rcp_f32 v236, v236
    v_rcp_f32 v237, v237
    v_pk_mul_f32 v[100:101], v[100:101], v[230:231]
    v_pk_mul_f32 v[102:103], v[102:103], v[232:233]
    s_mov_b32 s58, 2752512
    buffer_load_dwordx4 a[168:171], v247, s[28:31], s58 offen
    v_pk_mul_f32 v[116:117], v[116:117], v[234:235]
    v_pk_mul_f32 v[118:119], v[118:119], v[236:237]
    v_cvt_pk_bf16_f32 v100, v100, v101
    v_cvt_pk_bf16_f32 v101, v102, v103
    v_cvt_pk_bf16_f32 v102, v116, v117
    v_cvt_pk_bf16_f32 v103, v118, v119
    buffer_store_dwordx4 v[100:103], v224, s[36:39], s10 offen offset:3072 sc1
    v_pk_mul_f32 v[230:231], v[104:105], v[104:105]
    v_pk_mul_f32 v[232:233], v[106:107], v[106:107]
    v_pk_mul_f32 v[234:235], v[120:121], v[120:121]
    v_pk_mul_f32 v[236:237], v[122:123], v[122:123]
    v_pk_fma_f32 v[230:231], v[230:231], v[238:239], v[238:239] op_sel:[0,0,1] op_sel_hi:[1,0,1]
    v_pk_fma_f32 v[232:233], v[232:233], v[238:239], v[238:239] op_sel:[0,0,1] op_sel_hi:[1,0,1]
    s_mov_b32 s58, 2818048
    buffer_load_dwordx4 a[172:175], v247, s[28:31], s58 offen
    v_pk_fma_f32 v[234:235], v[234:235], v[238:239], v[238:239] op_sel:[0,0,1] op_sel_hi:[1,0,1]
    v_pk_fma_f32 v[236:237], v[236:237], v[238:239], v[238:239] op_sel:[0,0,1] op_sel_hi:[1,0,1]
    v_pk_mul_f32 v[230:231], v[230:231], v[104:105]
    v_pk_mul_f32 v[232:233], v[232:233], v[106:107]
    v_pk_mul_f32 v[234:235], v[234:235], v[120:121]
    v_pk_mul_f32 v[236:237], v[236:237], v[122:123]
    v_exp_f32 v230, v230
    v_exp_f32 v231, v231
    v_exp_f32 v232, v232
    v_exp_f32 v233, v233
    v_exp_f32 v234, v234
    v_exp_f32 v235, v235
    s_mov_b32 s58, 2883584
    buffer_load_dwordx4 a[176:179], v247, s[28:31], s58 offen
    v_exp_f32 v236, v236
    v_exp_f32 v237, v237
    v_pk_add_f32 v[230:231], v[230:231], 1.0 op_sel_hi:[1,0]
    v_pk_add_f32 v[232:233], v[232:233], 1.0 op_sel_hi:[1,0]
    v_pk_add_f32 v[234:235], v[234:235], 1.0 op_sel_hi:[1,0]
    v_pk_add_f32 v[236:237], v[236:237], 1.0 op_sel_hi:[1,0]
    v_rcp_f32 v230, v230
    v_rcp_f32 v231, v231
    v_rcp_f32 v232, v232
    v_rcp_f32 v233, v233
    v_rcp_f32 v234, v234
    v_rcp_f32 v235, v235
    s_mov_b32 s58, 2949120
    buffer_load_dwordx4 a[180:183], v247, s[28:31], s58 offen
    v_rcp_f32 v236, v236
    v_rcp_f32 v237, v237
    v_pk_mul_f32 v[104:105], v[104:105], v[230:231]
    v_pk_mul_f32 v[106:107], v[106:107], v[232:233]
    v_pk_mul_f32 v[120:121], v[120:121], v[234:235]
    v_pk_mul_f32 v[122:123], v[122:123], v[236:237]
    v_cvt_pk_bf16_f32 v104, v104, v105
    v_cvt_pk_bf16_f32 v105, v106, v107
    v_cvt_pk_bf16_f32 v106, v120, v121
    v_cvt_pk_bf16_f32 v107, v122, v123
    buffer_store_dwordx4 v[104:107], v224, s[36:39], s11 offen offset:2048 sc1
    v_pk_mul_f32 v[230:231], v[108:109], v[108:109]
    s_branch L_po_C_5
.p2align 12
L_pg_C_5:
    s_branch L_pg_K_2
L_po_C_5:
    v_pk_mul_f32 v[232:233], v[110:111], v[110:111]
    s_mov_b32 s58, 3014656
    buffer_load_dwordx4 a[184:187], v247, s[28:31], s58 offen
    v_pk_mul_f32 v[234:235], v[124:125], v[124:125]
    v_pk_mul_f32 v[236:237], v[126:127], v[126:127]
    v_pk_fma_f32 v[230:231], v[230:231], v[238:239], v[238:239] op_sel:[0,0,1] op_sel_hi:[1,0,1]
    v_pk_fma_f32 v[232:233], v[232:233], v[238:239], v[238:239] op_sel:[0,0,1] op_sel_hi:[1,0,1]
    v_pk_fma_f32 v[234:235], v[234:235], v[238:239], v[238:239] op_sel:[0,0,1] op_sel_hi:[1,0,1]
    v_pk_fma_f32 v[236:237], v[236:237], v[238:239], v[238:239] op_sel:[0,0,1] op_sel_hi:[1,0,1]
    v_pk_mul_f32 v[230:231], v[230:231], v[108:109]
    v_pk_mul_f32 v[232:233], v[232:233], v[110:111]
    v_pk_mul_f32 v[234:235], v[234:235], v[124:125]
    v_pk_mul_f32 v[236:237], v[236:237], v[126:127]
    v_exp_f32 v230, v230
    v_exp_f32 v231, v231
    s_add_u32 m0, s99, 65536
    s_nop 0
    buffer_load_dwordx4 v250, s[32:35], s98 offen offset:0 lds
    v_exp_f32 v232, v232
    v_exp_f32 v233, v233
    v_exp_f32 v234, v234
    v_exp_f32 v235, v235
    v_exp_f32 v236, v236
    v_exp_f32 v237, v237
    v_pk_add_f32 v[230:231], v[230:231], 1.0 op_sel_hi:[1,0]
    v_pk_add_f32 v[232:233], v[232:233], 1.0 op_sel_hi:[1,0]
    v_pk_add_f32 v[234:235], v[234:235], 1.0 op_sel_hi:[1,0]
    v_pk_add_f32 v[236:237], v[236:237], 1.0 op_sel_hi:[1,0]
    v_rcp_f32 v230, v230
    v_rcp_f32 v231, v231
    buffer_load_dwordx4 v251, s[32:35], s98 offen offset:1024 lds
    v_rcp_f32 v232, v232
    v_rcp_f32 v233, v233
    v_rcp_f32 v234, v234
    v_rcp_f32 v235, v235
    v_rcp_f32 v236, v236
    v_rcp_f32 v237, v237
    v_pk_mul_f32 v[108:109], v[108:109], v[230:231]
    v_pk_mul_f32 v[110:111], v[110:111], v[232:233]
    v_pk_mul_f32 v[124:125], v[124:125], v[234:235]
    v_pk_mul_f32 v[126:127], v[126:127], v[236:237]
    v_cvt_pk_bf16_f32 v108, v108, v109
    v_cvt_pk_bf16_f32 v109, v110, v111
    buffer_load_dwordx4 v252, s[32:35], s98 offen offset:2048 lds
    v_cvt_pk_bf16_f32 v110, v124, v125
    v_cvt_pk_bf16_f32 v111, v126, v127
    buffer_store_dwordx4 v[108:111], v224, s[36:39], s11 offen offset:3072 sc1
    v_pk_mul_f32 v[230:231], v[128:129], v[128:129]
    v_pk_mul_f32 v[232:233], v[130:131], v[130:131]
    v_pk_mul_f32 v[234:235], v[144:145], v[144:145]
    v_pk_mul_f32 v[236:237], v[146:147], v[146:147]
    v_pk_fma_f32 v[230:231], v[230:231], v[238:239], v[238:239] op_sel:[0,0,1] op_sel_hi:[1,0,1]
    v_pk_fma_f32 v[232:233], v[232:233], v[238:239], v[238:239] op_sel:[0,0,1] op_sel_hi:[1,0,1]
    v_pk_fma_f32 v[234:235], v[234:235], v[238:239], v[238:239] op_sel:[0,0,1] op_sel_hi:[1,0,1]
    v_pk_fma_f32 v[236:237], v[236:237], v[238:239], v[238:239] op_sel:[0,0,1] op_sel_hi:[1,0,1]
    v_pk_mul_f32 v[230:231], v[230:231], v[128:129]
    v_pk_mul_f32 v[232:233], v[232:233], v[130:131]
    buffer_load_dwordx4 v253, s[32:35], s98 offen offset:3072 lds
    v_pk_mul_f32 v[234:235], v[234:235], v[144:145]
    v_pk_mul_f32 v[236:237], v[236:237], v[146:147]
    v_exp_f32 v230, v230
    v_exp_f32 v231, v231
    v_exp_f32 v232, v232
    v_exp_f32 v233, v233
    v_exp_f32 v234, v234
    v_exp_f32 v235, v235
    v_exp_f32 v236, v236
    v_exp_f32 v237, v237
    v_pk_add_f32 v[230:231], v[230:231], 1.0 op_sel_hi:[1,0]
    v_pk_add_f32 v[232:233], v[232:233], 1.0 op_sel_hi:[1,0]
    s_xor_b32 s98, s98, 1024
    s_add_u32 m0, s99, 81920
    s_nop 0
    buffer_load_dwordx4 v250, s[32:35], s98 offen offset:0 lds
    v_pk_add_f32 v[234:235], v[234:235], 1.0 op_sel_hi:[1,0]
    v_pk_add_f32 v[236:237], v[236:237], 1.0 op_sel_hi:[1,0]
    v_rcp_f32 v230, v230
    v_rcp_f32 v231, v231
    v_rcp_f32 v232, v232
    v_rcp_f32 v233, v233
    v_rcp_f32 v234, v234
    v_rcp_f32 v235, v235
    v_rcp_f32 v236, v236
    v_rcp_f32 v237, v237
    v_pk_mul_f32 v[128:129], v[128:129], v[230:231]
    v_pk_mul_f32 v[130:131], v[130:131], v[232:233]
    buffer_load_dwordx4 v251, s[32:35], s98 offen offset:1024 lds
    v_pk_mul_f32 v[144:145], v[144:145], v[234:235]
    v_pk_mul_f32 v[146:147], v[146:147], v[236:237]
    v_cvt_pk_bf16_f32 v64, v128, v129
    v_cvt_pk_bf16_f32 v65, v130, v131
    v_cvt_pk_bf16_f32 v66, v144, v145
    v_cvt_pk_bf16_f32 v67, v146, v147
    buffer_store_dwordx4 v[64:67], v224, s[36:39], s6 offen offset:0 sc1
    v_pk_mul_f32 v[230:231], v[132:133], v[132:133]
    v_pk_mul_f32 v[232:233], v[134:135], v[134:135]
    v_pk_mul_f32 v[234:235], v[148:149], v[148:149]
    v_pk_mul_f32 v[236:237], v[150:151], v[150:151]
    v_pk_fma_f32 v[230:231], v[230:231], v[238:239], v[238:239] op_sel:[0,0,1] op_sel_hi:[1,0,1]
    v_pk_fma_f32 v[232:233], v[232:233], v[238:239], v[238:239] op_sel:[0,0,1] op_sel_hi:[1,0,1]
    buffer_load_dwordx4 v252, s[32:35], s98 offen offset:2048 lds
    v_pk_fma_f32 v[234:235], v[234:235], v[238:239], v[238:239] op_sel:[0,0,1] op_sel_hi:[1,0,1]
    v_pk_fma_f32 v[236:237], v[236:237], v[238:239], v[238:239] op_sel:[0,0,1] op_sel_hi:[1,0,1]
    v_pk_mul_f32 v[230:231], v[230:231], v[132:133]
    v_pk_mul_f32 v[232:233], v[232:233], v[134:135]
    v_pk_mul_f32 v[234:235], v[234:235], v[148:149]
    v_pk_mul_f32 v[236:237], v[236:237], v[150:151]
    v_exp_f32 v230, v230
    v_exp_f32 v231, v231
    v_exp_f32 v232, v232
    v_exp_f32 v233, v233
    v_exp_f32 v234, v234
    v_exp_f32 v235, v235
    buffer_load_dwordx4 v253, s[32:35], s98 offen offset:3072 lds
    v_exp_f32 v236, v236
    v_exp_f32 v237, v237
    v_pk_add_f32 v[230:231], v[230:231], 1.0 op_sel_hi:[1,0]
    v_pk_add_f32 v[232:233], v[232:233], 1.0 op_sel_hi:[1,0]
    v_pk_add_f32 v[234:235], v[234:235], 1.0 op_sel_hi:[1,0]
    v_pk_add_f32 v[236:237], v[236:237], 1.0 op_sel_hi:[1,0]
    v_rcp_f32 v230, v230
    v_rcp_f32 v231, v231
    v_rcp_f32 v232, v232
    v_rcp_f32 v233, v233
    v_rcp_f32 v234, v234
    v_rcp_f32 v235, v235
    s_xor_b32 s98, s98, 3072
    s_add_u32 m0, s99, 0
    s_nop 0
    buffer_load_dwordx4 v250, s[32:35], s98 offen offset:0 lds
    v_rcp_f32 v236, v236
    v_rcp_f32 v237, v237
    v_pk_mul_f32 v[132:133], v[132:133], v[230:231]
    v_pk_mul_f32 v[134:135], v[134:135], v[232:233]
    v_pk_mul_f32 v[148:149], v[148:149], v[234:235]
    v_pk_mul_f32 v[150:151], v[150:151], v[236:237]
    v_cvt_pk_bf16_f32 v68, v132, v133
    v_cvt_pk_bf16_f32 v69, v134, v135
    v_cvt_pk_bf16_f32 v70, v148, v149
    v_cvt_pk_bf16_f32 v71, v150, v151
    buffer_store_dwordx4 v[68:71], v224, s[36:39], s6 offen offset:1024 sc1
    v_pk_mul_f32 v[230:231], v[136:137], v[136:137]
    v_pk_mul_f32 v[232:233], v[138:139], v[138:139]
    buffer_load_dwordx4 v251, s[32:35], s98 offen offset:1024 lds
    v_pk_mul_f32 v[234:235], v[152:153], v[152:153]
    v_pk_mul_f32 v[236:237], v[154:155], v[154:155]
    v_pk_fma_f32 v[230:231], v[230:231], v[238:239], v[238:239] op_sel:[0,0,1] op_sel_hi:[1,0,1]
    v_pk_fma_f32 v[232:233], v[232:233], v[238:239], v[238:239] op_sel:[0,0,1] op_sel_hi:[1,0,1]
    v_pk_fma_f32 v[234:235], v[234:235], v[238:239], v[238:239] op_sel:[0,0,1] op_sel_hi:[1,0,1]
    v_pk_fma_f32 v[236:237], v[236:237], v[238:239], v[238:239] op_sel:[0,0,1] op_sel_hi:[1,0,1]
    v_pk_mul_f32 v[230:231], v[230:231], v[136:137]
    v_pk_mul_f32 v[232:233], v[232:233], v[138:139]
    v_pk_mul_f32 v[234:235], v[234:235], v[152:153]
    v_pk_mul_f32 v[236:237], v[236:237], v[154:155]
    v_exp_f32 v230, v230
    v_exp_f32 v231, v231
    buffer_load_dwordx4 v252, s[32:35], s98 offen offset:2048 lds
    v_exp_f32 v232, v232
    v_exp_f32 v233, v233
    v_exp_f32 v234, v234
    v_exp_f32 v235, v235
    v_exp_f32 v236, v236
    v_exp_f32 v237, v237
    v_pk_add_f32 v[230:231], v[230:231], 1.0 op_sel_hi:[1,0]
    v_pk_add_f32 v[232:233], v[232:233], 1.0 op_sel_hi:[1,0]
    v_pk_add_f32 v[234:235], v[234:235], 1.0 op_sel_hi:[1,0]
    v_pk_add_f32 v[236:237], v[236:237], 1.0 op_sel_hi:[1,0]
    v_rcp_f32 v230, v230
    v_rcp_f32 v231, v231
    buffer_load_dwordx4 v253, s[32:35], s98 offen offset:3072 lds
    v_rcp_f32 v232, v232
    v_rcp_f32 v233, v233
    v_rcp_f32 v234, v234
    v_rcp_f32 v235, v235
    v_rcp_f32 v236, v236
    v_rcp_f32 v237, v237
    v_pk_mul_f32 v[136:137], v[136:137], v[230:231]
    v_pk_mul_f32 v[138:139], v[138:139], v[232:233]
    v_pk_mul_f32 v[152:153], v[152:153], v[234:235]
    v_pk_mul_f32 v[154:155], v[154:155], v[236:237]
    v_cvt_pk_bf16_f32 v72, v136, v137
    v_cvt_pk_bf16_f32 v73, v138, v139
    s_xor_b32 s98, s98, 1024
    s_add_u32 m0, s99, 16384
    s_nop 0
    buffer_load_dwordx4 v250, s[32:35], s98 offen offset:0 lds
    v_cvt_pk_bf16_f32 v74, v152, v153
    v_cvt_pk_bf16_f32 v75, v154, v155
    buffer_store_dwordx4 v[72:75], v224, s[36:39], s7 offen offset:0 sc1
    v_pk_mul_f32 v[230:231], v[140:141], v[140:141]
    v_pk_mul_f32 v[232:233], v[142:143], v[142:143]
    v_pk_mul_f32 v[234:235], v[156:157], v[156:157]
    v_pk_mul_f32 v[236:237], v[158:159], v[158:159]
    v_pk_fma_f32 v[230:231], v[230:231], v[238:239], v[238:239] op_sel:[0,0,1] op_sel_hi:[1,0,1]
    v_pk_fma_f32 v[232:233], v[232:233], v[238:239], v[238:239] op_sel:[0,0,1] op_sel_hi:[1,0,1]
    v_pk_fma_f32 v[234:235], v[234:235], v[238:239], v[238:239] op_sel:[0,0,1] op_sel_hi:[1,0,1]
    v_pk_fma_f32 v[236:237], v[236:237], v[238:239], v[238:239] op_sel:[0,0,1] op_sel_hi:[1,0,1]
    v_pk_mul_f32 v[230:231], v[230:231], v[140:141]
    v_pk_mul_f32 v[232:233], v[232:233], v[142:143]
    buffer_load_dwordx4 v251, s[32:35], s98 offen offset:1024 lds
    v_pk_mul_f32 v[234:235], v[234:235], v[156:157]
    v_pk_mul_f32 v[236:237], v[236:237], v[158:159]
    v_exp_f32 v230, v230
    v_exp_f32 v231, v231
    v_exp_f32 v232, v232
    v_exp_f32 v233, v233
    v_exp_f32 v234, v234
    v_exp_f32 v235, v235
    v_exp_f32 v236, v236
    v_exp_f32 v237, v237
    v_pk_add_f32 v[230:231], v[230:231], 1.0 op_sel_hi:[1,0]
    v_pk_add_f32 v[232:233], v[232:233], 1.0 op_sel_hi:[1,0]
    buffer_load_dwordx4 v252, s[32:35], s98 offen offset:2048 lds
    v_pk_add_f32 v[234:235], v[234:235], 1.0 op_sel_hi:[1,0]
    v_pk_add_f32 v[236:237], v[236:237], 1.0 op_sel_hi:[1,0]
    v_rcp_f32 v230, v230
    v_rcp_f32 v231, v231
    v_rcp_f32 v232, v232
    v_rcp_f32 v233, v233
    v_rcp_f32 v234, v234
    v_rcp_f32 v235, v235
    v_rcp_f32 v236, v236
    v_rcp_f32 v237, v237
    v_pk_mul_f32 v[140:141], v[140:141], v[230:231]
    v_pk_mul_f32 v[142:143], v[142:143], v[232:233]
    buffer_load_dwordx4 v253, s[32:35], s98 offen offset:3072 lds
    v_pk_mul_f32 v[156:157], v[156:157], v[234:235]
    v_pk_mul_f32 v[158:159], v[158:159], v[236:237]
    v_cvt_pk_bf16_f32 v76, v140, v141
    v_cvt_pk_bf16_f32 v77, v142, v143
    v_cvt_pk_bf16_f32 v78, v156, v157
    v_cvt_pk_bf16_f32 v79, v158, v159
    buffer_store_dwordx4 v[76:79], v224, s[36:39], s7 offen offset:1024 sc1
    v_pk_mul_f32 v[230:231], v[160:161], v[160:161]
    v_pk_mul_f32 v[232:233], v[162:163], v[162:163]
    v_pk_mul_f32 v[234:235], v[176:177], v[176:177]
    v_pk_mul_f32 v[236:237], v[178:179], v[178:179]
    v_pk_fma_f32 v[230:231], v[230:231], v[238:239], v[238:239] op_sel:[0,0,1] op_sel_hi:[1,0,1]
    v_pk_fma_f32 v[232:233], v[232:233], v[238:239], v[238:239] op_sel:[0,0,1] op_sel_hi:[1,0,1]
    s_mov_b32 s58, 3080192
    buffer_load_dwordx4 a[188:191], v247, s[28:31], s58 offen
    v_pk_fma_f32 v[234:235], v[234:235], v[238:239], v[238:239] op_sel:[0,0,1] op_sel_hi:[1,0,1]
    v_pk_fma_f32 v[236:237], v[236:237], v[238:239], v[238:239] op_sel:[0,0,1] op_sel_hi:[1,0,1]
    v_pk_mul_f32 v[230:231], v[230:231], v[160:161]
    v_pk_mul_f32 v[232:233], v[232:233], v[162:163]
    v_pk_mul_f32 v[234:235], v[234:235], v[176:177]
    v_pk_mul_f32 v[236:237], v[236:237], v[178:179]
    v_exp_f32 v230, v230
    v_exp_f32 v231, v231
    v_exp_f32 v232, v232
    v_exp_f32 v233, v233
    v_exp_f32 v234, v234
    v_exp_f32 v235, v235
    s_mov_b32 s58, 3145728
    buffer_load_dwordx4 a[192:195], v247, s[28:31], s58 offen
    v_exp_f32 v236, v236
    v_exp_f32 v237, v237
    v_pk_add_f32 v[230:231], v[230:231], 1.0 op_sel_hi:[1,0]
    v_pk_add_f32 v[232:233], v[232:233], 1.0 op_sel_hi:[1,0]
    v_pk_add_f32 v[234:235], v[234:235], 1.0 op_sel_hi:[1,0]
    v_pk_add_f32 v[236:237], v[236:237], 1.0 op_sel_hi:[1,0]
    v_rcp_f32 v230, v230
    v_rcp_f32 v231, v231
    v_rcp_f32 v232, v232
    v_rcp_f32 v233, v233
    v_rcp_f32 v234, v234
    v_rcp_f32 v235, v235
    s_mov_b32 s58, 3211264
    buffer_load_dwordx4 a[196:199], v247, s[28:31], s58 offen
    v_rcp_f32 v236, v236
    v_rcp_f32 v237, v237
    v_pk_mul_f32 v[160:161], v[160:161], v[230:231]
    v_pk_mul_f32 v[162:163], v[162:163], v[232:233]
    v_pk_mul_f32 v[176:177], v[176:177], v[234:235]
    v_pk_mul_f32 v[178:179], v[178:179], v[236:237]
    v_cvt_pk_bf16_f32 v80, v160, v161
    v_cvt_pk_bf16_f32 v81, v162, v163
    v_cvt_pk_bf16_f32 v82, v176, v177
    v_cvt_pk_bf16_f32 v83, v178, v179
    v_pk_mul_f32 v[230:231], v[164:165], v[164:165]
    v_pk_mul_f32 v[232:233], v[166:167], v[166:167]
    s_mov_b32 s58, 3276800
    buffer_load_dwordx4 a[200:203], v247, s[28:31], s58 offen
    v_pk_mul_f32 v[234:235], v[180:181], v[180:181]
    v_pk_mul_f32 v[236:237], v[182:183], v[182:183]
    v_pk_fma_f32 v[230:231], v[230:231], v[238:239], v[238:239] op_sel:[0,0,1] op_sel_hi:[1,0,1]
    v_pk_fma_f32 v[232:233], v[232:233], v[238:239], v[238:239] op_sel:[0,0,1] op_sel_hi:[1,0,1]
    v_pk_fma_f32 v[234:235], v[234:235], v[238:239], v[238:239] op_sel:[0,0,1] op_sel_hi:[1,0,1]
    v_pk_fma_f32 v[236:237], v[236:237], v[238:239], v[238:239] op_sel:[0,0,1] op_sel_hi:[1,0,1]
    v_pk_mul_f32 v[230:231], v[230:231], v[164:165]
    v_pk_mul_f32 v[232:233], v[232:233], v[166:167]
    v_pk_mul_f32 v[234:235], v[234:235], v[180:181]
    v_pk_mul_f32 v[236:237], v[236:237], v[182:183]
    v_exp_f32 v230, v230
    v_exp_f32 v231, v231
    s_mov_b32 s58, 3342336
    buffer_load_dwordx4 a[204:207], v247, s[28:31], s58 offen
    v_exp_f32 v232, v232
    v_exp_f32 v233, v233
    v_exp_f32 v234, v234
    v_exp_f32 v235, v235
    v_exp_f32 v236, v236
    v_exp_f32 v237, v237
    v_pk_add_f32 v[230:231], v[230:231], 1.0 op_sel_hi:[1,0]
    v_pk_add_f32 v[232:233], v[232:233], 1.0 op_sel_hi:[1,0]
    v_pk_add_f32 v[234:235], v[234:235], 1.0 op_sel_hi:[1,0]
    v_pk_add_f32 v[236:237], v[236:237], 1.0 op_sel_hi:[1,0]
    v_rcp_f32 v230, v230
    v_rcp_f32 v231, v231
    s_mov_b32 s58, 3407872
    buffer_load_dwordx4 a[208:211], v247, s[28:31], s58 offen
    v_rcp_f32 v232, v232
    v_rcp_f32 v233, v233
    v_rcp_f32 v234, v234
    v_rcp_f32 v235, v235
    v_rcp_f32 v236, v236
    v_rcp_f32 v237, v237
    v_pk_mul_f32 v[164:165], v[164:165], v[230:231]
    v_pk_mul_f32 v[166:167], v[166:167], v[232:233]
    v_pk_mul_f32 v[180:181], v[180:181], v[234:235]
    v_pk_mul_f32 v[182:183], v[182:183], v[236:237]
    v_cvt_pk_bf16_f32 v84, v164, v165
    v_cvt_pk_bf16_f32 v85, v166, v167
    s_mov_b32 s58, 3473408
    buffer_load_dwordx4 a[212:215], v247, s[28:31], s58 offen
    v_cvt_pk_bf16_f32 v86, v180, v181
    v_cvt_pk_bf16_f32 v87, v182, v183
    v_pk_mul_f32 v[230:231], v[168:169], v[168:169]
    v_pk_mul_f32 v[232:233], v[170:171], v[170:171]
    v_pk_mul_f32 v[234:235], v[184:185], v[184:185]
    v_pk_mul_f32 v[236:237], v[186:187], v[186:187]
    v_pk_fma_f32 v[230:231], v[230:231], v[238:239], v[238:239] op_sel:[0,0,1] op_sel_hi:[1,0,1]
    v_pk_fma_f32 v[232:233], v[232:233], v[238:239], v[238:239] op_sel:[0,0,1] op_sel_hi:[1,0,1]
    v_pk_fma_f32 v[234:235], v[234:235], v[238:239], v[238:239] op_sel:[0,0,1] op_sel_hi:[1,0,1]
    v_pk_fma_f32 v[236:237], v[236:237], v[238:239], v[238:239] op_sel:[0,0,1] op_sel_hi:[1,0,1]
    v_pk_mul_f32 v[230:231], v[230:231], v[168:169]
    v_pk_mul_f32 v[232:233], v[232:233], v[170:171]
    s_mov_b32 s58, 3538944
    buffer_load_dwordx4 a[216:219], v247, s[28:31], s58 offen
    v_pk_mul_f32 v[234:235], v[234:235], v[184:185]
    v_pk_mul_f32 v[236:237], v[236:237], v[186:187]
    v_exp_f32 v230, v230
    v_exp_f32 v231, v231
    v_exp_f32 v232, v232
    v_exp_f32 v233, v233
    v_exp_f32 v234, v234
    v_exp_f32 v235, v235
    v_exp_f32 v236, v236
    v_exp_f32 v237, v237
    v_pk_add_f32 v[230:231], v[230:231], 1.0 op_sel_hi:[1,0]
    v_pk_add_f32 v[232:233], v[232:233], 1.0 op_sel_hi:[1,0]
    s_mov_b32 s58, 3604480
    buffer_load_dwordx4 a[220:223], v247, s[28:31], s58 offen
    v_pk_add_f32 v[234:235], v[234:235], 1.0 op_sel_hi:[1,0]
    v_pk_add_f32 v[236:237], v[236:237], 1.0 op_sel_hi:[1,0]
    v_rcp_f32 v230, v230
    v_rcp_f32 v231, v231
    v_rcp_f32 v232, v232
    v_rcp_f32 v233, v233
    v_rcp_f32 v234, v234
    v_rcp_f32 v235, v235
    v_rcp_f32 v236, v236
    v_rcp_f32 v237, v237
    v_pk_mul_f32 v[168:169], v[168:169], v[230:231]
    v_pk_mul_f32 v[170:171], v[170:171], v[232:233]
    s_add_u32 m0, s55, 49152
    s_nop 0
    buffer_load_dwordx4 v247, s[40:43], s54 offen lds
    s_add_u32 s54, s54, 65536
    v_pk_mul_f32 v[184:185], v[184:185], v[234:235]
    v_pk_mul_f32 v[186:187], v[186:187], v[236:237]
    v_cvt_pk_bf16_f32 v88, v168, v169
    v_cvt_pk_bf16_f32 v89, v170, v171
    v_cvt_pk_bf16_f32 v90, v184, v185
    v_cvt_pk_bf16_f32 v91, v186, v187
    v_pk_mul_f32 v[230:231], v[172:173], v[172:173]
    v_pk_mul_f32 v[232:233], v[174:175], v[174:175]
    v_pk_mul_f32 v[234:235], v[188:189], v[188:189]
    v_pk_mul_f32 v[236:237], v[190:191], v[190:191]
    v_pk_fma_f32 v[230:231], v[230:231], v[238:239], v[238:239] op_sel:[0,0,1] op_sel_hi:[1,0,1]
    v_pk_fma_f32 v[232:233], v[232:233], v[238:239], v[238:239] op_sel:[0,0,1] op_sel_hi:[1,0,1]
    s_add_u32 m0, s55, 53248
    s_nop 0
    buffer_load_dwordx4 v247, s[40:43], s54 offen lds
    s_add_u32 s54, s54, 65536
    v_pk_fma_f32 v[234:235], v[234:235], v[238:239], v[238:239] op_sel:[0,0,1] op_sel_hi:[1,0,1]
    v_pk_fma_f32 v[236:237], v[236:237], v[238:239], v[238:239] op_sel:[0,0,1] op_sel_hi:[1,0,1]
    v_pk_mul_f32 v[230:231], v[230:231], v[172:173]
    v_pk_mul_f32 v[232:233], v[232:233], v[174:175]
    v_pk_mul_f32 v[234:235], v[234:235], v[188:189]
    v_pk_mul_f32 v[236:237], v[236:237], v[190:191]
    v_exp_f32 v230, v230
    v_exp_f32 v231, v231
    v_exp_f32 v232, v232
    v_exp_f32 v233, v233
    v_exp_f32 v234, v234
    v_exp_f32 v235, v235
    s_add_u32 m0, s55, 57344
    s_nop 0
    buffer_load_dwordx4 v247, s[40:43], s54 offen lds
    s_add_u32 s54, s54, 65536
    v_exp_f32 v236, v236
    v_exp_f32 v237, v237
    v_pk_add_f32 v[230:231], v[230:231], 1.0 op_sel_hi:[1,0]
    v_pk_add_f32 v[232:233], v[232:233], 1.0 op_sel_hi:[1,0]
    v_pk_add_f32 v[234:235], v[234:235], 1.0 op_sel_hi:[1,0]
    v_pk_add_f32 v[236:237], v[236:237], 1.0 op_sel_hi:[1,0]
    v_rcp_f32 v230, v230
    v_rcp_f32 v231, v231
    v_rcp_f32 v232, v232
    v_rcp_f32 v233, v233
    v_rcp_f32 v234, v234
    v_rcp_f32 v235, v235
    s_add_u32 m0, s55, 61440
    s_nop 0
    buffer_load_dwordx4 v247, s[40:43], s54 offen lds
    s_add_u32 s54, s54, 65536
    v_rcp_f32 v236, v236
    v_rcp_f32 v237, v237
    v_pk_mul_f32 v[172:173], v[172:173], v[230:231]
    v_pk_mul_f32 v[174:175], v[174:175], v[232:233]
    v_pk_mul_f32 v[188:189], v[188:189], v[234:235]
    v_pk_mul_f32 v[190:191], v[190:191], v[236:237]
    v_cvt_pk_bf16_f32 v92, v172, v173
    v_cvt_pk_bf16_f32 v93, v174, v175
    v_cvt_pk_bf16_f32 v94, v188, v189
    v_cvt_pk_bf16_f32 v95, v190, v191
    v_accvgpr_read_b32 v8, a244
    v_accvgpr_read_b32 v24, a245
    v_accvgpr_read_b32 v40, a246
    v_accvgpr_read_b32 v56, a247
    v_lshlrev_b32 v0, 16, v8
    v_and_b32 v8, 0xffff0000, v8
    v_mov_b32 v1, v0
    v_mov_b64 v[2:3], v[0:1]
    v_mov_b64 v[4:5], v[0:1]
    v_mov_b64 v[6:7], v[0:1]
    v_mov_b32 v9, v8
    v_mov_b64 v[10:11], v[8:9]
    v_mov_b64 v[12:13], v[8:9]
    v_mov_b64 v[14:15], v[8:9]
    v_lshlrev_b32 v16, 16, v24
    v_and_b32 v24, 0xffff0000, v24
    v_mov_b32 v17, v16
    v_mov_b64 v[18:19], v[16:17]
    v_mov_b64 v[20:21], v[16:17]
    v_mov_b64 v[22:23], v[16:17]
    v_mov_b32 v25, v24
    v_mov_b64 v[26:27], v[24:25]
    v_mov_b64 v[28:29], v[24:25]
    v_mov_b64 v[30:31], v[24:25]
    v_lshlrev_b32 v32, 16, v40
    v_and_b32 v40, 0xffff0000, v40
    v_mov_b32 v33, v32
    v_mov_b64 v[34:35], v[32:33]
    v_mov_b64 v[36:37], v[32:33]
    v_mov_b64 v[38:39], v[32:33]
    v_mov_b32 v41, v40
    v_mov_b64 v[42:43], v[40:41]
    v_mov_b64 v[44:45], v[40:41]
    v_mov_b64 v[46:47], v[40:41]
    v_lshlrev_b32 v48, 16, v56
    v_and_b32 v56, 0xffff0000, v56
    v_mov_b32 v49, v48
    v_mov_b64 v[50:51], v[48:49]
    v_mov_b64 v[52:53], v[48:49]
    v_mov_b64 v[54:55], v[48:49]
    v_mov_b32 v57, v56
    v_mov_b64 v[58:59], v[56:57]
    v_mov_b64 v[60:61], v[56:57]
    v_mov_b64 v[62:63], v[56:57]
    s_branch L_k1tail_22
    s_branch L_po_B_0
.p2align 12
L_pg_B_0:
    s_branch L_pg_B_3
L_po_B_0:
L_zB_20:
    s_cmp_ge_u32 s49, 14
    s_cbranch_scc1 L_zC_21
    buffer_load_dwordx4 a[160:163], v224, s[28:31], s52 offen offset:0 sc1
    buffer_load_dwordx4 a[164:167], v250, s[28:31], s52 offen offset:1024 sc1
    buffer_load_dwordx4 a[168:171], v251, s[28:31], s52 offen offset:2048 sc1
    buffer_load_dwordx4 a[172:175], v252, s[28:31], s52 offen offset:3072 sc1
    buffer_load_dwordx4 a[176:179], v224, s[28:31], s53 offen offset:0 sc1
    buffer_load_dwordx4 a[180:183], v250, s[28:31], s53 offen offset:1024 sc1
    buffer_load_dwordx4 a[184:187], v251, s[28:31], s53 offen offset:2048 sc1
    buffer_load_dwordx4 a[188:191], v252, s[28:31], s53 offen offset:3072 sc1
    s_waitcnt vmcnt(4)
    s_mov_b32 s36, s24
    s_mov_b32 s37, s25
    s_mov_b32 s38, 0x2000000
    s_mov_b32 s39, 0x20000
    s_barrier
    ds_read_b64_tr_b16 a[0:1], v241 offset:0
    ds_read_b64_tr_b16 a[2:3], v241 offset:6144
    ds_read_b64_tr_b16 a[4:5], v242 offset:0
    ds_read_b64_tr_b16 a[6:7], v242 offset:6144
    ds_read_b64_tr_b16 a[8:9], v243 offset:0
    ds_read_b64_tr_b16 a[10:11], v243 offset:6144
    ds_read_b64_tr_b16 a[12:13], v244 offset:0
    ds_read_b64_tr_b16 a[14:15], v244 offset:6144
    ds_read_b64_tr_b16 a[16:17], v241 offset:2048
    ds_read_b64_tr_b16 a[18:19], v241 offset:8192
    s_mov_b32 s57, 4
    s_waitcnt lgkmcnt(6)
    v_mfma_f32_16x16x32_bf16 v[0:3], a[160:163], a[0:3], v[0:3]
    ds_read_b64_tr_b16 a[20:21], v242 offset:2048
    s_add_u32 s52, s52, s58
    s_add_u32 s53, s53, s58
    v_mfma_f32_16x16x32_bf16 v[4:7], a[164:167], a[0:3], v[4:7]
    buffer_load_dwordx4 a[32:35], v224, s[28:31], s52 offen offset:0 sc1
    v_mfma_f32_16x16x32_bf16 v[8:11], a[168:171], a[0:3], v[8:11]
    ds_read_b64_tr_b16 a[22:23], v242 offset:8192
    v_mfma_f32_16x16x32_bf16 v[12:15], a[172:175], a[0:3], v[12:15]
    v_mfma_f32_16x16x32_bf16 v[28:31], a[172:175], a[4:7], v[28:31]
    ds_read_b64_tr_b16 a[24:25], v243 offset:2048
    v_mfma_f32_16x16x32_bf16 v[24:27], a[168:171], a[4:7], v[24:27]
    buffer_load_dwordx4 a[36:39], v250, s[28:31], s52 offen offset:1024 sc1
    v_mfma_f32_16x16x32_bf16 v[20:23], a[164:167], a[4:7], v[20:23]
    ds_read_b64_tr_b16 a[26:27], v243 offset:8192
    v_mfma_f32_16x16x32_bf16 v[16:19], a[160:163], a[4:7], v[16:19]
    s_waitcnt lgkmcnt(6)
    v_mfma_f32_16x16x32_bf16 v[32:35], a[160:163], a[8:11], v[32:35]
    ds_read_b64_tr_b16 a[28:29], v244 offset:2048
    v_mfma_f32_16x16x32_bf16 v[36:39], a[164:167], a[8:11], v[36:39]
    buffer_load_dwordx4 a[40:43], v251, s[28:31], s52 offen offset:2048 sc1
    v_mfma_f32_16x16x32_bf16 v[40:43], a[168:171], a[8:11], v[40:43]
    ds_read_b64_tr_b16 a[30:31], v244 offset:8192
    v_mfma_f32_16x16x32_bf16 v[44:47], a[172:175], a[8:11], v[44:47]
    v_mfma_f32_16x16x32_bf16 v[60:63], a[172:175], a[12:15], v[60:63]
    ds_read_b64_tr_b16 a[0:1], v241 offset:4096
    v_mfma_f32_16x16x32_bf16 v[56:59], a[168:171], a[12:15], v[56:59]
    buffer_load_dwordx4 a[44:47], v252, s[28:31], s52 offen offset:3072 sc1
    v_mfma_f32_16x16x32_bf16 v[52:55], a[164:167], a[12:15], v[52:55]
    ds_read_b64_tr_b16 a[2:3], v241 offset:10240
    v_mfma_f32_16x16x32_bf16 v[48:51], a[160:163], a[12:15], v[48:51]
    s_waitcnt lgkmcnt(6)
    v_mfma_f32_16x16x32_bf16 v[64:67], a[160:163], a[16:19], v[64:67]
    ds_read_b64_tr_b16 a[4:5], v242 offset:4096
    v_mfma_f32_16x16x32_bf16 v[68:71], a[164:167], a[16:19], v[68:71]
    buffer_load_dwordx4 a[48:51], v224, s[28:31], s53 offen offset:0 sc1
    v_mfma_f32_16x16x32_bf16 v[72:75], a[168:171], a[16:19], v[72:75]
    ds_read_b64_tr_b16 a[6:7], v242 offset:10240
    v_mfma_f32_16x16x32_bf16 v[76:79], a[172:175], a[16:19], v[76:79]
    v_mfma_f32_16x16x32_bf16 v[92:95], a[172:175], a[20:23], v[92:95]
    ds_read_b64_tr_b16 a[8:9], v243 offset:4096
    v_mfma_f32_16x16x32_bf16 v[88:91], a[168:171], a[20:23], v[88:91]
    buffer_load_dwordx4 a[52:55], v250, s[28:31], s53 offen offset:1024 sc1
    v_mfma_f32_16x16x32_bf16 v[84:87], a[164:167], a[20:23], v[84:87]
    ds_read_b64_tr_b16 a[10:11], v243 offset:10240
    v_mfma_f32_16x16x32_bf16 v[80:83], a[160:163], a[20:23], v[80:83]
    s_waitcnt lgkmcnt(6)
    v_mfma_f32_16x16x32_bf16 v[96:99], a[160:163], a[24:27], v[96:99]
    ds_read_b64_tr_b16 a[12:13], v244 offset:4096
    v_mfma_f32_16x16x32_bf16 v[100:103], a[164:167], a[24:27], v[100:103]
    ds_read_b64_tr_b16 a[14:15], v244 offset:10240
    v_mfma_f32_16x16x32_bf16 v[104:107], a[168:171], a[24:27], v[104:107]
    v_mfma_f32_16x16x32_bf16 v[108:111], a[172:175], a[24:27], v[108:111]
    v_mfma_f32_16x16x32_bf16 v[124:127], a[172:175], a[28:31], v[124:127]
    ds_read_b64_tr_b16 a[16:17], v241 offset:12288
    v_mfma_f32_16x16x32_bf16 v[120:123], a[168:171], a[28:31], v[120:123]
    buffer_load_dwordx4 a[56:59], v251, s[28:31], s53 offen offset:2048 sc1
    v_mfma_f32_16x16x32_bf16 v[116:119], a[164:167], a[28:31], v[116:119]
    ds_read_b64_tr_b16 a[18:19], v241 offset:18432
    v_mfma_f32_16x16x32_bf16 v[112:115], a[160:163], a[28:31], v[112:115]
    s_waitcnt lgkmcnt(6)
    v_mfma_f32_16x16x32_bf16 v[128:131], a[0:3], a[160:163], v[128:131]
    ds_read_b64_tr_b16 a[20:21], v242 offset:12288
    v_mfma_f32_16x16x32_bf16 v[132:135], a[0:3], a[164:167], v[132:135]
    buffer_load_dwordx4 a[60:63], v252, s[28:31], s53 offen offset:3072 sc1
    v_mfma_f32_16x16x32_bf16 v[136:139], a[0:3], a[168:171], v[136:139]
    ds_read_b64_tr_b16 a[22:23], v242 offset:18432
    v_mfma_f32_16x16x32_bf16 v[140:143], a[0:3], a[172:175], v[140:143]
    v_mfma_f32_16x16x32_bf16 v[156:159], a[4:7], a[172:175], v[156:159]
    ds_read_b64_tr_b16 a[24:25], v243 offset:12288
    s_add_u32 m0, s55, 24576
    v_mfma_f32_16x16x32_bf16 v[152:155], a[4:7], a[168:171], v[152:155]
    buffer_load_dwordx4 v227, s[32:35], s64 offen offset:0 lds
    s_add_u32 s64, s64, s59
    v_mfma_f32_16x16x32_bf16 v[148:151], a[4:7], a[164:167], v[148:151]
    ds_read_b64_tr_b16 a[26:27], v243 offset:18432
    v_mfma_f32_16x16x32_bf16 v[144:147], a[4:7], a[160:163], v[144:147]
    s_waitcnt lgkmcnt(6)
    v_mfma_f32_16x16x32_bf16 v[160:163], a[8:11], a[160:163], v[160:163]
    ds_read_b64_tr_b16 a[28:29], v244 offset:12288
    v_mfma_f32_16x16x32_bf16 v[164:167], a[8:11], a[164:167], v[164:167]
    buffer_load_dwordx4 v227, s[32:35], s65 offen offset:1024 lds
    s_add_u32 s65, s65, s59
    v_mfma_f32_16x16x32_bf16 v[168:171], a[8:11], a[168:171], v[168:171]
    ds_read_b64_tr_b16 a[30:31], v244 offset:18432
    v_mfma_f32_16x16x32_bf16 v[172:175], a[8:11], a[172:175], v[172:175]
    v_mfma_f32_16x16x32_bf16 v[188:191], a[12:15], a[172:175], v[188:191]
    ds_read_b64_tr_b16 a[0:1], v241 offset:14336
    v_mfma_f32_16x16x32_bf16 v[184:187], a[12:15], a[168:171], v[184:187]
    buffer_load_dwordx4 v227, s[32:35], s66 offen offset:2048 lds
    s_add_u32 s66, s66, s59
    v_mfma_f32_16x16x32_bf16 v[180:183], a[12:15], a[164:167], v[180:183]
    ds_read_b64_tr_b16 a[2:3], v241 offset:20480
    v_mfma_f32_16x16x32_bf16 v[176:179], a[12:15], a[160:163], v[176:179]
    s_waitcnt vmcnt(11) lgkmcnt(6)
    v_mfma_f32_16x16x32_bf16 v[0:3], a[176:179], a[16:19], v[0:3]
    ds_read_b64_tr_b16 a[4:5], v242 offset:14336
    v_mfma_f32_16x16x32_bf16 v[4:7], a[180:183], a[16:19], v[4:7]
    ds_read_b64_tr_b16 a[6:7], v242 offset:20480
    v_mfma_f32_16x16x32_bf16 v[8:11], a[184:187], a[16:19], v[8:11]
    v_mfma_f32_16x16x32_bf16 v[12:15], a[188:191], a[16:19], v[12:15]
    v_mfma_f32_16x16x32_bf16 v[28:31], a[188:191], a[20:23], v[28:31]
    ds_read_b64_tr_b16 a[8:9], v243 offset:14336
    v_mfma_f32_16x16x32_bf16 v[24:27], a[184:187], a[20:23], v[24:27]
    buffer_load_dwordx4 v227, s[32:35], s67 offen offset:3072 lds
    s_add_u32 s67, s67, s59
    v_mfma_f32_16x16x32_bf16 v[20:23], a[180:183], a[20:23], v[20:23]
    ds_read_b64_tr_b16 a[10:11], v243 offset:20480
    v_mfma_f32_16x16x32_bf16 v[16:19], a[176:179], a[20:23], v[16:19]
    s_waitcnt lgkmcnt(6)
    v_mfma_f32_16x16x32_bf16 v[32:35], a[176:179], a[24:27], v[32:35]
    ds_read_b64_tr_b16 a[12:13], v244 offset:14336
    s_add_u32 m0, s55, 28672
    v_mfma_f32_16x16x32_bf16 v[36:39], a[180:183], a[24:27], v[36:39]
    buffer_load_dwordx4 v227, s[32:35], s68 offen offset:0 lds
    s_add_u32 s68, s68, s59
    v_mfma_f32_16x16x32_bf16 v[40:43], a[184:187], a[24:27], v[40:43]
    ds_read_b64_tr_b16 a[14:15], v244 offset:20480
    v_mfma_f32_16x16x32_bf16 v[44:47], a[188:191], a[24:27], v[44:47]
    v_mfma_f32_16x16x32_bf16 v[60:63], a[188:191], a[28:31], v[60:63]
    ds_read_b64_tr_b16 a[16:17], v241 offset:16384
    v_mfma_f32_16x16x32_bf16 v[56:59], a[184:187], a[28:31], v[56:59]
    buffer_load_dwordx4 v227, s[32:35], s69 offen offset:1024 lds
    s_add_u32 s69, s69, s59
    v_mfma_f32_16x16x32_bf16 v[52:55], a[180:183], a[28:31], v[52:55]
    ds_read_b64_tr_b16 a[18:19], v241 offset:22528
    v_mfma_f32_16x16x32_bf16 v[48:51], a[176:179], a[28:31], v[48:51]
    s_waitcnt lgkmcnt(6)
    v_mfma_f32_16x16x32_bf16 v[64:67], a[176:179], a[0:3], v[64:67]
    ds_read_b64_tr_b16 a[20:21], v242 offset:16384
    s_add_u32 s52, s52, s58
    s_add_u32 s53, s53, s58
    v_mfma_f32_16x16x32_bf16 v[68:71], a[180:183], a[0:3], v[68:71]
    buffer_load_dwordx4 a[64:67], v224, s[28:31], s52 offen offset:0 sc1
    v_mfma_f32_16x16x32_bf16 v[72:75], a[184:187], a[0:3], v[72:75]
    ds_read_b64_tr_b16 a[22:23], v242 offset:22528
    v_mfma_f32_16x16x32_bf16 v[76:79], a[188:191], a[0:3], v[76:79]
    v_mfma_f32_16x16x32_bf16 v[92:95], a[188:191], a[4:7], v[92:95]
    ds_read_b64_tr_b16 a[24:25], v243 offset:16384
    v_mfma_f32_16x16x32_bf16 v[88:91], a[184:187], a[4:7], v[88:91]
    buffer_load_dwordx4 a[68:71], v250, s[28:31], s52 offen offset:1024 sc1
    v_mfma_f32_16x16x32_bf16 v[84:87], a[180:183], a[4:7], v[84:87]
    ds_read_b64_tr_b16 a[26:27], v243 offset:22528
    v_mfma_f32_16x16x32_bf16 v[80:83], a[176:179], a[4:7], v[80:83]
    s_waitcnt lgkmcnt(6)
    v_mfma_f32_16x16x32_bf16 v[96:99], a[176:179], a[8:11], v[96:99]
    ds_read_b64_tr_b16 a[28:29], v244 offset:16384
    v_mfma_f32_16x16x32_bf16 v[100:103], a[180:183], a[8:11], v[100:103]
    ds_read_b64_tr_b16 a[30:31], v244 offset:22528
    v_mfma_f32_16x16x32_bf16 v[104:107], a[184:187], a[8:11], v[104:107]
    v_mfma_f32_16x16x32_bf16 v[108:111], a[188:191], a[8:11], v[108:111]
    s_waitcnt vmcnt(8)
    s_barrier
    v_mfma_f32_16x16x32_bf16 v[124:127], a[188:191], a[12:15], v[124:127]
    ds_read_b64_tr_b16 a[0:1], v229 offset:0
    v_mfma_f32_16x16x32_bf16 v[120:123], a[184:187], a[12:15], v[120:123]
    buffer_load_dwordx4 a[72:75], v251, s[28:31], s52 offen offset:2048 sc1
    v_mfma_f32_16x16x32_bf16 v[116:119], a[180:183], a[12:15], v[116:119]
    ds_read_b64_tr_b16 a[2:3], v229 offset:6144
    v_mfma_f32_16x16x32_bf16 v[112:115], a[176:179], a[12:15], v[112:115]
    s_waitcnt lgkmcnt(6)
    v_mfma_f32_16x16x32_bf16 v[128:131], a[16:19], a[176:179], v[128:131]
    ds_read_b64_tr_b16 a[4:5], v230 offset:0
    v_mfma_f32_16x16x32_bf16 v[132:135], a[16:19], a[180:183], v[132:135]
    buffer_load_dwordx4 a[76:79], v252, s[28:31], s52 offen offset:3072 sc1
    v_mfma_f32_16x16x32_bf16 v[136:139], a[16:19], a[184:187], v[136:139]
    ds_read_b64_tr_b16 a[6:7], v230 offset:6144
    v_mfma_f32_16x16x32_bf16 v[140:143], a[16:19], a[188:191], v[140:143]
    v_mfma_f32_16x16x32_bf16 v[156:159], a[20:23], a[188:191], v[156:159]
    ds_read_b64_tr_b16 a[8:9], v231 offset:0
    v_mfma_f32_16x16x32_bf16 v[152:155], a[20:23], a[184:187], v[152:155]
    buffer_load_dwordx4 a[80:83], v224, s[28:31], s53 offen offset:0 sc1
    v_mfma_f32_16x16x32_bf16 v[148:151], a[20:23], a[180:183], v[148:151]
    ds_read_b64_tr_b16 a[10:11], v231 offset:6144
    v_mfma_f32_16x16x32_bf16 v[144:147], a[20:23], a[176:179], v[144:147]
    s_waitcnt lgkmcnt(6)
    v_mfma_f32_16x16x32_bf16 v[160:163], a[24:27], a[176:179], v[160:163]
    ds_read_b64_tr_b16 a[12:13], v232 offset:0
    v_mfma_f32_16x16x32_bf16 v[164:167], a[24:27], a[180:183], v[164:167]
    buffer_load_dwordx4 a[84:87], v250, s[28:31], s53 offen offset:1024 sc1
    v_mfma_f32_16x16x32_bf16 v[168:171], a[24:27], a[184:187], v[168:171]
    ds_read_b64_tr_b16 a[14:15], v232 offset:6144
    v_mfma_f32_16x16x32_bf16 v[172:175], a[24:27], a[188:191], v[172:175]
    v_mfma_f32_16x16x32_bf16 v[188:191], a[28:31], a[188:191], v[188:191]
    ds_read_b64_tr_b16 a[16:17], v229 offset:2048
    v_mfma_f32_16x16x32_bf16 v[184:187], a[28:31], a[184:187], v[184:187]
    buffer_load_dwordx4 a[88:91], v251, s[28:31], s53 offen offset:2048 sc1
    v_mfma_f32_16x16x32_bf16 v[180:183], a[28:31], a[180:183], v[180:183]
    ds_read_b64_tr_b16 a[18:19], v229 offset:8192
    v_mfma_f32_16x16x32_bf16 v[176:179], a[28:31], a[176:179], v[176:179]
    s_waitcnt lgkmcnt(6)
    v_mfma_f32_16x16x32_bf16 v[0:3], a[32:35], a[0:3], v[0:3]
    ds_read_b64_tr_b16 a[20:21], v230 offset:2048
    v_mfma_f32_16x16x32_bf16 v[4:7], a[36:39], a[0:3], v[4:7]
    buffer_load_dwordx4 a[92:95], v252, s[28:31], s53 offen offset:3072 sc1
    v_mfma_f32_16x16x32_bf16 v[8:11], a[40:43], a[0:3], v[8:11]
    ds_read_b64_tr_b16 a[22:23], v230 offset:8192
    v_mfma_f32_16x16x32_bf16 v[12:15], a[44:47], a[0:3], v[12:15]
    v_mfma_f32_16x16x32_bf16 v[28:31], a[44:47], a[4:7], v[28:31]
    ds_read_b64_tr_b16 a[24:25], v231 offset:2048
    s_add_u32 s52, s52, s58
    s_add_u32 s53, s53, s58
    v_mfma_f32_16x16x32_bf16 v[24:27], a[40:43], a[4:7], v[24:27]
    s_add_u32 s56, s56, 1
    s_add_u32 m0, s55, 49152
    s_nop 0
    buffer_load_dwordx4 v227, s[32:35], s64 offen offset:0 lds
    v_mfma_f32_16x16x32_bf16 v[20:23], a[36:39], a[4:7], v[20:23]
    ds_read_b64_tr_b16 a[26:27], v231 offset:8192
    s_add_u32 s64, s64, s59
    v_mfma_f32_16x16x32_bf16 v[16:19], a[32:35], a[4:7], v[16:19]
    s_waitcnt lgkmcnt(6)
    v_mfma_f32_16x16x32_bf16 v[32:35], a[32:35], a[8:11], v[32:35]
    ds_read_b64_tr_b16 a[28:29], v232 offset:2048
    v_mfma_f32_16x16x32_bf16 v[36:39], a[36:39], a[8:11], v[36:39]
    ds_read_b64_tr_b16 a[30:31], v232 offset:8192
    v_mfma_f32_16x16x32_bf16 v[40:43], a[40:43], a[8:11], v[40:43]
    v_mfma_f32_16x16x32_bf16 v[44:47], a[44:47], a[8:11], v[44:47]
    v_mfma_f32_16x16x32_bf16 v[60:63], a[44:47], a[12:15], v[60:63]
    ds_read_b64_tr_b16 a[0:1], v229 offset:4096
    v_mfma_f32_16x16x32_bf16 v[56:59], a[40:43], a[12:15], v[56:59]
    buffer_load_dwordx4 a[96:99], v224, s[28:31], s52 offen offset:0 sc1
    v_mfma_f32_16x16x32_bf16 v[52:55], a[36:39], a[12:15], v[52:55]
    ds_read_b64_tr_b16 a[2:3], v229 offset:10240
    v_mfma_f32_16x16x32_bf16 v[48:51], a[32:35], a[12:15], v[48:51]
    s_waitcnt lgkmcnt(6)
    v_mfma_f32_16x16x32_bf16 v[64:67], a[32:35], a[16:19], v[64:67]
    ds_read_b64_tr_b16 a[4:5], v230 offset:4096
    v_mfma_f32_16x16x32_bf16 v[68:71], a[36:39], a[16:19], v[68:71]
    buffer_load_dwordx4 v227, s[32:35], s65 offen offset:1024 lds
    s_add_u32 s65, s65, s59
    v_mfma_f32_16x16x32_bf16 v[72:75], a[40:43], a[16:19], v[72:75]
    ds_read_b64_tr_b16 a[6:7], v230 offset:10240
    v_mfma_f32_16x16x32_bf16 v[76:79], a[44:47], a[16:19], v[76:79]
    v_mfma_f32_16x16x32_bf16 v[92:95], a[44:47], a[20:23], v[92:95]
    ds_read_b64_tr_b16 a[8:9], v231 offset:4096
    v_mfma_f32_16x16x32_bf16 v[88:91], a[40:43], a[20:23], v[88:91]
    buffer_load_dwordx4 a[100:103], v250, s[28:31], s52 offen offset:1024 sc1
    v_mfma_f32_16x16x32_bf16 v[84:87], a[36:39], a[20:23], v[84:87]
    ds_read_b64_tr_b16 a[10:11], v231 offset:10240
    v_mfma_f32_16x16x32_bf16 v[80:83], a[32:35], a[20:23], v[80:83]
    s_waitcnt lgkmcnt(6)
    v_mfma_f32_16x16x32_bf16 v[96:99], a[32:35], a[24:27], v[96:99]
    ds_read_b64_tr_b16 a[12:13], v232 offset:4096
    v_mfma_f32_16x16x32_bf16 v[100:103], a[36:39], a[24:27], v[100:103]
    buffer_load_dwordx4 v227, s[32:35], s66 offen offset:2048 lds
    s_add_u32 s66, s66, s59
    v_mfma_f32_16x16x32_bf16 v[104:107], a[40:43], a[24:27], v[104:107]
    ds_read_b64_tr_b16 a[14:15], v232 offset:10240
    v_mfma_f32_16x16x32_bf16 v[108:111], a[44:47], a[24:27], v[108:111]
    v_mfma_f32_16x16x32_bf16 v[124:127], a[44:47], a[28:31], v[124:127]
    ds_read_b64_tr_b16 a[16:17], v229 offset:12288
    v_mfma_f32_16x16x32_bf16 v[120:123], a[40:43], a[28:31], v[120:123]
    buffer_load_dwordx4 a[104:107], v251, s[28:31], s52 offen offset:2048 sc1
    v_mfma_f32_16x16x32_bf16 v[116:119], a[36:39], a[28:31], v[116:119]
    ds_read_b64_tr_b16 a[18:19], v229 offset:18432
    v_mfma_f32_16x16x32_bf16 v[112:115], a[32:35], a[28:31], v[112:115]
    s_waitcnt lgkmcnt(6)
    v_mfma_f32_16x16x32_bf16 v[128:131], a[0:3], a[32:35], v[128:131]
    ds_read_b64_tr_b16 a[20:21], v230 offset:12288
    v_mfma_f32_16x16x32_bf16 v[132:135], a[0:3], a[36:39], v[132:135]
    buffer_load_dwordx4 v227, s[32:35], s67 offen offset:3072 lds
    s_add_u32 s67, s67, s59
    v_mfma_f32_16x16x32_bf16 v[136:139], a[0:3], a[40:43], v[136:139]
    ds_read_b64_tr_b16 a[22:23], v230 offset:18432
    v_mfma_f32_16x16x32_bf16 v[140:143], a[0:3], a[44:47], v[140:143]
    v_mfma_f32_16x16x32_bf16 v[156:159], a[4:7], a[44:47], v[156:159]
    ds_read_b64_tr_b16 a[24:25], v231 offset:12288
    v_mfma_f32_16x16x32_bf16 v[152:155], a[4:7], a[40:43], v[152:155]
    buffer_load_dwordx4 a[108:111], v252, s[28:31], s52 offen offset:3072 sc1
    v_mfma_f32_16x16x32_bf16 v[148:151], a[4:7], a[36:39], v[148:151]
    ds_read_b64_tr_b16 a[26:27], v231 offset:18432
    v_mfma_f32_16x16x32_bf16 v[144:147], a[4:7], a[32:35], v[144:147]
    s_waitcnt lgkmcnt(6)
    v_mfma_f32_16x16x32_bf16 v[160:163], a[8:11], a[32:35], v[160:163]
    ds_read_b64_tr_b16 a[28:29], v232 offset:12288
    v_mfma_f32_16x16x32_bf16 v[164:167], a[8:11], a[36:39], v[164:167]
    ds_read_b64_tr_b16 a[30:31], v232 offset:18432
    v_mfma_f32_16x16x32_bf16 v[168:171], a[8:11], a[40:43], v[168:171]
    v_mfma_f32_16x16x32_bf16 v[172:175], a[8:11], a[44:47], v[172:175]
    v_mfma_f32_16x16x32_bf16 v[188:191], a[12:15], a[44:47], v[188:191]
    ds_read_b64_tr_b16 a[0:1], v229 offset:14336
    s_add_u32 m0, s55, 53248
    v_mfma_f32_16x16x32_bf16 v[184:187], a[12:15], a[40:43], v[184:187]
    buffer_load_dwordx4 v227, s[32:35], s68 offen offset:0 lds
    s_add_u32 s68, s68, s59
    v_mfma_f32_16x16x32_bf16 v[180:183], a[12:15], a[36:39], v[180:183]
    ds_read_b64_tr_b16 a[2:3], v229 offset:20480
    v_mfma_f32_16x16x32_bf16 v[176:179], a[12:15], a[32:35], v[176:179]
    s_waitcnt lgkmcnt(6)
    v_mfma_f32_16x16x32_bf16 v[0:3], a[48:51], a[16:19], v[0:3]
    ds_read_b64_tr_b16 a[4:5], v230 offset:14336
    v_mfma_f32_16x16x32_bf16 v[4:7], a[52:55], a[16:19], v[4:7]
    buffer_load_dwordx4 a[112:115], v224, s[28:31], s53 offen offset:0 sc1
    v_mfma_f32_16x16x32_bf16 v[8:11], a[56:59], a[16:19], v[8:11]
    ds_read_b64_tr_b16 a[6:7], v230 offset:20480
    v_mfma_f32_16x16x32_bf16 v[12:15], a[60:63], a[16:19], v[12:15]
    v_mfma_f32_16x16x32_bf16 v[28:31], a[60:63], a[20:23], v[28:31]
    ds_read_b64_tr_b16 a[8:9], v231 offset:14336
    v_mfma_f32_16x16x32_bf16 v[24:27], a[56:59], a[20:23], v[24:27]
    buffer_load_dwordx4 v227, s[32:35], s69 offen offset:1024 lds
    s_add_u32 s69, s69, s59
    v_mfma_f32_16x16x32_bf16 v[20:23], a[52:55], a[20:23], v[20:23]
    ds_read_b64_tr_b16 a[10:11], v231 offset:20480
    v_mfma_f32_16x16x32_bf16 v[16:19], a[48:51], a[20:23], v[16:19]
    s_waitcnt lgkmcnt(6)
    v_mfma_f32_16x16x32_bf16 v[32:35], a[48:51], a[24:27], v[32:35]
    ds_read_b64_tr_b16 a[12:13], v232 offset:14336
    v_mfma_f32_16x16x32_bf16 v[36:39], a[52:55], a[24:27], v[36:39]
    buffer_load_dwordx4 a[116:119], v250, s[28:31], s53 offen offset:1024 sc1
    v_mfma_f32_16x16x32_bf16 v[40:43], a[56:59], a[24:27], v[40:43]
    ds_read_b64_tr_b16 a[14:15], v232 offset:20480
    v_mfma_f32_16x16x32_bf16 v[44:47], a[60:63], a[24:27], v[44:47]
    v_mfma_f32_16x16x32_bf16 v[60:63], a[60:63], a[28:31], v[60:63]
    ds_read_b64_tr_b16 a[16:17], v229 offset:16384
    v_mfma_f32_16x16x32_bf16 v[56:59], a[56:59], a[28:31], v[56:59]
    buffer_load_dwordx4 a[120:123], v251, s[28:31], s53 offen offset:2048 sc1
    v_mfma_f32_16x16x32_bf16 v[52:55], a[52:55], a[28:31], v[52:55]
    ds_read_b64_tr_b16 a[18:19], v229 offset:22528
    v_mfma_f32_16x16x32_bf16 v[48:51], a[48:51], a[28:31], v[48:51]
    s_waitcnt lgkmcnt(6)
    v_mfma_f32_16x16x32_bf16 v[64:67], a[48:51], a[0:3], v[64:67]
    ds_read_b64_tr_b16 a[20:21], v230 offset:16384
    v_mfma_f32_16x16x32_bf16 v[68:71], a[52:55], a[0:3], v[68:71]
    buffer_load_dwordx4 a[124:127], v252, s[28:31], s53 offen offset:3072 sc1
    v_mfma_f32_16x16x32_bf16 v[72:75], a[56:59], a[0:3], v[72:75]
    ds_read_b64_tr_b16 a[22:23], v230 offset:22528
    v_mfma_f32_16x16x32_bf16 v[76:79], a[60:63], a[0:3], v[76:79]
    v_mfma_f32_16x16x32_bf16 v[92:95], a[60:63], a[4:7], v[92:95]
    ds_read_b64_tr_b16 a[24:25], v231 offset:16384
    s_add_u32 s52, s52, s58
    s_add_u32 s53, s53, s58
    v_mfma_f32_16x16x32_bf16 v[88:91], a[56:59], a[4:7], v[88:91]
    s_add_u32 s56, s56, 1
    s_add_u32 m0, s55, 73728
    s_nop 0
    buffer_load_dwordx4 v227, s[32:35], s64 offen offset:0 lds
    v_mfma_f32_16x16x32_bf16 v[84:87], a[52:55], a[4:7], v[84:87]
    ds_read_b64_tr_b16 a[26:27], v231 offset:22528
    s_add_u32 s64, s64, s59
    v_mfma_f32_16x16x32_bf16 v[80:83], a[48:51], a[4:7], v[80:83]
    s_waitcnt lgkmcnt(6)
    v_mfma_f32_16x16x32_bf16 v[96:99], a[48:51], a[8:11], v[96:99]
    ds_read_b64_tr_b16 a[28:29], v232 offset:16384
    v_mfma_f32_16x16x32_bf16 v[100:103], a[52:55], a[8:11], v[100:103]
    ds_read_b64_tr_b16 a[30:31], v232 offset:22528
    v_mfma_f32_16x16x32_bf16 v[104:107], a[56:59], a[8:11], v[104:107]
    v_mfma_f32_16x16x32_bf16 v[108:111], a[60:63], a[8:11], v[108:111]
    s_waitcnt vmcnt(15)
    s_barrier
    v_mfma_f32_16x16x32_bf16 v[124:127], a[60:63], a[12:15], v[124:127]
    ds_read_b64_tr_b16 a[0:1], v229 offset:24576
    v_mfma_f32_16x16x32_bf16 v[120:123], a[56:59], a[12:15], v[120:123]
    buffer_load_dwordx4 a[128:131], v224, s[28:31], s52 offen offset:0 sc1
    v_mfma_f32_16x16x32_bf16 v[116:119], a[52:55], a[12:15], v[116:119]
    ds_read_b64_tr_b16 a[2:3], v229 offset:30720
    v_mfma_f32_16x16x32_bf16 v[112:115], a[48:51], a[12:15], v[112:115]
    s_waitcnt lgkmcnt(6)
    v_mfma_f32_16x16x32_bf16 v[128:131], a[16:19], a[48:51], v[128:131]
    ds_read_b64_tr_b16 a[4:5], v230 offset:24576
    v_mfma_f32_16x16x32_bf16 v[132:135], a[16:19], a[52:55], v[132:135]
    buffer_load_dwordx4 v227, s[32:35], s65 offen offset:1024 lds
    s_add_u32 s65, s65, s59
    v_mfma_f32_16x16x32_bf16 v[136:139], a[16:19], a[56:59], v[136:139]
    ds_read_b64_tr_b16 a[6:7], v230 offset:30720
    v_mfma_f32_16x16x32_bf16 v[140:143], a[16:19], a[60:63], v[140:143]
    v_mfma_f32_16x16x32_bf16 v[156:159], a[20:23], a[60:63], v[156:159]
    ds_read_b64_tr_b16 a[8:9], v231 offset:24576
    v_mfma_f32_16x16x32_bf16 v[152:155], a[20:23], a[56:59], v[152:155]
    buffer_load_dwordx4 a[132:135], v250, s[28:31], s52 offen offset:1024 sc1
    v_mfma_f32_16x16x32_bf16 v[148:151], a[20:23], a[52:55], v[148:151]
    ds_read_b64_tr_b16 a[10:11], v231 offset:30720
    v_mfma_f32_16x16x32_bf16 v[144:147], a[20:23], a[48:51], v[144:147]
    s_waitcnt lgkmcnt(6)
    v_mfma_f32_16x16x32_bf16 v[160:163], a[24:27], a[48:51], v[160:163]
    ds_read_b64_tr_b16 a[12:13], v232 offset:24576
    v_mfma_f32_16x16x32_bf16 v[164:167], a[24:27], a[52:55], v[164:167]
    buffer_load_dwordx4 v227, s[32:35], s66 offen offset:2048 lds
    s_add_u32 s66, s66, s59
    v_mfma_f32_16x16x32_bf16 v[168:171], a[24:27], a[56:59], v[168:171]
    ds_read_b64_tr_b16 a[14:15], v232 offset:30720
    v_mfma_f32_16x16x32_bf16 v[172:175], a[24:27], a[60:63], v[172:175]
    v_mfma_f32_16x16x32_bf16 v[188:191], a[28:31], a[60:63], v[188:191]
    ds_read_b64_tr_b16 a[16:17], v229 offset:26624
    v_mfma_f32_16x16x32_bf16 v[184:187], a[28:31], a[56:59], v[184:187]
    buffer_load_dwordx4 a[136:139], v251, s[28:31], s52 offen offset:2048 sc1
    v_mfma_f32_16x16x32_bf16 v[180:183], a[28:31], a[52:55], v[180:183]
    ds_read_b64_tr_b16 a[18:19], v229 offset:32768
    v_mfma_f32_16x16x32_bf16 v[176:179], a[28:31], a[48:51], v[176:179]
    s_waitcnt lgkmcnt(6)
    v_mfma_f32_16x16x32_bf16 v[0:3], a[64:67], a[0:3], v[0:3]
    ds_read_b64_tr_b16 a[20:21], v230 offset:26624
    v_mfma_f32_16x16x32_bf16 v[4:7], a[68:71], a[0:3], v[4:7]
    ds_read_b64_tr_b16 a[22:23], v230 offset:32768
    v_mfma_f32_16x16x32_bf16 v[8:11], a[72:75], a[0:3], v[8:11]
    v_mfma_f32_16x16x32_bf16 v[12:15], a[76:79], a[0:3], v[12:15]
    v_mfma_f32_16x16x32_bf16 v[28:31], a[76:79], a[4:7], v[28:31]
    ds_read_b64_tr_b16 a[24:25], v231 offset:26624
    v_mfma_f32_16x16x32_bf16 v[24:27], a[72:75], a[4:7], v[24:27]
    buffer_load_dwordx4 v227, s[32:35], s67 offen offset:3072 lds
    s_add_u32 s67, s67, s59
    v_mfma_f32_16x16x32_bf16 v[20:23], a[68:71], a[4:7], v[20:23]
    ds_read_b64_tr_b16 a[26:27], v231 offset:32768
    v_mfma_f32_16x16x32_bf16 v[16:19], a[64:67], a[4:7], v[16:19]
    s_waitcnt lgkmcnt(6)
    v_mfma_f32_16x16x32_bf16 v[32:35], a[64:67], a[8:11], v[32:35]
    ds_read_b64_tr_b16 a[28:29], v232 offset:26624
    v_mfma_f32_16x16x32_bf16 v[36:39], a[68:71], a[8:11], v[36:39]
    buffer_load_dwordx4 a[140:143], v252, s[28:31], s52 offen offset:3072 sc1
    v_mfma_f32_16x16x32_bf16 v[40:43], a[72:75], a[8:11], v[40:43]
    ds_read_b64_tr_b16 a[30:31], v232 offset:32768
    v_mfma_f32_16x16x32_bf16 v[44:47], a[76:79], a[8:11], v[44:47]
    v_mfma_f32_16x16x32_bf16 v[60:63], a[76:79], a[12:15], v[60:63]
    ds_read_b64_tr_b16 a[0:1], v229 offset:28672
    s_add_u32 m0, s55, 77824
    v_mfma_f32_16x16x32_bf16 v[56:59], a[72:75], a[12:15], v[56:59]
    buffer_load_dwordx4 v227, s[32:35], s68 offen offset:0 lds
    s_add_u32 s68, s68, s59
    v_mfma_f32_16x16x32_bf16 v[52:55], a[68:71], a[12:15], v[52:55]
    ds_read_b64_tr_b16 a[2:3], v229 offset:34816
    v_mfma_f32_16x16x32_bf16 v[48:51], a[64:67], a[12:15], v[48:51]
    s_waitcnt lgkmcnt(6)
    v_mfma_f32_16x16x32_bf16 v[64:67], a[64:67], a[16:19], v[64:67]
    ds_read_b64_tr_b16 a[4:5], v230 offset:28672
    v_mfma_f32_16x16x32_bf16 v[68:71], a[68:71], a[16:19], v[68:71]
    buffer_load_dwordx4 a[144:147], v224, s[28:31], s53 offen offset:0 sc1
    v_mfma_f32_16x16x32_bf16 v[72:75], a[72:75], a[16:19], v[72:75]
    ds_read_b64_tr_b16 a[6:7], v230 offset:34816
    v_mfma_f32_16x16x32_bf16 v[76:79], a[76:79], a[16:19], v[76:79]
    v_mfma_f32_16x16x32_bf16 v[92:95], a[76:79], a[20:23], v[92:95]
    ds_read_b64_tr_b16 a[8:9], v231 offset:28672
    v_mfma_f32_16x16x32_bf16 v[88:91], a[72:75], a[20:23], v[88:91]
    buffer_load_dwordx4 v227, s[32:35], s69 offen offset:1024 lds
    s_add_u32 s69, s69, s59
    v_mfma_f32_16x16x32_bf16 v[84:87], a[68:71], a[20:23], v[84:87]
    ds_read_b64_tr_b16 a[10:11], v231 offset:34816
    v_mfma_f32_16x16x32_bf16 v[80:83], a[64:67], a[20:23], v[80:83]
    s_waitcnt lgkmcnt(6)
    v_mfma_f32_16x16x32_bf16 v[96:99], a[64:67], a[24:27], v[96:99]
    ds_read_b64_tr_b16 a[12:13], v232 offset:28672
    v_mfma_f32_16x16x32_bf16 v[100:103], a[68:71], a[24:27], v[100:103]
    ds_read_b64_tr_b16 a[14:15], v232 offset:34816
    v_mfma_f32_16x16x32_bf16 v[104:107], a[72:75], a[24:27], v[104:107]
    v_mfma_f32_16x16x32_bf16 v[108:111], a[76:79], a[24:27], v[108:111]
    v_mfma_f32_16x16x32_bf16 v[124:127], a[76:79], a[28:31], v[124:127]
    ds_read_b64_tr_b16 a[16:17], v229 offset:36864
    v_mfma_f32_16x16x32_bf16 v[120:123], a[72:75], a[28:31], v[120:123]
    buffer_load_dwordx4 a[148:151], v250, s[28:31], s53 offen offset:1024 sc1
    v_mfma_f32_16x16x32_bf16 v[116:119], a[68:71], a[28:31], v[116:119]
    ds_read_b64_tr_b16 a[18:19], v229 offset:43008
    v_mfma_f32_16x16x32_bf16 v[112:115], a[64:67], a[28:31], v[112:115]
    s_waitcnt lgkmcnt(6)
    v_mfma_f32_16x16x32_bf16 v[128:131], a[0:3], a[64:67], v[128:131]
    ds_read_b64_tr_b16 a[20:21], v230 offset:36864
    v_mfma_f32_16x16x32_bf16 v[132:135], a[0:3], a[68:71], v[132:135]
    buffer_load_dwordx4 a[152:155], v251, s[28:31], s53 offen offset:2048 sc1
    v_mfma_f32_16x16x32_bf16 v[136:139], a[0:3], a[72:75], v[136:139]
    ds_read_b64_tr_b16 a[22:23], v230 offset:43008
    v_mfma_f32_16x16x32_bf16 v[140:143], a[0:3], a[76:79], v[140:143]
    v_mfma_f32_16x16x32_bf16 v[156:159], a[4:7], a[76:79], v[156:159]
    ds_read_b64_tr_b16 a[24:25], v231 offset:36864
    v_mfma_f32_16x16x32_bf16 v[152:155], a[4:7], a[72:75], v[152:155]
    buffer_load_dwordx4 a[156:159], v252, s[28:31], s53 offen offset:3072 sc1
    v_mfma_f32_16x16x32_bf16 v[148:151], a[4:7], a[68:71], v[148:151]
    ds_read_b64_tr_b16 a[26:27], v231 offset:43008
    v_mfma_f32_16x16x32_bf16 v[144:147], a[4:7], a[64:67], v[144:147]
    s_waitcnt lgkmcnt(6)
    v_mfma_f32_16x16x32_bf16 v[160:163], a[8:11], a[64:67], v[160:163]
    ds_read_b64_tr_b16 a[28:29], v232 offset:36864
    s_add_u32 s52, s52, s58
    s_add_u32 s53, s53, s58
    v_mfma_f32_16x16x32_bf16 v[164:167], a[8:11], a[68:71], v[164:167]
    s_add_u32 s56, s56, 1
    s_add_u32 m0, s55, 98304
    s_nop 0
    buffer_load_dwordx4 v227, s[32:35], s64 offen offset:0 lds
    v_mfma_f32_16x16x32_bf16 v[168:171], a[8:11], a[72:75], v[168:171]
    ds_read_b64_tr_b16 a[30:31], v232 offset:43008
    s_add_u32 s64, s64, s59
    v_mfma_f32_16x16x32_bf16 v[172:175], a[8:11], a[76:79], v[172:175]
    v_mfma_f32_16x16x32_bf16 v[188:191], a[12:15], a[76:79], v[188:191]
    ds_read_b64_tr_b16 a[0:1], v229 offset:38912
    v_mfma_f32_16x16x32_bf16 v[184:187], a[12:15], a[72:75], v[184:187]
    buffer_load_dwordx4 a[160:163], v224, s[28:31], s52 offen offset:0 sc1
    v_mfma_f32_16x16x32_bf16 v[180:183], a[12:15], a[68:71], v[180:183]
    ds_read_b64_tr_b16 a[2:3], v229 offset:45056
    v_mfma_f32_16x16x32_bf16 v[176:179], a[12:15], a[64:67], v[176:179]
    s_waitcnt lgkmcnt(6)
    v_mfma_f32_16x16x32_bf16 v[0:3], a[80:83], a[16:19], v[0:3]
    ds_read_b64_tr_b16 a[4:5], v230 offset:38912
    v_mfma_f32_16x16x32_bf16 v[4:7], a[84:87], a[16:19], v[4:7]
    ds_read_b64_tr_b16 a[6:7], v230 offset:45056
    v_mfma_f32_16x16x32_bf16 v[8:11], a[88:91], a[16:19], v[8:11]
    v_mfma_f32_16x16x32_bf16 v[12:15], a[92:95], a[16:19], v[12:15]
    v_mfma_f32_16x16x32_bf16 v[28:31], a[92:95], a[20:23], v[28:31]
    ds_read_b64_tr_b16 a[8:9], v231 offset:38912
    v_mfma_f32_16x16x32_bf16 v[24:27], a[88:91], a[20:23], v[24:27]
    buffer_load_dwordx4 v227, s[32:35], s65 offen offset:1024 lds
    s_add_u32 s65, s65, s59
    v_mfma_f32_16x16x32_bf16 v[20:23], a[84:87], a[20:23], v[20:23]
    ds_read_b64_tr_b16 a[10:11], v231 offset:45056
    v_mfma_f32_16x16x32_bf16 v[16:19], a[80:83], a[20:23], v[16:19]
    s_waitcnt lgkmcnt(6)
    v_mfma_f32_16x16x32_bf16 v[32:35], a[80:83], a[24:27], v[32:35]
    ds_read_b64_tr_b16 a[12:13], v232 offset:38912
    v_mfma_f32_16x16x32_bf16 v[36:39], a[84:87], a[24:27], v[36:39]
    buffer_load_dwordx4 a[164:167], v250, s[28:31], s52 offen offset:1024 sc1
    v_mfma_f32_16x16x32_bf16 v[40:43], a[88:91], a[24:27], v[40:43]
    ds_read_b64_tr_b16 a[14:15], v232 offset:45056
    v_mfma_f32_16x16x32_bf16 v[44:47], a[92:95], a[24:27], v[44:47]
    v_mfma_f32_16x16x32_bf16 v[60:63], a[92:95], a[28:31], v[60:63]
    ds_read_b64_tr_b16 a[16:17], v229 offset:40960
    v_mfma_f32_16x16x32_bf16 v[56:59], a[88:91], a[28:31], v[56:59]
    buffer_load_dwordx4 v227, s[32:35], s66 offen offset:2048 lds
    s_add_u32 s66, s66, s59
    v_mfma_f32_16x16x32_bf16 v[52:55], a[84:87], a[28:31], v[52:55]
    ds_read_b64_tr_b16 a[18:19], v229 offset:47104
    v_mfma_f32_16x16x32_bf16 v[48:51], a[80:83], a[28:31], v[48:51]
    s_waitcnt lgkmcnt(6)
    v_mfma_f32_16x16x32_bf16 v[64:67], a[80:83], a[0:3], v[64:67]
    ds_read_b64_tr_b16 a[20:21], v230 offset:40960
    v_mfma_f32_16x16x32_bf16 v[68:71], a[84:87], a[0:3], v[68:71]
    s_branch L_po_B_1
.p2align 12
L_pg_B_1:
    s_branch L_pg_B_4
L_po_B_1:
    buffer_load_dwordx4 a[168:171], v251, s[28:31], s52 offen offset:2048 sc1
    v_mfma_f32_16x16x32_bf16 v[72:75], a[88:91], a[0:3], v[72:75]
    ds_read_b64_tr_b16 a[22:23], v230 offset:47104
    v_mfma_f32_16x16x32_bf16 v[76:79], a[92:95], a[0:3], v[76:79]
    v_mfma_f32_16x16x32_bf16 v[92:95], a[92:95], a[4:7], v[92:95]
    ds_read_b64_tr_b16 a[24:25], v231 offset:40960
    v_mfma_f32_16x16x32_bf16 v[88:91], a[88:91], a[4:7], v[88:91]
    buffer_load_dwordx4 v227, s[32:35], s67 offen offset:3072 lds
    s_add_u32 s67, s67, s59
    v_mfma_f32_16x16x32_bf16 v[84:87], a[84:87], a[4:7], v[84:87]
    ds_read_b64_tr_b16 a[26:27], v231 offset:47104
    v_mfma_f32_16x16x32_bf16 v[80:83], a[80:83], a[4:7], v[80:83]
    s_waitcnt lgkmcnt(6)
    v_mfma_f32_16x16x32_bf16 v[96:99], a[80:83], a[8:11], v[96:99]
    ds_read_b64_tr_b16 a[28:29], v232 offset:40960
    v_mfma_f32_16x16x32_bf16 v[100:103], a[84:87], a[8:11], v[100:103]
    ds_read_b64_tr_b16 a[30:31], v232 offset:47104
    v_mfma_f32_16x16x32_bf16 v[104:107], a[88:91], a[8:11], v[104:107]
    v_mfma_f32_16x16x32_bf16 v[108:111], a[92:95], a[8:11], v[108:111]
    s_waitcnt vmcnt(21)
    s_barrier
    v_mfma_f32_16x16x32_bf16 v[124:127], a[92:95], a[12:15], v[124:127]
    ds_read_b64_tr_b16 a[0:1], v235 offset:0
    v_mfma_f32_16x16x32_bf16 v[120:123], a[88:91], a[12:15], v[120:123]
    buffer_load_dwordx4 a[172:175], v252, s[28:31], s52 offen offset:3072 sc1
    v_mfma_f32_16x16x32_bf16 v[116:119], a[84:87], a[12:15], v[116:119]
    ds_read_b64_tr_b16 a[2:3], v235 offset:6144
    v_mfma_f32_16x16x32_bf16 v[112:115], a[80:83], a[12:15], v[112:115]
    s_waitcnt lgkmcnt(6)
    v_mfma_f32_16x16x32_bf16 v[128:131], a[16:19], a[80:83], v[128:131]
    ds_read_b64_tr_b16 a[4:5], v236 offset:0
    s_add_u32 m0, s55, 102400
    v_mfma_f32_16x16x32_bf16 v[132:135], a[16:19], a[84:87], v[132:135]
    buffer_load_dwordx4 v227, s[32:35], s68 offen offset:0 lds
    s_add_u32 s68, s68, s59
    v_mfma_f32_16x16x32_bf16 v[136:139], a[16:19], a[88:91], v[136:139]
    ds_read_b64_tr_b16 a[6:7], v236 offset:6144
    v_mfma_f32_16x16x32_bf16 v[140:143], a[16:19], a[92:95], v[140:143]
    v_mfma_f32_16x16x32_bf16 v[156:159], a[20:23], a[92:95], v[156:159]
    ds_read_b64_tr_b16 a[8:9], v237 offset:0
    v_mfma_f32_16x16x32_bf16 v[152:155], a[20:23], a[88:91], v[152:155]
    buffer_load_dwordx4 a[176:179], v224, s[28:31], s53 offen offset:0 sc1
    v_mfma_f32_16x16x32_bf16 v[148:151], a[20:23], a[84:87], v[148:151]
    ds_read_b64_tr_b16 a[10:11], v237 offset:6144
    v_mfma_f32_16x16x32_bf16 v[144:147], a[20:23], a[80:83], v[144:147]
    s_waitcnt lgkmcnt(6)
    v_mfma_f32_16x16x32_bf16 v[160:163], a[24:27], a[80:83], v[160:163]
    ds_read_b64_tr_b16 a[12:13], v238 offset:0
    v_mfma_f32_16x16x32_bf16 v[164:167], a[24:27], a[84:87], v[164:167]
    buffer_load_dwordx4 v227, s[32:35], s69 offen offset:1024 lds
    s_add_u32 s69, s69, s59
    v_mfma_f32_16x16x32_bf16 v[168:171], a[24:27], a[88:91], v[168:171]
    ds_read_b64_tr_b16 a[14:15], v238 offset:6144
    v_mfma_f32_16x16x32_bf16 v[172:175], a[24:27], a[92:95], v[172:175]
    v_mfma_f32_16x16x32_bf16 v[188:191], a[28:31], a[92:95], v[188:191]
    ds_read_b64_tr_b16 a[16:17], v235 offset:2048
    v_mfma_f32_16x16x32_bf16 v[184:187], a[28:31], a[88:91], v[184:187]
    buffer_load_dwordx4 a[180:183], v250, s[28:31], s53 offen offset:1024 sc1
    v_mfma_f32_16x16x32_bf16 v[180:183], a[28:31], a[84:87], v[180:183]
    ds_read_b64_tr_b16 a[18:19], v235 offset:8192
    v_mfma_f32_16x16x32_bf16 v[176:179], a[28:31], a[80:83], v[176:179]
    s_waitcnt lgkmcnt(6)
    v_mfma_f32_16x16x32_bf16 v[0:3], a[96:99], a[0:3], v[0:3]
    ds_read_b64_tr_b16 a[20:21], v236 offset:2048
    v_mfma_f32_16x16x32_bf16 v[4:7], a[100:103], a[0:3], v[4:7]
    buffer_load_dwordx4 a[184:187], v251, s[28:31], s53 offen offset:2048 sc1
    v_mfma_f32_16x16x32_bf16 v[8:11], a[104:107], a[0:3], v[8:11]
    ds_read_b64_tr_b16 a[22:23], v236 offset:8192
    v_mfma_f32_16x16x32_bf16 v[12:15], a[108:111], a[0:3], v[12:15]
    v_mfma_f32_16x16x32_bf16 v[28:31], a[108:111], a[4:7], v[28:31]
    ds_read_b64_tr_b16 a[24:25], v237 offset:2048
    v_mfma_f32_16x16x32_bf16 v[24:27], a[104:107], a[4:7], v[24:27]
    buffer_load_dwordx4 a[188:191], v252, s[28:31], s53 offen offset:3072 sc1
    v_mfma_f32_16x16x32_bf16 v[20:23], a[100:103], a[4:7], v[20:23]
    ds_read_b64_tr_b16 a[26:27], v237 offset:8192
    v_mfma_f32_16x16x32_bf16 v[16:19], a[96:99], a[4:7], v[16:19]
    s_waitcnt lgkmcnt(6)
    v_mfma_f32_16x16x32_bf16 v[32:35], a[96:99], a[8:11], v[32:35]
    ds_read_b64_tr_b16 a[28:29], v238 offset:2048
    v_mfma_f32_16x16x32_bf16 v[36:39], a[100:103], a[8:11], v[36:39]
    ds_read_b64_tr_b16 a[30:31], v238 offset:8192
    v_mfma_f32_16x16x32_bf16 v[40:43], a[104:107], a[8:11], v[40:43]
    v_mfma_f32_16x16x32_bf16 v[44:47], a[108:111], a[8:11], v[44:47]
    v_mfma_f32_16x16x32_bf16 v[60:63], a[108:111], a[12:15], v[60:63]
    ds_read_b64_tr_b16 a[0:1], v235 offset:4096
    s_add_u32 s52, s52, s58
    s_add_u32 s53, s53, s58
    v_mfma_f32_16x16x32_bf16 v[56:59], a[104:107], a[12:15], v[56:59]
    s_add_u32 s56, s56, 1
    s_add_u32 m0, s55, 0
    s_nop 0
    buffer_load_dwordx4 v227, s[32:35], s64 offen offset:0 lds
    v_mfma_f32_16x16x32_bf16 v[52:55], a[100:103], a[12:15], v[52:55]
    ds_read_b64_tr_b16 a[2:3], v235 offset:10240
    s_add_u32 s64, s64, s59
    v_mfma_f32_16x16x32_bf16 v[48:51], a[96:99], a[12:15], v[48:51]
    s_waitcnt lgkmcnt(6)
    v_mfma_f32_16x16x32_bf16 v[64:67], a[96:99], a[16:19], v[64:67]
    ds_read_b64_tr_b16 a[4:5], v236 offset:4096
    v_mfma_f32_16x16x32_bf16 v[68:71], a[100:103], a[16:19], v[68:71]
    buffer_load_dwordx4 a[32:35], v224, s[28:31], s52 offen offset:0 sc1
    v_mfma_f32_16x16x32_bf16 v[72:75], a[104:107], a[16:19], v[72:75]
    ds_read_b64_tr_b16 a[6:7], v236 offset:10240
    v_mfma_f32_16x16x32_bf16 v[76:79], a[108:111], a[16:19], v[76:79]
    v_mfma_f32_16x16x32_bf16 v[92:95], a[108:111], a[20:23], v[92:95]
    ds_read_b64_tr_b16 a[8:9], v237 offset:4096
    v_mfma_f32_16x16x32_bf16 v[88:91], a[104:107], a[20:23], v[88:91]
    buffer_load_dwordx4 v227, s[32:35], s65 offen offset:1024 lds
    s_add_u32 s65, s65, s59
    v_mfma_f32_16x16x32_bf16 v[84:87], a[100:103], a[20:23], v[84:87]
    ds_read_b64_tr_b16 a[10:11], v237 offset:10240
    v_mfma_f32_16x16x32_bf16 v[80:83], a[96:99], a[20:23], v[80:83]
    s_waitcnt lgkmcnt(6)
    v_mfma_f32_16x16x32_bf16 v[96:99], a[96:99], a[24:27], v[96:99]
    ds_read_b64_tr_b16 a[12:13], v238 offset:4096
    v_mfma_f32_16x16x32_bf16 v[100:103], a[100:103], a[24:27], v[100:103]
    buffer_load_dwordx4 a[36:39], v250, s[28:31], s52 offen offset:1024 sc1
    v_mfma_f32_16x16x32_bf16 v[104:107], a[104:107], a[24:27], v[104:107]
    ds_read_b64_tr_b16 a[14:15], v238 offset:10240
    v_mfma_f32_16x16x32_bf16 v[108:111], a[108:111], a[24:27], v[108:111]
    v_mfma_f32_16x16x32_bf16 v[124:127], a[108:111], a[28:31], v[124:127]
    ds_read_b64_tr_b16 a[16:17], v235 offset:12288
    v_mfma_f32_16x16x32_bf16 v[120:123], a[104:107], a[28:31], v[120:123]
    buffer_load_dwordx4 v227, s[32:35], s66 offen offset:2048 lds
    s_add_u32 s66, s66, s59
    v_mfma_f32_16x16x32_bf16 v[116:119], a[100:103], a[28:31], v[116:119]
    ds_read_b64_tr_b16 a[18:19], v235 offset:18432
    v_mfma_f32_16x16x32_bf16 v[112:115], a[96:99], a[28:31], v[112:115]
    s_waitcnt lgkmcnt(6)
    v_mfma_f32_16x16x32_bf16 v[128:131], a[0:3], a[96:99], v[128:131]
    ds_read_b64_tr_b16 a[20:21], v236 offset:12288
    v_mfma_f32_16x16x32_bf16 v[132:135], a[0:3], a[100:103], v[132:135]
    buffer_load_dwordx4 a[40:43], v251, s[28:31], s52 offen offset:2048 sc1
    v_mfma_f32_16x16x32_bf16 v[136:139], a[0:3], a[104:107], v[136:139]
    ds_read_b64_tr_b16 a[22:23], v236 offset:18432
    v_mfma_f32_16x16x32_bf16 v[140:143], a[0:3], a[108:111], v[140:143]
    v_mfma_f32_16x16x32_bf16 v[156:159], a[4:7], a[108:111], v[156:159]
    ds_read_b64_tr_b16 a[24:25], v237 offset:12288
    v_mfma_f32_16x16x32_bf16 v[152:155], a[4:7], a[104:107], v[152:155]
    buffer_load_dwordx4 v227, s[32:35], s67 offen offset:3072 lds
    s_add_u32 s67, s67, s59
    v_mfma_f32_16x16x32_bf16 v[148:151], a[4:7], a[100:103], v[148:151]
    ds_read_b64_tr_b16 a[26:27], v237 offset:18432
    v_mfma_f32_16x16x32_bf16 v[144:147], a[4:7], a[96:99], v[144:147]
    s_waitcnt lgkmcnt(6)
    v_mfma_f32_16x16x32_bf16 v[160:163], a[8:11], a[96:99], v[160:163]
    ds_read_b64_tr_b16 a[28:29], v238 offset:12288
    v_mfma_f32_16x16x32_bf16 v[164:167], a[8:11], a[100:103], v[164:167]
    ds_read_b64_tr_b16 a[30:31], v238 offset:18432
    v_mfma_f32_16x16x32_bf16 v[168:171], a[8:11], a[104:107], v[168:171]
    v_mfma_f32_16x16x32_bf16 v[172:175], a[8:11], a[108:111], v[172:175]
    v_mfma_f32_16x16x32_bf16 v[188:191], a[12:15], a[108:111], v[188:191]
    ds_read_b64_tr_b16 a[0:1], v235 offset:14336
    v_mfma_f32_16x16x32_bf16 v[184:187], a[12:15], a[104:107], v[184:187]
    buffer_load_dwordx4 a[44:47], v252, s[28:31], s52 offen offset:3072 sc1
    v_mfma_f32_16x16x32_bf16 v[180:183], a[12:15], a[100:103], v[180:183]
    ds_read_b64_tr_b16 a[2:3], v235 offset:20480
    v_mfma_f32_16x16x32_bf16 v[176:179], a[12:15], a[96:99], v[176:179]
    s_waitcnt lgkmcnt(6)
    v_mfma_f32_16x16x32_bf16 v[0:3], a[112:115], a[16:19], v[0:3]
    ds_read_b64_tr_b16 a[4:5], v236 offset:14336
    s_add_u32 m0, s55, 4096
    v_mfma_f32_16x16x32_bf16 v[4:7], a[116:119], a[16:19], v[4:7]
    buffer_load_dwordx4 v227, s[32:35], s68 offen offset:0 lds
    s_add_u32 s68, s68, s59
    v_mfma_f32_16x16x32_bf16 v[8:11], a[120:123], a[16:19], v[8:11]
    ds_read_b64_tr_b16 a[6:7], v236 offset:20480
    v_mfma_f32_16x16x32_bf16 v[12:15], a[124:127], a[16:19], v[12:15]
    v_mfma_f32_16x16x32_bf16 v[28:31], a[124:127], a[20:23], v[28:31]
    ds_read_b64_tr_b16 a[8:9], v237 offset:14336
    v_mfma_f32_16x16x32_bf16 v[24:27], a[120:123], a[20:23], v[24:27]
    buffer_load_dwordx4 a[48:51], v224, s[28:31], s53 offen offset:0 sc1
    v_mfma_f32_16x16x32_bf16 v[20:23], a[116:119], a[20:23], v[20:23]
    ds_read_b64_tr_b16 a[10:11], v237 offset:20480
    v_mfma_f32_16x16x32_bf16 v[16:19], a[112:115], a[20:23], v[16:19]
    s_waitcnt lgkmcnt(6)
    v_mfma_f32_16x16x32_bf16 v[32:35], a[112:115], a[24:27], v[32:35]
    ds_read_b64_tr_b16 a[12:13], v238 offset:14336
    v_mfma_f32_16x16x32_bf16 v[36:39], a[116:119], a[24:27], v[36:39]
    buffer_load_dwordx4 v227, s[32:35], s69 offen offset:1024 lds
    s_add_u32 s69, s69, s59
    v_mfma_f32_16x16x32_bf16 v[40:43], a[120:123], a[24:27], v[40:43]
    ds_read_b64_tr_b16 a[14:15], v238 offset:20480
    v_mfma_f32_16x16x32_bf16 v[44:47], a[124:127], a[24:27], v[44:47]
    v_mfma_f32_16x16x32_bf16 v[60:63], a[124:127], a[28:31], v[60:63]
    ds_read_b64_tr_b16 a[16:17], v235 offset:16384
    v_mfma_f32_16x16x32_bf16 v[56:59], a[120:123], a[28:31], v[56:59]
    buffer_load_dwordx4 a[52:55], v250, s[28:31], s53 offen offset:1024 sc1
    v_mfma_f32_16x16x32_bf16 v[52:55], a[116:119], a[28:31], v[52:55]
    ds_read_b64_tr_b16 a[18:19], v235 offset:22528
    v_mfma_f32_16x16x32_bf16 v[48:51], a[112:115], a[28:31], v[48:51]
    s_waitcnt lgkmcnt(6)
    v_mfma_f32_16x16x32_bf16 v[64:67], a[112:115], a[0:3], v[64:67]
    ds_read_b64_tr_b16 a[20:21], v236 offset:16384
    v_mfma_f32_16x16x32_bf16 v[68:71], a[116:119], a[0:3], v[68:71]
    buffer_load_dwordx4 a[56:59], v251, s[28:31], s53 offen offset:2048 sc1
    v_mfma_f32_16x16x32_bf16 v[72:75], a[120:123], a[0:3], v[72:75]
    ds_read_b64_tr_b16 a[22:23], v236 offset:22528
    v_mfma_f32_16x16x32_bf16 v[76:79], a[124:127], a[0:3], v[76:79]
    v_mfma_f32_16x16x32_bf16 v[92:95], a[124:127], a[4:7], v[92:95]
    ds_read_b64_tr_b16 a[24:25], v237 offset:16384
    v_mfma_f32_16x16x32_bf16 v[88:91], a[120:123], a[4:7], v[88:91]
    buffer_load_dwordx4 a[60:63], v252, s[28:31], s53 offen offset:3072 sc1
    v_mfma_f32_16x16x32_bf16 v[84:87], a[116:119], a[4:7], v[84:87]
    ds_read_b64_tr_b16 a[26:27], v237 offset:22528
    v_mfma_f32_16x16x32_bf16 v[80:83], a[112:115], a[4:7], v[80:83]
    s_waitcnt lgkmcnt(6)
    v_mfma_f32_16x16x32_bf16 v[96:99], a[112:115], a[8:11], v[96:99]
    ds_read_b64_tr_b16 a[28:29], v238 offset:16384
    v_mfma_f32_16x16x32_bf16 v[100:103], a[116:119], a[8:11], v[100:103]
    ds_read_b64_tr_b16 a[30:31], v238 offset:22528
    v_mfma_f32_16x16x32_bf16 v[104:107], a[120:123], a[8:11], v[104:107]
    v_mfma_f32_16x16x32_bf16 v[108:111], a[124:127], a[8:11], v[108:111]
    s_waitcnt vmcnt(28)
    s_barrier
    v_mfma_f32_16x16x32_bf16 v[124:127], a[124:127], a[12:15], v[124:127]
    ds_read_b64_tr_b16 a[0:1], v235 offset:24576
    s_add_u32 s52, s52, s58
    s_add_u32 s53, s53, s58
    v_mfma_f32_16x16x32_bf16 v[120:123], a[120:123], a[12:15], v[120:123]
    s_add_u32 s56, s56, 1
    s_add_u32 m0, s55, 24576
    s_nop 0
    buffer_load_dwordx4 v227, s[32:35], s64 offen offset:0 lds
    v_mfma_f32_16x16x32_bf16 v[116:119], a[116:119], a[12:15], v[116:119]
    ds_read_b64_tr_b16 a[2:3], v235 offset:30720
    s_add_u32 s64, s64, s59
    v_mfma_f32_16x16x32_bf16 v[112:115], a[112:115], a[12:15], v[112:115]
    s_waitcnt lgkmcnt(6)
    v_mfma_f32_16x16x32_bf16 v[128:131], a[16:19], a[112:115], v[128:131]
    ds_read_b64_tr_b16 a[4:5], v236 offset:24576
    v_mfma_f32_16x16x32_bf16 v[132:135], a[16:19], a[116:119], v[132:135]
    buffer_load_dwordx4 a[64:67], v224, s[28:31], s52 offen offset:0 sc1
    v_mfma_f32_16x16x32_bf16 v[136:139], a[16:19], a[120:123], v[136:139]
    ds_read_b64_tr_b16 a[6:7], v236 offset:30720
    v_mfma_f32_16x16x32_bf16 v[140:143], a[16:19], a[124:127], v[140:143]
    v_mfma_f32_16x16x32_bf16 v[156:159], a[20:23], a[124:127], v[156:159]
    ds_read_b64_tr_b16 a[8:9], v237 offset:24576
    v_mfma_f32_16x16x32_bf16 v[152:155], a[20:23], a[120:123], v[152:155]
    ds_read_b64_tr_b16 a[10:11], v237 offset:30720
    v_mfma_f32_16x16x32_bf16 v[148:151], a[20:23], a[116:119], v[148:151]
    v_mfma_f32_16x16x32_bf16 v[144:147], a[20:23], a[112:115], v[144:147]
    s_waitcnt lgkmcnt(6)
    v_mfma_f32_16x16x32_bf16 v[160:163], a[24:27], a[112:115], v[160:163]
    ds_read_b64_tr_b16 a[12:13], v238 offset:24576
    v_mfma_f32_16x16x32_bf16 v[164:167], a[24:27], a[116:119], v[164:167]
    buffer_load_dwordx4 v227, s[32:35], s65 offen offset:1024 lds
    s_add_u32 s65, s65, s59
    v_mfma_f32_16x16x32_bf16 v[168:171], a[24:27], a[120:123], v[168:171]
    ds_read_b64_tr_b16 a[14:15], v238 offset:30720
    v_mfma_f32_16x16x32_bf16 v[172:175], a[24:27], a[124:127], v[172:175]
    v_mfma_f32_16x16x32_bf16 v[188:191], a[28:31], a[124:127], v[188:191]
    ds_read_b64_tr_b16 a[16:17], v235 offset:26624
    v_mfma_f32_16x16x32_bf16 v[184:187], a[28:31], a[120:123], v[184:187]
    ds_read_b64_tr_b16 a[18:19], v235 offset:32768
    v_mfma_f32_16x16x32_bf16 v[180:183], a[28:31], a[116:119], v[180:183]
    v_mfma_f32_16x16x32_bf16 v[176:179], a[28:31], a[112:115], v[176:179]
    s_waitcnt lgkmcnt(6)
    v_mfma_f32_16x16x32_bf16 v[0:3], a[128:131], a[0:3], v[0:3]
    ds_read_b64_tr_b16 a[20:21], v236 offset:26624
    v_mfma_f32_16x16x32_bf16 v[4:7], a[132:135], a[0:3], v[4:7]
    buffer_load_dwordx4 a[68:71], v250, s[28:31], s52 offen offset:1024 sc1
    v_mfma_f32_16x16x32_bf16 v[8:11], a[136:139], a[0:3], v[8:11]
    ds_read_b64_tr_b16 a[22:23], v236 offset:32768
    v_mfma_f32_16x16x32_bf16 v[12:15], a[140:143], a[0:3], v[12:15]
    v_mfma_f32_16x16x32_bf16 v[28:31], a[140:143], a[4:7], v[28:31]
    ds_read_b64_tr_b16 a[24:25], v237 offset:26624
    v_mfma_f32_16x16x32_bf16 v[24:27], a[136:139], a[4:7], v[24:27]
    buffer_load_dwordx4 v227, s[32:35], s66 offen offset:2048 lds
    s_add_u32 s66, s66, s59
    v_mfma_f32_16x16x32_bf16 v[20:23], a[132:135], a[4:7], v[20:23]
    ds_read_b64_tr_b16 a[26:27], v237 offset:32768
    v_mfma_f32_16x16x32_bf16 v[16:19], a[128:131], a[4:7], v[16:19]
    s_waitcnt lgkmcnt(6)
    v_mfma_f32_16x16x32_bf16 v[32:35], a[128:131], a[8:11], v[32:35]
    ds_read_b64_tr_b16 a[28:29], v238 offset:26624
    v_mfma_f32_16x16x32_bf16 v[36:39], a[132:135], a[8:11], v[36:39]
    ds_read_b64_tr_b16 a[30:31], v238 offset:32768
    v_mfma_f32_16x16x32_bf16 v[40:43], a[136:139], a[8:11], v[40:43]
    v_mfma_f32_16x16x32_bf16 v[44:47], a[140:143], a[8:11], v[44:47]
    v_mfma_f32_16x16x32_bf16 v[60:63], a[140:143], a[12:15], v[60:63]
    ds_read_b64_tr_b16 a[0:1], v235 offset:28672
    v_mfma_f32_16x16x32_bf16 v[56:59], a[136:139], a[12:15], v[56:59]
    buffer_load_dwordx4 a[72:75], v251, s[28:31], s52 offen offset:2048 sc1
    v_mfma_f32_16x16x32_bf16 v[52:55], a[132:135], a[12:15], v[52:55]
    ds_read_b64_tr_b16 a[2:3], v235 offset:34816
    v_mfma_f32_16x16x32_bf16 v[48:51], a[128:131], a[12:15], v[48:51]
    s_waitcnt lgkmcnt(6)
    v_mfma_f32_16x16x32_bf16 v[64:67], a[128:131], a[16:19], v[64:67]
    ds_read_b64_tr_b16 a[4:5], v236 offset:28672
    v_mfma_f32_16x16x32_bf16 v[68:71], a[132:135], a[16:19], v[68:71]
    ds_read_b64_tr_b16 a[6:7], v236 offset:34816
    v_mfma_f32_16x16x32_bf16 v[72:75], a[136:139], a[16:19], v[72:75]
    v_mfma_f32_16x16x32_bf16 v[76:79], a[140:143], a[16:19], v[76:79]
    v_mfma_f32_16x16x32_bf16 v[92:95], a[140:143], a[20:23], v[92:95]
    ds_read_b64_tr_b16 a[8:9], v237 offset:28672
    v_mfma_f32_16x16x32_bf16 v[88:91], a[136:139], a[20:23], v[88:91]
    buffer_load_dwordx4 v227, s[32:35], s67 offen offset:3072 lds
    s_add_u32 s67, s67, s59
    v_mfma_f32_16x16x32_bf16 v[84:87], a[132:135], a[20:23], v[84:87]
    ds_read_b64_tr_b16 a[10:11], v237 offset:34816
    v_mfma_f32_16x16x32_bf16 v[80:83], a[128:131], a[20:23], v[80:83]
    s_waitcnt lgkmcnt(6)
    v_mfma_f32_16x16x32_bf16 v[96:99], a[128:131], a[24:27], v[96:99]
    ds_read_b64_tr_b16 a[12:13], v238 offset:28672
    v_mfma_f32_16x16x32_bf16 v[100:103], a[132:135], a[24:27], v[100:103]
    ds_read_b64_tr_b16 a[14:15], v238 offset:34816
    v_mfma_f32_16x16x32_bf16 v[104:107], a[136:139], a[24:27], v[104:107]
    v_mfma_f32_16x16x32_bf16 v[108:111], a[140:143], a[24:27], v[108:111]
    v_mfma_f32_16x16x32_bf16 v[124:127], a[140:143], a[28:31], v[124:127]
    ds_read_b64_tr_b16 a[16:17], v235 offset:36864
    v_mfma_f32_16x16x32_bf16 v[120:123], a[136:139], a[28:31], v[120:123]
    buffer_load_dwordx4 a[76:79], v252, s[28:31], s52 offen offset:3072 sc1
    v_mfma_f32_16x16x32_bf16 v[116:119], a[132:135], a[28:31], v[116:119]
    ds_read_b64_tr_b16 a[18:19], v235 offset:43008
    v_mfma_f32_16x16x32_bf16 v[112:115], a[128:131], a[28:31], v[112:115]
    s_waitcnt lgkmcnt(6)
    v_mfma_f32_16x16x32_bf16 v[128:131], a[0:3], a[128:131], v[128:131]
    ds_read_b64_tr_b16 a[20:21], v236 offset:36864
    s_add_u32 m0, s55, 28672
    v_mfma_f32_16x16x32_bf16 v[132:135], a[0:3], a[132:135], v[132:135]
    buffer_load_dwordx4 v227, s[32:35], s68 offen offset:0 lds
    s_add_u32 s68, s68, s59
    v_mfma_f32_16x16x32_bf16 v[136:139], a[0:3], a[136:139], v[136:139]
    ds_read_b64_tr_b16 a[22:23], v236 offset:43008
    v_mfma_f32_16x16x32_bf16 v[140:143], a[0:3], a[140:143], v[140:143]
    v_mfma_f32_16x16x32_bf16 v[156:159], a[4:7], a[140:143], v[156:159]
    ds_read_b64_tr_b16 a[24:25], v237 offset:36864
    v_mfma_f32_16x16x32_bf16 v[152:155], a[4:7], a[136:139], v[152:155]
    ds_read_b64_tr_b16 a[26:27], v237 offset:43008
    v_mfma_f32_16x16x32_bf16 v[148:151], a[4:7], a[132:135], v[148:151]
    v_mfma_f32_16x16x32_bf16 v[144:147], a[4:7], a[128:131], v[144:147]
    s_waitcnt lgkmcnt(6)
    v_mfma_f32_16x16x32_bf16 v[160:163], a[8:11], a[128:131], v[160:163]
    ds_read_b64_tr_b16 a[28:29], v238 offset:36864
    v_mfma_f32_16x16x32_bf16 v[164:167], a[8:11], a[132:135], v[164:167]
    buffer_load_dwordx4 a[80:83], v224, s[28:31], s53 offen offset:0 sc1
    v_mfma_f32_16x16x32_bf16 v[168:171], a[8:11], a[136:139], v[168:171]
    ds_read_b64_tr_b16 a[30:31], v238 offset:43008
    v_mfma_f32_16x16x32_bf16 v[172:175], a[8:11], a[140:143], v[172:175]
    v_mfma_f32_16x16x32_bf16 v[188:191], a[12:15], a[140:143], v[188:191]
    ds_read_b64_tr_b16 a[0:1], v235 offset:38912
    v_mfma_f32_16x16x32_bf16 v[184:187], a[12:15], a[136:139], v[184:187]
    ds_read_b64_tr_b16 a[2:3], v235 offset:45056
    v_mfma_f32_16x16x32_bf16 v[180:183], a[12:15], a[132:135], v[180:183]
    v_mfma_f32_16x16x32_bf16 v[176:179], a[12:15], a[128:131], v[176:179]
    s_waitcnt lgkmcnt(6)
    v_mfma_f32_16x16x32_bf16 v[0:3], a[144:147], a[16:19], v[0:3]
    ds_read_b64_tr_b16 a[4:5], v236 offset:38912
    v_mfma_f32_16x16x32_bf16 v[4:7], a[148:151], a[16:19], v[4:7]
    buffer_load_dwordx4 v227, s[32:35], s69 offen offset:1024 lds
    s_add_u32 s69, s69, s59
    v_mfma_f32_16x16x32_bf16 v[8:11], a[152:155], a[16:19], v[8:11]
    ds_read_b64_tr_b16 a[6:7], v236 offset:45056
    v_mfma_f32_16x16x32_bf16 v[12:15], a[156:159], a[16:19], v[12:15]
    v_mfma_f32_16x16x32_bf16 v[28:31], a[156:159], a[20:23], v[28:31]
    ds_read_b64_tr_b16 a[8:9], v237 offset:38912
    v_mfma_f32_16x16x32_bf16 v[24:27], a[152:155], a[20:23], v[24:27]
    buffer_load_dwordx4 a[84:87], v250, s[28:31], s53 offen offset:1024 sc1
    v_mfma_f32_16x16x32_bf16 v[20:23], a[148:151], a[20:23], v[20:23]
    ds_read_b64_tr_b16 a[10:11], v237 offset:45056
    v_mfma_f32_16x16x32_bf16 v[16:19], a[144:147], a[20:23], v[16:19]
    s_waitcnt lgkmcnt(6)
    v_mfma_f32_16x16x32_bf16 v[32:35], a[144:147], a[24:27], v[32:35]
    ds_read_b64_tr_b16 a[12:13], v238 offset:38912
    v_mfma_f32_16x16x32_bf16 v[36:39], a[148:151], a[24:27], v[36:39]
    ds_read_b64_tr_b16 a[14:15], v238 offset:45056
    v_mfma_f32_16x16x32_bf16 v[40:43], a[152:155], a[24:27], v[40:43]
    v_mfma_f32_16x16x32_bf16 v[44:47], a[156:159], a[24:27], v[44:47]
    v_mfma_f32_16x16x32_bf16 v[60:63], a[156:159], a[28:31], v[60:63]
    ds_read_b64_tr_b16 a[16:17], v235 offset:40960
    v_mfma_f32_16x16x32_bf16 v[56:59], a[152:155], a[28:31], v[56:59]
    buffer_load_dwordx4 a[88:91], v251, s[28:31], s53 offen offset:2048 sc1
    v_mfma_f32_16x16x32_bf16 v[52:55], a[148:151], a[28:31], v[52:55]
    ds_read_b64_tr_b16 a[18:19], v235 offset:47104
    v_mfma_f32_16x16x32_bf16 v[48:51], a[144:147], a[28:31], v[48:51]
    s_waitcnt lgkmcnt(6)
    v_mfma_f32_16x16x32_bf16 v[64:67], a[144:147], a[0:3], v[64:67]
    ds_read_b64_tr_b16 a[20:21], v236 offset:40960
    v_mfma_f32_16x16x32_bf16 v[68:71], a[148:151], a[0:3], v[68:71]
    ds_read_b64_tr_b16 a[22:23], v236 offset:47104
    v_mfma_f32_16x16x32_bf16 v[72:75], a[152:155], a[0:3], v[72:75]
    v_mfma_f32_16x16x32_bf16 v[76:79], a[156:159], a[0:3], v[76:79]
    v_mfma_f32_16x16x32_bf16 v[92:95], a[156:159], a[4:7], v[92:95]
    ds_read_b64_tr_b16 a[24:25], v237 offset:40960
    v_mfma_f32_16x16x32_bf16 v[88:91], a[152:155], a[4:7], v[88:91]
    buffer_load_dwordx4 a[92:95], v252, s[28:31], s53 offen offset:3072 sc1
    v_mfma_f32_16x16x32_bf16 v[84:87], a[148:151], a[4:7], v[84:87]
    ds_read_b64_tr_b16 a[26:27], v237 offset:47104
    v_mfma_f32_16x16x32_bf16 v[80:83], a[144:147], a[4:7], v[80:83]
    s_waitcnt lgkmcnt(6)
    v_mfma_f32_16x16x32_bf16 v[96:99], a[144:147], a[8:11], v[96:99]
    ds_read_b64_tr_b16 a[28:29], v238 offset:40960
    v_mfma_f32_16x16x32_bf16 v[100:103], a[148:151], a[8:11], v[100:103]
    ds_read_b64_tr_b16 a[30:31], v238 offset:47104
    v_mfma_f32_16x16x32_bf16 v[104:107], a[152:155], a[8:11], v[104:107]
    v_mfma_f32_16x16x32_bf16 v[108:111], a[156:159], a[8:11], v[108:111]
    s_waitcnt vmcnt(28)
    s_barrier
    v_mfma_f32_16x16x32_bf16 v[124:127], a[156:159], a[12:15], v[124:127]
    ds_read_b64_tr_b16 a[0:1], v241 offset:0
    s_add_u32 s52, s52, s58
    s_add_u32 s53, s53, s58
    v_mfma_f32_16x16x32_bf16 v[120:123], a[152:155], a[12:15], v[120:123]
    s_add_u32 s56, s56, 1
    s_add_u32 m0, s55, 49152
    s_nop 0
    buffer_load_dwordx4 v227, s[32:35], s64 offen offset:0 lds
    v_mfma_f32_16x16x32_bf16 v[116:119], a[148:151], a[12:15], v[116:119]
    ds_read_b64_tr_b16 a[2:3], v241 offset:6144
    s_add_u32 s64, s64, s59
    v_mfma_f32_16x16x32_bf16 v[112:115], a[144:147], a[12:15], v[112:115]
    s_waitcnt lgkmcnt(6)
    v_mfma_f32_16x16x32_bf16 v[128:131], a[16:19], a[144:147], v[128:131]
    ds_read_b64_tr_b16 a[4:5], v242 offset:0
    v_mfma_f32_16x16x32_bf16 v[132:135], a[16:19], a[148:151], v[132:135]
    buffer_load_dwordx4 a[96:99], v224, s[28:31], s52 offen offset:0 sc1
    v_mfma_f32_16x16x32_bf16 v[136:139], a[16:19], a[152:155], v[136:139]
    ds_read_b64_tr_b16 a[6:7], v242 offset:6144
    v_mfma_f32_16x16x32_bf16 v[140:143], a[16:19], a[156:159], v[140:143]
    v_mfma_f32_16x16x32_bf16 v[156:159], a[20:23], a[156:159], v[156:159]
    ds_read_b64_tr_b16 a[8:9], v243 offset:0
    v_mfma_f32_16x16x32_bf16 v[152:155], a[20:23], a[152:155], v[152:155]
    ds_read_b64_tr_b16 a[10:11], v243 offset:6144
    v_mfma_f32_16x16x32_bf16 v[148:151], a[20:23], a[148:151], v[148:151]
    v_mfma_f32_16x16x32_bf16 v[144:147], a[20:23], a[144:147], v[144:147]
    s_waitcnt lgkmcnt(6)
    v_mfma_f32_16x16x32_bf16 v[160:163], a[24:27], a[144:147], v[160:163]
    ds_read_b64_tr_b16 a[12:13], v244 offset:0
    v_mfma_f32_16x16x32_bf16 v[164:167], a[24:27], a[148:151], v[164:167]
    buffer_load_dwordx4 v227, s[32:35], s65 offen offset:1024 lds
    s_add_u32 s65, s65, s59
    v_mfma_f32_16x16x32_bf16 v[168:171], a[24:27], a[152:155], v[168:171]
    ds_read_b64_tr_b16 a[14:15], v244 offset:6144
    v_mfma_f32_16x16x32_bf16 v[172:175], a[24:27], a[156:159], v[172:175]
    v_mfma_f32_16x16x32_bf16 v[188:191], a[28:31], a[156:159], v[188:191]
    ds_read_b64_tr_b16 a[16:17], v241 offset:2048
    v_mfma_f32_16x16x32_bf16 v[184:187], a[28:31], a[152:155], v[184:187]
    ds_read_b64_tr_b16 a[18:19], v241 offset:8192
    v_mfma_f32_16x16x32_bf16 v[180:183], a[28:31], a[148:151], v[180:183]
    v_mfma_f32_16x16x32_bf16 v[176:179], a[28:31], a[144:147], v[176:179]
    s_waitcnt lgkmcnt(6)
    v_mfma_f32_16x16x32_bf16 v[0:3], a[160:163], a[0:3], v[0:3]
    ds_read_b64_tr_b16 a[20:21], v242 offset:2048
    v_mfma_f32_16x16x32_bf16 v[4:7], a[164:167], a[0:3], v[4:7]
    buffer_load_dwordx4 a[100:103], v250, s[28:31], s52 offen offset:1024 sc1
    v_mfma_f32_16x16x32_bf16 v[8:11], a[168:171], a[0:3], v[8:11]
    ds_read_b64_tr_b16 a[22:23], v242 offset:8192
    v_mfma_f32_16x16x32_bf16 v[12:15], a[172:175], a[0:3], v[12:15]
    v_mfma_f32_16x16x32_bf16 v[28:31], a[172:175], a[4:7], v[28:31]
    ds_read_b64_tr_b16 a[24:25], v243 offset:2048
    v_mfma_f32_16x16x32_bf16 v[24:27], a[168:171], a[4:7], v[24:27]
    buffer_load_dwordx4 v227, s[32:35], s66 offen offset:2048 lds
    s_add_u32 s66, s66, s59
    v_mfma_f32_16x16x32_bf16 v[20:23], a[164:167], a[4:7], v[20:23]
    ds_read_b64_tr_b16 a[26:27], v243 offset:8192
    v_mfma_f32_16x16x32_bf16 v[16:19], a[160:163], a[4:7], v[16:19]
    s_waitcnt lgkmcnt(6)
    v_mfma_f32_16x16x32_bf16 v[32:35], a[160:163], a[8:11], v[32:35]
    ds_read_b64_tr_b16 a[28:29], v244 offset:2048
    v_mfma_f32_16x16x32_bf16 v[36:39], a[164:167], a[8:11], v[36:39]
    ds_read_b64_tr_b16 a[30:31], v244 offset:8192
    v_mfma_f32_16x16x32_bf16 v[40:43], a[168:171], a[8:11], v[40:43]
    v_mfma_f32_16x16x32_bf16 v[44:47], a[172:175], a[8:11], v[44:47]
    v_mfma_f32_16x16x32_bf16 v[60:63], a[172:175], a[12:15], v[60:63]
    ds_read_b64_tr_b16 a[0:1], v241 offset:4096
    v_mfma_f32_16x16x32_bf16 v[56:59], a[168:171], a[12:15], v[56:59]
    buffer_load_dwordx4 a[104:107], v251, s[28:31], s52 offen offset:2048 sc1
    v_mfma_f32_16x16x32_bf16 v[52:55], a[164:167], a[12:15], v[52:55]
    ds_read_b64_tr_b16 a[2:3], v241 offset:10240
    v_mfma_f32_16x16x32_bf16 v[48:51], a[160:163], a[12:15], v[48:51]
    s_waitcnt lgkmcnt(6)
    v_mfma_f32_16x16x32_bf16 v[64:67], a[160:163], a[16:19], v[64:67]
    ds_read_b64_tr_b16 a[4:5], v242 offset:4096
    v_mfma_f32_16x16x32_bf16 v[68:71], a[164:167], a[16:19], v[68:71]
    ds_read_b64_tr_b16 a[6:7], v242 offset:10240
    v_mfma_f32_16x16x32_bf16 v[72:75], a[168:171], a[16:19], v[72:75]
    v_mfma_f32_16x16x32_bf16 v[76:79], a[172:175], a[16:19], v[76:79]
    v_mfma_f32_16x16x32_bf16 v[92:95], a[172:175], a[20:23], v[92:95]
    ds_read_b64_tr_b16 a[8:9], v243 offset:4096
    v_mfma_f32_16x16x32_bf16 v[88:91], a[168:171], a[20:23], v[88:91]
    buffer_load_dwordx4 v227, s[32:35], s67 offen offset:3072 lds
    s_add_u32 s67, s67, s59
    v_mfma_f32_16x16x32_bf16 v[84:87], a[164:167], a[20:23], v[84:87]
    ds_read_b64_tr_b16 a[10:11], v243 offset:10240
    v_mfma_f32_16x16x32_bf16 v[80:83], a[160:163], a[20:23], v[80:83]
    s_waitcnt lgkmcnt(6)
    v_mfma_f32_16x16x32_bf16 v[96:99], a[160:163], a[24:27], v[96:99]
    ds_read_b64_tr_b16 a[12:13], v244 offset:4096
    v_mfma_f32_16x16x32_bf16 v[100:103], a[164:167], a[24:27], v[100:103]
    ds_read_b64_tr_b16 a[14:15], v244 offset:10240
    v_mfma_f32_16x16x32_bf16 v[104:107], a[168:171], a[24:27], v[104:107]
    v_mfma_f32_16x16x32_bf16 v[108:111], a[172:175], a[24:27], v[108:111]
    v_mfma_f32_16x16x32_bf16 v[124:127], a[172:175], a[28:31], v[124:127]
    ds_read_b64_tr_b16 a[16:17], v241 offset:12288
    v_mfma_f32_16x16x32_bf16 v[120:123], a[168:171], a[28:31], v[120:123]
    buffer_load_dwordx4 a[108:111], v252, s[28:31], s52 offen offset:3072 sc1
    v_mfma_f32_16x16x32_bf16 v[116:119], a[164:167], a[28:31], v[116:119]
    ds_read_b64_tr_b16 a[18:19], v241 offset:18432
    v_mfma_f32_16x16x32_bf16 v[112:115], a[160:163], a[28:31], v[112:115]
    s_waitcnt lgkmcnt(6)
    v_mfma_f32_16x16x32_bf16 v[128:131], a[0:3], a[160:163], v[128:131]
    ds_read_b64_tr_b16 a[20:21], v242 offset:12288
    s_add_u32 m0, s55, 53248
    v_mfma_f32_16x16x32_bf16 v[132:135], a[0:3], a[164:167], v[132:135]
    buffer_load_dwordx4 v227, s[32:35], s68 offen offset:0 lds
    s_add_u32 s68, s68, s59
    v_mfma_f32_16x16x32_bf16 v[136:139], a[0:3], a[168:171], v[136:139]
    ds_read_b64_tr_b16 a[22:23], v242 offset:18432
    v_mfma_f32_16x16x32_bf16 v[140:143], a[0:3], a[172:175], v[140:143]
    v_mfma_f32_16x16x32_bf16 v[156:159], a[4:7], a[172:175], v[156:159]
    ds_read_b64_tr_b16 a[24:25], v243 offset:12288
    v_mfma_f32_16x16x32_bf16 v[152:155], a[4:7], a[168:171], v[152:155]
    ds_read_b64_tr_b16 a[26:27], v243 offset:18432
    v_mfma_f32_16x16x32_bf16 v[148:151], a[4:7], a[164:167], v[148:151]
    v_mfma_f32_16x16x32_bf16 v[144:147], a[4:7], a[160:163], v[144:147]
    s_waitcnt lgkmcnt(6)
    v_mfma_f32_16x16x32_bf16 v[160:163], a[8:11], a[160:163], v[160:163]
    ds_read_b64_tr_b16 a[28:29], v244 offset:12288
    v_mfma_f32_16x16x32_bf16 v[164:167], a[8:11], a[164:167], v[164:167]
    buffer_load_dwordx4 a[112:115], v224, s[28:31], s53 offen offset:0 sc1
    v_mfma_f32_16x16x32_bf16 v[168:171], a[8:11], a[168:171], v[168:171]
    ds_read_b64_tr_b16 a[30:31], v244 offset:18432
    v_mfma_f32_16x16x32_bf16 v[172:175], a[8:11], a[172:175], v[172:175]
    v_mfma_f32_16x16x32_bf16 v[188:191], a[12:15], a[172:175], v[188:191]
    ds_read_b64_tr_b16 a[0:1], v241 offset:14336
    v_mfma_f32_16x16x32_bf16 v[184:187], a[12:15], a[168:171], v[184:187]
    ds_read_b64_tr_b16 a[2:3], v241 offset:20480
    v_mfma_f32_16x16x32_bf16 v[180:183], a[12:15], a[164:167], v[180:183]
    v_mfma_f32_16x16x32_bf16 v[176:179], a[12:15], a[160:163], v[176:179]
    s_waitcnt lgkmcnt(6)
    v_mfma_f32_16x16x32_bf16 v[0:3], a[176:179], a[16:19], v[0:3]
    ds_read_b64_tr_b16 a[4:5], v242 offset:14336
    v_mfma_f32_16x16x32_bf16 v[4:7], a[180:183], a[16:19], v[4:7]
    buffer_load_dwordx4 v227, s[32:35], s69 offen offset:1024 lds
    s_add_u32 s69, s69, s59
    v_mfma_f32_16x16x32_bf16 v[8:11], a[184:187], a[16:19], v[8:11]
    ds_read_b64_tr_b16 a[6:7], v242 offset:20480
    v_mfma_f32_16x16x32_bf16 v[12:15], a[188:191], a[16:19], v[12:15]
    v_mfma_f32_16x16x32_bf16 v[28:31], a[188:191], a[20:23], v[28:31]
    ds_read_b64_tr_b16 a[8:9], v243 offset:14336
    v_mfma_f32_16x16x32_bf16 v[24:27], a[184:187], a[20:23], v[24:27]
    buffer_load_dwordx4 a[116:119], v250, s[28:31], s53 offen offset:1024 sc1
    v_mfma_f32_16x16x32_bf16 v[20:23], a[180:183], a[20:23], v[20:23]
    ds_read_b64_tr_b16 a[10:11], v243 offset:20480
    v_mfma_f32_16x16x32_bf16 v[16:19], a[176:179], a[20:23], v[16:19]
    s_branch L_po_B_2
.p2align 12
L_pg_B_2:
    s_branch L_pg_B_5
L_po_B_2:
    s_waitcnt lgkmcnt(6)
    v_mfma_f32_16x16x32_bf16 v[32:35], a[176:179], a[24:27], v[32:35]
    ds_read_b64_tr_b16 a[12:13], v244 offset:14336
    v_mfma_f32_16x16x32_bf16 v[36:39], a[180:183], a[24:27], v[36:39]
    ds_read_b64_tr_b16 a[14:15], v244 offset:20480
    v_mfma_f32_16x16x32_bf16 v[40:43], a[184:187], a[24:27], v[40:43]
    v_mfma_f32_16x16x32_bf16 v[44:47], a[188:191], a[24:27], v[44:47]
    v_mfma_f32_16x16x32_bf16 v[60:63], a[188:191], a[28:31], v[60:63]
    ds_read_b64_tr_b16 a[16:17], v241 offset:16384
    v_mfma_f32_16x16x32_bf16 v[56:59], a[184:187], a[28:31], v[56:59]
    buffer_load_dwordx4 a[120:123], v251, s[28:31], s53 offen offset:2048 sc1
    v_mfma_f32_16x16x32_bf16 v[52:55], a[180:183], a[28:31], v[52:55]
    ds_read_b64_tr_b16 a[18:19], v241 offset:22528
    v_mfma_f32_16x16x32_bf16 v[48:51], a[176:179], a[28:31], v[48:51]
    s_waitcnt lgkmcnt(6)
    v_mfma_f32_16x16x32_bf16 v[64:67], a[176:179], a[0:3], v[64:67]
    ds_read_b64_tr_b16 a[20:21], v242 offset:16384
    v_mfma_f32_16x16x32_bf16 v[68:71], a[180:183], a[0:3], v[68:71]
    ds_read_b64_tr_b16 a[22:23], v242 offset:22528
    v_mfma_f32_16x16x32_bf16 v[72:75], a[184:187], a[0:3], v[72:75]
    v_mfma_f32_16x16x32_bf16 v[76:79], a[188:191], a[0:3], v[76:79]
    v_mfma_f32_16x16x32_bf16 v[92:95], a[188:191], a[4:7], v[92:95]
    ds_read_b64_tr_b16 a[24:25], v243 offset:16384
    v_mfma_f32_16x16x32_bf16 v[88:91], a[184:187], a[4:7], v[88:91]
    buffer_load_dwordx4 a[124:127], v252, s[28:31], s53 offen offset:3072 sc1
    v_mfma_f32_16x16x32_bf16 v[84:87], a[180:183], a[4:7], v[84:87]
    ds_read_b64_tr_b16 a[26:27], v243 offset:22528
    v_mfma_f32_16x16x32_bf16 v[80:83], a[176:179], a[4:7], v[80:83]
    s_waitcnt lgkmcnt(6)
    v_mfma_f32_16x16x32_bf16 v[96:99], a[176:179], a[8:11], v[96:99]
    ds_read_b64_tr_b16 a[28:29], v244 offset:16384
    v_mfma_f32_16x16x32_bf16 v[100:103], a[180:183], a[8:11], v[100:103]
    ds_read_b64_tr_b16 a[30:31], v244 offset:22528
    v_mfma_f32_16x16x32_bf16 v[104:107], a[184:187], a[8:11], v[104:107]
    v_mfma_f32_16x16x32_bf16 v[108:111], a[188:191], a[8:11], v[108:111]
    s_waitcnt vmcnt(28)
    s_barrier
    v_mfma_f32_16x16x32_bf16 v[124:127], a[188:191], a[12:15], v[124:127]
    ds_read_b64_tr_b16 a[0:1], v229 offset:0
    s_add_u32 s52, s52, s58
    s_add_u32 s53, s53, s58
    v_mfma_f32_16x16x32_bf16 v[120:123], a[184:187], a[12:15], v[120:123]
    s_add_u32 s56, s56, 1
    s_add_u32 m0, s55, 73728
    s_nop 0
    buffer_load_dwordx4 v227, s[32:35], s64 offen offset:0 lds
    v_mfma_f32_16x16x32_bf16 v[116:119], a[180:183], a[12:15], v[116:119]
    ds_read_b64_tr_b16 a[2:3], v229 offset:6144
    s_add_u32 s64, s64, s59
    v_mfma_f32_16x16x32_bf16 v[112:115], a[176:179], a[12:15], v[112:115]
    s_waitcnt lgkmcnt(6)
    v_mfma_f32_16x16x32_bf16 v[128:131], a[16:19], a[176:179], v[128:131]
    ds_read_b64_tr_b16 a[4:5], v230 offset:0
    v_mfma_f32_16x16x32_bf16 v[132:135], a[16:19], a[180:183], v[132:135]
    buffer_load_dwordx4 a[128:131], v224, s[28:31], s52 offen offset:0 sc1
    v_mfma_f32_16x16x32_bf16 v[136:139], a[16:19], a[184:187], v[136:139]
    ds_read_b64_tr_b16 a[6:7], v230 offset:6144
    v_mfma_f32_16x16x32_bf16 v[140:143], a[16:19], a[188:191], v[140:143]
    v_mfma_f32_16x16x32_bf16 v[156:159], a[20:23], a[188:191], v[156:159]
    ds_read_b64_tr_b16 a[8:9], v231 offset:0
    v_mfma_f32_16x16x32_bf16 v[152:155], a[20:23], a[184:187], v[152:155]
    ds_read_b64_tr_b16 a[10:11], v231 offset:6144
    v_mfma_f32_16x16x32_bf16 v[148:151], a[20:23], a[180:183], v[148:151]
    v_mfma_f32_16x16x32_bf16 v[144:147], a[20:23], a[176:179], v[144:147]
    s_waitcnt lgkmcnt(6)
    v_mfma_f32_16x16x32_bf16 v[160:163], a[24:27], a[176:179], v[160:163]
    ds_read_b64_tr_b16 a[12:13], v232 offset:0
    v_mfma_f32_16x16x32_bf16 v[164:167], a[24:27], a[180:183], v[164:167]
    buffer_load_dwordx4 v227, s[32:35], s65 offen offset:1024 lds
    s_add_u32 s65, s65, s59
    v_mfma_f32_16x16x32_bf16 v[168:171], a[24:27], a[184:187], v[168:171]
    ds_read_b64_tr_b16 a[14:15], v232 offset:6144
    v_mfma_f32_16x16x32_bf16 v[172:175], a[24:27], a[188:191], v[172:175]
    v_mfma_f32_16x16x32_bf16 v[188:191], a[28:31], a[188:191], v[188:191]
    ds_read_b64_tr_b16 a[16:17], v229 offset:2048
    v_mfma_f32_16x16x32_bf16 v[184:187], a[28:31], a[184:187], v[184:187]
    ds_read_b64_tr_b16 a[18:19], v229 offset:8192
    v_mfma_f32_16x16x32_bf16 v[180:183], a[28:31], a[180:183], v[180:183]
    v_mfma_f32_16x16x32_bf16 v[176:179], a[28:31], a[176:179], v[176:179]
    s_sub_u32 s57, s57, 2
.p2align 3
L_loop_37:
    s_waitcnt lgkmcnt(6)
    v_mfma_f32_16x16x32_bf16 v[0:3], a[32:35], a[0:3], v[0:3]
    ds_read_b64_tr_b16 a[20:21], v230 offset:2048
    v_mfma_f32_16x16x32_bf16 v[4:7], a[36:39], a[0:3], v[4:7]
    buffer_load_dwordx4 a[132:135], v250, s[28:31], s52 offen offset:1024 sc1
    v_mfma_f32_16x16x32_bf16 v[8:11], a[40:43], a[0:3], v[8:11]
    ds_read_b64_tr_b16 a[22:23], v230 offset:8192
    v_mfma_f32_16x16x32_bf16 v[12:15], a[44:47], a[0:3], v[12:15]
    v_mfma_f32_16x16x32_bf16 v[28:31], a[44:47], a[4:7], v[28:31]
    ds_read_b64_tr_b16 a[24:25], v231 offset:2048
    v_mfma_f32_16x16x32_bf16 v[24:27], a[40:43], a[4:7], v[24:27]
    buffer_load_dwordx4 v227, s[32:35], s66 offen offset:2048 lds
    s_add_u32 s66, s66, s59
    v_mfma_f32_16x16x32_bf16 v[20:23], a[36:39], a[4:7], v[20:23]
    ds_read_b64_tr_b16 a[26:27], v231 offset:8192
    v_mfma_f32_16x16x32_bf16 v[16:19], a[32:35], a[4:7], v[16:19]
    s_waitcnt lgkmcnt(6)
    v_mfma_f32_16x16x32_bf16 v[32:35], a[32:35], a[8:11], v[32:35]
    ds_read_b64_tr_b16 a[28:29], v232 offset:2048
    v_mfma_f32_16x16x32_bf16 v[36:39], a[36:39], a[8:11], v[36:39]
    ds_read_b64_tr_b16 a[30:31], v232 offset:8192
    v_mfma_f32_16x16x32_bf16 v[40:43], a[40:43], a[8:11], v[40:43]
    v_mfma_f32_16x16x32_bf16 v[44:47], a[44:47], a[8:11], v[44:47]
    v_mfma_f32_16x16x32_bf16 v[60:63], a[44:47], a[12:15], v[60:63]
    ds_read_b64_tr_b16 a[0:1], v229 offset:4096
    v_mfma_f32_16x16x32_bf16 v[56:59], a[40:43], a[12:15], v[56:59]
    buffer_load_dwordx4 a[136:139], v251, s[28:31], s52 offen offset:2048 sc1
    v_mfma_f32_16x16x32_bf16 v[52:55], a[36:39], a[12:15], v[52:55]
    ds_read_b64_tr_b16 a[2:3], v229 offset:10240
    v_mfma_f32_16x16x32_bf16 v[48:51], a[32:35], a[12:15], v[48:51]
    s_waitcnt lgkmcnt(6)
    v_mfma_f32_16x16x32_bf16 v[64:67], a[32:35], a[16:19], v[64:67]
    ds_read_b64_tr_b16 a[4:5], v230 offset:4096
    v_mfma_f32_16x16x32_bf16 v[68:71], a[36:39], a[16:19], v[68:71]
    ds_read_b64_tr_b16 a[6:7], v230 offset:10240
    v_mfma_f32_16x16x32_bf16 v[72:75], a[40:43], a[16:19], v[72:75]
    v_mfma_f32_16x16x32_bf16 v[76:79], a[44:47], a[16:19], v[76:79]
    v_mfma_f32_16x16x32_bf16 v[92:95], a[44:47], a[20:23], v[92:95]
    ds_read_b64_tr_b16 a[8:9], v231 offset:4096
    v_mfma_f32_16x16x32_bf16 v[88:91], a[40:43], a[20:23], v[88:91]
    buffer_load_dwordx4 v227, s[32:35], s67 offen offset:3072 lds
    s_add_u32 s67, s67, s59
    v_mfma_f32_16x16x32_bf16 v[84:87], a[36:39], a[20:23], v[84:87]
    ds_read_b64_tr_b16 a[10:11], v231 offset:10240
    v_mfma_f32_16x16x32_bf16 v[80:83], a[32:35], a[20:23], v[80:83]
    s_waitcnt lgkmcnt(6)
    v_mfma_f32_16x16x32_bf16 v[96:99], a[32:35], a[24:27], v[96:99]
    ds_read_b64_tr_b16 a[12:13], v232 offset:4096
    v_mfma_f32_16x16x32_bf16 v[100:103], a[36:39], a[24:27], v[100:103]
    ds_read_b64_tr_b16 a[14:15], v232 offset:10240
    v_mfma_f32_16x16x32_bf16 v[104:107], a[40:43], a[24:27], v[104:107]
    v_mfma_f32_16x16x32_bf16 v[108:111], a[44:47], a[24:27], v[108:111]
    v_mfma_f32_16x16x32_bf16 v[124:127], a[44:47], a[28:31], v[124:127]
    ds_read_b64_tr_b16 a[16:17], v229 offset:12288
    v_mfma_f32_16x16x32_bf16 v[120:123], a[40:43], a[28:31], v[120:123]
    buffer_load_dwordx4 a[140:143], v252, s[28:31], s52 offen offset:3072 sc1
    v_mfma_f32_16x16x32_bf16 v[116:119], a[36:39], a[28:31], v[116:119]
    ds_read_b64_tr_b16 a[18:19], v229 offset:18432
    v_mfma_f32_16x16x32_bf16 v[112:115], a[32:35], a[28:31], v[112:115]
    s_waitcnt lgkmcnt(6)
    v_mfma_f32_16x16x32_bf16 v[128:131], a[0:3], a[32:35], v[128:131]
    ds_read_b64_tr_b16 a[20:21], v230 offset:12288
    s_add_u32 m0, s55, 77824
    v_mfma_f32_16x16x32_bf16 v[132:135], a[0:3], a[36:39], v[132:135]
    buffer_load_dwordx4 v227, s[32:35], s68 offen offset:0 lds
    s_add_u32 s68, s68, s59
    v_mfma_f32_16x16x32_bf16 v[136:139], a[0:3], a[40:43], v[136:139]
    ds_read_b64_tr_b16 a[22:23], v230 offset:18432
    v_mfma_f32_16x16x32_bf16 v[140:143], a[0:3], a[44:47], v[140:143]
    v_mfma_f32_16x16x32_bf16 v[156:159], a[4:7], a[44:47], v[156:159]
    ds_read_b64_tr_b16 a[24:25], v231 offset:12288
    v_mfma_f32_16x16x32_bf16 v[152:155], a[4:7], a[40:43], v[152:155]
    ds_read_b64_tr_b16 a[26:27], v231 offset:18432
    v_mfma_f32_16x16x32_bf16 v[148:151], a[4:7], a[36:39], v[148:151]
    v_mfma_f32_16x16x32_bf16 v[144:147], a[4:7], a[32:35], v[144:147]
    s_waitcnt lgkmcnt(6)
    v_mfma_f32_16x16x32_bf16 v[160:163], a[8:11], a[32:35], v[160:163]
    ds_read_b64_tr_b16 a[28:29], v232 offset:12288
    v_mfma_f32_16x16x32_bf16 v[164:167], a[8:11], a[36:39], v[164:167]
    buffer_load_dwordx4 a[144:147], v224, s[28:31], s53 offen offset:0 sc1
    v_mfma_f32_16x16x32_bf16 v[168:171], a[8:11], a[40:43], v[168:171]
    ds_read_b64_tr_b16 a[30:31], v232 offset:18432
    v_mfma_f32_16x16x32_bf16 v[172:175], a[8:11], a[44:47], v[172:175]
    v_mfma_f32_16x16x32_bf16 v[188:191], a[12:15], a[44:47], v[188:191]
    ds_read_b64_tr_b16 a[0:1], v229 offset:14336
    v_mfma_f32_16x16x32_bf16 v[184:187], a[12:15], a[40:43], v[184:187]
    ds_read_b64_tr_b16 a[2:3], v229 offset:20480
    v_mfma_f32_16x16x32_bf16 v[180:183], a[12:15], a[36:39], v[180:183]
    v_mfma_f32_16x16x32_bf16 v[176:179], a[12:15], a[32:35], v[176:179]
    s_waitcnt lgkmcnt(6)
    v_mfma_f32_16x16x32_bf16 v[0:3], a[48:51], a[16:19], v[0:3]
    ds_read_b64_tr_b16 a[4:5], v230 offset:14336
    v_mfma_f32_16x16x32_bf16 v[4:7], a[52:55], a[16:19], v[4:7]
    buffer_load_dwordx4 v227, s[32:35], s69 offen offset:1024 lds
    s_add_u32 s69, s69, s59
    v_mfma_f32_16x16x32_bf16 v[8:11], a[56:59], a[16:19], v[8:11]
    ds_read_b64_tr_b16 a[6:7], v230 offset:20480
    v_mfma_f32_16x16x32_bf16 v[12:15], a[60:63], a[16:19], v[12:15]
    v_mfma_f32_16x16x32_bf16 v[28:31], a[60:63], a[20:23], v[28:31]
    ds_read_b64_tr_b16 a[8:9], v231 offset:14336
    v_mfma_f32_16x16x32_bf16 v[24:27], a[56:59], a[20:23], v[24:27]
    buffer_load_dwordx4 a[148:151], v250, s[28:31], s53 offen offset:1024 sc1
    v_mfma_f32_16x16x32_bf16 v[20:23], a[52:55], a[20:23], v[20:23]
    ds_read_b64_tr_b16 a[10:11], v231 offset:20480
    v_mfma_f32_16x16x32_bf16 v[16:19], a[48:51], a[20:23], v[16:19]
    s_waitcnt lgkmcnt(6)
    v_mfma_f32_16x16x32_bf16 v[32:35], a[48:51], a[24:27], v[32:35]
    ds_read_b64_tr_b16 a[12:13], v232 offset:14336
    v_mfma_f32_16x16x32_bf16 v[36:39], a[52:55], a[24:27], v[36:39]
    ds_read_b64_tr_b16 a[14:15], v232 offset:20480
    v_mfma_f32_16x16x32_bf16 v[40:43], a[56:59], a[24:27], v[40:43]
    v_mfma_f32_16x16x32_bf16 v[44:47], a[60:63], a[24:27], v[44:47]
    v_mfma_f32_16x16x32_bf16 v[60:63], a[60:63], a[28:31], v[60:63]
    ds_read_b64_tr_b16 a[16:17], v229 offset:16384
    v_mfma_f32_16x16x32_bf16 v[56:59], a[56:59], a[28:31], v[56:59]
    buffer_load_dwordx4 a[152:155], v251, s[28:31], s53 offen offset:2048 sc1
    v_mfma_f32_16x16x32_bf16 v[52:55], a[52:55], a[28:31], v[52:55]
    ds_read_b64_tr_b16 a[18:19], v229 offset:22528
    v_mfma_f32_16x16x32_bf16 v[48:51], a[48:51], a[28:31], v[48:51]
    s_waitcnt lgkmcnt(6)
    v_mfma_f32_16x16x32_bf16 v[64:67], a[48:51], a[0:3], v[64:67]
    ds_read_b64_tr_b16 a[20:21], v230 offset:16384
    v_mfma_f32_16x16x32_bf16 v[68:71], a[52:55], a[0:3], v[68:71]
    ds_read_b64_tr_b16 a[22:23], v230 offset:22528
    v_mfma_f32_16x16x32_bf16 v[72:75], a[56:59], a[0:3], v[72:75]
    v_mfma_f32_16x16x32_bf16 v[76:79], a[60:63], a[0:3], v[76:79]
    v_mfma_f32_16x16x32_bf16 v[92:95], a[60:63], a[4:7], v[92:95]
    ds_read_b64_tr_b16 a[24:25], v231 offset:16384
    v_mfma_f32_16x16x32_bf16 v[88:91], a[56:59], a[4:7], v[88:91]
    buffer_load_dwordx4 a[156:159], v252, s[28:31], s53 offen offset:3072 sc1
    v_mfma_f32_16x16x32_bf16 v[84:87], a[52:55], a[4:7], v[84:87]
    ds_read_b64_tr_b16 a[26:27], v231 offset:22528
    v_mfma_f32_16x16x32_bf16 v[80:83], a[48:51], a[4:7], v[80:83]
    s_waitcnt lgkmcnt(6)
    v_mfma_f32_16x16x32_bf16 v[96:99], a[48:51], a[8:11], v[96:99]
    ds_read_b64_tr_b16 a[28:29], v232 offset:16384
    v_mfma_f32_16x16x32_bf16 v[100:103], a[52:55], a[8:11], v[100:103]
    ds_read_b64_tr_b16 a[30:31], v232 offset:22528
    v_mfma_f32_16x16x32_bf16 v[104:107], a[56:59], a[8:11], v[104:107]
    v_mfma_f32_16x16x32_bf16 v[108:111], a[60:63], a[8:11], v[108:111]
    s_waitcnt vmcnt(28)
    s_barrier
    v_mfma_f32_16x16x32_bf16 v[124:127], a[60:63], a[12:15], v[124:127]
    ds_read_b64_tr_b16 a[0:1], v229 offset:24576
    s_add_u32 s52, s52, s58
    s_add_u32 s53, s53, s58
    v_mfma_f32_16x16x32_bf16 v[120:123], a[56:59], a[12:15], v[120:123]
    s_add_u32 s56, s56, 1
    s_add_u32 m0, s55, 98304
    s_nop 0
    buffer_load_dwordx4 v227, s[32:35], s64 offen offset:0 lds
    v_mfma_f32_16x16x32_bf16 v[116:119], a[52:55], a[12:15], v[116:119]
    ds_read_b64_tr_b16 a[2:3], v229 offset:30720
    s_add_u32 s64, s64, s59
    v_mfma_f32_16x16x32_bf16 v[112:115], a[48:51], a[12:15], v[112:115]
    s_waitcnt lgkmcnt(6)
    v_mfma_f32_16x16x32_bf16 v[128:131], a[16:19], a[48:51], v[128:131]
    ds_read_b64_tr_b16 a[4:5], v230 offset:24576
    v_mfma_f32_16x16x32_bf16 v[132:135], a[16:19], a[52:55], v[132:135]
    buffer_load_dwordx4 a[160:163], v224, s[28:31], s52 offen offset:0 sc1
    v_mfma_f32_16x16x32_bf16 v[136:139], a[16:19], a[56:59], v[136:139]
    ds_read_b64_tr_b16 a[6:7], v230 offset:30720
    v_mfma_f32_16x16x32_bf16 v[140:143], a[16:19], a[60:63], v[140:143]
    v_mfma_f32_16x16x32_bf16 v[156:159], a[20:23], a[60:63], v[156:159]
    ds_read_b64_tr_b16 a[8:9], v231 offset:24576
    v_mfma_f32_16x16x32_bf16 v[152:155], a[20:23], a[56:59], v[152:155]
    ds_read_b64_tr_b16 a[10:11], v231 offset:30720
    v_mfma_f32_16x16x32_bf16 v[148:151], a[20:23], a[52:55], v[148:151]
    v_mfma_f32_16x16x32_bf16 v[144:147], a[20:23], a[48:51], v[144:147]
    s_waitcnt lgkmcnt(6)
    v_mfma_f32_16x16x32_bf16 v[160:163], a[24:27], a[48:51], v[160:163]
    ds_read_b64_tr_b16 a[12:13], v232 offset:24576
    v_mfma_f32_16x16x32_bf16 v[164:167], a[24:27], a[52:55], v[164:167]
    buffer_load_dwordx4 v227, s[32:35], s65 offen offset:1024 lds
    s_add_u32 s65, s65, s59
    v_mfma_f32_16x16x32_bf16 v[168:171], a[24:27], a[56:59], v[168:171]
    ds_read_b64_tr_b16 a[14:15], v232 offset:30720
    v_mfma_f32_16x16x32_bf16 v[172:175], a[24:27], a[60:63], v[172:175]
    v_mfma_f32_16x16x32_bf16 v[188:191], a[28:31], a[60:63], v[188:191]
    ds_read_b64_tr_b16 a[16:17], v229 offset:26624
    v_mfma_f32_16x16x32_bf16 v[184:187], a[28:31], a[56:59], v[184:187]
    ds_read_b64_tr_b16 a[18:19], v229 offset:32768
    v_mfma_f32_16x16x32_bf16 v[180:183], a[28:31], a[52:55], v[180:183]
    v_mfma_f32_16x16x32_bf16 v[176:179], a[28:31], a[48:51], v[176:179]
    s_waitcnt lgkmcnt(6)
    v_mfma_f32_16x16x32_bf16 v[0:3], a[64:67], a[0:3], v[0:3]
    ds_read_b64_tr_b16 a[20:21], v230 offset:26624
    v_mfma_f32_16x16x32_bf16 v[4:7], a[68:71], a[0:3], v[4:7]
    buffer_load_dwordx4 a[164:167], v250, s[28:31], s52 offen offset:1024 sc1
    v_mfma_f32_16x16x32_bf16 v[8:11], a[72:75], a[0:3], v[8:11]
    ds_read_b64_tr_b16 a[22:23], v230 offset:32768
    v_mfma_f32_16x16x32_bf16 v[12:15], a[76:79], a[0:3], v[12:15]
    v_mfma_f32_16x16x32_bf16 v[28:31], a[76:79], a[4:7], v[28:31]
    ds_read_b64_tr_b16 a[24:25], v231 offset:26624
    v_mfma_f32_16x16x32_bf16 v[24:27], a[72:75], a[4:7], v[24:27]
    buffer_load_dwordx4 v227, s[32:35], s66 offen offset:2048 lds
    s_add_u32 s66, s66, s59
    v_mfma_f32_16x16x32_bf16 v[20:23], a[68:71], a[4:7], v[20:23]
    ds_read_b64_tr_b16 a[26:27], v231 offset:32768
    v_mfma_f32_16x16x32_bf16 v[16:19], a[64:67], a[4:7], v[16:19]
    s_waitcnt lgkmcnt(6)
    v_mfma_f32_16x16x32_bf16 v[32:35], a[64:67], a[8:11], v[32:35]
    ds_read_b64_tr_b16 a[28:29], v232 offset:26624
    v_mfma_f32_16x16x32_bf16 v[36:39], a[68:71], a[8:11], v[36:39]
    ds_read_b64_tr_b16 a[30:31], v232 offset:32768
    v_mfma_f32_16x16x32_bf16 v[40:43], a[72:75], a[8:11], v[40:43]
    v_mfma_f32_16x16x32_bf16 v[44:47], a[76:79], a[8:11], v[44:47]
    v_mfma_f32_16x16x32_bf16 v[60:63], a[76:79], a[12:15], v[60:63]
    ds_read_b64_tr_b16 a[0:1], v229 offset:28672
    v_mfma_f32_16x16x32_bf16 v[56:59], a[72:75], a[12:15], v[56:59]
    buffer_load_dwordx4 a[168:171], v251, s[28:31], s52 offen offset:2048 sc1
    v_mfma_f32_16x16x32_bf16 v[52:55], a[68:71], a[12:15], v[52:55]
    ds_read_b64_tr_b16 a[2:3], v229 offset:34816
    v_mfma_f32_16x16x32_bf16 v[48:51], a[64:67], a[12:15], v[48:51]
    s_waitcnt lgkmcnt(6)
    v_mfma_f32_16x16x32_bf16 v[64:67], a[64:67], a[16:19], v[64:67]
    ds_read_b64_tr_b16 a[4:5], v230 offset:28672
    v_mfma_f32_16x16x32_bf16 v[68:71], a[68:71], a[16:19], v[68:71]
    ds_read_b64_tr_b16 a[6:7], v230 offset:34816
    v_mfma_f32_16x16x32_bf16 v[72:75], a[72:75], a[16:19], v[72:75]
    v_mfma_f32_16x16x32_bf16 v[76:79], a[76:79], a[16:19], v[76:79]
    v_mfma_f32_16x16x32_bf16 v[92:95], a[76:79], a[20:23], v[92:95]
    ds_read_b64_tr_b16 a[8:9], v231 offset:28672
    v_mfma_f32_16x16x32_bf16 v[88:91], a[72:75], a[20:23], v[88:91]
    buffer_load_dwordx4 v227, s[32:35], s67 offen offset:3072 lds
    s_add_u32 s67, s67, s59
    v_mfma_f32_16x16x32_bf16 v[84:87], a[68:71], a[20:23], v[84:87]
    ds_read_b64_tr_b16 a[10:11], v231 offset:34816
    v_mfma_f32_16x16x32_bf16 v[80:83], a[64:67], a[20:23], v[80:83]
    s_waitcnt lgkmcnt(6)
    v_mfma_f32_16x16x32_bf16 v[96:99], a[64:67], a[24:27], v[96:99]
    ds_read_b64_tr_b16 a[12:13], v232 offset:28672
    v_mfma_f32_16x16x32_bf16 v[100:103], a[68:71], a[24:27], v[100:103]
    ds_read_b64_tr_b16 a[14:15], v232 offset:34816
    v_mfma_f32_16x16x32_bf16 v[104:107], a[72:75], a[24:27], v[104:107]
    v_mfma_f32_16x16x32_bf16 v[108:111], a[76:79], a[24:27], v[108:111]
    v_mfma_f32_16x16x32_bf16 v[124:127], a[76:79], a[28:31], v[124:127]
    ds_read_b64_tr_b16 a[16:17], v229 offset:36864
    v_mfma_f32_16x16x32_bf16 v[120:123], a[72:75], a[28:31], v[120:123]
    buffer_load_dwordx4 a[172:175], v252, s[28:31], s52 offen offset:3072 sc1
    v_mfma_f32_16x16x32_bf16 v[116:119], a[68:71], a[28:31], v[116:119]
    ds_read_b64_tr_b16 a[18:19], v229 offset:43008
    v_mfma_f32_16x16x32_bf16 v[112:115], a[64:67], a[28:31], v[112:115]
    s_waitcnt lgkmcnt(6)
    v_mfma_f32_16x16x32_bf16 v[128:131], a[0:3], a[64:67], v[128:131]
    ds_read_b64_tr_b16 a[20:21], v230 offset:36864
    s_add_u32 m0, s55, 102400
    v_mfma_f32_16x16x32_bf16 v[132:135], a[0:3], a[68:71], v[132:135]
    buffer_load_dwordx4 v227, s[32:35], s68 offen offset:0 lds
    s_add_u32 s68, s68, s59
    v_mfma_f32_16x16x32_bf16 v[136:139], a[0:3], a[72:75], v[136:139]
    ds_read_b64_tr_b16 a[22:23], v230 offset:43008
    v_mfma_f32_16x16x32_bf16 v[140:143], a[0:3], a[76:79], v[140:143]
    v_mfma_f32_16x16x32_bf16 v[156:159], a[4:7], a[76:79], v[156:159]
    ds_read_b64_tr_b16 a[24:25], v231 offset:36864
    v_mfma_f32_16x16x32_bf16 v[152:155], a[4:7], a[72:75], v[152:155]
    ds_read_b64_tr_b16 a[26:27], v231 offset:43008
    v_mfma_f32_16x16x32_bf16 v[148:151], a[4:7], a[68:71], v[148:151]
    v_mfma_f32_16x16x32_bf16 v[144:147], a[4:7], a[64:67], v[144:147]
    s_waitcnt lgkmcnt(6)
    v_mfma_f32_16x16x32_bf16 v[160:163], a[8:11], a[64:67], v[160:163]
    ds_read_b64_tr_b16 a[28:29], v232 offset:36864
    v_mfma_f32_16x16x32_bf16 v[164:167], a[8:11], a[68:71], v[164:167]
    buffer_load_dwordx4 a[176:179], v224, s[28:31], s53 offen offset:0 sc1
    v_mfma_f32_16x16x32_bf16 v[168:171], a[8:11], a[72:75], v[168:171]
    ds_read_b64_tr_b16 a[30:31], v232 offset:43008
    v_mfma_f32_16x16x32_bf16 v[172:175], a[8:11], a[76:79], v[172:175]
    v_mfma_f32_16x16x32_bf16 v[188:191], a[12:15], a[76:79], v[188:191]
    ds_read_b64_tr_b16 a[0:1], v229 offset:38912
    v_mfma_f32_16x16x32_bf16 v[184:187], a[12:15], a[72:75], v[184:187]
    ds_read_b64_tr_b16 a[2:3], v229 offset:45056
    v_mfma_f32_16x16x32_bf16 v[180:183], a[12:15], a[68:71], v[180:183]
    v_mfma_f32_16x16x32_bf16 v[176:179], a[12:15], a[64:67], v[176:179]
    s_waitcnt lgkmcnt(6)
    v_mfma_f32_16x16x32_bf16 v[0:3], a[80:83], a[16:19], v[0:3]
    ds_read_b64_tr_b16 a[4:5], v230 offset:38912
    v_mfma_f32_16x16x32_bf16 v[4:7], a[84:87], a[16:19], v[4:7]
    buffer_load_dwordx4 v227, s[32:35], s69 offen offset:1024 lds
    s_add_u32 s69, s69, s59
    v_mfma_f32_16x16x32_bf16 v[8:11], a[88:91], a[16:19], v[8:11]
    ds_read_b64_tr_b16 a[6:7], v230 offset:45056
    v_mfma_f32_16x16x32_bf16 v[12:15], a[92:95], a[16:19], v[12:15]
    v_mfma_f32_16x16x32_bf16 v[28:31], a[92:95], a[20:23], v[28:31]
    ds_read_b64_tr_b16 a[8:9], v231 offset:38912
    v_mfma_f32_16x16x32_bf16 v[24:27], a[88:91], a[20:23], v[24:27]
    buffer_load_dwordx4 a[180:183], v250, s[28:31], s53 offen offset:1024 sc1
    v_mfma_f32_16x16x32_bf16 v[20:23], a[84:87], a[20:23], v[20:23]
    ds_read_b64_tr_b16 a[10:11], v231 offset:45056
    v_mfma_f32_16x16x32_bf16 v[16:19], a[80:83], a[20:23], v[16:19]
    s_waitcnt lgkmcnt(6)
    v_mfma_f32_16x16x32_bf16 v[32:35], a[80:83], a[24:27], v[32:35]
    ds_read_b64_tr_b16 a[12:13], v232 offset:38912
    v_mfma_f32_16x16x32_bf16 v[36:39], a[84:87], a[24:27], v[36:39]
    ds_read_b64_tr_b16 a[14:15], v232 offset:45056
    v_mfma_f32_16x16x32_bf16 v[40:43], a[88:91], a[24:27], v[40:43]
    v_mfma_f32_16x16x32_bf16 v[44:47], a[92:95], a[24:27], v[44:47]
    v_mfma_f32_16x16x32_bf16 v[60:63], a[92:95], a[28:31], v[60:63]
    ds_read_b64_tr_b16 a[16:17], v229 offset:40960
    v_mfma_f32_16x16x32_bf16 v[56:59], a[88:91], a[28:31], v[56:59]
    buffer_load_dwordx4 a[184:187], v251, s[28:31], s53 offen offset:2048 sc1
    v_mfma_f32_16x16x32_bf16 v[52:55], a[84:87], a[28:31], v[52:55]
    ds_read_b64_tr_b16 a[18:19], v229 offset:47104
    v_mfma_f32_16x16x32_bf16 v[48:51], a[80:83], a[28:31], v[48:51]
    s_waitcnt lgkmcnt(6)
    v_mfma_f32_16x16x32_bf16 v[64:67], a[80:83], a[0:3], v[64:67]
    ds_read_b64_tr_b16 a[20:21], v230 offset:40960
    v_mfma_f32_16x16x32_bf16 v[68:71], a[84:87], a[0:3], v[68:71]
    ds_read_b64_tr_b16 a[22:23], v230 offset:47104
    v_mfma_f32_16x16x32_bf16 v[72:75], a[88:91], a[0:3], v[72:75]
    v_mfma_f32_16x16x32_bf16 v[76:79], a[92:95], a[0:3], v[76:79]
    v_mfma_f32_16x16x32_bf16 v[92:95], a[92:95], a[4:7], v[92:95]
    ds_read_b64_tr_b16 a[24:25], v231 offset:40960
    v_mfma_f32_16x16x32_bf16 v[88:91], a[88:91], a[4:7], v[88:91]
    buffer_load_dwordx4 a[188:191], v252, s[28:31], s53 offen offset:3072 sc1
    v_mfma_f32_16x16x32_bf16 v[84:87], a[84:87], a[4:7], v[84:87]
    ds_read_b64_tr_b16 a[26:27], v231 offset:47104
    v_mfma_f32_16x16x32_bf16 v[80:83], a[80:83], a[4:7], v[80:83]
    s_waitcnt lgkmcnt(6)
    v_mfma_f32_16x16x32_bf16 v[96:99], a[80:83], a[8:11], v[96:99]
    ds_read_b64_tr_b16 a[28:29], v232 offset:40960
    v_mfma_f32_16x16x32_bf16 v[100:103], a[84:87], a[8:11], v[100:103]
    ds_read_b64_tr_b16 a[30:31], v232 offset:47104
    v_mfma_f32_16x16x32_bf16 v[104:107], a[88:91], a[8:11], v[104:107]
    v_mfma_f32_16x16x32_bf16 v[108:111], a[92:95], a[8:11], v[108:111]
    s_waitcnt vmcnt(28)
    s_barrier
    v_mfma_f32_16x16x32_bf16 v[124:127], a[92:95], a[12:15], v[124:127]
    ds_read_b64_tr_b16 a[0:1], v235 offset:0
    s_add_u32 s52, s52, s58
    s_add_u32 s53, s53, s58
    v_mfma_f32_16x16x32_bf16 v[120:123], a[88:91], a[12:15], v[120:123]
    ds_read_b64_tr_b16 a[2:3], v235 offset:6144
    s_add_u32 s56, s56, 1
    s_cmp_eq_u32 s56, 16
    v_mfma_f32_16x16x32_bf16 v[116:119], a[84:87], a[12:15], v[116:119]
    s_cbranch_scc0 L_tailsw_39
    v_accvgpr_read_b32 v250, a242
    v_accvgpr_read_b32 v251, a243
    v_mov_b32 v227, v226
    v_mov_b32 v228, v226
    global_load_dword a240, v[250:251], off
    s_lshl_b32 s1, s3, 14
    v_add_u32 v224, s1, v226
    v_add_u32 v250, 64512, v224
    v_add_u32 v251, 129024, v224
    v_add_u32 v252, 193536, v224
    v_add_u32 v225, 262144, v224
    s_mov_b64 s[28:29], s[18:19]
    s_mov_b32 s30, 0x380000
    s_mov_b64 s[32:33], s[8:9]
    s_mov_b32 s34, 0x200000
    s_mov_b64 s[40:41], s[8:9]
    s_mov_b32 s42, 0x200000
    s_mov_b32 s52, 524288
    s_mov_b32 s53, 786432
    s_mov_b32 s58, 524288
    s_mul_i32 s64, s3, 98304
    s_mov_b32 s59, 393216
    s_mov_b32 s61, 393216
    s_add_u32 s65, s64, 15360
    s_add_u32 s66, s64, 30720
    s_add_u32 s67, s64, 46080
    s_add_u32 s68, s64, 65536
    s_add_u32 s69, s64, 80896
L_tailsw_39:
    s_add_u32 m0, s55, 0
    s_nop 0
    buffer_load_dwordx4 v227, s[32:35], s64 offen offset:0 lds
    v_mfma_f32_16x16x32_bf16 v[112:115], a[80:83], a[12:15], v[112:115]
    s_add_u32 s64, s64, s59
    s_waitcnt lgkmcnt(6)
    v_mfma_f32_16x16x32_bf16 v[128:131], a[16:19], a[80:83], v[128:131]
    ds_read_b64_tr_b16 a[4:5], v236 offset:0
    v_mfma_f32_16x16x32_bf16 v[132:135], a[16:19], a[84:87], v[132:135]
    buffer_load_dwordx4 a[32:35], v224, s[28:31], s52 offen offset:0 sc1
    v_mfma_f32_16x16x32_bf16 v[136:139], a[16:19], a[88:91], v[136:139]
    ds_read_b64_tr_b16 a[6:7], v236 offset:6144
    v_mfma_f32_16x16x32_bf16 v[140:143], a[16:19], a[92:95], v[140:143]
    v_mfma_f32_16x16x32_bf16 v[156:159], a[20:23], a[92:95], v[156:159]
    ds_read_b64_tr_b16 a[8:9], v237 offset:0
    v_mfma_f32_16x16x32_bf16 v[152:155], a[20:23], a[88:91], v[152:155]
    ds_read_b64_tr_b16 a[10:11], v237 offset:6144
    v_mfma_f32_16x16x32_bf16 v[148:151], a[20:23], a[84:87], v[148:151]
    v_mfma_f32_16x16x32_bf16 v[144:147], a[20:23], a[80:83], v[144:147]
    s_waitcnt lgkmcnt(6)
    v_mfma_f32_16x16x32_bf16 v[160:163], a[24:27], a[80:83], v[160:163]
    ds_read_b64_tr_b16 a[12:13], v238 offset:0
    v_mfma_f32_16x16x32_bf16 v[164:167], a[24:27], a[84:87], v[164:167]
    buffer_load_dwordx4 v227, s[32:35], s65 offen offset:1024 lds
    s_add_u32 s65, s65, s59
    v_mfma_f32_16x16x32_bf16 v[168:171], a[24:27], a[88:91], v[168:171]
    ds_read_b64_tr_b16 a[14:15], v238 offset:6144
    v_mfma_f32_16x16x32_bf16 v[172:175], a[24:27], a[92:95], v[172:175]
    v_mfma_f32_16x16x32_bf16 v[188:191], a[28:31], a[92:95], v[188:191]
    ds_read_b64_tr_b16 a[16:17], v235 offset:2048
    v_mfma_f32_16x16x32_bf16 v[184:187], a[28:31], a[88:91], v[184:187]
    ds_read_b64_tr_b16 a[18:19], v235 offset:8192
    v_mfma_f32_16x16x32_bf16 v[180:183], a[28:31], a[84:87], v[180:183]
    v_mfma_f32_16x16x32_bf16 v[176:179], a[28:31], a[80:83], v[176:179]
    s_waitcnt lgkmcnt(6)
    v_mfma_f32_16x16x32_bf16 v[0:3], a[96:99], a[0:3], v[0:3]
    ds_read_b64_tr_b16 a[20:21], v236 offset:2048
    v_mfma_f32_16x16x32_bf16 v[4:7], a[100:103], a[0:3], v[4:7]
    buffer_load_dwordx4 a[36:39], v250, s[28:31], s52 offen offset:1024 sc1
    v_mfma_f32_16x16x32_bf16 v[8:11], a[104:107], a[0:3], v[8:11]
    ds_read_b64_tr_b16 a[22:23], v236 offset:8192
    v_mfma_f32_16x16x32_bf16 v[12:15], a[108:111], a[0:3], v[12:15]
    v_mfma_f32_16x16x32_bf16 v[28:31], a[108:111], a[4:7], v[28:31]
    ds_read_b64_tr_b16 a[24:25], v237 offset:2048
    v_mfma_f32_16x16x32_bf16 v[24:27], a[104:107], a[4:7], v[24:27]
    buffer_load_dwordx4 v227, s[32:35], s66 offen offset:2048 lds
    s_add_u32 s66, s66, s59
    v_mfma_f32_16x16x32_bf16 v[20:23], a[100:103], a[4:7], v[20:23]
    ds_read_b64_tr_b16 a[26:27], v237 offset:8192
    v_mfma_f32_16x16x32_bf16 v[16:19], a[96:99], a[4:7], v[16:19]
    s_waitcnt lgkmcnt(6)
    v_mfma_f32_16x16x32_bf16 v[32:35], a[96:99], a[8:11], v[32:35]
    ds_read_b64_tr_b16 a[28:29], v238 offset:2048
    v_mfma_f32_16x16x32_bf16 v[36:39], a[100:103], a[8:11], v[36:39]
    ds_read_b64_tr_b16 a[30:31], v238 offset:8192
    v_mfma_f32_16x16x32_bf16 v[40:43], a[104:107], a[8:11], v[40:43]
    v_mfma_f32_16x16x32_bf16 v[44:47], a[108:111], a[8:11], v[44:47]
    v_mfma_f32_16x16x32_bf16 v[60:63], a[108:111], a[12:15], v[60:63]
    ds_read_b64_tr_b16 a[0:1], v235 offset:4096
    v_mfma_f32_16x16x32_bf16 v[56:59], a[104:107], a[12:15], v[56:59]
    buffer_load_dwordx4 a[40:43], v251, s[28:31], s52 offen offset:2048 sc1
    v_mfma_f32_16x16x32_bf16 v[52:55], a[100:103], a[12:15], v[52:55]
    ds_read_b64_tr_b16 a[2:3], v235 offset:10240
    v_mfma_f32_16x16x32_bf16 v[48:51], a[96:99], a[12:15], v[48:51]
    s_waitcnt lgkmcnt(6)
    v_mfma_f32_16x16x32_bf16 v[64:67], a[96:99], a[16:19], v[64:67]
    ds_read_b64_tr_b16 a[4:5], v236 offset:4096
    v_mfma_f32_16x16x32_bf16 v[68:71], a[100:103], a[16:19], v[68:71]
    ds_read_b64_tr_b16 a[6:7], v236 offset:10240
    v_mfma_f32_16x16x32_bf16 v[72:75], a[104:107], a[16:19], v[72:75]
    v_mfma_f32_16x16x32_bf16 v[76:79], a[108:111], a[16:19], v[76:79]
    v_mfma_f32_16x16x32_bf16 v[92:95], a[108:111], a[20:23], v[92:95]
    ds_read_b64_tr_b16 a[8:9], v237 offset:4096
    v_mfma_f32_16x16x32_bf16 v[88:91], a[104:107], a[20:23], v[88:91]
    buffer_load_dwordx4 v227, s[32:35], s67 offen offset:3072 lds
    s_add_u32 s67, s67, s59
    v_mfma_f32_16x16x32_bf16 v[84:87], a[100:103], a[20:23], v[84:87]
    ds_read_b64_tr_b16 a[10:11], v237 offset:10240
    v_mfma_f32_16x16x32_bf16 v[80:83], a[96:99], a[20:23], v[80:83]
    s_waitcnt lgkmcnt(6)
    v_mfma_f32_16x16x32_bf16 v[96:99], a[96:99], a[24:27], v[96:99]
    ds_read_b64_tr_b16 a[12:13], v238 offset:4096
    v_mfma_f32_16x16x32_bf16 v[100:103], a[100:103], a[24:27], v[100:103]
    ds_read_b64_tr_b16 a[14:15], v238 offset:10240
    v_mfma_f32_16x16x32_bf16 v[104:107], a[104:107], a[24:27], v[104:107]
    v_mfma_f32_16x16x32_bf16 v[108:111], a[108:111], a[24:27], v[108:111]
    v_mfma_f32_16x16x32_bf16 v[124:127], a[108:111], a[28:31], v[124:127]
    ds_read_b64_tr_b16 a[16:17], v235 offset:12288
    v_mfma_f32_16x16x32_bf16 v[120:123], a[104:107], a[28:31], v[120:123]
    buffer_load_dwordx4 a[44:47], v252, s[28:31], s52 offen offset:3072 sc1
    v_mfma_f32_16x16x32_bf16 v[116:119], a[100:103], a[28:31], v[116:119]
    ds_read_b64_tr_b16 a[18:19], v235 offset:18432
    v_mfma_f32_16x16x32_bf16 v[112:115], a[96:99], a[28:31], v[112:115]
    s_waitcnt lgkmcnt(6)
    v_mfma_f32_16x16x32_bf16 v[128:131], a[0:3], a[96:99], v[128:131]
    ds_read_b64_tr_b16 a[20:21], v236 offset:12288
    s_add_u32 m0, s55, 4096
    v_mfma_f32_16x16x32_bf16 v[132:135], a[0:3], a[100:103], v[132:135]
    buffer_load_dwordx4 v227, s[32:35], s68 offen offset:0 lds
    s_add_u32 s68, s68, s59
    v_mfma_f32_16x16x32_bf16 v[136:139], a[0:3], a[104:107], v[136:139]
    ds_read_b64_tr_b16 a[22:23], v236 offset:18432
    v_mfma_f32_16x16x32_bf16 v[140:143], a[0:3], a[108:111], v[140:143]
    v_mfma_f32_16x16x32_bf16 v[156:159], a[4:7], a[108:111], v[156:159]
    s_branch L_po_B_3
.p2align 12
L_pg_B_3:
    s_branch L_pg_B_6
L_po_B_3:
    ds_read_b64_tr_b16 a[24:25], v237 offset:12288
    v_mfma_f32_16x16x32_bf16 v[152:155], a[4:7], a[104:107], v[152:155]
    ds_read_b64_tr_b16 a[26:27], v237 offset:18432
    v_mfma_f32_16x16x32_bf16 v[148:151], a[4:7], a[100:103], v[148:151]
    v_mfma_f32_16x16x32_bf16 v[144:147], a[4:7], a[96:99], v[144:147]
    s_waitcnt lgkmcnt(6)
    v_mfma_f32_16x16x32_bf16 v[160:163], a[8:11], a[96:99], v[160:163]
    ds_read_b64_tr_b16 a[28:29], v238 offset:12288
    v_mfma_f32_16x16x32_bf16 v[164:167], a[8:11], a[100:103], v[164:167]
    buffer_load_dwordx4 a[48:51], v224, s[28:31], s53 offen offset:0 sc1
    v_mfma_f32_16x16x32_bf16 v[168:171], a[8:11], a[104:107], v[168:171]
    ds_read_b64_tr_b16 a[30:31], v238 offset:18432
    v_mfma_f32_16x16x32_bf16 v[172:175], a[8:11], a[108:111], v[172:175]
    v_mfma_f32_16x16x32_bf16 v[188:191], a[12:15], a[108:111], v[188:191]
    ds_read_b64_tr_b16 a[0:1], v235 offset:14336
    v_mfma_f32_16x16x32_bf16 v[184:187], a[12:15], a[104:107], v[184:187]
    ds_read_b64_tr_b16 a[2:3], v235 offset:20480
    v_mfma_f32_16x16x32_bf16 v[180:183], a[12:15], a[100:103], v[180:183]
    v_mfma_f32_16x16x32_bf16 v[176:179], a[12:15], a[96:99], v[176:179]
    s_waitcnt lgkmcnt(6)
    v_mfma_f32_16x16x32_bf16 v[0:3], a[112:115], a[16:19], v[0:3]
    ds_read_b64_tr_b16 a[4:5], v236 offset:14336
    v_mfma_f32_16x16x32_bf16 v[4:7], a[116:119], a[16:19], v[4:7]
    buffer_load_dwordx4 v227, s[32:35], s69 offen offset:1024 lds
    s_add_u32 s69, s69, s59
    v_mfma_f32_16x16x32_bf16 v[8:11], a[120:123], a[16:19], v[8:11]
    ds_read_b64_tr_b16 a[6:7], v236 offset:20480
    v_mfma_f32_16x16x32_bf16 v[12:15], a[124:127], a[16:19], v[12:15]
    v_mfma_f32_16x16x32_bf16 v[28:31], a[124:127], a[20:23], v[28:31]
    ds_read_b64_tr_b16 a[8:9], v237 offset:14336
    v_mfma_f32_16x16x32_bf16 v[24:27], a[120:123], a[20:23], v[24:27]
    buffer_load_dwordx4 a[52:55], v250, s[28:31], s53 offen offset:1024 sc1
    v_mfma_f32_16x16x32_bf16 v[20:23], a[116:119], a[20:23], v[20:23]
    ds_read_b64_tr_b16 a[10:11], v237 offset:20480
    v_mfma_f32_16x16x32_bf16 v[16:19], a[112:115], a[20:23], v[16:19]
    s_waitcnt lgkmcnt(6)
    v_mfma_f32_16x16x32_bf16 v[32:35], a[112:115], a[24:27], v[32:35]
    ds_read_b64_tr_b16 a[12:13], v238 offset:14336
    v_mfma_f32_16x16x32_bf16 v[36:39], a[116:119], a[24:27], v[36:39]
    ds_read_b64_tr_b16 a[14:15], v238 offset:20480
    v_mfma_f32_16x16x32_bf16 v[40:43], a[120:123], a[24:27], v[40:43]
    v_mfma_f32_16x16x32_bf16 v[44:47], a[124:127], a[24:27], v[44:47]
    v_mfma_f32_16x16x32_bf16 v[60:63], a[124:127], a[28:31], v[60:63]
    ds_read_b64_tr_b16 a[16:17], v235 offset:16384
    v_mfma_f32_16x16x32_bf16 v[56:59], a[120:123], a[28:31], v[56:59]
    buffer_load_dwordx4 a[56:59], v251, s[28:31], s53 offen offset:2048 sc1
    v_mfma_f32_16x16x32_bf16 v[52:55], a[116:119], a[28:31], v[52:55]
    ds_read_b64_tr_b16 a[18:19], v235 offset:22528
    v_mfma_f32_16x16x32_bf16 v[48:51], a[112:115], a[28:31], v[48:51]
    s_waitcnt lgkmcnt(6)
    v_mfma_f32_16x16x32_bf16 v[64:67], a[112:115], a[0:3], v[64:67]
    ds_read_b64_tr_b16 a[20:21], v236 offset:16384
    v_mfma_f32_16x16x32_bf16 v[68:71], a[116:119], a[0:3], v[68:71]
    ds_read_b64_tr_b16 a[22:23], v236 offset:22528
    v_mfma_f32_16x16x32_bf16 v[72:75], a[120:123], a[0:3], v[72:75]
    v_mfma_f32_16x16x32_bf16 v[76:79], a[124:127], a[0:3], v[76:79]
    v_mfma_f32_16x16x32_bf16 v[92:95], a[124:127], a[4:7], v[92:95]
    ds_read_b64_tr_b16 a[24:25], v237 offset:16384
    v_mfma_f32_16x16x32_bf16 v[88:91], a[120:123], a[4:7], v[88:91]
    buffer_load_dwordx4 a[60:63], v252, s[28:31], s53 offen offset:3072 sc1
    v_mfma_f32_16x16x32_bf16 v[84:87], a[116:119], a[4:7], v[84:87]
    ds_read_b64_tr_b16 a[26:27], v237 offset:22528
    v_mfma_f32_16x16x32_bf16 v[80:83], a[112:115], a[4:7], v[80:83]
    s_waitcnt lgkmcnt(6)
    v_mfma_f32_16x16x32_bf16 v[96:99], a[112:115], a[8:11], v[96:99]
    ds_read_b64_tr_b16 a[28:29], v238 offset:16384
    v_mfma_f32_16x16x32_bf16 v[100:103], a[116:119], a[8:11], v[100:103]
    ds_read_b64_tr_b16 a[30:31], v238 offset:22528
    v_mfma_f32_16x16x32_bf16 v[104:107], a[120:123], a[8:11], v[104:107]
    v_mfma_f32_16x16x32_bf16 v[108:111], a[124:127], a[8:11], v[108:111]
    s_waitcnt vmcnt(28)
    s_barrier
    v_mfma_f32_16x16x32_bf16 v[124:127], a[124:127], a[12:15], v[124:127]
    ds_read_b64_tr_b16 a[0:1], v235 offset:24576
    s_add_u32 s52, s52, s58
    s_add_u32 s53, s53, s58
    v_mfma_f32_16x16x32_bf16 v[120:123], a[120:123], a[12:15], v[120:123]
    s_add_u32 s56, s56, 1
    s_add_u32 m0, s55, 24576
    s_nop 0
    buffer_load_dwordx4 v227, s[32:35], s64 offen offset:0 lds
    v_mfma_f32_16x16x32_bf16 v[116:119], a[116:119], a[12:15], v[116:119]
    ds_read_b64_tr_b16 a[2:3], v235 offset:30720
    s_add_u32 s64, s64, s59
    v_mfma_f32_16x16x32_bf16 v[112:115], a[112:115], a[12:15], v[112:115]
    s_waitcnt lgkmcnt(6)
    v_mfma_f32_16x16x32_bf16 v[128:131], a[16:19], a[112:115], v[128:131]
    ds_read_b64_tr_b16 a[4:5], v236 offset:24576
    v_mfma_f32_16x16x32_bf16 v[132:135], a[16:19], a[116:119], v[132:135]
    buffer_load_dwordx4 a[64:67], v224, s[28:31], s52 offen offset:0 sc1
    v_mfma_f32_16x16x32_bf16 v[136:139], a[16:19], a[120:123], v[136:139]
    ds_read_b64_tr_b16 a[6:7], v236 offset:30720
    v_mfma_f32_16x16x32_bf16 v[140:143], a[16:19], a[124:127], v[140:143]
    v_mfma_f32_16x16x32_bf16 v[156:159], a[20:23], a[124:127], v[156:159]
    ds_read_b64_tr_b16 a[8:9], v237 offset:24576
    v_mfma_f32_16x16x32_bf16 v[152:155], a[20:23], a[120:123], v[152:155]
    ds_read_b64_tr_b16 a[10:11], v237 offset:30720
    v_mfma_f32_16x16x32_bf16 v[148:151], a[20:23], a[116:119], v[148:151]
    v_mfma_f32_16x16x32_bf16 v[144:147], a[20:23], a[112:115], v[144:147]
    s_waitcnt lgkmcnt(6)
    v_mfma_f32_16x16x32_bf16 v[160:163], a[24:27], a[112:115], v[160:163]
    ds_read_b64_tr_b16 a[12:13], v238 offset:24576
    v_mfma_f32_16x16x32_bf16 v[164:167], a[24:27], a[116:119], v[164:167]
    buffer_load_dwordx4 v227, s[32:35], s65 offen offset:1024 lds
    s_add_u32 s65, s65, s59
    v_mfma_f32_16x16x32_bf16 v[168:171], a[24:27], a[120:123], v[168:171]
    ds_read_b64_tr_b16 a[14:15], v238 offset:30720
    v_mfma_f32_16x16x32_bf16 v[172:175], a[24:27], a[124:127], v[172:175]
    v_mfma_f32_16x16x32_bf16 v[188:191], a[28:31], a[124:127], v[188:191]
    ds_read_b64_tr_b16 a[16:17], v235 offset:26624
    v_mfma_f32_16x16x32_bf16 v[184:187], a[28:31], a[120:123], v[184:187]
    ds_read_b64_tr_b16 a[18:19], v235 offset:32768
    v_mfma_f32_16x16x32_bf16 v[180:183], a[28:31], a[116:119], v[180:183]
    v_mfma_f32_16x16x32_bf16 v[176:179], a[28:31], a[112:115], v[176:179]
    s_waitcnt lgkmcnt(6)
    v_mfma_f32_16x16x32_bf16 v[0:3], a[128:131], a[0:3], v[0:3]
    ds_read_b64_tr_b16 a[20:21], v236 offset:26624
    v_mfma_f32_16x16x32_bf16 v[4:7], a[132:135], a[0:3], v[4:7]
    buffer_load_dwordx4 a[68:71], v250, s[28:31], s52 offen offset:1024 sc1
    v_mfma_f32_16x16x32_bf16 v[8:11], a[136:139], a[0:3], v[8:11]
    ds_read_b64_tr_b16 a[22:23], v236 offset:32768
    v_mfma_f32_16x16x32_bf16 v[12:15], a[140:143], a[0:3], v[12:15]
    v_mfma_f32_16x16x32_bf16 v[28:31], a[140:143], a[4:7], v[28:31]
    ds_read_b64_tr_b16 a[24:25], v237 offset:26624
    v_mfma_f32_16x16x32_bf16 v[24:27], a[136:139], a[4:7], v[24:27]
    buffer_load_dwordx4 v227, s[32:35], s66 offen offset:2048 lds
    s_add_u32 s66, s66, s59
    v_mfma_f32_16x16x32_bf16 v[20:23], a[132:135], a[4:7], v[20:23]
    ds_read_b64_tr_b16 a[26:27], v237 offset:32768
    v_mfma_f32_16x16x32_bf16 v[16:19], a[128:131], a[4:7], v[16:19]
    s_waitcnt lgkmcnt(6)
    v_mfma_f32_16x16x32_bf16 v[32:35], a[128:131], a[8:11], v[32:35]
    ds_read_b64_tr_b16 a[28:29], v238 offset:26624
    v_mfma_f32_16x16x32_bf16 v[36:39], a[132:135], a[8:11], v[36:39]
    ds_read_b64_tr_b16 a[30:31], v238 offset:32768
    v_mfma_f32_16x16x32_bf16 v[40:43], a[136:139], a[8:11], v[40:43]
    v_mfma_f32_16x16x32_bf16 v[44:47], a[140:143], a[8:11], v[44:47]
    v_mfma_f32_16x16x32_bf16 v[60:63], a[140:143], a[12:15], v[60:63]
    ds_read_b64_tr_b16 a[0:1], v235 offset:28672
    v_mfma_f32_16x16x32_bf16 v[56:59], a[136:139], a[12:15], v[56:59]
    buffer_load_dwordx4 a[72:75], v251, s[28:31], s52 offen offset:2048 sc1
    v_mfma_f32_16x16x32_bf16 v[52:55], a[132:135], a[12:15], v[52:55]
    ds_read_b64_tr_b16 a[2:3], v235 offset:34816
    v_mfma_f32_16x16x32_bf16 v[48:51], a[128:131], a[12:15], v[48:51]
    s_waitcnt lgkmcnt(6)
    v_mfma_f32_16x16x32_bf16 v[64:67], a[128:131], a[16:19], v[64:67]
    ds_read_b64_tr_b16 a[4:5], v236 offset:28672
    v_mfma_f32_16x16x32_bf16 v[68:71], a[132:135], a[16:19], v[68:71]
    ds_read_b64_tr_b16 a[6:7], v236 offset:34816
    v_mfma_f32_16x16x32_bf16 v[72:75], a[136:139], a[16:19], v[72:75]
    v_mfma_f32_16x16x32_bf16 v[76:79], a[140:143], a[16:19], v[76:79]
    v_mfma_f32_16x16x32_bf16 v[92:95], a[140:143], a[20:23], v[92:95]
    ds_read_b64_tr_b16 a[8:9], v237 offset:28672
    v_mfma_f32_16x16x32_bf16 v[88:91], a[136:139], a[20:23], v[88:91]
    buffer_load_dwordx4 v227, s[32:35], s67 offen offset:3072 lds
    s_add_u32 s67, s67, s59
    v_mfma_f32_16x16x32_bf16 v[84:87], a[132:135], a[20:23], v[84:87]
    ds_read_b64_tr_b16 a[10:11], v237 offset:34816
    v_mfma_f32_16x16x32_bf16 v[80:83], a[128:131], a[20:23], v[80:83]
    s_waitcnt lgkmcnt(6)
    v_mfma_f32_16x16x32_bf16 v[96:99], a[128:131], a[24:27], v[96:99]
    ds_read_b64_tr_b16 a[12:13], v238 offset:28672
    v_mfma_f32_16x16x32_bf16 v[100:103], a[132:135], a[24:27], v[100:103]
    ds_read_b64_tr_b16 a[14:15], v238 offset:34816
    v_mfma_f32_16x16x32_bf16 v[104:107], a[136:139], a[24:27], v[104:107]
    v_mfma_f32_16x16x32_bf16 v[108:111], a[140:143], a[24:27], v[108:111]
    v_mfma_f32_16x16x32_bf16 v[124:127], a[140:143], a[28:31], v[124:127]
    ds_read_b64_tr_b16 a[16:17], v235 offset:36864
    v_mfma_f32_16x16x32_bf16 v[120:123], a[136:139], a[28:31], v[120:123]
    buffer_load_dwordx4 a[76:79], v252, s[28:31], s52 offen offset:3072 sc1
    v_mfma_f32_16x16x32_bf16 v[116:119], a[132:135], a[28:31], v[116:119]
    ds_read_b64_tr_b16 a[18:19], v235 offset:43008
    v_mfma_f32_16x16x32_bf16 v[112:115], a[128:131], a[28:31], v[112:115]
    s_waitcnt lgkmcnt(6)
    v_mfma_f32_16x16x32_bf16 v[128:131], a[0:3], a[128:131], v[128:131]
    ds_read_b64_tr_b16 a[20:21], v236 offset:36864
    s_add_u32 m0, s55, 28672
    v_mfma_f32_16x16x32_bf16 v[132:135], a[0:3], a[132:135], v[132:135]
    buffer_load_dwordx4 v227, s[32:35], s68 offen offset:0 lds
    s_add_u32 s68, s68, s59
    v_mfma_f32_16x16x32_bf16 v[136:139], a[0:3], a[136:139], v[136:139]
    ds_read_b64_tr_b16 a[22:23], v236 offset:43008
    v_mfma_f32_16x16x32_bf16 v[140:143], a[0:3], a[140:143], v[140:143]
    v_mfma_f32_16x16x32_bf16 v[156:159], a[4:7], a[140:143], v[156:159]
    ds_read_b64_tr_b16 a[24:25], v237 offset:36864
    v_mfma_f32_16x16x32_bf16 v[152:155], a[4:7], a[136:139], v[152:155]
    ds_read_b64_tr_b16 a[26:27], v237 offset:43008
    v_mfma_f32_16x16x32_bf16 v[148:151], a[4:7], a[132:135], v[148:151]
    v_mfma_f32_16x16x32_bf16 v[144:147], a[4:7], a[128:131], v[144:147]
    s_waitcnt lgkmcnt(6)
    v_mfma_f32_16x16x32_bf16 v[160:163], a[8:11], a[128:131], v[160:163]
    ds_read_b64_tr_b16 a[28:29], v238 offset:36864
    v_mfma_f32_16x16x32_bf16 v[164:167], a[8:11], a[132:135], v[164:167]
    buffer_load_dwordx4 a[80:83], v224, s[28:31], s53 offen offset:0 sc1
    v_mfma_f32_16x16x32_bf16 v[168:171], a[8:11], a[136:139], v[168:171]
    ds_read_b64_tr_b16 a[30:31], v238 offset:43008
    v_mfma_f32_16x16x32_bf16 v[172:175], a[8:11], a[140:143], v[172:175]
    v_mfma_f32_16x16x32_bf16 v[188:191], a[12:15], a[140:143], v[188:191]
    ds_read_b64_tr_b16 a[0:1], v235 offset:38912
    v_mfma_f32_16x16x32_bf16 v[184:187], a[12:15], a[136:139], v[184:187]
    ds_read_b64_tr_b16 a[2:3], v235 offset:45056
    v_mfma_f32_16x16x32_bf16 v[180:183], a[12:15], a[132:135], v[180:183]
    v_mfma_f32_16x16x32_bf16 v[176:179], a[12:15], a[128:131], v[176:179]
    s_waitcnt lgkmcnt(6)
    v_mfma_f32_16x16x32_bf16 v[0:3], a[144:147], a[16:19], v[0:3]
    ds_read_b64_tr_b16 a[4:5], v236 offset:38912
    v_mfma_f32_16x16x32_bf16 v[4:7], a[148:151], a[16:19], v[4:7]
    buffer_load_dwordx4 v227, s[32:35], s69 offen offset:1024 lds
    s_add_u32 s69, s69, s59
    v_mfma_f32_16x16x32_bf16 v[8:11], a[152:155], a[16:19], v[8:11]
    ds_read_b64_tr_b16 a[6:7], v236 offset:45056
    v_mfma_f32_16x16x32_bf16 v[12:15], a[156:159], a[16:19], v[12:15]
    v_mfma_f32_16x16x32_bf16 v[28:31], a[156:159], a[20:23], v[28:31]
    ds_read_b64_tr_b16 a[8:9], v237 offset:38912
    v_mfma_f32_16x16x32_bf16 v[24:27], a[152:155], a[20:23], v[24:27]
    buffer_load_dwordx4 a[84:87], v250, s[28:31], s53 offen offset:1024 sc1
    v_mfma_f32_16x16x32_bf16 v[20:23], a[148:151], a[20:23], v[20:23]
    ds_read_b64_tr_b16 a[10:11], v237 offset:45056
    v_mfma_f32_16x16x32_bf16 v[16:19], a[144:147], a[20:23], v[16:19]
    s_waitcnt lgkmcnt(6)
    v_mfma_f32_16x16x32_bf16 v[32:35], a[144:147], a[24:27], v[32:35]
    ds_read_b64_tr_b16 a[12:13], v238 offset:38912
    v_mfma_f32_16x16x32_bf16 v[36:39], a[148:151], a[24:27], v[36:39]
    ds_read_b64_tr_b16 a[14:15], v238 offset:45056
    v_mfma_f32_16x16x32_bf16 v[40:43], a[152:155], a[24:27], v[40:43]
    v_mfma_f32_16x16x32_bf16 v[44:47], a[156:159], a[24:27], v[44:47]
    v_mfma_f32_16x16x32_bf16 v[60:63], a[156:159], a[28:31], v[60:63]
    ds_read_b64_tr_b16 a[16:17], v235 offset:40960
    v_mfma_f32_16x16x32_bf16 v[56:59], a[152:155], a[28:31], v[56:59]
    buffer_load_dwordx4 a[88:91], v251, s[28:31], s53 offen offset:2048 sc1
    v_mfma_f32_16x16x32_bf16 v[52:55], a[148:151], a[28:31], v[52:55]
    ds_read_b64_tr_b16 a[18:19], v235 offset:47104
    v_mfma_f32_16x16x32_bf16 v[48:51], a[144:147], a[28:31], v[48:51]
    s_waitcnt lgkmcnt(6)
    v_mfma_f32_16x16x32_bf16 v[64:67], a[144:147], a[0:3], v[64:67]
    ds_read_b64_tr_b16 a[20:21], v236 offset:40960
    v_mfma_f32_16x16x32_bf16 v[68:71], a[148:151], a[0:3], v[68:71]
    ds_read_b64_tr_b16 a[22:23], v236 offset:47104
    v_mfma_f32_16x16x32_bf16 v[72:75], a[152:155], a[0:3], v[72:75]
    v_mfma_f32_16x16x32_bf16 v[76:79], a[156:159], a[0:3], v[76:79]
    v_mfma_f32_16x16x32_bf16 v[92:95], a[156:159], a[4:7], v[92:95]
    ds_read_b64_tr_b16 a[24:25], v237 offset:40960
    v_mfma_f32_16x16x32_bf16 v[88:91], a[152:155], a[4:7], v[88:91]
    buffer_load_dwordx4 a[92:95], v252, s[28:31], s53 offen offset:3072 sc1
    v_mfma_f32_16x16x32_bf16 v[84:87], a[148:151], a[4:7], v[84:87]
    ds_read_b64_tr_b16 a[26:27], v237 offset:47104
    v_mfma_f32_16x16x32_bf16 v[80:83], a[144:147], a[4:7], v[80:83]
    s_waitcnt lgkmcnt(6)
    v_mfma_f32_16x16x32_bf16 v[96:99], a[144:147], a[8:11], v[96:99]
    ds_read_b64_tr_b16 a[28:29], v238 offset:40960
    v_mfma_f32_16x16x32_bf16 v[100:103], a[148:151], a[8:11], v[100:103]
    ds_read_b64_tr_b16 a[30:31], v238 offset:47104
    v_mfma_f32_16x16x32_bf16 v[104:107], a[152:155], a[8:11], v[104:107]
    v_mfma_f32_16x16x32_bf16 v[108:111], a[156:159], a[8:11], v[108:111]
    s_waitcnt vmcnt(28)
    s_barrier
    v_mfma_f32_16x16x32_bf16 v[124:127], a[156:159], a[12:15], v[124:127]
    ds_read_b64_tr_b16 a[0:1], v241 offset:0
    s_add_u32 s52, s52, s58
    s_add_u32 s53, s53, s58
    v_mfma_f32_16x16x32_bf16 v[120:123], a[152:155], a[12:15], v[120:123]
    ds_read_b64_tr_b16 a[2:3], v241 offset:6144
    s_add_u32 s56, s56, 1
    s_cmp_eq_u32 s56, 18
    v_mfma_f32_16x16x32_bf16 v[116:119], a[148:151], a[12:15], v[116:119]
    s_cselect_b32 s55, 163840, s55
    s_cselect_b32 s34, 0, s34
    v_mfma_f32_16x16x32_bf16 v[112:115], a[144:147], a[12:15], v[112:115]
    s_cselect_b32 s42, 0, s42
    s_add_u32 m0, s55, 49152
    s_nop 0
    buffer_load_dwordx4 v227, s[32:35], s64 offen offset:0 lds
    s_waitcnt lgkmcnt(6)
    v_mfma_f32_16x16x32_bf16 v[128:131], a[16:19], a[144:147], v[128:131]
    ds_read_b64_tr_b16 a[4:5], v242 offset:0
    s_add_u32 s64, s64, s59
    v_mfma_f32_16x16x32_bf16 v[132:135], a[16:19], a[148:151], v[132:135]
    buffer_load_dwordx4 a[96:99], v224, s[28:31], s52 offen offset:0 sc1
    v_mfma_f32_16x16x32_bf16 v[136:139], a[16:19], a[152:155], v[136:139]
    ds_read_b64_tr_b16 a[6:7], v242 offset:6144
    v_mfma_f32_16x16x32_bf16 v[140:143], a[16:19], a[156:159], v[140:143]
    v_mfma_f32_16x16x32_bf16 v[156:159], a[20:23], a[156:159], v[156:159]
    ds_read_b64_tr_b16 a[8:9], v243 offset:0
    v_mfma_f32_16x16x32_bf16 v[152:155], a[20:23], a[152:155], v[152:155]
    ds_read_b64_tr_b16 a[10:11], v243 offset:6144
    v_mfma_f32_16x16x32_bf16 v[148:151], a[20:23], a[148:151], v[148:151]
    v_mfma_f32_16x16x32_bf16 v[144:147], a[20:23], a[144:147], v[144:147]
    s_waitcnt lgkmcnt(6)
    v_mfma_f32_16x16x32_bf16 v[160:163], a[24:27], a[144:147], v[160:163]
    ds_read_b64_tr_b16 a[12:13], v244 offset:0
    v_mfma_f32_16x16x32_bf16 v[164:167], a[24:27], a[148:151], v[164:167]
    buffer_load_dwordx4 v227, s[32:35], s65 offen offset:1024 lds
    s_add_u32 s65, s65, s59
    v_mfma_f32_16x16x32_bf16 v[168:171], a[24:27], a[152:155], v[168:171]
    ds_read_b64_tr_b16 a[14:15], v244 offset:6144
    v_mfma_f32_16x16x32_bf16 v[172:175], a[24:27], a[156:159], v[172:175]
    v_mfma_f32_16x16x32_bf16 v[188:191], a[28:31], a[156:159], v[188:191]
    ds_read_b64_tr_b16 a[16:17], v241 offset:2048
    v_mfma_f32_16x16x32_bf16 v[184:187], a[28:31], a[152:155], v[184:187]
    ds_read_b64_tr_b16 a[18:19], v241 offset:8192
    v_mfma_f32_16x16x32_bf16 v[180:183], a[28:31], a[148:151], v[180:183]
    v_mfma_f32_16x16x32_bf16 v[176:179], a[28:31], a[144:147], v[176:179]
L_entry_38:
    s_waitcnt lgkmcnt(6)
    v_mfma_f32_16x16x32_bf16 v[0:3], a[160:163], a[0:3], v[0:3]
    ds_read_b64_tr_b16 a[20:21], v242 offset:2048
    v_mfma_f32_16x16x32_bf16 v[4:7], a[164:167], a[0:3], v[4:7]
    buffer_load_dwordx4 a[100:103], v250, s[28:31], s52 offen offset:1024 sc1
    v_mfma_f32_16x16x32_bf16 v[8:11], a[168:171], a[0:3], v[8:11]
    ds_read_b64_tr_b16 a[22:23], v242 offset:8192
    v_mfma_f32_16x16x32_bf16 v[12:15], a[172:175], a[0:3], v[12:15]
    v_mfma_f32_16x16x32_bf16 v[28:31], a[172:175], a[4:7], v[28:31]
    ds_read_b64_tr_b16 a[24:25], v243 offset:2048
    v_mfma_f32_16x16x32_bf16 v[24:27], a[168:171], a[4:7], v[24:27]
    buffer_load_dwordx4 v227, s[32:35], s66 offen offset:2048 lds
    s_add_u32 s66, s66, s59
    v_mfma_f32_16x16x32_bf16 v[20:23], a[164:167], a[4:7], v[20:23]
    ds_read_b64_tr_b16 a[26:27], v243 offset:8192
    v_mfma_f32_16x16x32_bf16 v[16:19], a[160:163], a[4:7], v[16:19]
    s_waitcnt lgkmcnt(6)
    v_mfma_f32_16x16x32_bf16 v[32:35], a[160:163], a[8:11], v[32:35]
    ds_read_b64_tr_b16 a[28:29], v244 offset:2048
    v_mfma_f32_16x16x32_bf16 v[36:39], a[164:167], a[8:11], v[36:39]
    ds_read_b64_tr_b16 a[30:31], v244 offset:8192
    v_mfma_f32_16x16x32_bf16 v[40:43], a[168:171], a[8:11], v[40:43]
    v_mfma_f32_16x16x32_bf16 v[44:47], a[172:175], a[8:11], v[44:47]
    v_mfma_f32_16x16x32_bf16 v[60:63], a[172:175], a[12:15], v[60:63]
    ds_read_b64_tr_b16 a[0:1], v241 offset:4096
    v_mfma_f32_16x16x32_bf16 v[56:59], a[168:171], a[12:15], v[56:59]
    buffer_load_dwordx4 a[104:107], v251, s[28:31], s52 offen offset:2048 sc1
    v_mfma_f32_16x16x32_bf16 v[52:55], a[164:167], a[12:15], v[52:55]
    ds_read_b64_tr_b16 a[2:3], v241 offset:10240
    v_mfma_f32_16x16x32_bf16 v[48:51], a[160:163], a[12:15], v[48:51]
    s_waitcnt lgkmcnt(6)
    v_mfma_f32_16x16x32_bf16 v[64:67], a[160:163], a[16:19], v[64:67]
    ds_read_b64_tr_b16 a[4:5], v242 offset:4096
    v_mfma_f32_16x16x32_bf16 v[68:71], a[164:167], a[16:19], v[68:71]
    ds_read_b64_tr_b16 a[6:7], v242 offset:10240
    v_mfma_f32_16x16x32_bf16 v[72:75], a[168:171], a[16:19], v[72:75]
    v_mfma_f32_16x16x32_bf16 v[76:79], a[172:175], a[16:19], v[76:79]
    v_mfma_f32_16x16x32_bf16 v[92:95], a[172:175], a[20:23], v[92:95]
    ds_read_b64_tr_b16 a[8:9], v243 offset:4096
    v_mfma_f32_16x16x32_bf16 v[88:91], a[168:171], a[20:23], v[88:91]
    buffer_load_dwordx4 v227, s[32:35], s67 offen offset:3072 lds
    s_add_u32 s67, s67, s59
    v_mfma_f32_16x16x32_bf16 v[84:87], a[164:167], a[20:23], v[84:87]
    ds_read_b64_tr_b16 a[10:11], v243 offset:10240
    v_mfma_f32_16x16x32_bf16 v[80:83], a[160:163], a[20:23], v[80:83]
    s_waitcnt lgkmcnt(6)
    v_mfma_f32_16x16x32_bf16 v[96:99], a[160:163], a[24:27], v[96:99]
    ds_read_b64_tr_b16 a[12:13], v244 offset:4096
    v_mfma_f32_16x16x32_bf16 v[100:103], a[164:167], a[24:27], v[100:103]
    ds_read_b64_tr_b16 a[14:15], v244 offset:10240
    v_mfma_f32_16x16x32_bf16 v[104:107], a[168:171], a[24:27], v[104:107]
    v_mfma_f32_16x16x32_bf16 v[108:111], a[172:175], a[24:27], v[108:111]
    v_mfma_f32_16x16x32_bf16 v[124:127], a[172:175], a[28:31], v[124:127]
    ds_read_b64_tr_b16 a[16:17], v241 offset:12288
    v_mfma_f32_16x16x32_bf16 v[120:123], a[168:171], a[28:31], v[120:123]
    buffer_load_dwordx4 a[108:111], v252, s[28:31], s52 offen offset:3072 sc1
    v_mfma_f32_16x16x32_bf16 v[116:119], a[164:167], a[28:31], v[116:119]
    ds_read_b64_tr_b16 a[18:19], v241 offset:18432
    v_mfma_f32_16x16x32_bf16 v[112:115], a[160:163], a[28:31], v[112:115]
    s_waitcnt lgkmcnt(6)
    v_mfma_f32_16x16x32_bf16 v[128:131], a[0:3], a[160:163], v[128:131]
    ds_read_b64_tr_b16 a[20:21], v242 offset:12288
    s_add_u32 m0, s55, 53248
    v_mfma_f32_16x16x32_bf16 v[132:135], a[0:3], a[164:167], v[132:135]
    buffer_load_dwordx4 v227, s[32:35], s68 offen offset:0 lds
    s_add_u32 s68, s68, s59
    v_mfma_f32_16x16x32_bf16 v[136:139], a[0:3], a[168:171], v[136:139]
    ds_read_b64_tr_b16 a[22:23], v242 offset:18432
    v_mfma_f32_16x16x32_bf16 v[140:143], a[0:3], a[172:175], v[140:143]
    v_mfma_f32_16x16x32_bf16 v[156:159], a[4:7], a[172:175], v[156:159]
    ds_read_b64_tr_b16 a[24:25], v243 offset:12288
    v_mfma_f32_16x16x32_bf16 v[152:155], a[4:7], a[168:171], v[152:155]
    ds_read_b64_tr_b16 a[26:27], v243 offset:18432
    v_mfma_f32_16x16x32_bf16 v[148:151], a[4:7], a[164:167], v[148:151]
    v_mfma_f32_16x16x32_bf16 v[144:147], a[4:7], a[160:163], v[144:147]
    s_waitcnt lgkmcnt(6)
    v_mfma_f32_16x16x32_bf16 v[160:163], a[8:11], a[160:163], v[160:163]
    ds_read_b64_tr_b16 a[28:29], v244 offset:12288
    v_mfma_f32_16x16x32_bf16 v[164:167], a[8:11], a[164:167], v[164:167]
    buffer_load_dwordx4 a[112:115], v224, s[28:31], s53 offen offset:0 sc1
    v_mfma_f32_16x16x32_bf16 v[168:171], a[8:11], a[168:171], v[168:171]
    ds_read_b64_tr_b16 a[30:31], v244 offset:18432
    v_mfma_f32_16x16x32_bf16 v[172:175], a[8:11], a[172:175], v[172:175]
    v_mfma_f32_16x16x32_bf16 v[188:191], a[12:15], a[172:175], v[188:191]
    ds_read_b64_tr_b16 a[0:1], v241 offset:14336
    v_mfma_f32_16x16x32_bf16 v[184:187], a[12:15], a[168:171], v[184:187]
    ds_read_b64_tr_b16 a[2:3], v241 offset:20480
    v_mfma_f32_16x16x32_bf16 v[180:183], a[12:15], a[164:167], v[180:183]
    v_mfma_f32_16x16x32_bf16 v[176:179], a[12:15], a[160:163], v[176:179]
    s_waitcnt lgkmcnt(6)
    v_mfma_f32_16x16x32_bf16 v[0:3], a[176:179], a[16:19], v[0:3]
    ds_read_b64_tr_b16 a[4:5], v242 offset:14336
    v_mfma_f32_16x16x32_bf16 v[4:7], a[180:183], a[16:19], v[4:7]
    buffer_load_dwordx4 v227, s[32:35], s69 offen offset:1024 lds
    s_add_u32 s69, s69, s59
    v_mfma_f32_16x16x32_bf16 v[8:11], a[184:187], a[16:19], v[8:11]
    ds_read_b64_tr_b16 a[6:7], v242 offset:20480
    v_mfma_f32_16x16x32_bf16 v[12:15], a[188:191], a[16:19], v[12:15]
    v_mfma_f32_16x16x32_bf16 v[28:31], a[188:191], a[20:23], v[28:31]
    ds_read_b64_tr_b16 a[8:9], v243 offset:14336
    v_mfma_f32_16x16x32_bf16 v[24:27], a[184:187], a[20:23], v[24:27]
    buffer_load_dwordx4 a[116:119], v250, s[28:31], s53 offen offset:1024 sc1
    v_mfma_f32_16x16x32_bf16 v[20:23], a[180:183], a[20:23], v[20:23]
    ds_read_b64_tr_b16 a[10:11], v243 offset:20480
    v_mfma_f32_16x16x32_bf16 v[16:19], a[176:179], a[20:23], v[16:19]
    s_waitcnt lgkmcnt(6)
    v_mfma_f32_16x16x32_bf16 v[32:35], a[176:179], a[24:27], v[32:35]
    ds_read_b64_tr_b16 a[12:13], v244 offset:14336
    v_mfma_f32_16x16x32_bf16 v[36:39], a[180:183], a[24:27], v[36:39]
    ds_read_b64_tr_b16 a[14:15], v244 offset:20480
    v_mfma_f32_16x16x32_bf16 v[40:43], a[184:187], a[24:27], v[40:43]
    v_mfma_f32_16x16x32_bf16 v[44:47], a[188:191], a[24:27], v[44:47]
    v_mfma_f32_16x16x32_bf16 v[60:63], a[188:191], a[28:31], v[60:63]
    ds_read_b64_tr_b16 a[16:17], v241 offset:16384
    v_mfma_f32_16x16x32_bf16 v[56:59], a[184:187], a[28:31], v[56:59]
    buffer_load_dwordx4 a[120:123], v251, s[28:31], s53 offen offset:2048 sc1
    v_mfma_f32_16x16x32_bf16 v[52:55], a[180:183], a[28:31], v[52:55]
    ds_read_b64_tr_b16 a[18:19], v241 offset:22528
    v_mfma_f32_16x16x32_bf16 v[48:51], a[176:179], a[28:31], v[48:51]
    s_waitcnt lgkmcnt(6)
    v_mfma_f32_16x16x32_bf16 v[64:67], a[176:179], a[0:3], v[64:67]
    ds_read_b64_tr_b16 a[20:21], v242 offset:16384
    v_mfma_f32_16x16x32_bf16 v[68:71], a[180:183], a[0:3], v[68:71]
    ds_read_b64_tr_b16 a[22:23], v242 offset:22528
    v_mfma_f32_16x16x32_bf16 v[72:75], a[184:187], a[0:3], v[72:75]
    v_mfma_f32_16x16x32_bf16 v[76:79], a[188:191], a[0:3], v[76:79]
    v_mfma_f32_16x16x32_bf16 v[92:95], a[188:191], a[4:7], v[92:95]
    ds_read_b64_tr_b16 a[24:25], v243 offset:16384
    v_mfma_f32_16x16x32_bf16 v[88:91], a[184:187], a[4:7], v[88:91]
    buffer_load_dwordx4 a[124:127], v252, s[28:31], s53 offen offset:3072 sc1
    v_mfma_f32_16x16x32_bf16 v[84:87], a[180:183], a[4:7], v[84:87]
    ds_read_b64_tr_b16 a[26:27], v243 offset:22528
    v_mfma_f32_16x16x32_bf16 v[80:83], a[176:179], a[4:7], v[80:83]
    s_waitcnt lgkmcnt(6)
    v_mfma_f32_16x16x32_bf16 v[96:99], a[176:179], a[8:11], v[96:99]
    ds_read_b64_tr_b16 a[28:29], v244 offset:16384
    v_mfma_f32_16x16x32_bf16 v[100:103], a[180:183], a[8:11], v[100:103]
    ds_read_b64_tr_b16 a[30:31], v244 offset:22528
    v_mfma_f32_16x16x32_bf16 v[104:107], a[184:187], a[8:11], v[104:107]
    v_mfma_f32_16x16x32_bf16 v[108:111], a[188:191], a[8:11], v[108:111]
    s_waitcnt vmcnt(28)
    s_barrier
    v_mfma_f32_16x16x32_bf16 v[124:127], a[188:191], a[12:15], v[124:127]
    ds_read_b64_tr_b16 a[0:1], v229 offset:0
    s_add_u32 s52, s52, s58
    s_add_u32 s53, s53, s58
    v_mfma_f32_16x16x32_bf16 v[120:123], a[184:187], a[12:15], v[120:123]
    s_add_u32 s56, s56, 1
    s_add_u32 m0, s55, 73728
    s_nop 0
    buffer_load_dwordx4 v227, s[32:35], s64 offen offset:0 lds
    v_mfma_f32_16x16x32_bf16 v[116:119], a[180:183], a[12:15], v[116:119]
    ds_read_b64_tr_b16 a[2:3], v229 offset:6144
    s_add_u32 s64, s64, s59
    v_mfma_f32_16x16x32_bf16 v[112:115], a[176:179], a[12:15], v[112:115]
    s_waitcnt lgkmcnt(6)
    v_mfma_f32_16x16x32_bf16 v[128:131], a[16:19], a[176:179], v[128:131]
    ds_read_b64_tr_b16 a[4:5], v230 offset:0
    v_mfma_f32_16x16x32_bf16 v[132:135], a[16:19], a[180:183], v[132:135]
    buffer_load_dwordx4 a[128:131], v224, s[28:31], s52 offen offset:0 sc1
    v_mfma_f32_16x16x32_bf16 v[136:139], a[16:19], a[184:187], v[136:139]
    ds_read_b64_tr_b16 a[6:7], v230 offset:6144
    v_mfma_f32_16x16x32_bf16 v[140:143], a[16:19], a[188:191], v[140:143]
    v_mfma_f32_16x16x32_bf16 v[156:159], a[20:23], a[188:191], v[156:159]
    ds_read_b64_tr_b16 a[8:9], v231 offset:0
    v_mfma_f32_16x16x32_bf16 v[152:155], a[20:23], a[184:187], v[152:155]
    ds_read_b64_tr_b16 a[10:11], v231 offset:6144
    v_mfma_f32_16x16x32_bf16 v[148:151], a[20:23], a[180:183], v[148:151]
    v_mfma_f32_16x16x32_bf16 v[144:147], a[20:23], a[176:179], v[144:147]
    s_waitcnt lgkmcnt(6)
    v_mfma_f32_16x16x32_bf16 v[160:163], a[24:27], a[176:179], v[160:163]
    ds_read_b64_tr_b16 a[12:13], v232 offset:0
    v_mfma_f32_16x16x32_bf16 v[164:167], a[24:27], a[180:183], v[164:167]
    buffer_load_dwordx4 v227, s[32:35], s65 offen offset:1024 lds
    s_add_u32 s65, s65, s59
    v_mfma_f32_16x16x32_bf16 v[168:171], a[24:27], a[184:187], v[168:171]
    ds_read_b64_tr_b16 a[14:15], v232 offset:6144
    v_mfma_f32_16x16x32_bf16 v[172:175], a[24:27], a[188:191], v[172:175]
    v_mfma_f32_16x16x32_bf16 v[188:191], a[28:31], a[188:191], v[188:191]
    ds_read_b64_tr_b16 a[16:17], v229 offset:2048
    v_mfma_f32_16x16x32_bf16 v[184:187], a[28:31], a[184:187], v[184:187]
    ds_read_b64_tr_b16 a[18:19], v229 offset:8192
    v_mfma_f32_16x16x32_bf16 v[180:183], a[28:31], a[180:183], v[180:183]
    v_mfma_f32_16x16x32_bf16 v[176:179], a[28:31], a[176:179], v[176:179]
    s_sub_u32 s57, s57, 1
    s_cmp_lg_u32 s57, 0
    s_cbranch_scc1 L_loop_37
L_epi_B:
    s_mov_b64 s[32:33], s[14:15]
    s_lshl_b32 s34, s62, 23
    s_mov_b32 s42, 0x200000
    buffer_load_dword a240, v253, s[32:35], s11 offen
    v_mov_b32 v247, v224
    v_accvgpr_read_b32 v250, a248
    v_accvgpr_read_b32 v251, a249
    v_accvgpr_read_b32 v252, a250
    v_accvgpr_read_b32 v253, a251
    s_lshl_b32 s55, s3, 10
    s_mov_b32 s54, 786432
    v_mbcnt_lo_u32_b32 v248, -1, 0
    v_mbcnt_hi_u32_b32 v248, -1, v248
    s_waitcnt lgkmcnt(0)
    s_barrier
    v_mov_b32 v238, 0xbdd2d3e8
    v_mov_b32 v239, 0xc0135761
    v_pk_mul_f32 v[230:231], v[0:1], v[0:1]
    v_pk_mul_f32 v[232:233], v[2:3], v[2:3]
    v_pk_mul_f32 v[234:235], v[4:5], v[4:5]
    v_pk_mul_f32 v[236:237], v[6:7], v[6:7]
    v_pk_fma_f32 v[230:231], v[230:231], v[238:239], v[238:239] op_sel:[0,0,1] op_sel_hi:[1,0,1]
    v_pk_fma_f32 v[232:233], v[232:233], v[238:239], v[238:239] op_sel:[0,0,1] op_sel_hi:[1,0,1]
    v_pk_fma_f32 v[234:235], v[234:235], v[238:239], v[238:239] op_sel:[0,0,1] op_sel_hi:[1,0,1]
    v_pk_fma_f32 v[236:237], v[236:237], v[238:239], v[238:239] op_sel:[0,0,1] op_sel_hi:[1,0,1]
    v_pk_mul_f32 v[230:231], v[230:231], v[0:1]
    v_pk_mul_f32 v[232:233], v[232:233], v[2:3]
    v_pk_mul_f32 v[234:235], v[234:235], v[4:5]
    v_pk_mul_f32 v[236:237], v[236:237], v[6:7]
    v_exp_f32 v230, v230
    v_exp_f32 v231, v231
    v_exp_f32 v232, v232
    v_exp_f32 v233, v233
    v_exp_f32 v234, v234
    v_exp_f32 v235, v235
    v_exp_f32 v236, v236
    v_exp_f32 v237, v237
    v_pk_add_f32 v[230:231], v[230:231], 1.0 op_sel_hi:[1,0]
    v_pk_add_f32 v[232:233], v[232:233], 1.0 op_sel_hi:[1,0]
    v_pk_add_f32 v[234:235], v[234:235], 1.0 op_sel_hi:[1,0]
    v_pk_add_f32 v[236:237], v[236:237], 1.0 op_sel_hi:[1,0]
    v_rcp_f32 v230, v230
    v_rcp_f32 v231, v231
    v_rcp_f32 v232, v232
    v_rcp_f32 v233, v233
    v_rcp_f32 v234, v234
    v_rcp_f32 v235, v235
    v_rcp_f32 v236, v236
    v_rcp_f32 v237, v237
    v_pk_mul_f32 v[0:1], v[0:1], v[230:231]
    v_pk_mul_f32 v[2:3], v[2:3], v[232:233]
    v_pk_mul_f32 v[4:5], v[4:5], v[234:235]
    v_pk_mul_f32 v[6:7], v[6:7], v[236:237]
    v_pk_mul_f32 v[208:209], v[0:1], v[0:1]
    v_pk_mul_f32 v[210:211], v[2:3], v[2:3]
    v_pk_mul_f32 v[212:213], v[4:5], v[4:5]
    v_pk_mul_f32 v[214:215], v[6:7], v[6:7]
    v_pk_mul_f32 v[230:231], v[8:9], v[8:9]
    v_pk_mul_f32 v[232:233], v[10:11], v[10:11]
    v_pk_mul_f32 v[234:235], v[12:13], v[12:13]
    v_pk_mul_f32 v[236:237], v[14:15], v[14:15]
    v_pk_fma_f32 v[230:231], v[230:231], v[238:239], v[238:239] op_sel:[0,0,1] op_sel_hi:[1,0,1]
    v_pk_fma_f32 v[232:233], v[232:233], v[238:239], v[238:239] op_sel:[0,0,1] op_sel_hi:[1,0,1]
    v_pk_fma_f32 v[234:235], v[234:235], v[238:239], v[238:239] op_sel:[0,0,1] op_sel_hi:[1,0,1]
    v_pk_fma_f32 v[236:237], v[236:237], v[238:239], v[238:239] op_sel:[0,0,1] op_sel_hi:[1,0,1]
    v_pk_mul_f32 v[230:231], v[230:231], v[8:9]
    v_pk_mul_f32 v[232:233], v[232:233], v[10:11]
    s_branch L_po_B_4
.p2align 12
L_pg_B_4:
    s_branch L_pg_K_0
L_po_B_4:
    v_pk_mul_f32 v[234:235], v[234:235], v[12:13]
    v_pk_mul_f32 v[236:237], v[236:237], v[14:15]
    v_exp_f32 v230, v230
    v_exp_f32 v231, v231
    v_exp_f32 v232, v232
    v_exp_f32 v233, v233
    v_exp_f32 v234, v234
    v_exp_f32 v235, v235
    v_exp_f32 v236, v236
    v_exp_f32 v237, v237
    v_pk_add_f32 v[230:231], v[230:231], 1.0 op_sel_hi:[1,0]
    v_pk_add_f32 v[232:233], v[232:233], 1.0 op_sel_hi:[1,0]
    v_pk_add_f32 v[234:235], v[234:235], 1.0 op_sel_hi:[1,0]
    v_pk_add_f32 v[236:237], v[236:237], 1.0 op_sel_hi:[1,0]
    v_rcp_f32 v230, v230
    v_rcp_f32 v231, v231
    v_rcp_f32 v232, v232
    v_rcp_f32 v233, v233
    v_rcp_f32 v234, v234
    v_rcp_f32 v235, v235
    v_rcp_f32 v236, v236
    v_rcp_f32 v237, v237
    v_pk_mul_f32 v[8:9], v[8:9], v[230:231]
    v_pk_mul_f32 v[10:11], v[10:11], v[232:233]
    v_pk_mul_f32 v[12:13], v[12:13], v[234:235]
    v_pk_mul_f32 v[14:15], v[14:15], v[236:237]
    v_pk_mul_f32 v[216:217], v[8:9], v[8:9]
    v_pk_mul_f32 v[218:219], v[10:11], v[10:11]
    v_pk_mul_f32 v[220:221], v[12:13], v[12:13]
    v_pk_mul_f32 v[222:223], v[14:15], v[14:15]
    v_pk_mul_f32 v[230:231], v[16:17], v[16:17]
    v_pk_mul_f32 v[232:233], v[18:19], v[18:19]
    v_pk_mul_f32 v[234:235], v[20:21], v[20:21]
    v_pk_mul_f32 v[236:237], v[22:23], v[22:23]
    v_pk_fma_f32 v[230:231], v[230:231], v[238:239], v[238:239] op_sel:[0,0,1] op_sel_hi:[1,0,1]
    v_pk_fma_f32 v[232:233], v[232:233], v[238:239], v[238:239] op_sel:[0,0,1] op_sel_hi:[1,0,1]
    v_pk_fma_f32 v[234:235], v[234:235], v[238:239], v[238:239] op_sel:[0,0,1] op_sel_hi:[1,0,1]
    v_pk_fma_f32 v[236:237], v[236:237], v[238:239], v[238:239] op_sel:[0,0,1] op_sel_hi:[1,0,1]
    v_pk_mul_f32 v[230:231], v[230:231], v[16:17]
    v_pk_mul_f32 v[232:233], v[232:233], v[18:19]
    v_pk_mul_f32 v[234:235], v[234:235], v[20:21]
    v_pk_mul_f32 v[236:237], v[236:237], v[22:23]
    v_exp_f32 v230, v230
    v_exp_f32 v231, v231
    v_exp_f32 v232, v232
    v_exp_f32 v233, v233
    v_exp_f32 v234, v234
    v_exp_f32 v235, v235
    v_exp_f32 v236, v236
    v_exp_f32 v237, v237
    v_pk_add_f32 v[230:231], v[230:231], 1.0 op_sel_hi:[1,0]
    v_pk_add_f32 v[232:233], v[232:233], 1.0 op_sel_hi:[1,0]
    v_pk_add_f32 v[234:235], v[234:235], 1.0 op_sel_hi:[1,0]
    v_pk_add_f32 v[236:237], v[236:237], 1.0 op_sel_hi:[1,0]
    v_rcp_f32 v230, v230
    v_rcp_f32 v231, v231
    v_rcp_f32 v232, v232
    v_rcp_f32 v233, v233
    v_rcp_f32 v234, v234
    v_rcp_f32 v235, v235
    v_rcp_f32 v236, v236
    v_rcp_f32 v237, v237
    v_pk_mul_f32 v[16:17], v[16:17], v[230:231]
    v_pk_mul_f32 v[18:19], v[18:19], v[232:233]
    v_pk_mul_f32 v[20:21], v[20:21], v[234:235]
    v_pk_mul_f32 v[22:23], v[22:23], v[236:237]
    v_pk_add_f32 v[192:193], v[0:1], v[16:17]
    v_pk_fma_f32 v[208:209], v[16:17], v[16:17], v[208:209]
    v_pk_add_f32 v[194:195], v[2:3], v[18:19]
    v_pk_fma_f32 v[210:211], v[18:19], v[18:19], v[210:211]
    v_pk_add_f32 v[196:197], v[4:5], v[20:21]
    v_pk_fma_f32 v[212:213], v[20:21], v[20:21], v[212:213]
    v_pk_add_f32 v[198:199], v[6:7], v[22:23]
    v_pk_fma_f32 v[214:215], v[22:23], v[22:23], v[214:215]
    v_pk_mul_f32 v[230:231], v[24:25], v[24:25]
    v_pk_mul_f32 v[232:233], v[26:27], v[26:27]
    v_pk_mul_f32 v[234:235], v[28:29], v[28:29]
    v_pk_mul_f32 v[236:237], v[30:31], v[30:31]
    v_pk_fma_f32 v[230:231], v[230:231], v[238:239], v[238:239] op_sel:[0,0,1] op_sel_hi:[1,0,1]
    v_pk_fma_f32 v[232:233], v[232:233], v[238:239], v[238:239] op_sel:[0,0,1] op_sel_hi:[1,0,1]
    v_pk_fma_f32 v[234:235], v[234:235], v[238:239], v[238:239] op_sel:[0,0,1] op_sel_hi:[1,0,1]
    v_pk_fma_f32 v[236:237], v[236:237], v[238:239], v[238:239] op_sel:[0,0,1] op_sel_hi:[1,0,1]
    v_pk_mul_f32 v[230:231], v[230:231], v[24:25]
    v_pk_mul_f32 v[232:233], v[232:233], v[26:27]
    v_pk_mul_f32 v[234:235], v[234:235], v[28:29]
    v_pk_mul_f32 v[236:237], v[236:237], v[30:31]
    v_exp_f32 v230, v230
    v_exp_f32 v231, v231
    v_exp_f32 v232, v232
    v_exp_f32 v233, v233
    v_exp_f32 v234, v234
    v_exp_f32 v235, v235
    v_exp_f32 v236, v236
    v_exp_f32 v237, v237
    v_pk_add_f32 v[230:231], v[230:231], 1.0 op_sel_hi:[1,0]
    v_pk_add_f32 v[232:233], v[232:233], 1.0 op_sel_hi:[1,0]
    v_pk_add_f32 v[234:235], v[234:235], 1.0 op_sel_hi:[1,0]
    v_pk_add_f32 v[236:237], v[236:237], 1.0 op_sel_hi:[1,0]
    v_rcp_f32 v230, v230
    v_rcp_f32 v231, v231
    v_rcp_f32 v232, v232
    v_rcp_f32 v233, v233
    v_rcp_f32 v234, v234
    v_rcp_f32 v235, v235
    v_rcp_f32 v236, v236
    v_rcp_f32 v237, v237
    v_pk_mul_f32 v[24:25], v[24:25], v[230:231]
    v_pk_mul_f32 v[26:27], v[26:27], v[232:233]
    v_pk_mul_f32 v[28:29], v[28:29], v[234:235]
    v_pk_mul_f32 v[30:31], v[30:31], v[236:237]
    v_pk_add_f32 v[200:201], v[8:9], v[24:25]
    v_pk_fma_f32 v[216:217], v[24:25], v[24:25], v[216:217]
    v_pk_add_f32 v[202:203], v[10:11], v[26:27]
    v_pk_fma_f32 v[218:219], v[26:27], v[26:27], v[218:219]
    v_pk_add_f32 v[204:205], v[12:13], v[28:29]
    v_pk_fma_f32 v[220:221], v[28:29], v[28:29], v[220:221]
    v_pk_add_f32 v[206:207], v[14:15], v[30:31]
    v_pk_fma_f32 v[222:223], v[30:31], v[30:31], v[222:223]
    v_pk_mul_f32 v[230:231], v[32:33], v[32:33]
    v_pk_mul_f32 v[232:233], v[34:35], v[34:35]
    v_pk_mul_f32 v[234:235], v[36:37], v[36:37]
    v_pk_mul_f32 v[236:237], v[38:39], v[38:39]
    v_pk_fma_f32 v[230:231], v[230:231], v[238:239], v[238:239] op_sel:[0,0,1] op_sel_hi:[1,0,1]
    v_pk_fma_f32 v[232:233], v[232:233], v[238:239], v[238:239] op_sel:[0,0,1] op_sel_hi:[1,0,1]
    v_pk_fma_f32 v[234:235], v[234:235], v[238:239], v[238:239] op_sel:[0,0,1] op_sel_hi:[1,0,1]
    v_pk_fma_f32 v[236:237], v[236:237], v[238:239], v[238:239] op_sel:[0,0,1] op_sel_hi:[1,0,1]
    v_pk_mul_f32 v[230:231], v[230:231], v[32:33]
    v_pk_mul_f32 v[232:233], v[232:233], v[34:35]
    v_pk_mul_f32 v[234:235], v[234:235], v[36:37]
    v_pk_mul_f32 v[236:237], v[236:237], v[38:39]
    v_exp_f32 v230, v230
    v_exp_f32 v231, v231
    v_exp_f32 v232, v232
    v_exp_f32 v233, v233
    v_exp_f32 v234, v234
    v_exp_f32 v235, v235
    v_exp_f32 v236, v236
    v_exp_f32 v237, v237
    v_pk_add_f32 v[230:231], v[230:231], 1.0 op_sel_hi:[1,0]
    v_pk_add_f32 v[232:233], v[232:233], 1.0 op_sel_hi:[1,0]
    v_pk_add_f32 v[234:235], v[234:235], 1.0 op_sel_hi:[1,0]
    v_pk_add_f32 v[236:237], v[236:237], 1.0 op_sel_hi:[1,0]
    v_rcp_f32 v230, v230
    v_rcp_f32 v231, v231
    v_rcp_f32 v232, v232
    v_rcp_f32 v233, v233
    v_rcp_f32 v234, v234
    v_rcp_f32 v235, v235
    v_rcp_f32 v236, v236
    v_rcp_f32 v237, v237
    v_pk_mul_f32 v[32:33], v[32:33], v[230:231]
    v_pk_mul_f32 v[34:35], v[34:35], v[232:233]
    v_pk_mul_f32 v[36:37], v[36:37], v[234:235]
    v_pk_mul_f32 v[38:39], v[38:39], v[236:237]
    v_pk_add_f32 v[192:193], v[192:193], v[32:33]
    v_pk_fma_f32 v[208:209], v[32:33], v[32:33], v[208:209]
    v_pk_add_f32 v[194:195], v[194:195], v[34:35]
    v_pk_fma_f32 v[210:211], v[34:35], v[34:35], v[210:211]
    v_pk_add_f32 v[196:197], v[196:197], v[36:37]
    v_pk_fma_f32 v[212:213], v[36:37], v[36:37], v[212:213]
    v_pk_add_f32 v[198:199], v[198:199], v[38:39]
    v_pk_fma_f32 v[214:215], v[38:39], v[38:39], v[214:215]
    v_pk_mul_f32 v[230:231], v[40:41], v[40:41]
    v_pk_mul_f32 v[232:233], v[42:43], v[42:43]
    v_pk_mul_f32 v[234:235], v[44:45], v[44:45]
    v_pk_mul_f32 v[236:237], v[46:47], v[46:47]
    v_pk_fma_f32 v[230:231], v[230:231], v[238:239], v[238:239] op_sel:[0,0,1] op_sel_hi:[1,0,1]
    v_pk_fma_f32 v[232:233], v[232:233], v[238:239], v[238:239] op_sel:[0,0,1] op_sel_hi:[1,0,1]
    v_pk_fma_f32 v[234:235], v[234:235], v[238:239], v[238:239] op_sel:[0,0,1] op_sel_hi:[1,0,1]
    v_pk_fma_f32 v[236:237], v[236:237], v[238:239], v[238:239] op_sel:[0,0,1] op_sel_hi:[1,0,1]
    v_pk_mul_f32 v[230:231], v[230:231], v[40:41]
    v_pk_mul_f32 v[232:233], v[232:233], v[42:43]
    v_pk_mul_f32 v[234:235], v[234:235], v[44:45]
    v_pk_mul_f32 v[236:237], v[236:237], v[46:47]
    v_exp_f32 v230, v230
    v_exp_f32 v231, v231
    v_exp_f32 v232, v232
    v_exp_f32 v233, v233
    v_exp_f32 v234, v234
    v_exp_f32 v235, v235
    v_exp_f32 v236, v236
    v_exp_f32 v237, v237
    v_pk_add_f32 v[230:231], v[230:231], 1.0 op_sel_hi:[1,0]
    v_pk_add_f32 v[232:233], v[232:233], 1.0 op_sel_hi:[1,0]
    v_pk_add_f32 v[234:235], v[234:235], 1.0 op_sel_hi:[1,0]
    v_pk_add_f32 v[236:237], v[236:237], 1.0 op_sel_hi:[1,0]
    v_rcp_f32 v230, v230
    v_rcp_f32 v231, v231
    v_rcp_f32 v232, v232
    v_rcp_f32 v233, v233
    v_rcp_f32 v234, v234
    v_rcp_f32 v235, v235
    v_rcp_f32 v236, v236
    v_rcp_f32 v237, v237
    v_pk_mul_f32 v[40:41], v[40:41], v[230:231]
    v_pk_mul_f32 v[42:43], v[42:43], v[232:233]
    v_pk_mul_f32 v[44:45], v[44:45], v[234:235]
    v_pk_mul_f32 v[46:47], v[46:47], v[236:237]
    v_pk_add_f32 v[200:201], v[200:201], v[40:41]
    v_pk_fma_f32 v[216:217], v[40:41], v[40:41], v[216:217]
    v_pk_add_f32 v[202:203], v[202:203], v[42:43]
    v_pk_fma_f32 v[218:219], v[42:43], v[42:43], v[218:219]
    v_pk_add_f32 v[204:205], v[204:205], v[44:45]
    v_pk_fma_f32 v[220:221], v[44:45], v[44:45], v[220:221]
    v_pk_add_f32 v[206:207], v[206:207], v[46:47]
    v_pk_fma_f32 v[222:223], v[46:47], v[46:47], v[222:223]
    v_pk_mul_f32 v[230:231], v[48:49], v[48:49]
    v_pk_mul_f32 v[232:233], v[50:51], v[50:51]
    v_pk_mul_f32 v[234:235], v[52:53], v[52:53]
    v_pk_mul_f32 v[236:237], v[54:55], v[54:55]
    v_pk_fma_f32 v[230:231], v[230:231], v[238:239], v[238:239] op_sel:[0,0,1] op_sel_hi:[1,0,1]
    v_pk_fma_f32 v[232:233], v[232:233], v[238:239], v[238:239] op_sel:[0,0,1] op_sel_hi:[1,0,1]
    v_pk_fma_f32 v[234:235], v[234:235], v[238:239], v[238:239] op_sel:[0,0,1] op_sel_hi:[1,0,1]
    v_pk_fma_f32 v[236:237], v[236:237], v[238:239], v[238:239] op_sel:[0,0,1] op_sel_hi:[1,0,1]
    v_pk_mul_f32 v[230:231], v[230:231], v[48:49]
    v_pk_mul_f32 v[232:233], v[232:233], v[50:51]
    v_pk_mul_f32 v[234:235], v[234:235], v[52:53]
    v_pk_mul_f32 v[236:237], v[236:237], v[54:55]
    v_exp_f32 v230, v230
    v_exp_f32 v231, v231
    v_exp_f32 v232, v232
    v_exp_f32 v233, v233
    v_exp_f32 v234, v234
    v_exp_f32 v235, v235
    v_exp_f32 v236, v236
    v_exp_f32 v237, v237
    v_pk_add_f32 v[230:231], v[230:231], 1.0 op_sel_hi:[1,0]
    v_pk_add_f32 v[232:233], v[232:233], 1.0 op_sel_hi:[1,0]
    v_pk_add_f32 v[234:235], v[234:235], 1.0 op_sel_hi:[1,0]
    v_pk_add_f32 v[236:237], v[236:237], 1.0 op_sel_hi:[1,0]
    v_rcp_f32 v230, v230
    v_rcp_f32 v231, v231
    v_rcp_f32 v232, v232
    v_rcp_f32 v233, v233
    v_rcp_f32 v234, v234
    v_rcp_f32 v235, v235
    v_rcp_f32 v236, v236
    v_rcp_f32 v237, v237
    v_pk_mul_f32 v[48:49], v[48:49], v[230:231]
    v_pk_mul_f32 v[50:51], v[50:51], v[232:233]
    v_pk_mul_f32 v[52:53], v[52:53], v[234:235]
    v_pk_mul_f32 v[54:55], v[54:55], v[236:237]
    v_pk_add_f32 v[192:193], v[192:193], v[48:49]
    v_pk_fma_f32 v[208:209], v[48:49], v[48:49], v[208:209]
    v_pk_add_f32 v[194:195], v[194:195], v[50:51]
    v_pk_fma_f32 v[210:211], v[50:51], v[50:51], v[210:211]
    v_pk_add_f32 v[196:197], v[196:197], v[52:53]
    v_pk_fma_f32 v[212:213], v[52:53], v[52:53], v[212:213]
    v_pk_add_f32 v[198:199], v[198:199], v[54:55]
    v_pk_fma_f32 v[214:215], v[54:55], v[54:55], v[214:215]
    v_pk_mul_f32 v[230:231], v[56:57], v[56:57]
    v_pk_mul_f32 v[232:233], v[58:59], v[58:59]
    v_pk_mul_f32 v[234:235], v[60:61], v[60:61]
    v_pk_mul_f32 v[236:237], v[62:63], v[62:63]
    v_pk_fma_f32 v[230:231], v[230:231], v[238:239], v[238:239] op_sel:[0,0,1] op_sel_hi:[1,0,1]
    v_pk_fma_f32 v[232:233], v[232:233], v[238:239], v[238:239] op_sel:[0,0,1] op_sel_hi:[1,0,1]
    v_pk_fma_f32 v[234:235], v[234:235], v[238:239], v[238:239] op_sel:[0,0,1] op_sel_hi:[1,0,1]
    v_pk_fma_f32 v[236:237], v[236:237], v[238:239], v[238:239] op_sel:[0,0,1] op_sel_hi:[1,0,1]
    v_pk_mul_f32 v[230:231], v[230:231], v[56:57]
    v_pk_mul_f32 v[232:233], v[232:233], v[58:59]
    v_pk_mul_f32 v[234:235], v[234:235], v[60:61]
    v_pk_mul_f32 v[236:237], v[236:237], v[62:63]
    v_exp_f32 v230, v230
    v_exp_f32 v231, v231
    v_exp_f32 v232, v232
    v_exp_f32 v233, v233
    v_exp_f32 v234, v234
    v_exp_f32 v235, v235
    v_exp_f32 v236, v236
    v_exp_f32 v237, v237
    v_pk_add_f32 v[230:231], v[230:231], 1.0 op_sel_hi:[1,0]
    v_pk_add_f32 v[232:233], v[232:233], 1.0 op_sel_hi:[1,0]
    v_pk_add_f32 v[234:235], v[234:235], 1.0 op_sel_hi:[1,0]
    v_pk_add_f32 v[236:237], v[236:237], 1.0 op_sel_hi:[1,0]
    v_rcp_f32 v230, v230
    v_rcp_f32 v231, v231
    v_rcp_f32 v232, v232
    v_rcp_f32 v233, v233
    v_rcp_f32 v234, v234
    v_rcp_f32 v235, v235
    v_rcp_f32 v236, v236
    v_rcp_f32 v237, v237
    v_pk_mul_f32 v[56:57], v[56:57], v[230:231]
    v_pk_mul_f32 v[58:59], v[58:59], v[232:233]
    v_pk_mul_f32 v[60:61], v[60:61], v[234:235]
    v_pk_mul_f32 v[62:63], v[62:63], v[236:237]
    v_pk_add_f32 v[200:201], v[200:201], v[56:57]
    v_pk_fma_f32 v[216:217], v[56:57], v[56:57], v[216:217]
    v_pk_add_f32 v[202:203], v[202:203], v[58:59]
    v_pk_fma_f32 v[218:219], v[58:59], v[58:59], v[218:219]
    v_pk_add_f32 v[204:205], v[204:205], v[60:61]
    v_pk_fma_f32 v[220:221], v[60:61], v[60:61], v[220:221]
    v_pk_add_f32 v[206:207], v[206:207], v[62:63]
    v_pk_fma_f32 v[222:223], v[62:63], v[62:63], v[222:223]
    v_pk_mul_f32 v[230:231], v[64:65], v[64:65]
    v_pk_mul_f32 v[232:233], v[66:67], v[66:67]
    v_pk_mul_f32 v[234:235], v[68:69], v[68:69]
    v_pk_mul_f32 v[236:237], v[70:71], v[70:71]
    v_pk_fma_f32 v[230:231], v[230:231], v[238:239], v[238:239] op_sel:[0,0,1] op_sel_hi:[1,0,1]
    v_pk_fma_f32 v[232:233], v[232:233], v[238:239], v[238:239] op_sel:[0,0,1] op_sel_hi:[1,0,1]
    s_mov_b32 s58, 0
    buffer_load_dwordx4 a[0:3], v247, s[28:31], s58 offen
    v_pk_fma_f32 v[234:235], v[234:235], v[238:239], v[238:239] op_sel:[0,0,1] op_sel_hi:[1,0,1]
    v_pk_fma_f32 v[236:237], v[236:237], v[238:239], v[238:239] op_sel:[0,0,1] op_sel_hi:[1,0,1]
    v_pk_mul_f32 v[230:231], v[230:231], v[64:65]
    v_pk_mul_f32 v[232:233], v[232:233], v[66:67]
    v_pk_mul_f32 v[234:235], v[234:235], v[68:69]
    v_pk_mul_f32 v[236:237], v[236:237], v[70:71]
    v_exp_f32 v230, v230
    v_exp_f32 v231, v231
    v_exp_f32 v232, v232
    v_exp_f32 v233, v233
    v_exp_f32 v234, v234
    v_exp_f32 v235, v235
    v_exp_f32 v236, v236
    v_exp_f32 v237, v237
    v_pk_add_f32 v[230:231], v[230:231], 1.0 op_sel_hi:[1,0]
    v_pk_add_f32 v[232:233], v[232:233], 1.0 op_sel_hi:[1,0]
    v_pk_add_f32 v[234:235], v[234:235], 1.0 op_sel_hi:[1,0]
    v_pk_add_f32 v[236:237], v[236:237], 1.0 op_sel_hi:[1,0]
    v_rcp_f32 v230, v230
    v_rcp_f32 v231, v231
    v_rcp_f32 v232, v232
    v_rcp_f32 v233, v233
    v_rcp_f32 v234, v234
    v_rcp_f32 v235, v235
    v_rcp_f32 v236, v236
    v_rcp_f32 v237, v237
    v_pk_mul_f32 v[64:65], v[64:65], v[230:231]
    v_pk_mul_f32 v[66:67], v[66:67], v[232:233]
    v_pk_mul_f32 v[68:69], v[68:69], v[234:235]
    v_pk_mul_f32 v[70:71], v[70:71], v[236:237]
    s_mov_b32 s58, 65536
    buffer_load_dwordx4 a[4:7], v247, s[28:31], s58 offen
    v_pk_add_f32 v[192:193], v[192:193], v[64:65]
    v_pk_fma_f32 v[208:209], v[64:65], v[64:65], v[208:209]
    v_pk_add_f32 v[194:195], v[194:195], v[66:67]
    v_pk_fma_f32 v[210:211], v[66:67], v[66:67], v[210:211]
    v_pk_add_f32 v[196:197], v[196:197], v[68:69]
    v_pk_fma_f32 v[212:213], v[68:69], v[68:69], v[212:213]
    v_pk_add_f32 v[198:199], v[198:199], v[70:71]
    v_pk_fma_f32 v[214:215], v[70:71], v[70:71], v[214:215]
    v_pk_mul_f32 v[230:231], v[72:73], v[72:73]
    v_pk_mul_f32 v[232:233], v[74:75], v[74:75]
    v_pk_mul_f32 v[234:235], v[76:77], v[76:77]
    v_pk_mul_f32 v[236:237], v[78:79], v[78:79]
    v_pk_fma_f32 v[230:231], v[230:231], v[238:239], v[238:239] op_sel:[0,0,1] op_sel_hi:[1,0,1]
    v_pk_fma_f32 v[232:233], v[232:233], v[238:239], v[238:239] op_sel:[0,0,1] op_sel_hi:[1,0,1]
    v_pk_fma_f32 v[234:235], v[234:235], v[238:239], v[238:239] op_sel:[0,0,1] op_sel_hi:[1,0,1]
    v_pk_fma_f32 v[236:237], v[236:237], v[238:239], v[238:239] op_sel:[0,0,1] op_sel_hi:[1,0,1]
    v_pk_mul_f32 v[230:231], v[230:231], v[72:73]
    v_pk_mul_f32 v[232:233], v[232:233], v[74:75]
    v_pk_mul_f32 v[234:235], v[234:235], v[76:77]
    v_pk_mul_f32 v[236:237], v[236:237], v[78:79]
    v_exp_f32 v230, v230
    v_exp_f32 v231, v231
    v_exp_f32 v232, v232
    v_exp_f32 v233, v233
    v_exp_f32 v234, v234
    v_exp_f32 v235, v235
    v_exp_f32 v236, v236
    v_exp_f32 v237, v237
    v_pk_add_f32 v[230:231], v[230:231], 1.0 op_sel_hi:[1,0]
    v_pk_add_f32 v[232:233], v[232:233], 1.0 op_sel_hi:[1,0]
    s_mov_b32 s58, 131072
    buffer_load_dwordx4 a[8:11], v247, s[28:31], s58 offen
    v_pk_add_f32 v[234:235], v[234:235], 1.0 op_sel_hi:[1,0]
    v_pk_add_f32 v[236:237], v[236:237], 1.0 op_sel_hi:[1,0]
    v_rcp_f32 v230, v230
    v_rcp_f32 v231, v231
    v_rcp_f32 v232, v232
    v_rcp_f32 v233, v233
    v_rcp_f32 v234, v234
    v_rcp_f32 v235, v235
    v_rcp_f32 v236, v236
    v_rcp_f32 v237, v237
    v_pk_mul_f32 v[72:73], v[72:73], v[230:231]
    v_pk_mul_f32 v[74:75], v[74:75], v[232:233]
    v_pk_mul_f32 v[76:77], v[76:77], v[234:235]
    v_pk_mul_f32 v[78:79], v[78:79], v[236:237]
    v_pk_add_f32 v[200:201], v[200:201], v[72:73]
    v_pk_fma_f32 v[216:217], v[72:73], v[72:73], v[216:217]
    v_pk_add_f32 v[202:203], v[202:203], v[74:75]
    v_pk_fma_f32 v[218:219], v[74:75], v[74:75], v[218:219]
    v_pk_add_f32 v[204:205], v[204:205], v[76:77]
    v_pk_fma_f32 v[220:221], v[76:77], v[76:77], v[220:221]
    v_pk_add_f32 v[206:207], v[206:207], v[78:79]
    v_pk_fma_f32 v[222:223], v[78:79], v[78:79], v[222:223]
    v_pk_mul_f32 v[230:231], v[80:81], v[80:81]
    v_pk_mul_f32 v[232:233], v[82:83], v[82:83]
    v_pk_mul_f32 v[234:235], v[84:85], v[84:85]
    v_pk_mul_f32 v[236:237], v[86:87], v[86:87]
    v_pk_fma_f32 v[230:231], v[230:231], v[238:239], v[238:239] op_sel:[0,0,1] op_sel_hi:[1,0,1]
    v_pk_fma_f32 v[232:233], v[232:233], v[238:239], v[238:239] op_sel:[0,0,1] op_sel_hi:[1,0,1]
    v_pk_fma_f32 v[234:235], v[234:235], v[238:239], v[238:239] op_sel:[0,0,1] op_sel_hi:[1,0,1]
    v_pk_fma_f32 v[236:237], v[236:237], v[238:239], v[238:239] op_sel:[0,0,1] op_sel_hi:[1,0,1]
    s_mov_b32 s58, 196608
    buffer_load_dwordx4 a[12:15], v247, s[28:31], s58 offen
    v_pk_mul_f32 v[230:231], v[230:231], v[80:81]
    v_pk_mul_f32 v[232:233], v[232:233], v[82:83]
    v_pk_mul_f32 v[234:235], v[234:235], v[84:85]
    v_pk_mul_f32 v[236:237], v[236:237], v[86:87]
    v_exp_f32 v230, v230
    v_exp_f32 v231, v231
    v_exp_f32 v232, v232
    v_exp_f32 v233, v233
    v_exp_f32 v234, v234
    v_exp_f32 v235, v235
    v_exp_f32 v236, v236
    v_exp_f32 v237, v237
    v_pk_add_f32 v[230:231], v[230:231], 1.0 op_sel_hi:[1,0]
    v_pk_add_f32 v[232:233], v[232:233], 1.0 op_sel_hi:[1,0]
    v_pk_add_f32 v[234:235], v[234:235], 1.0 op_sel_hi:[1,0]
    v_pk_add_f32 v[236:237], v[236:237], 1.0 op_sel_hi:[1,0]
    v_rcp_f32 v230, v230
    v_rcp_f32 v231, v231
    v_rcp_f32 v232, v232
    v_rcp_f32 v233, v233
    v_rcp_f32 v234, v234
    v_rcp_f32 v235, v235
    v_rcp_f32 v236, v236
    v_rcp_f32 v237, v237
    v_pk_mul_f32 v[80:81], v[80:81], v[230:231]
    v_pk_mul_f32 v[82:83], v[82:83], v[232:233]
    v_pk_mul_f32 v[84:85], v[84:85], v[234:235]
    v_pk_mul_f32 v[86:87], v[86:87], v[236:237]
    v_pk_add_f32 v[192:193], v[192:193], v[80:81]
    v_pk_fma_f32 v[208:209], v[80:81], v[80:81], v[208:209]
    s_mov_b32 s58, 262144
    buffer_load_dwordx4 a[16:19], v247, s[28:31], s58 offen
    v_pk_add_f32 v[194:195], v[194:195], v[82:83]
    v_pk_fma_f32 v[210:211], v[82:83], v[82:83], v[210:211]
    v_pk_add_f32 v[196:197], v[196:197], v[84:85]
    v_pk_fma_f32 v[212:213], v[84:85], v[84:85], v[212:213]
    v_pk_add_f32 v[198:199], v[198:199], v[86:87]
    v_pk_fma_f32 v[214:215], v[86:87], v[86:87], v[214:215]
    v_pk_mul_f32 v[230:231], v[88:89], v[88:89]
    v_pk_mul_f32 v[232:233], v[90:91], v[90:91]
    v_pk_mul_f32 v[234:235], v[92:93], v[92:93]
    v_pk_mul_f32 v[236:237], v[94:95], v[94:95]
    v_pk_fma_f32 v[230:231], v[230:231], v[238:239], v[238:239] op_sel:[0,0,1] op_sel_hi:[1,0,1]
    v_pk_fma_f32 v[232:233], v[232:233], v[238:239], v[238:239] op_sel:[0,0,1] op_sel_hi:[1,0,1]
    v_pk_fma_f32 v[234:235], v[234:235], v[238:239], v[238:239] op_sel:[0,0,1] op_sel_hi:[1,0,1]
    v_pk_fma_f32 v[236:237], v[236:237], v[238:239], v[238:239] op_sel:[0,0,1] op_sel_hi:[1,0,1]
    v_pk_mul_f32 v[230:231], v[230:231], v[88:89]
    v_pk_mul_f32 v[232:233], v[232:233], v[90:91]
    v_pk_mul_f32 v[234:235], v[234:235], v[92:93]
    v_pk_mul_f32 v[236:237], v[236:237], v[94:95]
    v_exp_f32 v230, v230
    v_exp_f32 v231, v231
    v_exp_f32 v232, v232
    v_exp_f32 v233, v233
    v_exp_f32 v234, v234
    v_exp_f32 v235, v235
    v_exp_f32 v236, v236
    v_exp_f32 v237, v237
    v_pk_add_f32 v[230:231], v[230:231], 1.0 op_sel_hi:[1,0]
    v_pk_add_f32 v[232:233], v[232:233], 1.0 op_sel_hi:[1,0]
    v_pk_add_f32 v[234:235], v[234:235], 1.0 op_sel_hi:[1,0]
    v_pk_add_f32 v[236:237], v[236:237], 1.0 op_sel_hi:[1,0]
    s_mov_b32 s58, 327680
    buffer_load_dwordx4 a[20:23], v247, s[28:31], s58 offen
    v_rcp_f32 v230, v230
    v_rcp_f32 v231, v231
    v_rcp_f32 v232, v232
    v_rcp_f32 v233, v233
    v_rcp_f32 v234, v234
    v_rcp_f32 v235, v235
    v_rcp_f32 v236, v236
    v_rcp_f32 v237, v237
    v_pk_mul_f32 v[88:89], v[88:89], v[230:231]
    v_pk_mul_f32 v[90:91], v[90:91], v[232:233]
    v_pk_mul_f32 v[92:93], v[92:93], v[234:235]
    v_pk_mul_f32 v[94:95], v[94:95], v[236:237]
    v_pk_add_f32 v[200:201], v[200:201], v[88:89]
    v_pk_fma_f32 v[216:217], v[88:89], v[88:89], v[216:217]
    v_pk_add_f32 v[202:203], v[202:203], v[90:91]
    v_pk_fma_f32 v[218:219], v[90:91], v[90:91], v[218:219]
    v_pk_add_f32 v[204:205], v[204:205], v[92:93]
    v_pk_fma_f32 v[220:221], v[92:93], v[92:93], v[220:221]
    v_pk_add_f32 v[206:207], v[206:207], v[94:95]
    v_pk_fma_f32 v[222:223], v[94:95], v[94:95], v[222:223]
    v_pk_mul_f32 v[230:231], v[96:97], v[96:97]
    v_pk_mul_f32 v[232:233], v[98:99], v[98:99]
    v_pk_mul_f32 v[234:235], v[100:101], v[100:101]
    v_pk_mul_f32 v[236:237], v[102:103], v[102:103]
    v_pk_fma_f32 v[230:231], v[230:231], v[238:239], v[238:239] op_sel:[0,0,1] op_sel_hi:[1,0,1]
    v_pk_fma_f32 v[232:233], v[232:233], v[238:239], v[238:239] op_sel:[0,0,1] op_sel_hi:[1,0,1]
    v_pk_fma_f32 v[234:235], v[234:235], v[238:239], v[238:239] op_sel:[0,0,1] op_sel_hi:[1,0,1]
    v_pk_fma_f32 v[236:237], v[236:237], v[238:239], v[238:239] op_sel:[0,0,1] op_sel_hi:[1,0,1]
    v_pk_mul_f32 v[230:231], v[230:231], v[96:97]
    v_pk_mul_f32 v[232:233], v[232:233], v[98:99]
    s_mov_b32 s58, 393216
    buffer_load_dwordx4 a[24:27], v247, s[28:31], s58 offen
    v_pk_mul_f32 v[234:235], v[234:235], v[100:101]
    v_pk_mul_f32 v[236:237], v[236:237], v[102:103]
    v_exp_f32 v230, v230
    v_exp_f32 v231, v231
    v_exp_f32 v232, v232
    v_exp_f32 v233, v233
    v_exp_f32 v234, v234
    v_exp_f32 v235, v235
    v_exp_f32 v236, v236
    v_exp_f32 v237, v237
    v_pk_add_f32 v[230:231], v[230:231], 1.0 op_sel_hi:[1,0]
    v_pk_add_f32 v[232:233], v[232:233], 1.0 op_sel_hi:[1,0]
    v_pk_add_f32 v[234:235], v[234:235], 1.0 op_sel_hi:[1,0]
    v_pk_add_f32 v[236:237], v[236:237], 1.0 op_sel_hi:[1,0]
    v_rcp_f32 v230, v230
    v_rcp_f32 v231, v231
    v_rcp_f32 v232, v232
    v_rcp_f32 v233, v233
    v_rcp_f32 v234, v234
    v_rcp_f32 v235, v235
    v_rcp_f32 v236, v236
    v_rcp_f32 v237, v237
    v_pk_mul_f32 v[96:97], v[96:97], v[230:231]
    v_pk_mul_f32 v[98:99], v[98:99], v[232:233]
    v_pk_mul_f32 v[100:101], v[100:101], v[234:235]
    v_pk_mul_f32 v[102:103], v[102:103], v[236:237]
    v_pk_add_f32 v[192:193], v[192:193], v[96:97]
    v_pk_fma_f32 v[208:209], v[96:97], v[96:97], v[208:209]
    v_pk_add_f32 v[194:195], v[194:195], v[98:99]
    v_pk_fma_f32 v[210:211], v[98:99], v[98:99], v[210:211]
    s_mov_b32 s58, 458752
    buffer_load_dwordx4 a[28:31], v247, s[28:31], s58 offen
    v_pk_add_f32 v[196:197], v[196:197], v[100:101]
    v_pk_fma_f32 v[212:213], v[100:101], v[100:101], v[212:213]
    v_pk_add_f32 v[198:199], v[198:199], v[102:103]
    v_pk_fma_f32 v[214:215], v[102:103], v[102:103], v[214:215]
    v_pk_mul_f32 v[230:231], v[104:105], v[104:105]
    v_pk_mul_f32 v[232:233], v[106:107], v[106:107]
    v_pk_mul_f32 v[234:235], v[108:109], v[108:109]
    v_pk_mul_f32 v[236:237], v[110:111], v[110:111]
    v_pk_fma_f32 v[230:231], v[230:231], v[238:239], v[238:239] op_sel:[0,0,1] op_sel_hi:[1,0,1]
    v_pk_fma_f32 v[232:233], v[232:233], v[238:239], v[238:239] op_sel:[0,0,1] op_sel_hi:[1,0,1]
    v_pk_fma_f32 v[234:235], v[234:235], v[238:239], v[238:239] op_sel:[0,0,1] op_sel_hi:[1,0,1]
    v_pk_fma_f32 v[236:237], v[236:237], v[238:239], v[238:239] op_sel:[0,0,1] op_sel_hi:[1,0,1]
    v_pk_mul_f32 v[230:231], v[230:231], v[104:105]
    v_pk_mul_f32 v[232:233], v[232:233], v[106:107]
    v_pk_mul_f32 v[234:235], v[234:235], v[108:109]
    v_pk_mul_f32 v[236:237], v[236:237], v[110:111]
    v_exp_f32 v230, v230
    v_exp_f32 v231, v231
    v_exp_f32 v232, v232
    v_exp_f32 v233, v233
    v_exp_f32 v234, v234
    v_exp_f32 v235, v235
    v_exp_f32 v236, v236
    v_exp_f32 v237, v237
    v_pk_add_f32 v[230:231], v[230:231], 1.0 op_sel_hi:[1,0]
    v_pk_add_f32 v[232:233], v[232:233], 1.0 op_sel_hi:[1,0]
    v_pk_add_f32 v[234:235], v[234:235], 1.0 op_sel_hi:[1,0]
    v_pk_add_f32 v[236:237], v[236:237], 1.0 op_sel_hi:[1,0]
    v_rcp_f32 v230, v230
    v_rcp_f32 v231, v231
    s_mov_b32 s58, 2162688
    buffer_load_dwordx4 a[132:135], v247, s[28:31], s58 offen
    v_rcp_f32 v232, v232
    v_rcp_f32 v233, v233
    v_rcp_f32 v234, v234
    v_rcp_f32 v235, v235
    v_rcp_f32 v236, v236
    v_rcp_f32 v237, v237
    v_pk_mul_f32 v[104:105], v[104:105], v[230:231]
    v_pk_mul_f32 v[106:107], v[106:107], v[232:233]
    v_pk_mul_f32 v[108:109], v[108:109], v[234:235]
    v_pk_mul_f32 v[110:111], v[110:111], v[236:237]
    v_pk_add_f32 v[200:201], v[200:201], v[104:105]
    v_pk_fma_f32 v[216:217], v[104:105], v[104:105], v[216:217]
    v_pk_add_f32 v[202:203], v[202:203], v[106:107]
    v_pk_fma_f32 v[218:219], v[106:107], v[106:107], v[218:219]
    v_pk_add_f32 v[204:205], v[204:205], v[108:109]
    v_pk_fma_f32 v[220:221], v[108:109], v[108:109], v[220:221]
    v_pk_add_f32 v[206:207], v[206:207], v[110:111]
    v_pk_fma_f32 v[222:223], v[110:111], v[110:111], v[222:223]
    v_pk_mul_f32 v[230:231], v[112:113], v[112:113]
    v_pk_mul_f32 v[232:233], v[114:115], v[114:115]
    v_pk_mul_f32 v[234:235], v[116:117], v[116:117]
    v_pk_mul_f32 v[236:237], v[118:119], v[118:119]
    v_pk_fma_f32 v[230:231], v[230:231], v[238:239], v[238:239] op_sel:[0,0,1] op_sel_hi:[1,0,1]
    v_pk_fma_f32 v[232:233], v[232:233], v[238:239], v[238:239] op_sel:[0,0,1] op_sel_hi:[1,0,1]
    v_pk_fma_f32 v[234:235], v[234:235], v[238:239], v[238:239] op_sel:[0,0,1] op_sel_hi:[1,0,1]
    v_pk_fma_f32 v[236:237], v[236:237], v[238:239], v[238:239] op_sel:[0,0,1] op_sel_hi:[1,0,1]
    v_pk_mul_f32 v[230:231], v[230:231], v[112:113]
    v_pk_mul_f32 v[232:233], v[232:233], v[114:115]
    v_pk_mul_f32 v[234:235], v[234:235], v[116:117]
    v_pk_mul_f32 v[236:237], v[236:237], v[118:119]
    s_mov_b32 s58, 2228224
    buffer_load_dwordx4 a[136:139], v247, s[28:31], s58 offen
    v_exp_f32 v230, v230
    v_exp_f32 v231, v231
    v_exp_f32 v232, v232
    v_exp_f32 v233, v233
    v_exp_f32 v234, v234
    v_exp_f32 v235, v235
    v_exp_f32 v236, v236
    v_exp_f32 v237, v237
    v_pk_add_f32 v[230:231], v[230:231], 1.0 op_sel_hi:[1,0]
    v_pk_add_f32 v[232:233], v[232:233], 1.0 op_sel_hi:[1,0]
    v_pk_add_f32 v[234:235], v[234:235], 1.0 op_sel_hi:[1,0]
    v_pk_add_f32 v[236:237], v[236:237], 1.0 op_sel_hi:[1,0]
    v_rcp_f32 v230, v230
    v_rcp_f32 v231, v231
    v_rcp_f32 v232, v232
    v_rcp_f32 v233, v233
    v_rcp_f32 v234, v234
    v_rcp_f32 v235, v235
    v_rcp_f32 v236, v236
    v_rcp_f32 v237, v237
    v_pk_mul_f32 v[112:113], v[112:113], v[230:231]
    v_pk_mul_f32 v[114:115], v[114:115], v[232:233]
    v_pk_mul_f32 v[116:117], v[116:117], v[234:235]
    v_pk_mul_f32 v[118:119], v[118:119], v[236:237]
    v_pk_add_f32 v[192:193], v[192:193], v[112:113]
    v_pk_fma_f32 v[208:209], v[112:113], v[112:113], v[208:209]
    v_pk_add_f32 v[194:195], v[194:195], v[114:115]
    v_pk_fma_f32 v[210:211], v[114:115], v[114:115], v[210:211]
    v_pk_add_f32 v[196:197], v[196:197], v[116:117]
    v_pk_fma_f32 v[212:213], v[116:117], v[116:117], v[212:213]
    v_pk_add_f32 v[198:199], v[198:199], v[118:119]
    v_pk_fma_f32 v[214:215], v[118:119], v[118:119], v[214:215]
    s_branch L_po_B_5
.p2align 12
L_pg_B_5:
    s_branch L_pg_K_1
L_po_B_5:
    v_pk_mul_f32 v[230:231], v[120:121], v[120:121]
    v_pk_mul_f32 v[232:233], v[122:123], v[122:123]
    v_pk_mul_f32 v[234:235], v[124:125], v[124:125]
    v_pk_mul_f32 v[236:237], v[126:127], v[126:127]
    v_pk_fma_f32 v[230:231], v[230:231], v[238:239], v[238:239] op_sel:[0,0,1] op_sel_hi:[1,0,1]
    v_pk_fma_f32 v[232:233], v[232:233], v[238:239], v[238:239] op_sel:[0,0,1] op_sel_hi:[1,0,1]
    v_pk_fma_f32 v[234:235], v[234:235], v[238:239], v[238:239] op_sel:[0,0,1] op_sel_hi:[1,0,1]
    v_pk_fma_f32 v[236:237], v[236:237], v[238:239], v[238:239] op_sel:[0,0,1] op_sel_hi:[1,0,1]
    v_pk_mul_f32 v[230:231], v[230:231], v[120:121]
    v_pk_mul_f32 v[232:233], v[232:233], v[122:123]
    v_pk_mul_f32 v[234:235], v[234:235], v[124:125]
    v_pk_mul_f32 v[236:237], v[236:237], v[126:127]
    v_exp_f32 v230, v230
    v_exp_f32 v231, v231
    v_exp_f32 v232, v232
    v_exp_f32 v233, v233
    v_exp_f32 v234, v234
    v_exp_f32 v235, v235
    v_exp_f32 v236, v236
    v_exp_f32 v237, v237
    v_pk_add_f32 v[230:231], v[230:231], 1.0 op_sel_hi:[1,0]
    v_pk_add_f32 v[232:233], v[232:233], 1.0 op_sel_hi:[1,0]
    v_pk_add_f32 v[234:235], v[234:235], 1.0 op_sel_hi:[1,0]
    v_pk_add_f32 v[236:237], v[236:237], 1.0 op_sel_hi:[1,0]
    v_rcp_f32 v230, v230
    v_rcp_f32 v231, v231
    v_rcp_f32 v232, v232
    v_rcp_f32 v233, v233
    v_rcp_f32 v234, v234
    v_rcp_f32 v235, v235
    v_rcp_f32 v236, v236
    v_rcp_f32 v237, v237
    v_pk_mul_f32 v[120:121], v[120:121], v[230:231]
    v_pk_mul_f32 v[122:123], v[122:123], v[232:233]
    v_pk_mul_f32 v[124:125], v[124:125], v[234:235]
    v_pk_mul_f32 v[126:127], v[126:127], v[236:237]
    v_pk_add_f32 v[200:201], v[200:201], v[120:121]
    v_pk_fma_f32 v[216:217], v[120:121], v[120:121], v[216:217]
    v_pk_add_f32 v[202:203], v[202:203], v[122:123]
    v_pk_fma_f32 v[218:219], v[122:123], v[122:123], v[218:219]
    v_pk_add_f32 v[204:205], v[204:205], v[124:125]
    v_pk_fma_f32 v[220:221], v[124:125], v[124:125], v[220:221]
    v_pk_add_f32 v[206:207], v[206:207], v[126:127]
    v_pk_fma_f32 v[222:223], v[126:127], v[126:127], v[222:223]
    s_mov_b32 s0, 0xcccccccc
    s_mov_b32 s1, 0xcccccccc
    s_mov_b32 s10, 0xaaaaaaaa
    s_mov_b32 s11, 0xaaaaaaaa
    v_add_f32_dpp v192, v192, v192 row_ror:8 row_mask:0xf bank_mask:0x3
    v_add_f32_dpp v193, v193, v193 row_ror:8 row_mask:0xf bank_mask:0x3
    v_add_f32_dpp v194, v194, v194 row_ror:8 row_mask:0xf bank_mask:0x3
    v_add_f32_dpp v195, v195, v195 row_ror:8 row_mask:0xf bank_mask:0x3
    v_add_f32_dpp v196, v196, v196 row_ror:8 row_mask:0xf bank_mask:0x3
    v_add_f32_dpp v197, v197, v197 row_ror:8 row_mask:0xf bank_mask:0x3
    v_add_f32_dpp v198, v198, v198 row_ror:8 row_mask:0xf bank_mask:0x3
    v_add_f32_dpp v199, v199, v199 row_ror:8 row_mask:0xf bank_mask:0x3
    v_add_f32_dpp v192, v200, v200 row_ror:8 row_mask:0xf bank_mask:0xc
    v_add_f32_dpp v193, v201, v201 row_ror:8 row_mask:0xf bank_mask:0xc
    v_add_f32_dpp v194, v202, v202 row_ror:8 row_mask:0xf bank_mask:0xc
    v_add_f32_dpp v195, v203, v203 row_ror:8 row_mask:0xf bank_mask:0xc
    v_add_f32_dpp v196, v204, v204 row_ror:8 row_mask:0xf bank_mask:0xc
    v_add_f32_dpp v197, v205, v205 row_ror:8 row_mask:0xf bank_mask:0xc
    v_add_f32_dpp v198, v206, v206 row_ror:8 row_mask:0xf bank_mask:0xc
    v_add_f32_dpp v199, v207, v207 row_ror:8 row_mask:0xf bank_mask:0xc
    v_add_f32_dpp v208, v208, v208 row_ror:8 row_mask:0xf bank_mask:0x3
    v_add_f32_dpp v209, v209, v209 row_ror:8 row_mask:0xf bank_mask:0x3
    v_add_f32_dpp v210, v210, v210 row_ror:8 row_mask:0xf bank_mask:0x3
    v_add_f32_dpp v211, v211, v211 row_ror:8 row_mask:0xf bank_mask:0x3
    v_add_f32_dpp v212, v212, v212 row_ror:8 row_mask:0xf bank_mask:0x3
    v_add_f32_dpp v213, v213, v213 row_ror:8 row_mask:0xf bank_mask:0x3
    v_add_f32_dpp v214, v214, v214 row_ror:8 row_mask:0xf bank_mask:0x3
    v_add_f32_dpp v215, v215, v215 row_ror:8 row_mask:0xf bank_mask:0x3
    v_add_f32_dpp v208, v216, v216 row_ror:8 row_mask:0xf bank_mask:0xc
    v_add_f32_dpp v209, v217, v217 row_ror:8 row_mask:0xf bank_mask:0xc
    v_add_f32_dpp v210, v218, v218 row_ror:8 row_mask:0xf bank_mask:0xc
    v_add_f32_dpp v211, v219, v219 row_ror:8 row_mask:0xf bank_mask:0xc
    v_add_f32_dpp v212, v220, v220 row_ror:8 row_mask:0xf bank_mask:0xc
    v_add_f32_dpp v213, v221, v221 row_ror:8 row_mask:0xf bank_mask:0xc
    v_add_f32_dpp v214, v222, v222 row_ror:8 row_mask:0xf bank_mask:0xc
    v_add_f32_dpp v215, v223, v223 row_ror:8 row_mask:0xf bank_mask:0xc
    v_add_f32_dpp v192, v192, v192 row_shl:4 row_mask:0xf bank_mask:0x5
    v_add_f32_dpp v193, v193, v193 row_shl:4 row_mask:0xf bank_mask:0x5
    v_add_f32_dpp v194, v194, v194 row_shl:4 row_mask:0xf bank_mask:0x5
    v_add_f32_dpp v195, v195, v195 row_shl:4 row_mask:0xf bank_mask:0x5
    v_add_f32_dpp v192, v196, v196 row_shr:4 row_mask:0xf bank_mask:0xa
    v_add_f32_dpp v193, v197, v197 row_shr:4 row_mask:0xf bank_mask:0xa
    v_add_f32_dpp v194, v198, v198 row_shr:4 row_mask:0xf bank_mask:0xa
    v_add_f32_dpp v195, v199, v199 row_shr:4 row_mask:0xf bank_mask:0xa
    v_add_f32_dpp v208, v208, v208 row_shl:4 row_mask:0xf bank_mask:0x5
    v_add_f32_dpp v209, v209, v209 row_shl:4 row_mask:0xf bank_mask:0x5
    v_add_f32_dpp v210, v210, v210 row_shl:4 row_mask:0xf bank_mask:0x5
    v_add_f32_dpp v211, v211, v211 row_shl:4 row_mask:0xf bank_mask:0x5
    v_add_f32_dpp v208, v212, v212 row_shr:4 row_mask:0xf bank_mask:0xa
    v_add_f32_dpp v209, v213, v213 row_shr:4 row_mask:0xf bank_mask:0xa
    v_add_f32_dpp v210, v214, v214 row_shr:4 row_mask:0xf bank_mask:0xa
    v_add_f32_dpp v211, v215, v215 row_shr:4 row_mask:0xf bank_mask:0xa
    v_add_f32_dpp v192, v192, v192 quad_perm:[2,3,0,1] row_mask:0xf bank_mask:0xf
    v_add_f32_dpp v193, v193, v193 quad_perm:[2,3,0,1] row_mask:0xf bank_mask:0xf
    v_add_f32_dpp v194, v194, v194 quad_perm:[2,3,0,1] row_mask:0xf bank_mask:0xf
    v_add_f32_dpp v195, v195, v195 quad_perm:[2,3,0,1] row_mask:0xf bank_mask:0xf
    v_add_f32_dpp v208, v208, v208 quad_perm:[2,3,0,1] row_mask:0xf bank_mask:0xf
    v_add_f32_dpp v209, v209, v209 quad_perm:[2,3,0,1] row_mask:0xf bank_mask:0xf
    v_add_f32_dpp v210, v210, v210 quad_perm:[2,3,0,1] row_mask:0xf bank_mask:0xf
    v_add_f32_dpp v211, v211, v211 quad_perm:[2,3,0,1] row_mask:0xf bank_mask:0xf
    v_cndmask_b32 v192, v192, v194, s[0:1]
    v_cndmask_b32 v193, v193, v195, s[0:1]
    v_cndmask_b32 v208, v208, v210, s[0:1]
    v_cndmask_b32 v209, v209, v211, s[0:1]
    v_lshlrev_b32 v246, 3, v248
    v_add_f32_dpp v192, v192, v192 quad_perm:[1,0,3,2] row_mask:0xf bank_mask:0xf
    v_add_f32_dpp v193, v193, v193 quad_perm:[1,0,3,2] row_mask:0xf bank_mask:0xf
    v_add_f32_dpp v208, v208, v208 quad_perm:[1,0,3,2] row_mask:0xf bank_mask:0xf
    v_add_f32_dpp v209, v209, v209 quad_perm:[1,0,3,2] row_mask:0xf bank_mask:0xf
    v_cndmask_b32 v192, v192, v193, s[10:11]
    v_cndmask_b32 v193, v208, v209, s[10:11]
    v_and_b32 v193, 0x7fffffff, v193
    buffer_store_dwordx2 v[192:193], v246, s[44:47], s82 offen sc1
    s_mov_b32 s63, 0
    s_mov_b32 s58, 2293760
    buffer_load_dwordx4 a[140:143], v247, s[28:31], s58 offen
    v_lshlrev_b32 v224, 4, v248
    v_mov_b32 v244, s26
    s_mov_b32 s52, s16
    v_accvgpr_read_b32 v225, a252
    v_accvgpr_read_b32 v226, a253
    v_accvgpr_read_b32 v240, a254
    s_mov_b32 s58, 2359296
    buffer_load_dwordx4 a[144:147], v247, s[28:31], s58 offen
    v_add_u32 v227, 0x10000, v225
    v_add_u32 v228, 0x10000, v226
    v_pk_mul_f32 v[230:231], v[128:129], v[128:129]
    v_pk_mul_f32 v[232:233], v[130:131], v[130:131]
    v_pk_mul_f32 v[234:235], v[144:145], v[144:145]
    s_mov_b32 s58, 2424832
    buffer_load_dwordx4 a[148:151], v247, s[28:31], s58 offen
    v_pk_mul_f32 v[236:237], v[146:147], v[146:147]
    v_pk_fma_f32 v[230:231], v[230:231], v[238:239], v[238:239] op_sel:[0,0,1] op_sel_hi:[1,0,1]
    v_pk_fma_f32 v[232:233], v[232:233], v[238:239], v[238:239] op_sel:[0,0,1] op_sel_hi:[1,0,1]
    v_pk_fma_f32 v[234:235], v[234:235], v[238:239], v[238:239] op_sel:[0,0,1] op_sel_hi:[1,0,1]
    v_pk_fma_f32 v[236:237], v[236:237], v[238:239], v[238:239] op_sel:[0,0,1] op_sel_hi:[1,0,1]
    s_mov_b32 s58, 2490368
    buffer_load_dwordx4 a[152:155], v247, s[28:31], s58 offen
    v_pk_mul_f32 v[230:231], v[230:231], v[128:129]
    v_pk_mul_f32 v[232:233], v[232:233], v[130:131]
    v_pk_mul_f32 v[234:235], v[234:235], v[144:145]
    v_pk_mul_f32 v[236:237], v[236:237], v[146:147]
    v_exp_f32 v230, v230
    s_mov_b32 s58, 2555904
    buffer_load_dwordx4 a[156:159], v247, s[28:31], s58 offen
    v_exp_f32 v231, v231
    v_exp_f32 v232, v232
    v_exp_f32 v233, v233
    v_exp_f32 v234, v234
    v_exp_f32 v235, v235
    s_mov_b32 s58, 2621440
    buffer_load_dwordx4 a[160:163], v247, s[28:31], s58 offen
    v_exp_f32 v236, v236
    v_exp_f32 v237, v237
    v_pk_add_f32 v[230:231], v[230:231], 1.0 op_sel_hi:[1,0]
    v_pk_add_f32 v[232:233], v[232:233], 1.0 op_sel_hi:[1,0]
    v_pk_add_f32 v[234:235], v[234:235], 1.0 op_sel_hi:[1,0]
    s_mov_b32 s58, 2686976
    buffer_load_dwordx4 a[164:167], v247, s[28:31], s58 offen
    v_pk_add_f32 v[236:237], v[236:237], 1.0 op_sel_hi:[1,0]
    v_rcp_f32 v230, v230
    v_rcp_f32 v231, v231
    v_rcp_f32 v232, v232
    v_rcp_f32 v233, v233
    s_mov_b32 s58, 2752512
    buffer_load_dwordx4 a[168:171], v247, s[28:31], s58 offen
    v_rcp_f32 v234, v234
    v_rcp_f32 v235, v235
    v_rcp_f32 v236, v236
    v_rcp_f32 v237, v237
    v_pk_mul_f32 v[128:129], v[128:129], v[230:231]
    s_mov_b32 s58, 2818048
    buffer_load_dwordx4 a[172:175], v247, s[28:31], s58 offen
    v_pk_mul_f32 v[130:131], v[130:131], v[232:233]
    v_pk_mul_f32 v[144:145], v[144:145], v[234:235]
    v_pk_mul_f32 v[146:147], v[146:147], v[236:237]
    v_cvt_pk_bf16_f32 v128, v128, v129
    v_cvt_pk_bf16_f32 v129, v130, v131
    s_mov_b32 s58, 2883584
    buffer_load_dwordx4 a[176:179], v247, s[28:31], s58 offen
    v_cvt_pk_bf16_f32 v130, v144, v145
    v_cvt_pk_bf16_f32 v131, v146, v147
    buffer_store_dwordx4 v[128:131], v224, s[36:39], s6 offen offset:0 sc1
    v_pk_mul_f32 v[230:231], v[132:133], v[132:133]
    v_pk_mul_f32 v[232:233], v[134:135], v[134:135]
    v_pk_mul_f32 v[234:235], v[148:149], v[148:149]
    s_mov_b32 s58, 2949120
    buffer_load_dwordx4 a[180:183], v247, s[28:31], s58 offen
    v_pk_mul_f32 v[236:237], v[150:151], v[150:151]
    v_pk_fma_f32 v[230:231], v[230:231], v[238:239], v[238:239] op_sel:[0,0,1] op_sel_hi:[1,0,1]
    v_pk_fma_f32 v[232:233], v[232:233], v[238:239], v[238:239] op_sel:[0,0,1] op_sel_hi:[1,0,1]
    v_pk_fma_f32 v[234:235], v[234:235], v[238:239], v[238:239] op_sel:[0,0,1] op_sel_hi:[1,0,1]
    v_pk_fma_f32 v[236:237], v[236:237], v[238:239], v[238:239] op_sel:[0,0,1] op_sel_hi:[1,0,1]
    s_mov_b32 s58, 3014656
    buffer_load_dwordx4 a[184:187], v247, s[28:31], s58 offen
    v_pk_mul_f32 v[230:231], v[230:231], v[132:133]
    v_pk_mul_f32 v[232:233], v[232:233], v[134:135]
    v_pk_mul_f32 v[234:235], v[234:235], v[148:149]
    v_pk_mul_f32 v[236:237], v[236:237], v[150:151]
    v_exp_f32 v230, v230
    v_exp_f32 v231, v231
    v_exp_f32 v232, v232
    v_exp_f32 v233, v233
    v_exp_f32 v234, v234
    v_exp_f32 v235, v235
    v_exp_f32 v236, v236
    v_exp_f32 v237, v237
    v_pk_add_f32 v[230:231], v[230:231], 1.0 op_sel_hi:[1,0]
    v_pk_add_f32 v[232:233], v[232:233], 1.0 op_sel_hi:[1,0]
    v_pk_add_f32 v[234:235], v[234:235], 1.0 op_sel_hi:[1,0]
    v_pk_add_f32 v[236:237], v[236:237], 1.0 op_sel_hi:[1,0]
    v_rcp_f32 v230, v230
    v_rcp_f32 v231, v231
    v_rcp_f32 v232, v232
    v_rcp_f32 v233, v233
    v_rcp_f32 v234, v234
    v_rcp_f32 v235, v235
    v_rcp_f32 v236, v236
    v_rcp_f32 v237, v237
    v_pk_mul_f32 v[132:133], v[132:133], v[230:231]
    v_pk_mul_f32 v[134:135], v[134:135], v[232:233]
    v_pk_mul_f32 v[148:149], v[148:149], v[234:235]
    v_pk_mul_f32 v[150:151], v[150:151], v[236:237]
    v_cvt_pk_bf16_f32 v132, v132, v133
    v_cvt_pk_bf16_f32 v133, v134, v135
    v_cvt_pk_bf16_f32 v134, v148, v149
    v_cvt_pk_bf16_f32 v135, v150, v151
    buffer_store_dwordx4 v[132:135], v224, s[36:39], s6 offen offset:1024 sc1
    v_pk_mul_f32 v[230:231], v[136:137], v[136:137]
    v_pk_mul_f32 v[232:233], v[138:139], v[138:139]
    v_pk_mul_f32 v[234:235], v[152:153], v[152:153]
    v_pk_mul_f32 v[236:237], v[154:155], v[154:155]
    v_pk_fma_f32 v[230:231], v[230:231], v[238:239], v[238:239] op_sel:[0,0,1] op_sel_hi:[1,0,1]
    v_pk_fma_f32 v[232:233], v[232:233], v[238:239], v[238:239] op_sel:[0,0,1] op_sel_hi:[1,0,1]
    v_pk_fma_f32 v[234:235], v[234:235], v[238:239], v[238:239] op_sel:[0,0,1] op_sel_hi:[1,0,1]
    v_pk_fma_f32 v[236:237], v[236:237], v[238:239], v[238:239] op_sel:[0,0,1] op_sel_hi:[1,0,1]
    v_pk_mul_f32 v[230:231], v[230:231], v[136:137]
    v_pk_mul_f32 v[232:233], v[232:233], v[138:139]
    v_pk_mul_f32 v[234:235], v[234:235], v[152:153]
    v_pk_mul_f32 v[236:237], v[236:237], v[154:155]
    v_exp_f32 v230, v230
    v_exp_f32 v231, v231
    v_exp_f32 v232, v232
    v_exp_f32 v233, v233
    v_exp_f32 v234, v234
    v_exp_f32 v235, v235
    v_exp_f32 v236, v236
    v_exp_f32 v237, v237
    v_pk_add_f32 v[230:231], v[230:231], 1.0 op_sel_hi:[1,0]
    v_pk_add_f32 v[232:233], v[232:233], 1.0 op_sel_hi:[1,0]
    v_pk_add_f32 v[234:235], v[234:235], 1.0 op_sel_hi:[1,0]
    v_pk_add_f32 v[236:237], v[236:237], 1.0 op_sel_hi:[1,0]
    v_rcp_f32 v230, v230
    v_rcp_f32 v231, v231
    v_rcp_f32 v232, v232
    v_rcp_f32 v233, v233
    v_rcp_f32 v234, v234
    v_rcp_f32 v235, v235
    v_rcp_f32 v236, v236
    v_rcp_f32 v237, v237
    v_pk_mul_f32 v[136:137], v[136:137], v[230:231]
    v_pk_mul_f32 v[138:139], v[138:139], v[232:233]
    v_pk_mul_f32 v[152:153], v[152:153], v[234:235]
    v_pk_mul_f32 v[154:155], v[154:155], v[236:237]
    v_cvt_pk_bf16_f32 v136, v136, v137
    v_cvt_pk_bf16_f32 v137, v138, v139
    v_cvt_pk_bf16_f32 v138, v152, v153
    v_cvt_pk_bf16_f32 v139, v154, v155
    buffer_store_dwordx4 v[136:139], v224, s[36:39], s7 offen offset:0 sc1
    v_pk_mul_f32 v[230:231], v[140:141], v[140:141]
    v_pk_mul_f32 v[232:233], v[142:143], v[142:143]
    v_pk_mul_f32 v[234:235], v[156:157], v[156:157]
    v_pk_mul_f32 v[236:237], v[158:159], v[158:159]
    v_pk_fma_f32 v[230:231], v[230:231], v[238:239], v[238:239] op_sel:[0,0,1] op_sel_hi:[1,0,1]
    v_pk_fma_f32 v[232:233], v[232:233], v[238:239], v[238:239] op_sel:[0,0,1] op_sel_hi:[1,0,1]
    v_pk_fma_f32 v[234:235], v[234:235], v[238:239], v[238:239] op_sel:[0,0,1] op_sel_hi:[1,0,1]
    v_pk_fma_f32 v[236:237], v[236:237], v[238:239], v[238:239] op_sel:[0,0,1] op_sel_hi:[1,0,1]
    v_pk_mul_f32 v[230:231], v[230:231], v[140:141]
    v_pk_mul_f32 v[232:233], v[232:233], v[142:143]
    v_pk_mul_f32 v[234:235], v[234:235], v[156:157]
    v_pk_mul_f32 v[236:237], v[236:237], v[158:159]
    v_exp_f32 v230, v230
    v_exp_f32 v231, v231
    v_exp_f32 v232, v232
    v_exp_f32 v233, v233
    v_exp_f32 v234, v234
    v_exp_f32 v235, v235
    v_exp_f32 v236, v236
    v_exp_f32 v237, v237
    v_pk_add_f32 v[230:231], v[230:231], 1.0 op_sel_hi:[1,0]
    v_pk_add_f32 v[232:233], v[232:233], 1.0 op_sel_hi:[1,0]
    v_pk_add_f32 v[234:235], v[234:235], 1.0 op_sel_hi:[1,0]
    v_pk_add_f32 v[236:237], v[236:237], 1.0 op_sel_hi:[1,0]
    v_rcp_f32 v230, v230
    v_rcp_f32 v231, v231
    v_rcp_f32 v232, v232
    v_rcp_f32 v233, v233
    v_rcp_f32 v234, v234
    v_rcp_f32 v235, v235
    v_rcp_f32 v236, v236
    v_rcp_f32 v237, v237
    v_pk_mul_f32 v[140:141], v[140:141], v[230:231]
    v_pk_mul_f32 v[142:143], v[142:143], v[232:233]
    v_pk_mul_f32 v[156:157], v[156:157], v[234:235]
    v_pk_mul_f32 v[158:159], v[158:159], v[236:237]
    v_cvt_pk_bf16_f32 v140, v140, v141
    v_cvt_pk_bf16_f32 v141, v142, v143
    v_cvt_pk_bf16_f32 v142, v156, v157
    v_cvt_pk_bf16_f32 v143, v158, v159
    buffer_store_dwordx4 v[140:143], v224, s[36:39], s7 offen offset:1024 sc1
    v_pk_mul_f32 v[230:231], v[160:161], v[160:161]
    v_pk_mul_f32 v[232:233], v[162:163], v[162:163]
    v_pk_mul_f32 v[234:235], v[176:177], v[176:177]
    v_pk_mul_f32 v[236:237], v[178:179], v[178:179]
    v_pk_fma_f32 v[230:231], v[230:231], v[238:239], v[238:239] op_sel:[0,0,1] op_sel_hi:[1,0,1]
    v_pk_fma_f32 v[232:233], v[232:233], v[238:239], v[238:239] op_sel:[0,0,1] op_sel_hi:[1,0,1]
    v_pk_fma_f32 v[234:235], v[234:235], v[238:239], v[238:239] op_sel:[0,0,1] op_sel_hi:[1,0,1]
    v_pk_fma_f32 v[236:237], v[236:237], v[238:239], v[238:239] op_sel:[0,0,1] op_sel_hi:[1,0,1]
    v_pk_mul_f32 v[230:231], v[230:231], v[160:161]
    v_pk_mul_f32 v[232:233], v[232:233], v[162:163]
    v_pk_mul_f32 v[234:235], v[234:235], v[176:177]
    v_pk_mul_f32 v[236:237], v[236:237], v[178:179]
    v_exp_f32 v230, v230
    v_exp_f32 v231, v231
    v_exp_f32 v232, v232
    v_exp_f32 v233, v233
    v_exp_f32 v234, v234
    v_exp_f32 v235, v235
    v_exp_f32 v236, v236
    v_exp_f32 v237, v237
    v_pk_add_f32 v[230:231], v[230:231], 1.0 op_sel_hi:[1,0]
    v_pk_add_f32 v[232:233], v[232:233], 1.0 op_sel_hi:[1,0]
    v_pk_add_f32 v[234:235], v[234:235], 1.0 op_sel_hi:[1,0]
    v_pk_add_f32 v[236:237], v[236:237], 1.0 op_sel_hi:[1,0]
    v_rcp_f32 v230, v230
    v_rcp_f32 v231, v231
    v_rcp_f32 v232, v232
    v_rcp_f32 v233, v233
    v_rcp_f32 v234, v234
    v_rcp_f32 v235, v235
    v_rcp_f32 v236, v236
    v_rcp_f32 v237, v237
    v_pk_mul_f32 v[160:161], v[160:161], v[230:231]
    v_pk_mul_f32 v[162:163], v[162:163], v[232:233]
    v_pk_mul_f32 v[176:177], v[176:177], v[234:235]
    v_pk_mul_f32 v[178:179], v[178:179], v[236:237]
    buffer_load_dwordx2 v[196:197], v246, s[44:47], s80 offen offset:0 sc1
    buffer_load_dwordx2 v[198:199], v246, s[44:47], s80 offen offset:512 sc1
    buffer_load_dwordx2 v[200:201], v246, s[44:47], s80 offen offset:1024 sc1
    buffer_load_dwordx2 v[202:203], v246, s[44:47], s80 offen offset:1536 sc1
    buffer_load_dwordx2 v[204:205], v246, s[44:47], s80 offen offset:2048 sc1
    buffer_load_dwordx2 v[206:207], v246, s[44:47], s80 offen offset:2560 sc1
    buffer_load_dwordx2 v[208:209], v246, s[44:47], s80 offen offset:3072 sc1
    buffer_load_dwordx2 v[210:211], v246, s[44:47], s80 offen offset:3584 sc1
    buffer_load_dwordx2 v[212:213], v246, s[44:47], s81 offen offset:0 sc1
    buffer_load_dwordx2 v[214:215], v246, s[44:47], s81 offen offset:512 sc1
    buffer_load_dwordx2 v[216:217], v246, s[44:47], s81 offen offset:1024 sc1
    buffer_load_dwordx2 v[218:219], v246, s[44:47], s81 offen offset:1536 sc1
    buffer_load_dwordx2 v[220:221], v246, s[44:47], s81 offen offset:2048 sc1
    buffer_load_dwordx2 v[222:223], v246, s[44:47], s81 offen offset:2560 sc1
L_spoll_40:
    s_waitcnt vmcnt(0)
    v_or_b32 v192, v197, v199
    v_or3_b32 v192, v192, v201, v203
    v_or3_b32 v192, v192, v205, v207
    v_or3_b32 v192, v192, v209, v211
    v_or3_b32 v192, v192, v213, v215
    v_or3_b32 v192, v192, v217, v219
    v_or3_b32 v192, v192, v221, v223
    v_cmp_gt_i32 vcc, 0, v192
    s_add_u32 s63, s63, 1
    s_cmp_eq_u64 vcc, 0
    s_cbranch_scc1 L_spolled_41
    buffer_load_dwordx2 v[196:197], v246, s[44:47], s80 offen offset:0 sc1
    buffer_load_dwordx2 v[198:199], v246, s[44:47], s80 offen offset:512 sc1
    buffer_load_dwordx2 v[200:201], v246, s[44:47], s80 offen offset:1024 sc1
    buffer_load_dwordx2 v[202:203], v246, s[44:47], s80 offen offset:1536 sc1
    buffer_load_dwordx2 v[204:205], v246, s[44:47], s80 offen offset:2048 sc1
    buffer_load_dwordx2 v[206:207], v246, s[44:47], s80 offen offset:2560 sc1
    buffer_load_dwordx2 v[208:209], v246, s[44:47], s80 offen offset:3072 sc1
    buffer_load_dwordx2 v[210:211], v246, s[44:47], s80 offen offset:3584 sc1
    buffer_load_dwordx2 v[212:213], v246, s[44:47], s81 offen offset:0 sc1
    buffer_load_dwordx2 v[214:215], v246, s[44:47], s81 offen offset:512 sc1
    buffer_load_dwordx2 v[216:217], v246, s[44:47], s81 offen offset:1024 sc1
    buffer_load_dwordx2 v[218:219], v246, s[44:47], s81 offen offset:1536 sc1
    buffer_load_dwordx2 v[220:221], v246, s[44:47], s81 offen offset:2048 sc1
    buffer_load_dwordx2 v[222:223], v246, s[44:47], s81 offen offset:2560 sc1
    s_cmp_lt_u32 s63, 200000
    s_cbranch_scc1 L_spoll_40
    s_endpgm
L_spolled_41:
    v_pk_add_f32 v[196:197], v[196:197], v[210:211]
    v_pk_add_f32 v[198:199], v[198:199], v[212:213]
    v_pk_add_f32 v[200:201], v[200:201], v[214:215]
    v_pk_add_f32 v[202:203], v[202:203], v[216:217]
    v_pk_add_f32 v[204:205], v[204:205], v[218:219]
    v_pk_add_f32 v[206:207], v[206:207], v[220:221]
    v_pk_add_f32 v[208:209], v[208:209], v[222:223]
    v_pk_add_f32 v[196:197], v[196:197], v[198:199]
    v_pk_add_f32 v[200:201], v[200:201], v[202:203]
    v_pk_add_f32 v[204:205], v[204:205], v[206:207]
    v_pk_add_f32 v[196:197], v[196:197], v[208:209]
    v_pk_add_f32 v[200:201], v[200:201], v[204:205]
    v_pk_add_f32 v[196:197], v[196:197], v[200:201]
    v_mul_f32 v230, 0x3a124925, v196
    v_mul_f32 v231, 0x3a124925, v197
    v_fma_f32 v231, -v230, v230, v231
    v_max_f32 v231, 0, v231
    v_cvt_pk_bf16_f32 v230, 0, v230
    v_cvt_pk_bf16_f32 v231, 0, v231
    v_add_f32 v231, 0x3727c5ac, v231
    v_cvt_pk_bf16_f32 v231, 0, v231
    v_sqrt_f32 v231, v231
    s_nop 0
    v_cvt_pk_bf16_f32 v231, 0, v231
    v_rcp_f32 v232, v231
    s_nop 0
    v_mul_f32 v233, v230, v232
    v_sub_f32 v233, 0, v233
    v_mov_b32_dpp v192, v232 row_newbcast:0 row_mask:0xf bank_mask:0xf
    v_mov_b32_dpp v193, v232 row_newbcast:1 row_mask:0xf bank_mask:0xf
    v_mov_b32_dpp v194, v232 row_newbcast:2 row_mask:0xf bank_mask:0xf
    v_mov_b32_dpp v195, v232 row_newbcast:3 row_mask:0xf bank_mask:0xf
    v_mov_b32_dpp v196, v232 row_newbcast:4 row_mask:0xf bank_mask:0xf
    v_mov_b32_dpp v197, v232 row_newbcast:5 row_mask:0xf bank_mask:0xf
    v_mov_b32_dpp v198, v232 row_newbcast:6 row_mask:0xf bank_mask:0xf
    v_mov_b32_dpp v199, v232 row_newbcast:7 row_mask:0xf bank_mask:0xf
    v_mov_b32_dpp v200, v232 row_newbcast:8 row_mask:0xf bank_mask:0xf
    v_mov_b32_dpp v201, v232 row_newbcast:9 row_mask:0xf bank_mask:0xf
    v_mov_b32_dpp v202, v232 row_newbcast:10 row_mask:0xf bank_mask:0xf
    v_mov_b32_dpp v203, v232 row_newbcast:11 row_mask:0xf bank_mask:0xf
    v_mov_b32_dpp v204, v232 row_newbcast:12 row_mask:0xf bank_mask:0xf
    v_mov_b32_dpp v205, v232 row_newbcast:13 row_mask:0xf bank_mask:0xf
    v_mov_b32_dpp v206, v232 row_newbcast:14 row_mask:0xf bank_mask:0xf
    v_mov_b32_dpp v207, v232 row_newbcast:15 row_mask:0xf bank_mask:0xf
    v_mov_b32_dpp v208, v233 row_newbcast:0 row_mask:0xf bank_mask:0xf
    v_mov_b32_dpp v209, v233 row_newbcast:1 row_mask:0xf bank_mask:0xf
    v_mov_b32_dpp v210, v233 row_newbcast:2 row_mask:0xf bank_mask:0xf
    v_mov_b32_dpp v211, v233 row_newbcast:3 row_mask:0xf bank_mask:0xf
    v_mov_b32_dpp v212, v233 row_newbcast:4 row_mask:0xf bank_mask:0xf
    v_mov_b32_dpp v213, v233 row_newbcast:5 row_mask:0xf bank_mask:0xf
    v_mov_b32_dpp v214, v233 row_newbcast:6 row_mask:0xf bank_mask:0xf
    v_mov_b32_dpp v215, v233 row_newbcast:7 row_mask:0xf bank_mask:0xf
    v_mov_b32_dpp v216, v233 row_newbcast:8 row_mask:0xf bank_mask:0xf
    v_mov_b32_dpp v217, v233 row_newbcast:9 row_mask:0xf bank_mask:0xf
    v_mov_b32_dpp v218, v233 row_newbcast:10 row_mask:0xf bank_mask:0xf
    v_mov_b32_dpp v219, v233 row_newbcast:11 row_mask:0xf bank_mask:0xf
    v_mov_b32_dpp v220, v233 row_newbcast:12 row_mask:0xf bank_mask:0xf
    v_mov_b32_dpp v221, v233 row_newbcast:13 row_mask:0xf bank_mask:0xf
    v_mov_b32_dpp v222, v233 row_newbcast:14 row_mask:0xf bank_mask:0xf
    v_mov_b32_dpp v223, v233 row_newbcast:15 row_mask:0xf bank_mask:0xf
    v_pk_fma_f32 v[0:1], v[0:1], v[192:193], v[208:209]
    v_pk_fma_f32 v[2:3], v[2:3], v[194:195], v[210:211]
    v_pk_fma_f32 v[4:5], v[4:5], v[196:197], v[212:213]
    v_pk_fma_f32 v[6:7], v[6:7], v[198:199], v[214:215]
    v_cvt_pk_bf16_f32 v0, v0, v4
    v_cvt_pk_bf16_f32 v1, v1, v5
    v_cvt_pk_bf16_f32 v2, v2, v6
    v_cvt_pk_bf16_f32 v3, v3, v7
    buffer_store_dwordx4 v[0:3], v224, s[36:39], s83 offen offset:0 sc1
    v_pk_fma_f32 v[8:9], v[8:9], v[200:201], v[216:217]
    v_pk_fma_f32 v[10:11], v[10:11], v[202:203], v[218:219]
    v_pk_fma_f32 v[12:13], v[12:13], v[204:205], v[220:221]
    v_pk_fma_f32 v[14:15], v[14:15], v[206:207], v[222:223]
    v_cvt_pk_bf16_f32 v8, v8, v12
    v_cvt_pk_bf16_f32 v9, v9, v13
    v_cvt_pk_bf16_f32 v10, v10, v14
    v_cvt_pk_bf16_f32 v11, v11, v15
    buffer_store_dwordx4 v[8:11], v224, s[36:39], s83 offen offset:2048 sc1
    v_pk_fma_f32 v[16:17], v[16:17], v[192:193], v[208:209]
    v_pk_fma_f32 v[18:19], v[18:19], v[194:195], v[210:211]
    v_pk_fma_f32 v[20:21], v[20:21], v[196:197], v[212:213]
    v_pk_fma_f32 v[22:23], v[22:23], v[198:199], v[214:215]
    v_cvt_pk_bf16_f32 v16, v16, v20
    v_cvt_pk_bf16_f32 v17, v17, v21
    v_cvt_pk_bf16_f32 v18, v18, v22
    v_cvt_pk_bf16_f32 v19, v19, v23
    buffer_store_dwordx4 v[16:19], v224, s[36:39], s83 offen offset:1024 sc1
    v_pk_fma_f32 v[24:25], v[24:25], v[200:201], v[216:217]
    v_pk_fma_f32 v[26:27], v[26:27], v[202:203], v[218:219]
    v_pk_fma_f32 v[28:29], v[28:29], v[204:205], v[220:221]
    v_pk_fma_f32 v[30:31], v[30:31], v[206:207], v[222:223]
    v_cvt_pk_bf16_f32 v24, v24, v28
    v_cvt_pk_bf16_f32 v25, v25, v29
    v_cvt_pk_bf16_f32 v26, v26, v30
    v_cvt_pk_bf16_f32 v27, v27, v31
    buffer_store_dwordx4 v[24:27], v224, s[36:39], s83 offen offset:3072 sc1
    s_add_u32 s83, s83, 131072
    v_pk_fma_f32 v[32:33], v[32:33], v[192:193], v[208:209]
    v_pk_fma_f32 v[34:35], v[34:35], v[194:195], v[210:211]
    v_pk_fma_f32 v[36:37], v[36:37], v[196:197], v[212:213]
    v_pk_fma_f32 v[38:39], v[38:39], v[198:199], v[214:215]
    v_cvt_pk_bf16_f32 v32, v32, v36
    v_cvt_pk_bf16_f32 v33, v33, v37
    v_cvt_pk_bf16_f32 v34, v34, v38
    v_cvt_pk_bf16_f32 v35, v35, v39
    buffer_store_dwordx4 v[32:35], v224, s[36:39], s83 offen offset:0 sc1
    v_pk_fma_f32 v[40:41], v[40:41], v[200:201], v[216:217]
    v_pk_fma_f32 v[42:43], v[42:43], v[202:203], v[218:219]
    v_pk_fma_f32 v[44:45], v[44:45], v[204:205], v[220:221]
    v_pk_fma_f32 v[46:47], v[46:47], v[206:207], v[222:223]
    v_cvt_pk_bf16_f32 v40, v40, v44
    v_cvt_pk_bf16_f32 v41, v41, v45
    v_cvt_pk_bf16_f32 v42, v42, v46
    v_cvt_pk_bf16_f32 v43, v43, v47
    buffer_store_dwordx4 v[40:43], v224, s[36:39], s83 offen offset:2048 sc1
    v_pk_fma_f32 v[48:49], v[48:49], v[192:193], v[208:209]
    v_pk_fma_f32 v[50:51], v[50:51], v[194:195], v[210:211]
    v_pk_fma_f32 v[52:53], v[52:53], v[196:197], v[212:213]
    v_pk_fma_f32 v[54:55], v[54:55], v[198:199], v[214:215]
    v_cvt_pk_bf16_f32 v48, v48, v52
    v_cvt_pk_bf16_f32 v49, v49, v53
    v_cvt_pk_bf16_f32 v50, v50, v54
    v_cvt_pk_bf16_f32 v51, v51, v55
    buffer_store_dwordx4 v[48:51], v224, s[36:39], s83 offen offset:1024 sc1
    v_pk_fma_f32 v[56:57], v[56:57], v[200:201], v[216:217]
    v_pk_fma_f32 v[58:59], v[58:59], v[202:203], v[218:219]
    v_pk_fma_f32 v[60:61], v[60:61], v[204:205], v[220:221]
    v_pk_fma_f32 v[62:63], v[62:63], v[206:207], v[222:223]
    v_cvt_pk_bf16_f32 v56, v56, v60
    v_cvt_pk_bf16_f32 v57, v57, v61
    v_cvt_pk_bf16_f32 v58, v58, v62
    v_cvt_pk_bf16_f32 v59, v59, v63
    buffer_store_dwordx4 v[56:59], v224, s[36:39], s83 offen offset:3072 sc1
    s_add_u32 s83, s83, 131072
    v_pk_fma_f32 v[64:65], v[64:65], v[192:193], v[208:209]
    v_pk_fma_f32 v[66:67], v[66:67], v[194:195], v[210:211]
    v_pk_fma_f32 v[68:69], v[68:69], v[196:197], v[212:213]
    v_pk_fma_f32 v[70:71], v[70:71], v[198:199], v[214:215]
    v_cvt_pk_bf16_f32 v64, v64, v68
    v_cvt_pk_bf16_f32 v65, v65, v69
    v_cvt_pk_bf16_f32 v66, v66, v70
    v_cvt_pk_bf16_f32 v67, v67, v71
    buffer_store_dwordx4 v[64:67], v224, s[36:39], s83 offen offset:0 sc1
    v_pk_fma_f32 v[72:73], v[72:73], v[200:201], v[216:217]
    v_pk_fma_f32 v[74:75], v[74:75], v[202:203], v[218:219]
    v_pk_fma_f32 v[76:77], v[76:77], v[204:205], v[220:221]
    v_pk_fma_f32 v[78:79], v[78:79], v[206:207], v[222:223]
    v_cvt_pk_bf16_f32 v72, v72, v76
    v_cvt_pk_bf16_f32 v73, v73, v77
    v_cvt_pk_bf16_f32 v74, v74, v78
    v_cvt_pk_bf16_f32 v75, v75, v79
    buffer_store_dwordx4 v[72:75], v224, s[36:39], s83 offen offset:2048 sc1
    v_pk_fma_f32 v[80:81], v[80:81], v[192:193], v[208:209]
    v_pk_fma_f32 v[82:83], v[82:83], v[194:195], v[210:211]
    v_pk_fma_f32 v[84:85], v[84:85], v[196:197], v[212:213]
    v_pk_fma_f32 v[86:87], v[86:87], v[198:199], v[214:215]
    v_cvt_pk_bf16_f32 v80, v80, v84
    v_cvt_pk_bf16_f32 v81, v81, v85
    v_cvt_pk_bf16_f32 v82, v82, v86
    v_cvt_pk_bf16_f32 v83, v83, v87
    buffer_store_dwordx4 v[80:83], v224, s[36:39], s83 offen offset:1024 sc1
    v_pk_fma_f32 v[88:89], v[88:89], v[200:201], v[216:217]
    v_pk_fma_f32 v[90:91], v[90:91], v[202:203], v[218:219]
    v_pk_fma_f32 v[92:93], v[92:93], v[204:205], v[220:221]
    v_pk_fma_f32 v[94:95], v[94:95], v[206:207], v[222:223]
    v_cvt_pk_bf16_f32 v88, v88, v92
    v_cvt_pk_bf16_f32 v89, v89, v93
    v_cvt_pk_bf16_f32 v90, v90, v94
    v_cvt_pk_bf16_f32 v91, v91, v95
    buffer_store_dwordx4 v[88:91], v224, s[36:39], s83 offen offset:3072 sc1
    s_add_u32 s83, s83, 131072
    v_pk_fma_f32 v[96:97], v[96:97], v[192:193], v[208:209]
    v_pk_fma_f32 v[98:99], v[98:99], v[194:195], v[210:211]
    v_pk_fma_f32 v[100:101], v[100:101], v[196:197], v[212:213]
    v_pk_fma_f32 v[102:103], v[102:103], v[198:199], v[214:215]
    s_branch L_po_B_6
.p2align 12
L_pg_B_6:
    s_branch L_pg_K_2
L_po_B_6:
    v_cvt_pk_bf16_f32 v96, v96, v100
    v_cvt_pk_bf16_f32 v97, v97, v101
    v_cvt_pk_bf16_f32 v98, v98, v102
    v_cvt_pk_bf16_f32 v99, v99, v103
    buffer_store_dwordx4 v[96:99], v224, s[36:39], s83 offen offset:0 sc1
    v_pk_fma_f32 v[104:105], v[104:105], v[200:201], v[216:217]
    v_pk_fma_f32 v[106:107], v[106:107], v[202:203], v[218:219]
    v_pk_fma_f32 v[108:109], v[108:109], v[204:205], v[220:221]
    v_pk_fma_f32 v[110:111], v[110:111], v[206:207], v[222:223]
    v_cvt_pk_bf16_f32 v104, v104, v108
    v_cvt_pk_bf16_f32 v105, v105, v109
    v_cvt_pk_bf16_f32 v106, v106, v110
    v_cvt_pk_bf16_f32 v107, v107, v111
    buffer_store_dwordx4 v[104:107], v224, s[36:39], s83 offen offset:2048 sc1
    v_pk_fma_f32 v[112:113], v[112:113], v[192:193], v[208:209]
    v_pk_fma_f32 v[114:115], v[114:115], v[194:195], v[210:211]
    v_pk_fma_f32 v[116:117], v[116:117], v[196:197], v[212:213]
    v_pk_fma_f32 v[118:119], v[118:119], v[198:199], v[214:215]
    v_cvt_pk_bf16_f32 v112, v112, v116
    v_cvt_pk_bf16_f32 v113, v113, v117
    v_cvt_pk_bf16_f32 v114, v114, v118
    v_cvt_pk_bf16_f32 v115, v115, v119
    buffer_store_dwordx4 v[112:115], v224, s[36:39], s83 offen offset:1024 sc1
    v_pk_fma_f32 v[120:121], v[120:121], v[200:201], v[216:217]
    v_pk_fma_f32 v[122:123], v[122:123], v[202:203], v[218:219]
    v_pk_fma_f32 v[124:125], v[124:125], v[204:205], v[220:221]
    v_pk_fma_f32 v[126:127], v[126:127], v[206:207], v[222:223]
    v_cvt_pk_bf16_f32 v120, v120, v124
    v_cvt_pk_bf16_f32 v121, v121, v125
    v_cvt_pk_bf16_f32 v122, v122, v126
    v_cvt_pk_bf16_f32 v123, v123, v127
    buffer_store_dwordx4 v[120:123], v224, s[36:39], s83 offen offset:3072 sc1
    v_pk_mul_f32 v[230:231], v[164:165], v[164:165]
    v_pk_mul_f32 v[232:233], v[166:167], v[166:167]
    v_pk_mul_f32 v[234:235], v[180:181], v[180:181]
    v_pk_mul_f32 v[236:237], v[182:183], v[182:183]
    v_pk_fma_f32 v[230:231], v[230:231], v[238:239], v[238:239] op_sel:[0,0,1] op_sel_hi:[1,0,1]
    v_pk_fma_f32 v[232:233], v[232:233], v[238:239], v[238:239] op_sel:[0,0,1] op_sel_hi:[1,0,1]
    v_pk_fma_f32 v[234:235], v[234:235], v[238:239], v[238:239] op_sel:[0,0,1] op_sel_hi:[1,0,1]
    v_pk_fma_f32 v[236:237], v[236:237], v[238:239], v[238:239] op_sel:[0,0,1] op_sel_hi:[1,0,1]
    v_pk_mul_f32 v[230:231], v[230:231], v[164:165]
    v_pk_mul_f32 v[232:233], v[232:233], v[166:167]
    v_pk_mul_f32 v[234:235], v[234:235], v[180:181]
    v_pk_mul_f32 v[236:237], v[236:237], v[182:183]
    v_exp_f32 v230, v230
    v_exp_f32 v231, v231
    v_exp_f32 v232, v232
    v_exp_f32 v233, v233
    v_exp_f32 v234, v234
    v_exp_f32 v235, v235
    v_exp_f32 v236, v236
    v_exp_f32 v237, v237
    v_pk_add_f32 v[230:231], v[230:231], 1.0 op_sel_hi:[1,0]
    v_pk_add_f32 v[232:233], v[232:233], 1.0 op_sel_hi:[1,0]
    v_pk_add_f32 v[234:235], v[234:235], 1.0 op_sel_hi:[1,0]
    v_pk_add_f32 v[236:237], v[236:237], 1.0 op_sel_hi:[1,0]
    v_rcp_f32 v230, v230
    v_rcp_f32 v231, v231
    v_rcp_f32 v232, v232
    v_rcp_f32 v233, v233
    v_rcp_f32 v234, v234
    v_rcp_f32 v235, v235
    v_rcp_f32 v236, v236
    v_rcp_f32 v237, v237
    v_pk_mul_f32 v[164:165], v[164:165], v[230:231]
    v_pk_mul_f32 v[166:167], v[166:167], v[232:233]
    v_pk_mul_f32 v[180:181], v[180:181], v[234:235]
    v_pk_mul_f32 v[182:183], v[182:183], v[236:237]
    v_pk_mul_f32 v[230:231], v[168:169], v[168:169]
    v_pk_mul_f32 v[232:233], v[170:171], v[170:171]
    v_pk_mul_f32 v[234:235], v[184:185], v[184:185]
    v_pk_mul_f32 v[236:237], v[186:187], v[186:187]
    v_pk_fma_f32 v[230:231], v[230:231], v[238:239], v[238:239] op_sel:[0,0,1] op_sel_hi:[1,0,1]
    v_pk_fma_f32 v[232:233], v[232:233], v[238:239], v[238:239] op_sel:[0,0,1] op_sel_hi:[1,0,1]
    v_pk_fma_f32 v[234:235], v[234:235], v[238:239], v[238:239] op_sel:[0,0,1] op_sel_hi:[1,0,1]
    v_pk_fma_f32 v[236:237], v[236:237], v[238:239], v[238:239] op_sel:[0,0,1] op_sel_hi:[1,0,1]
    v_pk_mul_f32 v[230:231], v[230:231], v[168:169]
    v_pk_mul_f32 v[232:233], v[232:233], v[170:171]
    v_pk_mul_f32 v[234:235], v[234:235], v[184:185]
    v_pk_mul_f32 v[236:237], v[236:237], v[186:187]
    v_exp_f32 v230, v230
    v_exp_f32 v231, v231
    v_exp_f32 v232, v232
    v_exp_f32 v233, v233
    v_exp_f32 v234, v234
    v_exp_f32 v235, v235
    v_exp_f32 v236, v236
    v_exp_f32 v237, v237
    v_pk_add_f32 v[230:231], v[230:231], 1.0 op_sel_hi:[1,0]
    v_pk_add_f32 v[232:233], v[232:233], 1.0 op_sel_hi:[1,0]
    v_pk_add_f32 v[234:235], v[234:235], 1.0 op_sel_hi:[1,0]
    v_pk_add_f32 v[236:237], v[236:237], 1.0 op_sel_hi:[1,0]
    v_rcp_f32 v230, v230
    v_rcp_f32 v231, v231
    v_rcp_f32 v232, v232
    v_rcp_f32 v233, v233
    v_rcp_f32 v234, v234
    v_rcp_f32 v235, v235
    v_rcp_f32 v236, v236
    v_rcp_f32 v237, v237
    v_pk_mul_f32 v[168:169], v[168:169], v[230:231]
    v_pk_mul_f32 v[170:171], v[170:171], v[232:233]
    v_pk_mul_f32 v[184:185], v[184:185], v[234:235]
    v_pk_mul_f32 v[186:187], v[186:187], v[236:237]
    v_pk_mul_f32 v[230:231], v[172:173], v[172:173]
    v_pk_mul_f32 v[232:233], v[174:175], v[174:175]
    v_pk_mul_f32 v[234:235], v[188:189], v[188:189]
    v_pk_mul_f32 v[236:237], v[190:191], v[190:191]
    v_pk_fma_f32 v[230:231], v[230:231], v[238:239], v[238:239] op_sel:[0,0,1] op_sel_hi:[1,0,1]
    v_pk_fma_f32 v[232:233], v[232:233], v[238:239], v[238:239] op_sel:[0,0,1] op_sel_hi:[1,0,1]
    v_pk_fma_f32 v[234:235], v[234:235], v[238:239], v[238:239] op_sel:[0,0,1] op_sel_hi:[1,0,1]
    v_pk_fma_f32 v[236:237], v[236:237], v[238:239], v[238:239] op_sel:[0,0,1] op_sel_hi:[1,0,1]
    v_pk_mul_f32 v[230:231], v[230:231], v[172:173]
    v_pk_mul_f32 v[232:233], v[232:233], v[174:175]
    v_pk_mul_f32 v[234:235], v[234:235], v[188:189]
    v_pk_mul_f32 v[236:237], v[236:237], v[190:191]
    v_exp_f32 v230, v230
    v_exp_f32 v231, v231
    v_exp_f32 v232, v232
    v_exp_f32 v233, v233
    v_exp_f32 v234, v234
    v_exp_f32 v235, v235
    v_exp_f32 v236, v236
    v_exp_f32 v237, v237
    v_pk_add_f32 v[230:231], v[230:231], 1.0 op_sel_hi:[1,0]
    v_pk_add_f32 v[232:233], v[232:233], 1.0 op_sel_hi:[1,0]
    v_pk_add_f32 v[234:235], v[234:235], 1.0 op_sel_hi:[1,0]
    v_pk_add_f32 v[236:237], v[236:237], 1.0 op_sel_hi:[1,0]
    v_rcp_f32 v230, v230
    v_rcp_f32 v231, v231
    v_rcp_f32 v232, v232
    v_rcp_f32 v233, v233
    v_rcp_f32 v234, v234
    v_rcp_f32 v235, v235
    v_rcp_f32 v236, v236
    v_rcp_f32 v237, v237
    v_pk_mul_f32 v[172:173], v[172:173], v[230:231]
    v_pk_mul_f32 v[174:175], v[174:175], v[232:233]
    v_pk_mul_f32 v[188:189], v[188:189], v[234:235]
    v_pk_mul_f32 v[190:191], v[190:191], v[236:237]
    v_accvgpr_read_b32 v8, a244
    v_accvgpr_read_b32 v24, a245
    v_accvgpr_read_b32 v40, a246
    v_accvgpr_read_b32 v56, a247
    v_lshlrev_b32 v0, 16, v8
    v_and_b32 v8, 0xffff0000, v8
    v_mov_b32 v1, v0
    v_mov_b64 v[2:3], v[0:1]
    v_mov_b64 v[4:5], v[0:1]
    v_mov_b64 v[6:7], v[0:1]
    v_mov_b32 v9, v8
    v_mov_b64 v[10:11], v[8:9]
    v_mov_b64 v[12:13], v[8:9]
    v_mov_b64 v[14:15], v[8:9]
    v_lshlrev_b32 v16, 16, v24
    v_and_b32 v24, 0xffff0000, v24
    v_mov_b32 v17, v16
    v_mov_b64 v[18:19], v[16:17]
    v_mov_b64 v[20:21], v[16:17]
    v_mov_b64 v[22:23], v[16:17]
    v_mov_b32 v25, v24
    v_mov_b64 v[26:27], v[24:25]
    v_mov_b64 v[28:29], v[24:25]
    v_mov_b64 v[30:31], v[24:25]
    v_lshlrev_b32 v32, 16, v40
    v_and_b32 v40, 0xffff0000, v40
    v_mov_b32 v33, v32
    v_mov_b64 v[34:35], v[32:33]
    v_mov_b64 v[36:37], v[32:33]
    v_mov_b64 v[38:39], v[32:33]
    v_mov_b32 v41, v40
    v_mov_b64 v[42:43], v[40:41]
    v_mov_b64 v[44:45], v[40:41]
    v_mov_b64 v[46:47], v[40:41]
    v_lshlrev_b32 v48, 16, v56
    v_and_b32 v56, 0xffff0000, v56
    v_mov_b32 v49, v48
    v_mov_b64 v[50:51], v[48:49]
    v_mov_b64 v[52:53], v[48:49]
    v_mov_b64 v[54:55], v[48:49]
    v_mov_b32 v57, v56
    v_mov_b64 v[58:59], v[56:57]
    v_mov_b64 v[60:61], v[56:57]
    v_mov_b64 v[62:63], v[56:57]
    s_waitcnt vmcnt(0)
    s_barrier
    s_cmp_lg_u32 s3, 0
    s_cbranch_scc1 L_noflag_42
    v_mbcnt_lo_u32_b32 v246, -1, 0
    v_mov_b32 v243, s26
    v_lshlrev_b32 v246, 2, v246
    s_mov_b32 exec_hi, 0
    buffer_store_dword v243, v246, s[44:47], s84 offen sc1
    s_mov_b64 exec, -1
L_noflag_42:
    s_add_u32 m0, s99, 65536
    s_nop 0
    buffer_load_dwordx4 v250, s[32:35], s98 offen offset:0 lds
    v_cvt_pk_bf16_f32 v80, v160, v161
    v_cvt_pk_bf16_f32 v81, v162, v163
    buffer_load_dwordx4 v251, s[32:35], s98 offen offset:1024 lds
    v_cvt_pk_bf16_f32 v82, v176, v177
    v_cvt_pk_bf16_f32 v83, v178, v179
    buffer_load_dwordx4 v252, s[32:35], s98 offen offset:2048 lds
    v_cvt_pk_bf16_f32 v84, v164, v165
    v_cvt_pk_bf16_f32 v85, v166, v167
    buffer_load_dwordx4 v253, s[32:35], s98 offen offset:3072 lds
    v_cvt_pk_bf16_f32 v86, v180, v181
    v_cvt_pk_bf16_f32 v87, v182, v183
    s_xor_b32 s98, s98, 1024
    s_add_u32 m0, s99, 81920
    s_nop 0
    buffer_load_dwordx4 v250, s[32:35], s98 offen offset:0 lds
    v_cvt_pk_bf16_f32 v88, v168, v169
    v_cvt_pk_bf16_f32 v89, v170, v171
    buffer_load_dwordx4 v251, s[32:35], s98 offen offset:1024 lds
    v_cvt_pk_bf16_f32 v90, v184, v185
    v_cvt_pk_bf16_f32 v91, v186, v187
    buffer_load_dwordx4 v252, s[32:35], s98 offen offset:2048 lds
    v_cvt_pk_bf16_f32 v92, v172, v173
    v_cvt_pk_bf16_f32 v93, v174, v175
    buffer_load_dwordx4 v253, s[32:35], s98 offen offset:3072 lds
    v_cvt_pk_bf16_f32 v94, v188, v189
    v_cvt_pk_bf16_f32 v95, v190, v191
    s_xor_b32 s98, s98, 3072
    s_add_u32 m0, s99, 0
    s_nop 0
    buffer_load_dwordx4 v250, s[32:35], s98 offen offset:0 lds
    buffer_load_dwordx4 v251, s[32:35], s98 offen offset:1024 lds
    buffer_load_dwordx4 v252, s[32:35], s98 offen offset:2048 lds
    buffer_load_dwordx4 v253, s[32:35], s98 offen offset:3072 lds
    s_xor_b32 s98, s98, 1024
    s_add_u32 m0, s99, 16384
    s_nop 0
    buffer_load_dwordx4 v250, s[32:35], s98 offen offset:0 lds
    buffer_load_dwordx4 v251, s[32:35], s98 offen offset:1024 lds
    buffer_load_dwordx4 v252, s[32:35], s98 offen offset:2048 lds
    buffer_load_dwordx4 v253, s[32:35], s98 offen offset:3072 lds
    s_mov_b32 s58, 3080192
    buffer_load_dwordx4 a[188:191], v247, s[28:31], s58 offen
    s_mov_b32 s58, 3145728
    buffer_load_dwordx4 a[192:195], v247, s[28:31], s58 offen
    s_mov_b32 s58, 3211264
    buffer_load_dwordx4 a[196:199], v247, s[28:31], s58 offen
    s_mov_b32 s58, 3276800
    buffer_load_dwordx4 a[200:203], v247, s[28:31], s58 offen
    s_mov_b32 s58, 3342336
    buffer_load_dwordx4 a[204:207], v247, s[28:31], s58 offen
    s_mov_b32 s58, 3407872
    buffer_load_dwordx4 a[208:211], v247, s[28:31], s58 offen
    s_mov_b32 s58, 3473408
    buffer_load_dwordx4 a[212:215], v247, s[28:31], s58 offen
    s_mov_b32 s58, 3538944
    buffer_load_dwordx4 a[216:219], v247, s[28:31], s58 offen
    s_mov_b32 s58, 3604480
    buffer_load_dwordx4 a[220:223], v247, s[28:31], s58 offen
    s_add_u32 m0, s55, 49152
    s_nop 0
    buffer_load_dwordx4 v247, s[40:43], s54 offen lds
    s_add_u32 s54, s54, 65536
    s_add_u32 m0, s55, 53248
    s_nop 0
    buffer_load_dwordx4 v247, s[40:43], s54 offen lds
    s_add_u32 s54, s54, 65536
    s_add_u32 m0, s55, 57344
    s_nop 0
    buffer_load_dwordx4 v247, s[40:43], s54 offen lds
    s_add_u32 s54, s54, 65536
    s_add_u32 m0, s55, 61440
    s_nop 0
    buffer_load_dwordx4 v247, s[40:43], s54 offen lds
    s_add_u32 s54, s54, 65536
    s_branch L_po_K_0
.p2align 12
L_pg_K_0:
    s_branch L_pg_K_3
L_po_K_0:
L_k1tail_22:
L_k23:
    s_cmp_eq_u32 s62, 0
    s_cbranch_scc1 L_k3pre_43
    s_mov_b32 s63, 0
L_poll_44:
    buffer_load_dword v243, v240, s[44:47], 0 offen sc1
    s_waitcnt vmcnt(0)
    v_cmp_ne_u32 vcc, s26, v243
    s_add_u32 s63, s63, 1
    s_cmp_eq_u64 vcc, 0
    s_cbranch_scc1 L_polled_45
    s_sleep 2
    s_cmp_lt_u32 s63, 200000
    s_cbranch_scc1 L_poll_44
    s_endpgm
L_polled_45:
L_z2ok_23:
    buffer_load_dwordx4 v[160:163], v224, s[36:39], s52 offen offset:0 sc1
    buffer_load_dwordx4 v[164:167], v224, s[36:39], s52 offen offset:1024 sc1
    buffer_load_dwordx4 v[168:171], v224, s[36:39], s52 offen offset:2048 sc1
    buffer_load_dwordx4 v[172:175], v224, s[36:39], s52 offen offset:3072 sc1
    s_xor_b32 s52, s52, 32768
    buffer_load_dwordx4 v[176:179], v224, s[36:39], s52 offen offset:0 sc1
    buffer_load_dwordx4 v[180:183], v224, s[36:39], s52 offen offset:1024 sc1
    buffer_load_dwordx4 v[184:187], v224, s[36:39], s52 offen offset:2048 sc1
    buffer_load_dwordx4 v[188:191], v224, s[36:39], s52 offen offset:3072 sc1
    s_xor_b32 s52, s52, 98304
    buffer_load_dwordx4 v[96:99], v224, s[36:39], s52 offen offset:0 sc1
    buffer_load_dwordx4 v[100:103], v224, s[36:39], s52 offen offset:1024 sc1
    buffer_load_dwordx4 v[104:107], v224, s[36:39], s52 offen offset:2048 sc1
    buffer_load_dwordx4 v[108:111], v224, s[36:39], s52 offen offset:3072 sc1
    s_xor_b32 s52, s52, 32768
    s_waitcnt vmcnt(10)
    s_barrier
    ds_read_b128 a[224:227], v227 offset:0
    buffer_load_dwordx4 v[112:115], v224, s[36:39], s52 offen offset:0 sc1
    ds_read_b128 a[228:231], v227 offset:2048
    buffer_load_dwordx4 v[116:119], v224, s[36:39], s52 offen offset:1024 sc1
    ds_read_b128 a[232:235], v227 offset:4096
    buffer_load_dwordx4 v[120:123], v224, s[36:39], s52 offen offset:2048 sc1
    ds_read_b128 a[236:239], v227 offset:6144
    ds_read_b128 a[240:243], v227 offset:8192
    buffer_load_dwordx4 v[124:127], v224, s[36:39], s52 offen offset:3072 sc1
    s_xor_b32 s52, s52, 110592
    ds_read_b128 a[244:247], v227 offset:10240
    s_xor_b32 s98, s98, 3456
    s_add_u32 m0, s99, 32768
    buffer_load_dwordx4 v[128:131], v224, s[36:39], s52 offen offset:0 sc1
    s_waitcnt lgkmcnt(4)
    v_mfma_f32_16x16x32_bf16 v[0:3], v[160:163], a[224:227], v[0:3]
    ds_read_b128 a[248:251], v227 offset:12288
    v_mfma_f32_16x16x32_bf16 v[4:7], v[164:167], a[224:227], v[4:7]
    buffer_load_dwordx4 v250, s[32:35], s98 offen offset:0 lds
    v_mfma_f32_16x16x32_bf16 v[12:15], v[164:167], a[228:231], v[12:15]
    ds_read_b128 a[252:255], v227 offset:14336
    v_mfma_f32_16x16x32_bf16 v[8:11], v[160:163], a[228:231], v[8:11]
    s_waitcnt lgkmcnt(4)
    v_mfma_f32_16x16x32_bf16 v[16:19], v[160:163], a[232:235], v[16:19]
    ds_read_b128 a[224:227], v228 offset:0
    v_mfma_f32_16x16x32_bf16 v[20:23], v[164:167], a[232:235], v[20:23]
    buffer_load_dwordx4 v[132:135], v224, s[36:39], s52 offen offset:1024 sc1
    v_mfma_f32_16x16x32_bf16 v[28:31], v[164:167], a[236:239], v[28:31]
    ds_read_b128 a[228:231], v228 offset:2048
    v_mfma_f32_16x16x32_bf16 v[24:27], v[160:163], a[236:239], v[24:27]
    buffer_load_dwordx4 v251, s[32:35], s98 offen offset:1024 lds
    s_waitcnt lgkmcnt(4)
    v_mfma_f32_16x16x32_bf16 v[32:35], v[160:163], a[240:243], v[32:35]
    ds_read_b128 a[232:235], v228 offset:4096
    v_mfma_f32_16x16x32_bf16 v[36:39], v[164:167], a[240:243], v[36:39]
    buffer_load_dwordx4 v[136:139], v224, s[36:39], s52 offen offset:2048 sc1
    v_mfma_f32_16x16x32_bf16 v[44:47], v[164:167], a[244:247], v[44:47]
    ds_read_b128 a[236:239], v228 offset:6144
    v_mfma_f32_16x16x32_bf16 v[40:43], v[160:163], a[244:247], v[40:43]
    s_waitcnt lgkmcnt(4)
    v_mfma_f32_16x16x32_bf16 v[48:51], v[160:163], a[248:251], v[48:51]
    ds_read_b128 a[240:243], v228 offset:8192
    v_mfma_f32_16x16x32_bf16 v[52:55], v[164:167], a[248:251], v[52:55]
    buffer_load_dwordx4 v252, s[32:35], s98 offen offset:2048 lds
    v_mfma_f32_16x16x32_bf16 v[60:63], v[164:167], a[252:255], v[60:63]
    ds_read_b128 a[244:247], v228 offset:10240
    v_mfma_f32_16x16x32_bf16 v[56:59], v[160:163], a[252:255], v[56:59]
    buffer_load_dwordx4 v[140:143], v224, s[36:39], s52 offen offset:3072 sc1
    s_xor_b32 s52, s52, 4096
    s_waitcnt vmcnt(19) lgkmcnt(4)
    v_mfma_f32_16x16x32_bf16 v[0:3], v[168:171], a[224:227], v[0:3]
    ds_read_b128 a[248:251], v228 offset:12288
    v_mfma_f32_16x16x32_bf16 v[4:7], v[172:175], a[224:227], v[4:7]
    buffer_load_dwordx4 v253, s[32:35], s98 offen offset:3072 lds
    v_mfma_f32_16x16x32_bf16 v[12:15], v[172:175], a[228:231], v[12:15]
    ds_read_b128 a[252:255], v228 offset:14336
    v_mfma_f32_16x16x32_bf16 v[8:11], v[168:171], a[228:231], v[8:11]
    s_barrier
    s_waitcnt lgkmcnt(4)
    v_mfma_f32_16x16x32_bf16 v[16:19], v[168:171], a[232:235], v[16:19]
    ds_read_b128 a[224:227], v227 offset:16384
    v_mfma_f32_16x16x32_bf16 v[20:23], v[172:175], a[232:235], v[20:23]
    s_lshl_b32 s0, s3, 13
    s_add_u32 s0, s0, L_k23-L_code+16384
    v_lshl_add_u32 v194, v224, 3, s0
    s_getpc_b64 s[0:1]
L_pc_46:
    s_sub_u32 s0, s0, L_pc_46-L_code
    s_subb_u32 s1, s1, 0
    v_min_u32 v194, L_exit-L_code, v194
    v_mov_b32 v195, s1
    v_add_co_u32 v194, vcc, s0, v194
    s_nop 1
    v_addc_co_u32 v195, vcc, 0, v195, vcc
    global_load_dword v193, v[194:195], off
    v_mfma_f32_16x16x32_bf16 v[28:31], v[172:175], a[236:239], v[28:31]
    ds_read_b128 a[228:231], v227 offset:18432
    v_mfma_f32_16x16x32_bf16 v[24:27], v[168:171], a[236:239], v[24:27]
    s_bitcmp0_b32 s2, 3
    s_cbranch_scc0 L_alt_47
    buffer_store_dwordx4 v[80:83], v224, s[36:39], s12 offen offset:0 sc1
L_alt_47:
    s_waitcnt lgkmcnt(4)
    v_mfma_f32_16x16x32_bf16 v[32:35], v[168:171], a[240:243], v[32:35]
    ds_read_b128 a[232:235], v227 offset:20480
    v_mfma_f32_16x16x32_bf16 v[36:39], v[172:175], a[240:243], v[36:39]
    v_mfma_f32_16x16x32_bf16 v[44:47], v[172:175], a[244:247], v[44:47]
    ds_read_b128 a[236:239], v227 offset:22528
    v_mfma_f32_16x16x32_bf16 v[40:43], v[168:171], a[244:247], v[40:43]
    s_xor_b32 s98, s98, 128
    s_add_u32 m0, s99, 49152
    buffer_load_dwordx4 v[144:147], v224, s[36:39], s52 offen offset:0 sc1
    s_waitcnt lgkmcnt(4)
    v_mfma_f32_16x16x32_bf16 v[48:51], v[168:171], a[248:251], v[48:51]
    ds_read_b128 a[240:243], v227 offset:24576
    v_mfma_f32_16x16x32_bf16 v[52:55], v[172:175], a[248:251], v[52:55]
    buffer_load_dwordx4 v250, s[32:35], s98 offen offset:0 lds
    v_mfma_f32_16x16x32_bf16 v[60:63], v[172:175], a[252:255], v[60:63]
    ds_read_b128 a[244:247], v227 offset:26624
    v_mfma_f32_16x16x32_bf16 v[56:59], v[168:171], a[252:255], v[56:59]
    s_waitcnt vmcnt(21) lgkmcnt(4)
    v_mfma_f32_16x16x32_bf16 v[0:3], v[176:179], a[224:227], v[0:3]
    ds_read_b128 a[248:251], v227 offset:28672
    v_mfma_f32_16x16x32_bf16 v[4:7], v[180:183], a[224:227], v[4:7]
    buffer_load_dwordx4 v[148:151], v224, s[36:39], s52 offen offset:1024 sc1
    v_mfma_f32_16x16x32_bf16 v[12:15], v[180:183], a[228:231], v[12:15]
    ds_read_b128 a[252:255], v227 offset:30720
    v_mfma_f32_16x16x32_bf16 v[8:11], v[176:179], a[228:231], v[8:11]
    s_bfe_u32 s68, s2, 0x20001
    s_lshl_b32 s68, s68, 2
    s_waitcnt lgkmcnt(4)
    v_mfma_f32_16x16x32_bf16 v[16:19], v[176:179], a[232:235], v[16:19]
    ds_read_b128 a[224:227], v228 offset:16384
    v_mfma_f32_16x16x32_bf16 v[20:23], v[180:183], a[232:235], v[20:23]
    buffer_load_dwordx4 v251, s[32:35], s98 offen offset:1024 lds
    v_mfma_f32_16x16x32_bf16 v[28:31], v[180:183], a[236:239], v[28:31]
    ds_read_b128 a[228:231], v228 offset:18432
    v_mfma_f32_16x16x32_bf16 v[24:27], v[176:179], a[236:239], v[24:27]
    buffer_load_dwordx4 v[152:155], v224, s[36:39], s52 offen offset:2048 sc1
    s_waitcnt lgkmcnt(4)
    v_mfma_f32_16x16x32_bf16 v[32:35], v[176:179], a[240:243], v[32:35]
    ds_read_b128 a[232:235], v228 offset:20480
    v_mfma_f32_16x16x32_bf16 v[36:39], v[180:183], a[240:243], v[36:39]
    s_lshr_b32 s69, s2, 6
    s_add_u32 s68, s68, s69
    v_mfma_f32_16x16x32_bf16 v[44:47], v[180:183], a[244:247], v[44:47]
    ds_read_b128 a[236:239], v228 offset:22528
    v_mfma_f32_16x16x32_bf16 v[40:43], v[176:179], a[244:247], v[40:43]
    buffer_load_dwordx4 v252, s[32:35], s98 offen offset:2048 lds
    s_waitcnt lgkmcnt(4)
    v_mfma_f32_16x16x32_bf16 v[48:51], v[176:179], a[248:251], v[48:51]
    ds_read_b128 a[240:243], v228 offset:24576
    v_mfma_f32_16x16x32_bf16 v[52:55], v[180:183], a[248:251], v[52:55]
    buffer_load_dwordx4 v[156:159], v224, s[36:39], s52 offen offset:3072 sc1
    s_xor_b32 s52, s52, 12288
    v_mfma_f32_16x16x32_bf16 v[60:63], v[180:183], a[252:255], v[60:63]
    ds_read_b128 a[244:247], v228 offset:26624
    v_mfma_f32_16x16x32_bf16 v[56:59], v[176:179], a[252:255], v[56:59]
    s_lshl_b32 s64, s68, 2
    s_add_u32 s64, s64, s3
    s_waitcnt vmcnt(24) lgkmcnt(4)
    v_mfma_f32_16x16x32_bf16 v[0:3], v[184:187], a[224:227], v[0:3]
    ds_read_b128 a[248:251], v228 offset:28672
    v_mfma_f32_16x16x32_bf16 v[4:7], v[188:191], a[224:227], v[4:7]
    buffer_load_dwordx4 v253, s[32:35], s98 offen offset:3072 lds
    v_mfma_f32_16x16x32_bf16 v[12:15], v[188:191], a[228:231], v[12:15]
    ds_read_b128 a[252:255], v228 offset:30720
    v_mfma_f32_16x16x32_bf16 v[8:11], v[184:187], a[228:231], v[8:11]
    s_mul_i32 s67, s64, 180224
    s_add_u32 s67, s67, 0x400000
    s_barrier
    s_waitcnt lgkmcnt(4)
    v_mfma_f32_16x16x32_bf16 v[16:19], v[184:187], a[232:235], v[16:19]
    ds_read_b128 a[224:227], v225 offset:0
    v_mfma_f32_16x16x32_bf16 v[20:23], v[188:191], a[232:235], v[20:23]
    s_bitcmp1_b32 s2, 3
    s_cbranch_scc0 L_alt_48
    buffer_store_dwordx4 v[80:83], v224, s[36:39], s12 offen offset:0 sc1
L_alt_48:
    v_mfma_f32_16x16x32_bf16 v[28:31], v[188:191], a[236:239], v[28:31]
    ds_read_b128 a[228:231], v225 offset:2048
    v_mfma_f32_16x16x32_bf16 v[24:27], v[184:187], a[236:239], v[24:27]
    s_xor_b32 s98, s98, 384
    s_add_u32 m0, s99, 65536
    buffer_load_dwordx4 v[160:163], v224, s[36:39], s52 offen offset:0 sc1
    s_waitcnt lgkmcnt(4)
    v_mfma_f32_16x16x32_bf16 v[32:35], v[184:187], a[240:243], v[32:35]
    ds_read_b128 a[232:235], v225 offset:4096
    v_mfma_f32_16x16x32_bf16 v[36:39], v[188:191], a[240:243], v[36:39]
    v_lshrrev_b32 v200, 4, v224
    v_bfe_u32 v246, v224, 2, 7
    v_mfma_f32_16x16x32_bf16 v[44:47], v[188:191], a[244:247], v[44:47]
    ds_read_b128 a[236:239], v225 offset:6144
    v_mfma_f32_16x16x32_bf16 v[40:43], v[184:187], a[244:247], v[40:43]
    buffer_load_dwordx4 v250, s[32:35], s98 offen offset:0 lds
    s_waitcnt lgkmcnt(4)
    v_mfma_f32_16x16x32_bf16 v[48:51], v[184:187], a[248:251], v[48:51]
    ds_read_b128 a[240:243], v225 offset:8192
    v_mfma_f32_16x16x32_bf16 v[52:55], v[188:191], a[248:251], v[52:55]
    s_lshr_b32 s69, s96, 1
    s_lshr_b32 s71, s68, 1
    v_mfma_f32_16x16x32_bf16 v[60:63], v[188:191], a[252:255], v[60:63]
    ds_read_b128 a[244:247], v225 offset:10240
    v_mfma_f32_16x16x32_bf16 v[56:59], v[184:187], a[252:255], v[56:59]
    buffer_load_dwordx4 v[164:167], v224, s[36:39], s52 offen offset:1024 sc1
    s_waitcnt vmcnt(26) lgkmcnt(4)
    v_mfma_f32_16x16x32_bf16 v[0:3], v[96:99], a[224:227], v[0:3]
    ds_read_b128 a[248:251], v225 offset:12288
    v_mfma_f32_16x16x32_bf16 v[4:7], v[100:103], a[224:227], v[4:7]
    s_sub_u32 s71, s71, s69
    s_lshl_b32 s69, s69, 12
    v_mfma_f32_16x16x32_bf16 v[12:15], v[100:103], a[228:231], v[12:15]
    ds_read_b128 a[252:255], v225 offset:14336
    v_mfma_f32_16x16x32_bf16 v[8:11], v[96:99], a[228:231], v[8:11]
    buffer_load_dwordx4 v251, s[32:35], s98 offen offset:1024 lds
    s_waitcnt lgkmcnt(4)
    v_mfma_f32_16x16x32_bf16 v[16:19], v[96:99], a[232:235], v[16:19]
    ds_read_b128 a[224:227], v226 offset:0
    v_mfma_f32_16x16x32_bf16 v[20:23], v[100:103], a[232:235], v[20:23]
    buffer_load_dwordx4 v[168:171], v224, s[36:39], s52 offen offset:2048 sc1
    v_mfma_f32_16x16x32_bf16 v[28:31], v[100:103], a[236:239], v[28:31]
    ds_read_b128 a[228:231], v226 offset:2048
    v_mfma_f32_16x16x32_bf16 v[24:27], v[96:99], a[236:239], v[24:27]
    s_add_u32 s69, s69, 311296
    v_and_b32 v203, 15, v200
    s_waitcnt lgkmcnt(4)
    v_mfma_f32_16x16x32_bf16 v[32:35], v[96:99], a[240:243], v[32:35]
    ds_read_b128 a[232:235], v226 offset:4096
    v_mfma_f32_16x16x32_bf16 v[36:39], v[100:103], a[240:243], v[36:39]
    buffer_load_dwordx4 v252, s[32:35], s98 offen offset:2048 lds
    v_mfma_f32_16x16x32_bf16 v[44:47], v[100:103], a[244:247], v[44:47]
    ds_read_b128 a[236:239], v226 offset:6144
    v_mfma_f32_16x16x32_bf16 v[40:43], v[96:99], a[244:247], v[40:43]
    v_lshl_add_u32 v203, s3, 4, v203
    v_lshrrev_b32 v201, 5, v203
    s_waitcnt lgkmcnt(4)
    v_mfma_f32_16x16x32_bf16 v[48:51], v[96:99], a[248:251], v[48:51]
    ds_read_b128 a[240:243], v226 offset:8192
    v_mfma_f32_16x16x32_bf16 v[52:55], v[100:103], a[248:251], v[52:55]
    buffer_load_dwordx4 v[172:175], v224, s[36:39], s52 offen offset:3072 sc1
    s_xor_b32 s52, s52, 24576
    v_mfma_f32_16x16x32_bf16 v[60:63], v[100:103], a[252:255], v[60:63]
    ds_read_b128 a[244:247], v226 offset:10240
    v_mfma_f32_16x16x32_bf16 v[56:59], v[96:99], a[252:255], v[56:59]
    v_mul_i32_i24 v201, s71, v201
    v_and_b32 v202, 31, v203
    s_waitcnt vmcnt(28) lgkmcnt(4)
    v_mfma_f32_16x16x32_bf16 v[0:3], v[104:107], a[224:227], v[0:3]
    ds_read_b128 a[248:251], v226 offset:12288
    v_mfma_f32_16x16x32_bf16 v[4:7], v[108:111], a[224:227], v[4:7]
    buffer_load_dwordx4 v253, s[32:35], s98 offen offset:3072 lds
    v_mfma_f32_16x16x32_bf16 v[12:15], v[108:111], a[228:231], v[12:15]
    ds_read_b128 a[252:255], v226 offset:14336
    v_mfma_f32_16x16x32_bf16 v[8:11], v[104:107], a[228:231], v[8:11]
    v_lshl_add_u32 v201, v201, 5, v202
    v_lshl_add_u32 v240, v201, 7, s69
    s_barrier
    s_waitcnt lgkmcnt(4)
    v_mfma_f32_16x16x32_bf16 v[16:19], v[104:107], a[232:235], v[16:19]
    ds_read_b128 a[224:227], v225 offset:16384
    v_mfma_f32_16x16x32_bf16 v[20:23], v[108:111], a[232:235], v[20:23]
    s_bitcmp0_b32 s2, 3
    s_cbranch_scc0 L_alt_49
    buffer_store_dwordx4 v[84:87], v224, s[36:39], s12 offen offset:1024 sc1
L_alt_49:
    v_mfma_f32_16x16x32_bf16 v[28:31], v[108:111], a[236:239], v[28:31]
    ds_read_b128 a[228:231], v225 offset:18432
    v_mfma_f32_16x16x32_bf16 v[24:27], v[104:107], a[236:239], v[24:27]
    s_xor_b32 s98, s98, 768
    s_add_u32 m0, s99, 81920
    buffer_load_dwordx4 v[176:179], v224, s[36:39], s52 offen offset:0 sc1
    s_waitcnt lgkmcnt(4)
    v_mfma_f32_16x16x32_bf16 v[32:35], v[104:107], a[240:243], v[32:35]
    ds_read_b128 a[232:235], v225 offset:20480
    v_mfma_f32_16x16x32_bf16 v[36:39], v[108:111], a[240:243], v[36:39]
    v_and_b32 v202, 7, v200
    v_lshrrev_b32 v202, v202, 8
    v_mfma_f32_16x16x32_bf16 v[44:47], v[108:111], a[244:247], v[44:47]
    ds_read_b128 a[236:239], v225 offset:22528
    v_mfma_f32_16x16x32_bf16 v[40:43], v[104:107], a[244:247], v[40:43]
    buffer_load_dwordx4 v250, s[32:35], s98 offen offset:0 lds
    s_waitcnt lgkmcnt(4)
    v_mfma_f32_16x16x32_bf16 v[48:51], v[104:107], a[248:251], v[48:51]
    ds_read_b128 a[240:243], v225 offset:24576
    v_mfma_f32_16x16x32_bf16 v[52:55], v[108:111], a[248:251], v[52:55]
    v_and_b32 v202, 1, v202
    v_lshlrev_b32 v202, 7, v202
    v_mfma_f32_16x16x32_bf16 v[60:63], v[108:111], a[252:255], v[60:63]
    ds_read_b128 a[244:247], v225 offset:26624
    v_mfma_f32_16x16x32_bf16 v[56:59], v[104:107], a[252:255], v[56:59]
    buffer_load_dwordx4 v[180:183], v224, s[36:39], s52 offen offset:1024 sc1
    s_waitcnt vmcnt(30) lgkmcnt(4)
    v_mfma_f32_16x16x32_bf16 v[0:3], v[112:115], a[224:227], v[0:3]
    ds_read_b128 a[248:251], v225 offset:28672
    v_mfma_f32_16x16x32_bf16 v[4:7], v[116:119], a[224:227], v[4:7]
    v_sub_u32 v241, v240, v202
    v_and_b32 v245, 1, v200
    v_mfma_f32_16x16x32_bf16 v[12:15], v[116:119], a[228:231], v[12:15]
    ds_read_b128 a[252:255], v225 offset:30720
    v_mfma_f32_16x16x32_bf16 v[8:11], v[112:115], a[228:231], v[8:11]
    buffer_load_dwordx4 v251, s[32:35], s98 offen offset:1024 lds
    s_waitcnt lgkmcnt(4)
    v_mfma_f32_16x16x32_bf16 v[16:19], v[112:115], a[232:235], v[16:19]
    ds_read_b128 a[224:227], v226 offset:16384
    v_mfma_f32_16x16x32_bf16 v[20:23], v[116:119], a[232:235], v[20:23]
    buffer_load_dwordx4 v[184:187], v224, s[36:39], s52 offen offset:2048 sc1
    v_mfma_f32_16x16x32_bf16 v[28:31], v[116:119], a[236:239], v[28:31]
    ds_read_b128 a[228:231], v226 offset:18432
    v_mfma_f32_16x16x32_bf16 v[24:27], v[112:115], a[236:239], v[24:27]
    v_lshl_add_u32 v245, v245, 7, s48
    s_lshr_b32 s71, s68, 1
    s_waitcnt lgkmcnt(4)
    v_mfma_f32_16x16x32_bf16 v[32:35], v[112:115], a[240:243], v[32:35]
    ds_read_b128 a[232:235], v226 offset:20480
    v_mfma_f32_16x16x32_bf16 v[36:39], v[116:119], a[240:243], v[36:39]
    buffer_load_dwordx4 v252, s[32:35], s98 offen offset:2048 lds
    v_mfma_f32_16x16x32_bf16 v[44:47], v[116:119], a[244:247], v[44:47]
    ds_read_b128 a[236:239], v226 offset:22528
    v_mfma_f32_16x16x32_bf16 v[40:43], v[112:115], a[244:247], v[40:43]
    s_lshl_b32 s71, s71, 12
    s_add_u32 s71, s71, 311680
    s_waitcnt lgkmcnt(4)
    v_mfma_f32_16x16x32_bf16 v[48:51], v[112:115], a[248:251], v[48:51]
    ds_read_b128 a[240:243], v226 offset:24576
    v_mfma_f32_16x16x32_bf16 v[52:55], v[116:119], a[248:251], v[52:55]
    buffer_load_dwordx4 v[188:191], v224, s[36:39], s52 offen offset:3072 sc1
    s_xor_b32 s52, s52, 4096
    v_mfma_f32_16x16x32_bf16 v[60:63], v[116:119], a[252:255], v[60:63]
    ds_read_b128 a[244:247], v226 offset:26624
    v_mfma_f32_16x16x32_bf16 v[56:59], v[112:115], a[252:255], v[56:59]
    v_and_b32 v240, 3, v200
    v_lshl_add_u32 v240, v240, 10, s71
    s_waitcnt vmcnt(32) lgkmcnt(4)
    v_mfma_f32_16x16x32_bf16 v[0:3], v[120:123], a[224:227], v[0:3]
    ds_read_b128 a[248:251], v226 offset:28672
    v_mfma_f32_16x16x32_bf16 v[4:7], v[124:127], a[224:227], v[4:7]
    buffer_load_dwordx4 v253, s[32:35], s98 offen offset:3072 lds
    v_mfma_f32_16x16x32_bf16 v[12:15], v[124:127], a[228:231], v[12:15]
    ds_read_b128 a[252:255], v226 offset:30720
    v_mfma_f32_16x16x32_bf16 v[8:11], v[120:123], a[228:231], v[8:11]
    s_mul_i32 s72, s96, 458752
    s_lshl_b32 s69, s97, 11
    s_waitcnt vmcnt(25)
    s_barrier
    s_waitcnt lgkmcnt(4)
    v_mfma_f32_16x16x32_bf16 v[16:19], v[120:123], a[232:235], v[16:19]
    ds_read_b128 a[224:227], v225 offset:32768
    v_mfma_f32_16x16x32_bf16 v[20:23], v[124:127], a[232:235], v[20:23]
    s_bitcmp1_b32 s2, 3
    s_cbranch_scc0 L_alt_50
    buffer_store_dwordx4 v[84:87], v224, s[36:39], s12 offen offset:1024 sc1
L_alt_50:
    v_mfma_f32_16x16x32_bf16 v[28:31], v[124:127], a[236:239], v[28:31]
    ds_read_b128 a[228:231], v225 offset:34816
    v_mfma_f32_16x16x32_bf16 v[24:27], v[120:123], a[236:239], v[24:27]
    s_xor_b32 s98, s98, 128
    s_add_u32 m0, s99, 0
    buffer_load_dwordx4 v[96:99], v224, s[36:39], s52 offen offset:0 sc1
    s_waitcnt lgkmcnt(4)
    v_mfma_f32_16x16x32_bf16 v[32:35], v[120:123], a[240:243], v[32:35]
    ds_read_b128 a[232:235], v225 offset:36864
    v_mfma_f32_16x16x32_bf16 v[36:39], v[124:127], a[240:243], v[36:39]
    s_add_u32 s72, s72, s69
    s_add_u32 s72, s72, 0x1000000
    v_mfma_f32_16x16x32_bf16 v[44:47], v[124:127], a[244:247], v[44:47]
    ds_read_b128 a[236:239], v225 offset:38912
    v_mfma_f32_16x16x32_bf16 v[40:43], v[120:123], a[244:247], v[40:43]
    buffer_load_dwordx4 v250, s[32:35], s98 offen offset:0 lds
    s_waitcnt lgkmcnt(4)
    v_mfma_f32_16x16x32_bf16 v[48:51], v[120:123], a[248:251], v[48:51]
    ds_read_b128 a[240:243], v225 offset:40960
    v_mfma_f32_16x16x32_bf16 v[52:55], v[124:127], a[248:251], v[52:55]
    s_and_b32 s71, s48, 0x20000
    s_lshl_b32 s71, s71, 13
    v_mfma_f32_16x16x32_bf16 v[60:63], v[124:127], a[252:255], v[60:63]
    ds_read_b128 a[244:247], v225 offset:43008
    v_mfma_f32_16x16x32_bf16 v[56:59], v[120:123], a[252:255], v[56:59]
    buffer_load_dwordx4 v[100:103], v224, s[36:39], s52 offen offset:1024 sc1
    s_waitcnt lgkmcnt(4)
    v_mfma_f32_16x16x32_bf16 v[0:3], v[128:131], a[224:227], v[0:3]
    ds_read_b128 a[248:251], v225 offset:45056
    v_mfma_f32_16x16x32_bf16 v[4:7], v[132:135], a[224:227], v[4:7]
    s_add_u32 s72, s72, s71
    s_mul_i32 s76, s96, 720896
    v_mfma_f32_16x16x32_bf16 v[12:15], v[132:135], a[228:231], v[12:15]
    ds_read_b128 a[252:255], v225 offset:47104
    v_mfma_f32_16x16x32_bf16 v[8:11], v[128:131], a[228:231], v[8:11]
    buffer_load_dwordx4 v251, s[32:35], s98 offen offset:1024 lds
    s_waitcnt lgkmcnt(4)
    v_mfma_f32_16x16x32_bf16 v[16:19], v[128:131], a[232:235], v[16:19]
    ds_read_b128 a[224:227], v226 offset:32768
    v_mfma_f32_16x16x32_bf16 v[20:23], v[132:135], a[232:235], v[20:23]
    buffer_load_dwordx4 v[104:107], v224, s[36:39], s52 offen offset:2048 sc1
    v_mfma_f32_16x16x32_bf16 v[28:31], v[132:135], a[236:239], v[28:31]
    ds_read_b128 a[228:231], v226 offset:34816
    v_mfma_f32_16x16x32_bf16 v[24:27], v[128:131], a[236:239], v[24:27]
    s_add_u32 s76, s76, s69
    s_add_u32 s76, s76, 0x410000
    s_waitcnt lgkmcnt(4)
    v_mfma_f32_16x16x32_bf16 v[32:35], v[128:131], a[240:243], v[32:35]
    ds_read_b128 a[232:235], v226 offset:36864
    v_mfma_f32_16x16x32_bf16 v[36:39], v[132:135], a[240:243], v[36:39]
    buffer_load_dwordx4 v252, s[32:35], s98 offen offset:2048 lds
    v_mfma_f32_16x16x32_bf16 v[44:47], v[132:135], a[244:247], v[44:47]
    ds_read_b128 a[236:239], v226 offset:38912
    v_mfma_f32_16x16x32_bf16 v[40:43], v[128:131], a[244:247], v[40:43]
    s_add_u32 s73, s72, 114688
    s_add_u32 s77, s76, 180224
    s_waitcnt lgkmcnt(4)
    v_mfma_f32_16x16x32_bf16 v[48:51], v[128:131], a[248:251], v[48:51]
    ds_read_b128 a[240:243], v226 offset:40960
    v_mfma_f32_16x16x32_bf16 v[52:55], v[132:135], a[248:251], v[52:55]
    buffer_load_dwordx4 v[108:111], v224, s[36:39], s52 offen offset:3072 sc1
    s_xor_b32 s52, s52, 12288
    v_mfma_f32_16x16x32_bf16 v[60:63], v[132:135], a[252:255], v[60:63]
    ds_read_b128 a[244:247], v226 offset:43008
    v_mfma_f32_16x16x32_bf16 v[56:59], v[128:131], a[252:255], v[56:59]
    s_add_u32 s74, s73, 114688
    s_add_u32 s78, s77, 180224
    s_waitcnt lgkmcnt(4)
    v_mfma_f32_16x16x32_bf16 v[0:3], v[136:139], a[224:227], v[0:3]
    ds_read_b128 a[248:251], v226 offset:45056
    v_mfma_f32_16x16x32_bf16 v[4:7], v[140:143], a[224:227], v[4:7]
    buffer_load_dwordx4 v253, s[32:35], s98 offen offset:3072 lds
    v_mfma_f32_16x16x32_bf16 v[12:15], v[140:143], a[228:231], v[12:15]
    ds_read_b128 a[252:255], v226 offset:47104
    v_mfma_f32_16x16x32_bf16 v[8:11], v[136:139], a[228:231], v[8:11]
    s_add_u32 s75, s74, 114688
    s_add_u32 s79, s78, 180224
    s_waitcnt vmcnt(24)
    s_barrier
    s_waitcnt lgkmcnt(4)
    v_mfma_f32_16x16x32_bf16 v[16:19], v[136:139], a[232:235], v[16:19]
    ds_read_b128 a[224:227], v225 offset:49152
    v_mfma_f32_16x16x32_bf16 v[20:23], v[140:143], a[232:235], v[20:23]
    s_bitcmp0_b32 s2, 3
    s_cbranch_scc0 L_alt_51
    buffer_store_dwordx4 v[88:91], v224, s[36:39], s13 offen offset:0 sc1
L_alt_51:
    v_mfma_f32_16x16x32_bf16 v[28:31], v[140:143], a[236:239], v[28:31]
    ds_read_b128 a[228:231], v225 offset:51200
    v_mfma_f32_16x16x32_bf16 v[24:27], v[136:139], a[236:239], v[24:27]
    s_xor_b32 s98, s98, 384
    s_add_u32 m0, s99, 16384
    buffer_load_dwordx4 v[112:115], v224, s[36:39], s52 offen offset:0 sc1
    s_waitcnt lgkmcnt(4)
    v_mfma_f32_16x16x32_bf16 v[32:35], v[136:139], a[240:243], v[32:35]
    ds_read_b128 a[232:235], v225 offset:53248
    v_mfma_f32_16x16x32_bf16 v[36:39], v[140:143], a[240:243], v[36:39]
    s_lshl_b32 s69, s68, 11
    s_add_u32 s69, s69, 344064
    v_mfma_f32_16x16x32_bf16 v[44:47], v[140:143], a[244:247], v[44:47]
    ds_read_b128 a[236:239], v225 offset:55296
    v_mfma_f32_16x16x32_bf16 v[40:43], v[136:139], a[244:247], v[40:43]
    buffer_load_dwordx4 v250, s[32:35], s98 offen offset:0 lds
    s_waitcnt lgkmcnt(4)
    v_mfma_f32_16x16x32_bf16 v[48:51], v[136:139], a[248:251], v[48:51]
    ds_read_b128 a[240:243], v225 offset:57344
    v_mfma_f32_16x16x32_bf16 v[52:55], v[140:143], a[248:251], v[52:55]
    v_min_u32 v201, 13, v200
    v_lshl_add_u32 v242, v201, 7, s69
    v_mfma_f32_16x16x32_bf16 v[60:63], v[140:143], a[252:255], v[60:63]
    ds_read_b128 a[244:247], v225 offset:59392
    v_mfma_f32_16x16x32_bf16 v[56:59], v[136:139], a[252:255], v[56:59]
    buffer_load_dwordx4 v[116:119], v224, s[36:39], s52 offen offset:1024 sc1
    s_waitcnt lgkmcnt(4)
    v_mfma_f32_16x16x32_bf16 v[0:3], v[144:147], a[224:227], v[0:3]
    ds_read_b128 a[248:251], v225 offset:61440
    v_mfma_f32_16x16x32_bf16 v[4:7], v[148:151], a[224:227], v[4:7]
    s_lshr_b32 s69, s97, 2
    s_lshl_b32 s66, s96, 11
    v_mfma_f32_16x16x32_bf16 v[12:15], v[148:151], a[228:231], v[12:15]
    ds_read_b128 a[252:255], v225 offset:63488
    v_mfma_f32_16x16x32_bf16 v[8:11], v[144:147], a[228:231], v[8:11]
    buffer_load_dwordx4 v251, s[32:35], s98 offen offset:1024 lds
    s_waitcnt lgkmcnt(4)
    v_mfma_f32_16x16x32_bf16 v[16:19], v[144:147], a[232:235], v[16:19]
    ds_read_b128 a[224:227], v226 offset:49152
    v_mfma_f32_16x16x32_bf16 v[20:23], v[148:151], a[232:235], v[20:23]
    buffer_load_dwordx4 v[120:123], v224, s[36:39], s52 offen offset:2048 sc1
    v_mfma_f32_16x16x32_bf16 v[28:31], v[148:151], a[236:239], v[28:31]
    ds_read_b128 a[228:231], v226 offset:51200
    v_mfma_f32_16x16x32_bf16 v[24:27], v[144:147], a[236:239], v[24:27]
    s_lshl_b32 s69, s69, 7
    s_add_u32 s66, s66, s69
    s_waitcnt lgkmcnt(4)
    v_mfma_f32_16x16x32_bf16 v[32:35], v[144:147], a[240:243], v[32:35]
    ds_read_b128 a[232:235], v226 offset:53248
    v_mfma_f32_16x16x32_bf16 v[36:39], v[148:151], a[240:243], v[36:39]
    buffer_load_dwordx4 v252, s[32:35], s98 offen offset:2048 lds
    v_mfma_f32_16x16x32_bf16 v[44:47], v[148:151], a[244:247], v[44:47]
    ds_read_b128 a[236:239], v226 offset:55296
    v_mfma_f32_16x16x32_bf16 v[40:43], v[144:147], a[244:247], v[40:43]
    s_add_u32 s66, s66, 344064
    s_and_b32 s70, s2, 1
    s_waitcnt lgkmcnt(4)
    v_mfma_f32_16x16x32_bf16 v[48:51], v[144:147], a[248:251], v[48:51]
    ds_read_b128 a[240:243], v226 offset:57344
    v_mfma_f32_16x16x32_bf16 v[52:55], v[148:151], a[248:251], v[52:55]
    buffer_load_dwordx4 v[124:127], v224, s[36:39], s52 offen offset:3072 sc1
    s_xor_b32 s52, s52, 4096
    v_mfma_f32_16x16x32_bf16 v[60:63], v[148:151], a[252:255], v[60:63]
    ds_read_b128 a[244:247], v226 offset:59392
    v_mfma_f32_16x16x32_bf16 v[56:59], v[144:147], a[252:255], v[56:59]
    s_lshl_b32 s70, s70, 3
    s_bfe_u32 s69, s2, 0x30003
    s_waitcnt lgkmcnt(4)
    v_mfma_f32_16x16x32_bf16 v[0:3], v[152:155], a[224:227], v[0:3]
    ds_read_b128 a[248:251], v226 offset:61440
    v_mfma_f32_16x16x32_bf16 v[4:7], v[156:159], a[224:227], v[4:7]
    buffer_load_dwordx4 v253, s[32:35], s98 offen offset:3072 lds
    v_mfma_f32_16x16x32_bf16 v[12:15], v[156:159], a[228:231], v[12:15]
    ds_read_b128 a[252:255], v226 offset:63488
    v_mfma_f32_16x16x32_bf16 v[8:11], v[152:155], a[228:231], v[8:11]
    s_add_u32 s70, s70, s69
    s_lshl_b32 s70, s70, 7
    s_waitcnt vmcnt(24)
    s_barrier
    s_waitcnt lgkmcnt(4)
    v_mfma_f32_16x16x32_bf16 v[16:19], v[152:155], a[232:235], v[16:19]
    ds_read_b128 a[224:227], v227 offset:0
    v_mfma_f32_16x16x32_bf16 v[20:23], v[156:159], a[232:235], v[20:23]
    s_bitcmp1_b32 s2, 3
    s_cbranch_scc0 L_alt_52
    buffer_store_dwordx4 v[88:91], v224, s[36:39], s13 offen offset:0 sc1
L_alt_52:
    v_mfma_f32_16x16x32_bf16 v[28:31], v[156:159], a[236:239], v[28:31]
    ds_read_b128 a[228:231], v227 offset:2048
    v_mfma_f32_16x16x32_bf16 v[24:27], v[152:155], a[236:239], v[24:27]
    s_xor_b32 s98, s98, 128
    s_add_u32 m0, s99, 32768
    buffer_load_dwordx4 v[128:131], v224, s[36:39], s52 offen offset:0 sc1
    s_waitcnt lgkmcnt(4)
    v_mfma_f32_16x16x32_bf16 v[32:35], v[152:155], a[240:243], v[32:35]
    ds_read_b128 a[232:235], v227 offset:4096
    v_mfma_f32_16x16x32_bf16 v[36:39], v[156:159], a[240:243], v[36:39]
    s_lshl_b32 s65, s64, 16
    s_add_u32 s65, s65, s70
    v_mfma_f32_16x16x32_bf16 v[44:47], v[156:159], a[244:247], v[44:47]
    ds_read_b128 a[236:239], v227 offset:6144
    v_mfma_f32_16x16x32_bf16 v[40:43], v[152:155], a[244:247], v[40:43]
    buffer_load_dwordx4 v250, s[32:35], s98 offen offset:0 lds
    s_waitcnt lgkmcnt(4)
    v_mfma_f32_16x16x32_bf16 v[48:51], v[152:155], a[248:251], v[48:51]
    ds_read_b128 a[240:243], v227 offset:8192
    v_mfma_f32_16x16x32_bf16 v[52:55], v[156:159], a[248:251], v[52:55]
    v_add_u32 v237, s55, v224
    v_add_u32 v238, 0x10000, v237
    v_mfma_f32_16x16x32_bf16 v[60:63], v[156:159], a[252:255], v[60:63]
    ds_read_b128 a[244:247], v227 offset:10240
    v_mfma_f32_16x16x32_bf16 v[56:59], v[152:155], a[252:255], v[56:59]
    buffer_load_dwordx4 v[132:135], v224, s[36:39], s52 offen offset:1024 sc1
    s_waitcnt lgkmcnt(4)
    v_mfma_f32_16x16x32_bf16 v[0:3], v[160:163], a[224:227], v[0:3]
    ds_read_b128 a[248:251], v227 offset:12288
    v_mfma_f32_16x16x32_bf16 v[4:7], v[164:167], a[224:227], v[4:7]
    v_lshrrev_b32 v201, 2, v200
    v_and_b32 v202, 3, v200
    v_mfma_f32_16x16x32_bf16 v[12:15], v[164:167], a[228:231], v[12:15]
    ds_read_b128 a[252:255], v227 offset:14336
    v_mfma_f32_16x16x32_bf16 v[8:11], v[160:163], a[228:231], v[8:11]
    buffer_load_dwordx4 v251, s[32:35], s98 offen offset:1024 lds
    s_waitcnt lgkmcnt(4)
    v_mfma_f32_16x16x32_bf16 v[16:19], v[160:163], a[232:235], v[16:19]
    ds_read_b128 a[224:227], v228 offset:0
    v_mfma_f32_16x16x32_bf16 v[20:23], v[164:167], a[232:235], v[20:23]
    buffer_load_dwordx4 v[136:139], v224, s[36:39], s52 offen offset:2048 sc1
    v_mfma_f32_16x16x32_bf16 v[28:31], v[164:167], a[236:239], v[28:31]
    ds_read_b128 a[228:231], v228 offset:2048
    v_mfma_f32_16x16x32_bf16 v[24:27], v[160:163], a[236:239], v[24:27]
    v_bfe_u32 v203, v200, 3, 2
    v_lshlrev_b32 v201, 7, v201
    s_waitcnt lgkmcnt(4)
    v_mfma_f32_16x16x32_bf16 v[32:35], v[160:163], a[240:243], v[32:35]
    s_branch L_po_K_1
.p2align 12
L_pg_K_1:
    s_branch L_pg_K_4
L_po_K_1:
    ds_read_b128 a[232:235], v228 offset:4096
    v_mfma_f32_16x16x32_bf16 v[36:39], v[164:167], a[240:243], v[36:39]
    buffer_load_dwordx4 v252, s[32:35], s98 offen offset:2048 lds
    v_mfma_f32_16x16x32_bf16 v[44:47], v[164:167], a[244:247], v[44:47]
    ds_read_b128 a[236:239], v228 offset:6144
    v_mfma_f32_16x16x32_bf16 v[40:43], v[160:163], a[244:247], v[40:43]
    v_lshl_add_u32 v201, v202, 3, v201
    v_xor_b32 v202, 0, v203
    s_waitcnt lgkmcnt(4)
    v_mfma_f32_16x16x32_bf16 v[48:51], v[160:163], a[248:251], v[48:51]
    ds_read_b128 a[240:243], v228 offset:8192
    v_mfma_f32_16x16x32_bf16 v[52:55], v[164:167], a[248:251], v[52:55]
    buffer_load_dwordx4 v[140:143], v224, s[36:39], s52 offen offset:3072 sc1
    s_xor_b32 s52, s52, 61440
    v_mfma_f32_16x16x32_bf16 v[60:63], v[164:167], a[252:255], v[60:63]
    ds_read_b128 a[244:247], v228 offset:10240
    v_mfma_f32_16x16x32_bf16 v[56:59], v[160:163], a[252:255], v[56:59]
    v_lshl_add_u32 v229, v202, 5, v201
    v_add_u32 v233, 0x10000, v229
    s_waitcnt lgkmcnt(4)
    v_mfma_f32_16x16x32_bf16 v[0:3], v[168:171], a[224:227], v[0:3]
    ds_read_b128 a[248:251], v228 offset:12288
    v_mfma_f32_16x16x32_bf16 v[4:7], v[172:175], a[224:227], v[4:7]
    buffer_load_dwordx4 v253, s[32:35], s98 offen offset:3072 lds
    v_mfma_f32_16x16x32_bf16 v[12:15], v[172:175], a[228:231], v[12:15]
    ds_read_b128 a[252:255], v228 offset:14336
    v_mfma_f32_16x16x32_bf16 v[8:11], v[168:171], a[228:231], v[8:11]
    v_xor_b32 v202, 1, v203
    v_lshl_add_u32 v230, v202, 5, v201
    s_waitcnt vmcnt(24)
    s_barrier
    s_waitcnt lgkmcnt(4)
    v_mfma_f32_16x16x32_bf16 v[16:19], v[168:171], a[232:235], v[16:19]
    ds_read_b128 a[224:227], v227 offset:16384
    v_mfma_f32_16x16x32_bf16 v[20:23], v[172:175], a[232:235], v[20:23]
    s_bitcmp0_b32 s2, 3
    s_cbranch_scc0 L_alt_53
    buffer_store_dwordx4 v[92:95], v224, s[36:39], s13 offen offset:1024 sc1
L_alt_53:
    v_mfma_f32_16x16x32_bf16 v[28:31], v[172:175], a[236:239], v[28:31]
    ds_read_b128 a[228:231], v227 offset:18432
    v_mfma_f32_16x16x32_bf16 v[24:27], v[168:171], a[236:239], v[24:27]
    s_xor_b32 s98, s98, 1920
    s_add_u32 m0, s99, 49152
    buffer_load_dwordx4 v[144:147], v224, s[36:39], s52 offen offset:0 sc1
    s_waitcnt lgkmcnt(4)
    v_mfma_f32_16x16x32_bf16 v[32:35], v[168:171], a[240:243], v[32:35]
    ds_read_b128 a[232:235], v227 offset:20480
    v_mfma_f32_16x16x32_bf16 v[36:39], v[172:175], a[240:243], v[36:39]
    v_add_u32 v234, 0x10000, v230
    v_xor_b32 v202, 2, v203
    v_mfma_f32_16x16x32_bf16 v[44:47], v[172:175], a[244:247], v[44:47]
    ds_read_b128 a[236:239], v227 offset:22528
    v_mfma_f32_16x16x32_bf16 v[40:43], v[168:171], a[244:247], v[40:43]
    buffer_load_dwordx4 v250, s[32:35], s98 offen offset:0 lds
    s_waitcnt lgkmcnt(4)
    v_mfma_f32_16x16x32_bf16 v[48:51], v[168:171], a[248:251], v[48:51]
    ds_read_b128 a[240:243], v227 offset:24576
    v_mfma_f32_16x16x32_bf16 v[52:55], v[172:175], a[248:251], v[52:55]
    v_lshl_add_u32 v231, v202, 5, v201
    v_add_u32 v235, 0x10000, v231
    v_mfma_f32_16x16x32_bf16 v[60:63], v[172:175], a[252:255], v[60:63]
    ds_read_b128 a[244:247], v227 offset:26624
    v_mfma_f32_16x16x32_bf16 v[56:59], v[168:171], a[252:255], v[56:59]
    buffer_load_dwordx4 v[148:151], v224, s[36:39], s52 offen offset:1024 sc1
    s_waitcnt lgkmcnt(4)
    v_mfma_f32_16x16x32_bf16 v[0:3], v[176:179], a[224:227], v[0:3]
    ds_read_b128 a[248:251], v227 offset:28672
    v_mfma_f32_16x16x32_bf16 v[4:7], v[180:183], a[224:227], v[4:7]
    v_xor_b32 v202, 3, v203
    v_lshl_add_u32 v232, v202, 5, v201
    v_mfma_f32_16x16x32_bf16 v[12:15], v[180:183], a[228:231], v[12:15]
    ds_read_b128 a[252:255], v227 offset:30720
    v_mfma_f32_16x16x32_bf16 v[8:11], v[176:179], a[228:231], v[8:11]
    buffer_load_dwordx4 v251, s[32:35], s98 offen offset:1024 lds
    s_waitcnt lgkmcnt(4)
    v_mfma_f32_16x16x32_bf16 v[16:19], v[176:179], a[232:235], v[16:19]
    ds_read_b128 a[224:227], v228 offset:16384
    v_mfma_f32_16x16x32_bf16 v[20:23], v[180:183], a[232:235], v[20:23]
    buffer_load_dwordx4 v[152:155], v224, s[36:39], s52 offen offset:2048 sc1
    v_mfma_f32_16x16x32_bf16 v[28:31], v[180:183], a[236:239], v[28:31]
    ds_read_b128 a[228:231], v228 offset:18432
    v_mfma_f32_16x16x32_bf16 v[24:27], v[176:179], a[236:239], v[24:27]
    v_add_u32 v236, 0x10000, v232
    v_and_b32 v201, 15, v200
    s_waitcnt lgkmcnt(4)
    v_mfma_f32_16x16x32_bf16 v[32:35], v[176:179], a[240:243], v[32:35]
    ds_read_b128 a[232:235], v228 offset:20480
    v_mfma_f32_16x16x32_bf16 v[36:39], v[180:183], a[240:243], v[36:39]
    buffer_load_dwordx4 v252, s[32:35], s98 offen offset:2048 lds
    v_mfma_f32_16x16x32_bf16 v[44:47], v[180:183], a[244:247], v[44:47]
    ds_read_b128 a[236:239], v228 offset:22528
    v_mfma_f32_16x16x32_bf16 v[40:43], v[176:179], a[244:247], v[40:43]
    v_lshlrev_b32 v201, 12, v201
    v_bfe_u32 v202, v200, 4, 1
    s_waitcnt lgkmcnt(4)
    v_mfma_f32_16x16x32_bf16 v[48:51], v[176:179], a[248:251], v[48:51]
    ds_read_b128 a[240:243], v228 offset:24576
    v_mfma_f32_16x16x32_bf16 v[52:55], v[180:183], a[248:251], v[52:55]
    buffer_load_dwordx4 v[156:159], v224, s[36:39], s52 offen offset:3072 sc1
    s_xor_b32 s52, s52, 4096
    v_mfma_f32_16x16x32_bf16 v[60:63], v[180:183], a[252:255], v[60:63]
    ds_read_b128 a[244:247], v228 offset:26624
    v_mfma_f32_16x16x32_bf16 v[56:59], v[176:179], a[252:255], v[56:59]
    v_bfe_u32 v203, v200, 5, 1
    v_lshl_add_u32 v201, v202, 5, v201
    s_waitcnt lgkmcnt(4)
    v_mfma_f32_16x16x32_bf16 v[0:3], v[184:187], a[224:227], v[0:3]
    ds_read_b128 a[248:251], v228 offset:28672
    v_mfma_f32_16x16x32_bf16 v[4:7], v[188:191], a[224:227], v[4:7]
    buffer_load_dwordx4 v253, s[32:35], s98 offen offset:3072 lds
    v_mfma_f32_16x16x32_bf16 v[12:15], v[188:191], a[228:231], v[12:15]
    ds_read_b128 a[252:255], v228 offset:30720
    v_mfma_f32_16x16x32_bf16 v[8:11], v[184:187], a[228:231], v[8:11]
    v_lshl_add_u32 v239, v203, 4, v201
    s_waitcnt vmcnt(24)
    s_barrier
    s_waitcnt lgkmcnt(4)
    v_mfma_f32_16x16x32_bf16 v[16:19], v[184:187], a[232:235], v[16:19]
    ds_read_b128 a[224:227], v225 offset:0
    v_mfma_f32_16x16x32_bf16 v[20:23], v[188:191], a[232:235], v[20:23]
    s_bitcmp1_b32 s2, 3
    s_cbranch_scc0 L_alt_54
    buffer_store_dwordx4 v[92:95], v224, s[36:39], s13 offen offset:1024 sc1
L_alt_54:
    v_mfma_f32_16x16x32_bf16 v[28:31], v[188:191], a[236:239], v[28:31]
    ds_read_b128 a[228:231], v225 offset:2048
    v_mfma_f32_16x16x32_bf16 v[24:27], v[184:187], a[236:239], v[24:27]
    s_xor_b32 s98, s98, 128
    s_add_u32 m0, s99, 65536
    buffer_load_dwordx4 v[160:163], v224, s[36:39], s52 offen offset:0 sc1
    s_waitcnt lgkmcnt(4)
    v_mfma_f32_16x16x32_bf16 v[32:35], v[184:187], a[240:243], v[32:35]
    ds_read_b128 a[232:235], v225 offset:4096
    v_mfma_f32_16x16x32_bf16 v[36:39], v[188:191], a[240:243], v[36:39]
    v_mfma_f32_16x16x32_bf16 v[44:47], v[188:191], a[244:247], v[44:47]
    ds_read_b128 a[236:239], v225 offset:6144
    v_mfma_f32_16x16x32_bf16 v[40:43], v[184:187], a[244:247], v[40:43]
    buffer_load_dwordx4 v250, s[32:35], s98 offen offset:0 lds
    s_waitcnt lgkmcnt(4)
    v_mfma_f32_16x16x32_bf16 v[48:51], v[184:187], a[248:251], v[48:51]
    ds_read_b128 a[240:243], v225 offset:8192
    v_mfma_f32_16x16x32_bf16 v[52:55], v[188:191], a[248:251], v[52:55]
    v_mfma_f32_16x16x32_bf16 v[60:63], v[188:191], a[252:255], v[60:63]
    ds_read_b128 a[244:247], v225 offset:10240
    v_mfma_f32_16x16x32_bf16 v[56:59], v[184:187], a[252:255], v[56:59]
    buffer_load_dwordx4 v[164:167], v224, s[36:39], s52 offen offset:1024 sc1
    s_waitcnt lgkmcnt(4)
    v_mfma_f32_16x16x32_bf16 v[0:3], v[96:99], a[224:227], v[0:3]
    ds_read_b128 a[248:251], v225 offset:12288
    v_mfma_f32_16x16x32_bf16 v[4:7], v[100:103], a[224:227], v[4:7]
    v_mfma_f32_16x16x32_bf16 v[12:15], v[100:103], a[228:231], v[12:15]
    ds_read_b128 a[252:255], v225 offset:14336
    v_mfma_f32_16x16x32_bf16 v[8:11], v[96:99], a[228:231], v[8:11]
    buffer_load_dwordx4 v251, s[32:35], s98 offen offset:1024 lds
    s_waitcnt lgkmcnt(4)
    v_mfma_f32_16x16x32_bf16 v[16:19], v[96:99], a[232:235], v[16:19]
    ds_read_b128 a[224:227], v226 offset:0
    v_mfma_f32_16x16x32_bf16 v[20:23], v[100:103], a[232:235], v[20:23]
    buffer_load_dwordx4 v[168:171], v224, s[36:39], s52 offen offset:2048 sc1
    v_mfma_f32_16x16x32_bf16 v[28:31], v[100:103], a[236:239], v[28:31]
    ds_read_b128 a[228:231], v226 offset:2048
    v_mfma_f32_16x16x32_bf16 v[24:27], v[96:99], a[236:239], v[24:27]
    s_waitcnt lgkmcnt(4)
    v_mfma_f32_16x16x32_bf16 v[32:35], v[96:99], a[240:243], v[32:35]
    ds_read_b128 a[232:235], v226 offset:4096
    v_mfma_f32_16x16x32_bf16 v[36:39], v[100:103], a[240:243], v[36:39]
    buffer_load_dwordx4 v252, s[32:35], s98 offen offset:2048 lds
    v_mfma_f32_16x16x32_bf16 v[44:47], v[100:103], a[244:247], v[44:47]
    ds_read_b128 a[236:239], v226 offset:6144
    v_mfma_f32_16x16x32_bf16 v[40:43], v[96:99], a[244:247], v[40:43]
    s_waitcnt lgkmcnt(4)
    v_mfma_f32_16x16x32_bf16 v[48:51], v[96:99], a[248:251], v[48:51]
    ds_read_b128 a[240:243], v226 offset:8192
    v_mfma_f32_16x16x32_bf16 v[52:55], v[100:103], a[248:251], v[52:55]
    buffer_load_dwordx4 v[172:175], v224, s[36:39], s52 offen offset:3072 sc1
    s_xor_b32 s52, s52, 12288
    v_mfma_f32_16x16x32_bf16 v[60:63], v[100:103], a[252:255], v[60:63]
    ds_read_b128 a[244:247], v226 offset:10240
    v_mfma_f32_16x16x32_bf16 v[56:59], v[96:99], a[252:255], v[56:59]
    s_waitcnt lgkmcnt(4)
    v_mfma_f32_16x16x32_bf16 v[0:3], v[104:107], a[224:227], v[0:3]
    ds_read_b128 a[248:251], v226 offset:12288
    v_mfma_f32_16x16x32_bf16 v[4:7], v[108:111], a[224:227], v[4:7]
    buffer_load_dwordx4 v253, s[32:35], s98 offen offset:3072 lds
    v_mfma_f32_16x16x32_bf16 v[12:15], v[108:111], a[228:231], v[12:15]
    ds_read_b128 a[252:255], v226 offset:14336
    v_mfma_f32_16x16x32_bf16 v[8:11], v[104:107], a[228:231], v[8:11]
    s_waitcnt vmcnt(24)
    s_barrier
    s_waitcnt lgkmcnt(4)
    v_mfma_f32_16x16x32_bf16 v[16:19], v[104:107], a[232:235], v[16:19]
    ds_read_b128 a[224:227], v225 offset:16384
    v_mfma_f32_16x16x32_bf16 v[20:23], v[108:111], a[232:235], v[20:23]
    s_xor_b32 s98, s98, 384
    s_add_u32 m0, s99, 81920
    buffer_load_dwordx4 v[176:179], v224, s[36:39], s52 offen offset:0 sc1
    v_mfma_f32_16x16x32_bf16 v[28:31], v[108:111], a[236:239], v[28:31]
    ds_read_b128 a[228:231], v225 offset:18432
    v_mfma_f32_16x16x32_bf16 v[24:27], v[104:107], a[236:239], v[24:27]
    s_waitcnt lgkmcnt(4)
    v_mfma_f32_16x16x32_bf16 v[32:35], v[104:107], a[240:243], v[32:35]
    ds_read_b128 a[232:235], v225 offset:20480
    v_mfma_f32_16x16x32_bf16 v[36:39], v[108:111], a[240:243], v[36:39]
    buffer_load_dwordx4 v250, s[32:35], s98 offen offset:0 lds
    v_mfma_f32_16x16x32_bf16 v[44:47], v[108:111], a[244:247], v[44:47]
    ds_read_b128 a[236:239], v225 offset:22528
    v_mfma_f32_16x16x32_bf16 v[40:43], v[104:107], a[244:247], v[40:43]
    s_waitcnt lgkmcnt(4)
    v_mfma_f32_16x16x32_bf16 v[48:51], v[104:107], a[248:251], v[48:51]
    ds_read_b128 a[240:243], v225 offset:24576
    v_mfma_f32_16x16x32_bf16 v[52:55], v[108:111], a[248:251], v[52:55]
    buffer_load_dwordx4 v[180:183], v224, s[36:39], s52 offen offset:1024 sc1
    v_mfma_f32_16x16x32_bf16 v[60:63], v[108:111], a[252:255], v[60:63]
    ds_read_b128 a[244:247], v225 offset:26624
    v_mfma_f32_16x16x32_bf16 v[56:59], v[104:107], a[252:255], v[56:59]
    s_waitcnt lgkmcnt(4)
    v_mfma_f32_16x16x32_bf16 v[0:3], v[112:115], a[224:227], v[0:3]
    ds_read_b128 a[248:251], v225 offset:28672
    v_mfma_f32_16x16x32_bf16 v[4:7], v[116:119], a[224:227], v[4:7]
    buffer_load_dwordx4 v251, s[32:35], s98 offen offset:1024 lds
    v_mfma_f32_16x16x32_bf16 v[12:15], v[116:119], a[228:231], v[12:15]
    ds_read_b128 a[252:255], v225 offset:30720
    v_mfma_f32_16x16x32_bf16 v[8:11], v[112:115], a[228:231], v[8:11]
    s_waitcnt lgkmcnt(4)
    v_mfma_f32_16x16x32_bf16 v[16:19], v[112:115], a[232:235], v[16:19]
    ds_read_b128 a[224:227], v226 offset:16384
    v_mfma_f32_16x16x32_bf16 v[20:23], v[116:119], a[232:235], v[20:23]
    buffer_load_dwordx4 v[184:187], v224, s[36:39], s52 offen offset:2048 sc1
    v_mfma_f32_16x16x32_bf16 v[28:31], v[116:119], a[236:239], v[28:31]
    ds_read_b128 a[228:231], v226 offset:18432
    v_mfma_f32_16x16x32_bf16 v[24:27], v[112:115], a[236:239], v[24:27]
    s_waitcnt lgkmcnt(4)
    v_mfma_f32_16x16x32_bf16 v[32:35], v[112:115], a[240:243], v[32:35]
    ds_read_b128 a[232:235], v226 offset:20480
    v_mfma_f32_16x16x32_bf16 v[36:39], v[116:119], a[240:243], v[36:39]
    buffer_load_dwordx4 v252, s[32:35], s98 offen offset:2048 lds
    v_mfma_f32_16x16x32_bf16 v[44:47], v[116:119], a[244:247], v[44:47]
    ds_read_b128 a[236:239], v226 offset:22528
    v_mfma_f32_16x16x32_bf16 v[40:43], v[112:115], a[244:247], v[40:43]
    s_waitcnt lgkmcnt(4)
    v_mfma_f32_16x16x32_bf16 v[48:51], v[112:115], a[248:251], v[48:51]
    ds_read_b128 a[240:243], v226 offset:24576
    v_mfma_f32_16x16x32_bf16 v[52:55], v[116:119], a[248:251], v[52:55]
    buffer_load_dwordx4 v[188:191], v224, s[36:39], s52 offen offset:3072 sc1
    s_xor_b32 s52, s52, 24576
    v_mfma_f32_16x16x32_bf16 v[60:63], v[116:119], a[252:255], v[60:63]
    ds_read_b128 a[244:247], v226 offset:26624
    v_mfma_f32_16x16x32_bf16 v[56:59], v[112:115], a[252:255], v[56:59]
    s_waitcnt lgkmcnt(4)
    v_mfma_f32_16x16x32_bf16 v[0:3], v[120:123], a[224:227], v[0:3]
    ds_read_b128 a[248:251], v226 offset:28672
    v_mfma_f32_16x16x32_bf16 v[4:7], v[124:127], a[224:227], v[4:7]
    buffer_load_dwordx4 v253, s[32:35], s98 offen offset:3072 lds
    v_mfma_f32_16x16x32_bf16 v[12:15], v[124:127], a[228:231], v[12:15]
    ds_read_b128 a[252:255], v226 offset:30720
    v_mfma_f32_16x16x32_bf16 v[8:11], v[120:123], a[228:231], v[8:11]
    s_waitcnt vmcnt(24)
    s_barrier
    s_waitcnt lgkmcnt(4)
    v_mfma_f32_16x16x32_bf16 v[16:19], v[120:123], a[232:235], v[16:19]
    ds_read_b128 a[224:227], v225 offset:32768
    v_mfma_f32_16x16x32_bf16 v[20:23], v[124:127], a[232:235], v[20:23]
    s_xor_b32 s98, s98, 768
    s_add_u32 m0, s99, 0
    buffer_load_dwordx4 v[96:99], v224, s[36:39], s52 offen offset:0 sc1
    v_mfma_f32_16x16x32_bf16 v[28:31], v[124:127], a[236:239], v[28:31]
    ds_read_b128 a[228:231], v225 offset:34816
    v_mfma_f32_16x16x32_bf16 v[24:27], v[120:123], a[236:239], v[24:27]
    s_waitcnt lgkmcnt(4)
    v_mfma_f32_16x16x32_bf16 v[32:35], v[120:123], a[240:243], v[32:35]
    ds_read_b128 a[232:235], v225 offset:36864
    v_mfma_f32_16x16x32_bf16 v[36:39], v[124:127], a[240:243], v[36:39]
    buffer_load_dwordx4 v250, s[32:35], s98 offen offset:0 lds
    v_mfma_f32_16x16x32_bf16 v[44:47], v[124:127], a[244:247], v[44:47]
    ds_read_b128 a[236:239], v225 offset:38912
    v_mfma_f32_16x16x32_bf16 v[40:43], v[120:123], a[244:247], v[40:43]
    s_waitcnt lgkmcnt(4)
    v_mfma_f32_16x16x32_bf16 v[48:51], v[120:123], a[248:251], v[48:51]
    ds_read_b128 a[240:243], v225 offset:40960
    v_mfma_f32_16x16x32_bf16 v[52:55], v[124:127], a[248:251], v[52:55]
    buffer_load_dwordx4 v[100:103], v224, s[36:39], s52 offen offset:1024 sc1
    v_mfma_f32_16x16x32_bf16 v[60:63], v[124:127], a[252:255], v[60:63]
    ds_read_b128 a[244:247], v225 offset:43008
    v_mfma_f32_16x16x32_bf16 v[56:59], v[120:123], a[252:255], v[56:59]
    s_waitcnt lgkmcnt(4)
    v_mfma_f32_16x16x32_bf16 v[0:3], v[128:131], a[224:227], v[0:3]
    ds_read_b128 a[248:251], v225 offset:45056
    v_mfma_f32_16x16x32_bf16 v[4:7], v[132:135], a[224:227], v[4:7]
    buffer_load_dwordx4 v251, s[32:35], s98 offen offset:1024 lds
    v_mfma_f32_16x16x32_bf16 v[12:15], v[132:135], a[228:231], v[12:15]
    ds_read_b128 a[252:255], v225 offset:47104
    v_mfma_f32_16x16x32_bf16 v[8:11], v[128:131], a[228:231], v[8:11]
    s_waitcnt lgkmcnt(4)
    v_mfma_f32_16x16x32_bf16 v[16:19], v[128:131], a[232:235], v[16:19]
    ds_read_b128 a[224:227], v226 offset:32768
    v_mfma_f32_16x16x32_bf16 v[20:23], v[132:135], a[232:235], v[20:23]
    buffer_load_dwordx4 v[104:107], v224, s[36:39], s52 offen offset:2048 sc1
    v_mfma_f32_16x16x32_bf16 v[28:31], v[132:135], a[236:239], v[28:31]
    ds_read_b128 a[228:231], v226 offset:34816
    v_mfma_f32_16x16x32_bf16 v[24:27], v[128:131], a[236:239], v[24:27]
    s_waitcnt lgkmcnt(4)
    v_mfma_f32_16x16x32_bf16 v[32:35], v[128:131], a[240:243], v[32:35]
    ds_read_b128 a[232:235], v226 offset:36864
    v_mfma_f32_16x16x32_bf16 v[36:39], v[132:135], a[240:243], v[36:39]
    buffer_load_dwordx4 v252, s[32:35], s98 offen offset:2048 lds
    v_mfma_f32_16x16x32_bf16 v[44:47], v[132:135], a[244:247], v[44:47]
    ds_read_b128 a[236:239], v226 offset:38912
    v_mfma_f32_16x16x32_bf16 v[40:43], v[128:131], a[244:247], v[40:43]
    s_waitcnt lgkmcnt(4)
    v_mfma_f32_16x16x32_bf16 v[48:51], v[128:131], a[248:251], v[48:51]
    ds_read_b128 a[240:243], v226 offset:40960
    v_mfma_f32_16x16x32_bf16 v[52:55], v[132:135], a[248:251], v[52:55]
    buffer_load_dwordx4 v[108:111], v224, s[36:39], s52 offen offset:3072 sc1
    s_xor_b32 s52, s52, 4096
    v_mfma_f32_16x16x32_bf16 v[60:63], v[132:135], a[252:255], v[60:63]
    ds_read_b128 a[244:247], v226 offset:43008
    v_mfma_f32_16x16x32_bf16 v[56:59], v[128:131], a[252:255], v[56:59]
    s_waitcnt lgkmcnt(4)
    v_mfma_f32_16x16x32_bf16 v[0:3], v[136:139], a[224:227], v[0:3]
    ds_read_b128 a[248:251], v226 offset:45056
    v_mfma_f32_16x16x32_bf16 v[4:7], v[140:143], a[224:227], v[4:7]
    buffer_load_dwordx4 v253, s[32:35], s98 offen offset:3072 lds
    v_mfma_f32_16x16x32_bf16 v[12:15], v[140:143], a[228:231], v[12:15]
    ds_read_b128 a[252:255], v226 offset:47104
    v_mfma_f32_16x16x32_bf16 v[8:11], v[136:139], a[228:231], v[8:11]
    s_waitcnt vmcnt(24)
    s_barrier
    s_waitcnt lgkmcnt(4)
    v_mfma_f32_16x16x32_bf16 v[16:19], v[136:139], a[232:235], v[16:19]
    ds_read_b128 a[224:227], v225 offset:49152
    v_mfma_f32_16x16x32_bf16 v[20:23], v[140:143], a[232:235], v[20:23]
    s_xor_b32 s98, s98, 128
    s_add_u32 m0, s99, 16384
    buffer_load_dwordx4 v[112:115], v224, s[36:39], s52 offen offset:0 sc1
    v_mfma_f32_16x16x32_bf16 v[28:31], v[140:143], a[236:239], v[28:31]
    ds_read_b128 a[228:231], v225 offset:51200
    v_mfma_f32_16x16x32_bf16 v[24:27], v[136:139], a[236:239], v[24:27]
    s_waitcnt lgkmcnt(4)
    v_mfma_f32_16x16x32_bf16 v[32:35], v[136:139], a[240:243], v[32:35]
    ds_read_b128 a[232:235], v225 offset:53248
    v_mfma_f32_16x16x32_bf16 v[36:39], v[140:143], a[240:243], v[36:39]
    buffer_load_dwordx4 v250, s[32:35], s98 offen offset:0 lds
    v_mfma_f32_16x16x32_bf16 v[44:47], v[140:143], a[244:247], v[44:47]
    ds_read_b128 a[236:239], v225 offset:55296
    v_mfma_f32_16x16x32_bf16 v[40:43], v[136:139], a[244:247], v[40:43]
    s_waitcnt lgkmcnt(4)
    v_mfma_f32_16x16x32_bf16 v[48:51], v[136:139], a[248:251], v[48:51]
    ds_read_b128 a[240:243], v225 offset:57344
    v_mfma_f32_16x16x32_bf16 v[52:55], v[140:143], a[248:251], v[52:55]
    buffer_load_dwordx4 v[116:119], v224, s[36:39], s52 offen offset:1024 sc1
    v_mfma_f32_16x16x32_bf16 v[60:63], v[140:143], a[252:255], v[60:63]
    ds_read_b128 a[244:247], v225 offset:59392
    v_mfma_f32_16x16x32_bf16 v[56:59], v[136:139], a[252:255], v[56:59]
    s_waitcnt lgkmcnt(4)
    v_mfma_f32_16x16x32_bf16 v[0:3], v[144:147], a[224:227], v[0:3]
    ds_read_b128 a[248:251], v225 offset:61440
    v_mfma_f32_16x16x32_bf16 v[4:7], v[148:151], a[224:227], v[4:7]
    buffer_load_dwordx4 v251, s[32:35], s98 offen offset:1024 lds
    v_mfma_f32_16x16x32_bf16 v[12:15], v[148:151], a[228:231], v[12:15]
    ds_read_b128 a[252:255], v225 offset:63488
    v_mfma_f32_16x16x32_bf16 v[8:11], v[144:147], a[228:231], v[8:11]
    s_waitcnt lgkmcnt(4)
    v_mfma_f32_16x16x32_bf16 v[16:19], v[144:147], a[232:235], v[16:19]
    ds_read_b128 a[224:227], v226 offset:49152
    v_mfma_f32_16x16x32_bf16 v[20:23], v[148:151], a[232:235], v[20:23]
    buffer_load_dwordx4 v[120:123], v224, s[36:39], s52 offen offset:2048 sc1
    v_mfma_f32_16x16x32_bf16 v[28:31], v[148:151], a[236:239], v[28:31]
    ds_read_b128 a[228:231], v226 offset:51200
    v_mfma_f32_16x16x32_bf16 v[24:27], v[144:147], a[236:239], v[24:27]
    s_waitcnt lgkmcnt(4)
    v_mfma_f32_16x16x32_bf16 v[32:35], v[144:147], a[240:243], v[32:35]
    ds_read_b128 a[232:235], v226 offset:53248
    v_mfma_f32_16x16x32_bf16 v[36:39], v[148:151], a[240:243], v[36:39]
    buffer_load_dwordx4 v252, s[32:35], s98 offen offset:2048 lds
    v_mfma_f32_16x16x32_bf16 v[44:47], v[148:151], a[244:247], v[44:47]
    ds_read_b128 a[236:239], v226 offset:55296
    v_mfma_f32_16x16x32_bf16 v[40:43], v[144:147], a[244:247], v[40:43]
    s_waitcnt lgkmcnt(4)
    v_mfma_f32_16x16x32_bf16 v[48:51], v[144:147], a[248:251], v[48:51]
    ds_read_b128 a[240:243], v226 offset:57344
    v_mfma_f32_16x16x32_bf16 v[52:55], v[148:151], a[248:251], v[52:55]
    buffer_load_dwordx4 v[124:127], v224, s[36:39], s52 offen offset:3072 sc1
    s_xor_b32 s52, s52, 12288
    v_mfma_f32_16x16x32_bf16 v[60:63], v[148:151], a[252:255], v[60:63]
    ds_read_b128 a[244:247], v226 offset:59392
    v_mfma_f32_16x16x32_bf16 v[56:59], v[144:147], a[252:255], v[56:59]
    s_waitcnt lgkmcnt(4)
    v_mfma_f32_16x16x32_bf16 v[0:3], v[152:155], a[224:227], v[0:3]
    ds_read_b128 a[248:251], v226 offset:61440
    v_mfma_f32_16x16x32_bf16 v[4:7], v[156:159], a[224:227], v[4:7]
    buffer_load_dwordx4 v253, s[32:35], s98 offen offset:3072 lds
    v_mfma_f32_16x16x32_bf16 v[12:15], v[156:159], a[228:231], v[12:15]
    ds_read_b128 a[252:255], v226 offset:63488
    v_mfma_f32_16x16x32_bf16 v[8:11], v[152:155], a[228:231], v[8:11]
    s_waitcnt vmcnt(24)
    s_barrier
    buffer_store_dword v244, v246, s[44:47], s50 offen sc1
    s_waitcnt lgkmcnt(4)
    v_mfma_f32_16x16x32_bf16 v[16:19], v[152:155], a[232:235], v[16:19]
    ds_read_b128 a[224:227], v227 offset:0
    v_mfma_f32_16x16x32_bf16 v[20:23], v[156:159], a[232:235], v[20:23]
    s_xor_b32 s98, s98, 384
    s_add_u32 m0, s99, 32768
    buffer_load_dwordx4 v[128:131], v224, s[36:39], s52 offen offset:0 sc1
    v_mfma_f32_16x16x32_bf16 v[28:31], v[156:159], a[236:239], v[28:31]
    ds_read_b128 a[228:231], v227 offset:2048
    v_mfma_f32_16x16x32_bf16 v[24:27], v[152:155], a[236:239], v[24:27]
    s_waitcnt lgkmcnt(4)
    v_mfma_f32_16x16x32_bf16 v[32:35], v[152:155], a[240:243], v[32:35]
    ds_read_b128 a[232:235], v227 offset:4096
    v_mfma_f32_16x16x32_bf16 v[36:39], v[156:159], a[240:243], v[36:39]
    buffer_load_dwordx4 v250, s[32:35], s98 offen offset:0 lds
    v_mfma_f32_16x16x32_bf16 v[44:47], v[156:159], a[244:247], v[44:47]
    ds_read_b128 a[236:239], v227 offset:6144
    v_mfma_f32_16x16x32_bf16 v[40:43], v[152:155], a[244:247], v[40:43]
    s_waitcnt lgkmcnt(4)
    v_mfma_f32_16x16x32_bf16 v[48:51], v[152:155], a[248:251], v[48:51]
    ds_read_b128 a[240:243], v227 offset:8192
    v_mfma_f32_16x16x32_bf16 v[52:55], v[156:159], a[248:251], v[52:55]
    buffer_load_dwordx4 v[132:135], v224, s[36:39], s52 offen offset:1024 sc1
    v_mfma_f32_16x16x32_bf16 v[60:63], v[156:159], a[252:255], v[60:63]
    ds_read_b128 a[244:247], v227 offset:10240
    v_mfma_f32_16x16x32_bf16 v[56:59], v[152:155], a[252:255], v[56:59]
    s_waitcnt lgkmcnt(4)
    v_mfma_f32_16x16x32_bf16 v[0:3], v[160:163], a[224:227], v[0:3]
    ds_read_b128 a[248:251], v227 offset:12288
    v_mfma_f32_16x16x32_bf16 v[4:7], v[164:167], a[224:227], v[4:7]
    buffer_load_dwordx4 v251, s[32:35], s98 offen offset:1024 lds
    v_mfma_f32_16x16x32_bf16 v[12:15], v[164:167], a[228:231], v[12:15]
    ds_read_b128 a[252:255], v227 offset:14336
    v_mfma_f32_16x16x32_bf16 v[8:11], v[160:163], a[228:231], v[8:11]
    s_waitcnt lgkmcnt(4)
    v_mfma_f32_16x16x32_bf16 v[16:19], v[160:163], a[232:235], v[16:19]
    ds_read_b128 a[224:227], v228 offset:0
    v_mfma_f32_16x16x32_bf16 v[20:23], v[164:167], a[232:235], v[20:23]
    buffer_load_dwordx4 v[136:139], v224, s[36:39], s52 offen offset:2048 sc1
    v_mfma_f32_16x16x32_bf16 v[28:31], v[164:167], a[236:239], v[28:31]
    ds_read_b128 a[228:231], v228 offset:2048
    v_mfma_f32_16x16x32_bf16 v[24:27], v[160:163], a[236:239], v[24:27]
    s_waitcnt lgkmcnt(4)
    v_mfma_f32_16x16x32_bf16 v[32:35], v[160:163], a[240:243], v[32:35]
    ds_read_b128 a[232:235], v228 offset:4096
    v_mfma_f32_16x16x32_bf16 v[36:39], v[164:167], a[240:243], v[36:39]
    buffer_load_dwordx4 v252, s[32:35], s98 offen offset:2048 lds
    v_mfma_f32_16x16x32_bf16 v[44:47], v[164:167], a[244:247], v[44:47]
    ds_read_b128 a[236:239], v228 offset:6144
    v_mfma_f32_16x16x32_bf16 v[40:43], v[160:163], a[244:247], v[40:43]
    s_waitcnt lgkmcnt(4)
    v_mfma_f32_16x16x32_bf16 v[48:51], v[160:163], a[248:251], v[48:51]
    ds_read_b128 a[240:243], v228 offset:8192
    v_mfma_f32_16x16x32_bf16 v[52:55], v[164:167], a[248:251], v[52:55]
    buffer_load_dwordx4 v[140:143], v224, s[36:39], s52 offen offset:3072 sc1
    s_xor_b32 s52, s52, 4096
    v_mfma_f32_16x16x32_bf16 v[60:63], v[164:167], a[252:255], v[60:63]
    ds_read_b128 a[244:247], v228 offset:10240
    v_mfma_f32_16x16x32_bf16 v[56:59], v[160:163], a[252:255], v[56:59]
    s_waitcnt lgkmcnt(4)
    v_mfma_f32_16x16x32_bf16 v[0:3], v[168:171], a[224:227], v[0:3]
    ds_read_b128 a[248:251], v228 offset:12288
    v_mfma_f32_16x16x32_bf16 v[4:7], v[172:175], a[224:227], v[4:7]
    buffer_load_dwordx4 v253, s[32:35], s98 offen offset:3072 lds
    v_mfma_f32_16x16x32_bf16 v[12:15], v[172:175], a[228:231], v[12:15]
    ds_read_b128 a[252:255], v228 offset:14336
    v_mfma_f32_16x16x32_bf16 v[8:11], v[168:171], a[228:231], v[8:11]
    s_waitcnt vmcnt(25)
    s_barrier
    s_waitcnt lgkmcnt(4)
    v_mfma_f32_16x16x32_bf16 v[16:19], v[168:171], a[232:235], v[16:19]
    ds_read_b128 a[224:227], v227 offset:16384
    v_mfma_f32_16x16x32_bf16 v[20:23], v[172:175], a[232:235], v[20:23]
    s_xor_b32 s98, s98, 128
    s_add_u32 m0, s99, 49152
    buffer_load_dwordx4 v[144:147], v224, s[36:39], s52 offen offset:0 sc1
    v_mfma_f32_16x16x32_bf16 v[28:31], v[172:175], a[236:239], v[28:31]
    ds_read_b128 a[228:231], v227 offset:18432
    v_mfma_f32_16x16x32_bf16 v[24:27], v[168:171], a[236:239], v[24:27]
    s_waitcnt lgkmcnt(4)
    v_mfma_f32_16x16x32_bf16 v[32:35], v[168:171], a[240:243], v[32:35]
    ds_read_b128 a[232:235], v227 offset:20480
    v_mfma_f32_16x16x32_bf16 v[36:39], v[172:175], a[240:243], v[36:39]
    buffer_load_dwordx4 v250, s[32:35], s98 offen offset:0 lds
    v_mfma_f32_16x16x32_bf16 v[44:47], v[172:175], a[244:247], v[44:47]
    ds_read_b128 a[236:239], v227 offset:22528
    v_mfma_f32_16x16x32_bf16 v[40:43], v[168:171], a[244:247], v[40:43]
    s_waitcnt lgkmcnt(4)
    v_mfma_f32_16x16x32_bf16 v[48:51], v[168:171], a[248:251], v[48:51]
    ds_read_b128 a[240:243], v227 offset:24576
    v_mfma_f32_16x16x32_bf16 v[52:55], v[172:175], a[248:251], v[52:55]
    buffer_load_dwordx4 v[148:151], v224, s[36:39], s52 offen offset:1024 sc1
    v_mfma_f32_16x16x32_bf16 v[60:63], v[172:175], a[252:255], v[60:63]
    ds_read_b128 a[244:247], v227 offset:26624
    v_mfma_f32_16x16x32_bf16 v[56:59], v[168:171], a[252:255], v[56:59]
    s_waitcnt lgkmcnt(4)
    v_mfma_f32_16x16x32_bf16 v[0:3], v[176:179], a[224:227], v[0:3]
    ds_read_b128 a[248:251], v227 offset:28672
    v_mfma_f32_16x16x32_bf16 v[4:7], v[180:183], a[224:227], v[4:7]
    buffer_load_dwordx4 v251, s[32:35], s98 offen offset:1024 lds
    v_mfma_f32_16x16x32_bf16 v[12:15], v[180:183], a[228:231], v[12:15]
    ds_read_b128 a[252:255], v227 offset:30720
    v_mfma_f32_16x16x32_bf16 v[8:11], v[176:179], a[228:231], v[8:11]
    s_waitcnt lgkmcnt(4)
    v_mfma_f32_16x16x32_bf16 v[16:19], v[176:179], a[232:235], v[16:19]
    ds_read_b128 a[224:227], v228 offset:16384
    v_mfma_f32_16x16x32_bf16 v[20:23], v[180:183], a[232:235], v[20:23]
    buffer_load_dwordx4 v[152:155], v224, s[36:39], s52 offen offset:2048 sc1
    v_mfma_f32_16x16x32_bf16 v[28:31], v[180:183], a[236:239], v[28:31]
    ds_read_b128 a[228:231], v228 offset:18432
    v_mfma_f32_16x16x32_bf16 v[24:27], v[176:179], a[236:239], v[24:27]
    s_waitcnt lgkmcnt(4)
    v_mfma_f32_16x16x32_bf16 v[32:35], v[176:179], a[240:243], v[32:35]
    ds_read_b128 a[232:235], v228 offset:20480
    v_mfma_f32_16x16x32_bf16 v[36:39], v[180:183], a[240:243], v[36:39]
    buffer_load_dwordx4 v252, s[32:35], s98 offen offset:2048 lds
    v_mfma_f32_16x16x32_bf16 v[44:47], v[180:183], a[244:247], v[44:47]
    ds_read_b128 a[236:239], v228 offset:22528
    v_mfma_f32_16x16x32_bf16 v[40:43], v[176:179], a[244:247], v[40:43]
    s_waitcnt lgkmcnt(4)
    v_mfma_f32_16x16x32_bf16 v[48:51], v[176:179], a[248:251], v[48:51]
    ds_read_b128 a[240:243], v228 offset:24576
    v_mfma_f32_16x16x32_bf16 v[52:55], v[180:183], a[248:251], v[52:55]
    buffer_load_dwordx4 v[156:159], v224, s[36:39], s52 offen offset:3072 sc1
    s_xor_b32 s52, s52, 126976
    v_mfma_f32_16x16x32_bf16 v[60:63], v[180:183], a[252:255], v[60:63]
    ds_read_b128 a[244:247], v228 offset:26624
    v_mfma_f32_16x16x32_bf16 v[56:59], v[176:179], a[252:255], v[56:59]
    s_waitcnt lgkmcnt(4)
    v_mfma_f32_16x16x32_bf16 v[0:3], v[184:187], a[224:227], v[0:3]
    ds_read_b128 a[248:251], v228 offset:28672
    v_mfma_f32_16x16x32_bf16 v[4:7], v[188:191], a[224:227], v[4:7]
    buffer_load_dwordx4 v253, s[32:35], s98 offen offset:3072 lds
    v_mfma_f32_16x16x32_bf16 v[12:15], v[188:191], a[228:231], v[12:15]
    ds_read_b128 a[252:255], v228 offset:30720
    v_mfma_f32_16x16x32_bf16 v[8:11], v[184:187], a[228:231], v[8:11]
    s_waitcnt vmcnt(25)
    s_barrier
    s_waitcnt lgkmcnt(4)
    v_mfma_f32_16x16x32_bf16 v[16:19], v[184:187], a[232:235], v[16:19]
    ds_read_b128 a[224:227], v225 offset:0
    v_mfma_f32_16x16x32_bf16 v[20:23], v[188:191], a[232:235], v[20:23]
    s_xor_b32 s98, s98, 3968
    s_add_u32 m0, s99, 65536
    buffer_load_dwordx4 v[160:163], v224, s[36:39], s52 offen offset:0 sc1
    v_mfma_f32_16x16x32_bf16 v[28:31], v[188:191], a[236:239], v[28:31]
    ds_read_b128 a[228:231], v225 offset:2048
    v_mfma_f32_16x16x32_bf16 v[24:27], v[184:187], a[236:239], v[24:27]
    s_waitcnt lgkmcnt(4)
    v_mfma_f32_16x16x32_bf16 v[32:35], v[184:187], a[240:243], v[32:35]
    ds_read_b128 a[232:235], v225 offset:4096
    v_mfma_f32_16x16x32_bf16 v[36:39], v[188:191], a[240:243], v[36:39]
    buffer_load_dwordx4 v250, s[32:35], s98 offen offset:0 lds
    v_mfma_f32_16x16x32_bf16 v[44:47], v[188:191], a[244:247], v[44:47]
    ds_read_b128 a[236:239], v225 offset:6144
    v_mfma_f32_16x16x32_bf16 v[40:43], v[184:187], a[244:247], v[40:43]
    s_waitcnt lgkmcnt(4)
    v_mfma_f32_16x16x32_bf16 v[48:51], v[184:187], a[248:251], v[48:51]
    s_branch L_po_K_2
.p2align 12
L_pg_K_2:
    s_branch L_pg_K_5
L_po_K_2:
    ds_read_b128 a[240:243], v225 offset:8192
    v_mfma_f32_16x16x32_bf16 v[52:55], v[188:191], a[248:251], v[52:55]
    buffer_load_dwordx4 v[164:167], v224, s[36:39], s52 offen offset:1024 sc1
    v_mfma_f32_16x16x32_bf16 v[60:63], v[188:191], a[252:255], v[60:63]
    ds_read_b128 a[244:247], v225 offset:10240
    v_mfma_f32_16x16x32_bf16 v[56:59], v[184:187], a[252:255], v[56:59]
    s_waitcnt lgkmcnt(4)
    v_mfma_f32_16x16x32_bf16 v[0:3], v[96:99], a[224:227], v[0:3]
    ds_read_b128 a[248:251], v225 offset:12288
    v_mfma_f32_16x16x32_bf16 v[4:7], v[100:103], a[224:227], v[4:7]
    buffer_load_dwordx4 v251, s[32:35], s98 offen offset:1024 lds
    v_mfma_f32_16x16x32_bf16 v[12:15], v[100:103], a[228:231], v[12:15]
    ds_read_b128 a[252:255], v225 offset:14336
    v_mfma_f32_16x16x32_bf16 v[8:11], v[96:99], a[228:231], v[8:11]
    s_waitcnt lgkmcnt(4)
    v_mfma_f32_16x16x32_bf16 v[16:19], v[96:99], a[232:235], v[16:19]
    ds_read_b128 a[224:227], v226 offset:0
    v_mfma_f32_16x16x32_bf16 v[20:23], v[100:103], a[232:235], v[20:23]
    buffer_load_dwordx4 v[168:171], v224, s[36:39], s52 offen offset:2048 sc1
    v_mfma_f32_16x16x32_bf16 v[28:31], v[100:103], a[236:239], v[28:31]
    ds_read_b128 a[228:231], v226 offset:2048
    v_mfma_f32_16x16x32_bf16 v[24:27], v[96:99], a[236:239], v[24:27]
    s_waitcnt lgkmcnt(4)
    v_mfma_f32_16x16x32_bf16 v[32:35], v[96:99], a[240:243], v[32:35]
    ds_read_b128 a[232:235], v226 offset:4096
    v_mfma_f32_16x16x32_bf16 v[36:39], v[100:103], a[240:243], v[36:39]
    buffer_load_dwordx4 v252, s[32:35], s98 offen offset:2048 lds
    v_mfma_f32_16x16x32_bf16 v[44:47], v[100:103], a[244:247], v[44:47]
    ds_read_b128 a[236:239], v226 offset:6144
    v_mfma_f32_16x16x32_bf16 v[40:43], v[96:99], a[244:247], v[40:43]
    s_waitcnt lgkmcnt(4)
    v_mfma_f32_16x16x32_bf16 v[48:51], v[96:99], a[248:251], v[48:51]
    ds_read_b128 a[240:243], v226 offset:8192
    v_mfma_f32_16x16x32_bf16 v[52:55], v[100:103], a[248:251], v[52:55]
    buffer_load_dwordx4 v[172:175], v224, s[36:39], s52 offen offset:3072 sc1
    s_xor_b32 s52, s52, 4096
    v_mfma_f32_16x16x32_bf16 v[60:63], v[100:103], a[252:255], v[60:63]
    ds_read_b128 a[244:247], v226 offset:10240
    v_mfma_f32_16x16x32_bf16 v[56:59], v[96:99], a[252:255], v[56:59]
    s_waitcnt lgkmcnt(4)
    v_mfma_f32_16x16x32_bf16 v[0:3], v[104:107], a[224:227], v[0:3]
    ds_read_b128 a[248:251], v226 offset:12288
    v_mfma_f32_16x16x32_bf16 v[4:7], v[108:111], a[224:227], v[4:7]
    buffer_load_dwordx4 v253, s[32:35], s98 offen offset:3072 lds
    v_mfma_f32_16x16x32_bf16 v[12:15], v[108:111], a[228:231], v[12:15]
    ds_read_b128 a[252:255], v226 offset:14336
    v_mfma_f32_16x16x32_bf16 v[8:11], v[104:107], a[228:231], v[8:11]
    s_waitcnt vmcnt(25)
    s_barrier
    s_waitcnt lgkmcnt(4)
    v_mfma_f32_16x16x32_bf16 v[16:19], v[104:107], a[232:235], v[16:19]
    ds_read_b128 a[224:227], v225 offset:16384
    v_mfma_f32_16x16x32_bf16 v[20:23], v[108:111], a[232:235], v[20:23]
    s_xor_b32 s98, s98, 128
    s_add_u32 m0, s99, 81920
    buffer_load_dwordx4 v[176:179], v224, s[36:39], s52 offen offset:0 sc1
    v_mfma_f32_16x16x32_bf16 v[28:31], v[108:111], a[236:239], v[28:31]
    ds_read_b128 a[228:231], v225 offset:18432
    v_mfma_f32_16x16x32_bf16 v[24:27], v[104:107], a[236:239], v[24:27]
    s_waitcnt lgkmcnt(4)
    v_mfma_f32_16x16x32_bf16 v[32:35], v[104:107], a[240:243], v[32:35]
    ds_read_b128 a[232:235], v225 offset:20480
    v_mfma_f32_16x16x32_bf16 v[36:39], v[108:111], a[240:243], v[36:39]
    buffer_load_dwordx4 v250, s[32:35], s98 offen offset:0 lds
    v_mfma_f32_16x16x32_bf16 v[44:47], v[108:111], a[244:247], v[44:47]
    ds_read_b128 a[236:239], v225 offset:22528
    v_mfma_f32_16x16x32_bf16 v[40:43], v[104:107], a[244:247], v[40:43]
    s_waitcnt lgkmcnt(4)
    v_mfma_f32_16x16x32_bf16 v[48:51], v[104:107], a[248:251], v[48:51]
    ds_read_b128 a[240:243], v225 offset:24576
    v_mfma_f32_16x16x32_bf16 v[52:55], v[108:111], a[248:251], v[52:55]
    buffer_load_dwordx4 v[180:183], v224, s[36:39], s52 offen offset:1024 sc1
    v_mfma_f32_16x16x32_bf16 v[60:63], v[108:111], a[252:255], v[60:63]
    ds_read_b128 a[244:247], v225 offset:26624
    v_mfma_f32_16x16x32_bf16 v[56:59], v[104:107], a[252:255], v[56:59]
    s_waitcnt lgkmcnt(4)
    v_mfma_f32_16x16x32_bf16 v[0:3], v[112:115], a[224:227], v[0:3]
    ds_read_b128 a[248:251], v225 offset:28672
    v_mfma_f32_16x16x32_bf16 v[4:7], v[116:119], a[224:227], v[4:7]
    buffer_load_dwordx4 v251, s[32:35], s98 offen offset:1024 lds
    v_mfma_f32_16x16x32_bf16 v[12:15], v[116:119], a[228:231], v[12:15]
    ds_read_b128 a[252:255], v225 offset:30720
    v_mfma_f32_16x16x32_bf16 v[8:11], v[112:115], a[228:231], v[8:11]
    s_waitcnt lgkmcnt(4)
    v_mfma_f32_16x16x32_bf16 v[16:19], v[112:115], a[232:235], v[16:19]
    ds_read_b128 a[224:227], v226 offset:16384
    v_mfma_f32_16x16x32_bf16 v[20:23], v[116:119], a[232:235], v[20:23]
    buffer_load_dwordx4 v[184:187], v224, s[36:39], s52 offen offset:2048 sc1
    v_mfma_f32_16x16x32_bf16 v[28:31], v[116:119], a[236:239], v[28:31]
    ds_read_b128 a[228:231], v226 offset:18432
    v_mfma_f32_16x16x32_bf16 v[24:27], v[112:115], a[236:239], v[24:27]
    s_waitcnt lgkmcnt(4)
    v_mfma_f32_16x16x32_bf16 v[32:35], v[112:115], a[240:243], v[32:35]
    ds_read_b128 a[232:235], v226 offset:20480
    v_mfma_f32_16x16x32_bf16 v[36:39], v[116:119], a[240:243], v[36:39]
    buffer_load_dwordx4 v252, s[32:35], s98 offen offset:2048 lds
    v_mfma_f32_16x16x32_bf16 v[44:47], v[116:119], a[244:247], v[44:47]
    ds_read_b128 a[236:239], v226 offset:22528
    v_mfma_f32_16x16x32_bf16 v[40:43], v[112:115], a[244:247], v[40:43]
    s_waitcnt lgkmcnt(4)
    v_mfma_f32_16x16x32_bf16 v[48:51], v[112:115], a[248:251], v[48:51]
    ds_read_b128 a[240:243], v226 offset:24576
    v_mfma_f32_16x16x32_bf16 v[52:55], v[116:119], a[248:251], v[52:55]
    buffer_load_dwordx4 v[188:191], v224, s[36:39], s52 offen offset:3072 sc1
    s_xor_b32 s52, s52, 12288
    v_mfma_f32_16x16x32_bf16 v[60:63], v[116:119], a[252:255], v[60:63]
    ds_read_b128 a[244:247], v226 offset:26624
    v_mfma_f32_16x16x32_bf16 v[56:59], v[112:115], a[252:255], v[56:59]
    s_waitcnt lgkmcnt(4)
    v_mfma_f32_16x16x32_bf16 v[0:3], v[120:123], a[224:227], v[0:3]
    ds_read_b128 a[248:251], v226 offset:28672
    v_mfma_f32_16x16x32_bf16 v[4:7], v[124:127], a[224:227], v[4:7]
    buffer_load_dwordx4 v253, s[32:35], s98 offen offset:3072 lds
    v_mfma_f32_16x16x32_bf16 v[12:15], v[124:127], a[228:231], v[12:15]
    ds_read_b128 a[252:255], v226 offset:30720
    v_mfma_f32_16x16x32_bf16 v[8:11], v[120:123], a[228:231], v[8:11]
    s_waitcnt vmcnt(24)
    s_barrier
    s_waitcnt lgkmcnt(4)
    v_mfma_f32_16x16x32_bf16 v[16:19], v[120:123], a[232:235], v[16:19]
    ds_read_b128 a[224:227], v225 offset:32768
    v_mfma_f32_16x16x32_bf16 v[20:23], v[124:127], a[232:235], v[20:23]
    s_xor_b32 s98, s98, 384
    s_add_u32 m0, s99, 0
    buffer_load_dwordx4 v[96:99], v224, s[36:39], s52 offen offset:0 sc1
    v_mfma_f32_16x16x32_bf16 v[28:31], v[124:127], a[236:239], v[28:31]
    ds_read_b128 a[228:231], v225 offset:34816
    v_mfma_f32_16x16x32_bf16 v[24:27], v[120:123], a[236:239], v[24:27]
    s_waitcnt lgkmcnt(4)
    v_mfma_f32_16x16x32_bf16 v[32:35], v[120:123], a[240:243], v[32:35]
    ds_read_b128 a[232:235], v225 offset:36864
    v_mfma_f32_16x16x32_bf16 v[36:39], v[124:127], a[240:243], v[36:39]
    buffer_load_dwordx4 v250, s[32:35], s98 offen offset:0 lds
    v_mfma_f32_16x16x32_bf16 v[44:47], v[124:127], a[244:247], v[44:47]
    ds_read_b128 a[236:239], v225 offset:38912
    v_mfma_f32_16x16x32_bf16 v[40:43], v[120:123], a[244:247], v[40:43]
    s_waitcnt lgkmcnt(4)
    v_mfma_f32_16x16x32_bf16 v[48:51], v[120:123], a[248:251], v[48:51]
    ds_read_b128 a[240:243], v225 offset:40960
    v_mfma_f32_16x16x32_bf16 v[52:55], v[124:127], a[248:251], v[52:55]
    buffer_load_dwordx4 v[100:103], v224, s[36:39], s52 offen offset:1024 sc1
    v_mfma_f32_16x16x32_bf16 v[60:63], v[124:127], a[252:255], v[60:63]
    ds_read_b128 a[244:247], v225 offset:43008
    v_mfma_f32_16x16x32_bf16 v[56:59], v[120:123], a[252:255], v[56:59]
    s_waitcnt lgkmcnt(4)
    v_mfma_f32_16x16x32_bf16 v[0:3], v[128:131], a[224:227], v[0:3]
    ds_read_b128 a[248:251], v225 offset:45056
    v_mfma_f32_16x16x32_bf16 v[4:7], v[132:135], a[224:227], v[4:7]
    buffer_load_dwordx4 v251, s[32:35], s98 offen offset:1024 lds
    v_mfma_f32_16x16x32_bf16 v[12:15], v[132:135], a[228:231], v[12:15]
    ds_read_b128 a[252:255], v225 offset:47104
    v_mfma_f32_16x16x32_bf16 v[8:11], v[128:131], a[228:231], v[8:11]
    s_waitcnt lgkmcnt(4)
    v_mfma_f32_16x16x32_bf16 v[16:19], v[128:131], a[232:235], v[16:19]
    ds_read_b128 a[224:227], v226 offset:32768
    v_mfma_f32_16x16x32_bf16 v[20:23], v[132:135], a[232:235], v[20:23]
    buffer_load_dwordx4 v[104:107], v224, s[36:39], s52 offen offset:2048 sc1
    v_mfma_f32_16x16x32_bf16 v[28:31], v[132:135], a[236:239], v[28:31]
    ds_read_b128 a[228:231], v226 offset:34816
    v_mfma_f32_16x16x32_bf16 v[24:27], v[128:131], a[236:239], v[24:27]
    s_waitcnt lgkmcnt(4)
    v_mfma_f32_16x16x32_bf16 v[32:35], v[128:131], a[240:243], v[32:35]
    ds_read_b128 a[232:235], v226 offset:36864
    v_mfma_f32_16x16x32_bf16 v[36:39], v[132:135], a[240:243], v[36:39]
    buffer_load_dwordx4 v252, s[32:35], s98 offen offset:2048 lds
    v_mfma_f32_16x16x32_bf16 v[44:47], v[132:135], a[244:247], v[44:47]
    ds_read_b128 a[236:239], v226 offset:38912
    v_mfma_f32_16x16x32_bf16 v[40:43], v[128:131], a[244:247], v[40:43]
    s_waitcnt lgkmcnt(4)
    v_mfma_f32_16x16x32_bf16 v[48:51], v[128:131], a[248:251], v[48:51]
    ds_read_b128 a[240:243], v226 offset:40960
    v_mfma_f32_16x16x32_bf16 v[52:55], v[132:135], a[248:251], v[52:55]
    buffer_load_dwordx4 v[108:111], v224, s[36:39], s52 offen offset:3072 sc1
    s_xor_b32 s52, s52, 24576
    v_mfma_f32_16x16x32_bf16 v[60:63], v[132:135], a[252:255], v[60:63]
    ds_read_b128 a[244:247], v226 offset:43008
    v_mfma_f32_16x16x32_bf16 v[56:59], v[128:131], a[252:255], v[56:59]
    s_waitcnt lgkmcnt(4)
    v_mfma_f32_16x16x32_bf16 v[0:3], v[136:139], a[224:227], v[0:3]
    ds_read_b128 a[248:251], v226 offset:45056
    v_mfma_f32_16x16x32_bf16 v[4:7], v[140:143], a[224:227], v[4:7]
    buffer_load_dwordx4 v253, s[32:35], s98 offen offset:3072 lds
    v_mfma_f32_16x16x32_bf16 v[12:15], v[140:143], a[228:231], v[12:15]
    ds_read_b128 a[252:255], v226 offset:47104
    v_mfma_f32_16x16x32_bf16 v[8:11], v[136:139], a[228:231], v[8:11]
    s_waitcnt vmcnt(24)
    s_barrier
    s_waitcnt lgkmcnt(4)
    v_mfma_f32_16x16x32_bf16 v[16:19], v[136:139], a[232:235], v[16:19]
    ds_read_b128 a[224:227], v225 offset:49152
    v_mfma_f32_16x16x32_bf16 v[20:23], v[140:143], a[232:235], v[20:23]
    s_xor_b32 s98, s98, 768
    s_add_u32 m0, s99, 16384
    buffer_load_dwordx4 v[112:115], v224, s[36:39], s52 offen offset:0 sc1
    v_mfma_f32_16x16x32_bf16 v[28:31], v[140:143], a[236:239], v[28:31]
    ds_read_b128 a[228:231], v225 offset:51200
    v_mfma_f32_16x16x32_bf16 v[24:27], v[136:139], a[236:239], v[24:27]
    s_waitcnt lgkmcnt(4)
    v_mfma_f32_16x16x32_bf16 v[32:35], v[136:139], a[240:243], v[32:35]
    ds_read_b128 a[232:235], v225 offset:53248
    v_mfma_f32_16x16x32_bf16 v[36:39], v[140:143], a[240:243], v[36:39]
    buffer_load_dwordx4 v250, s[32:35], s98 offen offset:0 lds
    v_mfma_f32_16x16x32_bf16 v[44:47], v[140:143], a[244:247], v[44:47]
    ds_read_b128 a[236:239], v225 offset:55296
    v_mfma_f32_16x16x32_bf16 v[40:43], v[136:139], a[244:247], v[40:43]
    s_waitcnt lgkmcnt(4)
    v_mfma_f32_16x16x32_bf16 v[48:51], v[136:139], a[248:251], v[48:51]
    ds_read_b128 a[240:243], v225 offset:57344
    v_mfma_f32_16x16x32_bf16 v[52:55], v[140:143], a[248:251], v[52:55]
    buffer_load_dwordx4 v[116:119], v224, s[36:39], s52 offen offset:1024 sc1
    v_mfma_f32_16x16x32_bf16 v[60:63], v[140:143], a[252:255], v[60:63]
    ds_read_b128 a[244:247], v225 offset:59392
    v_mfma_f32_16x16x32_bf16 v[56:59], v[136:139], a[252:255], v[56:59]
    s_waitcnt lgkmcnt(4)
    v_mfma_f32_16x16x32_bf16 v[0:3], v[144:147], a[224:227], v[0:3]
    ds_read_b128 a[248:251], v225 offset:61440
    v_mfma_f32_16x16x32_bf16 v[4:7], v[148:151], a[224:227], v[4:7]
    buffer_load_dwordx4 v251, s[32:35], s98 offen offset:1024 lds
    v_mfma_f32_16x16x32_bf16 v[12:15], v[148:151], a[228:231], v[12:15]
    ds_read_b128 a[252:255], v225 offset:63488
    v_mfma_f32_16x16x32_bf16 v[8:11], v[144:147], a[228:231], v[8:11]
    s_waitcnt lgkmcnt(4)
    v_mfma_f32_16x16x32_bf16 v[16:19], v[144:147], a[232:235], v[16:19]
    ds_read_b128 a[224:227], v226 offset:49152
    v_mfma_f32_16x16x32_bf16 v[20:23], v[148:151], a[232:235], v[20:23]
    buffer_load_dwordx4 v[120:123], v224, s[36:39], s52 offen offset:2048 sc1
    v_mfma_f32_16x16x32_bf16 v[28:31], v[148:151], a[236:239], v[28:31]
    ds_read_b128 a[228:231], v226 offset:51200
    v_mfma_f32_16x16x32_bf16 v[24:27], v[144:147], a[236:239], v[24:27]
    s_waitcnt lgkmcnt(4)
    v_mfma_f32_16x16x32_bf16 v[32:35], v[144:147], a[240:243], v[32:35]
    ds_read_b128 a[232:235], v226 offset:53248
    v_mfma_f32_16x16x32_bf16 v[36:39], v[148:151], a[240:243], v[36:39]
    buffer_load_dwordx4 v252, s[32:35], s98 offen offset:2048 lds
    v_mfma_f32_16x16x32_bf16 v[44:47], v[148:151], a[244:247], v[44:47]
    ds_read_b128 a[236:239], v226 offset:55296
    v_mfma_f32_16x16x32_bf16 v[40:43], v[144:147], a[244:247], v[40:43]
    s_waitcnt lgkmcnt(4)
    v_mfma_f32_16x16x32_bf16 v[48:51], v[144:147], a[248:251], v[48:51]
    ds_read_b128 a[240:243], v226 offset:57344
    v_mfma_f32_16x16x32_bf16 v[52:55], v[148:151], a[248:251], v[52:55]
    buffer_load_dwordx4 v[124:127], v224, s[36:39], s52 offen offset:3072 sc1
    s_xor_b32 s52, s52, 4096
    v_mfma_f32_16x16x32_bf16 v[60:63], v[148:151], a[252:255], v[60:63]
    ds_read_b128 a[244:247], v226 offset:59392
    v_mfma_f32_16x16x32_bf16 v[56:59], v[144:147], a[252:255], v[56:59]
    s_waitcnt lgkmcnt(4)
    v_mfma_f32_16x16x32_bf16 v[0:3], v[152:155], a[224:227], v[0:3]
    ds_read_b128 a[248:251], v226 offset:61440
    v_mfma_f32_16x16x32_bf16 v[4:7], v[156:159], a[224:227], v[4:7]
    buffer_load_dwordx4 v253, s[32:35], s98 offen offset:3072 lds
    v_mfma_f32_16x16x32_bf16 v[12:15], v[156:159], a[228:231], v[12:15]
    ds_read_b128 a[252:255], v226 offset:63488
    v_mfma_f32_16x16x32_bf16 v[8:11], v[152:155], a[228:231], v[8:11]
    s_waitcnt vmcnt(24)
    s_barrier
    s_waitcnt lgkmcnt(4)
    v_mfma_f32_16x16x32_bf16 v[16:19], v[152:155], a[232:235], v[16:19]
    ds_read_b128 a[224:227], v227 offset:0
    v_mfma_f32_16x16x32_bf16 v[20:23], v[156:159], a[232:235], v[20:23]
    s_xor_b32 s98, s98, 128
    s_add_u32 m0, s99, 32768
    buffer_load_dwordx4 v[128:131], v224, s[36:39], s52 offen offset:0 sc1
    v_mfma_f32_16x16x32_bf16 v[28:31], v[156:159], a[236:239], v[28:31]
    ds_read_b128 a[228:231], v227 offset:2048
    v_mfma_f32_16x16x32_bf16 v[24:27], v[152:155], a[236:239], v[24:27]
    s_waitcnt lgkmcnt(4)
    v_mfma_f32_16x16x32_bf16 v[32:35], v[152:155], a[240:243], v[32:35]
    ds_read_b128 a[232:235], v227 offset:4096
    v_mfma_f32_16x16x32_bf16 v[36:39], v[156:159], a[240:243], v[36:39]
    buffer_load_dwordx4 v250, s[32:35], s98 offen offset:0 lds
    v_mfma_f32_16x16x32_bf16 v[44:47], v[156:159], a[244:247], v[44:47]
    ds_read_b128 a[236:239], v227 offset:6144
    v_mfma_f32_16x16x32_bf16 v[40:43], v[152:155], a[244:247], v[40:43]
    s_waitcnt lgkmcnt(4)
    v_mfma_f32_16x16x32_bf16 v[48:51], v[152:155], a[248:251], v[48:51]
    ds_read_b128 a[240:243], v227 offset:8192
    v_mfma_f32_16x16x32_bf16 v[52:55], v[156:159], a[248:251], v[52:55]
    buffer_load_dwordx4 v[132:135], v224, s[36:39], s52 offen offset:1024 sc1
    v_mfma_f32_16x16x32_bf16 v[60:63], v[156:159], a[252:255], v[60:63]
    ds_read_b128 a[244:247], v227 offset:10240
    v_mfma_f32_16x16x32_bf16 v[56:59], v[152:155], a[252:255], v[56:59]
    s_waitcnt lgkmcnt(4)
    v_mfma_f32_16x16x32_bf16 v[0:3], v[160:163], a[224:227], v[0:3]
    ds_read_b128 a[248:251], v227 offset:12288
    v_mfma_f32_16x16x32_bf16 v[4:7], v[164:167], a[224:227], v[4:7]
    buffer_load_dwordx4 v251, s[32:35], s98 offen offset:1024 lds
    v_mfma_f32_16x16x32_bf16 v[12:15], v[164:167], a[228:231], v[12:15]
    ds_read_b128 a[252:255], v227 offset:14336
    v_mfma_f32_16x16x32_bf16 v[8:11], v[160:163], a[228:231], v[8:11]
    s_waitcnt lgkmcnt(4)
    v_mfma_f32_16x16x32_bf16 v[16:19], v[160:163], a[232:235], v[16:19]
    ds_read_b128 a[224:227], v228 offset:0
    v_mfma_f32_16x16x32_bf16 v[20:23], v[164:167], a[232:235], v[20:23]
    buffer_load_dwordx4 v[136:139], v224, s[36:39], s52 offen offset:2048 sc1
    v_mfma_f32_16x16x32_bf16 v[28:31], v[164:167], a[236:239], v[28:31]
    ds_read_b128 a[228:231], v228 offset:2048
    v_mfma_f32_16x16x32_bf16 v[24:27], v[160:163], a[236:239], v[24:27]
    s_waitcnt lgkmcnt(4)
    v_mfma_f32_16x16x32_bf16 v[32:35], v[160:163], a[240:243], v[32:35]
    ds_read_b128 a[232:235], v228 offset:4096
    v_mfma_f32_16x16x32_bf16 v[36:39], v[164:167], a[240:243], v[36:39]
    buffer_load_dwordx4 v252, s[32:35], s98 offen offset:2048 lds
    v_mfma_f32_16x16x32_bf16 v[44:47], v[164:167], a[244:247], v[44:47]
    ds_read_b128 a[236:239], v228 offset:6144
    v_mfma_f32_16x16x32_bf16 v[40:43], v[160:163], a[244:247], v[40:43]
    s_waitcnt lgkmcnt(4)
    v_mfma_f32_16x16x32_bf16 v[48:51], v[160:163], a[248:251], v[48:51]
    ds_read_b128 a[240:243], v228 offset:8192
    v_mfma_f32_16x16x32_bf16 v[52:55], v[164:167], a[248:251], v[52:55]
    buffer_load_dwordx4 v[140:143], v224, s[36:39], s52 offen offset:3072 sc1
    s_xor_b32 s52, s52, 12288
    v_mfma_f32_16x16x32_bf16 v[60:63], v[164:167], a[252:255], v[60:63]
    ds_read_b128 a[244:247], v228 offset:10240
    v_mfma_f32_16x16x32_bf16 v[56:59], v[160:163], a[252:255], v[56:59]
    s_waitcnt lgkmcnt(4)
    v_mfma_f32_16x16x32_bf16 v[0:3], v[168:171], a[224:227], v[0:3]
    ds_read_b128 a[248:251], v228 offset:12288
    v_mfma_f32_16x16x32_bf16 v[4:7], v[172:175], a[224:227], v[4:7]
    buffer_load_dwordx4 v253, s[32:35], s98 offen offset:3072 lds
    v_mfma_f32_16x16x32_bf16 v[12:15], v[172:175], a[228:231], v[12:15]
    ds_read_b128 a[252:255], v228 offset:14336
    v_mfma_f32_16x16x32_bf16 v[8:11], v[168:171], a[228:231], v[8:11]
    s_waitcnt vmcnt(24)
    s_barrier
    s_waitcnt lgkmcnt(4)
    v_mfma_f32_16x16x32_bf16 v[16:19], v[168:171], a[232:235], v[16:19]
    ds_read_b128 a[224:227], v227 offset:16384
    v_mfma_f32_16x16x32_bf16 v[20:23], v[172:175], a[232:235], v[20:23]
    buffer_load_dword v243, v241, s[44:47], 0 offen sc1
    v_mfma_f32_16x16x32_bf16 v[28:31], v[172:175], a[236:239], v[28:31]
    ds_read_b128 a[228:231], v227 offset:18432
    v_mfma_f32_16x16x32_bf16 v[24:27], v[168:171], a[236:239], v[24:27]
    s_xor_b32 s98, s98, 384
    s_add_u32 m0, s99, 49152
    buffer_load_dwordx4 v[144:147], v224, s[36:39], s52 offen offset:0 sc1
    s_waitcnt lgkmcnt(4)
    v_mfma_f32_16x16x32_bf16 v[32:35], v[168:171], a[240:243], v[32:35]
    ds_read_b128 a[232:235], v227 offset:20480
    v_mfma_f32_16x16x32_bf16 v[36:39], v[172:175], a[240:243], v[36:39]
    v_mfma_f32_16x16x32_bf16 v[44:47], v[172:175], a[244:247], v[44:47]
    ds_read_b128 a[236:239], v227 offset:22528
    v_mfma_f32_16x16x32_bf16 v[40:43], v[168:171], a[244:247], v[40:43]
    buffer_load_dwordx4 v250, s[32:35], s98 offen offset:0 lds
    s_waitcnt lgkmcnt(4)
    v_mfma_f32_16x16x32_bf16 v[48:51], v[168:171], a[248:251], v[48:51]
    ds_read_b128 a[240:243], v227 offset:24576
    v_mfma_f32_16x16x32_bf16 v[52:55], v[172:175], a[248:251], v[52:55]
    v_mfma_f32_16x16x32_bf16 v[60:63], v[172:175], a[252:255], v[60:63]
    ds_read_b128 a[244:247], v227 offset:26624
    v_mfma_f32_16x16x32_bf16 v[56:59], v[168:171], a[252:255], v[56:59]
    buffer_load_dwordx4 v[148:151], v224, s[36:39], s52 offen offset:1024 sc1
    s_waitcnt lgkmcnt(4)
    v_mfma_f32_16x16x32_bf16 v[0:3], v[176:179], a[224:227], v[0:3]
    ds_read_b128 a[248:251], v227 offset:28672
    v_mfma_f32_16x16x32_bf16 v[4:7], v[180:183], a[224:227], v[4:7]
    v_mfma_f32_16x16x32_bf16 v[12:15], v[180:183], a[228:231], v[12:15]
    ds_read_b128 a[252:255], v227 offset:30720
    v_mfma_f32_16x16x32_bf16 v[8:11], v[176:179], a[228:231], v[8:11]
    buffer_load_dwordx4 v251, s[32:35], s98 offen offset:1024 lds
    s_waitcnt lgkmcnt(4)
    v_mfma_f32_16x16x32_bf16 v[16:19], v[176:179], a[232:235], v[16:19]
    ds_read_b128 a[224:227], v228 offset:16384
    v_mfma_f32_16x16x32_bf16 v[20:23], v[180:183], a[232:235], v[20:23]
    buffer_load_dwordx4 v[152:155], v224, s[36:39], s52 offen offset:2048 sc1
    v_mfma_f32_16x16x32_bf16 v[28:31], v[180:183], a[236:239], v[28:31]
    ds_read_b128 a[228:231], v228 offset:18432
    v_mfma_f32_16x16x32_bf16 v[24:27], v[176:179], a[236:239], v[24:27]
    s_waitcnt lgkmcnt(4)
    v_mfma_f32_16x16x32_bf16 v[32:35], v[176:179], a[240:243], v[32:35]
    ds_read_b128 a[232:235], v228 offset:20480
    v_mfma_f32_16x16x32_bf16 v[36:39], v[180:183], a[240:243], v[36:39]
    buffer_load_dwordx4 v252, s[32:35], s98 offen offset:2048 lds
    v_mfma_f32_16x16x32_bf16 v[44:47], v[180:183], a[244:247], v[44:47]
    ds_read_b128 a[236:239], v228 offset:22528
    v_mfma_f32_16x16x32_bf16 v[40:43], v[176:179], a[244:247], v[40:43]
    s_waitcnt lgkmcnt(4)
    v_mfma_f32_16x16x32_bf16 v[48:51], v[176:179], a[248:251], v[48:51]
    ds_read_b128 a[240:243], v228 offset:24576
    v_mfma_f32_16x16x32_bf16 v[52:55], v[180:183], a[248:251], v[52:55]
    buffer_load_dwordx4 v[156:159], v224, s[36:39], s52 offen offset:3072 sc1
    s_xor_b32 s52, s52, 4096
    v_mfma_f32_16x16x32_bf16 v[60:63], v[180:183], a[252:255], v[60:63]
    ds_read_b128 a[244:247], v228 offset:26624
    v_mfma_f32_16x16x32_bf16 v[56:59], v[176:179], a[252:255], v[56:59]
    s_waitcnt lgkmcnt(4)
    v_mfma_f32_16x16x32_bf16 v[0:3], v[184:187], a[224:227], v[0:3]
    ds_read_b128 a[248:251], v228 offset:28672
    v_mfma_f32_16x16x32_bf16 v[4:7], v[188:191], a[224:227], v[4:7]
    buffer_load_dwordx4 v253, s[32:35], s98 offen offset:3072 lds
    v_mfma_f32_16x16x32_bf16 v[12:15], v[188:191], a[228:231], v[12:15]
    ds_read_b128 a[252:255], v228 offset:30720
    v_mfma_f32_16x16x32_bf16 v[8:11], v[184:187], a[228:231], v[8:11]
    s_waitcnt vmcnt(25)
    s_barrier
    s_waitcnt lgkmcnt(4)
    v_mfma_f32_16x16x32_bf16 v[16:19], v[184:187], a[232:235], v[16:19]
    ds_read_b128 a[224:227], v225 offset:0
    v_mfma_f32_16x16x32_bf16 v[20:23], v[188:191], a[232:235], v[20:23]
    s_xor_b32 s98, s98, 128
    s_add_u32 m0, s99, 65536
    buffer_load_dwordx4 v[160:163], v224, s[36:39], s52 offen offset:0 sc1
    v_mfma_f32_16x16x32_bf16 v[28:31], v[188:191], a[236:239], v[28:31]
    ds_read_b128 a[228:231], v225 offset:2048
    v_mfma_f32_16x16x32_bf16 v[24:27], v[184:187], a[236:239], v[24:27]
    s_waitcnt lgkmcnt(4)
    v_mfma_f32_16x16x32_bf16 v[32:35], v[184:187], a[240:243], v[32:35]
    ds_read_b128 a[232:235], v225 offset:4096
    v_mfma_f32_16x16x32_bf16 v[36:39], v[188:191], a[240:243], v[36:39]
    buffer_load_dwordx4 v250, s[32:35], s98 offen offset:0 lds
    v_mfma_f32_16x16x32_bf16 v[44:47], v[188:191], a[244:247], v[44:47]
    ds_read_b128 a[236:239], v225 offset:6144
    v_mfma_f32_16x16x32_bf16 v[40:43], v[184:187], a[244:247], v[40:43]
    s_waitcnt lgkmcnt(4)
    v_mfma_f32_16x16x32_bf16 v[48:51], v[184:187], a[248:251], v[48:51]
    ds_read_b128 a[240:243], v225 offset:8192
    v_mfma_f32_16x16x32_bf16 v[52:55], v[188:191], a[248:251], v[52:55]
    buffer_load_dwordx4 v[164:167], v224, s[36:39], s52 offen offset:1024 sc1
    v_mfma_f32_16x16x32_bf16 v[60:63], v[188:191], a[252:255], v[60:63]
    ds_read_b128 a[244:247], v225 offset:10240
    v_mfma_f32_16x16x32_bf16 v[56:59], v[184:187], a[252:255], v[56:59]
    s_waitcnt lgkmcnt(4)
    v_mfma_f32_16x16x32_bf16 v[0:3], v[96:99], a[224:227], v[0:3]
    ds_read_b128 a[248:251], v225 offset:12288
    v_mfma_f32_16x16x32_bf16 v[4:7], v[100:103], a[224:227], v[4:7]
    buffer_load_dwordx4 v251, s[32:35], s98 offen offset:1024 lds
    v_mfma_f32_16x16x32_bf16 v[12:15], v[100:103], a[228:231], v[12:15]
    ds_read_b128 a[252:255], v225 offset:14336
    v_mfma_f32_16x16x32_bf16 v[8:11], v[96:99], a[228:231], v[8:11]
    s_waitcnt lgkmcnt(4)
    v_mfma_f32_16x16x32_bf16 v[16:19], v[96:99], a[232:235], v[16:19]
    ds_read_b128 a[224:227], v226 offset:0
    v_mfma_f32_16x16x32_bf16 v[20:23], v[100:103], a[232:235], v[20:23]
    buffer_load_dwordx4 v[168:171], v224, s[36:39], s52 offen offset:2048 sc1
    v_mfma_f32_16x16x32_bf16 v[28:31], v[100:103], a[236:239], v[28:31]
    ds_read_b128 a[228:231], v226 offset:2048
    v_mfma_f32_16x16x32_bf16 v[24:27], v[96:99], a[236:239], v[24:27]
    s_waitcnt lgkmcnt(4)
    v_mfma_f32_16x16x32_bf16 v[32:35], v[96:99], a[240:243], v[32:35]
    ds_read_b128 a[232:235], v226 offset:4096
    v_mfma_f32_16x16x32_bf16 v[36:39], v[100:103], a[240:243], v[36:39]
    buffer_load_dwordx4 v252, s[32:35], s98 offen offset:2048 lds
    v_mfma_f32_16x16x32_bf16 v[44:47], v[100:103], a[244:247], v[44:47]
    ds_read_b128 a[236:239], v226 offset:6144
    v_mfma_f32_16x16x32_bf16 v[40:43], v[96:99], a[244:247], v[40:43]
    s_waitcnt lgkmcnt(4)
    v_mfma_f32_16x16x32_bf16 v[48:51], v[96:99], a[248:251], v[48:51]
    ds_read_b128 a[240:243], v226 offset:8192
    v_mfma_f32_16x16x32_bf16 v[52:55], v[100:103], a[248:251], v[52:55]
    buffer_load_dwordx4 v[172:175], v224, s[36:39], s52 offen offset:3072 sc1
    s_xor_b32 s52, s52, 61440
    v_mfma_f32_16x16x32_bf16 v[60:63], v[100:103], a[252:255], v[60:63]
    ds_read_b128 a[244:247], v226 offset:10240
    v_mfma_f32_16x16x32_bf16 v[56:59], v[96:99], a[252:255], v[56:59]
    s_waitcnt lgkmcnt(4)
    v_mfma_f32_16x16x32_bf16 v[0:3], v[104:107], a[224:227], v[0:3]
    ds_read_b128 a[248:251], v226 offset:12288
    v_mfma_f32_16x16x32_bf16 v[4:7], v[108:111], a[224:227], v[4:7]
    buffer_load_dwordx4 v253, s[32:35], s98 offen offset:3072 lds
    v_mfma_f32_16x16x32_bf16 v[12:15], v[108:111], a[228:231], v[12:15]
    ds_read_b128 a[252:255], v226 offset:14336
    v_mfma_f32_16x16x32_bf16 v[8:11], v[104:107], a[228:231], v[8:11]
    s_waitcnt vmcnt(25)
    s_barrier
    s_waitcnt lgkmcnt(4)
    v_mfma_f32_16x16x32_bf16 v[16:19], v[104:107], a[232:235], v[16:19]
    ds_read_b128 a[224:227], v225 offset:16384
    v_mfma_f32_16x16x32_bf16 v[20:23], v[108:111], a[232:235], v[20:23]
    s_xor_b32 s98, s98, 1920
    s_add_u32 m0, s99, 81920
    buffer_load_dwordx4 v[176:179], v224, s[36:39], s52 offen offset:0 sc1
    v_mfma_f32_16x16x32_bf16 v[28:31], v[108:111], a[236:239], v[28:31]
    ds_read_b128 a[228:231], v225 offset:18432
    v_mfma_f32_16x16x32_bf16 v[24:27], v[104:107], a[236:239], v[24:27]
    s_waitcnt lgkmcnt(4)
    v_mfma_f32_16x16x32_bf16 v[32:35], v[104:107], a[240:243], v[32:35]
    ds_read_b128 a[232:235], v225 offset:20480
    v_mfma_f32_16x16x32_bf16 v[36:39], v[108:111], a[240:243], v[36:39]
    buffer_load_dwordx4 v250, s[32:35], s98 offen offset:0 lds
    v_mfma_f32_16x16x32_bf16 v[44:47], v[108:111], a[244:247], v[44:47]
    ds_read_b128 a[236:239], v225 offset:22528
    v_mfma_f32_16x16x32_bf16 v[40:43], v[104:107], a[244:247], v[40:43]
    s_waitcnt lgkmcnt(4)
    v_mfma_f32_16x16x32_bf16 v[48:51], v[104:107], a[248:251], v[48:51]
    ds_read_b128 a[240:243], v225 offset:24576
    v_mfma_f32_16x16x32_bf16 v[52:55], v[108:111], a[248:251], v[52:55]
    buffer_load_dwordx4 v[180:183], v224, s[36:39], s52 offen offset:1024 sc1
    v_mfma_f32_16x16x32_bf16 v[60:63], v[108:111], a[252:255], v[60:63]
    ds_read_b128 a[244:247], v225 offset:26624
    v_mfma_f32_16x16x32_bf16 v[56:59], v[104:107], a[252:255], v[56:59]
    s_waitcnt lgkmcnt(4)
    v_mfma_f32_16x16x32_bf16 v[0:3], v[112:115], a[224:227], v[0:3]
    ds_read_b128 a[248:251], v225 offset:28672
    v_mfma_f32_16x16x32_bf16 v[4:7], v[116:119], a[224:227], v[4:7]
    buffer_load_dwordx4 v251, s[32:35], s98 offen offset:1024 lds
    v_mfma_f32_16x16x32_bf16 v[12:15], v[116:119], a[228:231], v[12:15]
    ds_read_b128 a[252:255], v225 offset:30720
    v_mfma_f32_16x16x32_bf16 v[8:11], v[112:115], a[228:231], v[8:11]
    s_waitcnt lgkmcnt(4)
    v_mfma_f32_16x16x32_bf16 v[16:19], v[112:115], a[232:235], v[16:19]
    ds_read_b128 a[224:227], v226 offset:16384
    v_mfma_f32_16x16x32_bf16 v[20:23], v[116:119], a[232:235], v[20:23]
    buffer_load_dwordx4 v[184:187], v224, s[36:39], s52 offen offset:2048 sc1
    v_mfma_f32_16x16x32_bf16 v[28:31], v[116:119], a[236:239], v[28:31]
    ds_read_b128 a[228:231], v226 offset:18432
    v_mfma_f32_16x16x32_bf16 v[24:27], v[112:115], a[236:239], v[24:27]
    s_waitcnt lgkmcnt(4)
    v_mfma_f32_16x16x32_bf16 v[32:35], v[112:115], a[240:243], v[32:35]
    ds_read_b128 a[232:235], v226 offset:20480
    v_mfma_f32_16x16x32_bf16 v[36:39], v[116:119], a[240:243], v[36:39]
    buffer_load_dwordx4 v252, s[32:35], s98 offen offset:2048 lds
    v_mfma_f32_16x16x32_bf16 v[44:47], v[116:119], a[244:247], v[44:47]
    ds_read_b128 a[236:239], v226 offset:22528
    v_mfma_f32_16x16x32_bf16 v[40:43], v[112:115], a[244:247], v[40:43]
    s_waitcnt lgkmcnt(4)
    v_mfma_f32_16x16x32_bf16 v[48:51], v[112:115], a[248:251], v[48:51]
    ds_read_b128 a[240:243], v226 offset:24576
    v_mfma_f32_16x16x32_bf16 v[52:55], v[116:119], a[248:251], v[52:55]
    buffer_load_dwordx4 v[188:191], v224, s[36:39], s52 offen offset:3072 sc1
    s_xor_b32 s52, s52, 4096
    v_mfma_f32_16x16x32_bf16 v[60:63], v[116:119], a[252:255], v[60:63]
    ds_read_b128 a[244:247], v226 offset:26624
    v_mfma_f32_16x16x32_bf16 v[56:59], v[112:115], a[252:255], v[56:59]
    s_waitcnt lgkmcnt(4)
    v_mfma_f32_16x16x32_bf16 v[0:3], v[120:123], a[224:227], v[0:3]
    ds_read_b128 a[248:251], v226 offset:28672
    v_mfma_f32_16x16x32_bf16 v[4:7], v[124:127], a[224:227], v[4:7]
    buffer_load_dwordx4 v253, s[32:35], s98 offen offset:3072 lds
    v_mfma_f32_16x16x32_bf16 v[12:15], v[124:127], a[228:231], v[12:15]
    ds_read_b128 a[252:255], v226 offset:30720
    v_mfma_f32_16x16x32_bf16 v[8:11], v[120:123], a[228:231], v[8:11]
    s_waitcnt vmcnt(25)
    s_waitcnt vmcnt(24)
    v_cmp_ne_u32 vcc, s26, v243
    s_nop 0
    s_cmp_eq_u64 vcc, 0
    s_cbranch_scc0 L_check_55
L_check_ret_56:
    s_barrier
    s_waitcnt lgkmcnt(4)
    v_mfma_f32_16x16x32_bf16 v[16:19], v[120:123], a[232:235], v[16:19]
    ds_read_b128 a[224:227], v225 offset:32768
    v_mfma_f32_16x16x32_bf16 v[20:23], v[124:127], a[232:235], v[20:23]
    buffer_load_dwordx4 v[64:67], v224, s[36:39], s72 offen offset:0 sc1
    v_mfma_f32_16x16x32_bf16 v[28:31], v[124:127], a[236:239], v[28:31]
    ds_read_b128 a[228:231], v225 offset:34816
    v_mfma_f32_16x16x32_bf16 v[24:27], v[120:123], a[236:239], v[24:27]
    s_xor_b32 s98, s98, 128
    s_add_u32 m0, s99, 0
    buffer_load_dwordx4 v[96:99], v224, s[36:39], s52 offen offset:0 sc1
    s_waitcnt lgkmcnt(4)
    v_mfma_f32_16x16x32_bf16 v[32:35], v[120:123], a[240:243], v[32:35]
    ds_read_b128 a[232:235], v225 offset:36864
    v_mfma_f32_16x16x32_bf16 v[36:39], v[124:127], a[240:243], v[36:39]
    s_branch L_po_K_3
.p2align 12
L_pg_K_3:
    s_branch L_pg_K_6
L_po_K_3:
    v_mfma_f32_16x16x32_bf16 v[44:47], v[124:127], a[244:247], v[44:47]
    ds_read_b128 a[236:239], v225 offset:38912
    v_mfma_f32_16x16x32_bf16 v[40:43], v[120:123], a[244:247], v[40:43]
    buffer_load_dwordx4 v250, s[32:35], s98 offen offset:0 lds
    s_waitcnt lgkmcnt(4)
    v_mfma_f32_16x16x32_bf16 v[48:51], v[120:123], a[248:251], v[48:51]
    ds_read_b128 a[240:243], v225 offset:40960
    v_mfma_f32_16x16x32_bf16 v[52:55], v[124:127], a[248:251], v[52:55]
    v_mfma_f32_16x16x32_bf16 v[60:63], v[124:127], a[252:255], v[60:63]
    ds_read_b128 a[244:247], v225 offset:43008
    v_mfma_f32_16x16x32_bf16 v[56:59], v[120:123], a[252:255], v[56:59]
    buffer_load_dwordx4 v[100:103], v224, s[36:39], s52 offen offset:1024 sc1
    s_waitcnt lgkmcnt(4)
    v_mfma_f32_16x16x32_bf16 v[0:3], v[128:131], a[224:227], v[0:3]
    ds_read_b128 a[248:251], v225 offset:45056
    v_mfma_f32_16x16x32_bf16 v[4:7], v[132:135], a[224:227], v[4:7]
    v_mfma_f32_16x16x32_bf16 v[12:15], v[132:135], a[228:231], v[12:15]
    ds_read_b128 a[252:255], v225 offset:47104
    v_mfma_f32_16x16x32_bf16 v[8:11], v[128:131], a[228:231], v[8:11]
    buffer_load_dwordx4 v251, s[32:35], s98 offen offset:1024 lds
    s_waitcnt lgkmcnt(4)
    v_mfma_f32_16x16x32_bf16 v[16:19], v[128:131], a[232:235], v[16:19]
    ds_read_b128 a[224:227], v226 offset:32768
    v_mfma_f32_16x16x32_bf16 v[20:23], v[132:135], a[232:235], v[20:23]
    buffer_load_dwordx4 v[104:107], v224, s[36:39], s52 offen offset:2048 sc1
    v_mfma_f32_16x16x32_bf16 v[28:31], v[132:135], a[236:239], v[28:31]
    ds_read_b128 a[228:231], v226 offset:34816
    v_mfma_f32_16x16x32_bf16 v[24:27], v[128:131], a[236:239], v[24:27]
    s_waitcnt lgkmcnt(4)
    v_mfma_f32_16x16x32_bf16 v[32:35], v[128:131], a[240:243], v[32:35]
    ds_read_b128 a[232:235], v226 offset:36864
    v_mfma_f32_16x16x32_bf16 v[36:39], v[132:135], a[240:243], v[36:39]
    buffer_load_dwordx4 v252, s[32:35], s98 offen offset:2048 lds
    v_mfma_f32_16x16x32_bf16 v[44:47], v[132:135], a[244:247], v[44:47]
    ds_read_b128 a[236:239], v226 offset:38912
    v_mfma_f32_16x16x32_bf16 v[40:43], v[128:131], a[244:247], v[40:43]
    s_waitcnt lgkmcnt(4)
    v_mfma_f32_16x16x32_bf16 v[48:51], v[128:131], a[248:251], v[48:51]
    ds_read_b128 a[240:243], v226 offset:40960
    v_mfma_f32_16x16x32_bf16 v[52:55], v[132:135], a[248:251], v[52:55]
    buffer_load_dwordx4 v[108:111], v224, s[36:39], s52 offen offset:3072 sc1
    s_xor_b32 s52, s52, 12288
    v_mfma_f32_16x16x32_bf16 v[60:63], v[132:135], a[252:255], v[60:63]
    ds_read_b128 a[244:247], v226 offset:43008
    v_mfma_f32_16x16x32_bf16 v[56:59], v[128:131], a[252:255], v[56:59]
    s_waitcnt lgkmcnt(4)
    v_mfma_f32_16x16x32_bf16 v[0:3], v[136:139], a[224:227], v[0:3]
    ds_read_b128 a[248:251], v226 offset:45056
    v_mfma_f32_16x16x32_bf16 v[4:7], v[140:143], a[224:227], v[4:7]
    buffer_load_dwordx4 v253, s[32:35], s98 offen offset:3072 lds
    v_mfma_f32_16x16x32_bf16 v[12:15], v[140:143], a[228:231], v[12:15]
    ds_read_b128 a[252:255], v226 offset:47104
    v_mfma_f32_16x16x32_bf16 v[8:11], v[136:139], a[228:231], v[8:11]
    s_waitcnt vmcnt(25)
    s_barrier
    s_waitcnt lgkmcnt(4)
    v_mfma_f32_16x16x32_bf16 v[16:19], v[136:139], a[232:235], v[16:19]
    ds_read_b128 a[224:227], v225 offset:49152
    v_mfma_f32_16x16x32_bf16 v[20:23], v[140:143], a[232:235], v[20:23]
    buffer_load_dwordx4 v[68:71], v224, s[36:39], s72 offen offset:1024 sc1
    v_mfma_f32_16x16x32_bf16 v[28:31], v[140:143], a[236:239], v[28:31]
    ds_read_b128 a[228:231], v225 offset:51200
    v_mfma_f32_16x16x32_bf16 v[24:27], v[136:139], a[236:239], v[24:27]
    s_xor_b32 s98, s98, 384
    s_add_u32 m0, s99, 16384
    buffer_load_dwordx4 v[112:115], v224, s[36:39], s52 offen offset:0 sc1
    s_waitcnt lgkmcnt(4)
    v_mfma_f32_16x16x32_bf16 v[32:35], v[136:139], a[240:243], v[32:35]
    ds_read_b128 a[232:235], v225 offset:53248
    v_mfma_f32_16x16x32_bf16 v[36:39], v[140:143], a[240:243], v[36:39]
    v_mfma_f32_16x16x32_bf16 v[44:47], v[140:143], a[244:247], v[44:47]
    ds_read_b128 a[236:239], v225 offset:55296
    v_mfma_f32_16x16x32_bf16 v[40:43], v[136:139], a[244:247], v[40:43]
    buffer_load_dwordx4 v250, s[32:35], s98 offen offset:0 lds
    s_waitcnt lgkmcnt(4)
    v_mfma_f32_16x16x32_bf16 v[48:51], v[136:139], a[248:251], v[48:51]
    ds_read_b128 a[240:243], v225 offset:57344
    v_mfma_f32_16x16x32_bf16 v[52:55], v[140:143], a[248:251], v[52:55]
    v_mfma_f32_16x16x32_bf16 v[60:63], v[140:143], a[252:255], v[60:63]
    ds_read_b128 a[244:247], v225 offset:59392
    v_mfma_f32_16x16x32_bf16 v[56:59], v[136:139], a[252:255], v[56:59]
    buffer_load_dwordx4 v[116:119], v224, s[36:39], s52 offen offset:1024 sc1
    s_waitcnt lgkmcnt(4)
    v_mfma_f32_16x16x32_bf16 v[0:3], v[144:147], a[224:227], v[0:3]
    ds_read_b128 a[248:251], v225 offset:61440
    v_mfma_f32_16x16x32_bf16 v[4:7], v[148:151], a[224:227], v[4:7]
    v_mfma_f32_16x16x32_bf16 v[12:15], v[148:151], a[228:231], v[12:15]
    ds_read_b128 a[252:255], v225 offset:63488
    v_mfma_f32_16x16x32_bf16 v[8:11], v[144:147], a[228:231], v[8:11]
    buffer_load_dwordx4 v251, s[32:35], s98 offen offset:1024 lds
    s_waitcnt lgkmcnt(4)
    v_mfma_f32_16x16x32_bf16 v[16:19], v[144:147], a[232:235], v[16:19]
    ds_read_b128 a[224:227], v226 offset:49152
    v_mfma_f32_16x16x32_bf16 v[20:23], v[148:151], a[232:235], v[20:23]
    buffer_load_dwordx4 v[120:123], v224, s[36:39], s52 offen offset:2048 sc1
    v_mfma_f32_16x16x32_bf16 v[28:31], v[148:151], a[236:239], v[28:31]
    ds_read_b128 a[228:231], v226 offset:51200
    v_mfma_f32_16x16x32_bf16 v[24:27], v[144:147], a[236:239], v[24:27]
    s_waitcnt lgkmcnt(4)
    v_mfma_f32_16x16x32_bf16 v[32:35], v[144:147], a[240:243], v[32:35]
    ds_read_b128 a[232:235], v226 offset:53248
    v_mfma_f32_16x16x32_bf16 v[36:39], v[148:151], a[240:243], v[36:39]
    buffer_load_dwordx4 v252, s[32:35], s98 offen offset:2048 lds
    v_mfma_f32_16x16x32_bf16 v[44:47], v[148:151], a[244:247], v[44:47]
    ds_read_b128 a[236:239], v226 offset:55296
    v_mfma_f32_16x16x32_bf16 v[40:43], v[144:147], a[244:247], v[40:43]
    s_waitcnt lgkmcnt(4)
    v_mfma_f32_16x16x32_bf16 v[48:51], v[144:147], a[248:251], v[48:51]
    ds_read_b128 a[240:243], v226 offset:57344
    v_mfma_f32_16x16x32_bf16 v[52:55], v[148:151], a[248:251], v[52:55]
    buffer_load_dwordx4 v[124:127], v224, s[36:39], s52 offen offset:3072 sc1
    s_xor_b32 s52, s52, 24576
    v_mfma_f32_16x16x32_bf16 v[60:63], v[148:151], a[252:255], v[60:63]
    ds_read_b128 a[244:247], v226 offset:59392
    v_mfma_f32_16x16x32_bf16 v[56:59], v[144:147], a[252:255], v[56:59]
    s_waitcnt lgkmcnt(4)
    v_mfma_f32_16x16x32_bf16 v[0:3], v[152:155], a[224:227], v[0:3]
    ds_read_b128 a[248:251], v226 offset:61440
    v_mfma_f32_16x16x32_bf16 v[4:7], v[156:159], a[224:227], v[4:7]
    buffer_load_dwordx4 v253, s[32:35], s98 offen offset:3072 lds
    v_mfma_f32_16x16x32_bf16 v[12:15], v[156:159], a[228:231], v[12:15]
    ds_read_b128 a[252:255], v226 offset:63488
    v_mfma_f32_16x16x32_bf16 v[8:11], v[152:155], a[228:231], v[8:11]
    s_waitcnt vmcnt(26)
    s_barrier
    s_waitcnt lgkmcnt(4)
    v_mfma_f32_16x16x32_bf16 v[16:19], v[152:155], a[232:235], v[16:19]
    ds_read_b128 a[224:227], v227 offset:0
    v_mfma_f32_16x16x32_bf16 v[20:23], v[156:159], a[232:235], v[20:23]
    buffer_load_dwordx4 v[72:75], v224, s[36:39], s73 offen offset:0 sc1
    v_mfma_f32_16x16x32_bf16 v[28:31], v[156:159], a[236:239], v[28:31]
    ds_read_b128 a[228:231], v227 offset:2048
    v_mfma_f32_16x16x32_bf16 v[24:27], v[152:155], a[236:239], v[24:27]
    s_xor_b32 s98, s98, 768
    s_add_u32 m0, s99, 32768
    buffer_load_dwordx4 v[128:131], v224, s[36:39], s52 offen offset:0 sc1
    s_waitcnt lgkmcnt(4)
    v_mfma_f32_16x16x32_bf16 v[32:35], v[152:155], a[240:243], v[32:35]
    ds_read_b128 a[232:235], v227 offset:4096
    v_mfma_f32_16x16x32_bf16 v[36:39], v[156:159], a[240:243], v[36:39]
    v_mfma_f32_16x16x32_bf16 v[44:47], v[156:159], a[244:247], v[44:47]
    ds_read_b128 a[236:239], v227 offset:6144
    v_mfma_f32_16x16x32_bf16 v[40:43], v[152:155], a[244:247], v[40:43]
    buffer_load_dwordx4 v250, s[32:35], s98 offen offset:0 lds
    s_waitcnt lgkmcnt(4)
    v_mfma_f32_16x16x32_bf16 v[48:51], v[152:155], a[248:251], v[48:51]
    ds_read_b128 a[240:243], v227 offset:8192
    v_mfma_f32_16x16x32_bf16 v[52:55], v[156:159], a[248:251], v[52:55]
    v_mfma_f32_16x16x32_bf16 v[60:63], v[156:159], a[252:255], v[60:63]
    ds_read_b128 a[244:247], v227 offset:10240
    v_mfma_f32_16x16x32_bf16 v[56:59], v[152:155], a[252:255], v[56:59]
    buffer_load_dwordx4 v[132:135], v224, s[36:39], s52 offen offset:1024 sc1
    s_waitcnt lgkmcnt(4)
    v_mfma_f32_16x16x32_bf16 v[0:3], v[160:163], a[224:227], v[0:3]
    ds_read_b128 a[248:251], v227 offset:12288
    v_mfma_f32_16x16x32_bf16 v[4:7], v[164:167], a[224:227], v[4:7]
    v_mfma_f32_16x16x32_bf16 v[12:15], v[164:167], a[228:231], v[12:15]
    ds_read_b128 a[252:255], v227 offset:14336
    v_mfma_f32_16x16x32_bf16 v[8:11], v[160:163], a[228:231], v[8:11]
    buffer_load_dwordx4 v251, s[32:35], s98 offen offset:1024 lds
    s_waitcnt lgkmcnt(4)
    v_mfma_f32_16x16x32_bf16 v[16:19], v[160:163], a[232:235], v[16:19]
    ds_read_b128 a[224:227], v228 offset:0
    v_mfma_f32_16x16x32_bf16 v[20:23], v[164:167], a[232:235], v[20:23]
    buffer_load_dwordx4 v[136:139], v224, s[36:39], s52 offen offset:2048 sc1
    v_mfma_f32_16x16x32_bf16 v[28:31], v[164:167], a[236:239], v[28:31]
    ds_read_b128 a[228:231], v228 offset:2048
    v_mfma_f32_16x16x32_bf16 v[24:27], v[160:163], a[236:239], v[24:27]
    s_waitcnt lgkmcnt(4)
    v_mfma_f32_16x16x32_bf16 v[32:35], v[160:163], a[240:243], v[32:35]
    ds_read_b128 a[232:235], v228 offset:4096
    v_mfma_f32_16x16x32_bf16 v[36:39], v[164:167], a[240:243], v[36:39]
    buffer_load_dwordx4 v252, s[32:35], s98 offen offset:2048 lds
    v_mfma_f32_16x16x32_bf16 v[44:47], v[164:167], a[244:247], v[44:47]
    ds_read_b128 a[236:239], v228 offset:6144
    v_mfma_f32_16x16x32_bf16 v[40:43], v[160:163], a[244:247], v[40:43]
    s_waitcnt lgkmcnt(4)
    v_mfma_f32_16x16x32_bf16 v[48:51], v[160:163], a[248:251], v[48:51]
    ds_read_b128 a[240:243], v228 offset:8192
    v_mfma_f32_16x16x32_bf16 v[52:55], v[164:167], a[248:251], v[52:55]
    buffer_load_dwordx4 v[140:143], v224, s[36:39], s52 offen offset:3072 sc1
    s_xor_b32 s52, s52, 4096
    v_mfma_f32_16x16x32_bf16 v[60:63], v[164:167], a[252:255], v[60:63]
    ds_read_b128 a[244:247], v228 offset:10240
    v_mfma_f32_16x16x32_bf16 v[56:59], v[160:163], a[252:255], v[56:59]
    s_waitcnt lgkmcnt(4)
    v_mfma_f32_16x16x32_bf16 v[0:3], v[168:171], a[224:227], v[0:3]
    ds_read_b128 a[248:251], v228 offset:12288
    v_mfma_f32_16x16x32_bf16 v[4:7], v[172:175], a[224:227], v[4:7]
    buffer_load_dwordx4 v253, s[32:35], s98 offen offset:3072 lds
    v_mfma_f32_16x16x32_bf16 v[12:15], v[172:175], a[228:231], v[12:15]
    ds_read_b128 a[252:255], v228 offset:14336
    v_mfma_f32_16x16x32_bf16 v[8:11], v[168:171], a[228:231], v[8:11]
    s_waitcnt vmcnt(27)
    s_barrier
    s_waitcnt lgkmcnt(4)
    v_mfma_f32_16x16x32_bf16 v[16:19], v[168:171], a[232:235], v[16:19]
    ds_read_b128 a[224:227], v227 offset:16384
    v_mfma_f32_16x16x32_bf16 v[20:23], v[172:175], a[232:235], v[20:23]
    buffer_load_dwordx4 v[76:79], v224, s[36:39], s73 offen offset:1024 sc1
    v_mfma_f32_16x16x32_bf16 v[28:31], v[172:175], a[236:239], v[28:31]
    ds_read_b128 a[228:231], v227 offset:18432
    v_mfma_f32_16x16x32_bf16 v[24:27], v[168:171], a[236:239], v[24:27]
    s_xor_b32 s98, s98, 128
    s_add_u32 m0, s99, 49152
    buffer_load_dwordx4 v[144:147], v224, s[36:39], s52 offen offset:0 sc1
    s_waitcnt lgkmcnt(4)
    v_mfma_f32_16x16x32_bf16 v[32:35], v[168:171], a[240:243], v[32:35]
    ds_read_b128 a[232:235], v227 offset:20480
    v_mfma_f32_16x16x32_bf16 v[36:39], v[172:175], a[240:243], v[36:39]
    v_mfma_f32_16x16x32_bf16 v[44:47], v[172:175], a[244:247], v[44:47]
    ds_read_b128 a[236:239], v227 offset:22528
    v_mfma_f32_16x16x32_bf16 v[40:43], v[168:171], a[244:247], v[40:43]
    buffer_load_dwordx4 v250, s[32:35], s98 offen offset:0 lds
    s_waitcnt lgkmcnt(4)
    v_mfma_f32_16x16x32_bf16 v[48:51], v[168:171], a[248:251], v[48:51]
    ds_read_b128 a[240:243], v227 offset:24576
    v_mfma_f32_16x16x32_bf16 v[52:55], v[172:175], a[248:251], v[52:55]
    v_mfma_f32_16x16x32_bf16 v[60:63], v[172:175], a[252:255], v[60:63]
    ds_read_b128 a[244:247], v227 offset:26624
    v_mfma_f32_16x16x32_bf16 v[56:59], v[168:171], a[252:255], v[56:59]
    buffer_load_dwordx4 v[148:151], v224, s[36:39], s52 offen offset:1024 sc1
    s_waitcnt lgkmcnt(4)
    v_mfma_f32_16x16x32_bf16 v[0:3], v[176:179], a[224:227], v[0:3]
    ds_read_b128 a[248:251], v227 offset:28672
    v_mfma_f32_16x16x32_bf16 v[4:7], v[180:183], a[224:227], v[4:7]
    v_mfma_f32_16x16x32_bf16 v[12:15], v[180:183], a[228:231], v[12:15]
    ds_read_b128 a[252:255], v227 offset:30720
    v_mfma_f32_16x16x32_bf16 v[8:11], v[176:179], a[228:231], v[8:11]
    buffer_load_dwordx4 v251, s[32:35], s98 offen offset:1024 lds
    s_waitcnt lgkmcnt(4)
    v_mfma_f32_16x16x32_bf16 v[16:19], v[176:179], a[232:235], v[16:19]
    ds_read_b128 a[224:227], v228 offset:16384
    v_mfma_f32_16x16x32_bf16 v[20:23], v[180:183], a[232:235], v[20:23]
    buffer_load_dwordx4 v[152:155], v224, s[36:39], s52 offen offset:2048 sc1
    v_mfma_f32_16x16x32_bf16 v[28:31], v[180:183], a[236:239], v[28:31]
    ds_read_b128 a[228:231], v228 offset:18432
    v_mfma_f32_16x16x32_bf16 v[24:27], v[176:179], a[236:239], v[24:27]
    s_waitcnt lgkmcnt(4)
    v_mfma_f32_16x16x32_bf16 v[32:35], v[176:179], a[240:243], v[32:35]
    ds_read_b128 a[232:235], v228 offset:20480
    v_mfma_f32_16x16x32_bf16 v[36:39], v[180:183], a[240:243], v[36:39]
    buffer_load_dwordx4 v252, s[32:35], s98 offen offset:2048 lds
    v_mfma_f32_16x16x32_bf16 v[44:47], v[180:183], a[244:247], v[44:47]
    ds_read_b128 a[236:239], v228 offset:22528
    v_mfma_f32_16x16x32_bf16 v[40:43], v[176:179], a[244:247], v[40:43]
    s_waitcnt lgkmcnt(4)
    v_mfma_f32_16x16x32_bf16 v[48:51], v[176:179], a[248:251], v[48:51]
    ds_read_b128 a[240:243], v228 offset:24576
    v_mfma_f32_16x16x32_bf16 v[52:55], v[180:183], a[248:251], v[52:55]
    buffer_load_dwordx4 v[156:159], v224, s[36:39], s52 offen offset:3072 sc1
    s_xor_b32 s52, s52, 12288
    v_mfma_f32_16x16x32_bf16 v[60:63], v[180:183], a[252:255], v[60:63]
    ds_read_b128 a[244:247], v228 offset:26624
    v_mfma_f32_16x16x32_bf16 v[56:59], v[176:179], a[252:255], v[56:59]
    s_waitcnt lgkmcnt(4)
    v_mfma_f32_16x16x32_bf16 v[0:3], v[184:187], a[224:227], v[0:3]
    ds_read_b128 a[248:251], v228 offset:28672
    v_mfma_f32_16x16x32_bf16 v[4:7], v[188:191], a[224:227], v[4:7]
    buffer_load_dwordx4 v253, s[32:35], s98 offen offset:3072 lds
    v_mfma_f32_16x16x32_bf16 v[12:15], v[188:191], a[228:231], v[12:15]
    ds_read_b128 a[252:255], v228 offset:30720
    v_mfma_f32_16x16x32_bf16 v[8:11], v[184:187], a[228:231], v[8:11]
    s_waitcnt vmcnt(27)
    s_barrier
    s_waitcnt lgkmcnt(4)
    v_mfma_f32_16x16x32_bf16 v[16:19], v[184:187], a[232:235], v[16:19]
    ds_read_b128 a[224:227], v225 offset:0
    v_mfma_f32_16x16x32_bf16 v[20:23], v[188:191], a[232:235], v[20:23]
    buffer_load_dwordx4 v[80:83], v224, s[36:39], s74 offen offset:0 sc1
    v_mfma_f32_16x16x32_bf16 v[28:31], v[188:191], a[236:239], v[28:31]
    ds_read_b128 a[228:231], v225 offset:2048
    v_mfma_f32_16x16x32_bf16 v[24:27], v[184:187], a[236:239], v[24:27]
    s_xor_b32 s98, s98, 384
    s_add_u32 m0, s99, 65536
    buffer_load_dwordx4 v[160:163], v224, s[36:39], s52 offen offset:0 sc1
    s_waitcnt lgkmcnt(4)
    v_mfma_f32_16x16x32_bf16 v[32:35], v[184:187], a[240:243], v[32:35]
    ds_read_b128 a[232:235], v225 offset:4096
    v_mfma_f32_16x16x32_bf16 v[36:39], v[188:191], a[240:243], v[36:39]
    v_mfma_f32_16x16x32_bf16 v[44:47], v[188:191], a[244:247], v[44:47]
    ds_read_b128 a[236:239], v225 offset:6144
    v_mfma_f32_16x16x32_bf16 v[40:43], v[184:187], a[244:247], v[40:43]
    buffer_load_dwordx4 v250, s[32:35], s98 offen offset:0 lds
    s_waitcnt lgkmcnt(4)
    v_mfma_f32_16x16x32_bf16 v[48:51], v[184:187], a[248:251], v[48:51]
    ds_read_b128 a[240:243], v225 offset:8192
    v_mfma_f32_16x16x32_bf16 v[52:55], v[188:191], a[248:251], v[52:55]
    v_mfma_f32_16x16x32_bf16 v[60:63], v[188:191], a[252:255], v[60:63]
    ds_read_b128 a[244:247], v225 offset:10240
    v_mfma_f32_16x16x32_bf16 v[56:59], v[184:187], a[252:255], v[56:59]
    buffer_load_dwordx4 v[164:167], v224, s[36:39], s52 offen offset:1024 sc1
    s_waitcnt lgkmcnt(4)
    v_mfma_f32_16x16x32_bf16 v[0:3], v[96:99], a[224:227], v[0:3]
    ds_read_b128 a[248:251], v225 offset:12288
    v_mfma_f32_16x16x32_bf16 v[4:7], v[100:103], a[224:227], v[4:7]
    v_mfma_f32_16x16x32_bf16 v[12:15], v[100:103], a[228:231], v[12:15]
    ds_read_b128 a[252:255], v225 offset:14336
    v_mfma_f32_16x16x32_bf16 v[8:11], v[96:99], a[228:231], v[8:11]
    buffer_load_dwordx4 v251, s[32:35], s98 offen offset:1024 lds
    s_waitcnt lgkmcnt(4)
    v_mfma_f32_16x16x32_bf16 v[16:19], v[96:99], a[232:235], v[16:19]
    ds_read_b128 a[224:227], v226 offset:0
    v_mfma_f32_16x16x32_bf16 v[20:23], v[100:103], a[232:235], v[20:23]
    buffer_load_dwordx4 v[168:171], v224, s[36:39], s52 offen offset:2048 sc1
    v_mfma_f32_16x16x32_bf16 v[28:31], v[100:103], a[236:239], v[28:31]
    ds_read_b128 a[228:231], v226 offset:2048
    v_mfma_f32_16x16x32_bf16 v[24:27], v[96:99], a[236:239], v[24:27]
    s_waitcnt lgkmcnt(4)
    v_mfma_f32_16x16x32_bf16 v[32:35], v[96:99], a[240:243], v[32:35]
    ds_read_b128 a[232:235], v226 offset:4096
    v_mfma_f32_16x16x32_bf16 v[36:39], v[100:103], a[240:243], v[36:39]
    buffer_load_dwordx4 v252, s[32:35], s98 offen offset:2048 lds
    v_mfma_f32_16x16x32_bf16 v[44:47], v[100:103], a[244:247], v[44:47]
    ds_read_b128 a[236:239], v226 offset:6144
    v_mfma_f32_16x16x32_bf16 v[40:43], v[96:99], a[244:247], v[40:43]
    s_waitcnt lgkmcnt(4)
    v_mfma_f32_16x16x32_bf16 v[48:51], v[96:99], a[248:251], v[48:51]
    ds_read_b128 a[240:243], v226 offset:8192
    v_mfma_f32_16x16x32_bf16 v[52:55], v[100:103], a[248:251], v[52:55]
    buffer_load_dwordx4 v[172:175], v224, s[36:39], s52 offen offset:3072 sc1
    s_xor_b32 s52, s52, 4096
    v_mfma_f32_16x16x32_bf16 v[60:63], v[100:103], a[252:255], v[60:63]
    ds_read_b128 a[244:247], v226 offset:10240
    v_mfma_f32_16x16x32_bf16 v[56:59], v[96:99], a[252:255], v[56:59]
    s_waitcnt lgkmcnt(4)
    v_mfma_f32_16x16x32_bf16 v[0:3], v[104:107], a[224:227], v[0:3]
    ds_read_b128 a[248:251], v226 offset:12288
    v_mfma_f32_16x16x32_bf16 v[4:7], v[108:111], a[224:227], v[4:7]
    buffer_load_dwordx4 v253, s[32:35], s98 offen offset:3072 lds
    v_mfma_f32_16x16x32_bf16 v[12:15], v[108:111], a[228:231], v[12:15]
    ds_read_b128 a[252:255], v226 offset:14336
    v_mfma_f32_16x16x32_bf16 v[8:11], v[104:107], a[228:231], v[8:11]
    s_waitcnt vmcnt(27)
    s_barrier
    s_waitcnt lgkmcnt(4)
    v_mfma_f32_16x16x32_bf16 v[16:19], v[104:107], a[232:235], v[16:19]
    ds_read_b128 a[224:227], v225 offset:16384
    v_mfma_f32_16x16x32_bf16 v[20:23], v[108:111], a[232:235], v[20:23]
    buffer_load_dwordx4 v[84:87], v224, s[36:39], s74 offen offset:1024 sc1
    v_mfma_f32_16x16x32_bf16 v[28:31], v[108:111], a[236:239], v[28:31]
    ds_read_b128 a[228:231], v225 offset:18432
    v_mfma_f32_16x16x32_bf16 v[24:27], v[104:107], a[236:239], v[24:27]
    s_xor_b32 s98, s98, 128
    s_add_u32 m0, s99, 81920
    buffer_load_dwordx4 v[176:179], v224, s[36:39], s52 offen offset:0 sc1
    s_waitcnt lgkmcnt(4)
    v_mfma_f32_16x16x32_bf16 v[32:35], v[104:107], a[240:243], v[32:35]
    ds_read_b128 a[232:235], v225 offset:20480
    v_mfma_f32_16x16x32_bf16 v[36:39], v[108:111], a[240:243], v[36:39]
    v_mfma_f32_16x16x32_bf16 v[44:47], v[108:111], a[244:247], v[44:47]
    ds_read_b128 a[236:239], v225 offset:22528
    v_mfma_f32_16x16x32_bf16 v[40:43], v[104:107], a[244:247], v[40:43]
    buffer_load_dwordx4 v250, s[32:35], s98 offen offset:0 lds
    s_waitcnt lgkmcnt(4)
    v_mfma_f32_16x16x32_bf16 v[48:51], v[104:107], a[248:251], v[48:51]
    ds_read_b128 a[240:243], v225 offset:24576
    v_mfma_f32_16x16x32_bf16 v[52:55], v[108:111], a[248:251], v[52:55]
    v_mfma_f32_16x16x32_bf16 v[60:63], v[108:111], a[252:255], v[60:63]
    ds_read_b128 a[244:247], v225 offset:26624
    v_mfma_f32_16x16x32_bf16 v[56:59], v[104:107], a[252:255], v[56:59]
    buffer_load_dwordx4 v[180:183], v224, s[36:39], s52 offen offset:1024 sc1
    s_waitcnt lgkmcnt(4)
    v_mfma_f32_16x16x32_bf16 v[0:3], v[112:115], a[224:227], v[0:3]
    ds_read_b128 a[248:251], v225 offset:28672
    v_mfma_f32_16x16x32_bf16 v[4:7], v[116:119], a[224:227], v[4:7]
    v_mfma_f32_16x16x32_bf16 v[12:15], v[116:119], a[228:231], v[12:15]
    ds_read_b128 a[252:255], v225 offset:30720
    v_mfma_f32_16x16x32_bf16 v[8:11], v[112:115], a[228:231], v[8:11]
    buffer_load_dwordx4 v251, s[32:35], s98 offen offset:1024 lds
    s_waitcnt lgkmcnt(4)
    v_mfma_f32_16x16x32_bf16 v[16:19], v[112:115], a[232:235], v[16:19]
    ds_read_b128 a[224:227], v226 offset:16384
    v_mfma_f32_16x16x32_bf16 v[20:23], v[116:119], a[232:235], v[20:23]
    buffer_load_dwordx4 v[184:187], v224, s[36:39], s52 offen offset:2048 sc1
    v_mfma_f32_16x16x32_bf16 v[28:31], v[116:119], a[236:239], v[28:31]
    ds_read_b128 a[228:231], v226 offset:18432
    v_mfma_f32_16x16x32_bf16 v[24:27], v[112:115], a[236:239], v[24:27]
    s_waitcnt lgkmcnt(4)
    v_mfma_f32_16x16x32_bf16 v[32:35], v[112:115], a[240:243], v[32:35]
    ds_read_b128 a[232:235], v226 offset:20480
    v_mfma_f32_16x16x32_bf16 v[36:39], v[116:119], a[240:243], v[36:39]
    buffer_load_dwordx4 v252, s[32:35], s98 offen offset:2048 lds
    v_mfma_f32_16x16x32_bf16 v[44:47], v[116:119], a[244:247], v[44:47]
    ds_read_b128 a[236:239], v226 offset:22528
    v_mfma_f32_16x16x32_bf16 v[40:43], v[112:115], a[244:247], v[40:43]
    s_waitcnt lgkmcnt(4)
    v_mfma_f32_16x16x32_bf16 v[48:51], v[112:115], a[248:251], v[48:51]
    ds_read_b128 a[240:243], v226 offset:24576
    v_mfma_f32_16x16x32_bf16 v[52:55], v[116:119], a[248:251], v[52:55]
    buffer_load_dwordx4 v[188:191], v224, s[36:39], s52 offen offset:3072 sc1
    s_xor_b32 s52, s52, 258048
    v_mfma_f32_16x16x32_bf16 v[60:63], v[116:119], a[252:255], v[60:63]
    ds_read_b128 a[244:247], v226 offset:26624
    v_mfma_f32_16x16x32_bf16 v[56:59], v[112:115], a[252:255], v[56:59]
    s_waitcnt lgkmcnt(4)
    v_mfma_f32_16x16x32_bf16 v[0:3], v[120:123], a[224:227], v[0:3]
    ds_read_b128 a[248:251], v226 offset:28672
    v_mfma_f32_16x16x32_bf16 v[4:7], v[124:127], a[224:227], v[4:7]
    buffer_load_dwordx4 v253, s[32:35], s98 offen offset:3072 lds
    v_mfma_f32_16x16x32_bf16 v[12:15], v[124:127], a[228:231], v[12:15]
    ds_read_b128 a[252:255], v226 offset:30720
    v_mfma_f32_16x16x32_bf16 v[8:11], v[120:123], a[228:231], v[8:11]
    s_waitcnt vmcnt(27)
    s_barrier
    s_waitcnt lgkmcnt(4)
    v_mfma_f32_16x16x32_bf16 v[16:19], v[120:123], a[232:235], v[16:19]
    ds_read_b128 a[224:227], v225 offset:32768
    v_mfma_f32_16x16x32_bf16 v[20:23], v[124:127], a[232:235], v[20:23]
    buffer_load_dwordx4 v[88:91], v224, s[36:39], s75 offen offset:0 sc1
    v_mfma_f32_16x16x32_bf16 v[28:31], v[124:127], a[236:239], v[28:31]
    ds_read_b128 a[228:231], v225 offset:34816
    v_mfma_f32_16x16x32_bf16 v[24:27], v[120:123], a[236:239], v[24:27]
    buffer_load_dwordx4 v[96:99], v224, s[36:39], s67 offen offset:0 sc1
    s_waitcnt lgkmcnt(4)
    v_mfma_f32_16x16x32_bf16 v[32:35], v[120:123], a[240:243], v[32:35]
    ds_read_b128 a[232:235], v225 offset:36864
    v_mfma_f32_16x16x32_bf16 v[36:39], v[124:127], a[240:243], v[36:39]
    v_mfma_f32_16x16x32_bf16 v[44:47], v[124:127], a[244:247], v[44:47]
    ds_read_b128 a[236:239], v225 offset:38912
    v_mfma_f32_16x16x32_bf16 v[40:43], v[120:123], a[244:247], v[40:43]
    s_add_u32 m0, s55, 65536
    s_nop 0
    buffer_load_dwordx4 v247, s[40:43], s54 offen lds
    s_add_u32 s54, s54, 65536
    s_waitcnt lgkmcnt(4)
    v_mfma_f32_16x16x32_bf16 v[48:51], v[120:123], a[248:251], v[48:51]
    ds_read_b128 a[240:243], v225 offset:40960
    v_mfma_f32_16x16x32_bf16 v[52:55], v[124:127], a[248:251], v[52:55]
    v_mfma_f32_16x16x32_bf16 v[60:63], v[124:127], a[252:255], v[60:63]
    ds_read_b128 a[244:247], v225 offset:43008
    v_mfma_f32_16x16x32_bf16 v[56:59], v[120:123], a[252:255], v[56:59]
    buffer_load_dwordx4 v[100:103], v224, s[36:39], s67 offen offset:1024 sc1
    s_waitcnt lgkmcnt(4)
    v_mfma_f32_16x16x32_bf16 v[0:3], v[128:131], a[224:227], v[0:3]
    ds_read_b128 a[248:251], v225 offset:45056
    v_mfma_f32_16x16x32_bf16 v[4:7], v[132:135], a[224:227], v[4:7]
    v_mfma_f32_16x16x32_bf16 v[12:15], v[132:135], a[228:231], v[12:15]
    ds_read_b128 a[252:255], v225 offset:47104
    v_mfma_f32_16x16x32_bf16 v[8:11], v[128:131], a[228:231], v[8:11]
    s_add_u32 m0, s55, 69632
    s_nop 0
    buffer_load_dwordx4 v247, s[40:43], s54 offen lds
    s_add_u32 s54, s54, 65536
    s_waitcnt lgkmcnt(4)
    v_mfma_f32_16x16x32_bf16 v[16:19], v[128:131], a[232:235], v[16:19]
    ds_read_b128 a[224:227], v226 offset:32768
    v_mfma_f32_16x16x32_bf16 v[20:23], v[132:135], a[232:235], v[20:23]
    buffer_load_dwordx4 v[104:107], v224, s[36:39], s67 offen offset:2048 sc1
    v_mfma_f32_16x16x32_bf16 v[28:31], v[132:135], a[236:239], v[28:31]
    ds_read_b128 a[228:231], v226 offset:34816
    v_mfma_f32_16x16x32_bf16 v[24:27], v[128:131], a[236:239], v[24:27]
    s_waitcnt lgkmcnt(4)
    v_mfma_f32_16x16x32_bf16 v[32:35], v[128:131], a[240:243], v[32:35]
    ds_read_b128 a[232:235], v226 offset:36864
    v_mfma_f32_16x16x32_bf16 v[36:39], v[132:135], a[240:243], v[36:39]
    s_add_u32 m0, s55, 73728
    s_nop 0
    buffer_load_dwordx4 v247, s[40:43], s54 offen lds
    s_add_u32 s54, s54, 65536
    v_mfma_f32_16x16x32_bf16 v[44:47], v[132:135], a[244:247], v[44:47]
    ds_read_b128 a[236:239], v226 offset:38912
    v_mfma_f32_16x16x32_bf16 v[40:43], v[128:131], a[244:247], v[40:43]
    s_waitcnt lgkmcnt(4)
    v_mfma_f32_16x16x32_bf16 v[48:51], v[128:131], a[248:251], v[48:51]
    ds_read_b128 a[240:243], v226 offset:40960
    v_mfma_f32_16x16x32_bf16 v[52:55], v[132:135], a[248:251], v[52:55]
    buffer_load_dwordx4 v[108:111], v224, s[36:39], s67 offen offset:3072 sc1
    s_add_u32 s67, s67, 4096
    v_mfma_f32_16x16x32_bf16 v[60:63], v[132:135], a[252:255], v[60:63]
    ds_read_b128 a[244:247], v226 offset:43008
    v_mfma_f32_16x16x32_bf16 v[56:59], v[128:131], a[252:255], v[56:59]
    s_waitcnt lgkmcnt(4)
    v_mfma_f32_16x16x32_bf16 v[0:3], v[136:139], a[224:227], v[0:3]
    ds_read_b128 a[248:251], v226 offset:45056
    v_mfma_f32_16x16x32_bf16 v[4:7], v[140:143], a[224:227], v[4:7]
    s_add_u32 m0, s55, 77824
    s_nop 0
    buffer_load_dwordx4 v247, s[40:43], s54 offen lds
    s_add_u32 s54, s54, 65536
    v_mfma_f32_16x16x32_bf16 v[12:15], v[140:143], a[228:231], v[12:15]
    ds_read_b128 a[252:255], v226 offset:47104
    v_mfma_f32_16x16x32_bf16 v[8:11], v[136:139], a[228:231], v[8:11]
    s_waitcnt vmcnt(27)
    s_barrier
    s_waitcnt lgkmcnt(4)
    v_mfma_f32_16x16x32_bf16 v[16:19], v[136:139], a[232:235], v[16:19]
    ds_read_b128 a[224:227], v225 offset:49152
    v_mfma_f32_16x16x32_bf16 v[20:23], v[140:143], a[232:235], v[20:23]
    buffer_load_dwordx4 v[92:95], v224, s[36:39], s75 offen offset:1024 sc1
    v_mfma_f32_16x16x32_bf16 v[28:31], v[140:143], a[236:239], v[28:31]
    ds_read_b128 a[228:231], v225 offset:51200
    v_mfma_f32_16x16x32_bf16 v[24:27], v[136:139], a[236:239], v[24:27]
    buffer_load_dword v243, v245, s[44:47], 0 offen sc1
    s_waitcnt lgkmcnt(4)
    v_mfma_f32_16x16x32_bf16 v[32:35], v[136:139], a[240:243], v[32:35]
    ds_read_b128 a[232:235], v225 offset:53248
    v_mfma_f32_16x16x32_bf16 v[36:39], v[140:143], a[240:243], v[36:39]
    v_mfma_f32_16x16x32_bf16 v[44:47], v[140:143], a[244:247], v[44:47]
    ds_read_b128 a[236:239], v225 offset:55296
    v_mfma_f32_16x16x32_bf16 v[40:43], v[136:139], a[244:247], v[40:43]
    buffer_load_dwordx4 v[112:115], v224, s[36:39], s67 offen offset:0 sc1
    s_waitcnt lgkmcnt(4)
    v_mfma_f32_16x16x32_bf16 v[48:51], v[136:139], a[248:251], v[48:51]
    ds_read_b128 a[240:243], v225 offset:57344
    v_mfma_f32_16x16x32_bf16 v[52:55], v[140:143], a[248:251], v[52:55]
    s_add_u32 m0, s55, 81920
    s_nop 0
    buffer_load_dwordx4 v247, s[40:43], s54 offen lds
    s_add_u32 s54, s54, 65536
    v_mfma_f32_16x16x32_bf16 v[60:63], v[140:143], a[252:255], v[60:63]
    ds_read_b128 a[244:247], v225 offset:59392
    v_mfma_f32_16x16x32_bf16 v[56:59], v[136:139], a[252:255], v[56:59]
    s_waitcnt lgkmcnt(4)
    v_mfma_f32_16x16x32_bf16 v[0:3], v[144:147], a[224:227], v[0:3]
    ds_read_b128 a[248:251], v225 offset:61440
    v_mfma_f32_16x16x32_bf16 v[4:7], v[148:151], a[224:227], v[4:7]
    buffer_load_dwordx4 v[116:119], v224, s[36:39], s67 offen offset:1024 sc1
    v_mfma_f32_16x16x32_bf16 v[12:15], v[148:151], a[228:231], v[12:15]
    ds_read_b128 a[252:255], v225 offset:63488
    v_mfma_f32_16x16x32_bf16 v[8:11], v[144:147], a[228:231], v[8:11]
    s_waitcnt lgkmcnt(4)
    v_mfma_f32_16x16x32_bf16 v[16:19], v[144:147], a[232:235], v[16:19]
    ds_read_b128 a[224:227], v226 offset:49152
    v_mfma_f32_16x16x32_bf16 v[20:23], v[148:151], a[232:235], v[20:23]
    s_add_u32 m0, s55, 86016
    s_nop 0
    buffer_load_dwordx4 v247, s[40:43], s54 offen lds
    s_add_u32 s54, s54, 65536
    v_mfma_f32_16x16x32_bf16 v[28:31], v[148:151], a[236:239], v[28:31]
    ds_read_b128 a[228:231], v226 offset:51200
    v_mfma_f32_16x16x32_bf16 v[24:27], v[144:147], a[236:239], v[24:27]
    buffer_load_dwordx4 v[120:123], v224, s[36:39], s67 offen offset:2048 sc1
    s_waitcnt lgkmcnt(4)
    v_mfma_f32_16x16x32_bf16 v[32:35], v[144:147], a[240:243], v[32:35]
    ds_read_b128 a[232:235], v226 offset:53248
    v_mfma_f32_16x16x32_bf16 v[36:39], v[148:151], a[240:243], v[36:39]
    v_mfma_f32_16x16x32_bf16 v[44:47], v[148:151], a[244:247], v[44:47]
    ds_read_b128 a[236:239], v226 offset:55296
    v_mfma_f32_16x16x32_bf16 v[40:43], v[144:147], a[244:247], v[40:43]
    s_add_u32 m0, s55, 90112
    s_nop 0
    buffer_load_dwordx4 v247, s[40:43], s54 offen lds
    s_add_u32 s54, s54, 65536
    s_waitcnt lgkmcnt(4)
    v_mfma_f32_16x16x32_bf16 v[48:51], v[144:147], a[248:251], v[48:51]
    ds_read_b128 a[240:243], v226 offset:57344
    v_mfma_f32_16x16x32_bf16 v[52:55], v[148:151], a[248:251], v[52:55]
    buffer_load_dwordx4 v[124:127], v224, s[36:39], s67 offen offset:3072 sc1
    s_add_u32 s67, s67, 4096
    v_mfma_f32_16x16x32_bf16 v[60:63], v[148:151], a[252:255], v[60:63]
    s_branch L_po_K_4
.p2align 12
L_pg_K_4:
    s_branch L_pg_K_7
L_po_K_4:
    ds_read_b128 a[244:247], v226 offset:59392
    v_mfma_f32_16x16x32_bf16 v[56:59], v[144:147], a[252:255], v[56:59]
    s_waitcnt lgkmcnt(4)
    v_mfma_f32_16x16x32_bf16 v[0:3], v[152:155], a[224:227], v[0:3]
    ds_read_b128 a[248:251], v226 offset:61440
    v_mfma_f32_16x16x32_bf16 v[4:7], v[156:159], a[224:227], v[4:7]
    s_add_u32 m0, s55, 94208
    s_nop 0
    buffer_load_dwordx4 v247, s[40:43], s54 offen lds
    s_add_u32 s54, s54, 65536
    v_mfma_f32_16x16x32_bf16 v[12:15], v[156:159], a[228:231], v[12:15]
    ds_read_b128 a[252:255], v226 offset:63488
    v_mfma_f32_16x16x32_bf16 v[8:11], v[152:155], a[228:231], v[8:11]
    s_waitcnt vmcnt(28)
    s_barrier
    s_waitcnt vmcnt(8)
    v_cmp_ne_u32 vcc, s26, v243
    s_nop 0
    s_cmp_eq_u64 vcc, 0
    s_cbranch_scc0 L_check_57
L_check_ret_58:
    s_mov_b32 s82, 0
    s_cmp_lt_u32 s97, 43
    s_cbranch_scc1 L_noz1_59
    s_cmp_lg_u32 s3, 3
    s_cbranch_scc1 L_noz1_59
    s_mov_b32 s82, 1
    s_bitset0_b32 s72, 30
    s_bitset0_b32 s73, 30
    s_bitset0_b32 s74, 30
    s_bitset0_b32 s75, 30
    buffer_load_dwordx4 v[64:67], v224, s[36:39], s72 offen offset:0 sc1
    buffer_load_dwordx4 v[68:71], v224, s[36:39], s72 offen offset:1024 sc1
    buffer_load_dwordx4 v[72:75], v224, s[36:39], s73 offen offset:0 sc1
    buffer_load_dwordx4 v[76:79], v224, s[36:39], s73 offen offset:1024 sc1
    buffer_load_dwordx4 v[80:83], v224, s[36:39], s74 offen offset:0 sc1
    buffer_load_dwordx4 v[84:87], v224, s[36:39], s74 offen offset:1024 sc1
    buffer_load_dwordx4 v[88:91], v224, s[36:39], s75 offen offset:0 sc1
    buffer_load_dwordx4 v[92:95], v224, s[36:39], s75 offen offset:1024 sc1
L_noz1_59:
    s_waitcnt lgkmcnt(4)
    v_mfma_f32_16x16x32_bf16 v[16:19], v[152:155], a[232:235], v[16:19]
    ds_read_b128 a[224:227], v227 offset:0
    v_mfma_f32_16x16x32_bf16 v[20:23], v[156:159], a[232:235], v[20:23]
    buffer_load_dwordx4 v[128:131], v224, s[36:39], s67 offen offset:0 sc1
    v_mfma_f32_16x16x32_bf16 v[28:31], v[156:159], a[236:239], v[28:31]
    ds_read_b128 a[228:231], v227 offset:2048
    v_mfma_f32_16x16x32_bf16 v[24:27], v[152:155], a[236:239], v[24:27]
    s_waitcnt lgkmcnt(4)
    v_mfma_f32_16x16x32_bf16 v[32:35], v[152:155], a[240:243], v[32:35]
    ds_read_b128 a[232:235], v227 offset:4096
    v_mfma_f32_16x16x32_bf16 v[36:39], v[156:159], a[240:243], v[36:39]
    s_add_u32 m0, s55, 98304
    s_nop 0
    buffer_load_dwordx4 v247, s[40:43], s54 offen lds
    s_add_u32 s54, s54, 65536
    v_mfma_f32_16x16x32_bf16 v[44:47], v[156:159], a[244:247], v[44:47]
    ds_read_b128 a[236:239], v227 offset:6144
    v_mfma_f32_16x16x32_bf16 v[40:43], v[152:155], a[244:247], v[40:43]
    s_waitcnt lgkmcnt(4)
    v_mfma_f32_16x16x32_bf16 v[48:51], v[152:155], a[248:251], v[48:51]
    ds_read_b128 a[240:243], v227 offset:8192
    v_mfma_f32_16x16x32_bf16 v[52:55], v[156:159], a[248:251], v[52:55]
    buffer_load_dwordx4 v[132:135], v224, s[36:39], s67 offen offset:1024 sc1
    v_mfma_f32_16x16x32_bf16 v[60:63], v[156:159], a[252:255], v[60:63]
    ds_read_b128 a[244:247], v227 offset:10240
    v_mfma_f32_16x16x32_bf16 v[56:59], v[152:155], a[252:255], v[56:59]
    s_waitcnt lgkmcnt(4)
    v_mfma_f32_16x16x32_bf16 v[0:3], v[160:163], a[224:227], v[0:3]
    ds_read_b128 a[248:251], v227 offset:12288
    v_mfma_f32_16x16x32_bf16 v[4:7], v[164:167], a[224:227], v[4:7]
    s_add_u32 m0, s55, 102400
    s_nop 0
    buffer_load_dwordx4 v247, s[40:43], s54 offen lds
    s_add_u32 s54, s54, 65536
    v_mfma_f32_16x16x32_bf16 v[12:15], v[164:167], a[228:231], v[12:15]
    ds_read_b128 a[252:255], v227 offset:14336
    v_mfma_f32_16x16x32_bf16 v[8:11], v[160:163], a[228:231], v[8:11]
    s_waitcnt lgkmcnt(4)
    v_mfma_f32_16x16x32_bf16 v[16:19], v[160:163], a[232:235], v[16:19]
    ds_read_b128 a[224:227], v228 offset:0
    v_mfma_f32_16x16x32_bf16 v[20:23], v[164:167], a[232:235], v[20:23]
    buffer_load_dwordx4 v[136:139], v224, s[36:39], s67 offen offset:2048 sc1
    v_mfma_f32_16x16x32_bf16 v[28:31], v[164:167], a[236:239], v[28:31]
    ds_read_b128 a[228:231], v228 offset:2048
    v_mfma_f32_16x16x32_bf16 v[24:27], v[160:163], a[236:239], v[24:27]
    s_waitcnt lgkmcnt(4)
    v_mfma_f32_16x16x32_bf16 v[32:35], v[160:163], a[240:243], v[32:35]
    ds_read_b128 a[232:235], v228 offset:4096
    v_mfma_f32_16x16x32_bf16 v[36:39], v[164:167], a[240:243], v[36:39]
    s_add_u32 m0, s55, 106496
    s_nop 0
    buffer_load_dwordx4 v247, s[40:43], s54 offen lds
    s_add_u32 s54, s54, 65536
    v_mfma_f32_16x16x32_bf16 v[44:47], v[164:167], a[244:247], v[44:47]
    ds_read_b128 a[236:239], v228 offset:6144
    v_mfma_f32_16x16x32_bf16 v[40:43], v[160:163], a[244:247], v[40:43]
    s_waitcnt lgkmcnt(4)
    v_mfma_f32_16x16x32_bf16 v[48:51], v[160:163], a[248:251], v[48:51]
    ds_read_b128 a[240:243], v228 offset:8192
    v_mfma_f32_16x16x32_bf16 v[52:55], v[164:167], a[248:251], v[52:55]
    buffer_load_dwordx4 v[140:143], v224, s[36:39], s67 offen offset:3072 sc1
    s_add_u32 s67, s67, 8192
    v_mfma_f32_16x16x32_bf16 v[60:63], v[164:167], a[252:255], v[60:63]
    ds_read_b128 a[244:247], v228 offset:10240
    v_mfma_f32_16x16x32_bf16 v[56:59], v[160:163], a[252:255], v[56:59]
    s_waitcnt lgkmcnt(4)
    v_mfma_f32_16x16x32_bf16 v[0:3], v[168:171], a[224:227], v[0:3]
    ds_read_b128 a[248:251], v228 offset:12288
    v_mfma_f32_16x16x32_bf16 v[4:7], v[172:175], a[224:227], v[4:7]
    s_add_u32 m0, s55, 110592
    s_nop 0
    buffer_load_dwordx4 v247, s[40:43], s54 offen lds
    s_add_u32 s54, s54, 65536
    v_mfma_f32_16x16x32_bf16 v[12:15], v[172:175], a[228:231], v[12:15]
    ds_read_b128 a[252:255], v228 offset:14336
    v_mfma_f32_16x16x32_bf16 v[8:11], v[168:171], a[228:231], v[8:11]
    s_barrier
    s_waitcnt lgkmcnt(4)
    v_mfma_f32_16x16x32_bf16 v[16:19], v[168:171], a[232:235], v[16:19]
    ds_read_b128 a[224:227], v227 offset:16384
    v_mfma_f32_16x16x32_bf16 v[20:23], v[172:175], a[232:235], v[20:23]
    buffer_load_dwordx4 v[144:147], v224, s[36:39], s67 offen offset:0 sc1
    v_mfma_f32_16x16x32_bf16 v[28:31], v[172:175], a[236:239], v[28:31]
    ds_read_b128 a[228:231], v227 offset:18432
    v_mfma_f32_16x16x32_bf16 v[24:27], v[168:171], a[236:239], v[24:27]
    s_waitcnt lgkmcnt(4)
    v_mfma_f32_16x16x32_bf16 v[32:35], v[168:171], a[240:243], v[32:35]
    ds_read_b128 a[232:235], v227 offset:20480
    v_mfma_f32_16x16x32_bf16 v[36:39], v[172:175], a[240:243], v[36:39]
    s_add_u32 m0, s55, 114688
    s_nop 0
    buffer_load_dwordx4 v247, s[40:43], s54 offen lds
    s_add_u32 s54, s54, 65536
    v_mfma_f32_16x16x32_bf16 v[44:47], v[172:175], a[244:247], v[44:47]
    ds_read_b128 a[236:239], v227 offset:22528
    v_mfma_f32_16x16x32_bf16 v[40:43], v[168:171], a[244:247], v[40:43]
    s_waitcnt lgkmcnt(4)
    v_mfma_f32_16x16x32_bf16 v[48:51], v[168:171], a[248:251], v[48:51]
    ds_read_b128 a[240:243], v227 offset:24576
    v_mfma_f32_16x16x32_bf16 v[52:55], v[172:175], a[248:251], v[52:55]
    buffer_load_dwordx4 v[148:151], v224, s[36:39], s67 offen offset:1024 sc1
    v_mfma_f32_16x16x32_bf16 v[60:63], v[172:175], a[252:255], v[60:63]
    ds_read_b128 a[244:247], v227 offset:26624
    v_mfma_f32_16x16x32_bf16 v[56:59], v[168:171], a[252:255], v[56:59]
    s_waitcnt lgkmcnt(4)
    v_mfma_f32_16x16x32_bf16 v[0:3], v[176:179], a[224:227], v[0:3]
    ds_read_b128 a[248:251], v227 offset:28672
    v_mfma_f32_16x16x32_bf16 v[4:7], v[180:183], a[224:227], v[4:7]
    s_add_u32 m0, s55, 118784
    s_nop 0
    buffer_load_dwordx4 v247, s[40:43], s54 offen lds
    s_add_u32 s54, s54, 65536
    v_mfma_f32_16x16x32_bf16 v[12:15], v[180:183], a[228:231], v[12:15]
    ds_read_b128 a[252:255], v227 offset:30720
    v_mfma_f32_16x16x32_bf16 v[8:11], v[176:179], a[228:231], v[8:11]
    s_waitcnt lgkmcnt(4)
    v_mfma_f32_16x16x32_bf16 v[16:19], v[176:179], a[232:235], v[16:19]
    ds_read_b128 a[224:227], v228 offset:16384
    v_mfma_f32_16x16x32_bf16 v[20:23], v[180:183], a[232:235], v[20:23]
    buffer_load_dwordx4 v[152:155], v224, s[36:39], s67 offen offset:2048 sc1
    v_mfma_f32_16x16x32_bf16 v[28:31], v[180:183], a[236:239], v[28:31]
    ds_read_b128 a[228:231], v228 offset:18432
    v_mfma_f32_16x16x32_bf16 v[24:27], v[176:179], a[236:239], v[24:27]
    s_waitcnt lgkmcnt(4)
    v_mfma_f32_16x16x32_bf16 v[32:35], v[176:179], a[240:243], v[32:35]
    ds_read_b128 a[232:235], v228 offset:20480
    v_mfma_f32_16x16x32_bf16 v[36:39], v[180:183], a[240:243], v[36:39]
    s_add_u32 m0, s55, 122880
    s_nop 0
    buffer_load_dwordx4 v247, s[40:43], s54 offen lds
    s_add_u32 s54, s54, 65536
    v_mfma_f32_16x16x32_bf16 v[44:47], v[180:183], a[244:247], v[44:47]
    ds_read_b128 a[236:239], v228 offset:22528
    v_mfma_f32_16x16x32_bf16 v[40:43], v[176:179], a[244:247], v[40:43]
    s_waitcnt lgkmcnt(4)
    v_mfma_f32_16x16x32_bf16 v[48:51], v[176:179], a[248:251], v[48:51]
    ds_read_b128 a[240:243], v228 offset:24576
    v_mfma_f32_16x16x32_bf16 v[52:55], v[180:183], a[248:251], v[52:55]
    buffer_load_dwordx4 v[156:159], v224, s[36:39], s67 offen offset:3072 sc1
    s_add_u32 s67, s67, 4096
    v_mfma_f32_16x16x32_bf16 v[60:63], v[180:183], a[252:255], v[60:63]
    ds_read_b128 a[244:247], v228 offset:26624
    v_mfma_f32_16x16x32_bf16 v[56:59], v[176:179], a[252:255], v[56:59]
    s_waitcnt lgkmcnt(4)
    v_mfma_f32_16x16x32_bf16 v[0:3], v[184:187], a[224:227], v[0:3]
    ds_read_b128 a[248:251], v228 offset:28672
    v_mfma_f32_16x16x32_bf16 v[4:7], v[188:191], a[224:227], v[4:7]
    s_add_u32 m0, s55, 126976
    s_nop 0
    buffer_load_dwordx4 v247, s[40:43], s54 offen lds
    s_add_u32 s54, s54, 65536
    v_mfma_f32_16x16x32_bf16 v[12:15], v[188:191], a[228:231], v[12:15]
    ds_read_b128 a[252:255], v228 offset:30720
    v_mfma_f32_16x16x32_bf16 v[8:11], v[184:187], a[228:231], v[8:11]
    s_waitcnt lgkmcnt(4)
    v_mfma_f32_16x16x32_bf16 v[16:19], v[184:187], a[232:235], v[16:19]
    v_mfma_f32_16x16x32_bf16 v[20:23], v[188:191], a[232:235], v[20:23]
    v_mfma_f32_16x16x32_bf16 v[28:31], v[188:191], a[236:239], v[28:31]
    v_mfma_f32_16x16x32_bf16 v[24:27], v[184:187], a[236:239], v[24:27]
    s_waitcnt lgkmcnt(2)
    v_mfma_f32_16x16x32_bf16 v[32:35], v[184:187], a[240:243], v[32:35]
    v_mfma_f32_16x16x32_bf16 v[36:39], v[188:191], a[240:243], v[36:39]
    v_mfma_f32_16x16x32_bf16 v[44:47], v[188:191], a[244:247], v[44:47]
    v_mfma_f32_16x16x32_bf16 v[40:43], v[184:187], a[244:247], v[40:43]
    s_waitcnt lgkmcnt(0)
    v_mfma_f32_16x16x32_bf16 v[48:51], v[184:187], a[248:251], v[48:51]
    v_mfma_f32_16x16x32_bf16 v[52:55], v[188:191], a[248:251], v[52:55]
    v_mfma_f32_16x16x32_bf16 v[60:63], v[188:191], a[252:255], v[60:63]
    v_mfma_f32_16x16x32_bf16 v[56:59], v[184:187], a[252:255], v[56:59]
    s_waitcnt vmcnt(16)
    v_lshlrev_b32 v246, 16, v64
    v_and_b32 v247, 0xffff0000, v64
    v_lshlrev_b32 v248, 16, v65
    v_and_b32 v249, 0xffff0000, v65
    v_lshlrev_b32 v250, 16, v66
    v_and_b32 v251, 0xffff0000, v66
    v_lshlrev_b32 v252, 16, v67
    v_and_b32 v253, 0xffff0000, v67
    v_pk_mul_f32 v[246:247], v[246:247], v[0:1]
    v_pk_mul_f32 v[248:249], v[248:249], v[2:3]
    v_pk_mul_f32 v[250:251], v[250:251], v[4:5]
    v_pk_mul_f32 v[252:253], v[252:253], v[6:7]
    v_cvt_pk_bf16_f32 v64, v246, v247
    v_cvt_pk_bf16_f32 v65, v248, v249
    v_cvt_pk_bf16_f32 v66, v250, v251
    v_cvt_pk_bf16_f32 v67, v252, v253
    buffer_store_dwordx4 v[64:67], v224, s[36:39], s76 offen offset:0 sc1
    v_lshlrev_b32 v246, 16, v68
    v_and_b32 v247, 0xffff0000, v68
    v_lshlrev_b32 v248, 16, v69
    v_and_b32 v249, 0xffff0000, v69
    v_lshlrev_b32 v250, 16, v70
    v_and_b32 v251, 0xffff0000, v70
    v_lshlrev_b32 v252, 16, v71
    v_and_b32 v253, 0xffff0000, v71
    v_pk_mul_f32 v[246:247], v[246:247], v[8:9]
    v_pk_mul_f32 v[248:249], v[248:249], v[10:11]
    v_pk_mul_f32 v[250:251], v[250:251], v[12:13]
    v_pk_mul_f32 v[252:253], v[252:253], v[14:15]
    v_cvt_pk_bf16_f32 v68, v246, v247
    v_cvt_pk_bf16_f32 v69, v248, v249
    v_cvt_pk_bf16_f32 v70, v250, v251
    v_cvt_pk_bf16_f32 v71, v252, v253
    buffer_store_dwordx4 v[68:71], v224, s[36:39], s76 offen offset:1024 sc1
    v_lshlrev_b32 v246, 16, v72
    v_and_b32 v247, 0xffff0000, v72
    v_lshlrev_b32 v248, 16, v73
    v_and_b32 v249, 0xffff0000, v73
    v_lshlrev_b32 v250, 16, v74
    v_and_b32 v251, 0xffff0000, v74
    v_lshlrev_b32 v252, 16, v75
    v_and_b32 v253, 0xffff0000, v75
    v_pk_mul_f32 v[246:247], v[246:247], v[16:17]
    v_pk_mul_f32 v[248:249], v[248:249], v[18:19]
    v_pk_mul_f32 v[250:251], v[250:251], v[20:21]
    v_pk_mul_f32 v[252:253], v[252:253], v[22:23]
    v_cvt_pk_bf16_f32 v72, v246, v247
    v_cvt_pk_bf16_f32 v73, v248, v249
    v_cvt_pk_bf16_f32 v74, v250, v251
    v_cvt_pk_bf16_f32 v75, v252, v253
    buffer_store_dwordx4 v[72:75], v224, s[36:39], s77 offen offset:0 sc1
    v_lshlrev_b32 v246, 16, v76
    v_and_b32 v247, 0xffff0000, v76
    v_lshlrev_b32 v248, 16, v77
    v_and_b32 v249, 0xffff0000, v77
    v_lshlrev_b32 v250, 16, v78
    v_and_b32 v251, 0xffff0000, v78
    v_lshlrev_b32 v252, 16, v79
    v_and_b32 v253, 0xffff0000, v79
    v_pk_mul_f32 v[246:247], v[246:247], v[24:25]
    v_pk_mul_f32 v[248:249], v[248:249], v[26:27]
    v_pk_mul_f32 v[250:251], v[250:251], v[28:29]
    v_pk_mul_f32 v[252:253], v[252:253], v[30:31]
    v_cvt_pk_bf16_f32 v76, v246, v247
    v_cvt_pk_bf16_f32 v77, v248, v249
    v_cvt_pk_bf16_f32 v78, v250, v251
    v_cvt_pk_bf16_f32 v79, v252, v253
    buffer_store_dwordx4 v[76:79], v224, s[36:39], s77 offen offset:1024 sc1
    v_lshlrev_b32 v246, 16, v80
    v_and_b32 v247, 0xffff0000, v80
    v_lshlrev_b32 v248, 16, v81
    v_and_b32 v249, 0xffff0000, v81
    v_lshlrev_b32 v250, 16, v82
    v_and_b32 v251, 0xffff0000, v82
    v_lshlrev_b32 v252, 16, v83
    v_and_b32 v253, 0xffff0000, v83
    v_pk_mul_f32 v[246:247], v[246:247], v[32:33]
    v_pk_mul_f32 v[248:249], v[248:249], v[34:35]
    v_pk_mul_f32 v[250:251], v[250:251], v[36:37]
    v_pk_mul_f32 v[252:253], v[252:253], v[38:39]
    v_cvt_pk_bf16_f32 v80, v246, v247
    v_cvt_pk_bf16_f32 v81, v248, v249
    v_cvt_pk_bf16_f32 v82, v250, v251
    v_cvt_pk_bf16_f32 v83, v252, v253
    buffer_store_dwordx4 v[80:83], v224, s[36:39], s78 offen offset:0 sc1
    v_lshlrev_b32 v246, 16, v84
    v_and_b32 v247, 0xffff0000, v84
    v_lshlrev_b32 v248, 16, v85
    v_and_b32 v249, 0xffff0000, v85
    v_lshlrev_b32 v250, 16, v86
    v_and_b32 v251, 0xffff0000, v86
    v_lshlrev_b32 v252, 16, v87
    v_and_b32 v253, 0xffff0000, v87
    v_pk_mul_f32 v[246:247], v[246:247], v[40:41]
    v_pk_mul_f32 v[248:249], v[248:249], v[42:43]
    v_pk_mul_f32 v[250:251], v[250:251], v[44:45]
    v_pk_mul_f32 v[252:253], v[252:253], v[46:47]
    v_cvt_pk_bf16_f32 v84, v246, v247
    v_cvt_pk_bf16_f32 v85, v248, v249
    v_cvt_pk_bf16_f32 v86, v250, v251
    v_cvt_pk_bf16_f32 v87, v252, v253
    buffer_store_dwordx4 v[84:87], v224, s[36:39], s78 offen offset:1024 sc1
    v_lshlrev_b32 v246, 16, v88
    v_and_b32 v247, 0xffff0000, v88
    v_lshlrev_b32 v248, 16, v89
    v_and_b32 v249, 0xffff0000, v89
    v_lshlrev_b32 v250, 16, v90
    v_and_b32 v251, 0xffff0000, v90
    v_lshlrev_b32 v252, 16, v91
    v_and_b32 v253, 0xffff0000, v91
    v_pk_mul_f32 v[246:247], v[246:247], v[48:49]
    v_pk_mul_f32 v[248:249], v[248:249], v[50:51]
    v_pk_mul_f32 v[250:251], v[250:251], v[52:53]
    v_pk_mul_f32 v[252:253], v[252:253], v[54:55]
    v_cvt_pk_bf16_f32 v88, v246, v247
    v_cvt_pk_bf16_f32 v89, v248, v249
    v_cvt_pk_bf16_f32 v90, v250, v251
    v_cvt_pk_bf16_f32 v91, v252, v253
    buffer_store_dwordx4 v[88:91], v224, s[36:39], s79 offen offset:0 sc1
    v_lshlrev_b32 v246, 16, v92
    v_and_b32 v247, 0xffff0000, v92
    v_lshlrev_b32 v248, 16, v93
    v_and_b32 v249, 0xffff0000, v93
    v_lshlrev_b32 v250, 16, v94
    v_and_b32 v251, 0xffff0000, v94
    v_lshlrev_b32 v252, 16, v95
    v_and_b32 v253, 0xffff0000, v95
    v_pk_mul_f32 v[246:247], v[246:247], v[56:57]
    v_pk_mul_f32 v[248:249], v[248:249], v[58:59]
    v_pk_mul_f32 v[250:251], v[250:251], v[60:61]
    v_pk_mul_f32 v[252:253], v[252:253], v[62:63]
    v_cvt_pk_bf16_f32 v92, v246, v247
    v_cvt_pk_bf16_f32 v93, v248, v249
    v_cvt_pk_bf16_f32 v94, v250, v251
    v_cvt_pk_bf16_f32 v95, v252, v253
    buffer_store_dwordx4 v[92:95], v224, s[36:39], s79 offen offset:1024 sc1
L_ujoin_60:
    s_barrier
    v_add_u32 v252, 0x20000, v237
    v_add_u32 v248, 0x20000, v229
    v_add_u32 v249, 0x20000, v230
    v_add_u32 v250, 0x20000, v231
    v_add_u32 v251, 0x20000, v232
    ds_read_b64_tr_b16 a[224:225], v229 offset:0
    ds_read_b64_tr_b16 a[226:227], v229 offset:2048
    ds_read_b64_tr_b16 a[228:229], v230 offset:0
    ds_read_b64_tr_b16 a[230:231], v230 offset:2048
    ds_read_b64_tr_b16 a[232:233], v231 offset:0
    ds_read_b64_tr_b16 a[234:235], v231 offset:2048
    ds_read_b64_tr_b16 a[236:237], v232 offset:0
    ds_read_b64_tr_b16 a[238:239], v232 offset:2048
    ds_read_b64_tr_b16 a[240:241], v229 offset:4096
    ds_read_b64_tr_b16 a[242:243], v229 offset:6144
    ds_read_b64_tr_b16 a[244:245], v230 offset:4096
    ds_read_b64_tr_b16 a[246:247], v230 offset:6144
    s_waitcnt lgkmcnt(8)
    v_mfma_f32_16x16x32_bf16 v[0:3], a[224:227], v[96:99], 0
    ds_read_b64_tr_b16 a[248:249], v231 offset:4096
    buffer_load_dwordx4 v[160:163], v224, s[36:39], s67 offen offset:0 sc1
    v_mfma_f32_16x16x32_bf16 v[16:19], a[224:227], v[100:103], 0
    ds_read_b64_tr_b16 a[250:251], v231 offset:6144
    v_mfma_f32_16x16x32_bf16 v[20:23], a[228:231], v[100:103], 0
    ds_read_b64_tr_b16 a[252:253], v232 offset:4096
    ds_read_b64_tr_b16 a[254:255], v232 offset:6144
    v_mfma_f32_16x16x32_bf16 v[4:7], a[228:231], v[96:99], 0
    buffer_load_dword v243, v240, s[44:47], 0 offen sc1
    ds_write_b128 v252, a[0:3] offset:0
    s_waitcnt lgkmcnt(9)
    v_mfma_f32_16x16x32_bf16 v[8:11], a[232:235], v[96:99], 0
    buffer_load_dwordx4 v[164:167], v224, s[36:39], s67 offen offset:1024 sc1
    v_mfma_f32_16x16x32_bf16 v[24:27], a[232:235], v[100:103], 0
    ds_read_b64_tr_b16 a[224:225], v229 offset:8192
    ds_read_b64_tr_b16 a[226:227], v229 offset:10240
    v_mfma_f32_16x16x32_bf16 v[28:31], a[236:239], v[100:103], 0
    ds_read_b64_tr_b16 a[228:229], v230 offset:8192
    ds_read_b64_tr_b16 a[230:231], v230 offset:10240
    v_mfma_f32_16x16x32_bf16 v[12:15], a[236:239], v[96:99], 0
    ds_write_b128 v252, a[4:7] offset:4096
    s_waitcnt lgkmcnt(10)
    v_mfma_f32_16x16x32_bf16 v[0:3], a[240:243], v[104:107], v[0:3]
    buffer_load_dwordx4 v[168:171], v224, s[36:39], s67 offen offset:2048 sc1
    v_mfma_f32_16x16x32_bf16 v[16:19], a[240:243], v[108:111], v[16:19]
    ds_read_b64_tr_b16 a[232:233], v231 offset:8192
    ds_read_b64_tr_b16 a[234:235], v231 offset:10240
    v_mfma_f32_16x16x32_bf16 v[20:23], a[244:247], v[108:111], v[20:23]
    ds_read_b64_tr_b16 a[236:237], v232 offset:8192
    v_mfma_f32_16x16x32_bf16 v[4:7], a[244:247], v[104:107], v[4:7]
    ds_read_b64_tr_b16 a[238:239], v232 offset:10240
    s_waitcnt lgkmcnt(10)
    v_mfma_f32_16x16x32_bf16 v[8:11], a[248:251], v[104:107], v[8:11]
    ds_read_b64_tr_b16 a[240:241], v229 offset:12288
    ds_read_b64_tr_b16 a[242:243], v229 offset:14336
    v_mfma_f32_16x16x32_bf16 v[24:27], a[248:251], v[108:111], v[24:27]
    buffer_load_dwordx4 v[172:175], v224, s[36:39], s67 offen offset:3072 sc1
    s_add_u32 s67, s67, 4096
    ds_write_b128 v252, a[8:11] offset:8192
    v_mfma_f32_16x16x32_bf16 v[28:31], a[252:255], v[108:111], v[28:31]
    v_mfma_f32_16x16x32_bf16 v[12:15], a[252:255], v[104:107], v[12:15]
    ds_read_b64_tr_b16 a[244:245], v230 offset:12288
    ds_read_b64_tr_b16 a[246:247], v230 offset:14336
    s_waitcnt lgkmcnt(10)
    v_mfma_f32_16x16x32_bf16 v[0:3], a[224:227], v[112:115], v[0:3]
    ds_read_b64_tr_b16 a[248:249], v231 offset:12288
    ds_read_b64_tr_b16 a[250:251], v231 offset:14336
    v_mfma_f32_16x16x32_bf16 v[16:19], a[224:227], v[116:119], v[16:19]
    buffer_load_dwordx4 v[176:179], v224, s[36:39], s67 offen offset:0 sc1
    ds_write_b128 v252, a[12:15] offset:12288
    v_mfma_f32_16x16x32_bf16 v[20:23], a[228:231], v[116:119], v[20:23]
    v_mfma_f32_16x16x32_bf16 v[4:7], a[228:231], v[112:115], v[4:7]
    ds_read_b64_tr_b16 a[252:253], v232 offset:12288
    ds_read_b64_tr_b16 a[254:255], v232 offset:14336
    s_waitcnt lgkmcnt(10)
    v_mfma_f32_16x16x32_bf16 v[8:11], a[232:235], v[112:115], v[8:11]
    ds_read_b64_tr_b16 a[224:225], v229 offset:16384
    buffer_load_dwordx4 v[180:183], v224, s[36:39], s67 offen offset:1024 sc1
    v_mfma_f32_16x16x32_bf16 v[24:27], a[232:235], v[116:119], v[24:27]
    ds_read_b64_tr_b16 a[226:227], v229 offset:18432
    v_mfma_f32_16x16x32_bf16 v[28:31], a[236:239], v[116:119], v[28:31]
    ds_read_b64_tr_b16 a[228:229], v230 offset:16384
    ds_read_b64_tr_b16 a[230:231], v230 offset:18432
    v_mfma_f32_16x16x32_bf16 v[12:15], a[236:239], v[112:115], v[12:15]
    ds_write_b128 v252, a[16:19] offset:16384
    s_waitcnt lgkmcnt(10)
    v_mfma_f32_16x16x32_bf16 v[0:3], a[240:243], v[120:123], v[0:3]
    buffer_load_dwordx4 v[184:187], v224, s[36:39], s67 offen offset:2048 sc1
    v_mfma_f32_16x16x32_bf16 v[16:19], a[240:243], v[124:127], v[16:19]
    ds_read_b64_tr_b16 a[232:233], v231 offset:16384
    ds_read_b64_tr_b16 a[234:235], v231 offset:18432
    v_mfma_f32_16x16x32_bf16 v[20:23], a[244:247], v[124:127], v[20:23]
    ds_read_b64_tr_b16 a[236:237], v232 offset:16384
    v_mfma_f32_16x16x32_bf16 v[4:7], a[244:247], v[120:123], v[4:7]
    ds_read_b64_tr_b16 a[238:239], v232 offset:18432
    s_waitcnt lgkmcnt(9)
    v_mfma_f32_16x16x32_bf16 v[8:11], a[248:251], v[120:123], v[8:11]
    ds_read_b64_tr_b16 a[240:241], v229 offset:20480
    ds_read_b64_tr_b16 a[242:243], v229 offset:22528
    v_mfma_f32_16x16x32_bf16 v[24:27], a[248:251], v[124:127], v[24:27]
    buffer_load_dwordx4 v[188:191], v224, s[36:39], s67 offen offset:3072 sc1
    s_add_u32 s67, s67, 8192
    ds_write_b128 v252, a[20:23] offset:20480
    v_mfma_f32_16x16x32_bf16 v[28:31], a[252:255], v[124:127], v[28:31]
    v_mfma_f32_16x16x32_bf16 v[12:15], a[252:255], v[120:123], v[12:15]
    ds_read_b64_tr_b16 a[244:245], v230 offset:20480
    ds_read_b64_tr_b16 a[246:247], v230 offset:22528
    s_waitcnt vmcnt(30) lgkmcnt(10)
    v_mfma_f32_16x16x32_bf16 v[0:3], a[224:227], v[128:131], v[0:3]
    ds_read_b64_tr_b16 a[248:249], v231 offset:20480
    ds_read_b64_tr_b16 a[250:251], v231 offset:22528
    v_mfma_f32_16x16x32_bf16 v[16:19], a[224:227], v[132:135], v[16:19]
    buffer_load_dwordx4 v[192:195], v224, s[36:39], s67 offen offset:0 sc1
    ds_write_b128 v252, a[24:27] offset:24576
    v_mfma_f32_16x16x32_bf16 v[20:23], a[228:231], v[132:135], v[20:23]
    v_mfma_f32_16x16x32_bf16 v[4:7], a[228:231], v[128:131], v[4:7]
    ds_read_b64_tr_b16 a[252:253], v232 offset:20480
    ds_read_b64_tr_b16 a[254:255], v232 offset:22528
    s_waitcnt lgkmcnt(10)
    v_mfma_f32_16x16x32_bf16 v[8:11], a[232:235], v[128:131], v[8:11]
    ds_read_b64_tr_b16 a[224:225], v229 offset:32768
    buffer_load_dwordx4 v[196:199], v224, s[36:39], s67 offen offset:1024 sc1
    v_mfma_f32_16x16x32_bf16 v[24:27], a[232:235], v[132:135], v[24:27]
    ds_read_b64_tr_b16 a[226:227], v229 offset:34816
    v_mfma_f32_16x16x32_bf16 v[28:31], a[236:239], v[132:135], v[28:31]
    ds_read_b64_tr_b16 a[228:229], v230 offset:32768
    ds_read_b64_tr_b16 a[230:231], v230 offset:34816
    v_mfma_f32_16x16x32_bf16 v[12:15], a[236:239], v[128:131], v[12:15]
    ds_write_b128 v252, a[28:31] offset:28672
    s_waitcnt vmcnt(28) lgkmcnt(10)
    v_mfma_f32_16x16x32_bf16 v[0:3], a[240:243], v[136:139], v[0:3]
    buffer_load_dwordx4 v[200:203], v224, s[36:39], s67 offen offset:2048 sc1
    v_mfma_f32_16x16x32_bf16 v[16:19], a[240:243], v[140:143], v[16:19]
    ds_read_b64_tr_b16 a[232:233], v231 offset:32768
    ds_read_b64_tr_b16 a[234:235], v231 offset:34816
    v_mfma_f32_16x16x32_bf16 v[20:23], a[244:247], v[140:143], v[20:23]
    ds_read_b64_tr_b16 a[236:237], v232 offset:32768
    v_mfma_f32_16x16x32_bf16 v[4:7], a[244:247], v[136:139], v[4:7]
    ds_read_b64_tr_b16 a[238:239], v232 offset:34816
    s_waitcnt lgkmcnt(9)
    v_mfma_f32_16x16x32_bf16 v[8:11], a[248:251], v[136:139], v[8:11]
    ds_read_b64_tr_b16 a[240:241], v229 offset:36864
    buffer_load_dwordx4 v[204:207], v224, s[36:39], s67 offen offset:3072 sc1
    v_mfma_f32_16x16x32_bf16 v[24:27], a[248:251], v[140:143], v[24:27]
    ds_read_b64_tr_b16 a[242:243], v229 offset:38912
    s_add_u32 s67, s67, 4096
    v_mfma_f32_16x16x32_bf16 v[28:31], a[252:255], v[140:143], v[28:31]
    ds_read_b64_tr_b16 a[244:245], v230 offset:36864
    v_mfma_f32_16x16x32_bf16 v[12:15], a[252:255], v[136:139], v[12:15]
    ds_read_b64_tr_b16 a[246:247], v230 offset:38912
    s_waitcnt vmcnt(13)
    s_barrier
    s_cmp_eq_u32 s62, 0
    s_cbranch_scc1 L_nouf_61
    s_cmp_lg_u32 s3, 0
    s_cbranch_scc1 L_noflag_62
    v_mbcnt_lo_u32_b32 v247, -1, 0
    v_mov_b32 v246, s26
    v_lshlrev_b32 v247, 2, v247
    s_mov_b32 exec_hi, 0
    buffer_store_dword v246, v247, s[44:47], s66 offen sc1
    s_mov_b64 exec, -1
L_noflag_62:
L_nouf_61:
    s_waitcnt lgkmcnt(9)
    v_mfma_f32_16x16x32_bf16 v[0:3], a[224:227], v[144:147], v[0:3]
    ds_read_b64_tr_b16 a[248:249], v231 offset:36864
    buffer_load_dwordx4 v[208:211], v224, s[36:39], s67 offen offset:0 sc1
    v_mfma_f32_16x16x32_bf16 v[16:19], a[224:227], v[148:151], v[16:19]
    ds_read_b64_tr_b16 a[250:251], v231 offset:38912
    v_mfma_f32_16x16x32_bf16 v[20:23], a[228:231], v[148:151], v[20:23]
    ds_read_b64_tr_b16 a[252:253], v232 offset:36864
    ds_read_b64_tr_b16 a[254:255], v232 offset:38912
    v_mfma_f32_16x16x32_bf16 v[4:7], a[228:231], v[144:147], v[4:7]
    ds_write_b128 v237, a[32:35] offset:0
    s_waitcnt lgkmcnt(9)
    v_mfma_f32_16x16x32_bf16 v[8:11], a[232:235], v[144:147], v[8:11]
    buffer_load_dwordx4 v[212:215], v224, s[36:39], s67 offen offset:1024 sc1
    v_mfma_f32_16x16x32_bf16 v[24:27], a[232:235], v[148:151], v[24:27]
    ds_read_b64_tr_b16 a[224:225], v229 offset:40960
    ds_read_b64_tr_b16 a[226:227], v229 offset:43008
    v_mfma_f32_16x16x32_bf16 v[28:31], a[236:239], v[148:151], v[28:31]
    ds_read_b64_tr_b16 a[228:229], v230 offset:40960
    v_mfma_f32_16x16x32_bf16 v[12:15], a[236:239], v[144:147], v[12:15]
    ds_read_b64_tr_b16 a[230:231], v230 offset:43008
    s_waitcnt lgkmcnt(9)
    v_mfma_f32_16x16x32_bf16 v[0:3], a[240:243], v[152:155], v[0:3]
    ds_read_b64_tr_b16 a[232:233], v231 offset:40960
    buffer_load_dwordx4 v[216:219], v224, s[36:39], s67 offen offset:2048 sc1
    v_mfma_f32_16x16x32_bf16 v[16:19], a[240:243], v[156:159], v[16:19]
    ds_read_b64_tr_b16 a[234:235], v231 offset:43008
    v_mfma_f32_16x16x32_bf16 v[20:23], a[244:247], v[156:159], v[20:23]
    ds_read_b64_tr_b16 a[236:237], v232 offset:40960
    v_mfma_f32_16x16x32_bf16 v[4:7], a[244:247], v[152:155], v[4:7]
    ds_read_b64_tr_b16 a[238:239], v232 offset:43008
    s_waitcnt lgkmcnt(9)
    v_mfma_f32_16x16x32_bf16 v[8:11], a[248:251], v[152:155], v[8:11]
    ds_read_b64_tr_b16 a[240:241], v229 offset:45056
    ds_read_b64_tr_b16 a[242:243], v229 offset:47104
    v_mfma_f32_16x16x32_bf16 v[24:27], a[248:251], v[156:159], v[24:27]
    buffer_load_dwordx4 v[220:223], v224, s[36:39], s67 offen offset:3072 sc1
    s_add_u32 s67, s67, 4096
    ds_write_b128 v237, a[36:39] offset:4096
    v_mfma_f32_16x16x32_bf16 v[28:31], a[252:255], v[156:159], v[28:31]
    v_mfma_f32_16x16x32_bf16 v[12:15], a[252:255], v[152:155], v[12:15]
    ds_read_b64_tr_b16 a[244:245], v230 offset:45056
    ds_read_b64_tr_b16 a[246:247], v230 offset:47104
    s_waitcnt vmcnt(14) lgkmcnt(9)
    v_mfma_f32_16x16x32_bf16 v[0:3], a[224:227], v[160:163], v[0:3]
    ds_read_b64_tr_b16 a[248:249], v231 offset:45056
    buffer_load_dwordx4 v[96:99], v224, s[36:39], s67 offen offset:0 sc1
    v_mfma_f32_16x16x32_bf16 v[16:19], a[224:227], v[164:167], v[16:19]
    ds_read_b64_tr_b16 a[250:251], v231 offset:47104
    v_mfma_f32_16x16x32_bf16 v[20:23], a[228:231], v[164:167], v[20:23]
    ds_read_b64_tr_b16 a[252:253], v232 offset:45056
    v_mfma_f32_16x16x32_bf16 v[4:7], a[228:231], v[160:163], v[4:7]
    ds_read_b64_tr_b16 a[254:255], v232 offset:47104
    s_waitcnt lgkmcnt(9)
    v_mfma_f32_16x16x32_bf16 v[8:11], a[232:235], v[160:163], v[8:11]
    s_branch L_po_K_5
.p2align 12
L_pg_K_5:
    s_branch L_pg_K_8
L_po_K_5:
    ds_read_b64_tr_b16 a[224:225], v229 offset:49152
    buffer_load_dwordx4 v[100:103], v224, s[36:39], s67 offen offset:1024 sc1
    v_mfma_f32_16x16x32_bf16 v[24:27], a[232:235], v[164:167], v[24:27]
    ds_read_b64_tr_b16 a[226:227], v229 offset:51200
    v_mfma_f32_16x16x32_bf16 v[28:31], a[236:239], v[164:167], v[28:31]
    ds_read_b64_tr_b16 a[228:229], v230 offset:49152
    ds_read_b64_tr_b16 a[230:231], v230 offset:51200
    v_mfma_f32_16x16x32_bf16 v[12:15], a[236:239], v[160:163], v[12:15]
    ds_write_b128 v237, a[40:43] offset:8192
    s_waitcnt vmcnt(14) lgkmcnt(9)
    v_mfma_f32_16x16x32_bf16 v[0:3], a[240:243], v[168:171], v[0:3]
    buffer_load_dwordx4 v[104:107], v224, s[36:39], s67 offen offset:2048 sc1
    v_mfma_f32_16x16x32_bf16 v[16:19], a[240:243], v[172:175], v[16:19]
    ds_read_b64_tr_b16 a[232:233], v231 offset:49152
    ds_read_b64_tr_b16 a[234:235], v231 offset:51200
    v_mfma_f32_16x16x32_bf16 v[20:23], a[244:247], v[172:175], v[20:23]
    ds_read_b64_tr_b16 a[236:237], v232 offset:49152
    v_mfma_f32_16x16x32_bf16 v[4:7], a[244:247], v[168:171], v[4:7]
    ds_read_b64_tr_b16 a[238:239], v232 offset:51200
    s_waitcnt lgkmcnt(9)
    v_mfma_f32_16x16x32_bf16 v[8:11], a[248:251], v[168:171], v[8:11]
    ds_read_b64_tr_b16 a[240:241], v229 offset:53248
    buffer_load_dwordx4 v[108:111], v224, s[36:39], s67 offen offset:3072 sc1
    v_mfma_f32_16x16x32_bf16 v[24:27], a[248:251], v[172:175], v[24:27]
    ds_read_b64_tr_b16 a[242:243], v229 offset:55296
    s_add_u32 s67, s67, 8192
    v_mfma_f32_16x16x32_bf16 v[28:31], a[252:255], v[172:175], v[28:31]
    ds_read_b64_tr_b16 a[244:245], v230 offset:53248
    v_mfma_f32_16x16x32_bf16 v[12:15], a[252:255], v[168:171], v[12:15]
    ds_read_b64_tr_b16 a[246:247], v230 offset:55296
    s_waitcnt vmcnt(14) lgkmcnt(9)
    v_mfma_f32_16x16x32_bf16 v[0:3], a[224:227], v[176:179], v[0:3]
    ds_read_b64_tr_b16 a[248:249], v231 offset:53248
    ds_read_b64_tr_b16 a[250:251], v231 offset:55296
    v_mfma_f32_16x16x32_bf16 v[16:19], a[224:227], v[180:183], v[16:19]
    buffer_load_dwordx4 v[112:115], v224, s[36:39], s67 offen offset:0 sc1
    ds_write_b128 v237, a[44:47] offset:12288
    v_mfma_f32_16x16x32_bf16 v[20:23], a[228:231], v[180:183], v[20:23]
    s_mov_b32 s40, s4
    v_mfma_f32_16x16x32_bf16 v[4:7], a[228:231], v[176:179], v[4:7]
    ds_read_b64_tr_b16 a[252:253], v232 offset:53248
    ds_read_b64_tr_b16 a[254:255], v232 offset:55296
    s_waitcnt lgkmcnt(9)
    v_mfma_f32_16x16x32_bf16 v[8:11], a[232:235], v[176:179], v[8:11]
    ds_read_b64_tr_b16 a[224:225], v233 offset:0
    buffer_load_dwordx4 v[116:119], v224, s[36:39], s67 offen offset:1024 sc1
    v_mfma_f32_16x16x32_bf16 v[24:27], a[232:235], v[180:183], v[24:27]
    ds_read_b64_tr_b16 a[226:227], v233 offset:2048
    v_mfma_f32_16x16x32_bf16 v[28:31], a[236:239], v[180:183], v[28:31]
    ds_read_b64_tr_b16 a[228:229], v234 offset:0
    s_mov_b32 s41, s5
    v_mfma_f32_16x16x32_bf16 v[12:15], a[236:239], v[176:179], v[12:15]
    ds_read_b64_tr_b16 a[230:231], v234 offset:2048
    s_waitcnt vmcnt(14) lgkmcnt(9)
    v_mfma_f32_16x16x32_bf16 v[0:3], a[240:243], v[184:187], v[0:3]
    ds_read_b64_tr_b16 a[232:233], v235 offset:0
    buffer_load_dwordx4 v[120:123], v224, s[36:39], s67 offen offset:2048 sc1
    v_mfma_f32_16x16x32_bf16 v[16:19], a[240:243], v[188:191], v[16:19]
    ds_read_b64_tr_b16 a[234:235], v235 offset:2048
    v_mfma_f32_16x16x32_bf16 v[20:23], a[244:247], v[188:191], v[20:23]
    ds_read_b64_tr_b16 a[236:237], v236 offset:0
    ds_read_b64_tr_b16 a[238:239], v236 offset:2048
    v_mfma_f32_16x16x32_bf16 v[4:7], a[244:247], v[184:187], v[4:7]
    s_mov_b32 s42, 0x400000
    ds_write_b128 v237, a[48:51] offset:16384
    s_waitcnt lgkmcnt(9)
    v_mfma_f32_16x16x32_bf16 v[8:11], a[248:251], v[184:187], v[8:11]
    buffer_load_dwordx4 v[124:127], v224, s[36:39], s67 offen offset:3072 sc1
    s_add_u32 s67, s67, 4096
    v_mfma_f32_16x16x32_bf16 v[24:27], a[248:251], v[188:191], v[24:27]
    ds_read_b64_tr_b16 a[240:241], v233 offset:4096
    ds_read_b64_tr_b16 a[242:243], v233 offset:6144
    v_mfma_f32_16x16x32_bf16 v[28:31], a[252:255], v[188:191], v[28:31]
    ds_read_b64_tr_b16 a[244:245], v234 offset:4096
    s_mov_b32 s43, 0x20000
    v_mfma_f32_16x16x32_bf16 v[12:15], a[252:255], v[184:187], v[12:15]
    ds_read_b64_tr_b16 a[246:247], v234 offset:6144
    s_waitcnt vmcnt(14) lgkmcnt(9)
    v_mfma_f32_16x16x32_bf16 v[0:3], a[224:227], v[192:195], v[0:3]
    ds_read_b64_tr_b16 a[248:249], v235 offset:4096
    buffer_load_dwordx4 v[128:131], v224, s[36:39], s67 offen offset:0 sc1
    v_mfma_f32_16x16x32_bf16 v[16:19], a[224:227], v[196:199], v[16:19]
    ds_read_b64_tr_b16 a[250:251], v235 offset:6144
    v_mfma_f32_16x16x32_bf16 v[20:23], a[228:231], v[196:199], v[20:23]
    ds_read_b64_tr_b16 a[252:253], v236 offset:4096
    s_mov_b32 s32, s20
    v_mfma_f32_16x16x32_bf16 v[4:7], a[228:231], v[192:195], v[4:7]
    ds_read_b64_tr_b16 a[254:255], v236 offset:6144
    s_waitcnt lgkmcnt(9)
    v_mfma_f32_16x16x32_bf16 v[8:11], a[232:235], v[192:195], v[8:11]
    ds_read_b64_tr_b16 a[224:225], v233 offset:8192
    ds_read_b64_tr_b16 a[226:227], v233 offset:10240
    v_mfma_f32_16x16x32_bf16 v[24:27], a[232:235], v[196:199], v[24:27]
    buffer_load_dwordx4 v[132:135], v224, s[36:39], s67 offen offset:1024 sc1
    ds_write_b128 v237, a[52:55] offset:20480
    v_mfma_f32_16x16x32_bf16 v[28:31], a[236:239], v[196:199], v[28:31]
    s_mov_b32 s33, s21
    v_mfma_f32_16x16x32_bf16 v[12:15], a[236:239], v[192:195], v[12:15]
    ds_read_b64_tr_b16 a[228:229], v234 offset:8192
    ds_read_b64_tr_b16 a[230:231], v234 offset:10240
    s_waitcnt vmcnt(14) lgkmcnt(9)
    v_mfma_f32_16x16x32_bf16 v[0:3], a[240:243], v[200:203], v[0:3]
    ds_read_b64_tr_b16 a[232:233], v235 offset:8192
    buffer_load_dwordx4 v[136:139], v224, s[36:39], s67 offen offset:2048 sc1
    v_mfma_f32_16x16x32_bf16 v[16:19], a[240:243], v[204:207], v[16:19]
    ds_read_b64_tr_b16 a[234:235], v235 offset:10240
    v_mfma_f32_16x16x32_bf16 v[20:23], a[244:247], v[204:207], v[20:23]
    ds_read_b64_tr_b16 a[236:237], v236 offset:8192
    s_mov_b32 s34, 0x400000
    v_mfma_f32_16x16x32_bf16 v[4:7], a[244:247], v[200:203], v[4:7]
    ds_read_b64_tr_b16 a[238:239], v236 offset:10240
    s_waitcnt lgkmcnt(9)
    v_mfma_f32_16x16x32_bf16 v[8:11], a[248:251], v[200:203], v[8:11]
    ds_read_b64_tr_b16 a[240:241], v233 offset:12288
    buffer_load_dwordx4 v[140:143], v224, s[36:39], s67 offen offset:3072 sc1
    v_mfma_f32_16x16x32_bf16 v[24:27], a[248:251], v[204:207], v[24:27]
    ds_read_b64_tr_b16 a[242:243], v233 offset:14336
    s_add_u32 s67, s67, 4096
    v_mfma_f32_16x16x32_bf16 v[28:31], a[252:255], v[204:207], v[28:31]
    ds_read_b64_tr_b16 a[244:245], v234 offset:12288
    s_mov_b32 s35, 0x20000
    v_mfma_f32_16x16x32_bf16 v[12:15], a[252:255], v[200:203], v[12:15]
    ds_read_b64_tr_b16 a[246:247], v234 offset:14336
    s_waitcnt vmcnt(14) lgkmcnt(8)
    v_mfma_f32_16x16x32_bf16 v[0:3], a[224:227], v[208:211], v[0:3]
    ds_read_b64_tr_b16 a[248:249], v235 offset:12288
    buffer_load_dwordx4 v[144:147], v224, s[36:39], s67 offen offset:0 sc1
    v_mfma_f32_16x16x32_bf16 v[16:19], a[224:227], v[212:215], v[16:19]
    ds_read_b64_tr_b16 a[250:251], v235 offset:14336
    v_mfma_f32_16x16x32_bf16 v[20:23], a[228:231], v[212:215], v[20:23]
    ds_read_b64_tr_b16 a[252:253], v236 offset:12288
    v_mfma_f32_16x16x32_bf16 v[4:7], a[228:231], v[208:211], v[4:7]
    ds_read_b64_tr_b16 a[254:255], v236 offset:14336
    s_barrier
    s_waitcnt lgkmcnt(8)
    v_mfma_f32_16x16x32_bf16 v[8:11], a[232:235], v[208:211], v[8:11]
    ds_read_b64_tr_b16 a[224:225], v233 offset:16384
    buffer_load_dwordx4 v[148:151], v224, s[36:39], s67 offen offset:1024 sc1
    v_mfma_f32_16x16x32_bf16 v[24:27], a[232:235], v[212:215], v[24:27]
    ds_read_b64_tr_b16 a[226:227], v233 offset:18432
    v_mfma_f32_16x16x32_bf16 v[28:31], a[236:239], v[212:215], v[28:31]
    ds_read_b64_tr_b16 a[228:229], v234 offset:16384
    ds_read_b64_tr_b16 a[230:231], v234 offset:18432
    v_mfma_f32_16x16x32_bf16 v[12:15], a[236:239], v[208:211], v[12:15]
    ds_write_b128 v237, a[56:59] offset:32768
    s_waitcnt vmcnt(14) lgkmcnt(9)
    v_mfma_f32_16x16x32_bf16 v[0:3], a[240:243], v[216:219], v[0:3]
    buffer_load_dwordx4 v[152:155], v224, s[36:39], s67 offen offset:2048 sc1
    v_mfma_f32_16x16x32_bf16 v[16:19], a[240:243], v[220:223], v[16:19]
    ds_read_b64_tr_b16 a[232:233], v235 offset:16384
    ds_read_b64_tr_b16 a[234:235], v235 offset:18432
    v_mfma_f32_16x16x32_bf16 v[20:23], a[244:247], v[220:223], v[20:23]
    ds_read_b64_tr_b16 a[236:237], v236 offset:16384
    v_mfma_f32_16x16x32_bf16 v[4:7], a[244:247], v[216:219], v[4:7]
    ds_read_b64_tr_b16 a[238:239], v236 offset:18432
    s_waitcnt lgkmcnt(9)
    v_mfma_f32_16x16x32_bf16 v[8:11], a[248:251], v[216:219], v[8:11]
    ds_read_b64_tr_b16 a[240:241], v233 offset:20480
    buffer_load_dwordx4 v[156:159], v224, s[36:39], s67 offen offset:3072 sc1
    v_mfma_f32_16x16x32_bf16 v[24:27], a[248:251], v[220:223], v[24:27]
    ds_read_b64_tr_b16 a[242:243], v233 offset:22528
    s_sub_u32 s67, s67, 45056
    v_mfma_f32_16x16x32_bf16 v[28:31], a[252:255], v[220:223], v[28:31]
    ds_read_b64_tr_b16 a[244:245], v234 offset:20480
    v_mfma_f32_16x16x32_bf16 v[12:15], a[252:255], v[216:219], v[12:15]
    ds_read_b64_tr_b16 a[246:247], v234 offset:22528
    v_cmp_ne_u32 vcc, s26, v243
    s_nop 0
    s_cmp_eq_u64 vcc, 0
    s_cbranch_scc0 L_check_63
L_check_ret_64:
    s_waitcnt vmcnt(14) lgkmcnt(9)
    v_mfma_f32_16x16x32_bf16 v[0:3], a[224:227], v[96:99], v[0:3]
    ds_read_b64_tr_b16 a[248:249], v235 offset:20480
    buffer_load_dwordx4 v[160:163], v224, s[36:39], s67 offen offset:0 sc1
    v_mfma_f32_16x16x32_bf16 v[16:19], a[224:227], v[100:103], v[16:19]
    ds_read_b64_tr_b16 a[250:251], v235 offset:22528
    v_mfma_f32_16x16x32_bf16 v[20:23], a[228:231], v[100:103], v[20:23]
    ds_read_b64_tr_b16 a[252:253], v236 offset:20480
    ds_read_b64_tr_b16 a[254:255], v236 offset:22528
    v_mfma_f32_16x16x32_bf16 v[4:7], a[228:231], v[96:99], v[4:7]
    ds_write_b128 v237, a[60:63] offset:36864
    s_waitcnt lgkmcnt(9)
    v_mfma_f32_16x16x32_bf16 v[8:11], a[232:235], v[96:99], v[8:11]
    buffer_load_dwordx4 v[164:167], v224, s[36:39], s67 offen offset:1024 sc1
    v_mfma_f32_16x16x32_bf16 v[24:27], a[232:235], v[100:103], v[24:27]
    ds_read_b64_tr_b16 a[224:225], v233 offset:32768
    ds_read_b64_tr_b16 a[226:227], v233 offset:34816
    v_mfma_f32_16x16x32_bf16 v[28:31], a[236:239], v[100:103], v[28:31]
    ds_read_b64_tr_b16 a[228:229], v234 offset:32768
    v_mfma_f32_16x16x32_bf16 v[12:15], a[236:239], v[96:99], v[12:15]
    ds_read_b64_tr_b16 a[230:231], v234 offset:34816
    s_waitcnt vmcnt(14) lgkmcnt(9)
    v_mfma_f32_16x16x32_bf16 v[0:3], a[240:243], v[104:107], v[0:3]
    ds_read_b64_tr_b16 a[232:233], v235 offset:32768
    buffer_load_dwordx4 v[168:171], v224, s[36:39], s67 offen offset:2048 sc1
    v_mfma_f32_16x16x32_bf16 v[16:19], a[240:243], v[108:111], v[16:19]
    ds_read_b64_tr_b16 a[234:235], v235 offset:34816
    v_mfma_f32_16x16x32_bf16 v[20:23], a[244:247], v[108:111], v[20:23]
    ds_read_b64_tr_b16 a[236:237], v236 offset:32768
    v_mfma_f32_16x16x32_bf16 v[4:7], a[244:247], v[104:107], v[4:7]
    ds_read_b64_tr_b16 a[238:239], v236 offset:34816
    s_waitcnt lgkmcnt(9)
    v_mfma_f32_16x16x32_bf16 v[8:11], a[248:251], v[104:107], v[8:11]
    ds_read_b64_tr_b16 a[240:241], v233 offset:36864
    buffer_load_dwordx4 v[172:175], v224, s[36:39], s67 offen offset:3072 sc1
    v_mfma_f32_16x16x32_bf16 v[24:27], a[248:251], v[108:111], v[24:27]
    ds_read_b64_tr_b16 a[242:243], v233 offset:38912
    s_add_u32 s67, s67, 16384
    v_mfma_f32_16x16x32_bf16 v[28:31], a[252:255], v[108:111], v[28:31]
    ds_read_b64_tr_b16 a[244:245], v234 offset:36864
    ds_read_b64_tr_b16 a[246:247], v234 offset:38912
    v_mfma_f32_16x16x32_bf16 v[12:15], a[252:255], v[104:107], v[12:15]
    ds_write_b128 v237, a[64:67] offset:40960
    s_waitcnt vmcnt(14) lgkmcnt(9)
    v_mfma_f32_16x16x32_bf16 v[0:3], a[224:227], v[112:115], v[0:3]
    buffer_load_dwordx4 v[176:179], v224, s[36:39], s67 offen offset:0 sc1
    v_mfma_f32_16x16x32_bf16 v[16:19], a[224:227], v[116:119], v[16:19]
    ds_read_b64_tr_b16 a[248:249], v235 offset:36864
    ds_read_b64_tr_b16 a[250:251], v235 offset:38912
    v_mfma_f32_16x16x32_bf16 v[20:23], a[228:231], v[116:119], v[20:23]
    ds_read_b64_tr_b16 a[252:253], v236 offset:36864
    v_mfma_f32_16x16x32_bf16 v[4:7], a[228:231], v[112:115], v[4:7]
    ds_read_b64_tr_b16 a[254:255], v236 offset:38912
    s_waitcnt lgkmcnt(9)
    v_mfma_f32_16x16x32_bf16 v[8:11], a[232:235], v[112:115], v[8:11]
    ds_read_b64_tr_b16 a[224:225], v233 offset:40960
    buffer_load_dwordx4 v[180:183], v224, s[36:39], s67 offen offset:1024 sc1
    v_mfma_f32_16x16x32_bf16 v[24:27], a[232:235], v[116:119], v[24:27]
    ds_read_b64_tr_b16 a[226:227], v233 offset:43008
    v_mfma_f32_16x16x32_bf16 v[28:31], a[236:239], v[116:119], v[28:31]
    ds_read_b64_tr_b16 a[228:229], v234 offset:40960
    v_mfma_f32_16x16x32_bf16 v[12:15], a[236:239], v[112:115], v[12:15]
    ds_read_b64_tr_b16 a[230:231], v234 offset:43008
    s_waitcnt vmcnt(14) lgkmcnt(9)
    v_mfma_f32_16x16x32_bf16 v[0:3], a[240:243], v[120:123], v[0:3]
    ds_read_b64_tr_b16 a[232:233], v235 offset:40960
    buffer_load_dwordx4 v[184:187], v224, s[36:39], s67 offen offset:2048 sc1
    v_mfma_f32_16x16x32_bf16 v[16:19], a[240:243], v[124:127], v[16:19]
    ds_read_b64_tr_b16 a[234:235], v235 offset:43008
    v_mfma_f32_16x16x32_bf16 v[20:23], a[244:247], v[124:127], v[20:23]
    ds_read_b64_tr_b16 a[236:237], v236 offset:40960
    ds_read_b64_tr_b16 a[238:239], v236 offset:43008
    v_mfma_f32_16x16x32_bf16 v[4:7], a[244:247], v[120:123], v[4:7]
    ds_write_b128 v237, a[68:71] offset:45056
    s_waitcnt lgkmcnt(9)
    v_mfma_f32_16x16x32_bf16 v[8:11], a[248:251], v[120:123], v[8:11]
    buffer_load_dwordx4 v[188:191], v224, s[36:39], s67 offen offset:3072 sc1
    s_add_u32 s67, s67, 16384
    v_mfma_f32_16x16x32_bf16 v[24:27], a[248:251], v[124:127], v[24:27]
    ds_read_b64_tr_b16 a[240:241], v233 offset:45056
    ds_read_b64_tr_b16 a[242:243], v233 offset:47104
    v_mfma_f32_16x16x32_bf16 v[28:31], a[252:255], v[124:127], v[28:31]
    ds_read_b64_tr_b16 a[244:245], v234 offset:45056
    v_mfma_f32_16x16x32_bf16 v[12:15], a[252:255], v[120:123], v[12:15]
    ds_read_b64_tr_b16 a[246:247], v234 offset:47104
    s_waitcnt vmcnt(14) lgkmcnt(9)
    v_mfma_f32_16x16x32_bf16 v[0:3], a[224:227], v[128:131], v[0:3]
    ds_read_b64_tr_b16 a[248:249], v235 offset:45056
    buffer_load_dwordx4 v[192:195], v224, s[36:39], s67 offen offset:0 sc1
    v_mfma_f32_16x16x32_bf16 v[16:19], a[224:227], v[132:135], v[16:19]
    ds_read_b64_tr_b16 a[250:251], v235 offset:47104
    v_mfma_f32_16x16x32_bf16 v[20:23], a[228:231], v[132:135], v[20:23]
    ds_read_b64_tr_b16 a[252:253], v236 offset:45056
    buffer_load_dword v243, v242, s[44:47], 0 offen sc1
    v_mfma_f32_16x16x32_bf16 v[4:7], a[228:231], v[128:131], v[4:7]
    ds_read_b64_tr_b16 a[254:255], v236 offset:47104
    s_waitcnt lgkmcnt(9)
    v_mfma_f32_16x16x32_bf16 v[8:11], a[232:235], v[128:131], v[8:11]
    ds_read_b64_tr_b16 a[224:225], v233 offset:49152
    buffer_load_dwordx4 v[196:199], v224, s[36:39], s67 offen offset:1024 sc1
    v_mfma_f32_16x16x32_bf16 v[24:27], a[232:235], v[132:135], v[24:27]
    ds_read_b64_tr_b16 a[226:227], v233 offset:51200
    v_mfma_f32_16x16x32_bf16 v[28:31], a[236:239], v[132:135], v[28:31]
    ds_read_b64_tr_b16 a[228:229], v234 offset:49152
    ds_read_b64_tr_b16 a[230:231], v234 offset:51200
    v_mfma_f32_16x16x32_bf16 v[12:15], a[236:239], v[128:131], v[12:15]
    ds_write_b128 v237, a[72:75] offset:49152
    s_waitcnt vmcnt(15) lgkmcnt(9)
    v_mfma_f32_16x16x32_bf16 v[0:3], a[240:243], v[136:139], v[0:3]
    buffer_load_dwordx4 v[200:203], v224, s[36:39], s67 offen offset:2048 sc1
    v_mfma_f32_16x16x32_bf16 v[16:19], a[240:243], v[140:143], v[16:19]
    ds_read_b64_tr_b16 a[232:233], v235 offset:49152
    ds_read_b64_tr_b16 a[234:235], v235 offset:51200
    v_mfma_f32_16x16x32_bf16 v[20:23], a[244:247], v[140:143], v[20:23]
    ds_read_b64_tr_b16 a[236:237], v236 offset:49152
    v_mfma_f32_16x16x32_bf16 v[4:7], a[244:247], v[136:139], v[4:7]
    ds_read_b64_tr_b16 a[238:239], v236 offset:51200
    s_waitcnt lgkmcnt(9)
    v_mfma_f32_16x16x32_bf16 v[8:11], a[248:251], v[136:139], v[8:11]
    ds_read_b64_tr_b16 a[240:241], v233 offset:53248
    buffer_load_dwordx4 v[204:207], v224, s[36:39], s67 offen offset:3072 sc1
    v_mfma_f32_16x16x32_bf16 v[24:27], a[248:251], v[140:143], v[24:27]
    ds_read_b64_tr_b16 a[242:243], v233 offset:55296
    s_add_u32 s67, s67, 16384
    v_mfma_f32_16x16x32_bf16 v[28:31], a[252:255], v[140:143], v[28:31]
    ds_read_b64_tr_b16 a[244:245], v234 offset:53248
    v_mfma_f32_16x16x32_bf16 v[12:15], a[252:255], v[136:139], v[12:15]
    ds_read_b64_tr_b16 a[246:247], v234 offset:55296
    s_waitcnt vmcnt(15) lgkmcnt(9)
    v_mfma_f32_16x16x32_bf16 v[0:3], a[224:227], v[144:147], v[0:3]
    ds_read_b64_tr_b16 a[248:249], v235 offset:53248
    buffer_load_dwordx4 v[208:211], v224, s[36:39], s67 offen offset:0 sc1
    v_mfma_f32_16x16x32_bf16 v[16:19], a[224:227], v[148:151], v[16:19]
    ds_read_b64_tr_b16 a[250:251], v235 offset:55296
    v_mfma_f32_16x16x32_bf16 v[20:23], a[228:231], v[148:151], v[20:23]
    ds_read_b64_tr_b16 a[252:253], v236 offset:53248
    ds_read_b64_tr_b16 a[254:255], v236 offset:55296
    v_mfma_f32_16x16x32_bf16 v[4:7], a[228:231], v[144:147], v[4:7]
    ds_write_b128 v237, a[76:79] offset:53248
    s_waitcnt lgkmcnt(9)
    v_mfma_f32_16x16x32_bf16 v[8:11], a[232:235], v[144:147], v[8:11]
    buffer_load_dwordx4 v[212:215], v224, s[36:39], s67 offen offset:1024 sc1
    v_mfma_f32_16x16x32_bf16 v[24:27], a[232:235], v[148:151], v[24:27]
    ds_read_b64_tr_b16 a[224:225], v229 offset:24576
    ds_read_b64_tr_b16 a[226:227], v229 offset:26624
    v_mfma_f32_16x16x32_bf16 v[28:31], a[236:239], v[148:151], v[28:31]
    ds_read_b64_tr_b16 a[228:229], v230 offset:24576
    v_mfma_f32_16x16x32_bf16 v[12:15], a[236:239], v[144:147], v[12:15]
    ds_read_b64_tr_b16 a[230:231], v230 offset:26624
    s_waitcnt vmcnt(15) lgkmcnt(9)
    v_mfma_f32_16x16x32_bf16 v[0:3], a[240:243], v[152:155], v[0:3]
    ds_read_b64_tr_b16 a[232:233], v231 offset:24576
    buffer_load_dwordx4 v[216:219], v224, s[36:39], s67 offen offset:2048 sc1
    v_mfma_f32_16x16x32_bf16 v[16:19], a[240:243], v[156:159], v[16:19]
    ds_read_b64_tr_b16 a[234:235], v231 offset:26624
    v_mfma_f32_16x16x32_bf16 v[20:23], a[244:247], v[156:159], v[20:23]
    ds_read_b64_tr_b16 a[236:237], v232 offset:24576
    v_mfma_f32_16x16x32_bf16 v[4:7], a[244:247], v[152:155], v[4:7]
    ds_read_b64_tr_b16 a[238:239], v232 offset:26624
    s_waitcnt lgkmcnt(9)
    v_mfma_f32_16x16x32_bf16 v[8:11], a[248:251], v[152:155], v[8:11]
    ds_read_b64_tr_b16 a[240:241], v229 offset:28672
    buffer_load_dwordx4 v[220:223], v224, s[36:39], s67 offen offset:3072 sc1
    v_mfma_f32_16x16x32_bf16 v[24:27], a[248:251], v[156:159], v[24:27]
    ds_read_b64_tr_b16 a[242:243], v229 offset:30720
    s_add_u32 s67, s67, 4096
    v_mfma_f32_16x16x32_bf16 v[28:31], a[252:255], v[156:159], v[28:31]
    ds_read_b64_tr_b16 a[244:245], v230 offset:28672
    ds_read_b64_tr_b16 a[246:247], v230 offset:30720
    v_mfma_f32_16x16x32_bf16 v[12:15], a[252:255], v[152:155], v[12:15]
    ds_write_b128 v238, a[80:83] offset:0
    s_waitcnt vmcnt(7)
    v_cmp_ne_u32 vcc, s26, v243
    s_nop 0
    s_cmp_eq_u64 vcc, 0
    s_cbranch_scc0 L_check_65
L_check_ret_66:
    s_waitcnt lgkmcnt(9)
    v_mfma_f32_16x16x32_bf16 v[0:3], a[224:227], v[160:163], v[0:3]
    buffer_load_dwordx4 v[96:99], v224, s[36:39], s67 offen offset:0 sc1
    v_mfma_f32_16x16x32_bf16 v[16:19], a[224:227], v[164:167], v[16:19]
    ds_read_b64_tr_b16 a[248:249], v231 offset:28672
    ds_read_b64_tr_b16 a[250:251], v231 offset:30720
    v_mfma_f32_16x16x32_bf16 v[20:23], a[228:231], v[164:167], v[20:23]
    ds_read_b64_tr_b16 a[252:253], v232 offset:28672
    v_mfma_f32_16x16x32_bf16 v[4:7], a[228:231], v[160:163], v[4:7]
    ds_read_b64_tr_b16 a[254:255], v232 offset:30720
    s_waitcnt lgkmcnt(9)
    v_mfma_f32_16x16x32_bf16 v[8:11], a[232:235], v[160:163], v[8:11]
    ds_read_b64_tr_b16 a[224:225], v229 offset:57344
    buffer_load_dwordx4 v[100:103], v224, s[36:39], s67 offen offset:1024 sc1
    v_mfma_f32_16x16x32_bf16 v[24:27], a[232:235], v[164:167], v[24:27]
    ds_read_b64_tr_b16 a[226:227], v229 offset:59392
    v_mfma_f32_16x16x32_bf16 v[28:31], a[236:239], v[164:167], v[28:31]
    ds_read_b64_tr_b16 a[228:229], v230 offset:57344
    v_mfma_f32_16x16x32_bf16 v[12:15], a[236:239], v[160:163], v[12:15]
    ds_read_b64_tr_b16 a[230:231], v230 offset:59392
    s_waitcnt lgkmcnt(9)
    v_mfma_f32_16x16x32_bf16 v[0:3], a[240:243], v[168:171], v[0:3]
    ds_read_b64_tr_b16 a[232:233], v231 offset:57344
    buffer_load_dwordx4 v[104:107], v224, s[36:39], s67 offen offset:2048 sc1
    v_mfma_f32_16x16x32_bf16 v[16:19], a[240:243], v[172:175], v[16:19]
    ds_read_b64_tr_b16 a[234:235], v231 offset:59392
    v_mfma_f32_16x16x32_bf16 v[20:23], a[244:247], v[172:175], v[20:23]
    ds_read_b64_tr_b16 a[236:237], v232 offset:57344
    ds_read_b64_tr_b16 a[238:239], v232 offset:59392
    v_mfma_f32_16x16x32_bf16 v[4:7], a[244:247], v[168:171], v[4:7]
    ds_write_b128 v238, a[84:87] offset:4096
    s_waitcnt lgkmcnt(9)
    v_mfma_f32_16x16x32_bf16 v[8:11], a[248:251], v[168:171], v[8:11]
    buffer_load_dwordx4 v[108:111], v224, s[36:39], s67 offen offset:3072 sc1
    s_add_u32 s67, s67, 4096
    v_mfma_f32_16x16x32_bf16 v[24:27], a[248:251], v[172:175], v[24:27]
    ds_read_b64_tr_b16 a[240:241], v229 offset:61440
    ds_read_b64_tr_b16 a[242:243], v229 offset:63488
    v_mfma_f32_16x16x32_bf16 v[28:31], a[252:255], v[172:175], v[28:31]
    ds_read_b64_tr_b16 a[244:245], v230 offset:61440
    v_mfma_f32_16x16x32_bf16 v[12:15], a[252:255], v[168:171], v[12:15]
    ds_read_b64_tr_b16 a[246:247], v230 offset:63488
    s_waitcnt lgkmcnt(9)
    v_mfma_f32_16x16x32_bf16 v[0:3], a[224:227], v[176:179], v[0:3]
    ds_read_b64_tr_b16 a[248:249], v231 offset:61440
    buffer_load_dwordx4 v[112:115], v224, s[36:39], s67 offen offset:0 sc1
    v_mfma_f32_16x16x32_bf16 v[16:19], a[224:227], v[180:183], v[16:19]
    ds_read_b64_tr_b16 a[250:251], v231 offset:63488
    v_mfma_f32_16x16x32_bf16 v[20:23], a[228:231], v[180:183], v[20:23]
    ds_read_b64_tr_b16 a[252:253], v232 offset:61440
    v_mfma_f32_16x16x32_bf16 v[4:7], a[228:231], v[176:179], v[4:7]
    ds_read_b64_tr_b16 a[254:255], v232 offset:63488
    s_waitcnt lgkmcnt(9)
    v_mfma_f32_16x16x32_bf16 v[8:11], a[232:235], v[176:179], v[8:11]
    ds_read_b64_tr_b16 a[224:225], v233 offset:24576
    buffer_load_dwordx4 v[116:119], v224, s[36:39], s67 offen offset:1024 sc1
    v_mfma_f32_16x16x32_bf16 v[24:27], a[232:235], v[180:183], v[24:27]
    ds_read_b64_tr_b16 a[226:227], v233 offset:26624
    v_mfma_f32_16x16x32_bf16 v[28:31], a[236:239], v[180:183], v[28:31]
    ds_read_b64_tr_b16 a[228:229], v234 offset:24576
    ds_read_b64_tr_b16 a[230:231], v234 offset:26624
    v_mfma_f32_16x16x32_bf16 v[12:15], a[236:239], v[176:179], v[12:15]
    ds_write_b128 v238, a[88:91] offset:8192
    s_waitcnt lgkmcnt(9)
    v_mfma_f32_16x16x32_bf16 v[0:3], a[240:243], v[184:187], v[0:3]
    buffer_load_dwordx4 v[120:123], v224, s[36:39], s67 offen offset:2048 sc1
    v_mfma_f32_16x16x32_bf16 v[16:19], a[240:243], v[188:191], v[16:19]
    ds_read_b64_tr_b16 a[232:233], v235 offset:24576
    ds_read_b64_tr_b16 a[234:235], v235 offset:26624
    v_mfma_f32_16x16x32_bf16 v[20:23], a[244:247], v[188:191], v[20:23]
    ds_read_b64_tr_b16 a[236:237], v236 offset:24576
    v_mfma_f32_16x16x32_bf16 v[4:7], a[244:247], v[184:187], v[4:7]
    ds_read_b64_tr_b16 a[238:239], v236 offset:26624
    s_waitcnt lgkmcnt(9)
    v_mfma_f32_16x16x32_bf16 v[8:11], a[248:251], v[184:187], v[8:11]
    ds_read_b64_tr_b16 a[240:241], v233 offset:28672
    buffer_load_dwordx4 v[124:127], v224, s[36:39], s67 offen offset:3072 sc1
    v_mfma_f32_16x16x32_bf16 v[24:27], a[248:251], v[188:191], v[24:27]
    ds_read_b64_tr_b16 a[242:243], v233 offset:30720
    s_add_u32 s67, s67, 4096
    v_mfma_f32_16x16x32_bf16 v[28:31], a[252:255], v[188:191], v[28:31]
    ds_read_b64_tr_b16 a[244:245], v234 offset:28672
    v_mfma_f32_16x16x32_bf16 v[12:15], a[252:255], v[184:187], v[12:15]
    ds_read_b64_tr_b16 a[246:247], v234 offset:30720
    s_waitcnt vmcnt(14) lgkmcnt(9)
    v_mfma_f32_16x16x32_bf16 v[0:3], a[224:227], v[192:195], v[0:3]
    ds_read_b64_tr_b16 a[248:249], v235 offset:28672
    buffer_load_dwordx4 v[128:131], v224, s[36:39], s67 offen offset:0 sc1
    v_mfma_f32_16x16x32_bf16 v[16:19], a[224:227], v[196:199], v[16:19]
    ds_read_b64_tr_b16 a[250:251], v235 offset:30720
    v_mfma_f32_16x16x32_bf16 v[20:23], a[228:231], v[196:199], v[20:23]
    ds_read_b64_tr_b16 a[252:253], v236 offset:28672
    ds_read_b64_tr_b16 a[254:255], v236 offset:30720
    v_mfma_f32_16x16x32_bf16 v[4:7], a[228:231], v[192:195], v[4:7]
    ds_write_b128 v238, a[92:95] offset:12288
    s_waitcnt lgkmcnt(9)
    v_mfma_f32_16x16x32_bf16 v[8:11], a[232:235], v[192:195], v[8:11]
    buffer_load_dwordx4 v[132:135], v224, s[36:39], s67 offen offset:1024 sc1
    v_mfma_f32_16x16x32_bf16 v[24:27], a[232:235], v[196:199], v[24:27]
    ds_read_b64_tr_b16 a[224:225], v233 offset:57344
    ds_read_b64_tr_b16 a[226:227], v233 offset:59392
    v_mfma_f32_16x16x32_bf16 v[28:31], a[236:239], v[196:199], v[28:31]
    ds_read_b64_tr_b16 a[228:229], v234 offset:57344
    v_mfma_f32_16x16x32_bf16 v[12:15], a[236:239], v[192:195], v[12:15]
    ds_read_b64_tr_b16 a[230:231], v234 offset:59392
    s_waitcnt vmcnt(14) lgkmcnt(9)
    v_mfma_f32_16x16x32_bf16 v[0:3], a[240:243], v[200:203], v[0:3]
    ds_read_b64_tr_b16 a[232:233], v235 offset:57344
    buffer_load_dwordx4 v[136:139], v224, s[36:39], s67 offen offset:2048 sc1
    v_mfma_f32_16x16x32_bf16 v[16:19], a[240:243], v[204:207], v[16:19]
    ds_read_b64_tr_b16 a[234:235], v235 offset:59392
    v_mfma_f32_16x16x32_bf16 v[20:23], a[244:247], v[204:207], v[20:23]
    ds_read_b64_tr_b16 a[236:237], v236 offset:57344
    v_mfma_f32_16x16x32_bf16 v[4:7], a[244:247], v[200:203], v[4:7]
    ds_read_b64_tr_b16 a[238:239], v236 offset:59392
    s_waitcnt lgkmcnt(9)
    v_mfma_f32_16x16x32_bf16 v[8:11], a[248:251], v[200:203], v[8:11]
    ds_read_b64_tr_b16 a[240:241], v233 offset:61440
    buffer_load_dwordx4 v[140:143], v224, s[36:39], s67 offen offset:3072 sc1
    v_mfma_f32_16x16x32_bf16 v[24:27], a[248:251], v[204:207], v[24:27]
    ds_read_b64_tr_b16 a[242:243], v233 offset:63488
    s_add_u32 s67, s67, 4096
    v_mfma_f32_16x16x32_bf16 v[28:31], a[252:255], v[204:207], v[28:31]
    ds_read_b64_tr_b16 a[244:245], v234 offset:61440
    v_mfma_f32_16x16x32_bf16 v[12:15], a[252:255], v[200:203], v[12:15]
    ds_read_b64_tr_b16 a[246:247], v234 offset:63488
    s_waitcnt vmcnt(14) lgkmcnt(8)
    v_mfma_f32_16x16x32_bf16 v[0:3], a[224:227], v[208:211], v[0:3]
    ds_read_b64_tr_b16 a[248:249], v235 offset:61440
    buffer_load_dwordx4 v[144:147], v224, s[36:39], s67 offen offset:0 sc1
    v_mfma_f32_16x16x32_bf16 v[16:19], a[224:227], v[212:215], v[16:19]
    ds_read_b64_tr_b16 a[250:251], v235 offset:63488
    v_mfma_f32_16x16x32_bf16 v[20:23], a[228:231], v[212:215], v[20:23]
    ds_read_b64_tr_b16 a[252:253], v236 offset:61440
    v_mfma_f32_16x16x32_bf16 v[4:7], a[228:231], v[208:211], v[4:7]
    ds_read_b64_tr_b16 a[254:255], v236 offset:63488
    s_barrier
    s_waitcnt lgkmcnt(8)
    v_mfma_f32_16x16x32_bf16 v[8:11], a[232:235], v[208:211], v[8:11]
    ds_read_b64_tr_b16 a[224:225], v248 offset:0
    buffer_load_dwordx4 v[148:151], v224, s[36:39], s67 offen offset:1024 sc1
    v_mfma_f32_16x16x32_bf16 v[24:27], a[232:235], v[212:215], v[24:27]
    ds_read_b64_tr_b16 a[226:227], v248 offset:2048
    v_mfma_f32_16x16x32_bf16 v[28:31], a[236:239], v[212:215], v[28:31]
    ds_read_b64_tr_b16 a[228:229], v249 offset:0
    ds_read_b64_tr_b16 a[230:231], v249 offset:2048
    v_mfma_f32_16x16x32_bf16 v[12:15], a[236:239], v[208:211], v[12:15]
    ds_write_b128 v238, a[96:99] offset:16384
    s_waitcnt vmcnt(14) lgkmcnt(9)
    v_mfma_f32_16x16x32_bf16 v[0:3], a[240:243], v[216:219], v[0:3]
    buffer_load_dwordx4 v[152:155], v224, s[36:39], s67 offen offset:2048 sc1
    v_mfma_f32_16x16x32_bf16 v[16:19], a[240:243], v[220:223], v[16:19]
    ds_read_b64_tr_b16 a[232:233], v250 offset:0
    ds_read_b64_tr_b16 a[234:235], v250 offset:2048
    v_mfma_f32_16x16x32_bf16 v[20:23], a[244:247], v[220:223], v[20:23]
    ds_read_b64_tr_b16 a[236:237], v251 offset:0
    v_mfma_f32_16x16x32_bf16 v[4:7], a[244:247], v[216:219], v[4:7]
    ds_read_b64_tr_b16 a[238:239], v251 offset:2048
    s_waitcnt lgkmcnt(9)
    v_mfma_f32_16x16x32_bf16 v[8:11], a[248:251], v[216:219], v[8:11]
    ds_read_b64_tr_b16 a[240:241], v248 offset:4096
    buffer_load_dwordx4 v[156:159], v224, s[36:39], s67 offen offset:3072 sc1
    v_mfma_f32_16x16x32_bf16 v[24:27], a[248:251], v[220:223], v[24:27]
    ds_read_b64_tr_b16 a[242:243], v248 offset:6144
    s_add_u32 s67, s67, 4096
    v_mfma_f32_16x16x32_bf16 v[28:31], a[252:255], v[220:223], v[28:31]
    ds_read_b64_tr_b16 a[244:245], v249 offset:4096
    v_mfma_f32_16x16x32_bf16 v[12:15], a[252:255], v[216:219], v[12:15]
    ds_read_b64_tr_b16 a[246:247], v249 offset:6144
    s_waitcnt vmcnt(14) lgkmcnt(9)
    v_mfma_f32_16x16x32_bf16 v[0:3], a[224:227], v[96:99], v[0:3]
    ds_read_b64_tr_b16 a[248:249], v250 offset:4096
    ds_read_b64_tr_b16 a[250:251], v250 offset:6144
    v_mfma_f32_16x16x32_bf16 v[16:19], a[224:227], v[100:103], v[16:19]
    buffer_load_dwordx4 v[160:163], v224, s[36:39], s67 offen offset:0 sc1
    ds_write_b128 v238, a[100:103] offset:20480
    v_mfma_f32_16x16x32_bf16 v[20:23], a[228:231], v[100:103], v[20:23]
    v_mfma_f32_16x16x32_bf16 v[4:7], a[228:231], v[96:99], v[4:7]
    ds_read_b64_tr_b16 a[252:253], v251 offset:4096
    ds_read_b64_tr_b16 a[254:255], v251 offset:6144
    s_waitcnt lgkmcnt(9)
    v_mfma_f32_16x16x32_bf16 v[8:11], a[232:235], v[96:99], v[8:11]
    ds_read_b64_tr_b16 a[224:225], v248 offset:8192
    buffer_load_dwordx4 v[164:167], v224, s[36:39], s67 offen offset:1024 sc1
    v_mfma_f32_16x16x32_bf16 v[24:27], a[232:235], v[100:103], v[24:27]
    ds_read_b64_tr_b16 a[226:227], v248 offset:10240
    v_mfma_f32_16x16x32_bf16 v[28:31], a[236:239], v[100:103], v[28:31]
    ds_read_b64_tr_b16 a[228:229], v249 offset:8192
    v_mfma_f32_16x16x32_bf16 v[12:15], a[236:239], v[96:99], v[12:15]
    ds_read_b64_tr_b16 a[230:231], v249 offset:10240
    s_waitcnt vmcnt(14) lgkmcnt(9)
    v_mfma_f32_16x16x32_bf16 v[0:3], a[240:243], v[104:107], v[0:3]
    ds_read_b64_tr_b16 a[232:233], v250 offset:8192
    buffer_load_dwordx4 v[168:171], v224, s[36:39], s67 offen offset:2048 sc1
    v_mfma_f32_16x16x32_bf16 v[16:19], a[240:243], v[108:111], v[16:19]
    s_branch L_po_K_6
.p2align 12
L_pg_K_6:
    s_branch L_vret
L_po_K_6:
    ds_read_b64_tr_b16 a[234:235], v250 offset:10240
    v_mfma_f32_16x16x32_bf16 v[20:23], a[244:247], v[108:111], v[20:23]
    ds_read_b64_tr_b16 a[236:237], v251 offset:8192
    ds_read_b64_tr_b16 a[238:239], v251 offset:10240
    v_mfma_f32_16x16x32_bf16 v[4:7], a[244:247], v[104:107], v[4:7]
    ds_write_b128 v238, a[104:107] offset:32768
    s_waitcnt lgkmcnt(9)
    v_mfma_f32_16x16x32_bf16 v[8:11], a[248:251], v[104:107], v[8:11]
    buffer_load_dwordx4 v[172:175], v224, s[36:39], s67 offen offset:3072 sc1
    s_add_u32 s67, s67, 4096
    v_mfma_f32_16x16x32_bf16 v[24:27], a[248:251], v[108:111], v[24:27]
    ds_read_b64_tr_b16 a[240:241], v248 offset:12288
    ds_read_b64_tr_b16 a[242:243], v248 offset:14336
    v_mfma_f32_16x16x32_bf16 v[28:31], a[252:255], v[108:111], v[28:31]
    ds_read_b64_tr_b16 a[244:245], v249 offset:12288
    buffer_load_dwordx4 v[176:179], v224, s[36:39], s67 offen offset:0 sc1
    v_mfma_f32_16x16x32_bf16 v[12:15], a[252:255], v[104:107], v[12:15]
    ds_read_b64_tr_b16 a[246:247], v249 offset:14336
    s_waitcnt vmcnt(15) lgkmcnt(9)
    v_mfma_f32_16x16x32_bf16 v[0:3], a[224:227], v[112:115], v[0:3]
    ds_read_b64_tr_b16 a[248:249], v250 offset:12288
    v_mfma_f32_16x16x32_bf16 v[16:19], a[224:227], v[116:119], v[16:19]
    ds_read_b64_tr_b16 a[250:251], v250 offset:14336
    v_mfma_f32_16x16x32_bf16 v[20:23], a[228:231], v[116:119], v[20:23]
    ds_read_b64_tr_b16 a[252:253], v251 offset:12288
    buffer_load_dwordx4 v[180:183], v224, s[36:39], s67 offen offset:1024 sc1
    v_mfma_f32_16x16x32_bf16 v[4:7], a[228:231], v[112:115], v[4:7]
    ds_read_b64_tr_b16 a[254:255], v251 offset:14336
    s_waitcnt lgkmcnt(9)
    v_mfma_f32_16x16x32_bf16 v[8:11], a[232:235], v[112:115], v[8:11]
    ds_read_b64_tr_b16 a[224:225], v248 offset:16384
    ds_read_b64_tr_b16 a[226:227], v248 offset:18432
    v_mfma_f32_16x16x32_bf16 v[24:27], a[232:235], v[116:119], v[24:27]
    ds_write_b128 v238, a[108:111] offset:36864
    v_mfma_f32_16x16x32_bf16 v[28:31], a[236:239], v[116:119], v[28:31]
    buffer_load_dwordx4 v[184:187], v224, s[36:39], s67 offen offset:2048 sc1
    v_mfma_f32_16x16x32_bf16 v[12:15], a[236:239], v[112:115], v[12:15]
    ds_read_b64_tr_b16 a[228:229], v249 offset:16384
    ds_read_b64_tr_b16 a[230:231], v249 offset:18432
    s_waitcnt vmcnt(15) lgkmcnt(9)
    v_mfma_f32_16x16x32_bf16 v[0:3], a[240:243], v[120:123], v[0:3]
    ds_read_b64_tr_b16 a[232:233], v250 offset:16384
    v_mfma_f32_16x16x32_bf16 v[16:19], a[240:243], v[124:127], v[16:19]
    ds_read_b64_tr_b16 a[234:235], v250 offset:18432
    v_mfma_f32_16x16x32_bf16 v[20:23], a[244:247], v[124:127], v[20:23]
    ds_read_b64_tr_b16 a[236:237], v251 offset:16384
    buffer_load_dwordx4 v[188:191], v224, s[36:39], s67 offen offset:3072 sc1
    v_mfma_f32_16x16x32_bf16 v[4:7], a[244:247], v[120:123], v[4:7]
    ds_read_b64_tr_b16 a[238:239], v251 offset:18432
    s_add_u32 s67, s67, 4096
    s_waitcnt lgkmcnt(9)
    v_mfma_f32_16x16x32_bf16 v[8:11], a[248:251], v[120:123], v[8:11]
    ds_read_b64_tr_b16 a[240:241], v248 offset:20480
    buffer_load_dwordx4 v[192:195], v224, s[36:39], s67 offen offset:0 sc1
    v_mfma_f32_16x16x32_bf16 v[24:27], a[248:251], v[124:127], v[24:27]
    ds_read_b64_tr_b16 a[242:243], v248 offset:22528
    v_mfma_f32_16x16x32_bf16 v[28:31], a[252:255], v[124:127], v[28:31]
    ds_read_b64_tr_b16 a[244:245], v249 offset:20480
    ds_read_b64_tr_b16 a[246:247], v249 offset:22528
    v_mfma_f32_16x16x32_bf16 v[12:15], a[252:255], v[120:123], v[12:15]
    ds_write_b128 v238, a[112:115] offset:40960
    s_waitcnt vmcnt(15) lgkmcnt(9)
    v_mfma_f32_16x16x32_bf16 v[0:3], a[224:227], v[128:131], v[0:3]
    buffer_load_dwordx4 v[196:199], v224, s[36:39], s67 offen offset:1024 sc1
    v_mfma_f32_16x16x32_bf16 v[16:19], a[224:227], v[132:135], v[16:19]
    ds_read_b64_tr_b16 a[248:249], v250 offset:20480
    ds_read_b64_tr_b16 a[250:251], v250 offset:22528
    v_mfma_f32_16x16x32_bf16 v[20:23], a[228:231], v[132:135], v[20:23]
    ds_read_b64_tr_b16 a[252:253], v251 offset:20480
    v_mfma_f32_16x16x32_bf16 v[4:7], a[228:231], v[128:131], v[4:7]
    ds_read_b64_tr_b16 a[254:255], v251 offset:22528
    s_waitcnt lgkmcnt(9)
    v_mfma_f32_16x16x32_bf16 v[8:11], a[232:235], v[128:131], v[8:11]
    ds_read_b64_tr_b16 a[224:225], v248 offset:24576
    buffer_load_dwordx4 v[200:203], v224, s[36:39], s67 offen offset:2048 sc1
    v_mfma_f32_16x16x32_bf16 v[24:27], a[232:235], v[132:135], v[24:27]
    ds_read_b64_tr_b16 a[226:227], v248 offset:26624
    v_mfma_f32_16x16x32_bf16 v[28:31], a[236:239], v[132:135], v[28:31]
    ds_read_b64_tr_b16 a[228:229], v249 offset:24576
    v_mfma_f32_16x16x32_bf16 v[12:15], a[236:239], v[128:131], v[12:15]
    ds_read_b64_tr_b16 a[230:231], v249 offset:26624
    s_waitcnt vmcnt(15) lgkmcnt(9)
    v_mfma_f32_16x16x32_bf16 v[0:3], a[240:243], v[136:139], v[0:3]
    ds_read_b64_tr_b16 a[232:233], v250 offset:24576
    ds_read_b64_tr_b16 a[234:235], v250 offset:26624
    v_mfma_f32_16x16x32_bf16 v[16:19], a[240:243], v[140:143], v[16:19]
    buffer_load_dwordx4 v[204:207], v224, s[36:39], s67 offen offset:3072 sc1
    s_add_u32 s67, s67, 4096
    ds_write_b128 v238, a[116:119] offset:45056
    v_mfma_f32_16x16x32_bf16 v[20:23], a[244:247], v[140:143], v[20:23]
    buffer_load_dwordx4 v[208:211], v224, s[36:39], s67 offen offset:0 sc1
    v_mfma_f32_16x16x32_bf16 v[4:7], a[244:247], v[136:139], v[4:7]
    ds_read_b64_tr_b16 a[236:237], v251 offset:24576
    ds_read_b64_tr_b16 a[238:239], v251 offset:26624
    s_waitcnt lgkmcnt(9)
    v_mfma_f32_16x16x32_bf16 v[8:11], a[248:251], v[136:139], v[8:11]
    ds_read_b64_tr_b16 a[240:241], v248 offset:28672
    v_mfma_f32_16x16x32_bf16 v[24:27], a[248:251], v[140:143], v[24:27]
    ds_read_b64_tr_b16 a[242:243], v248 offset:30720
    v_mfma_f32_16x16x32_bf16 v[28:31], a[252:255], v[140:143], v[28:31]
    ds_read_b64_tr_b16 a[244:245], v249 offset:28672
    buffer_load_dwordx4 v[212:215], v224, s[36:39], s67 offen offset:1024 sc1
    v_mfma_f32_16x16x32_bf16 v[12:15], a[252:255], v[136:139], v[12:15]
    ds_read_b64_tr_b16 a[246:247], v249 offset:30720
    s_waitcnt vmcnt(16) lgkmcnt(9)
    v_mfma_f32_16x16x32_bf16 v[0:3], a[224:227], v[144:147], v[0:3]
    ds_read_b64_tr_b16 a[248:249], v250 offset:28672
    v_mfma_f32_16x16x32_bf16 v[16:19], a[224:227], v[148:151], v[16:19]
    ds_read_b64_tr_b16 a[250:251], v250 offset:30720
    v_mfma_f32_16x16x32_bf16 v[20:23], a[228:231], v[148:151], v[20:23]
    ds_read_b64_tr_b16 a[252:253], v251 offset:28672
    ds_read_b64_tr_b16 a[254:255], v251 offset:30720
    v_mfma_f32_16x16x32_bf16 v[4:7], a[228:231], v[144:147], v[4:7]
    buffer_load_dwordx4 v[216:219], v224, s[36:39], s67 offen offset:2048 sc1
    ds_write_b128 v238, a[120:123] offset:49152
    s_waitcnt lgkmcnt(9)
    v_mfma_f32_16x16x32_bf16 v[8:11], a[232:235], v[144:147], v[8:11]
    v_mfma_f32_16x16x32_bf16 v[24:27], a[232:235], v[148:151], v[24:27]
    ds_read_b64_tr_b16 a[224:225], v229 offset:0
    ds_read_b64_tr_b16 a[226:227], v229 offset:2048
    v_mfma_f32_16x16x32_bf16 v[28:31], a[236:239], v[148:151], v[28:31]
    ds_read_b64_tr_b16 a[228:229], v230 offset:0
    buffer_load_dwordx4 v[220:223], v224, s[36:39], s67 offen offset:3072 sc1
    v_mfma_f32_16x16x32_bf16 v[12:15], a[236:239], v[144:147], v[12:15]
    ds_read_b64_tr_b16 a[230:231], v230 offset:2048
    s_add_u32 s67, s67, 4096
    s_waitcnt vmcnt(16) lgkmcnt(9)
    v_mfma_f32_16x16x32_bf16 v[0:3], a[240:243], v[152:155], v[0:3]
    ds_read_b64_tr_b16 a[232:233], v231 offset:0
    buffer_load_dwordx4 v[96:99], v224, s[36:39], s67 offen offset:0 sc1
    v_mfma_f32_16x16x32_bf16 v[16:19], a[240:243], v[156:159], v[16:19]
    ds_read_b64_tr_b16 a[234:235], v231 offset:2048
    v_mfma_f32_16x16x32_bf16 v[20:23], a[244:247], v[156:159], v[20:23]
    ds_read_b64_tr_b16 a[236:237], v232 offset:0
    v_mfma_f32_16x16x32_bf16 v[4:7], a[244:247], v[152:155], v[4:7]
    ds_read_b64_tr_b16 a[238:239], v232 offset:2048
    s_waitcnt lgkmcnt(9)
    v_mfma_f32_16x16x32_bf16 v[8:11], a[248:251], v[152:155], v[8:11]
    ds_read_b64_tr_b16 a[240:241], v229 offset:4096
    ds_read_b64_tr_b16 a[242:243], v229 offset:6144
    v_mfma_f32_16x16x32_bf16 v[24:27], a[248:251], v[156:159], v[24:27]
    buffer_load_dwordx4 v[100:103], v224, s[36:39], s67 offen offset:1024 sc1
    ds_write_b128 v238, a[124:127] offset:53248
    v_mfma_f32_16x16x32_bf16 v[28:31], a[252:255], v[156:159], v[28:31]
    v_mfma_f32_16x16x32_bf16 v[12:15], a[252:255], v[152:155], v[12:15]
    ds_read_b64_tr_b16 a[244:245], v230 offset:4096
    ds_read_b64_tr_b16 a[246:247], v230 offset:6144
    s_waitcnt vmcnt(16) lgkmcnt(9)
    v_mfma_f32_16x16x32_bf16 v[0:3], a[224:227], v[160:163], v[0:3]
    ds_read_b64_tr_b16 a[248:249], v231 offset:4096
    buffer_load_dwordx4 v[104:107], v224, s[36:39], s67 offen offset:2048 sc1
    v_mfma_f32_16x16x32_bf16 v[16:19], a[224:227], v[164:167], v[16:19]
    ds_read_b64_tr_b16 a[250:251], v231 offset:6144
    v_mfma_f32_16x16x32_bf16 v[20:23], a[228:231], v[164:167], v[20:23]
    ds_read_b64_tr_b16 a[252:253], v232 offset:4096
    v_mfma_f32_16x16x32_bf16 v[4:7], a[228:231], v[160:163], v[4:7]
    ds_read_b64_tr_b16 a[254:255], v232 offset:6144
    s_waitcnt lgkmcnt(9)
    v_mfma_f32_16x16x32_bf16 v[8:11], a[232:235], v[160:163], v[8:11]
    ds_read_b64_tr_b16 a[224:225], v229 offset:8192
    buffer_load_dwordx4 v[108:111], v224, s[36:39], s67 offen offset:3072 sc1
    v_mfma_f32_16x16x32_bf16 v[24:27], a[232:235], v[164:167], v[24:27]
    ds_read_b64_tr_b16 a[226:227], v229 offset:10240
    s_add_u32 s67, s67, 4096
    v_mfma_f32_16x16x32_bf16 v[28:31], a[236:239], v[164:167], v[28:31]
    ds_read_b64_tr_b16 a[228:229], v230 offset:8192
    ds_read_b64_tr_b16 a[230:231], v230 offset:10240
    v_mfma_f32_16x16x32_bf16 v[12:15], a[236:239], v[160:163], v[12:15]
    buffer_load_dwordx4 v[112:115], v224, s[36:39], s67 offen offset:0 sc1
    ds_write_b128 v237, a[128:131] offset:24576
    s_waitcnt vmcnt(17) lgkmcnt(9)
    v_mfma_f32_16x16x32_bf16 v[0:3], a[240:243], v[168:171], v[0:3]
    v_mfma_f32_16x16x32_bf16 v[16:19], a[240:243], v[172:175], v[16:19]
    ds_read_b64_tr_b16 a[232:233], v231 offset:8192
    ds_read_b64_tr_b16 a[234:235], v231 offset:10240
    v_mfma_f32_16x16x32_bf16 v[20:23], a[244:247], v[172:175], v[20:23]
    ds_read_b64_tr_b16 a[236:237], v232 offset:8192
    buffer_load_dwordx4 v[116:119], v224, s[36:39], s67 offen offset:1024 sc1
    v_mfma_f32_16x16x32_bf16 v[4:7], a[244:247], v[168:171], v[4:7]
    ds_read_b64_tr_b16 a[238:239], v232 offset:10240
    s_waitcnt lgkmcnt(9)
    v_mfma_f32_16x16x32_bf16 v[8:11], a[248:251], v[168:171], v[8:11]
    ds_read_b64_tr_b16 a[240:241], v229 offset:12288
    v_mfma_f32_16x16x32_bf16 v[24:27], a[248:251], v[172:175], v[24:27]
    ds_read_b64_tr_b16 a[242:243], v229 offset:14336
    v_mfma_f32_16x16x32_bf16 v[28:31], a[252:255], v[172:175], v[28:31]
    ds_read_b64_tr_b16 a[244:245], v230 offset:12288
    buffer_load_dwordx4 v[120:123], v224, s[36:39], s67 offen offset:2048 sc1
    v_mfma_f32_16x16x32_bf16 v[12:15], a[252:255], v[168:171], v[12:15]
    ds_read_b64_tr_b16 a[246:247], v230 offset:14336
    s_waitcnt vmcnt(17) lgkmcnt(9)
    v_mfma_f32_16x16x32_bf16 v[0:3], a[224:227], v[176:179], v[0:3]
    ds_read_b64_tr_b16 a[248:249], v231 offset:12288
    ds_read_b64_tr_b16 a[250:251], v231 offset:14336
    v_mfma_f32_16x16x32_bf16 v[16:19], a[224:227], v[180:183], v[16:19]
    ds_write_b128 v237, a[132:135] offset:28672
    v_mfma_f32_16x16x32_bf16 v[20:23], a[228:231], v[180:183], v[20:23]
    buffer_load_dwordx4 v[124:127], v224, s[36:39], s67 offen offset:3072 sc1
    s_add_u32 s67, s67, 4096
    v_mfma_f32_16x16x32_bf16 v[4:7], a[228:231], v[176:179], v[4:7]
    ds_read_b64_tr_b16 a[252:253], v232 offset:12288
    ds_read_b64_tr_b16 a[254:255], v232 offset:14336
    s_waitcnt lgkmcnt(9)
    v_mfma_f32_16x16x32_bf16 v[8:11], a[232:235], v[176:179], v[8:11]
    ds_read_b64_tr_b16 a[224:225], v229 offset:16384
    buffer_load_dwordx4 v[128:131], v224, s[36:39], s67 offen offset:0 sc1
    v_mfma_f32_16x16x32_bf16 v[24:27], a[232:235], v[180:183], v[24:27]
    ds_read_b64_tr_b16 a[226:227], v229 offset:18432
    v_mfma_f32_16x16x32_bf16 v[28:31], a[236:239], v[180:183], v[28:31]
    ds_read_b64_tr_b16 a[228:229], v230 offset:16384
    v_mfma_f32_16x16x32_bf16 v[12:15], a[236:239], v[176:179], v[12:15]
    ds_read_b64_tr_b16 a[230:231], v230 offset:18432
    s_waitcnt vmcnt(17) lgkmcnt(9)
    v_mfma_f32_16x16x32_bf16 v[0:3], a[240:243], v[184:187], v[0:3]
    ds_read_b64_tr_b16 a[232:233], v231 offset:16384
    buffer_load_dwordx4 v[132:135], v224, s[36:39], s67 offen offset:1024 sc1
    v_mfma_f32_16x16x32_bf16 v[16:19], a[240:243], v[188:191], v[16:19]
    ds_read_b64_tr_b16 a[234:235], v231 offset:18432
    v_mfma_f32_16x16x32_bf16 v[20:23], a[244:247], v[188:191], v[20:23]
    ds_read_b64_tr_b16 a[236:237], v232 offset:16384
    ds_read_b64_tr_b16 a[238:239], v232 offset:18432
    v_mfma_f32_16x16x32_bf16 v[4:7], a[244:247], v[184:187], v[4:7]
    ds_write_b128 v237, a[136:139] offset:57344
    s_waitcnt lgkmcnt(9)
    v_mfma_f32_16x16x32_bf16 v[8:11], a[248:251], v[184:187], v[8:11]
    buffer_load_dwordx4 v[136:139], v224, s[36:39], s67 offen offset:2048 sc1
    v_mfma_f32_16x16x32_bf16 v[24:27], a[248:251], v[188:191], v[24:27]
    ds_read_b64_tr_b16 a[240:241], v229 offset:20480
    ds_read_b64_tr_b16 a[242:243], v229 offset:22528
    v_mfma_f32_16x16x32_bf16 v[28:31], a[252:255], v[188:191], v[28:31]
    ds_read_b64_tr_b16 a[244:245], v230 offset:20480
    v_mfma_f32_16x16x32_bf16 v[12:15], a[252:255], v[184:187], v[12:15]
    ds_read_b64_tr_b16 a[246:247], v230 offset:22528
    s_waitcnt vmcnt(17) lgkmcnt(9)
    v_mfma_f32_16x16x32_bf16 v[0:3], a[224:227], v[192:195], v[0:3]
    ds_read_b64_tr_b16 a[248:249], v231 offset:20480
    buffer_load_dwordx4 v[140:143], v224, s[36:39], s67 offen offset:3072 sc1
    v_mfma_f32_16x16x32_bf16 v[16:19], a[224:227], v[196:199], v[16:19]
    ds_read_b64_tr_b16 a[250:251], v231 offset:22528
    s_add_u32 s67, s67, 4096
    v_mfma_f32_16x16x32_bf16 v[20:23], a[228:231], v[196:199], v[20:23]
    ds_read_b64_tr_b16 a[252:253], v232 offset:20480
    buffer_load_dwordx4 v[144:147], v224, s[36:39], s67 offen offset:0 sc1
    v_mfma_f32_16x16x32_bf16 v[4:7], a[228:231], v[192:195], v[4:7]
    ds_read_b64_tr_b16 a[254:255], v232 offset:22528
    s_waitcnt lgkmcnt(9)
    v_mfma_f32_16x16x32_bf16 v[8:11], a[232:235], v[192:195], v[8:11]
    ds_read_b64_tr_b16 a[224:225], v229 offset:32768
    ds_read_b64_tr_b16 a[226:227], v229 offset:34816
    v_mfma_f32_16x16x32_bf16 v[24:27], a[232:235], v[196:199], v[24:27]
    ds_write_b128 v237, a[140:143] offset:61440
    v_mfma_f32_16x16x32_bf16 v[28:31], a[236:239], v[196:199], v[28:31]
    buffer_load_dwordx4 v[148:151], v224, s[36:39], s67 offen offset:1024 sc1
    v_mfma_f32_16x16x32_bf16 v[12:15], a[236:239], v[192:195], v[12:15]
    ds_read_b64_tr_b16 a[228:229], v230 offset:32768
    ds_read_b64_tr_b16 a[230:231], v230 offset:34816
    s_waitcnt vmcnt(18) lgkmcnt(9)
    v_mfma_f32_16x16x32_bf16 v[0:3], a[240:243], v[200:203], v[0:3]
    ds_read_b64_tr_b16 a[232:233], v231 offset:32768
    v_mfma_f32_16x16x32_bf16 v[16:19], a[240:243], v[204:207], v[16:19]
    ds_read_b64_tr_b16 a[234:235], v231 offset:34816
    v_mfma_f32_16x16x32_bf16 v[20:23], a[244:247], v[204:207], v[20:23]
    ds_read_b64_tr_b16 a[236:237], v232 offset:32768
    buffer_load_dwordx4 v[152:155], v224, s[36:39], s67 offen offset:2048 sc1
    v_mfma_f32_16x16x32_bf16 v[4:7], a[244:247], v[200:203], v[4:7]
    ds_read_b64_tr_b16 a[238:239], v232 offset:34816
    s_waitcnt lgkmcnt(9)
    v_mfma_f32_16x16x32_bf16 v[8:11], a[248:251], v[200:203], v[8:11]
    ds_read_b64_tr_b16 a[240:241], v229 offset:36864
    v_mfma_f32_16x16x32_bf16 v[24:27], a[248:251], v[204:207], v[24:27]
    ds_read_b64_tr_b16 a[242:243], v229 offset:38912
    v_mfma_f32_16x16x32_bf16 v[28:31], a[252:255], v[204:207], v[28:31]
    ds_read_b64_tr_b16 a[244:245], v230 offset:36864
    buffer_load_dwordx4 v[156:159], v224, s[36:39], s67 offen offset:3072 sc1
    v_mfma_f32_16x16x32_bf16 v[12:15], a[252:255], v[200:203], v[12:15]
    ds_read_b64_tr_b16 a[246:247], v230 offset:38912
    s_add_u32 s67, s67, 4096
    s_waitcnt vmcnt(18) lgkmcnt(8)
    v_mfma_f32_16x16x32_bf16 v[0:3], a[224:227], v[208:211], v[0:3]
    ds_read_b64_tr_b16 a[248:249], v231 offset:36864
    buffer_load_dwordx4 v[160:163], v224, s[36:39], s67 offen offset:0 sc1
    v_mfma_f32_16x16x32_bf16 v[16:19], a[224:227], v[212:215], v[16:19]
    ds_read_b64_tr_b16 a[250:251], v231 offset:38912
    v_mfma_f32_16x16x32_bf16 v[20:23], a[228:231], v[212:215], v[20:23]
    ds_read_b64_tr_b16 a[252:253], v232 offset:36864
    v_mfma_f32_16x16x32_bf16 v[4:7], a[228:231], v[208:211], v[4:7]
    ds_read_b64_tr_b16 a[254:255], v232 offset:38912
    s_barrier
    s_waitcnt lgkmcnt(8)
    v_mfma_f32_16x16x32_bf16 v[8:11], a[232:235], v[208:211], v[8:11]
    ds_read_b64_tr_b16 a[224:225], v229 offset:40960
    buffer_load_dwordx4 v[164:167], v224, s[36:39], s67 offen offset:1024 sc1
    v_mfma_f32_16x16x32_bf16 v[24:27], a[232:235], v[212:215], v[24:27]
    ds_read_b64_tr_b16 a[226:227], v229 offset:43008
    v_mfma_f32_16x16x32_bf16 v[28:31], a[236:239], v[212:215], v[28:31]
    ds_read_b64_tr_b16 a[228:229], v230 offset:40960
    ds_read_b64_tr_b16 a[230:231], v230 offset:43008
    v_mfma_f32_16x16x32_bf16 v[12:15], a[236:239], v[208:211], v[12:15]
    ds_write_b128 v238, a[144:147] offset:24576
    s_waitcnt vmcnt(18) lgkmcnt(9)
    v_mfma_f32_16x16x32_bf16 v[0:3], a[240:243], v[216:219], v[0:3]
    buffer_load_dwordx4 v[168:171], v224, s[36:39], s67 offen offset:2048 sc1
    v_mfma_f32_16x16x32_bf16 v[16:19], a[240:243], v[220:223], v[16:19]
    ds_read_b64_tr_b16 a[232:233], v231 offset:40960
    ds_read_b64_tr_b16 a[234:235], v231 offset:43008
    v_mfma_f32_16x16x32_bf16 v[20:23], a[244:247], v[220:223], v[20:23]
    ds_read_b64_tr_b16 a[236:237], v232 offset:40960
    v_mfma_f32_16x16x32_bf16 v[4:7], a[244:247], v[216:219], v[4:7]
    ds_read_b64_tr_b16 a[238:239], v232 offset:43008
    s_waitcnt lgkmcnt(9)
    v_mfma_f32_16x16x32_bf16 v[8:11], a[248:251], v[216:219], v[8:11]
    ds_read_b64_tr_b16 a[240:241], v229 offset:45056
    buffer_load_dwordx4 v[172:175], v224, s[36:39], s67 offen offset:3072 sc1
    v_mfma_f32_16x16x32_bf16 v[24:27], a[248:251], v[220:223], v[24:27]
    ds_read_b64_tr_b16 a[242:243], v229 offset:47104
    s_add_u32 s67, s67, 4096
    v_mfma_f32_16x16x32_bf16 v[28:31], a[252:255], v[220:223], v[28:31]
    ds_read_b64_tr_b16 a[244:245], v230 offset:45056
    buffer_load_dwordx4 v[176:179], v224, s[36:39], s67 offen offset:0 sc1
    v_mfma_f32_16x16x32_bf16 v[12:15], a[252:255], v[216:219], v[12:15]
    ds_read_b64_tr_b16 a[246:247], v230 offset:47104
    s_waitcnt vmcnt(19) lgkmcnt(9)
    v_mfma_f32_16x16x32_bf16 v[0:3], a[224:227], v[96:99], v[0:3]
    ds_read_b64_tr_b16 a[248:249], v231 offset:45056
    ds_read_b64_tr_b16 a[250:251], v231 offset:47104
    v_mfma_f32_16x16x32_bf16 v[16:19], a[224:227], v[100:103], v[16:19]
    ds_write_b128 v238, a[148:151] offset:28672
    v_mfma_f32_16x16x32_bf16 v[20:23], a[228:231], v[100:103], v[20:23]
    buffer_load_dwordx4 v[180:183], v224, s[36:39], s67 offen offset:1024 sc1
    v_mfma_f32_16x16x32_bf16 v[4:7], a[228:231], v[96:99], v[4:7]
    ds_read_b64_tr_b16 a[252:253], v232 offset:45056
    ds_read_b64_tr_b16 a[254:255], v232 offset:47104
    s_waitcnt lgkmcnt(9)
    v_mfma_f32_16x16x32_bf16 v[8:11], a[232:235], v[96:99], v[8:11]
    ds_read_b64_tr_b16 a[224:225], v229 offset:49152
    v_mfma_f32_16x16x32_bf16 v[24:27], a[232:235], v[100:103], v[24:27]
    ds_read_b64_tr_b16 a[226:227], v229 offset:51200
    v_mfma_f32_16x16x32_bf16 v[28:31], a[236:239], v[100:103], v[28:31]
    ds_read_b64_tr_b16 a[228:229], v230 offset:49152
    buffer_load_dwordx4 v[184:187], v224, s[36:39], s67 offen offset:2048 sc1
    v_mfma_f32_16x16x32_bf16 v[12:15], a[236:239], v[96:99], v[12:15]
    ds_read_b64_tr_b16 a[230:231], v230 offset:51200
    s_waitcnt vmcnt(19) lgkmcnt(9)
    v_mfma_f32_16x16x32_bf16 v[0:3], a[240:243], v[104:107], v[0:3]
    ds_read_b64_tr_b16 a[232:233], v231 offset:49152
    v_mfma_f32_16x16x32_bf16 v[16:19], a[240:243], v[108:111], v[16:19]
    ds_read_b64_tr_b16 a[234:235], v231 offset:51200
    v_mfma_f32_16x16x32_bf16 v[20:23], a[244:247], v[108:111], v[20:23]
    ds_read_b64_tr_b16 a[236:237], v232 offset:49152
    ds_read_b64_tr_b16 a[238:239], v232 offset:51200
    v_mfma_f32_16x16x32_bf16 v[4:7], a[244:247], v[104:107], v[4:7]
    buffer_load_dwordx4 v[188:191], v224, s[36:39], s67 offen offset:3072 sc1
    s_add_u32 s67, s67, 4096
    ds_write_b128 v238, a[152:155] offset:57344
    s_waitcnt lgkmcnt(9)
    v_mfma_f32_16x16x32_bf16 v[8:11], a[248:251], v[104:107], v[8:11]
    buffer_load_dwordx4 v[192:195], v224, s[36:39], s67 offen offset:0 sc1
    v_mfma_f32_16x16x32_bf16 v[24:27], a[248:251], v[108:111], v[24:27]
    ds_read_b64_tr_b16 a[240:241], v229 offset:53248
    ds_read_b64_tr_b16 a[242:243], v229 offset:55296
    v_mfma_f32_16x16x32_bf16 v[28:31], a[252:255], v[108:111], v[28:31]
    ds_read_b64_tr_b16 a[244:245], v230 offset:53248
    v_mfma_f32_16x16x32_bf16 v[12:15], a[252:255], v[104:107], v[12:15]
    ds_read_b64_tr_b16 a[246:247], v230 offset:55296
    s_waitcnt vmcnt(19) lgkmcnt(9)
    v_mfma_f32_16x16x32_bf16 v[0:3], a[224:227], v[112:115], v[0:3]
    ds_read_b64_tr_b16 a[248:249], v231 offset:53248
    buffer_load_dwordx4 v[196:199], v224, s[36:39], s67 offen offset:1024 sc1
    v_mfma_f32_16x16x32_bf16 v[16:19], a[224:227], v[116:119], v[16:19]
    ds_read_b64_tr_b16 a[250:251], v231 offset:55296
    v_mfma_f32_16x16x32_bf16 v[20:23], a[228:231], v[116:119], v[20:23]
    ds_read_b64_tr_b16 a[252:253], v232 offset:53248
    v_mfma_f32_16x16x32_bf16 v[4:7], a[228:231], v[112:115], v[4:7]
    ds_read_b64_tr_b16 a[254:255], v232 offset:55296
    s_waitcnt lgkmcnt(9)
    v_mfma_f32_16x16x32_bf16 v[8:11], a[232:235], v[112:115], v[8:11]
    ds_read_b64_tr_b16 a[224:225], v233 offset:0
    ds_read_b64_tr_b16 a[226:227], v233 offset:2048
    v_mfma_f32_16x16x32_bf16 v[24:27], a[232:235], v[116:119], v[24:27]
    buffer_load_dwordx4 v[200:203], v224, s[36:39], s67 offen offset:2048 sc1
    ds_write_b128 v238, a[156:159] offset:61440
    v_mfma_f32_16x16x32_bf16 v[28:31], a[236:239], v[116:119], v[28:31]
    v_mfma_f32_16x16x32_bf16 v[12:15], a[236:239], v[112:115], v[12:15]
    ds_read_b64_tr_b16 a[228:229], v234 offset:0
    ds_read_b64_tr_b16 a[230:231], v234 offset:2048
    s_waitcnt vmcnt(19) lgkmcnt(9)
    v_mfma_f32_16x16x32_bf16 v[0:3], a[240:243], v[120:123], v[0:3]
    ds_read_b64_tr_b16 a[232:233], v235 offset:0
    buffer_load_dwordx4 v[204:207], v224, s[36:39], s67 offen offset:3072 sc1
    v_mfma_f32_16x16x32_bf16 v[16:19], a[240:243], v[124:127], v[16:19]
    ds_read_b64_tr_b16 a[234:235], v235 offset:2048
    s_add_u32 s67, s67, 4096
    v_mfma_f32_16x16x32_bf16 v[20:23], a[244:247], v[124:127], v[20:23]
    ds_read_b64_tr_b16 a[236:237], v236 offset:0
    buffer_load_dwordx4 v[208:211], v224, s[36:39], s67 offen offset:0 sc1
    v_mfma_f32_16x16x32_bf16 v[4:7], a[244:247], v[120:123], v[4:7]
    ds_read_b64_tr_b16 a[238:239], v236 offset:2048
    s_waitcnt lgkmcnt(9)
    v_mfma_f32_16x16x32_bf16 v[8:11], a[248:251], v[120:123], v[8:11]
    ds_read_b64_tr_b16 a[240:241], v233 offset:4096
    v_mfma_f32_16x16x32_bf16 v[24:27], a[248:251], v[124:127], v[24:27]
    ds_read_b64_tr_b16 a[242:243], v233 offset:6144
    v_mfma_f32_16x16x32_bf16 v[28:31], a[252:255], v[124:127], v[28:31]
    ds_read_b64_tr_b16 a[244:245], v234 offset:4096
    ds_read_b64_tr_b16 a[246:247], v234 offset:6144
    v_mfma_f32_16x16x32_bf16 v[12:15], a[252:255], v[120:123], v[12:15]
    buffer_load_dwordx4 v[212:215], v224, s[36:39], s67 offen offset:1024 sc1
    ds_write_b128 v252, a[160:163] offset:0
    s_waitcnt vmcnt(20) lgkmcnt(9)
    v_mfma_f32_16x16x32_bf16 v[0:3], a[224:227], v[128:131], v[0:3]
    v_mfma_f32_16x16x32_bf16 v[16:19], a[224:227], v[132:135], v[16:19]
    ds_read_b64_tr_b16 a[248:249], v235 offset:4096
    ds_read_b64_tr_b16 a[250:251], v235 offset:6144
    v_mfma_f32_16x16x32_bf16 v[20:23], a[228:231], v[132:135], v[20:23]
    ds_read_b64_tr_b16 a[252:253], v236 offset:4096
    buffer_load_dwordx4 v[216:219], v224, s[36:39], s67 offen offset:2048 sc1
    v_mfma_f32_16x16x32_bf16 v[4:7], a[228:231], v[128:131], v[4:7]
    ds_read_b64_tr_b16 a[254:255], v236 offset:6144
    s_waitcnt lgkmcnt(9)
    v_mfma_f32_16x16x32_bf16 v[8:11], a[232:235], v[128:131], v[8:11]
    ds_read_b64_tr_b16 a[224:225], v233 offset:8192
    v_mfma_f32_16x16x32_bf16 v[24:27], a[232:235], v[132:135], v[24:27]
    ds_read_b64_tr_b16 a[226:227], v233 offset:10240
    v_mfma_f32_16x16x32_bf16 v[28:31], a[236:239], v[132:135], v[28:31]
    ds_read_b64_tr_b16 a[228:229], v234 offset:8192
    buffer_load_dwordx4 v[220:223], v224, s[36:39], s67 offen offset:3072 sc1
    v_mfma_f32_16x16x32_bf16 v[12:15], a[236:239], v[128:131], v[12:15]
    ds_read_b64_tr_b16 a[230:231], v234 offset:10240
    s_add_u32 s67, s67, 4096
    s_waitcnt vmcnt(20) lgkmcnt(9)
    v_mfma_f32_16x16x32_bf16 v[0:3], a[240:243], v[136:139], v[0:3]
    ds_read_b64_tr_b16 a[232:233], v235 offset:8192
    ds_read_b64_tr_b16 a[234:235], v235 offset:10240
    v_mfma_f32_16x16x32_bf16 v[16:19], a[240:243], v[140:143], v[16:19]
    buffer_load_dwordx4 v[96:99], v224, s[36:39], s67 offen offset:0 sc1
    ds_write_b128 v252, a[164:167] offset:4096
    v_mfma_f32_16x16x32_bf16 v[20:23], a[244:247], v[140:143], v[20:23]
    v_mfma_f32_16x16x32_bf16 v[4:7], a[244:247], v[136:139], v[4:7]
    ds_read_b64_tr_b16 a[236:237], v236 offset:8192
    ds_read_b64_tr_b16 a[238:239], v236 offset:10240
    s_waitcnt lgkmcnt(9)
    v_mfma_f32_16x16x32_bf16 v[8:11], a[248:251], v[136:139], v[8:11]
    ds_read_b64_tr_b16 a[240:241], v233 offset:12288
    buffer_load_dwordx4 v[100:103], v224, s[36:39], s67 offen offset:1024 sc1
    v_mfma_f32_16x16x32_bf16 v[24:27], a[248:251], v[140:143], v[24:27]
    ds_read_b64_tr_b16 a[242:243], v233 offset:14336
    v_mfma_f32_16x16x32_bf16 v[28:31], a[252:255], v[140:143], v[28:31]
    ds_read_b64_tr_b16 a[244:245], v234 offset:12288
    v_mfma_f32_16x16x32_bf16 v[12:15], a[252:255], v[136:139], v[12:15]
    ds_read_b64_tr_b16 a[246:247], v234 offset:14336
    s_waitcnt vmcnt(20) lgkmcnt(9)
    v_mfma_f32_16x16x32_bf16 v[0:3], a[224:227], v[144:147], v[0:3]
    ds_read_b64_tr_b16 a[248:249], v235 offset:12288
    buffer_load_dwordx4 v[104:107], v224, s[36:39], s67 offen offset:2048 sc1
    v_mfma_f32_16x16x32_bf16 v[16:19], a[224:227], v[148:151], v[16:19]
    ds_read_b64_tr_b16 a[250:251], v235 offset:14336
    v_mfma_f32_16x16x32_bf16 v[20:23], a[228:231], v[148:151], v[20:23]
    ds_read_b64_tr_b16 a[252:253], v236 offset:12288
    ds_read_b64_tr_b16 a[254:255], v236 offset:14336
    v_mfma_f32_16x16x32_bf16 v[4:7], a[228:231], v[144:147], v[4:7]
    ds_write_b128 v252, a[168:171] offset:8192
    s_waitcnt lgkmcnt(9)
    v_mfma_f32_16x16x32_bf16 v[8:11], a[232:235], v[144:147], v[8:11]
    buffer_load_dwordx4 v[108:111], v224, s[36:39], s67 offen offset:3072 sc1
    s_add_u32 s67, s67, 4096
    v_mfma_f32_16x16x32_bf16 v[24:27], a[232:235], v[148:151], v[24:27]
    ds_read_b64_tr_b16 a[224:225], v233 offset:16384
    ds_read_b64_tr_b16 a[226:227], v233 offset:18432
    v_mfma_f32_16x16x32_bf16 v[28:31], a[236:239], v[148:151], v[28:31]
    ds_read_b64_tr_b16 a[228:229], v234 offset:16384
    buffer_load_dwordx4 v[112:115], v224, s[36:39], s67 offen offset:0 sc1
    v_mfma_f32_16x16x32_bf16 v[12:15], a[236:239], v[144:147], v[12:15]
    ds_read_b64_tr_b16 a[230:231], v234 offset:18432
    s_waitcnt vmcnt(21) lgkmcnt(9)
    v_mfma_f32_16x16x32_bf16 v[0:3], a[240:243], v[152:155], v[0:3]
    ds_read_b64_tr_b16 a[232:233], v235 offset:16384
    v_mfma_f32_16x16x32_bf16 v[16:19], a[240:243], v[156:159], v[16:19]
    ds_read_b64_tr_b16 a[234:235], v235 offset:18432
    v_mfma_f32_16x16x32_bf16 v[20:23], a[244:247], v[156:159], v[20:23]
    ds_read_b64_tr_b16 a[236:237], v236 offset:16384
    buffer_load_dwordx4 v[116:119], v224, s[36:39], s67 offen offset:1024 sc1
    v_mfma_f32_16x16x32_bf16 v[4:7], a[244:247], v[152:155], v[4:7]
    ds_read_b64_tr_b16 a[238:239], v236 offset:18432
    s_waitcnt lgkmcnt(9)
    v_mfma_f32_16x16x32_bf16 v[8:11], a[248:251], v[152:155], v[8:11]
    ds_read_b64_tr_b16 a[240:241], v233 offset:20480
    ds_read_b64_tr_b16 a[242:243], v233 offset:22528
    v_mfma_f32_16x16x32_bf16 v[24:27], a[248:251], v[156:159], v[24:27]
    ds_write_b128 v252, a[172:175] offset:12288
    v_mfma_f32_16x16x32_bf16 v[28:31], a[252:255], v[156:159], v[28:31]
    buffer_load_dwordx4 v[120:123], v224, s[36:39], s67 offen offset:2048 sc1
    v_mfma_f32_16x16x32_bf16 v[12:15], a[252:255], v[152:155], v[12:15]
    ds_read_b64_tr_b16 a[244:245], v234 offset:20480
    ds_read_b64_tr_b16 a[246:247], v234 offset:22528
    s_waitcnt vmcnt(21) lgkmcnt(9)
    v_mfma_f32_16x16x32_bf16 v[0:3], a[224:227], v[160:163], v[0:3]
    ds_read_b64_tr_b16 a[248:249], v235 offset:20480
    v_mfma_f32_16x16x32_bf16 v[16:19], a[224:227], v[164:167], v[16:19]
    ds_read_b64_tr_b16 a[250:251], v235 offset:22528
    v_mfma_f32_16x16x32_bf16 v[20:23], a[228:231], v[164:167], v[20:23]
    ds_read_b64_tr_b16 a[252:253], v236 offset:20480
    buffer_load_dwordx4 v[124:127], v224, s[36:39], s67 offen offset:3072 sc1
    v_mfma_f32_16x16x32_bf16 v[4:7], a[228:231], v[160:163], v[4:7]
    ds_read_b64_tr_b16 a[254:255], v236 offset:22528
    s_add_u32 s67, s67, 4096
    s_waitcnt lgkmcnt(9)
    v_mfma_f32_16x16x32_bf16 v[8:11], a[232:235], v[160:163], v[8:11]
    ds_read_b64_tr_b16 a[224:225], v233 offset:32768
    buffer_load_dwordx4 v[128:131], v224, s[36:39], s67 offen offset:0 sc1
    v_mfma_f32_16x16x32_bf16 v[24:27], a[232:235], v[164:167], v[24:27]
    ds_read_b64_tr_b16 a[226:227], v233 offset:34816
    v_mfma_f32_16x16x32_bf16 v[28:31], a[236:239], v[164:167], v[28:31]
    ds_read_b64_tr_b16 a[228:229], v234 offset:32768
    ds_read_b64_tr_b16 a[230:231], v234 offset:34816
    v_mfma_f32_16x16x32_bf16 v[12:15], a[236:239], v[160:163], v[12:15]
    ds_write_b128 v252, a[176:179] offset:16384
    s_waitcnt vmcnt(21) lgkmcnt(9)
    v_mfma_f32_16x16x32_bf16 v[0:3], a[240:243], v[168:171], v[0:3]
    buffer_load_dwordx4 v[132:135], v224, s[36:39], s67 offen offset:1024 sc1
    v_mfma_f32_16x16x32_bf16 v[16:19], a[240:243], v[172:175], v[16:19]
    ds_read_b64_tr_b16 a[232:233], v235 offset:32768
    ds_read_b64_tr_b16 a[234:235], v235 offset:34816
    v_mfma_f32_16x16x32_bf16 v[20:23], a[244:247], v[172:175], v[20:23]
    ds_read_b64_tr_b16 a[236:237], v236 offset:32768
    v_mfma_f32_16x16x32_bf16 v[4:7], a[244:247], v[168:171], v[4:7]
    ds_read_b64_tr_b16 a[238:239], v236 offset:34816
    s_waitcnt lgkmcnt(9)
    v_mfma_f32_16x16x32_bf16 v[8:11], a[248:251], v[168:171], v[8:11]
    ds_read_b64_tr_b16 a[240:241], v233 offset:36864
    buffer_load_dwordx4 v[136:139], v224, s[36:39], s67 offen offset:2048 sc1
    v_mfma_f32_16x16x32_bf16 v[24:27], a[248:251], v[172:175], v[24:27]
    ds_read_b64_tr_b16 a[242:243], v233 offset:38912
    v_mfma_f32_16x16x32_bf16 v[28:31], a[252:255], v[172:175], v[28:31]
    ds_read_b64_tr_b16 a[244:245], v234 offset:36864
    v_mfma_f32_16x16x32_bf16 v[12:15], a[252:255], v[168:171], v[12:15]
    s_branch L_po_K_7
.p2align 12
L_pg_K_7:
    s_branch L_vret
L_po_K_7:
    ds_read_b64_tr_b16 a[246:247], v234 offset:38912
    s_waitcnt vmcnt(21) lgkmcnt(9)
    v_mfma_f32_16x16x32_bf16 v[0:3], a[224:227], v[176:179], v[0:3]
    ds_read_b64_tr_b16 a[248:249], v235 offset:36864
    ds_read_b64_tr_b16 a[250:251], v235 offset:38912
    v_mfma_f32_16x16x32_bf16 v[16:19], a[224:227], v[180:183], v[16:19]
    buffer_load_dwordx4 v[140:143], v224, s[36:39], s67 offen offset:3072 sc1
    s_add_u32 s67, s67, 4096
    ds_write_b128 v252, a[180:183] offset:20480
    v_mfma_f32_16x16x32_bf16 v[20:23], a[228:231], v[180:183], v[20:23]
    buffer_load_dwordx4 v[144:147], v224, s[36:39], s67 offen offset:0 sc1
    v_mfma_f32_16x16x32_bf16 v[4:7], a[228:231], v[176:179], v[4:7]
    ds_read_b64_tr_b16 a[252:253], v236 offset:36864
    ds_read_b64_tr_b16 a[254:255], v236 offset:38912
    s_waitcnt lgkmcnt(9)
    v_mfma_f32_16x16x32_bf16 v[8:11], a[232:235], v[176:179], v[8:11]
    ds_read_b64_tr_b16 a[224:225], v233 offset:40960
    v_mfma_f32_16x16x32_bf16 v[24:27], a[232:235], v[180:183], v[24:27]
    ds_read_b64_tr_b16 a[226:227], v233 offset:43008
    v_mfma_f32_16x16x32_bf16 v[28:31], a[236:239], v[180:183], v[28:31]
    ds_read_b64_tr_b16 a[228:229], v234 offset:40960
    buffer_load_dwordx4 v[148:151], v224, s[36:39], s67 offen offset:1024 sc1
    v_mfma_f32_16x16x32_bf16 v[12:15], a[236:239], v[176:179], v[12:15]
    ds_read_b64_tr_b16 a[230:231], v234 offset:43008
    s_waitcnt vmcnt(22) lgkmcnt(9)
    v_mfma_f32_16x16x32_bf16 v[0:3], a[240:243], v[184:187], v[0:3]
    ds_read_b64_tr_b16 a[232:233], v235 offset:40960
    v_mfma_f32_16x16x32_bf16 v[16:19], a[240:243], v[188:191], v[16:19]
    ds_read_b64_tr_b16 a[234:235], v235 offset:43008
    v_mfma_f32_16x16x32_bf16 v[20:23], a[244:247], v[188:191], v[20:23]
    ds_read_b64_tr_b16 a[236:237], v236 offset:40960
    ds_read_b64_tr_b16 a[238:239], v236 offset:43008
    v_mfma_f32_16x16x32_bf16 v[4:7], a[244:247], v[184:187], v[4:7]
    buffer_load_dwordx4 v[152:155], v224, s[36:39], s67 offen offset:2048 sc1
    ds_write_b128 v252, a[184:187] offset:24576
    s_waitcnt lgkmcnt(9)
    v_mfma_f32_16x16x32_bf16 v[8:11], a[248:251], v[184:187], v[8:11]
    v_mfma_f32_16x16x32_bf16 v[24:27], a[248:251], v[188:191], v[24:27]
    ds_read_b64_tr_b16 a[240:241], v233 offset:45056
    ds_read_b64_tr_b16 a[242:243], v233 offset:47104
    v_mfma_f32_16x16x32_bf16 v[28:31], a[252:255], v[188:191], v[28:31]
    ds_read_b64_tr_b16 a[244:245], v234 offset:45056
    buffer_load_dwordx4 v[156:159], v224, s[36:39], s67 offen offset:3072 sc1
    v_mfma_f32_16x16x32_bf16 v[12:15], a[252:255], v[184:187], v[12:15]
    ds_read_b64_tr_b16 a[246:247], v234 offset:47104
    s_add_u32 s67, s67, 4096
    s_waitcnt vmcnt(22) lgkmcnt(9)
    v_mfma_f32_16x16x32_bf16 v[0:3], a[224:227], v[192:195], v[0:3]
    ds_read_b64_tr_b16 a[248:249], v235 offset:45056
    buffer_load_dwordx4 v[160:163], v224, s[36:39], s67 offen offset:0 sc1
    v_mfma_f32_16x16x32_bf16 v[16:19], a[224:227], v[196:199], v[16:19]
    ds_read_b64_tr_b16 a[250:251], v235 offset:47104
    v_mfma_f32_16x16x32_bf16 v[20:23], a[228:231], v[196:199], v[20:23]
    ds_read_b64_tr_b16 a[252:253], v236 offset:45056
    v_mfma_f32_16x16x32_bf16 v[4:7], a[228:231], v[192:195], v[4:7]
    ds_read_b64_tr_b16 a[254:255], v236 offset:47104
    s_waitcnt lgkmcnt(9)
    v_mfma_f32_16x16x32_bf16 v[8:11], a[232:235], v[192:195], v[8:11]
    ds_read_b64_tr_b16 a[224:225], v233 offset:49152
    ds_read_b64_tr_b16 a[226:227], v233 offset:51200
    v_mfma_f32_16x16x32_bf16 v[24:27], a[232:235], v[196:199], v[24:27]
    buffer_load_dwordx4 v[164:167], v224, s[36:39], s67 offen offset:1024 sc1
    ds_write_b128 v252, a[188:191] offset:28672
    v_mfma_f32_16x16x32_bf16 v[28:31], a[236:239], v[196:199], v[28:31]
    v_mfma_f32_16x16x32_bf16 v[12:15], a[236:239], v[192:195], v[12:15]
    ds_read_b64_tr_b16 a[228:229], v234 offset:49152
    ds_read_b64_tr_b16 a[230:231], v234 offset:51200
    s_waitcnt vmcnt(22) lgkmcnt(9)
    v_mfma_f32_16x16x32_bf16 v[0:3], a[240:243], v[200:203], v[0:3]
    ds_read_b64_tr_b16 a[232:233], v235 offset:49152
    buffer_load_dwordx4 v[168:171], v224, s[36:39], s67 offen offset:2048 sc1
    v_mfma_f32_16x16x32_bf16 v[16:19], a[240:243], v[204:207], v[16:19]
    ds_read_b64_tr_b16 a[234:235], v235 offset:51200
    v_mfma_f32_16x16x32_bf16 v[20:23], a[244:247], v[204:207], v[20:23]
    ds_read_b64_tr_b16 a[236:237], v236 offset:49152
    v_mfma_f32_16x16x32_bf16 v[4:7], a[244:247], v[200:203], v[4:7]
    ds_read_b64_tr_b16 a[238:239], v236 offset:51200
    s_waitcnt lgkmcnt(9)
    v_mfma_f32_16x16x32_bf16 v[8:11], a[248:251], v[200:203], v[8:11]
    ds_read_b64_tr_b16 a[240:241], v233 offset:53248
    buffer_load_dwordx4 v[172:175], v224, s[36:39], s67 offen offset:3072 sc1
    v_mfma_f32_16x16x32_bf16 v[24:27], a[248:251], v[204:207], v[24:27]
    ds_read_b64_tr_b16 a[242:243], v233 offset:55296
    s_add_u32 s67, s67, 4096
    v_mfma_f32_16x16x32_bf16 v[28:31], a[252:255], v[204:207], v[28:31]
    ds_read_b64_tr_b16 a[244:245], v234 offset:53248
    buffer_load_dwordx4 v[176:179], v224, s[36:39], s67 offen offset:0 sc1
    v_mfma_f32_16x16x32_bf16 v[12:15], a[252:255], v[200:203], v[12:15]
    ds_read_b64_tr_b16 a[246:247], v234 offset:55296
    s_waitcnt vmcnt(23) lgkmcnt(8)
    v_mfma_f32_16x16x32_bf16 v[0:3], a[224:227], v[208:211], v[0:3]
    ds_read_b64_tr_b16 a[248:249], v235 offset:53248
    v_mfma_f32_16x16x32_bf16 v[16:19], a[224:227], v[212:215], v[16:19]
    ds_read_b64_tr_b16 a[250:251], v235 offset:55296
    v_mfma_f32_16x16x32_bf16 v[20:23], a[228:231], v[212:215], v[20:23]
    ds_read_b64_tr_b16 a[252:253], v236 offset:53248
    buffer_load_dwordx4 v[180:183], v224, s[36:39], s67 offen offset:1024 sc1
    v_mfma_f32_16x16x32_bf16 v[4:7], a[228:231], v[208:211], v[4:7]
    ds_read_b64_tr_b16 a[254:255], v236 offset:55296
    s_barrier
    s_waitcnt lgkmcnt(8)
    v_mfma_f32_16x16x32_bf16 v[8:11], a[232:235], v[208:211], v[8:11]
    ds_read_b64_tr_b16 a[224:225], v229 offset:24576
    v_mfma_f32_16x16x32_bf16 v[24:27], a[232:235], v[212:215], v[24:27]
    ds_read_b64_tr_b16 a[226:227], v229 offset:26624
    v_mfma_f32_16x16x32_bf16 v[28:31], a[236:239], v[212:215], v[28:31]
    ds_read_b64_tr_b16 a[228:229], v230 offset:24576
    ds_read_b64_tr_b16 a[230:231], v230 offset:26624
    v_mfma_f32_16x16x32_bf16 v[12:15], a[236:239], v[208:211], v[12:15]
    buffer_load_dwordx4 v[184:187], v224, s[36:39], s67 offen offset:2048 sc1
    ds_write_b128 v237, a[192:195] offset:0
    s_waitcnt vmcnt(23) lgkmcnt(9)
    v_mfma_f32_16x16x32_bf16 v[0:3], a[240:243], v[216:219], v[0:3]
    v_mfma_f32_16x16x32_bf16 v[16:19], a[240:243], v[220:223], v[16:19]
    ds_read_b64_tr_b16 a[232:233], v231 offset:24576
    ds_read_b64_tr_b16 a[234:235], v231 offset:26624
    v_mfma_f32_16x16x32_bf16 v[20:23], a[244:247], v[220:223], v[20:23]
    ds_read_b64_tr_b16 a[236:237], v232 offset:24576
    buffer_load_dwordx4 v[188:191], v224, s[36:39], s67 offen offset:3072 sc1
    v_mfma_f32_16x16x32_bf16 v[4:7], a[244:247], v[216:219], v[4:7]
    ds_read_b64_tr_b16 a[238:239], v232 offset:26624
    s_add_u32 s67, s67, 4096
    s_waitcnt lgkmcnt(9)
    v_mfma_f32_16x16x32_bf16 v[8:11], a[248:251], v[216:219], v[8:11]
    ds_read_b64_tr_b16 a[240:241], v229 offset:28672
    buffer_load_dwordx4 v[192:195], v224, s[36:39], s67 offen offset:0 sc1
    v_mfma_f32_16x16x32_bf16 v[24:27], a[248:251], v[220:223], v[24:27]
    ds_read_b64_tr_b16 a[242:243], v229 offset:30720
    v_mfma_f32_16x16x32_bf16 v[28:31], a[252:255], v[220:223], v[28:31]
    ds_read_b64_tr_b16 a[244:245], v230 offset:28672
    v_mfma_f32_16x16x32_bf16 v[12:15], a[252:255], v[216:219], v[12:15]
    ds_read_b64_tr_b16 a[246:247], v230 offset:30720
    s_waitcnt vmcnt(23) lgkmcnt(9)
    v_mfma_f32_16x16x32_bf16 v[0:3], a[224:227], v[96:99], v[0:3]
    ds_read_b64_tr_b16 a[248:249], v231 offset:28672
    buffer_load_dwordx4 v[196:199], v224, s[36:39], s67 offen offset:1024 sc1
    v_mfma_f32_16x16x32_bf16 v[16:19], a[224:227], v[100:103], v[16:19]
    ds_read_b64_tr_b16 a[250:251], v231 offset:30720
    v_mfma_f32_16x16x32_bf16 v[20:23], a[228:231], v[100:103], v[20:23]
    ds_read_b64_tr_b16 a[252:253], v232 offset:28672
    v_mfma_f32_16x16x32_bf16 v[4:7], a[228:231], v[96:99], v[4:7]
    ds_read_b64_tr_b16 a[254:255], v232 offset:30720
    s_waitcnt lgkmcnt(8)
    v_mfma_f32_16x16x32_bf16 v[8:11], a[232:235], v[96:99], v[8:11]
    ds_read_b64_tr_b16 a[224:225], v229 offset:57344
    ds_read_b64_tr_b16 a[226:227], v229 offset:59392
    v_mfma_f32_16x16x32_bf16 v[24:27], a[232:235], v[100:103], v[24:27]
    buffer_load_dwordx4 v[200:203], v224, s[36:39], s67 offen offset:2048 sc1
    ds_write_b128 v237, a[196:199] offset:4096
    v_mfma_f32_16x16x32_bf16 v[28:31], a[236:239], v[100:103], v[28:31]
    v_mfma_f32_16x16x32_bf16 v[12:15], a[236:239], v[96:99], v[12:15]
    ds_read_b64_tr_b16 a[228:229], v230 offset:57344
    ds_read_b64_tr_b16 a[230:231], v230 offset:59392
    s_waitcnt vmcnt(23) lgkmcnt(9)
    v_mfma_f32_16x16x32_bf16 v[0:3], a[240:243], v[104:107], v[0:3]
    ds_read_b64_tr_b16 a[232:233], v231 offset:57344
    buffer_load_dwordx4 v[204:207], v224, s[36:39], s67 offen offset:3072 sc1
    v_mfma_f32_16x16x32_bf16 v[16:19], a[240:243], v[108:111], v[16:19]
    ds_read_b64_tr_b16 a[234:235], v231 offset:59392
    s_add_u32 s67, s67, 4096
    v_mfma_f32_16x16x32_bf16 v[20:23], a[244:247], v[108:111], v[20:23]
    ds_read_b64_tr_b16 a[236:237], v232 offset:57344
    buffer_load_dwordx4 v[208:211], v224, s[36:39], s67 offen offset:0 sc1
    v_mfma_f32_16x16x32_bf16 v[4:7], a[244:247], v[104:107], v[4:7]
    ds_read_b64_tr_b16 a[238:239], v232 offset:59392
    s_waitcnt lgkmcnt(9)
    v_mfma_f32_16x16x32_bf16 v[8:11], a[248:251], v[104:107], v[8:11]
    ds_read_b64_tr_b16 a[240:241], v229 offset:61440
    v_mfma_f32_16x16x32_bf16 v[24:27], a[248:251], v[108:111], v[24:27]
    ds_read_b64_tr_b16 a[242:243], v229 offset:63488
    v_mfma_f32_16x16x32_bf16 v[28:31], a[252:255], v[108:111], v[28:31]
    ds_read_b64_tr_b16 a[244:245], v230 offset:61440
    buffer_load_dwordx4 v[212:215], v224, s[36:39], s67 offen offset:1024 sc1
    v_mfma_f32_16x16x32_bf16 v[12:15], a[252:255], v[104:107], v[12:15]
    ds_read_b64_tr_b16 a[246:247], v230 offset:63488
    s_waitcnt vmcnt(24) lgkmcnt(8)
    v_mfma_f32_16x16x32_bf16 v[0:3], a[224:227], v[112:115], v[0:3]
    ds_read_b64_tr_b16 a[248:249], v231 offset:61440
    v_mfma_f32_16x16x32_bf16 v[16:19], a[224:227], v[116:119], v[16:19]
    ds_read_b64_tr_b16 a[250:251], v231 offset:63488
    v_mfma_f32_16x16x32_bf16 v[20:23], a[228:231], v[116:119], v[20:23]
    ds_read_b64_tr_b16 a[252:253], v232 offset:61440
    buffer_load_dwordx4 v[216:219], v224, s[36:39], s67 offen offset:2048 sc1
    v_mfma_f32_16x16x32_bf16 v[4:7], a[228:231], v[112:115], v[4:7]
    ds_read_b64_tr_b16 a[254:255], v232 offset:63488
    s_waitcnt lgkmcnt(8)
    v_mfma_f32_16x16x32_bf16 v[8:11], a[232:235], v[112:115], v[8:11]
    ds_read_b64_tr_b16 a[224:225], v233 offset:24576
    ds_read_b64_tr_b16 a[226:227], v233 offset:26624
    v_mfma_f32_16x16x32_bf16 v[24:27], a[232:235], v[116:119], v[24:27]
    ds_write_b128 v237, a[200:203] offset:8192
    v_mfma_f32_16x16x32_bf16 v[28:31], a[236:239], v[116:119], v[28:31]
    buffer_load_dwordx4 v[220:223], v224, s[36:39], s67 offen offset:3072 sc1
    s_add_u32 s67, s67, 4096
    v_mfma_f32_16x16x32_bf16 v[12:15], a[236:239], v[112:115], v[12:15]
    ds_read_b64_tr_b16 a[228:229], v234 offset:24576
    ds_read_b64_tr_b16 a[230:231], v234 offset:26624
    s_waitcnt vmcnt(24) lgkmcnt(9)
    v_mfma_f32_16x16x32_bf16 v[0:3], a[240:243], v[120:123], v[0:3]
    ds_read_b64_tr_b16 a[232:233], v235 offset:24576
    buffer_load_dwordx4 v[96:99], v224, s[36:39], s67 offen offset:0 sc1
    v_mfma_f32_16x16x32_bf16 v[16:19], a[240:243], v[124:127], v[16:19]
    ds_read_b64_tr_b16 a[234:235], v235 offset:26624
    v_mfma_f32_16x16x32_bf16 v[20:23], a[244:247], v[124:127], v[20:23]
    ds_read_b64_tr_b16 a[236:237], v236 offset:24576
    v_mfma_f32_16x16x32_bf16 v[4:7], a[244:247], v[120:123], v[4:7]
    ds_read_b64_tr_b16 a[238:239], v236 offset:26624
    s_waitcnt lgkmcnt(9)
    v_mfma_f32_16x16x32_bf16 v[8:11], a[248:251], v[120:123], v[8:11]
    ds_read_b64_tr_b16 a[240:241], v233 offset:28672
    buffer_load_dwordx4 v[100:103], v224, s[36:39], s67 offen offset:1024 sc1
    v_mfma_f32_16x16x32_bf16 v[24:27], a[248:251], v[124:127], v[24:27]
    ds_read_b64_tr_b16 a[242:243], v233 offset:30720
    v_mfma_f32_16x16x32_bf16 v[28:31], a[252:255], v[124:127], v[28:31]
    ds_read_b64_tr_b16 a[244:245], v234 offset:28672
    v_mfma_f32_16x16x32_bf16 v[12:15], a[252:255], v[120:123], v[12:15]
    ds_read_b64_tr_b16 a[246:247], v234 offset:30720
    s_waitcnt vmcnt(24) lgkmcnt(8)
    v_mfma_f32_16x16x32_bf16 v[0:3], a[224:227], v[128:131], v[0:3]
    ds_read_b64_tr_b16 a[248:249], v235 offset:28672
    buffer_load_dwordx4 v[104:107], v224, s[36:39], s67 offen offset:2048 sc1
    v_mfma_f32_16x16x32_bf16 v[16:19], a[224:227], v[132:135], v[16:19]
    ds_read_b64_tr_b16 a[250:251], v235 offset:30720
    v_mfma_f32_16x16x32_bf16 v[20:23], a[228:231], v[132:135], v[20:23]
    ds_read_b64_tr_b16 a[252:253], v236 offset:28672
    ds_read_b64_tr_b16 a[254:255], v236 offset:30720
    v_mfma_f32_16x16x32_bf16 v[4:7], a[228:231], v[128:131], v[4:7]
    ds_write_b128 v237, a[204:207] offset:12288
    s_waitcnt lgkmcnt(9)
    v_mfma_f32_16x16x32_bf16 v[8:11], a[232:235], v[128:131], v[8:11]
    buffer_load_dwordx4 v[108:111], v224, s[36:39], s67 offen offset:3072 sc1
    s_add_u32 s67, s67, 4096
    v_mfma_f32_16x16x32_bf16 v[24:27], a[232:235], v[132:135], v[24:27]
    ds_read_b64_tr_b16 a[224:225], v233 offset:57344
    ds_read_b64_tr_b16 a[226:227], v233 offset:59392
    v_mfma_f32_16x16x32_bf16 v[28:31], a[236:239], v[132:135], v[28:31]
    ds_read_b64_tr_b16 a[228:229], v234 offset:57344
    buffer_load_dwordx4 v[112:115], v224, s[36:39], s67 offen offset:0 sc1
    v_mfma_f32_16x16x32_bf16 v[12:15], a[236:239], v[128:131], v[12:15]
    ds_read_b64_tr_b16 a[230:231], v234 offset:59392
    s_waitcnt vmcnt(25) lgkmcnt(9)
    v_mfma_f32_16x16x32_bf16 v[0:3], a[240:243], v[136:139], v[0:3]
    ds_read_b64_tr_b16 a[232:233], v235 offset:57344
    v_mfma_f32_16x16x32_bf16 v[16:19], a[240:243], v[140:143], v[16:19]
    ds_read_b64_tr_b16 a[234:235], v235 offset:59392
    v_mfma_f32_16x16x32_bf16 v[20:23], a[244:247], v[140:143], v[20:23]
    ds_read_b64_tr_b16 a[236:237], v236 offset:57344
    buffer_load_dwordx4 v[116:119], v224, s[36:39], s67 offen offset:1024 sc1
    v_mfma_f32_16x16x32_bf16 v[4:7], a[244:247], v[136:139], v[4:7]
    ds_read_b64_tr_b16 a[238:239], v236 offset:59392
    s_waitcnt lgkmcnt(9)
    v_mfma_f32_16x16x32_bf16 v[8:11], a[248:251], v[136:139], v[8:11]
    ds_read_b64_tr_b16 a[240:241], v233 offset:61440
    v_mfma_f32_16x16x32_bf16 v[24:27], a[248:251], v[140:143], v[24:27]
    ds_read_b64_tr_b16 a[242:243], v233 offset:63488
    v_mfma_f32_16x16x32_bf16 v[28:31], a[252:255], v[140:143], v[28:31]
    ds_read_b64_tr_b16 a[244:245], v234 offset:61440
    buffer_load_dwordx4 v[120:123], v224, s[36:39], s67 offen offset:2048 sc1
    v_mfma_f32_16x16x32_bf16 v[12:15], a[252:255], v[136:139], v[12:15]
    ds_read_b64_tr_b16 a[246:247], v234 offset:63488
    s_waitcnt vmcnt(25) lgkmcnt(8)
    v_mfma_f32_16x16x32_bf16 v[0:3], a[224:227], v[144:147], v[0:3]
    ds_read_b64_tr_b16 a[248:249], v235 offset:61440
    v_mfma_f32_16x16x32_bf16 v[16:19], a[224:227], v[148:151], v[16:19]
    ds_read_b64_tr_b16 a[250:251], v235 offset:63488
    v_mfma_f32_16x16x32_bf16 v[20:23], a[228:231], v[148:151], v[20:23]
    ds_read_b64_tr_b16 a[252:253], v236 offset:61440
    ds_read_b64_tr_b16 a[254:255], v236 offset:63488
    v_mfma_f32_16x16x32_bf16 v[4:7], a[228:231], v[144:147], v[4:7]
    buffer_load_dwordx4 v[124:127], v224, s[36:39], s67 offen offset:3072 sc1
    s_add_u32 s67, s67, 4096
    ds_write_b128 v237, a[208:211] offset:16384
    s_waitcnt lgkmcnt(9)
    v_mfma_f32_16x16x32_bf16 v[8:11], a[232:235], v[144:147], v[8:11]
    buffer_load_dwordx4 v[128:131], v224, s[36:39], s67 offen offset:0 sc1
    v_mfma_f32_16x16x32_bf16 v[24:27], a[232:235], v[148:151], v[24:27]
    ds_read_b64_tr_b16 a[224:225], v248 offset:0
    ds_read_b64_tr_b16 a[226:227], v248 offset:2048
    v_mfma_f32_16x16x32_bf16 v[28:31], a[236:239], v[148:151], v[28:31]
    ds_read_b64_tr_b16 a[228:229], v249 offset:0
    v_mfma_f32_16x16x32_bf16 v[12:15], a[236:239], v[144:147], v[12:15]
    ds_read_b64_tr_b16 a[230:231], v249 offset:2048
    s_waitcnt vmcnt(25) lgkmcnt(9)
    v_mfma_f32_16x16x32_bf16 v[0:3], a[240:243], v[152:155], v[0:3]
    ds_read_b64_tr_b16 a[232:233], v250 offset:0
    buffer_load_dwordx4 v[132:135], v224, s[36:39], s67 offen offset:1024 sc1
    v_mfma_f32_16x16x32_bf16 v[16:19], a[240:243], v[156:159], v[16:19]
    ds_read_b64_tr_b16 a[234:235], v250 offset:2048
    v_mfma_f32_16x16x32_bf16 v[20:23], a[244:247], v[156:159], v[20:23]
    ds_read_b64_tr_b16 a[236:237], v251 offset:0
    v_mfma_f32_16x16x32_bf16 v[4:7], a[244:247], v[152:155], v[4:7]
    ds_read_b64_tr_b16 a[238:239], v251 offset:2048
    s_waitcnt lgkmcnt(9)
    v_mfma_f32_16x16x32_bf16 v[8:11], a[248:251], v[152:155], v[8:11]
    ds_read_b64_tr_b16 a[240:241], v248 offset:4096
    buffer_load_dwordx4 v[136:139], v224, s[36:39], s67 offen offset:2048 sc1
    v_mfma_f32_16x16x32_bf16 v[24:27], a[248:251], v[156:159], v[24:27]
    ds_read_b64_tr_b16 a[242:243], v248 offset:6144
    v_mfma_f32_16x16x32_bf16 v[28:31], a[252:255], v[156:159], v[28:31]
    ds_read_b64_tr_b16 a[244:245], v249 offset:4096
    v_mfma_f32_16x16x32_bf16 v[12:15], a[252:255], v[152:155], v[12:15]
    ds_read_b64_tr_b16 a[246:247], v249 offset:6144
    s_waitcnt vmcnt(25) lgkmcnt(8)
    v_mfma_f32_16x16x32_bf16 v[0:3], a[224:227], v[160:163], v[0:3]
    ds_read_b64_tr_b16 a[248:249], v250 offset:4096
    buffer_load_dwordx4 v[140:143], v224, s[36:39], s67 offen offset:3072 sc1
    v_mfma_f32_16x16x32_bf16 v[16:19], a[224:227], v[164:167], v[16:19]
    ds_read_b64_tr_b16 a[250:251], v250 offset:6144
    s_add_u32 s67, s67, 4096
    v_mfma_f32_16x16x32_bf16 v[20:23], a[228:231], v[164:167], v[20:23]
    ds_read_b64_tr_b16 a[252:253], v251 offset:4096
    ds_read_b64_tr_b16 a[254:255], v251 offset:6144
    v_mfma_f32_16x16x32_bf16 v[4:7], a[228:231], v[160:163], v[4:7]
    buffer_load_dwordx4 v[144:147], v224, s[36:39], s67 offen offset:0 sc1
    ds_write_b128 v237, a[212:215] offset:20480
    s_waitcnt lgkmcnt(9)
    v_mfma_f32_16x16x32_bf16 v[8:11], a[232:235], v[160:163], v[8:11]
    v_mfma_f32_16x16x32_bf16 v[24:27], a[232:235], v[164:167], v[24:27]
    ds_read_b64_tr_b16 a[224:225], v248 offset:8192
    ds_read_b64_tr_b16 a[226:227], v248 offset:10240
    v_mfma_f32_16x16x32_bf16 v[28:31], a[236:239], v[164:167], v[28:31]
    ds_read_b64_tr_b16 a[228:229], v249 offset:8192
    buffer_load_dwordx4 v[148:151], v224, s[36:39], s67 offen offset:1024 sc1
    v_mfma_f32_16x16x32_bf16 v[12:15], a[236:239], v[160:163], v[12:15]
    ds_read_b64_tr_b16 a[230:231], v249 offset:10240
    s_waitcnt vmcnt(26) lgkmcnt(9)
    v_mfma_f32_16x16x32_bf16 v[0:3], a[240:243], v[168:171], v[0:3]
    ds_read_b64_tr_b16 a[232:233], v250 offset:8192
    v_mfma_f32_16x16x32_bf16 v[16:19], a[240:243], v[172:175], v[16:19]
    ds_read_b64_tr_b16 a[234:235], v250 offset:10240
    v_mfma_f32_16x16x32_bf16 v[20:23], a[244:247], v[172:175], v[20:23]
    ds_read_b64_tr_b16 a[236:237], v251 offset:8192
    buffer_load_dwordx4 v[152:155], v224, s[36:39], s67 offen offset:2048 sc1
    v_mfma_f32_16x16x32_bf16 v[4:7], a[244:247], v[168:171], v[4:7]
    ds_read_b64_tr_b16 a[238:239], v251 offset:10240
    s_waitcnt lgkmcnt(9)
    v_mfma_f32_16x16x32_bf16 v[8:11], a[248:251], v[168:171], v[8:11]
    ds_read_b64_tr_b16 a[240:241], v248 offset:12288
    buffer_load_dwordx4 v[156:159], v224, s[36:39], s67 offen offset:3072 sc1
    v_mfma_f32_16x16x32_bf16 v[24:27], a[248:251], v[172:175], v[24:27]
    ds_read_b64_tr_b16 a[242:243], v248 offset:14336
    s_add_u32 s67, s67, 4096
    v_mfma_f32_16x16x32_bf16 v[28:31], a[252:255], v[172:175], v[28:31]
    ds_read_b64_tr_b16 a[244:245], v249 offset:12288
    buffer_load_dwordx4 v[64:67], v239, s[40:43], s65 offen offset:0
    v_mfma_f32_16x16x32_bf16 v[12:15], a[252:255], v[168:171], v[12:15]
    ds_read_b64_tr_b16 a[246:247], v249 offset:14336
    s_waitcnt vmcnt(27) lgkmcnt(8)
    v_mfma_f32_16x16x32_bf16 v[0:3], a[224:227], v[176:179], v[0:3]
    ds_read_b64_tr_b16 a[248:249], v250 offset:12288
    ds_read_b64_tr_b16 a[250:251], v250 offset:14336
    v_mfma_f32_16x16x32_bf16 v[16:19], a[224:227], v[180:183], v[16:19]
    buffer_load_dwordx4 v[68:71], v239, s[40:43], s65 offen offset:64
    ds_write_b128 v237, a[216:219] offset:32768
    v_mfma_f32_16x16x32_bf16 v[20:23], a[228:231], v[180:183], v[20:23]
    buffer_load_dwordx4 v[72:75], v239, s[40:43], s65 offen offset:2048
    v_mfma_f32_16x16x32_bf16 v[4:7], a[228:231], v[176:179], v[4:7]
    ds_read_b64_tr_b16 a[252:253], v251 offset:12288
    ds_read_b64_tr_b16 a[254:255], v251 offset:14336
    s_waitcnt lgkmcnt(9)
    v_mfma_f32_16x16x32_bf16 v[8:11], a[232:235], v[176:179], v[8:11]
    ds_read_b64_tr_b16 a[224:225], v248 offset:16384
    buffer_load_dwordx4 v[76:79], v239, s[40:43], s65 offen offset:2112
    v_mfma_f32_16x16x32_bf16 v[24:27], a[232:235], v[180:183], v[24:27]
    ds_read_b64_tr_b16 a[226:227], v248 offset:18432
    v_mfma_f32_16x16x32_bf16 v[28:31], a[236:239], v[180:183], v[28:31]
    ds_read_b64_tr_b16 a[228:229], v249 offset:16384
    v_mfma_f32_16x16x32_bf16 v[12:15], a[236:239], v[176:179], v[12:15]
    ds_read_b64_tr_b16 a[230:231], v249 offset:18432
    s_waitcnt vmcnt(28) lgkmcnt(9)
    v_mfma_f32_16x16x32_bf16 v[0:3], a[240:243], v[184:187], v[0:3]
    ds_read_b64_tr_b16 a[232:233], v250 offset:16384
    v_mfma_f32_16x16x32_bf16 v[16:19], a[240:243], v[188:191], v[16:19]
    ds_read_b64_tr_b16 a[234:235], v250 offset:18432
    v_mfma_f32_16x16x32_bf16 v[20:23], a[244:247], v[188:191], v[20:23]
    ds_read_b64_tr_b16 a[236:237], v251 offset:16384
    v_mfma_f32_16x16x32_bf16 v[4:7], a[244:247], v[184:187], v[4:7]
    ds_read_b64_tr_b16 a[238:239], v251 offset:18432
    s_waitcnt lgkmcnt(8)
    v_mfma_f32_16x16x32_bf16 v[8:11], a[248:251], v[184:187], v[8:11]
    ds_read_b64_tr_b16 a[240:241], v248 offset:20480
    v_mfma_f32_16x16x32_bf16 v[24:27], a[248:251], v[188:191], v[24:27]
    ds_read_b64_tr_b16 a[242:243], v248 offset:22528
    v_mfma_f32_16x16x32_bf16 v[28:31], a[252:255], v[188:191], v[28:31]
    ds_read_b64_tr_b16 a[244:245], v249 offset:20480
    v_mfma_f32_16x16x32_bf16 v[12:15], a[252:255], v[184:187], v[12:15]
    ds_read_b64_tr_b16 a[246:247], v249 offset:22528
    s_waitcnt vmcnt(26) lgkmcnt(8)
    v_mfma_f32_16x16x32_bf16 v[0:3], a[224:227], v[192:195], v[0:3]
    ds_read_b64_tr_b16 a[248:249], v250 offset:20480
    ds_read_b64_tr_b16 a[250:251], v250 offset:22528
    v_mfma_f32_16x16x32_bf16 v[16:19], a[224:227], v[196:199], v[16:19]
    ds_write_b128 v237, a[220:223] offset:36864
    v_mfma_f32_16x16x32_bf16 v[20:23], a[228:231], v[196:199], v[20:23]
    v_mfma_f32_16x16x32_bf16 v[4:7], a[228:231], v[192:195], v[4:7]
    ds_read_b64_tr_b16 a[252:253], v251 offset:20480
    ds_read_b64_tr_b16 a[254:255], v251 offset:22528
    s_waitcnt lgkmcnt(9)
    v_mfma_f32_16x16x32_bf16 v[8:11], a[232:235], v[192:195], v[8:11]
    ds_read_b64_tr_b16 a[224:225], v248 offset:24576
    v_mfma_f32_16x16x32_bf16 v[24:27], a[232:235], v[196:199], v[24:27]
    ds_read_b64_tr_b16 a[226:227], v248 offset:26624
    v_mfma_f32_16x16x32_bf16 v[28:31], a[236:239], v[196:199], v[28:31]
    ds_read_b64_tr_b16 a[228:229], v249 offset:24576
    v_mfma_f32_16x16x32_bf16 v[12:15], a[236:239], v[192:195], v[12:15]
    ds_read_b64_tr_b16 a[230:231], v249 offset:26624
    s_waitcnt vmcnt(24) lgkmcnt(9)
    v_mfma_f32_16x16x32_bf16 v[0:3], a[240:243], v[200:203], v[0:3]
    ds_read_b64_tr_b16 a[232:233], v250 offset:24576
    v_mfma_f32_16x16x32_bf16 v[16:19], a[240:243], v[204:207], v[16:19]
    ds_read_b64_tr_b16 a[234:235], v250 offset:26624
    v_mfma_f32_16x16x32_bf16 v[20:23], a[244:247], v[204:207], v[20:23]
    ds_read_b64_tr_b16 a[236:237], v251 offset:24576
    v_mfma_f32_16x16x32_bf16 v[4:7], a[244:247], v[200:203], v[4:7]
    ds_read_b64_tr_b16 a[238:239], v251 offset:26624
    s_waitcnt lgkmcnt(8)
    v_mfma_f32_16x16x32_bf16 v[8:11], a[248:251], v[200:203], v[8:11]
    ds_read_b64_tr_b16 a[240:241], v248 offset:28672
    v_mfma_f32_16x16x32_bf16 v[24:27], a[248:251], v[204:207], v[24:27]
    ds_read_b64_tr_b16 a[242:243], v248 offset:30720
    v_mfma_f32_16x16x32_bf16 v[28:31], a[252:255], v[204:207], v[28:31]
    ds_read_b64_tr_b16 a[244:245], v249 offset:28672
    v_mfma_f32_16x16x32_bf16 v[12:15], a[252:255], v[200:203], v[12:15]
    ds_read_b64_tr_b16 a[246:247], v249 offset:30720
    s_waitcnt vmcnt(22) lgkmcnt(8)
    v_mfma_f32_16x16x32_bf16 v[0:3], a[224:227], v[208:211], v[0:3]
    ds_read_b64_tr_b16 a[248:249], v250 offset:28672
    v_mfma_f32_16x16x32_bf16 v[16:19], a[224:227], v[212:215], v[16:19]
    ds_read_b64_tr_b16 a[250:251], v250 offset:30720
    v_mfma_f32_16x16x32_bf16 v[20:23], a[228:231], v[212:215], v[20:23]
    ds_read_b64_tr_b16 a[252:253], v251 offset:28672
    v_mfma_f32_16x16x32_bf16 v[4:7], a[228:231], v[208:211], v[4:7]
    ds_read_b64_tr_b16 a[254:255], v251 offset:30720
    s_barrier
    s_waitcnt lgkmcnt(8)
    v_mfma_f32_16x16x32_bf16 v[8:11], a[232:235], v[208:211], v[8:11]
    ds_read_b64_tr_b16 a[224:225], v229 offset:0
    v_mfma_f32_16x16x32_bf16 v[24:27], a[232:235], v[212:215], v[24:27]
    ds_read_b64_tr_b16 a[226:227], v229 offset:2048
    v_mfma_f32_16x16x32_bf16 v[28:31], a[236:239], v[212:215], v[28:31]
    ds_read_b64_tr_b16 a[228:229], v230 offset:0
    v_mfma_f32_16x16x32_bf16 v[12:15], a[236:239], v[208:211], v[12:15]
    ds_read_b64_tr_b16 a[230:231], v230 offset:2048
    s_waitcnt vmcnt(20) lgkmcnt(8)
    v_mfma_f32_16x16x32_bf16 v[0:3], a[240:243], v[216:219], v[0:3]
    ds_read_b64_tr_b16 a[232:233], v231 offset:0
    v_mfma_f32_16x16x32_bf16 v[16:19], a[240:243], v[220:223], v[16:19]
    ds_read_b64_tr_b16 a[234:235], v231 offset:2048
    v_mfma_f32_16x16x32_bf16 v[20:23], a[244:247], v[220:223], v[20:23]
    ds_read_b64_tr_b16 a[236:237], v232 offset:0
    v_mfma_f32_16x16x32_bf16 v[4:7], a[244:247], v[216:219], v[4:7]
    ds_read_b64_tr_b16 a[238:239], v232 offset:2048
    s_waitcnt lgkmcnt(8)
    v_mfma_f32_16x16x32_bf16 v[8:11], a[248:251], v[216:219], v[8:11]
    ds_read_b64_tr_b16 a[240:241], v229 offset:4096
    v_mfma_f32_16x16x32_bf16 v[24:27], a[248:251], v[220:223], v[24:27]
    ds_read_b64_tr_b16 a[242:243], v229 offset:6144
    v_mfma_f32_16x16x32_bf16 v[28:31], a[252:255], v[220:223], v[28:31]
    ds_read_b64_tr_b16 a[244:245], v230 offset:4096
    v_mfma_f32_16x16x32_bf16 v[12:15], a[252:255], v[216:219], v[12:15]
    ds_read_b64_tr_b16 a[246:247], v230 offset:6144
    s_waitcnt vmcnt(18) lgkmcnt(8)
    v_mfma_f32_16x16x32_bf16 v[0:3], a[224:227], v[96:99], v[0:3]
    ds_read_b64_tr_b16 a[248:249], v231 offset:4096
    v_mfma_f32_16x16x32_bf16 v[16:19], a[224:227], v[100:103], v[16:19]
    ds_read_b64_tr_b16 a[250:251], v231 offset:6144
    v_mfma_f32_16x16x32_bf16 v[20:23], a[228:231], v[100:103], v[20:23]
    ds_read_b64_tr_b16 a[252:253], v232 offset:4096
    v_mfma_f32_16x16x32_bf16 v[4:7], a[228:231], v[96:99], v[4:7]
    ds_read_b64_tr_b16 a[254:255], v232 offset:6144
    s_waitcnt lgkmcnt(8)
    v_mfma_f32_16x16x32_bf16 v[8:11], a[232:235], v[96:99], v[8:11]
    ds_read_b64_tr_b16 a[224:225], v229 offset:8192
    v_mfma_f32_16x16x32_bf16 v[24:27], a[232:235], v[100:103], v[24:27]
    ds_read_b64_tr_b16 a[226:227], v229 offset:10240
    v_mfma_f32_16x16x32_bf16 v[28:31], a[236:239], v[100:103], v[28:31]
    ds_read_b64_tr_b16 a[228:229], v230 offset:8192
    v_mfma_f32_16x16x32_bf16 v[12:15], a[236:239], v[96:99], v[12:15]
    ds_read_b64_tr_b16 a[230:231], v230 offset:10240
    s_waitcnt vmcnt(16) lgkmcnt(8)
    v_mfma_f32_16x16x32_bf16 v[0:3], a[240:243], v[104:107], v[0:3]
    ds_read_b64_tr_b16 a[232:233], v229 offset:12288
    v_mfma_f32_16x16x32_bf16 v[16:19], a[240:243], v[108:111], v[16:19]
    ds_read_b64_tr_b16 a[234:235], v229 offset:14336
    v_mfma_f32_16x16x32_bf16 v[20:23], a[244:247], v[108:111], v[20:23]
    ds_read_b64_tr_b16 a[236:237], v230 offset:12288
    v_mfma_f32_16x16x32_bf16 v[4:7], a[244:247], v[104:107], v[4:7]
    ds_read_b64_tr_b16 a[238:239], v230 offset:14336
    s_waitcnt lgkmcnt(8)
    v_mfma_f32_16x16x32_bf16 v[8:11], a[248:251], v[104:107], v[8:11]
    ds_read_b64_tr_b16 a[240:241], v229 offset:16384
    v_mfma_f32_16x16x32_bf16 v[24:27], a[248:251], v[108:111], v[24:27]
    ds_read_b64_tr_b16 a[242:243], v229 offset:18432
    v_mfma_f32_16x16x32_bf16 v[28:31], a[252:255], v[108:111], v[28:31]
    ds_read_b64_tr_b16 a[244:245], v230 offset:16384
    v_mfma_f32_16x16x32_bf16 v[12:15], a[252:255], v[104:107], v[12:15]
    ds_read_b64_tr_b16 a[246:247], v230 offset:18432
    s_waitcnt vmcnt(14) lgkmcnt(8)
    v_mfma_f32_16x16x32_bf16 v[0:3], a[224:227], v[112:115], v[0:3]
    ds_read_b64_tr_b16 a[248:249], v229 offset:20480
    v_mfma_f32_16x16x32_bf16 v[16:19], a[224:227], v[116:119], v[16:19]
    ds_read_b64_tr_b16 a[250:251], v229 offset:22528
    v_mfma_f32_16x16x32_bf16 v[20:23], a[228:231], v[116:119], v[20:23]
    ds_read_b64_tr_b16 a[252:253], v230 offset:20480
    v_mfma_f32_16x16x32_bf16 v[4:7], a[228:231], v[112:115], v[4:7]
    ds_read_b64_tr_b16 a[254:255], v230 offset:22528
    s_waitcnt vmcnt(0) lgkmcnt(8)
    v_mfma_f32_16x16x32_bf16 v[0:3], a[232:235], v[120:123], v[0:3]
    ds_read_b64_tr_b16 a[224:225], v229 offset:32768
    v_permlane16_swap_b32 v64, v66
    v_permlane16_swap_b32 v65, v67
    v_mfma_f32_16x16x32_bf16 v[16:19], a[232:235], v[124:127], v[16:19]
    ds_read_b64_tr_b16 a[226:227], v229 offset:34816
    v_permlane16_swap_b32 v68, v70
    v_permlane16_swap_b32 v69, v71
    v_mfma_f32_16x16x32_bf16 v[20:23], a[236:239], v[124:127], v[20:23]
    ds_read_b64_tr_b16 a[228:229], v230 offset:32768
    v_permlane16_swap_b32 v72, v74
    v_permlane16_swap_b32 v73, v75
    v_mfma_f32_16x16x32_bf16 v[4:7], a[236:239], v[120:123], v[4:7]
    ds_read_b64_tr_b16 a[230:231], v230 offset:34816
    v_permlane16_swap_b32 v76, v78
    v_permlane16_swap_b32 v77, v79
    s_waitcnt lgkmcnt(8)
    v_mfma_f32_16x16x32_bf16 v[0:3], a[240:243], v[128:131], v[0:3]
    ds_read_b64_tr_b16 a[232:233], v229 offset:36864
    v_lshlrev_b32 v32, 16, v64
    v_and_b32 v33, 0xffff0000, v64
    v_mfma_f32_16x16x32_bf16 v[16:19], a[240:243], v[132:135], v[16:19]
    ds_read_b64_tr_b16 a[234:235], v229 offset:38912
    v_lshlrev_b32 v34, 16, v65
    v_and_b32 v35, 0xffff0000, v65
    v_mfma_f32_16x16x32_bf16 v[20:23], a[244:247], v[132:135], v[20:23]
    ds_read_b64_tr_b16 a[236:237], v230 offset:36864
    v_lshlrev_b32 v36, 16, v66
    v_and_b32 v37, 0xffff0000, v66
    v_mfma_f32_16x16x32_bf16 v[4:7], a[244:247], v[128:131], v[4:7]
    ds_read_b64_tr_b16 a[238:239], v230 offset:38912
    v_lshlrev_b32 v38, 16, v67
    v_and_b32 v39, 0xffff0000, v67
    s_waitcnt lgkmcnt(8)
    v_mfma_f32_16x16x32_bf16 v[0:3], a[248:251], v[136:139], v[0:3]
    s_branch L_po_K_8
.p2align 12
L_pg_K_8:
    s_branch L_vret
L_po_K_8:
    ds_read_b64_tr_b16 a[240:241], v231 offset:8192
    v_lshlrev_b32 v40, 16, v68
    v_and_b32 v41, 0xffff0000, v68
    v_mfma_f32_16x16x32_bf16 v[16:19], a[248:251], v[140:143], v[16:19]
    ds_read_b64_tr_b16 a[242:243], v231 offset:10240
    v_lshlrev_b32 v42, 16, v69
    v_and_b32 v43, 0xffff0000, v69
    v_mfma_f32_16x16x32_bf16 v[20:23], a[252:255], v[140:143], v[20:23]
    ds_read_b64_tr_b16 a[244:245], v232 offset:8192
    v_lshlrev_b32 v44, 16, v70
    v_and_b32 v45, 0xffff0000, v70
    v_mfma_f32_16x16x32_bf16 v[4:7], a[252:255], v[136:139], v[4:7]
    ds_read_b64_tr_b16 a[246:247], v232 offset:10240
    v_lshlrev_b32 v46, 16, v71
    v_and_b32 v47, 0xffff0000, v71
    s_waitcnt lgkmcnt(8)
    v_mfma_f32_16x16x32_bf16 v[0:3], a[224:227], v[144:147], v[0:3]
    ds_read_b64_tr_b16 a[248:249], v231 offset:12288
    v_lshlrev_b32 v48, 16, v72
    v_and_b32 v49, 0xffff0000, v72
    v_mfma_f32_16x16x32_bf16 v[16:19], a[224:227], v[148:151], v[16:19]
    ds_read_b64_tr_b16 a[250:251], v231 offset:14336
    v_lshlrev_b32 v50, 16, v73
    v_and_b32 v51, 0xffff0000, v73
    v_mfma_f32_16x16x32_bf16 v[20:23], a[228:231], v[148:151], v[20:23]
    ds_read_b64_tr_b16 a[252:253], v232 offset:12288
    v_lshlrev_b32 v52, 16, v74
    v_and_b32 v53, 0xffff0000, v74
    v_mfma_f32_16x16x32_bf16 v[4:7], a[228:231], v[144:147], v[4:7]
    ds_read_b64_tr_b16 a[254:255], v232 offset:14336
    v_lshlrev_b32 v54, 16, v75
    v_and_b32 v55, 0xffff0000, v75
    s_waitcnt lgkmcnt(8)
    v_mfma_f32_16x16x32_bf16 v[0:3], a[232:235], v[152:155], v[0:3]
    ds_read_b64_tr_b16 a[224:225], v231 offset:16384
    v_lshlrev_b32 v56, 16, v76
    v_and_b32 v57, 0xffff0000, v76
    v_mfma_f32_16x16x32_bf16 v[16:19], a[232:235], v[156:159], v[16:19]
    ds_read_b64_tr_b16 a[226:227], v231 offset:18432
    v_lshlrev_b32 v58, 16, v77
    v_and_b32 v59, 0xffff0000, v77
    v_mfma_f32_16x16x32_bf16 v[20:23], a[236:239], v[156:159], v[20:23]
    ds_read_b64_tr_b16 a[228:229], v232 offset:16384
    v_lshlrev_b32 v60, 16, v78
    v_and_b32 v61, 0xffff0000, v78
    v_mfma_f32_16x16x32_bf16 v[4:7], a[236:239], v[152:155], v[4:7]
    ds_read_b64_tr_b16 a[230:231], v232 offset:18432
    v_lshlrev_b32 v62, 16, v79
    v_and_b32 v63, 0xffff0000, v79
    s_waitcnt lgkmcnt(8)
    v_mfma_f32_16x16x32_bf16 v[8:11], a[240:243], v[112:115], v[8:11]
    ds_read_b64_tr_b16 a[232:233], v231 offset:20480
    v_mfma_f32_16x16x32_bf16 v[24:27], a[240:243], v[116:119], v[24:27]
    ds_read_b64_tr_b16 a[234:235], v231 offset:22528
    v_mfma_f32_16x16x32_bf16 v[28:31], a[244:247], v[116:119], v[28:31]
    ds_read_b64_tr_b16 a[236:237], v232 offset:20480
    v_add_f32 v0, v0, v32
    v_add_f32 v1, v1, v33
    v_mfma_f32_16x16x32_bf16 v[12:15], a[244:247], v[112:115], v[12:15]
    ds_read_b64_tr_b16 a[238:239], v232 offset:22528
    v_add_f32 v2, v2, v34
    s_waitcnt lgkmcnt(8)
    v_mfma_f32_16x16x32_bf16 v[8:11], a[248:251], v[120:123], v[8:11]
    ds_read_b64_tr_b16 a[240:241], v231 offset:32768
    v_add_f32 v3, v3, v35
    v_add_f32 v16, v16, v48
    v_mfma_f32_16x16x32_bf16 v[24:27], a[248:251], v[124:127], v[24:27]
    ds_read_b64_tr_b16 a[242:243], v231 offset:34816
    v_add_f32 v17, v17, v49
    v_mfma_f32_16x16x32_bf16 v[28:31], a[252:255], v[124:127], v[28:31]
    ds_read_b64_tr_b16 a[244:245], v232 offset:32768
    v_add_f32 v18, v18, v50
    v_add_f32 v19, v19, v51
    v_mfma_f32_16x16x32_bf16 v[12:15], a[252:255], v[120:123], v[12:15]
    ds_read_b64_tr_b16 a[246:247], v232 offset:34816
    v_add_f32 v4, v4, v36
    s_waitcnt lgkmcnt(8)
    v_mfma_f32_16x16x32_bf16 v[8:11], a[224:227], v[128:131], v[8:11]
    ds_read_b64_tr_b16 a[248:249], v231 offset:36864
    v_add_f32 v5, v5, v37
    v_add_f32 v6, v6, v38
    v_mfma_f32_16x16x32_bf16 v[24:27], a[224:227], v[132:135], v[24:27]
    ds_read_b64_tr_b16 a[250:251], v231 offset:38912
    v_add_f32 v7, v7, v39
    v_mfma_f32_16x16x32_bf16 v[28:31], a[228:231], v[132:135], v[28:31]
    ds_read_b64_tr_b16 a[252:253], v232 offset:36864
    v_add_f32 v20, v20, v52
    v_add_f32 v21, v21, v53
    v_mfma_f32_16x16x32_bf16 v[12:15], a[228:231], v[128:131], v[12:15]
    ds_read_b64_tr_b16 a[254:255], v232 offset:38912
    v_add_f32 v22, v22, v54
    s_waitcnt lgkmcnt(8)
    v_mfma_f32_16x16x32_bf16 v[8:11], a[232:235], v[136:139], v[8:11]
    v_add_f32 v23, v23, v55
    v_mfma_f32_16x16x32_bf16 v[24:27], a[232:235], v[140:143], v[24:27]
    v_cvt_pk_bf16_f32 v64, v0, v1
    v_mfma_f32_16x16x32_bf16 v[28:31], a[236:239], v[140:143], v[28:31]
    v_cvt_pk_bf16_f32 v65, v2, v3
    v_cvt_pk_bf16_f32 v66, v4, v5
    v_mfma_f32_16x16x32_bf16 v[12:15], a[236:239], v[136:139], v[12:15]
    v_cvt_pk_bf16_f32 v67, v6, v7
    s_waitcnt lgkmcnt(4)
    v_mfma_f32_16x16x32_bf16 v[8:11], a[240:243], v[144:147], v[8:11]
    v_cvt_pk_bf16_f32 v72, v16, v17
    v_cvt_pk_bf16_f32 v73, v18, v19
    v_mfma_f32_16x16x32_bf16 v[24:27], a[240:243], v[148:151], v[24:27]
    v_cvt_pk_bf16_f32 v74, v20, v21
    v_mfma_f32_16x16x32_bf16 v[28:31], a[244:247], v[148:151], v[28:31]
    v_cvt_pk_bf16_f32 v75, v22, v23
    s_nop 1
    v_mfma_f32_16x16x32_bf16 v[12:15], a[244:247], v[144:147], v[12:15]
    v_permlane16_swap_b32 v64, v66
    s_waitcnt lgkmcnt(0)
    v_mfma_f32_16x16x32_bf16 v[8:11], a[248:251], v[152:155], v[8:11]
    v_permlane16_swap_b32 v65, v67
    buffer_store_dwordx4 v[64:67], v239, s[32:35], s65 offen offset:0
    v_mfma_f32_16x16x32_bf16 v[24:27], a[248:251], v[156:159], v[24:27]
    v_permlane16_swap_b32 v72, v74
    v_mfma_f32_16x16x32_bf16 v[28:31], a[252:255], v[156:159], v[28:31]
    v_permlane16_swap_b32 v73, v75
    v_mfma_f32_16x16x32_bf16 v[12:15], a[252:255], v[152:155], v[12:15]
    buffer_store_dwordx4 v[72:75], v239, s[32:35], s65 offen offset:2048
    s_nop 7
    v_pk_add_f32 v[8:9], v[8:9], v[40:41]
    v_pk_add_f32 v[10:11], v[10:11], v[42:43]
    v_pk_add_f32 v[12:13], v[12:13], v[44:45]
    v_pk_add_f32 v[14:15], v[14:15], v[46:47]
    v_pk_add_f32 v[24:25], v[24:25], v[56:57]
    v_pk_add_f32 v[26:27], v[26:27], v[58:59]
    v_pk_add_f32 v[28:29], v[28:29], v[60:61]
    v_pk_add_f32 v[30:31], v[30:31], v[62:63]
    v_cvt_pk_bf16_f32 v68, v8, v9
    v_cvt_pk_bf16_f32 v69, v10, v11
    v_cvt_pk_bf16_f32 v70, v12, v13
    v_cvt_pk_bf16_f32 v71, v14, v15
    v_cvt_pk_bf16_f32 v76, v24, v25
    v_cvt_pk_bf16_f32 v77, v26, v27
    v_cvt_pk_bf16_f32 v78, v28, v29
    v_cvt_pk_bf16_f32 v79, v30, v31
    s_nop 1
    v_permlane16_swap_b32 v68, v70
    v_permlane16_swap_b32 v69, v71
    buffer_store_dwordx4 v[68:71], v239, s[32:35], s65 offen offset:64
    v_permlane16_swap_b32 v76, v78
    v_permlane16_swap_b32 v77, v79
    buffer_store_dwordx4 v[76:79], v239, s[32:35], s65 offen offset:2112
    s_or_b32 s69, s2, s3
    s_cmp_lg_u32 s69, 0
    s_cbranch_scc1 L_noep_67
    s_add_u32 s27, s27, 1
    v_mov_b32 v243, s27
    s_mov_b32 s69, 0x5c000
    s_mov_b64 exec, 1
    buffer_store_dword v243, off, s[44:47], s69 sc1
    s_mov_b64 exec, -1
L_noep_67:
    s_endpgm
L_k3pre_43:
    buffer_store_dwordx4 v[80:83], v224, s[36:39], s12 offen offset:0 sc1
    buffer_store_dwordx4 v[84:87], v224, s[36:39], s12 offen offset:1024 sc1
    buffer_store_dwordx4 v[88:91], v224, s[36:39], s13 offen offset:0 sc1
    buffer_store_dwordx4 v[92:95], v224, s[36:39], s13 offen offset:1024 sc1
    s_bfe_u32 s68, s2, 0x20001
    s_lshl_b32 s68, s68, 2
    s_lshr_b32 s69, s2, 6
    s_add_u32 s68, s68, s69
    s_lshl_b32 s64, s68, 2
    s_add_u32 s64, s64, s3
    s_mul_i32 s67, s64, 180224
    s_add_u32 s67, s67, 0x400000
    v_lshrrev_b32 v200, 4, v224
    v_bfe_u32 v246, v224, 2, 7
    s_lshr_b32 s69, s96, 1
    s_lshr_b32 s71, s68, 1
    s_sub_u32 s71, s71, s69
    s_lshl_b32 s69, s69, 12
    s_add_u32 s69, s69, 311296
    v_and_b32 v203, 15, v200
    v_lshl_add_u32 v203, s3, 4, v203
    v_lshrrev_b32 v201, 5, v203
    v_mul_i32_i24 v201, s71, v201
    v_and_b32 v202, 31, v203
    v_lshl_add_u32 v201, v201, 5, v202
    v_lshl_add_u32 v240, v201, 7, s69
    v_and_b32 v202, 7, v200
    v_lshrrev_b32 v202, v202, 8
    v_and_b32 v202, 1, v202
    v_lshlrev_b32 v202, 7, v202
    v_sub_u32 v241, v240, v202
    v_and_b32 v245, 1, v200
    v_lshl_add_u32 v245, v245, 7, s48
    s_lshr_b32 s71, s68, 1
    s_lshl_b32 s71, s71, 12
    s_add_u32 s71, s71, 311680
    v_and_b32 v240, 3, v200
    v_lshl_add_u32 v240, v240, 10, s71
    s_mul_i32 s72, s96, 458752
    s_lshl_b32 s69, s97, 11
    s_add_u32 s72, s72, s69
    s_add_u32 s72, s72, 0x1000000
    s_and_b32 s71, s48, 0x20000
    s_lshl_b32 s71, s71, 13
    s_add_u32 s72, s72, s71
    s_mul_i32 s76, s96, 720896
    s_add_u32 s76, s76, s69
    s_add_u32 s76, s76, 0x410000
    s_add_u32 s73, s72, 114688
    s_add_u32 s77, s76, 180224
    s_add_u32 s74, s73, 114688
    s_add_u32 s78, s77, 180224
    s_add_u32 s75, s74, 114688
    s_add_u32 s79, s78, 180224
    s_lshl_b32 s69, s68, 11
    s_add_u32 s69, s69, 344064
    v_min_u32 v201, 13, v200
    v_lshl_add_u32 v242, v201, 7, s69
    s_lshr_b32 s69, s97, 2
    s_lshl_b32 s66, s96, 11
    s_lshl_b32 s69, s69, 7
    s_add_u32 s66, s66, s69
    s_add_u32 s66, s66, 344064
    s_and_b32 s70, s2, 1
    s_lshl_b32 s70, s70, 3
    s_bfe_u32 s69, s2, 0x30003
    s_add_u32 s70, s70, s69
    s_lshl_b32 s70, s70, 7
    s_lshl_b32 s65, s64, 16
    s_add_u32 s65, s65, s70
    v_add_u32 v237, s55, v224
    v_add_u32 v238, 0x10000, v237
    v_lshrrev_b32 v201, 2, v200
    v_and_b32 v202, 3, v200
    v_bfe_u32 v203, v200, 3, 2
    v_lshlrev_b32 v201, 7, v201
    v_lshl_add_u32 v201, v202, 3, v201
    v_xor_b32 v202, 0, v203
    v_lshl_add_u32 v229, v202, 5, v201
    v_add_u32 v233, 0x10000, v229
    v_xor_b32 v202, 1, v203
    v_lshl_add_u32 v230, v202, 5, v201
    v_add_u32 v234, 0x10000, v230
    v_xor_b32 v202, 2, v203
    v_lshl_add_u32 v231, v202, 5, v201
    v_add_u32 v235, 0x10000, v231
    v_xor_b32 v202, 3, v203
    v_lshl_add_u32 v232, v202, 5, v201
    v_add_u32 v236, 0x10000, v232
    v_and_b32 v201, 15, v200
    v_lshlrev_b32 v201, 12, v201
    v_bfe_u32 v202, v200, 4, 1
    v_bfe_u32 v203, v200, 5, 1
    v_lshl_add_u32 v201, v202, 5, v201
    v_lshl_add_u32 v239, v203, 4, v201
    s_mov_b32 s63, 0
L_poll_68:
    buffer_load_dword v243, v241, s[44:47], 0 offen sc1
    s_waitcnt vmcnt(0)
    v_cmp_ne_u32 vcc, s26, v243
    s_add_u32 s63, s63, 1
    s_cmp_eq_u64 vcc, 0
    s_cbranch_scc1 L_polled_69
    s_sleep 2
    s_cmp_lt_u32 s63, 200000
    s_cbranch_scc1 L_poll_68
    s_endpgm
L_polled_69:
    s_barrier
    s_cmp_lg_u32 s3, 0
    s_cbranch_scc1 L_noflag_70
    v_mbcnt_lo_u32_b32 v249, -1, 0
    v_mov_b32 v248, s26
    v_lshlrev_b32 v249, 2, v249
    s_mov_b32 exec_hi, 0
    buffer_store_dword v248, v249, s[44:47], s50 offen sc1
    s_mov_b64 exec, -1
L_noflag_70:
    buffer_load_dwordx4 v[96:99], v224, s[36:39], s67 offen offset:0 sc1
    buffer_load_dwordx4 v[100:103], v224, s[36:39], s67 offen offset:1024 sc1
    buffer_load_dwordx4 v[104:107], v224, s[36:39], s67 offen offset:2048 sc1
    buffer_load_dwordx4 v[108:111], v224, s[36:39], s67 offen offset:3072 sc1
    s_add_u32 s67, s67, 4096
    buffer_load_dwordx4 v[112:115], v224, s[36:39], s67 offen offset:0 sc1
    buffer_load_dwordx4 v[116:119], v224, s[36:39], s67 offen offset:1024 sc1
    buffer_load_dwordx4 v[120:123], v224, s[36:39], s67 offen offset:2048 sc1
    buffer_load_dwordx4 v[124:127], v224, s[36:39], s67 offen offset:3072 sc1
    s_add_u32 s67, s67, 4096
    buffer_load_dwordx4 v[128:131], v224, s[36:39], s67 offen offset:0 sc1
    buffer_load_dwordx4 v[132:135], v224, s[36:39], s67 offen offset:1024 sc1
    buffer_load_dwordx4 v[136:139], v224, s[36:39], s67 offen offset:2048 sc1
    buffer_load_dwordx4 v[140:143], v224, s[36:39], s67 offen offset:3072 sc1
    s_add_u32 s67, s67, 8192
    buffer_load_dwordx4 v[144:147], v224, s[36:39], s67 offen offset:0 sc1
    buffer_load_dwordx4 v[148:151], v224, s[36:39], s67 offen offset:1024 sc1
    buffer_load_dwordx4 v[152:155], v224, s[36:39], s67 offen offset:2048 sc1
    buffer_load_dwordx4 v[156:159], v224, s[36:39], s67 offen offset:3072 sc1
    s_add_u32 s67, s67, 4096
    s_add_u32 m0, s55, 65536
    s_nop 0
    buffer_load_dwordx4 v247, s[40:43], s54 offen lds
    s_add_u32 s54, s54, 65536
    s_add_u32 m0, s55, 69632
    s_nop 0
    buffer_load_dwordx4 v247, s[40:43], s54 offen lds
    s_add_u32 s54, s54, 65536
    s_add_u32 m0, s55, 73728
    s_nop 0
    buffer_load_dwordx4 v247, s[40:43], s54 offen lds
    s_add_u32 s54, s54, 65536
    s_add_u32 m0, s55, 77824
    s_nop 0
    buffer_load_dwordx4 v247, s[40:43], s54 offen lds
    s_add_u32 s54, s54, 65536
    s_add_u32 m0, s55, 81920
    s_nop 0
    buffer_load_dwordx4 v247, s[40:43], s54 offen lds
    s_add_u32 s54, s54, 65536
    s_add_u32 m0, s55, 86016
    s_nop 0
    buffer_load_dwordx4 v247, s[40:43], s54 offen lds
    s_add_u32 s54, s54, 65536
    s_add_u32 m0, s55, 90112
    s_nop 0
    buffer_load_dwordx4 v247, s[40:43], s54 offen lds
    s_add_u32 s54, s54, 65536
    s_add_u32 m0, s55, 94208
    s_nop 0
    buffer_load_dwordx4 v247, s[40:43], s54 offen lds
    s_add_u32 s54, s54, 65536
    s_add_u32 m0, s55, 98304
    s_nop 0
    buffer_load_dwordx4 v247, s[40:43], s54 offen lds
    s_add_u32 s54, s54, 65536
    s_add_u32 m0, s55, 102400
    s_nop 0
    buffer_load_dwordx4 v247, s[40:43], s54 offen lds
    s_add_u32 s54, s54, 65536
    s_add_u32 m0, s55, 106496
    s_nop 0
    buffer_load_dwordx4 v247, s[40:43], s54 offen lds
    s_add_u32 s54, s54, 65536
    s_add_u32 m0, s55, 110592
    s_nop 0
    buffer_load_dwordx4 v247, s[40:43], s54 offen lds
    s_add_u32 s54, s54, 65536
    s_add_u32 m0, s55, 114688
    s_nop 0
    buffer_load_dwordx4 v247, s[40:43], s54 offen lds
    s_add_u32 s54, s54, 65536
    s_add_u32 m0, s55, 118784
    s_nop 0
    buffer_load_dwordx4 v247, s[40:43], s54 offen lds
    s_add_u32 s54, s54, 65536
    s_add_u32 m0, s55, 122880
    s_nop 0
    buffer_load_dwordx4 v247, s[40:43], s54 offen lds
    s_add_u32 s54, s54, 65536
    s_add_u32 m0, s55, 126976
    s_nop 0
    buffer_load_dwordx4 v247, s[40:43], s54 offen lds
    s_add_u32 s54, s54, 65536
    s_waitcnt vmcnt(16)
    s_branch L_ujoin_60
L_lzf_32:
    v_bfe_u32 v0, v224, 2, 7
    s_waitcnt vmcnt(15)
    buffer_store_dword v244, v0, s[44:47], s48 offen sc1
    s_branch L_lzf_ret_33
L_check_55:
    s_mov_b32 s63, 0
L_poll_71:
    buffer_load_dword v243, v241, s[44:47], 0 offen sc1
    s_waitcnt vmcnt(0)
    v_cmp_ne_u32 vcc, s26, v243
    s_add_u32 s63, s63, 1
    s_cmp_eq_u64 vcc, 0
    s_cbranch_scc1 L_polled_72
    s_sleep 2
    s_cmp_lt_u32 s63, 200000
    s_cbranch_scc1 L_poll_71
    s_endpgm
L_polled_72:
    s_branch L_check_ret_56
L_check_57:
    s_mov_b32 s63, 0
L_poll_73:
    buffer_load_dword v243, v245, s[44:47], 0 offen sc1
    s_waitcnt vmcnt(0)
    v_cmp_ne_u32 vcc, s26, v243
    s_add_u32 s63, s63, 1
    s_cmp_eq_u64 vcc, 0
    s_cbranch_scc1 L_polled_74
    s_sleep 2
    s_cmp_lt_u32 s63, 200000
    s_cbranch_scc1 L_poll_73
    s_endpgm
L_polled_74:
    s_branch L_check_ret_58
L_check_63:
    s_mov_b32 s63, 0
L_poll_75:
    buffer_load_dword v243, v240, s[44:47], 0 offen sc1
    s_waitcnt vmcnt(0)
    v_cmp_ne_u32 vcc, s26, v243
    s_add_u32 s63, s63, 1
    s_cmp_eq_u64 vcc, 0
    s_cbranch_scc1 L_polled_76
    s_sleep 2
    s_cmp_lt_u32 s63, 200000
    s_cbranch_scc1 L_poll_75
    s_endpgm
L_polled_76:
    s_branch L_check_ret_64
L_check_65:
    s_mov_b32 s63, 0
L_poll_77:
    buffer_load_dword v243, v242, s[44:47], 0 offen sc1
    s_waitcnt vmcnt(0)
    v_cmp_ne_u32 vcc, s26, v243
    s_add_u32 s63, s63, 1
    s_cmp_eq_u64 vcc, 0
    s_cbranch_scc1 L_polled_78
    s_sleep 2
    s_cmp_lt_u32 s63, 200000
    s_cbranch_scc1 L_poll_77
    s_endpgm
L_polled_78:
    s_branch L_check_ret_66
L_exit:
    s_endpgm
.section .rodata,"a"
.p2align 6
.amdhsa_kernel parallel_sum__sliding_local_dilated__mixer_gmlp__prompt_kernel
  .amdhsa_next_free_vgpr 512
  .amdhsa_next_free_sgpr 102
  .amdhsa_accum_offset 256
  .amdhsa_group_segment_fixed_size 0
  .amdhsa_kernarg_size 88
  .amdhsa_user_sgpr_count 2
  .amdhsa_user_sgpr_kernarg_segment_ptr 1
  .amdhsa_system_sgpr_workgroup_id_x 1
  .amdhsa_float_denorm_mode_32 3
  .amdhsa_float_denorm_mode_16_64 3
.end_amdhsa_kernel
```
